```python
import torch

def _softmax(x, axis=-1):
    return torch.softmax(x, dim=axis)
def _gelu(x):
    return torch.nn.functional.gelu(x, approximate="tanh")
def _silu(x):
    return torch.nn.functional.silu(x)
def _sigmoid(x):
    return torch.sigmoid(x)
def _layernorm(x, axis=-1, eps=1e-5):
    m = x.mean(dim=axis, keepdim=True)
    v = x.var(dim=axis, keepdim=True, unbiased=False)
    return (x - m) / torch.sqrt(v + eps)
def _scatter_add(tgt, idx, src, axis=0):
    return tgt.clone().index_add_(axis, idx, src)
def _segment_sum(src, seg, n):
    out = torch.zeros((n,) + src.shape[1:], dtype=src.dtype)
    return out.index_add_(0, seg, src)
def _pad(x, pw):
    flat = tuple(v for pair in reversed(pw) for v in pair)
    return torch.nn.functional.pad(x, flat)

kernel_name = 'sequential_preLN__ssm_conv_s4__moe_arch_mod__prompt'

def setup_inputs():

    _w = (lambda a: (lambda t: t.to(torch.bfloat16) if t.is_floating_point() else t)(torch.as_tensor(a)))
    def _A_setup():
        B, L, D, N = 1, 2048, 576, 128
        A_re = -(lambda _x: torch.exp(torch.as_tensor(_x)))((lambda *s: torch.randn(*s, dtype=torch.bfloat16) * 1.6)(D, N))
        A_im = torch.pi * (lambda *s: torch.randn(*s, dtype=torch.bfloat16) * 0.2)(D, N)
        B_re = (lambda *s: torch.randn(*s, dtype=torch.bfloat16) * 0.2)(D, N)
        B_im = (lambda *s: torch.randn(*s, dtype=torch.bfloat16) * 0.2)(D, N)
        C_re = (lambda *s: torch.randn(*s, dtype=torch.bfloat16) * 0.2)(D, N)
        C_im = (lambda *s: torch.randn(*s, dtype=torch.bfloat16) * 0.2)(D, N)
        log_dt = (lambda *s: torch.randn(*s, dtype=torch.bfloat16) * 0.2)(D) * 0.5 - 4.0
        Dskip = (lambda *s: torch.randn(*s, dtype=torch.bfloat16) * 0.2)(D)
        return {
            "u": _w((lambda *s: torch.randn(*s, dtype=torch.bfloat16) * 0.05)(B, L, D)),
            "A_re": _w(A_re),
            "A_im": _w(A_im),
            "B_re": _w(B_re),
            "B_im": _w(B_im),
            "C_re": _w(C_re),
            "C_im": _w(C_im),
            "log_dt": _w(log_dt),
            "Dskip": _w(Dskip),
        }
    _A_in = _A_setup()

    def _B_setup():
        B, S, D, F, C = 1, 2048, 576, 4608, 8
        return {
            "x": _w((lambda *s: torch.randn(*s, dtype=torch.bfloat16) * 0.05)(B, S, D)),
            "w_r": _w((lambda *s: torch.randn(*s, dtype=torch.bfloat16) * 0.2)(D)),
            "w_gate": _w((lambda *s: torch.randn(*s, dtype=torch.bfloat16) * 0.2)(D, F)),
            "w_up": _w((lambda *s: torch.randn(*s, dtype=torch.bfloat16) * 0.2)(D, F)),
            "w_down": _w((lambda *s: torch.randn(*s, dtype=torch.bfloat16) * 0.2)(F, D)),
        }
    _B_in = _B_setup()

    return {
        "A_u": _A_in["u"],
        "A_A_re": _A_in["A_re"],
        "A_A_im": _A_in["A_im"],
        "A_B_re": _A_in["B_re"],
        "A_B_im": _A_in["B_im"],
        "A_C_re": _A_in["C_re"],
        "A_C_im": _A_in["C_im"],
        "A_log_dt": _A_in["log_dt"],
        "A_Dskip": _A_in["Dskip"],
        "B_x": _B_in["x"],
        "B_w_r": _B_in["w_r"],
        "B_w_gate": _B_in["w_gate"],
        "B_w_up": _B_in["w_up"],
        "B_w_down": _B_in["w_down"],
    }

def reference(A_u, A_A_re, A_A_im, A_B_re, A_B_im, A_C_re, A_C_im, A_log_dt, A_Dskip, B_x, B_w_r, B_w_gate, B_w_up, B_w_down):
    def _A_ref(u, A_re, A_im, B_re, B_im, C_re, C_im, log_dt, Dskip):
        Bsz, L, D = u.shape
        dt = torch.exp(log_dt)[:, None]
        A = A_re + 1j * A_im
        Bc = B_re + 1j * B_im
        Cc = C_re + 1j * C_im
        logdA = dt * A
        dB = dt * Bc
        l = (lambda x, dt: x.to(dt))(torch.arange(L), A_re.dtype)
        P = torch.exp(logdA[:, :, None] * l[None, None, :])
        K = torch.einsum("dn,dnl,dn->dl", Cc, P, dB).real
        L2 = 2 * L
        Kp = _pad(K, ((0, 0), (0, L)))
        up = (lambda x, *d: x.permute(*d))(u, 0, 2, 1)
        up = _pad(up, ((0, 0), (0, 0), (0, L)))
        Kf = (lambda x, axes=(-2,-1): torch.fft.rfft2(x.float(), dim=axes))(Kp[:, None, :], axes=(-2, -1))
        Uf = (lambda x, axes=(-2,-1): torch.fft.rfft2(x.float(), dim=axes))(up[:, :, None, :], axes=(-2, -1))
        Yf = Uf * Kf[None, :, :, :]
        y = (lambda x, s, axes=(-2,-1): torch.fft.irfft2(x, s=s, dim=axes).to(torch.bfloat16))(Yf, (1, L2), axes=(-2, -1))[:, :, 0, :L]
        y = (lambda x, *d: x.permute(*d))(y, 0, 2, 1) + u * Dskip[None, None, :]
        return y

    def _B_ref(x, w_r, w_gate, w_up, w_down):
        B, S, D = x.shape
        C = 8
        r = x @ w_r
        idx = torch.argsort(-r, axis=-1)[:, :C]
        idx_e = (lambda x, n, axis: torch.repeat_interleave(x, n, dim=axis))(idx.reshape(B, C, 1), D, axis=2)
        x_sel = (lambda x, i, axis: torch.take_along_dim(x, i, dim=axis))(x, idx_e, axis=1)
        g = _silu(x_sel @ w_gate)
        u = x_sel @ w_up
        y = (g * u) @ w_down
        r_sel = _sigmoid((lambda x, i, axis: torch.take_along_dim(x, i, dim=axis))(r, idx, axis=1))
        y = y * r_sel.reshape(B, C, 1)
        b_off = (torch.arange(B) * S).reshape(B, 1)
        flat_idx = (idx + b_off).reshape(B * C)
        zero = (x * 0.0).reshape(B * S, D)
        upd = _scatter_add(zero, flat_idx, y.reshape(B * C, D), axis=0)
        return x + upd.reshape(B, S, D)

    x = A_u
    h = x + _A_ref(_layernorm(x, axis=-1), A_A_re, A_A_im, A_B_re, A_B_im, A_C_re, A_C_im, A_log_dt, A_Dskip)
    h2 = h + _B_ref(_layernorm(h, axis=-1), B_w_r, B_w_gate, B_w_up, B_w_down)
    return h2
```

```asm
; @launch kernel=prep_kernel grid=(832,1,1) block=(256,1,1) lds=37888
; @launch kernel=conv_kernel grid=(576,1,1) block=(256,1,1) lds=29184
; @launch kernel=ln2_kernel grid=(256,1,1) block=(256,1,1) lds=9280
; @launch kernel=ffn_kernel grid=(288,1,1) block=(256,1,1) lds=61952
; @launch kernel=fin_kernel grid=(288,1,1) block=(128,1,1) lds=2048
.amdgcn_target "amdgcn-amd-amdhsa--gfx950"
    .text
    .globl prep_kernel
    .p2align 8
    .type prep_kernel,@function
prep_kernel:
    s_cmp_ge_u32 s2, 832
    s_cbranch_scc1 K1_END
    s_load_dwordx2 s[4:5], s[0:1], 128
    s_cmp_ge_u32 s2, 256
    s_cbranch_scc1 K1_KGEN
    s_load_dwordx2 s[6:7], s[0:1], 0
    s_mov_b32 s40, 0x3ae38e39
    v_lshrrev_b32 v1, 5, v0
    v_and_b32 v2, 31, v0
    s_lshl_b32 s3, s2, 3
    v_add_u32 v3, s3, v1
    s_movk_i32 s16, 1152
    v_mul_lo_u32 v3, v3, s16
    v_lshl_add_u32 v3, v2, 2, v3
    s_waitcnt lgkmcnt(0)
    s_mov_b32 s8, s6
    s_mov_b32 s9, s7
    s_mov_b32 s10, 2359296
    s_mov_b32 s11, 0x00020000
    s_mov_b32 s12, s4
    s_mov_b32 s13, s5
    s_mov_b32 s14, 2359296
    s_mov_b32 s15, 0x00020000
    buffer_load_dword v40, v3, s[8:11], 0 offen offset:0
    buffer_load_dword v41, v3, s[8:11], 0 offen offset:128
    buffer_load_dword v42, v3, s[8:11], 0 offen offset:256
    buffer_load_dword v43, v3, s[8:11], 0 offen offset:384
    buffer_load_dword v44, v3, s[8:11], 0 offen offset:512
    buffer_load_dword v45, v3, s[8:11], 0 offen offset:640
    buffer_load_dword v46, v3, s[8:11], 0 offen offset:768
    buffer_load_dword v47, v3, s[8:11], 0 offen offset:896
    buffer_load_dword v48, v3, s[8:11], 0 offen offset:1024
    v_lshlrev_b32 v4, 5, v2
    v_sub_u32 v5, 7, v1
    v_lshl_add_u32 v4, v5, 1, v4
    s_waitcnt vmcnt(8)
    v_lshlrev_b32 v10, 16, v40
    v_and_b32 v11, 0xffff0000, v40
    s_waitcnt vmcnt(7)
    v_lshlrev_b32 v12, 16, v41
    v_and_b32 v13, 0xffff0000, v41
    s_waitcnt vmcnt(6)
    v_lshlrev_b32 v14, 16, v42
    v_and_b32 v15, 0xffff0000, v42
    s_waitcnt vmcnt(5)
    v_lshlrev_b32 v16, 16, v43
    v_and_b32 v17, 0xffff0000, v43
    s_waitcnt vmcnt(4)
    v_lshlrev_b32 v18, 16, v44
    v_and_b32 v19, 0xffff0000, v44
    s_waitcnt vmcnt(3)
    v_lshlrev_b32 v20, 16, v45
    v_and_b32 v21, 0xffff0000, v45
    s_waitcnt vmcnt(2)
    v_lshlrev_b32 v22, 16, v46
    v_and_b32 v23, 0xffff0000, v46
    s_waitcnt vmcnt(1)
    v_lshlrev_b32 v24, 16, v47
    v_and_b32 v25, 0xffff0000, v47
    s_waitcnt vmcnt(0)
    v_lshlrev_b32 v26, 16, v48
    v_and_b32 v27, 0xffff0000, v48
    v_add_f32 v30, v10, v11
    v_add_f32 v31, v12, v13
    v_add_f32 v30, v30, v14
    v_add_f32 v31, v31, v15
    v_add_f32 v30, v30, v16
    v_add_f32 v31, v31, v17
    v_add_f32 v30, v30, v18
    v_add_f32 v31, v31, v19
    v_add_f32 v30, v30, v20
    v_add_f32 v31, v31, v21
    v_add_f32 v30, v30, v22
    v_add_f32 v31, v31, v23
    v_add_f32 v30, v30, v24
    v_add_f32 v31, v31, v25
    v_add_f32 v30, v30, v26
    v_add_f32 v31, v31, v27
    v_add_f32 v30, v30, v31
    s_nop 1
    v_add_f32_dpp v30, v30, v30 quad_perm:[1,0,3,2] row_mask:0xf bank_mask:0xf
    s_nop 1
    v_add_f32_dpp v30, v30, v30 quad_perm:[2,3,0,1] row_mask:0xf bank_mask:0xf
    s_nop 1
    v_add_f32_dpp v30, v30, v30 row_half_mirror row_mask:0xf bank_mask:0xf
    s_nop 1
    v_add_f32_dpp v30, v30, v30 row_mirror row_mask:0xf bank_mask:0xf
    v_mov_b32 v31, v30
    s_nop 1
    v_permlane16_swap_b32 v30, v31
    v_add_f32 v30, v30, v31
    v_mul_f32 v32, s40, v30
    v_sub_f32 v34, v10, v32
    v_sub_f32 v35, v11, v32
    v_mul_f32 v30, v34, v34
    v_mul_f32 v31, v35, v35
    v_sub_f32 v34, v12, v32
    v_sub_f32 v35, v13, v32
    v_fmac_f32 v30, v34, v34
    v_fmac_f32 v31, v35, v35
    v_sub_f32 v34, v14, v32
    v_sub_f32 v35, v15, v32
    v_fmac_f32 v30, v34, v34
    v_fmac_f32 v31, v35, v35
    v_sub_f32 v34, v16, v32
    v_sub_f32 v35, v17, v32
    v_fmac_f32 v30, v34, v34
    v_fmac_f32 v31, v35, v35
    v_sub_f32 v34, v18, v32
    v_sub_f32 v35, v19, v32
    v_fmac_f32 v30, v34, v34
    v_fmac_f32 v31, v35, v35
    v_sub_f32 v34, v20, v32
    v_sub_f32 v35, v21, v32
    v_fmac_f32 v30, v34, v34
    v_fmac_f32 v31, v35, v35
    v_sub_f32 v34, v22, v32
    v_sub_f32 v35, v23, v32
    v_fmac_f32 v30, v34, v34
    v_fmac_f32 v31, v35, v35
    v_sub_f32 v34, v24, v32
    v_sub_f32 v35, v25, v32
    v_fmac_f32 v30, v34, v34
    v_fmac_f32 v31, v35, v35
    v_sub_f32 v34, v26, v32
    v_sub_f32 v35, v27, v32
    v_fmac_f32 v30, v34, v34
    v_fmac_f32 v31, v35, v35
    v_add_f32 v30, v30, v31
    s_nop 1
    v_add_f32_dpp v30, v30, v30 quad_perm:[1,0,3,2] row_mask:0xf bank_mask:0xf
    s_nop 1
    v_add_f32_dpp v30, v30, v30 quad_perm:[2,3,0,1] row_mask:0xf bank_mask:0xf
    s_nop 1
    v_add_f32_dpp v30, v30, v30 row_half_mirror row_mask:0xf bank_mask:0xf
    s_nop 1
    v_add_f32_dpp v30, v30, v30 row_mirror row_mask:0xf bank_mask:0xf
    v_mov_b32 v31, v30
    s_nop 1
    v_permlane16_swap_b32 v30, v31
    v_add_f32 v30, v30, v31
    v_mul_f32 v30, s40, v30
    v_cvt_pk_bf16_f32 v30, v30, v30
    v_lshlrev_b32 v30, 16, v30
    v_cvt_pk_bf16_f32 v32, v32, v32
    v_lshlrev_b32 v32, 16, v32
    v_add_f32 v30, 0x3727c5ac, v30
    v_cvt_pk_bf16_f32 v30, v30, v30
    v_lshlrev_b32 v30, 16, v30
    v_sqrt_f32 v30, v30
    s_nop 0
    v_cvt_pk_bf16_f32 v30, v30, v30
    v_lshlrev_b32 v30, 16, v30
    v_rcp_f32 v33, v30
    v_sub_f32 v10, v10, v32
    v_sub_f32 v11, v11, v32
    v_cvt_pk_bf16_f32 v11, v10, v11
    v_lshlrev_b32 v10, 16, v11
    v_and_b32 v11, 0xffff0000, v11
    v_mul_f32 v10, v10, v33
    v_mul_f32 v11, v11, v33
    v_cvt_pk_bf16_f32 v40, v10, v11
    v_sub_f32 v12, v12, v32
    v_sub_f32 v13, v13, v32
    v_cvt_pk_bf16_f32 v13, v12, v13
    v_lshlrev_b32 v12, 16, v13
    v_and_b32 v13, 0xffff0000, v13
    v_mul_f32 v12, v12, v33
    v_mul_f32 v13, v13, v33
    v_cvt_pk_bf16_f32 v41, v12, v13
    v_sub_f32 v14, v14, v32
    v_sub_f32 v15, v15, v32
    v_cvt_pk_bf16_f32 v15, v14, v15
    v_lshlrev_b32 v14, 16, v15
    v_and_b32 v15, 0xffff0000, v15
    v_mul_f32 v14, v14, v33
    v_mul_f32 v15, v15, v33
    v_cvt_pk_bf16_f32 v42, v14, v15
    v_sub_f32 v16, v16, v32
    v_sub_f32 v17, v17, v32
    v_cvt_pk_bf16_f32 v17, v16, v17
    v_lshlrev_b32 v16, 16, v17
    v_and_b32 v17, 0xffff0000, v17
    v_mul_f32 v16, v16, v33
    v_mul_f32 v17, v17, v33
    v_cvt_pk_bf16_f32 v43, v16, v17
    v_sub_f32 v18, v18, v32
    v_sub_f32 v19, v19, v32
    v_cvt_pk_bf16_f32 v19, v18, v19
    v_lshlrev_b32 v18, 16, v19
    v_and_b32 v19, 0xffff0000, v19
    v_mul_f32 v18, v18, v33
    v_mul_f32 v19, v19, v33
    v_cvt_pk_bf16_f32 v44, v18, v19
    v_sub_f32 v20, v20, v32
    v_sub_f32 v21, v21, v32
    v_cvt_pk_bf16_f32 v21, v20, v21
    v_lshlrev_b32 v20, 16, v21
    v_and_b32 v21, 0xffff0000, v21
    v_mul_f32 v20, v20, v33
    v_mul_f32 v21, v21, v33
    v_cvt_pk_bf16_f32 v45, v20, v21
    v_sub_f32 v22, v22, v32
    v_sub_f32 v23, v23, v32
    v_cvt_pk_bf16_f32 v23, v22, v23
    v_lshlrev_b32 v22, 16, v23
    v_and_b32 v23, 0xffff0000, v23
    v_mul_f32 v22, v22, v33
    v_mul_f32 v23, v23, v33
    v_cvt_pk_bf16_f32 v46, v22, v23
    v_sub_f32 v24, v24, v32
    v_sub_f32 v25, v25, v32
    v_cvt_pk_bf16_f32 v25, v24, v25
    v_lshlrev_b32 v24, 16, v25
    v_and_b32 v25, 0xffff0000, v25
    v_mul_f32 v24, v24, v33
    v_mul_f32 v25, v25, v33
    v_cvt_pk_bf16_f32 v47, v24, v25
    v_sub_f32 v26, v26, v32
    v_sub_f32 v27, v27, v32
    v_cvt_pk_bf16_f32 v27, v26, v27
    v_lshlrev_b32 v26, 16, v27
    v_and_b32 v27, 0xffff0000, v27
    v_mul_f32 v26, v26, v33
    v_mul_f32 v27, v27, v33
    v_cvt_pk_bf16_f32 v48, v26, v27
    ds_write_b16 v4, v40 offset:0
    ds_write_b16_d16_hi v4, v40 offset:16
    ds_write_b16 v4, v41 offset:1024
    ds_write_b16_d16_hi v4, v41 offset:1040
    ds_write_b16 v4, v42 offset:2048
    ds_write_b16_d16_hi v4, v42 offset:2064
    ds_write_b16 v4, v43 offset:3072
    ds_write_b16_d16_hi v4, v43 offset:3088
    ds_write_b16 v4, v44 offset:4096
    ds_write_b16_d16_hi v4, v44 offset:4112
    ds_write_b16 v4, v45 offset:5120
    ds_write_b16_d16_hi v4, v45 offset:5136
    ds_write_b16 v4, v46 offset:6144
    ds_write_b16_d16_hi v4, v46 offset:6160
    ds_write_b16 v4, v47 offset:7168
    ds_write_b16_d16_hi v4, v47 offset:7184
    ds_write_b16 v4, v48 offset:8192
    ds_write_b16_d16_hi v4, v48 offset:8208
    v_lshlrev_b32 v5, 4, v0
    s_mul_i32 s3, s2, 9216
    s_waitcnt lgkmcnt(0)
    s_barrier
    ds_read_b128 v[10:13], v5
    ds_read_b128 v[14:17], v5 offset:4096
    ds_read_b128 v[18:21], v5 offset:8192
    s_waitcnt lgkmcnt(2)
    buffer_store_dwordx4 v[10:13], v5, s[12:15], s3 offen
    v_add_u32 v6, 4096, v5
    s_waitcnt lgkmcnt(1)
    buffer_store_dwordx4 v[14:17], v6, s[12:15], s3 offen
    v_cmp_gt_u32 vcc, 64, v0
    s_nop 0
    s_and_saveexec_b64 s[20:21], vcc
    s_cbranch_execz K1_END
    v_add_u32 v6, 8192, v5
    s_waitcnt lgkmcnt(0)
    buffer_store_dwordx4 v[18:21], v6, s[12:15], s3 offen
    s_endpgm
K1_KGEN:
    s_load_dwordx4 s[8:11], s[0:1], 8
    s_load_dwordx4 s[12:15], s[0:1], 24
    s_load_dwordx4 s[16:19], s[0:1], 40
    s_load_dwordx2 s[20:21], s[0:1], 56
    s_sub_u32 s3, s2, 256
    v_and_b32 v1, 127, v0
    s_lshl_b32 s6, s3, 8
    v_lshl_add_u32 v2, v1, 1, s6
    s_lshl_b32 s7, s3, 1
    v_mov_b32 v3, s7
    s_mov_b32 s42, 0x3e22f983
    s_mov_b32 s43, 0x31dc9c88
    v_readfirstlane_b32 s44, v0
    s_nop 0
    s_lshr_b32 s44, s44, 6
    s_waitcnt lgkmcnt(0)
    s_mov_b32 s48, s8
    s_mov_b32 s49, s9
    s_mov_b32 s50, 147456
    s_mov_b32 s51, 0x00020000
    s_mov_b32 s52, s10
    s_mov_b32 s53, s11
    s_mov_b32 s54, 147456
    s_mov_b32 s55, 0x00020000
    s_mov_b32 s56, s12
    s_mov_b32 s57, s13
    s_mov_b32 s58, 147456
    s_mov_b32 s59, 0x00020000
    s_mov_b32 s60, s14
    s_mov_b32 s61, s15
    s_mov_b32 s62, 147456
    s_mov_b32 s63, 0x00020000
    s_mov_b32 s64, s16
    s_mov_b32 s65, s17
    s_mov_b32 s66, 147456
    s_mov_b32 s67, 0x00020000
    s_mov_b32 s68, s18
    s_mov_b32 s69, s19
    s_mov_b32 s70, 147456
    s_mov_b32 s71, 0x00020000
    s_mov_b32 s72, s20
    s_mov_b32 s73, s21
    s_mov_b32 s74, 1152
    s_mov_b32 s75, 0x00020000
    buffer_load_ushort v10, v3, s[72:75], 0 offen
    buffer_load_ushort v11, v2, s[48:51], 0 offen
    buffer_load_ushort v12, v2, s[52:55], 0 offen
    buffer_load_ushort v13, v2, s[56:59], 0 offen
    buffer_load_ushort v14, v2, s[60:63], 0 offen
    buffer_load_ushort v15, v2, s[64:67], 0 offen
    buffer_load_ushort v16, v2, s[68:71], 0 offen
    s_lshl_b32 s6, s3, 12
    s_add_u32 s6, s6, 2359296
    s_add_u32 s76, s4, s6
    s_addc_u32 s77, s5, 0
    s_movk_i32 s78, 4096
    s_mov_b32 s79, 0x00020000
    v_lshlrev_b32 v4, 2, v1
    s_waitcnt vmcnt(6)
    v_lshlrev_b32 v10, 16, v10
    s_mov_b32 s45, 0x3fb8aa3b
    s_mov_b32 s46, 0x32a57060
    v_mul_f32 v20, s45, v10
    v_fma_f32 v21, v10, s45, -v20
    v_fmac_f32 v21, s46, v10
    v_exp_f32 v20, v20
    v_mul_f32 v21, 0x3f317218, v21
    v_fma_f32 v20, v20, v21, v20
    v_cvt_pk_bf16_f32 v20, v20, v20
    v_lshlrev_b32 v20, 16, v20
    s_waitcnt vmcnt(0)
    v_lshlrev_b32 v11, 16, v11
    v_lshlrev_b32 v12, 16, v12
    v_lshlrev_b32 v13, 16, v13
    v_lshlrev_b32 v14, 16, v14
    v_lshlrev_b32 v15, 16, v15
    v_lshlrev_b32 v16, 16, v16
    v_mul_f32 v11, v11, v20
    v_mul_f32 v12, v12, v20
    v_mul_f32 v13, v13, v20
    v_mul_f32 v14, v14, v20
    v_mul_f32 v11, s45, v11
    v_mul_f32 v22, v15, v13
    v_mul_f32 v23, v15, v14
    v_fma_f32 v22, -v16, v14, v22
    v_fmac_f32 v23, v16, v13
    s_mov_b32 s41, 0x43000000
    v_mul_f32 v30, s41, v11
    v_exp_f32 v30, v30
    v_mul_f32 v31, s41, v12
    v_mul_f32 v32, s42, v31
    v_fma_f32 v24, v31, s42, -v32
    v_fmac_f32 v24, s43, v31
    v_fract_f32 v32, v32
    v_add_f32 v32, v32, v24
    v_cos_f32 v24, v32
    v_sin_f32 v25, v32
    v_mul_f32 v24, v24, v30
    v_mul_f32 v25, v25, v30
    s_cmp_ge_u32 s44, 2
    s_cbranch_scc1 K1_ROLE1
    s_mov_b32 s41, 0x41000000
    v_mul_f32 v30, s41, v11
    v_exp_f32 v30, v30
    v_mul_f32 v31, s41, v12
    v_mul_f32 v32, s42, v31
    v_fma_f32 v26, v31, s42, -v32
    v_fmac_f32 v26, s43, v31
    v_fract_f32 v32, v32
    v_add_f32 v32, v32, v26
    v_cos_f32 v26, v32
    v_sin_f32 v27, v32
    v_mul_f32 v26, v26, v30
    v_mul_f32 v27, v27, v30
    s_mov_b32 s41, 0x44800000
    v_mul_f32 v30, s41, v11
    v_exp_f32 v30, v30
    v_mul_f32 v31, s41, v12
    v_mul_f32 v32, s42, v31
    v_fma_f32 v28, v31, s42, -v32
    v_fmac_f32 v28, s43, v31
    v_fract_f32 v32, v32
    v_add_f32 v32, v32, v28
    v_cos_f32 v28, v32
    v_sin_f32 v29, v32
    v_mul_f32 v28, v28, v30
    v_mul_f32 v29, v29, v30
    v_mul_f32 v34, v22, v28
    v_mul_f32 v35, v22, v29
    v_fma_f32 v34, -v23, v29, v34
    v_fmac_f32 v35, v23, v28
    v_mov_b32 v36, 1.0
    v_mov_b32 v37, 0
    v_cvt_pk_bf16_f32 v40, v36, -v37
    ds_write_b32 v4, v40 offset:26112
    v_cvt_pk_bf16_f32 v41, v26, -v27
    ds_write_b32 v4, v41 offset:26656
    v_cvt_pk_bf16_f32 v42, v34, v35
    ds_write_b32 v4, v42 offset:17408
    v_mov_b32 v44, v26
    v_mov_b32 v45, v27
    v_mul_f32 v36, v26, v44
    v_mul_f32 v37, v26, v45
    v_fma_f32 v36, -v27, v45, v36
    v_fmac_f32 v37, v27, v44
    v_mul_f32 v38, v34, v24
    v_mul_f32 v39, v34, v25
    v_fma_f32 v38, -v35, v25, v38
    v_fmac_f32 v39, v35, v24
    v_cvt_pk_bf16_f32 v40, v36, -v37
    ds_write_b32 v4, v40 offset:27200
    v_cvt_pk_bf16_f32 v41, v38, v39
    ds_write_b32 v4, v41 offset:17952
    v_mul_f32 v26, v36, v44
    v_mul_f32 v27, v36, v45
    v_fma_f32 v26, -v37, v45, v26
    v_fmac_f32 v27, v37, v44
    v_mul_f32 v34, v38, v24
    v_mul_f32 v35, v38, v25
    v_fma_f32 v34, -v39, v25, v34
    v_fmac_f32 v35, v39, v24
    v_cvt_pk_bf16_f32 v40, v26, -v27
    ds_write_b32 v4, v40 offset:27744
    v_cvt_pk_bf16_f32 v41, v34, v35
    ds_write_b32 v4, v41 offset:18496
    v_mul_f32 v36, v26, v44
    v_mul_f32 v37, v26, v45
    v_fma_f32 v36, -v27, v45, v36
    v_fmac_f32 v37, v27, v44
    v_mul_f32 v38, v34, v24
    v_mul_f32 v39, v34, v25
    v_fma_f32 v38, -v35, v25, v38
    v_fmac_f32 v39, v35, v24
    v_cvt_pk_bf16_f32 v40, v36, -v37
    ds_write_b32 v4, v40 offset:28288
    v_cvt_pk_bf16_f32 v41, v38, v39
    ds_write_b32 v4, v41 offset:19040
    v_mul_f32 v26, v36, v44
    v_mul_f32 v27, v36, v45
    v_fma_f32 v26, -v37, v45, v26
    v_fmac_f32 v27, v37, v44
    v_mul_f32 v34, v38, v24
    v_mul_f32 v35, v38, v25
    v_fma_f32 v34, -v39, v25, v34
    v_fmac_f32 v35, v39, v24
    v_cvt_pk_bf16_f32 v40, v26, -v27
    ds_write_b32 v4, v40 offset:28832
    v_cvt_pk_bf16_f32 v41, v34, v35
    ds_write_b32 v4, v41 offset:19584
    v_mul_f32 v36, v26, v44
    v_mul_f32 v37, v26, v45
    v_fma_f32 v36, -v27, v45, v36
    v_fmac_f32 v37, v27, v44
    v_mul_f32 v38, v34, v24
    v_mul_f32 v39, v34, v25
    v_fma_f32 v38, -v35, v25, v38
    v_fmac_f32 v39, v35, v24
    v_cvt_pk_bf16_f32 v40, v36, -v37
    ds_write_b32 v4, v40 offset:29376
    v_cvt_pk_bf16_f32 v41, v38, v39
    ds_write_b32 v4, v41 offset:20128
    v_mul_f32 v26, v36, v44
    v_mul_f32 v27, v36, v45
    v_fma_f32 v26, -v37, v45, v26
    v_fmac_f32 v27, v37, v44
    v_mul_f32 v34, v38, v24
    v_mul_f32 v35, v38, v25
    v_fma_f32 v34, -v39, v25, v34
    v_fmac_f32 v35, v39, v24
    v_cvt_pk_bf16_f32 v40, v26, -v27
    ds_write_b32 v4, v40 offset:29920
    v_cvt_pk_bf16_f32 v41, v34, v35
    ds_write_b32 v4, v41 offset:20672
    v_mul_f32 v36, v26, v44
    v_mul_f32 v37, v26, v45
    v_fma_f32 v36, -v27, v45, v36
    v_fmac_f32 v37, v27, v44
    v_mul_f32 v38, v34, v24
    v_mul_f32 v39, v34, v25
    v_fma_f32 v38, -v35, v25, v38
    v_fmac_f32 v39, v35, v24
    v_cvt_pk_bf16_f32 v40, v36, -v37
    ds_write_b32 v4, v40 offset:30464
    v_cvt_pk_bf16_f32 v41, v38, v39
    ds_write_b32 v4, v41 offset:21216
    v_mul_f32 v26, v36, v44
    v_mul_f32 v27, v36, v45
    v_fma_f32 v26, -v37, v45, v26
    v_fmac_f32 v27, v37, v44
    v_mul_f32 v34, v38, v24
    v_mul_f32 v35, v38, v25
    v_fma_f32 v34, -v39, v25, v34
    v_fmac_f32 v35, v39, v24
    v_cvt_pk_bf16_f32 v40, v26, -v27
    ds_write_b32 v4, v40 offset:31008
    v_cvt_pk_bf16_f32 v41, v34, v35
    ds_write_b32 v4, v41 offset:21760
    v_mul_f32 v36, v26, v44
    v_mul_f32 v37, v26, v45
    v_fma_f32 v36, -v27, v45, v36
    v_fmac_f32 v37, v27, v44
    v_cvt_pk_bf16_f32 v40, v36, -v37
    ds_write_b32 v4, v40 offset:31552
    v_mul_f32 v26, v36, v44
    v_mul_f32 v27, v36, v45
    v_fma_f32 v26, -v37, v45, v26
    v_fmac_f32 v27, v37, v44
    v_cvt_pk_bf16_f32 v40, v26, -v27
    ds_write_b32 v4, v40 offset:32096
    v_mul_f32 v36, v26, v44
    v_mul_f32 v37, v26, v45
    v_fma_f32 v36, -v27, v45, v36
    v_fmac_f32 v37, v27, v44
    v_cvt_pk_bf16_f32 v40, v36, -v37
    ds_write_b32 v4, v40 offset:32640
    v_mul_f32 v26, v36, v44
    v_mul_f32 v27, v36, v45
    v_fma_f32 v26, -v37, v45, v26
    v_fmac_f32 v27, v37, v44
    v_cvt_pk_bf16_f32 v40, v26, -v27
    ds_write_b32 v4, v40 offset:33184
    v_mul_f32 v36, v26, v44
    v_mul_f32 v37, v26, v45
    v_fma_f32 v36, -v27, v45, v36
    v_fmac_f32 v37, v27, v44
    v_cvt_pk_bf16_f32 v40, v36, -v37
    ds_write_b32 v4, v40 offset:33728
    v_mul_f32 v26, v36, v44
    v_mul_f32 v27, v36, v45
    v_fma_f32 v26, -v37, v45, v26
    v_fmac_f32 v27, v37, v44
    v_cvt_pk_bf16_f32 v40, v26, -v27
    ds_write_b32 v4, v40 offset:34272
    s_branch K1_MFMA
K1_ROLE1:
    s_mov_b32 s41, 0x3f800000
    v_mul_f32 v30, s41, v11
    v_exp_f32 v30, v30
    v_mul_f32 v31, s41, v12
    v_mul_f32 v32, s42, v31
    v_fma_f32 v26, v31, s42, -v32
    v_fmac_f32 v26, s43, v31
    v_fract_f32 v32, v32
    v_add_f32 v32, v32, v26
    v_cos_f32 v26, v32
    v_sin_f32 v27, v32
    v_mul_f32 v26, v26, v30
    v_mul_f32 v27, v27, v30
    s_mov_b32 s41, 0x40000000
    v_mul_f32 v30, s41, v11
    v_exp_f32 v30, v30
    v_mul_f32 v31, s41, v12
    v_mul_f32 v32, s42, v31
    v_fma_f32 v28, v31, s42, -v32
    v_fmac_f32 v28, s43, v31
    v_fract_f32 v32, v32
    v_add_f32 v32, v32, v28
    v_cos_f32 v28, v32
    v_sin_f32 v29, v32
    v_mul_f32 v28, v28, v30
    v_mul_f32 v29, v29, v30
    s_mov_b32 s41, 0x40800000
    v_mul_f32 v30, s41, v11
    v_exp_f32 v30, v30
    v_mul_f32 v31, s41, v12
    v_mul_f32 v32, s42, v31
    v_fma_f32 v44, v31, s42, -v32
    v_fmac_f32 v44, s43, v31
    v_fract_f32 v32, v32
    v_add_f32 v32, v32, v44
    v_cos_f32 v44, v32
    v_sin_f32 v45, v32
    v_mul_f32 v44, v44, v30
    v_mul_f32 v45, v45, v30
    v_mov_b32 v50, v22
    v_mov_b32 v51, v23
    v_mul_f32 v52, v50, v24
    v_mul_f32 v53, v50, v25
    v_fma_f32 v52, -v51, v25, v52
    v_fmac_f32 v53, v51, v24
    v_mul_f32 v54, v52, v24
    v_mul_f32 v55, v52, v25
    v_fma_f32 v54, -v53, v25, v54
    v_fmac_f32 v55, v53, v24
    v_mul_f32 v56, v54, v24
    v_mul_f32 v57, v54, v25
    v_fma_f32 v56, -v55, v25, v56
    v_fmac_f32 v57, v55, v24
    v_mul_f32 v58, v56, v24
    v_mul_f32 v59, v56, v25
    v_fma_f32 v58, -v57, v25, v58
    v_fmac_f32 v59, v57, v24
    v_mul_f32 v60, v58, v24
    v_mul_f32 v61, v58, v25
    v_fma_f32 v60, -v59, v25, v60
    v_fmac_f32 v61, v59, v24
    v_mul_f32 v62, v60, v24
    v_mul_f32 v63, v60, v25
    v_fma_f32 v62, -v61, v25, v62
    v_fmac_f32 v63, v61, v24
    v_mul_f32 v64, v62, v24
    v_mul_f32 v65, v62, v25
    v_fma_f32 v64, -v63, v25, v64
    v_fmac_f32 v65, v63, v24
    v_cvt_pk_bf16_f32 v40, v50, v51
    ds_write_b32 v4, v40 offset:0
    v_cvt_pk_bf16_f32 v41, v52, v53
    ds_write_b32 v4, v41 offset:4352
    v_cvt_pk_bf16_f32 v40, v54, v55
    ds_write_b32 v4, v40 offset:8704
    v_cvt_pk_bf16_f32 v41, v56, v57
    ds_write_b32 v4, v41 offset:10880
    v_cvt_pk_bf16_f32 v40, v58, v59
    ds_write_b32 v4, v40 offset:13056
    v_cvt_pk_bf16_f32 v41, v60, v61
    ds_write_b32 v4, v41 offset:14144
    v_cvt_pk_bf16_f32 v40, v62, v63
    ds_write_b32 v4, v40 offset:15232
    v_cvt_pk_bf16_f32 v41, v64, v65
    ds_write_b32 v4, v41 offset:16320
    v_mul_f32 v34, v58, v44
    v_mul_f32 v35, v58, v45
    v_fma_f32 v34, -v59, v45, v34
    v_fmac_f32 v35, v59, v44
    v_cvt_pk_bf16_f32 v40, v34, v35
    ds_write_b32 v4, v40 offset:13600
    v_mul_f32 v34, v60, v44
    v_mul_f32 v35, v60, v45
    v_fma_f32 v34, -v61, v45, v34
    v_fmac_f32 v35, v61, v44
    v_cvt_pk_bf16_f32 v41, v34, v35
    ds_write_b32 v4, v41 offset:14688
    v_mul_f32 v34, v62, v44
    v_mul_f32 v35, v62, v45
    v_fma_f32 v34, -v63, v45, v34
    v_fmac_f32 v35, v63, v44
    v_cvt_pk_bf16_f32 v40, v34, v35
    ds_write_b32 v4, v40 offset:15776
    v_mul_f32 v34, v64, v44
    v_mul_f32 v35, v64, v45
    v_fma_f32 v34, -v65, v45, v34
    v_fmac_f32 v35, v65, v44
    v_cvt_pk_bf16_f32 v41, v34, v35
    ds_write_b32 v4, v41 offset:16864
    v_mul_f32 v70, v50, v26
    v_mul_f32 v71, v50, v27
    v_fma_f32 v70, -v51, v27, v70
    v_fmac_f32 v71, v51, v26
    v_mul_f32 v72, v52, v26
    v_mul_f32 v73, v52, v27
    v_fma_f32 v72, -v53, v27, v72
    v_fmac_f32 v73, v53, v26
    v_mul_f32 v74, v54, v28
    v_mul_f32 v75, v54, v29
    v_fma_f32 v74, -v55, v29, v74
    v_fmac_f32 v75, v55, v28
    v_mul_f32 v76, v56, v28
    v_mul_f32 v77, v56, v29
    v_fma_f32 v76, -v57, v29, v76
    v_fmac_f32 v77, v57, v28
    v_cvt_pk_bf16_f32 v40, v70, v71
    ds_write_b32 v4, v40 offset:544
    v_cvt_pk_bf16_f32 v41, v72, v73
    ds_write_b32 v4, v41 offset:4896
    v_cvt_pk_bf16_f32 v40, v74, v75
    ds_write_b32 v4, v40 offset:9248
    v_cvt_pk_bf16_f32 v41, v76, v77
    ds_write_b32 v4, v41 offset:11424
    v_mul_f32 v50, v70, v26
    v_mul_f32 v51, v70, v27
    v_fma_f32 v50, -v71, v27, v50
    v_fmac_f32 v51, v71, v26
    v_mul_f32 v52, v72, v26
    v_mul_f32 v53, v72, v27
    v_fma_f32 v52, -v73, v27, v52
    v_fmac_f32 v53, v73, v26
    v_mul_f32 v54, v74, v28
    v_mul_f32 v55, v74, v29
    v_fma_f32 v54, -v75, v29, v54
    v_fmac_f32 v55, v75, v28
    v_mul_f32 v56, v76, v28
    v_mul_f32 v57, v76, v29
    v_fma_f32 v56, -v77, v29, v56
    v_fmac_f32 v57, v77, v28
    v_cvt_pk_bf16_f32 v40, v50, v51
    ds_write_b32 v4, v40 offset:1088
    v_cvt_pk_bf16_f32 v41, v52, v53
    ds_write_b32 v4, v41 offset:5440
    v_cvt_pk_bf16_f32 v40, v54, v55
    ds_write_b32 v4, v40 offset:9792
    v_cvt_pk_bf16_f32 v41, v56, v57
    ds_write_b32 v4, v41 offset:11968
    v_mul_f32 v70, v50, v26
    v_mul_f32 v71, v50, v27
    v_fma_f32 v70, -v51, v27, v70
    v_fmac_f32 v71, v51, v26
    v_mul_f32 v72, v52, v26
    v_mul_f32 v73, v52, v27
    v_fma_f32 v72, -v53, v27, v72
    v_fmac_f32 v73, v53, v26
    v_mul_f32 v74, v54, v28
    v_mul_f32 v75, v54, v29
    v_fma_f32 v74, -v55, v29, v74
    v_fmac_f32 v75, v55, v28
    v_mul_f32 v76, v56, v28
    v_mul_f32 v77, v56, v29
    v_fma_f32 v76, -v57, v29, v76
    v_fmac_f32 v77, v57, v28
    v_cvt_pk_bf16_f32 v40, v70, v71
    ds_write_b32 v4, v40 offset:1632
    v_cvt_pk_bf16_f32 v41, v72, v73
    ds_write_b32 v4, v41 offset:5984
    v_cvt_pk_bf16_f32 v40, v74, v75
    ds_write_b32 v4, v40 offset:10336
    v_cvt_pk_bf16_f32 v41, v76, v77
    ds_write_b32 v4, v41 offset:12512
    v_mul_f32 v50, v70, v26
    v_mul_f32 v51, v70, v27
    v_fma_f32 v50, -v71, v27, v50
    v_fmac_f32 v51, v71, v26
    v_mul_f32 v52, v72, v26
    v_mul_f32 v53, v72, v27
    v_fma_f32 v52, -v73, v27, v52
    v_fmac_f32 v53, v73, v26
    v_cvt_pk_bf16_f32 v40, v50, v51
    ds_write_b32 v4, v40 offset:2176
    v_cvt_pk_bf16_f32 v41, v52, v53
    ds_write_b32 v4, v41 offset:6528
    v_mul_f32 v70, v50, v26
    v_mul_f32 v71, v50, v27
    v_fma_f32 v70, -v51, v27, v70
    v_fmac_f32 v71, v51, v26
    v_mul_f32 v72, v52, v26
    v_mul_f32 v73, v52, v27
    v_fma_f32 v72, -v53, v27, v72
    v_fmac_f32 v73, v53, v26
    v_cvt_pk_bf16_f32 v40, v70, v71
    ds_write_b32 v4, v40 offset:2720
    v_cvt_pk_bf16_f32 v41, v72, v73
    ds_write_b32 v4, v41 offset:7072
    v_mul_f32 v50, v70, v26
    v_mul_f32 v51, v70, v27
    v_fma_f32 v50, -v71, v27, v50
    v_fmac_f32 v51, v71, v26
    v_mul_f32 v52, v72, v26
    v_mul_f32 v53, v72, v27
    v_fma_f32 v52, -v73, v27, v52
    v_fmac_f32 v53, v73, v26
    v_cvt_pk_bf16_f32 v40, v50, v51
    ds_write_b32 v4, v40 offset:3264
    v_cvt_pk_bf16_f32 v41, v52, v53
    ds_write_b32 v4, v41 offset:7616
    v_mul_f32 v70, v50, v26
    v_mul_f32 v71, v50, v27
    v_fma_f32 v70, -v51, v27, v70
    v_fmac_f32 v71, v51, v26
    v_mul_f32 v72, v52, v26
    v_mul_f32 v73, v52, v27
    v_fma_f32 v72, -v53, v27, v72
    v_fmac_f32 v73, v53, v26
    v_cvt_pk_bf16_f32 v40, v70, v71
    ds_write_b32 v4, v40 offset:3808
    v_cvt_pk_bf16_f32 v41, v72, v73
    ds_write_b32 v4, v41 offset:8160
K1_MFMA:
    v_and_b32 v5, 15, v0
    v_bfe_u32 v6, v0, 4, 2
    s_movk_i32 s6, 544
    v_mul_lo_u32 v7, v5, s6
    v_lshl_add_u32 v7, v6, 4, v7
    s_mul_i32 s7, s44, 8704
    v_add_u32 v8, s7, v7
    s_waitcnt lgkmcnt(0)
    s_barrier
    s_cmp_ge_u32 s44, 3
    s_cbranch_scc1 K1_EXPAND
    ds_read_b128 v[16:19], v8 offset:0
    ds_read_b128 v[20:23], v7 offset:26112
    ds_read_b128 v[24:27], v8 offset:64
    ds_read_b128 v[28:31], v7 offset:26176
    ds_read_b128 v[32:35], v8 offset:128
    ds_read_b128 v[36:39], v7 offset:26240
    ds_read_b128 v[40:43], v8 offset:192
    ds_read_b128 v[44:47], v7 offset:26304
    ds_read_b128 v[48:51], v8 offset:256
    ds_read_b128 v[52:55], v7 offset:26368
    ds_read_b128 v[56:59], v8 offset:320
    ds_read_b128 v[60:63], v7 offset:26432
    ds_read_b128 v[64:67], v8 offset:384
    ds_read_b128 v[68:71], v7 offset:26496
    ds_read_b128 v[72:75], v8 offset:448
    ds_read_b128 v[76:79], v7 offset:26560
    v_mov_b32 v12, 0
    v_mov_b32 v13, 0
    v_mov_b32 v14, 0
    v_mov_b32 v15, 0
    s_waitcnt lgkmcnt(14)
    s_nop 0
    v_mfma_f32_16x16x32_bf16 v[12:15], v[16:19], v[20:23], v[12:15]
    s_waitcnt lgkmcnt(12)
    v_mfma_f32_16x16x32_bf16 v[12:15], v[24:27], v[28:31], v[12:15]
    s_waitcnt lgkmcnt(10)
    v_mfma_f32_16x16x32_bf16 v[12:15], v[32:35], v[36:39], v[12:15]
    s_waitcnt lgkmcnt(8)
    v_mfma_f32_16x16x32_bf16 v[12:15], v[40:43], v[44:47], v[12:15]
    s_waitcnt lgkmcnt(6)
    v_mfma_f32_16x16x32_bf16 v[12:15], v[48:51], v[52:55], v[12:15]
    s_waitcnt lgkmcnt(4)
    v_mfma_f32_16x16x32_bf16 v[12:15], v[56:59], v[60:63], v[12:15]
    s_waitcnt lgkmcnt(2)
    v_mfma_f32_16x16x32_bf16 v[12:15], v[64:67], v[68:71], v[12:15]
    s_waitcnt lgkmcnt(0)
    v_mfma_f32_16x16x32_bf16 v[12:15], v[72:75], v[76:79], v[12:15]
    s_cmp_eq_u32 s44, 1
    s_cbranch_scc1 K1_T1
    s_cmp_eq_u32 s44, 2
    s_cbranch_scc1 K1_T2
    v_and_b32 v9, 1, v6
    v_lshlrev_b32 v9, 4, v9
    v_lshrrev_b32 v10, 1, v6
    v_lshl_add_u32 v9, v10, 9, v9
    v_lshl_add_u32 v9, v5, 5, v9
    s_nop 4
    ds_write_b128 v9, v[12:15] offset:34816
    s_branch K1_EXPAND
K1_T1:
    v_lshlrev_b32 v9, 8, v6
    v_lshl_add_u32 v10, v5, 4, v9
    v_lshl_add_u32 v11, v5, 3, v9
    v_cmp_gt_u32 vcc, 2, v6
    s_nop 1
    v_cndmask_b32 v9, v11, v10, vcc
    v_mov_b32 v10, 128
    v_cndmask_b32 v10, v10, 8, vcc
    v_add_u32 v10, v10, v9
    ds_write_b64 v9, v[12:13] offset:35840
    ds_write_b64 v10, v[14:15] offset:35840
    s_branch K1_EXPAND
K1_T2:
    v_lshlrev_b32 v9, 8, v6
    v_lshl_add_u32 v9, v5, 2, v9
    s_nop 6
    ds_write_b32 v9, v12 offset:36864
    ds_write_b32 v9, v13 offset:36928
    ds_write_b32 v9, v14 offset:36992
    ds_write_b32 v9, v15 offset:37056
K1_EXPAND:
    v_lshlrev_b32 v20, 3, v0
    v_cmp_gt_u32 vcc, 16, v0
    v_add_u32 v21, 0, v20
    v_add_u32 v22, 1, v20
    v_cvt_f32_u32 v23, v21
    v_cvt_f32_u32 v24, v22
    v_cvt_pk_bf16_f32 v23, v23, v24
    v_lshrrev_b32 v24, 16, v23
    v_and_b32 v23, 0xffff, v23
    v_subrev_u32 v23, 17024, v23
    v_subrev_u32 v24, 17024, v24
    v_cndmask_b32 v23, v23, v21, vcc
    v_cndmask_b32 v24, v24, v22, vcc
    v_lshlrev_b32 v30, 2, v23
    v_lshlrev_b32 v31, 2, v24
    v_add_u32 v21, 2, v20
    v_add_u32 v22, 3, v20
    v_cvt_f32_u32 v23, v21
    v_cvt_f32_u32 v24, v22
    v_cvt_pk_bf16_f32 v23, v23, v24
    v_lshrrev_b32 v24, 16, v23
    v_and_b32 v23, 0xffff, v23
    v_subrev_u32 v23, 17024, v23
    v_subrev_u32 v24, 17024, v24
    v_cndmask_b32 v23, v23, v21, vcc
    v_cndmask_b32 v24, v24, v22, vcc
    v_lshlrev_b32 v32, 2, v23
    v_lshlrev_b32 v33, 2, v24
    v_add_u32 v21, 4, v20
    v_add_u32 v22, 5, v20
    v_cvt_f32_u32 v23, v21
    v_cvt_f32_u32 v24, v22
    v_cvt_pk_bf16_f32 v23, v23, v24
    v_lshrrev_b32 v24, 16, v23
    v_and_b32 v23, 0xffff, v23
    v_subrev_u32 v23, 17024, v23
    v_subrev_u32 v24, 17024, v24
    v_cndmask_b32 v23, v23, v21, vcc
    v_cndmask_b32 v24, v24, v22, vcc
    v_lshlrev_b32 v34, 2, v23
    v_lshlrev_b32 v35, 2, v24
    v_add_u32 v21, 6, v20
    v_add_u32 v22, 7, v20
    v_cvt_f32_u32 v23, v21
    v_cvt_f32_u32 v24, v22
    v_cvt_pk_bf16_f32 v23, v23, v24
    v_lshrrev_b32 v24, 16, v23
    v_and_b32 v23, 0xffff, v23
    v_subrev_u32 v23, 17024, v23
    v_subrev_u32 v24, 17024, v24
    v_cndmask_b32 v23, v23, v21, vcc
    v_cndmask_b32 v24, v24, v22, vcc
    v_lshlrev_b32 v36, 2, v23
    v_lshlrev_b32 v37, 2, v24
    v_lshlrev_b32 v25, 4, v0
    s_waitcnt lgkmcnt(0)
    s_barrier
    ds_read_b32 v40, v30 offset:34816
    ds_read_b32 v41, v31 offset:34816
    ds_read_b32 v42, v32 offset:34816
    ds_read_b32 v43, v33 offset:34816
    ds_read_b32 v44, v34 offset:34816
    ds_read_b32 v45, v35 offset:34816
    ds_read_b32 v46, v36 offset:34816
    ds_read_b32 v47, v37 offset:34816
    s_waitcnt lgkmcnt(0)
    v_cvt_pk_bf16_f32 v48, v40, v41
    v_cvt_pk_bf16_f32 v49, v42, v43
    v_cvt_pk_bf16_f32 v50, v44, v45
    v_cvt_pk_bf16_f32 v51, v46, v47
    buffer_store_dwordx4 v[48:51], v25, s[76:79], 0 offen
K1_END:
    s_endpgm
    .text
    .globl conv_kernel
    .p2align 8
    .type conv_kernel,@function
conv_kernel:
    s_cmp_ge_u32 s2, 576
    s_cbranch_scc1 K2_END
    s_load_dwordx2 s[4:5], s[0:1], 128
    s_load_dwordx2 s[6:7], s[0:1], 64
    v_readfirstlane_b32 s44, v0
    s_nop 0
    s_lshr_b32 s44, s44, 6
    s_movk_i32 s16, 9216
    v_mul_lo_u32 v1, v0, s16
    s_lshl_b32 s3, s2, 4
    v_lshlrev_b32 v2, 4, v0
    s_lshl_b32 s17, s2, 1
    v_mov_b32 v3, s17
    s_waitcnt lgkmcnt(0)
    s_mov_b32 s8, s4
    s_mov_b32 s9, s5
    s_mov_b32 s10, 2359296
    s_mov_b32 s11, 0x00020000
    s_lshl_b32 s18, s2, 12
    s_add_u32 s18, s18, 2359296
    s_add_u32 s12, s4, s18
    s_addc_u32 s13, s5, 0
    s_movk_i32 s14, 4096
    s_mov_b32 s15, 0x00020000
    s_add_u32 s20, s4, 4718592
    s_addc_u32 s21, s5, 0
    s_mov_b32 s22, 2359296
    s_mov_b32 s23, 0x00020000
    s_mov_b32 s24, s6
    s_mov_b32 s25, s7
    s_mov_b32 s26, 1152
    s_mov_b32 s27, 0x00020000
    buffer_load_dwordx4 v[8:11], v1, s[8:11], s3 offen
    buffer_load_dwordx4 v[12:15], v2, s[12:15], 0 offen
    buffer_load_dwordx4 v[16:19], v2, s[12:15], 0 offen offset:4
    buffer_load_dword v20, v2, s[12:15], 0 offen offset:20
    v_subrev_u32 v5, 16, v2
    v_subrev_u32 v6, 12, v2
    v_mov_b32 v24, 0
    v_mov_b32 v25, 0
    v_mov_b32 v26, 0
    v_mov_b32 v27, 0
    v_mov_b32 v28, 0
    v_mov_b32 v29, 0
    v_mov_b32 v30, 0
    buffer_load_dword v31, v5, s[12:15], 0 offen
    buffer_load_dword v32, v6, s[12:15], 0 offen
    buffer_load_ushort v7, v3, s[24:27], 0 offen
    v_mov_b32 v36, 0
    v_mov_b32 v37, 0
    v_mov_b32 v38, 0
    v_mov_b32 v39, 0
    v_cmp_gt_u32 vcc, 32, v0
    s_nop 0
    s_and_saveexec_b64 s[30:31], vcc
    ds_write_b128 v2, v[36:39] offset:4096
    s_mov_b64 exec, s[30:31]
    v_sub_u32 v21, 4080, v2
    s_waitcnt vmcnt(6)
    ds_write_b128 v21, v[8:11]
    s_waitcnt vmcnt(3)
    ds_write_b128 v2, v[12:15] offset:4640
    ds_write_b128 v2, v[16:19] offset:12960
    v_alignbit_b32 v40, v16, v12, 16
    v_alignbit_b32 v41, v17, v13, 16
    v_alignbit_b32 v42, v18, v14, 16
    v_alignbit_b32 v43, v19, v15, 16
    v_alignbit_b32 v44, v17, v16, 16
    v_alignbit_b32 v45, v18, v17, 16
    v_alignbit_b32 v46, v19, v18, 16
    v_alignbit_b32 v47, v20, v19, 16
    ds_write_b128 v2, v[40:43] offset:8800
    ds_write_b128 v2, v[44:47] offset:17120
    v_cmp_gt_u32 vcc, 2, v0
    s_waitcnt vmcnt(1)
    s_and_saveexec_b64 s[30:31], vcc
    ds_write_b128 v2, v[24:27] offset:4608
    ds_write_b128 v2, v[28:31] offset:12928
    v_alignbit_b32 v48, v28, v24, 16
    v_alignbit_b32 v49, v29, v25, 16
    v_alignbit_b32 v50, v30, v26, 16
    v_alignbit_b32 v51, v31, v27, 16
    v_alignbit_b32 v52, v29, v28, 16
    v_alignbit_b32 v53, v30, v29, 16
    v_alignbit_b32 v54, v31, v30, 16
    v_alignbit_b32 v55, v32, v31, 16
    ds_write_b128 v2, v[48:51] offset:8768
    ds_write_b128 v2, v[52:55] offset:17088
    s_mov_b64 exec, s[30:31]
    v_and_b32 v4, 15, v0
    v_bfe_u32 v5, v0, 4, 2
    v_add_u32 v6, 1, v4
    v_and_b32 v8, 3, v6
    v_sub_u32 v6, v6, v8
    v_lshl_add_u32 v6, v5, 3, v6
    v_lshlrev_b32 v6, 1, v6
    s_movk_i32 s16, 4160
    v_mul_lo_u32 v8, v8, s16
    v_add_u32 v6, v6, v8
    s_lshl_b32 s17, s44, 6
    s_add_u32 s18, s17, 4608
    v_add_u32 v6, s18, v6
    v_lshlrev_b32 v8, 5, v4
    v_sub_u32 v8, 480, v8
    v_lshl_add_u32 v8, v5, 4, v8
    v_add_u32 v8, s17, v8
    v_mov_b32 v12, 0
    v_mov_b32 v13, 0
    v_mov_b32 v14, 0
    v_mov_b32 v15, 0
    v_mov_b32 v16, 0
    v_mov_b32 v17, 0
    v_mov_b32 v18, 0
    v_mov_b32 v19, 0
    v_mov_b32 v20, 0
    v_mov_b32 v21, 0
    v_mov_b32 v22, 0
    v_mov_b32 v23, 0
    v_mov_b32 v24, 0
    v_mov_b32 v25, 0
    v_mov_b32 v26, 0
    v_mov_b32 v27, 0
    v_mov_b32 v28, 0
    v_mov_b32 v29, 0
    v_mov_b32 v30, 0
    v_mov_b32 v31, 0
    v_mov_b32 v32, 0
    v_mov_b32 v33, 0
    v_mov_b32 v34, 0
    v_mov_b32 v35, 0
    v_mov_b32 v36, 0
    v_mov_b32 v37, 0
    v_mov_b32 v38, 0
    v_mov_b32 v39, 0
    v_mov_b32 v40, 0
    v_mov_b32 v41, 0
    v_mov_b32 v42, 0
    v_mov_b32 v43, 0
    s_waitcnt lgkmcnt(0)
    s_barrier
    ds_read_b64 v[44:45], v6 offset:0
    ds_read_b64 v[46:47], v6 offset:8
    ds_read_b128 v[76:79], v8 offset:3584
    ds_read_b64 v[48:49], v6 offset:512
    ds_read_b64 v[50:51], v6 offset:520
    ds_read_b128 v[80:83], v8 offset:3072
    ds_read_b64 v[52:53], v6 offset:1024
    ds_read_b64 v[54:55], v6 offset:1032
    ds_read_b128 v[84:87], v8 offset:2560
    ds_read_b64 v[56:57], v6 offset:1536
    ds_read_b64 v[58:59], v6 offset:1544
    ds_read_b128 v[88:91], v8 offset:2048
    ds_read_b64 v[60:61], v6 offset:2048
    ds_read_b64 v[62:63], v6 offset:2056
    ds_read_b128 v[92:95], v8 offset:1536
    ds_read_b64 v[64:65], v6 offset:2560
    ds_read_b64 v[66:67], v6 offset:2568
    ds_read_b128 v[96:99], v8 offset:1024
    ds_read_b64 v[68:69], v6 offset:3072
    ds_read_b64 v[70:71], v6 offset:3080
    ds_read_b128 v[100:103], v8 offset:512
    ds_read_b64 v[72:73], v6 offset:3584
    ds_read_b64 v[74:75], v6 offset:3592
    ds_read_b128 v[104:107], v8 offset:0
    s_waitcnt lgkmcnt(15)
    v_mfma_f32_16x16x32_bf16 v[12:15], v[44:47], v[76:79], v[12:15]
    s_waitcnt lgkmcnt(15)
    v_mfma_f32_16x16x32_bf16 v[16:19], v[48:51], v[76:79], v[16:19]
    v_mfma_f32_16x16x32_bf16 v[20:23], v[48:51], v[80:83], v[20:23]
    v_mfma_f32_16x16x32_bf16 v[16:19], v[44:47], v[80:83], v[16:19]
    s_waitcnt lgkmcnt(15)
    v_mfma_f32_16x16x32_bf16 v[20:23], v[52:55], v[76:79], v[20:23]
    v_mfma_f32_16x16x32_bf16 v[24:27], v[52:55], v[80:83], v[24:27]
    v_mfma_f32_16x16x32_bf16 v[28:31], v[52:55], v[84:87], v[28:31]
    v_mfma_f32_16x16x32_bf16 v[20:23], v[44:47], v[84:87], v[20:23]
    v_mfma_f32_16x16x32_bf16 v[24:27], v[48:51], v[84:87], v[24:27]
    s_waitcnt lgkmcnt(12)
    v_mfma_f32_16x16x32_bf16 v[24:27], v[56:59], v[76:79], v[24:27]
    v_mfma_f32_16x16x32_bf16 v[28:31], v[56:59], v[80:83], v[28:31]
    v_mfma_f32_16x16x32_bf16 v[32:35], v[56:59], v[84:87], v[32:35]
    v_mfma_f32_16x16x32_bf16 v[36:39], v[56:59], v[88:91], v[36:39]
    v_mfma_f32_16x16x32_bf16 v[24:27], v[44:47], v[88:91], v[24:27]
    v_mfma_f32_16x16x32_bf16 v[28:31], v[48:51], v[88:91], v[28:31]
    v_mfma_f32_16x16x32_bf16 v[32:35], v[52:55], v[88:91], v[32:35]
    s_waitcnt lgkmcnt(9)
    v_mfma_f32_16x16x32_bf16 v[28:31], v[60:63], v[76:79], v[28:31]
    v_mfma_f32_16x16x32_bf16 v[32:35], v[60:63], v[80:83], v[32:35]
    v_mfma_f32_16x16x32_bf16 v[36:39], v[60:63], v[84:87], v[36:39]
    v_mfma_f32_16x16x32_bf16 v[40:43], v[60:63], v[88:91], v[40:43]
    v_mfma_f32_16x16x32_bf16 v[28:31], v[44:47], v[92:95], v[28:31]
    v_mfma_f32_16x16x32_bf16 v[32:35], v[48:51], v[92:95], v[32:35]
    v_mfma_f32_16x16x32_bf16 v[36:39], v[52:55], v[92:95], v[36:39]
    v_mfma_f32_16x16x32_bf16 v[40:43], v[56:59], v[92:95], v[40:43]
    s_waitcnt lgkmcnt(6)
    v_mfma_f32_16x16x32_bf16 v[32:35], v[64:67], v[76:79], v[32:35]
    v_mfma_f32_16x16x32_bf16 v[36:39], v[64:67], v[80:83], v[36:39]
    v_mfma_f32_16x16x32_bf16 v[40:43], v[64:67], v[84:87], v[40:43]
    v_mfma_f32_16x16x32_bf16 v[32:35], v[44:47], v[96:99], v[32:35]
    v_mfma_f32_16x16x32_bf16 v[36:39], v[48:51], v[96:99], v[36:39]
    v_mfma_f32_16x16x32_bf16 v[40:43], v[52:55], v[96:99], v[40:43]
    s_waitcnt lgkmcnt(3)
    v_mfma_f32_16x16x32_bf16 v[36:39], v[68:71], v[76:79], v[36:39]
    v_mfma_f32_16x16x32_bf16 v[40:43], v[68:71], v[80:83], v[40:43]
    v_mfma_f32_16x16x32_bf16 v[36:39], v[44:47], v[100:103], v[36:39]
    v_mfma_f32_16x16x32_bf16 v[40:43], v[48:51], v[100:103], v[40:43]
    s_waitcnt lgkmcnt(0)
    v_mfma_f32_16x16x32_bf16 v[40:43], v[72:75], v[76:79], v[40:43]
    v_mfma_f32_16x16x32_bf16 v[40:43], v[44:47], v[104:107], v[40:43]
    ds_read_b64 v[108:109], v6 offset:256
    ds_read_b64 v[110:111], v6 offset:264
    ds_read_b128 v[140:143], v8 offset:3840
    ds_read_b64 v[112:113], v6 offset:768
    ds_read_b64 v[114:115], v6 offset:776
    ds_read_b128 v[144:147], v8 offset:3328
    ds_read_b64 v[116:117], v6 offset:1280
    ds_read_b64 v[118:119], v6 offset:1288
    ds_read_b128 v[148:151], v8 offset:2816
    ds_read_b64 v[120:121], v6 offset:1792
    ds_read_b64 v[122:123], v6 offset:1800
    ds_read_b128 v[152:155], v8 offset:2304
    ds_read_b64 v[124:125], v6 offset:2304
    ds_read_b64 v[126:127], v6 offset:2312
    ds_read_b128 v[156:159], v8 offset:1792
    ds_read_b64 v[128:129], v6 offset:2816
    ds_read_b64 v[130:131], v6 offset:2824
    ds_read_b128 v[160:163], v8 offset:1280
    ds_read_b64 v[132:133], v6 offset:3328
    ds_read_b64 v[134:135], v6 offset:3336
    ds_read_b128 v[164:167], v8 offset:768
    ds_read_b64 v[136:137], v6 offset:3840
    ds_read_b64 v[138:139], v6 offset:3848
    ds_read_b128 v[168:171], v8 offset:256
    s_waitcnt lgkmcnt(15)
    v_mfma_f32_16x16x32_bf16 v[12:15], v[108:111], v[140:143], v[12:15]
    s_waitcnt lgkmcnt(15)
    v_mfma_f32_16x16x32_bf16 v[16:19], v[112:115], v[140:143], v[16:19]
    v_mfma_f32_16x16x32_bf16 v[20:23], v[112:115], v[144:147], v[20:23]
    v_mfma_f32_16x16x32_bf16 v[16:19], v[108:111], v[144:147], v[16:19]
    s_waitcnt lgkmcnt(15)
    v_mfma_f32_16x16x32_bf16 v[20:23], v[116:119], v[140:143], v[20:23]
    v_mfma_f32_16x16x32_bf16 v[24:27], v[116:119], v[144:147], v[24:27]
    v_mfma_f32_16x16x32_bf16 v[28:31], v[116:119], v[148:151], v[28:31]
    v_mfma_f32_16x16x32_bf16 v[20:23], v[108:111], v[148:151], v[20:23]
    v_mfma_f32_16x16x32_bf16 v[24:27], v[112:115], v[148:151], v[24:27]
    s_waitcnt lgkmcnt(12)
    v_mfma_f32_16x16x32_bf16 v[24:27], v[120:123], v[140:143], v[24:27]
    v_mfma_f32_16x16x32_bf16 v[28:31], v[120:123], v[144:147], v[28:31]
    v_mfma_f32_16x16x32_bf16 v[32:35], v[120:123], v[148:151], v[32:35]
    v_mfma_f32_16x16x32_bf16 v[36:39], v[120:123], v[152:155], v[36:39]
    v_mfma_f32_16x16x32_bf16 v[24:27], v[108:111], v[152:155], v[24:27]
    v_mfma_f32_16x16x32_bf16 v[28:31], v[112:115], v[152:155], v[28:31]
    v_mfma_f32_16x16x32_bf16 v[32:35], v[116:119], v[152:155], v[32:35]
    s_waitcnt lgkmcnt(9)
    v_mfma_f32_16x16x32_bf16 v[28:31], v[124:127], v[140:143], v[28:31]
    v_mfma_f32_16x16x32_bf16 v[32:35], v[124:127], v[144:147], v[32:35]
    v_mfma_f32_16x16x32_bf16 v[36:39], v[124:127], v[148:151], v[36:39]
    v_mfma_f32_16x16x32_bf16 v[40:43], v[124:127], v[152:155], v[40:43]
    v_mfma_f32_16x16x32_bf16 v[28:31], v[108:111], v[156:159], v[28:31]
    v_mfma_f32_16x16x32_bf16 v[32:35], v[112:115], v[156:159], v[32:35]
    v_mfma_f32_16x16x32_bf16 v[36:39], v[116:119], v[156:159], v[36:39]
    v_mfma_f32_16x16x32_bf16 v[40:43], v[120:123], v[156:159], v[40:43]
    s_waitcnt lgkmcnt(6)
    v_mfma_f32_16x16x32_bf16 v[32:35], v[128:131], v[140:143], v[32:35]
    v_mfma_f32_16x16x32_bf16 v[36:39], v[128:131], v[144:147], v[36:39]
    v_mfma_f32_16x16x32_bf16 v[40:43], v[128:131], v[148:151], v[40:43]
    v_mfma_f32_16x16x32_bf16 v[32:35], v[108:111], v[160:163], v[32:35]
    v_mfma_f32_16x16x32_bf16 v[36:39], v[112:115], v[160:163], v[36:39]
    v_mfma_f32_16x16x32_bf16 v[40:43], v[116:119], v[160:163], v[40:43]
    s_waitcnt lgkmcnt(3)
    v_mfma_f32_16x16x32_bf16 v[36:39], v[132:135], v[140:143], v[36:39]
    v_mfma_f32_16x16x32_bf16 v[40:43], v[132:135], v[144:147], v[40:43]
    v_mfma_f32_16x16x32_bf16 v[36:39], v[108:111], v[164:167], v[36:39]
    v_mfma_f32_16x16x32_bf16 v[40:43], v[112:115], v[164:167], v[40:43]
    s_waitcnt lgkmcnt(0)
    v_mfma_f32_16x16x32_bf16 v[40:43], v[136:139], v[140:143], v[40:43]
    v_mfma_f32_16x16x32_bf16 v[40:43], v[108:111], v[168:171], v[40:43]
    s_barrier
    v_and_b32 v9, 63, v0
    v_lshlrev_b32 v9, 4, v9
    s_cmp_lg_u32 s44, 0
    s_cbranch_scc1 K2_RW1
    ds_write_b128 v9, v[20:23] offset:12800
    ds_write_b128 v9, v[24:27] offset:15872
    ds_write_b128 v9, v[28:31] offset:17920
    ds_write_b128 v9, v[32:35] offset:20992
    ds_write_b128 v9, v[36:39] offset:23040
    ds_write_b128 v9, v[40:43] offset:26112
    v_mov_b32 v44, v12
    v_mov_b32 v45, v13
    v_mov_b32 v46, v14
    v_mov_b32 v47, v15
    v_mov_b32 v48, v16
    v_mov_b32 v49, v17
    v_mov_b32 v50, v18
    v_mov_b32 v51, v19
    s_branch K2_RD
K2_RW1:
    s_cmp_lg_u32 s44, 1
    s_cbranch_scc1 K2_RW2
    ds_write_b128 v9, v[12:15] offset:4608
    ds_write_b128 v9, v[16:19] offset:7680
    ds_write_b128 v9, v[28:31] offset:18944
    ds_write_b128 v9, v[32:35] offset:22016
    ds_write_b128 v9, v[36:39] offset:24064
    ds_write_b128 v9, v[40:43] offset:27136
    v_mov_b32 v44, v20
    v_mov_b32 v45, v21
    v_mov_b32 v46, v22
    v_mov_b32 v47, v23
    v_mov_b32 v48, v24
    v_mov_b32 v49, v25
    v_mov_b32 v50, v26
    v_mov_b32 v51, v27
    s_branch K2_RD
K2_RW2:
    s_cmp_lg_u32 s44, 2
    s_cbranch_scc1 K2_RW3
    ds_write_b128 v9, v[12:15] offset:5632
    ds_write_b128 v9, v[16:19] offset:8704
    ds_write_b128 v9, v[20:23] offset:10752
    ds_write_b128 v9, v[24:27] offset:13824
    ds_write_b128 v9, v[36:39] offset:25088
    ds_write_b128 v9, v[40:43] offset:28160
    v_mov_b32 v44, v28
    v_mov_b32 v45, v29
    v_mov_b32 v46, v30
    v_mov_b32 v47, v31
    v_mov_b32 v48, v32
    v_mov_b32 v49, v33
    v_mov_b32 v50, v34
    v_mov_b32 v51, v35
    s_branch K2_RD
K2_RW3:
    ds_write_b128 v9, v[12:15] offset:6656
    ds_write_b128 v9, v[16:19] offset:9728
    ds_write_b128 v9, v[20:23] offset:11776
    ds_write_b128 v9, v[24:27] offset:14848
    ds_write_b128 v9, v[28:31] offset:16896
    ds_write_b128 v9, v[32:35] offset:19968
    v_mov_b32 v44, v36
    v_mov_b32 v45, v37
    v_mov_b32 v46, v38
    v_mov_b32 v47, v39
    v_mov_b32 v48, v40
    v_mov_b32 v49, v41
    v_mov_b32 v50, v42
    v_mov_b32 v51, v43
K2_RD:
    s_mul_i32 s17, s44, 6144
    v_add_u32 v9, s17, v9
    v_lshlrev_b32 v10, 5, v4
    v_lshl_add_u32 v10, v5, 3, v10
    s_lshl_b32 s17, s44, 10
    v_add_u32 v10, s17, v10
    v_sub_u32 v11, 3576, v10
    s_waitcnt lgkmcnt(0)
    s_barrier
    ds_read_b128 v[52:55], v9 offset:4608
    ds_read_b128 v[56:59], v9 offset:5632
    ds_read_b128 v[60:63], v9 offset:6656
    ds_read_b128 v[64:67], v9 offset:7680
    ds_read_b128 v[68:71], v9 offset:8704
    ds_read_b128 v[72:75], v9 offset:9728
    ds_read_b64 v[80:81], v11 offset:512
    ds_read_b64 v[82:83], v11
    v_lshrrev_b32 v12, 1, v5
    v_lshl_add_u32 v12, v4, 1, v12
    s_lshl_b32 s17, s44, 6
    v_add_u32 v12, s17, v12
    s_movk_i32 s16, 9216
    v_mul_lo_u32 v12, v12, s16
    v_and_b32 v13, 1, v5
    v_lshl_add_u32 v12, v13, 3, v12
    v_add_u32 v13, 294912, v12
    s_waitcnt vmcnt(0)
    v_lshlrev_b32 v7, 16, v7
    s_waitcnt lgkmcnt(0)
    v_add_f32 v44, v44, v52
    v_add_f32 v45, v45, v53
    v_add_f32 v46, v46, v54
    v_add_f32 v47, v47, v55
    v_add_f32 v44, v44, v56
    v_add_f32 v45, v45, v57
    v_add_f32 v46, v46, v58
    v_add_f32 v47, v47, v59
    v_add_f32 v44, v44, v60
    v_add_f32 v45, v45, v61
    v_add_f32 v46, v46, v62
    v_add_f32 v47, v47, v63
    v_cvt_pk_bf16_f32 v44, v44, v45
    v_cvt_pk_bf16_f32 v46, v46, v47
    v_and_b32 v20, 0xffff0000, v81
    v_lshlrev_b32 v21, 16, v81
    v_and_b32 v22, 0xffff0000, v80
    v_lshlrev_b32 v23, 16, v80
    v_mul_f32 v20, v20, v7
    v_mul_f32 v21, v21, v7
    v_mul_f32 v22, v22, v7
    v_mul_f32 v23, v23, v7
    v_cvt_pk_bf16_f32 v20, v20, v21
    v_cvt_pk_bf16_f32 v22, v22, v23
    v_lshlrev_b32 v24, 16, v44
    v_and_b32 v25, 0xffff0000, v44
    v_lshlrev_b32 v26, 16, v20
    v_and_b32 v27, 0xffff0000, v20
    v_add_f32 v24, v24, v26
    v_add_f32 v25, v25, v27
    v_cvt_pk_bf16_f32 v28, v24, v25
    v_lshlrev_b32 v24, 16, v46
    v_and_b32 v25, 0xffff0000, v46
    v_lshlrev_b32 v26, 16, v22
    v_and_b32 v27, 0xffff0000, v22
    v_add_f32 v24, v24, v26
    v_add_f32 v25, v25, v27
    v_cvt_pk_bf16_f32 v29, v24, v25
    buffer_store_dwordx2 v[28:29], v12, s[20:23], s3 offen
    v_add_f32 v48, v48, v64
    v_add_f32 v49, v49, v65
    v_add_f32 v50, v50, v66
    v_add_f32 v51, v51, v67
    v_add_f32 v48, v48, v68
    v_add_f32 v49, v49, v69
    v_add_f32 v50, v50, v70
    v_add_f32 v51, v51, v71
    v_add_f32 v48, v48, v72
    v_add_f32 v49, v49, v73
    v_add_f32 v50, v50, v74
    v_add_f32 v51, v51, v75
    v_cvt_pk_bf16_f32 v48, v48, v49
    v_cvt_pk_bf16_f32 v50, v50, v51
    v_and_b32 v20, 0xffff0000, v83
    v_lshlrev_b32 v21, 16, v83
    v_and_b32 v22, 0xffff0000, v82
    v_lshlrev_b32 v23, 16, v82
    v_mul_f32 v20, v20, v7
    v_mul_f32 v21, v21, v7
    v_mul_f32 v22, v22, v7
    v_mul_f32 v23, v23, v7
    v_cvt_pk_bf16_f32 v20, v20, v21
    v_cvt_pk_bf16_f32 v22, v22, v23
    v_lshlrev_b32 v24, 16, v48
    v_and_b32 v25, 0xffff0000, v48
    v_lshlrev_b32 v26, 16, v20
    v_and_b32 v27, 0xffff0000, v20
    v_add_f32 v24, v24, v26
    v_add_f32 v25, v25, v27
    v_cvt_pk_bf16_f32 v30, v24, v25
    v_lshlrev_b32 v24, 16, v50
    v_and_b32 v25, 0xffff0000, v50
    v_lshlrev_b32 v26, 16, v22
    v_and_b32 v27, 0xffff0000, v22
    v_add_f32 v24, v24, v26
    v_add_f32 v25, v25, v27
    v_cvt_pk_bf16_f32 v31, v24, v25
    buffer_store_dwordx2 v[30:31], v13, s[20:23], s3 offen
K2_END:
    s_endpgm
    .text
    .globl ln2_kernel
    .p2align 8
    .type ln2_kernel,@function
ln2_kernel:
    s_cmp_ge_u32 s2, 256
    s_cbranch_scc1 K3_END
    s_load_dwordx2 s[4:5], s[0:1], 128
    s_load_dwordx2 s[6:7], s[0:1], 0
    s_load_dwordx2 s[28:29], s[0:1], 80
    s_load_dwordx2 s[30:31], s[0:1], 112
    s_mov_b32 s40, 0x3ae38e39
    v_lshrrev_b32 v1, 5, v0
    v_and_b32 v2, 31, v0
    s_lshl_b32 s3, s2, 3
    v_add_u32 v9, s3, v1
    s_movk_i32 s16, 1152
    v_mul_lo_u32 v3, v9, s16
    v_lshl_add_u32 v3, v2, 2, v3
    v_mul_lo_u32 v4, v1, s16
    v_lshl_add_u32 v4, v2, 2, v4
    v_lshlrev_b32 v5, 4, v0
    v_lshlrev_b32 v6, 1, v0
    v_lshlrev_b32 v7, 2, v2
    s_mul_i32 s3, s2, 9216
    s_waitcnt lgkmcnt(0)
    s_mov_b32 s8, s6
    s_mov_b32 s9, s7
    s_mov_b32 s10, 2359296
    s_mov_b32 s11, 0x00020000
    s_add_u32 s17, s3, 4718592
    s_add_u32 s12, s4, s17
    s_addc_u32 s13, s5, 0
    s_movk_i32 s14, 9216
    s_mov_b32 s15, 0x00020000
    s_add_u32 s20, s4, 7077888
    s_addc_u32 s21, s5, 0
    s_mov_b32 s22, 2359296
    s_mov_b32 s23, 0x00020000
    s_add_u32 s24, s4, 9437184
    s_addc_u32 s25, s5, 0
    s_mov_b32 s26, 2359296
    s_mov_b32 s27, 0x00020000
    s_mov_b32 s32, s28
    s_mov_b32 s33, s29
    s_mov_b32 s34, 1152
    s_mov_b32 s35, 0x00020000
    s_mov_b32 s36, s30
    s_mov_b32 s37, s31
    s_mov_b32 s38, 2359296
    s_mov_b32 s39, 0x00020000
    s_add_u32 s44, s4, 11796480
    s_addc_u32 s45, s5, 0
    s_mov_b32 s46, 8192
    s_mov_b32 s47, 0x00020000
    v_add_u32 v8, 4096, v5
    buffer_load_dwordx4 v[60:63], v5, s[12:15], 0 offen
    buffer_load_dwordx4 v[64:67], v8, s[12:15], 0 offen
    v_add_u32 v8, 8192, v5
    buffer_load_dwordx4 v[68:71], v8, s[12:15], 0 offen
    buffer_load_dword v40, v3, s[8:11], 0 offen offset:0
    buffer_load_dword v41, v3, s[8:11], 0 offen offset:128
    buffer_load_dword v42, v3, s[8:11], 0 offen offset:256
    buffer_load_dword v43, v3, s[8:11], 0 offen offset:384
    buffer_load_dword v44, v3, s[8:11], 0 offen offset:512
    buffer_load_dword v45, v3, s[8:11], 0 offen offset:640
    buffer_load_dword v46, v3, s[8:11], 0 offen offset:768
    buffer_load_dword v47, v3, s[8:11], 0 offen offset:896
    buffer_load_dword v48, v3, s[8:11], 0 offen offset:1024
    buffer_load_dword v50, v7, s[32:35], 0 offen offset:0
    buffer_load_dword v51, v7, s[32:35], 0 offen offset:128
    buffer_load_dword v52, v7, s[32:35], 0 offen offset:256
    buffer_load_dword v53, v7, s[32:35], 0 offen offset:384
    buffer_load_dword v54, v7, s[32:35], 0 offen offset:512
    buffer_load_dword v55, v7, s[32:35], 0 offen offset:640
    buffer_load_dword v56, v7, s[32:35], 0 offen offset:768
    buffer_load_dword v57, v7, s[32:35], 0 offen offset:896
    buffer_load_dword v58, v7, s[32:35], 0 offen offset:1024
    s_waitcnt vmcnt(20)
    ds_write_b16 v6, v60 offset:0
    ds_write_b16_d16_hi v6, v60 offset:1152
    ds_write_b16 v6, v61 offset:2304
    ds_write_b16_d16_hi v6, v61 offset:3456
    ds_write_b16 v6, v62 offset:4608
    ds_write_b16_d16_hi v6, v62 offset:5760
    ds_write_b16 v6, v63 offset:6912
    ds_write_b16_d16_hi v6, v63 offset:8064
    s_waitcnt vmcnt(19)
    ds_write_b16 v6, v64 offset:512
    ds_write_b16_d16_hi v6, v64 offset:1664
    ds_write_b16 v6, v65 offset:2816
    ds_write_b16_d16_hi v6, v65 offset:3968
    ds_write_b16 v6, v66 offset:5120
    ds_write_b16_d16_hi v6, v66 offset:6272
    ds_write_b16 v6, v67 offset:7424
    ds_write_b16_d16_hi v6, v67 offset:8576
    v_cmp_gt_u32 vcc, 64, v0
    s_waitcnt vmcnt(18)
    s_and_saveexec_b64 s[18:19], vcc
    ds_write_b16 v6, v68 offset:1024
    ds_write_b16_d16_hi v6, v68 offset:2176
    ds_write_b16 v6, v69 offset:3328
    ds_write_b16_d16_hi v6, v69 offset:4480
    ds_write_b16 v6, v70 offset:5632
    ds_write_b16_d16_hi v6, v70 offset:6784
    ds_write_b16 v6, v71 offset:7936
    ds_write_b16_d16_hi v6, v71 offset:9088
    s_mov_b64 exec, s[18:19]
    s_waitcnt lgkmcnt(0)
    s_barrier
    ds_read_b32 v60, v4 offset:0
    ds_read_b32 v61, v4 offset:128
    ds_read_b32 v62, v4 offset:256
    ds_read_b32 v63, v4 offset:384
    ds_read_b32 v64, v4 offset:512
    ds_read_b32 v65, v4 offset:640
    ds_read_b32 v66, v4 offset:768
    ds_read_b32 v67, v4 offset:896
    ds_read_b32 v68, v4 offset:1024
    s_waitcnt vmcnt(9)
    s_waitcnt lgkmcnt(8)
    v_lshlrev_b32 v10, 16, v40
    v_and_b32 v11, 0xffff0000, v40
    v_lshlrev_b32 v30, 16, v60
    v_and_b32 v31, 0xffff0000, v60
    v_add_f32 v10, v10, v30
    v_add_f32 v11, v11, v31
    v_cvt_pk_bf16_f32 v60, v10, v11
    v_lshlrev_b32 v10, 16, v60
    v_and_b32 v11, 0xffff0000, v60
    buffer_store_dword v60, v3, s[24:27], 0 offen offset:0
    s_waitcnt lgkmcnt(7)
    v_lshlrev_b32 v12, 16, v41
    v_and_b32 v13, 0xffff0000, v41
    v_lshlrev_b32 v30, 16, v61
    v_and_b32 v31, 0xffff0000, v61
    v_add_f32 v12, v12, v30
    v_add_f32 v13, v13, v31
    v_cvt_pk_bf16_f32 v61, v12, v13
    v_lshlrev_b32 v12, 16, v61
    v_and_b32 v13, 0xffff0000, v61
    buffer_store_dword v61, v3, s[24:27], 0 offen offset:128
    s_waitcnt lgkmcnt(6)
    v_lshlrev_b32 v14, 16, v42
    v_and_b32 v15, 0xffff0000, v42
    v_lshlrev_b32 v30, 16, v62
    v_and_b32 v31, 0xffff0000, v62
    v_add_f32 v14, v14, v30
    v_add_f32 v15, v15, v31
    v_cvt_pk_bf16_f32 v62, v14, v15
    v_lshlrev_b32 v14, 16, v62
    v_and_b32 v15, 0xffff0000, v62
    buffer_store_dword v62, v3, s[24:27], 0 offen offset:256
    s_waitcnt lgkmcnt(5)
    v_lshlrev_b32 v16, 16, v43
    v_and_b32 v17, 0xffff0000, v43
    v_lshlrev_b32 v30, 16, v63
    v_and_b32 v31, 0xffff0000, v63
    v_add_f32 v16, v16, v30
    v_add_f32 v17, v17, v31
    v_cvt_pk_bf16_f32 v63, v16, v17
    v_lshlrev_b32 v16, 16, v63
    v_and_b32 v17, 0xffff0000, v63
    buffer_store_dword v63, v3, s[24:27], 0 offen offset:384
    s_waitcnt lgkmcnt(4)
    v_lshlrev_b32 v18, 16, v44
    v_and_b32 v19, 0xffff0000, v44
    v_lshlrev_b32 v30, 16, v64
    v_and_b32 v31, 0xffff0000, v64
    v_add_f32 v18, v18, v30
    v_add_f32 v19, v19, v31
    v_cvt_pk_bf16_f32 v64, v18, v19
    v_lshlrev_b32 v18, 16, v64
    v_and_b32 v19, 0xffff0000, v64
    buffer_store_dword v64, v3, s[24:27], 0 offen offset:512
    s_waitcnt lgkmcnt(3)
    v_lshlrev_b32 v20, 16, v45
    v_and_b32 v21, 0xffff0000, v45
    v_lshlrev_b32 v30, 16, v65
    v_and_b32 v31, 0xffff0000, v65
    v_add_f32 v20, v20, v30
    v_add_f32 v21, v21, v31
    v_cvt_pk_bf16_f32 v65, v20, v21
    v_lshlrev_b32 v20, 16, v65
    v_and_b32 v21, 0xffff0000, v65
    buffer_store_dword v65, v3, s[24:27], 0 offen offset:640
    s_waitcnt lgkmcnt(2)
    v_lshlrev_b32 v22, 16, v46
    v_and_b32 v23, 0xffff0000, v46
    v_lshlrev_b32 v30, 16, v66
    v_and_b32 v31, 0xffff0000, v66
    v_add_f32 v22, v22, v30
    v_add_f32 v23, v23, v31
    v_cvt_pk_bf16_f32 v66, v22, v23
    v_lshlrev_b32 v22, 16, v66
    v_and_b32 v23, 0xffff0000, v66
    buffer_store_dword v66, v3, s[24:27], 0 offen offset:768
    s_waitcnt lgkmcnt(1)
    v_lshlrev_b32 v24, 16, v47
    v_and_b32 v25, 0xffff0000, v47
    v_lshlrev_b32 v30, 16, v67
    v_and_b32 v31, 0xffff0000, v67
    v_add_f32 v24, v24, v30
    v_add_f32 v25, v25, v31
    v_cvt_pk_bf16_f32 v67, v24, v25
    v_lshlrev_b32 v24, 16, v67
    v_and_b32 v25, 0xffff0000, v67
    buffer_store_dword v67, v3, s[24:27], 0 offen offset:896
    s_waitcnt lgkmcnt(0)
    v_lshlrev_b32 v26, 16, v48
    v_and_b32 v27, 0xffff0000, v48
    v_lshlrev_b32 v30, 16, v68
    v_and_b32 v31, 0xffff0000, v68
    v_add_f32 v26, v26, v30
    v_add_f32 v27, v27, v31
    v_cvt_pk_bf16_f32 v68, v26, v27
    v_lshlrev_b32 v26, 16, v68
    v_and_b32 v27, 0xffff0000, v68
    buffer_store_dword v68, v3, s[24:27], 0 offen offset:1024
    v_add_f32 v30, v10, v11
    v_add_f32 v31, v12, v13
    v_add_f32 v30, v30, v14
    v_add_f32 v31, v31, v15
    v_add_f32 v30, v30, v16
    v_add_f32 v31, v31, v17
    v_add_f32 v30, v30, v18
    v_add_f32 v31, v31, v19
    v_add_f32 v30, v30, v20
    v_add_f32 v31, v31, v21
    v_add_f32 v30, v30, v22
    v_add_f32 v31, v31, v23
    v_add_f32 v30, v30, v24
    v_add_f32 v31, v31, v25
    v_add_f32 v30, v30, v26
    v_add_f32 v31, v31, v27
    v_add_f32 v30, v30, v31
    s_nop 1
    v_add_f32_dpp v30, v30, v30 quad_perm:[1,0,3,2] row_mask:0xf bank_mask:0xf
    s_nop 1
    v_add_f32_dpp v30, v30, v30 quad_perm:[2,3,0,1] row_mask:0xf bank_mask:0xf
    s_nop 1
    v_add_f32_dpp v30, v30, v30 row_half_mirror row_mask:0xf bank_mask:0xf
    s_nop 1
    v_add_f32_dpp v30, v30, v30 row_mirror row_mask:0xf bank_mask:0xf
    v_mov_b32 v31, v30
    s_nop 1
    v_permlane16_swap_b32 v30, v31
    v_add_f32 v30, v30, v31
    v_mul_f32 v32, s40, v30
    v_sub_f32 v34, v10, v32
    v_sub_f32 v35, v11, v32
    v_mul_f32 v30, v34, v34
    v_mul_f32 v31, v35, v35
    v_sub_f32 v34, v12, v32
    v_sub_f32 v35, v13, v32
    v_fmac_f32 v30, v34, v34
    v_fmac_f32 v31, v35, v35
    v_sub_f32 v34, v14, v32
    v_sub_f32 v35, v15, v32
    v_fmac_f32 v30, v34, v34
    v_fmac_f32 v31, v35, v35
    v_sub_f32 v34, v16, v32
    v_sub_f32 v35, v17, v32
    v_fmac_f32 v30, v34, v34
    v_fmac_f32 v31, v35, v35
    v_sub_f32 v34, v18, v32
    v_sub_f32 v35, v19, v32
    v_fmac_f32 v30, v34, v34
    v_fmac_f32 v31, v35, v35
    v_sub_f32 v34, v20, v32
    v_sub_f32 v35, v21, v32
    v_fmac_f32 v30, v34, v34
    v_fmac_f32 v31, v35, v35
    v_sub_f32 v34, v22, v32
    v_sub_f32 v35, v23, v32
    v_fmac_f32 v30, v34, v34
    v_fmac_f32 v31, v35, v35
    v_sub_f32 v34, v24, v32
    v_sub_f32 v35, v25, v32
    v_fmac_f32 v30, v34, v34
    v_fmac_f32 v31, v35, v35
    v_sub_f32 v34, v26, v32
    v_sub_f32 v35, v27, v32
    v_fmac_f32 v30, v34, v34
    v_fmac_f32 v31, v35, v35
    v_add_f32 v30, v30, v31
    s_nop 1
    v_add_f32_dpp v30, v30, v30 quad_perm:[1,0,3,2] row_mask:0xf bank_mask:0xf
    s_nop 1
    v_add_f32_dpp v30, v30, v30 quad_perm:[2,3,0,1] row_mask:0xf bank_mask:0xf
    s_nop 1
    v_add_f32_dpp v30, v30, v30 row_half_mirror row_mask:0xf bank_mask:0xf
    s_nop 1
    v_add_f32_dpp v30, v30, v30 row_mirror row_mask:0xf bank_mask:0xf
    v_mov_b32 v31, v30
    s_nop 1
    v_permlane16_swap_b32 v30, v31
    v_add_f32 v30, v30, v31
    v_mul_f32 v30, s40, v30
    v_cvt_pk_bf16_f32 v30, v30, v30
    v_lshlrev_b32 v30, 16, v30
    v_cvt_pk_bf16_f32 v32, v32, v32
    v_lshlrev_b32 v32, 16, v32
    v_add_f32 v30, 0x3727c5ac, v30
    v_cvt_pk_bf16_f32 v30, v30, v30
    v_lshlrev_b32 v30, 16, v30
    v_sqrt_f32 v30, v30
    s_nop 0
    v_cvt_pk_bf16_f32 v30, v30, v30
    v_lshlrev_b32 v30, 16, v30
    v_rcp_f32 v33, v30
    v_sub_f32 v10, v10, v32
    v_sub_f32 v11, v11, v32
    v_cvt_pk_bf16_f32 v11, v10, v11
    v_lshlrev_b32 v10, 16, v11
    v_and_b32 v11, 0xffff0000, v11
    v_mul_f32 v10, v10, v33
    v_mul_f32 v11, v11, v33
    v_cvt_pk_bf16_f32 v40, v10, v11
    v_sub_f32 v12, v12, v32
    v_sub_f32 v13, v13, v32
    v_cvt_pk_bf16_f32 v13, v12, v13
    v_lshlrev_b32 v12, 16, v13
    v_and_b32 v13, 0xffff0000, v13
    v_mul_f32 v12, v12, v33
    v_mul_f32 v13, v13, v33
    v_cvt_pk_bf16_f32 v41, v12, v13
    v_sub_f32 v14, v14, v32
    v_sub_f32 v15, v15, v32
    v_cvt_pk_bf16_f32 v15, v14, v15
    v_lshlrev_b32 v14, 16, v15
    v_and_b32 v15, 0xffff0000, v15
    v_mul_f32 v14, v14, v33
    v_mul_f32 v15, v15, v33
    v_cvt_pk_bf16_f32 v42, v14, v15
    v_sub_f32 v16, v16, v32
    v_sub_f32 v17, v17, v32
    v_cvt_pk_bf16_f32 v17, v16, v17
    v_lshlrev_b32 v16, 16, v17
    v_and_b32 v17, 0xffff0000, v17
    v_mul_f32 v16, v16, v33
    v_mul_f32 v17, v17, v33
    v_cvt_pk_bf16_f32 v43, v16, v17
    v_sub_f32 v18, v18, v32
    v_sub_f32 v19, v19, v32
    v_cvt_pk_bf16_f32 v19, v18, v19
    v_lshlrev_b32 v18, 16, v19
    v_and_b32 v19, 0xffff0000, v19
    v_mul_f32 v18, v18, v33
    v_mul_f32 v19, v19, v33
    v_cvt_pk_bf16_f32 v44, v18, v19
    v_sub_f32 v20, v20, v32
    v_sub_f32 v21, v21, v32
    v_cvt_pk_bf16_f32 v21, v20, v21
    v_lshlrev_b32 v20, 16, v21
    v_and_b32 v21, 0xffff0000, v21
    v_mul_f32 v20, v20, v33
    v_mul_f32 v21, v21, v33
    v_cvt_pk_bf16_f32 v45, v20, v21
    v_sub_f32 v22, v22, v32
    v_sub_f32 v23, v23, v32
    v_cvt_pk_bf16_f32 v23, v22, v23
    v_lshlrev_b32 v22, 16, v23
    v_and_b32 v23, 0xffff0000, v23
    v_mul_f32 v22, v22, v33
    v_mul_f32 v23, v23, v33
    v_cvt_pk_bf16_f32 v46, v22, v23
    v_sub_f32 v24, v24, v32
    v_sub_f32 v25, v25, v32
    v_cvt_pk_bf16_f32 v25, v24, v25
    v_lshlrev_b32 v24, 16, v25
    v_and_b32 v25, 0xffff0000, v25
    v_mul_f32 v24, v24, v33
    v_mul_f32 v25, v25, v33
    v_cvt_pk_bf16_f32 v47, v24, v25
    v_sub_f32 v26, v26, v32
    v_sub_f32 v27, v27, v32
    v_cvt_pk_bf16_f32 v27, v26, v27
    v_lshlrev_b32 v26, 16, v27
    v_and_b32 v27, 0xffff0000, v27
    v_mul_f32 v26, v26, v33
    v_mul_f32 v27, v27, v33
    v_cvt_pk_bf16_f32 v48, v26, v27
    s_waitcnt vmcnt(9)
    v_mov_b32 v36, 0
    v_mov_b32 v37, 0
    buffer_store_dword v40, v3, s[20:23], 0 offen offset:0
    v_lshlrev_b32 v30, 16, v40
    v_and_b32 v31, 0xffff0000, v40
    v_lshlrev_b32 v32, 16, v50
    v_and_b32 v33, 0xffff0000, v50
    v_fmac_f32 v36, v30, v32
    v_fmac_f32 v37, v31, v33
    v_lshlrev_b32 v32, 16, v60
    v_and_b32 v33, 0xffff0000, v60
    v_add_f32 v30, v30, v32
    v_add_f32 v31, v31, v33
    v_cvt_pk_bf16_f32 v70, v30, v31
    buffer_store_dword v70, v3, s[36:39], 0 offen offset:0
    buffer_store_dword v41, v3, s[20:23], 0 offen offset:128
    v_lshlrev_b32 v30, 16, v41
    v_and_b32 v31, 0xffff0000, v41
    v_lshlrev_b32 v32, 16, v51
    v_and_b32 v33, 0xffff0000, v51
    v_fmac_f32 v36, v30, v32
    v_fmac_f32 v37, v31, v33
    v_lshlrev_b32 v32, 16, v61
    v_and_b32 v33, 0xffff0000, v61
    v_add_f32 v30, v30, v32
    v_add_f32 v31, v31, v33
    v_cvt_pk_bf16_f32 v71, v30, v31
    buffer_store_dword v71, v3, s[36:39], 0 offen offset:128
    buffer_store_dword v42, v3, s[20:23], 0 offen offset:256
    v_lshlrev_b32 v30, 16, v42
    v_and_b32 v31, 0xffff0000, v42
    v_lshlrev_b32 v32, 16, v52
    v_and_b32 v33, 0xffff0000, v52
    v_fmac_f32 v36, v30, v32
    v_fmac_f32 v37, v31, v33
    v_lshlrev_b32 v32, 16, v62
    v_and_b32 v33, 0xffff0000, v62
    v_add_f32 v30, v30, v32
    v_add_f32 v31, v31, v33
    v_cvt_pk_bf16_f32 v72, v30, v31
    buffer_store_dword v72, v3, s[36:39], 0 offen offset:256
    buffer_store_dword v43, v3, s[20:23], 0 offen offset:384
    v_lshlrev_b32 v30, 16, v43
    v_and_b32 v31, 0xffff0000, v43
    v_lshlrev_b32 v32, 16, v53
    v_and_b32 v33, 0xffff0000, v53
    v_fmac_f32 v36, v30, v32
    v_fmac_f32 v37, v31, v33
    v_lshlrev_b32 v32, 16, v63
    v_and_b32 v33, 0xffff0000, v63
    v_add_f32 v30, v30, v32
    v_add_f32 v31, v31, v33
    v_cvt_pk_bf16_f32 v73, v30, v31
    buffer_store_dword v73, v3, s[36:39], 0 offen offset:384
    buffer_store_dword v44, v3, s[20:23], 0 offen offset:512
    v_lshlrev_b32 v30, 16, v44
    v_and_b32 v31, 0xffff0000, v44
    v_lshlrev_b32 v32, 16, v54
    v_and_b32 v33, 0xffff0000, v54
    v_fmac_f32 v36, v30, v32
    v_fmac_f32 v37, v31, v33
    v_lshlrev_b32 v32, 16, v64
    v_and_b32 v33, 0xffff0000, v64
    v_add_f32 v30, v30, v32
    v_add_f32 v31, v31, v33
    v_cvt_pk_bf16_f32 v74, v30, v31
    buffer_store_dword v74, v3, s[36:39], 0 offen offset:512
    buffer_store_dword v45, v3, s[20:23], 0 offen offset:640
    v_lshlrev_b32 v30, 16, v45
    v_and_b32 v31, 0xffff0000, v45
    v_lshlrev_b32 v32, 16, v55
    v_and_b32 v33, 0xffff0000, v55
    v_fmac_f32 v36, v30, v32
    v_fmac_f32 v37, v31, v33
    v_lshlrev_b32 v32, 16, v65
    v_and_b32 v33, 0xffff0000, v65
    v_add_f32 v30, v30, v32
    v_add_f32 v31, v31, v33
    v_cvt_pk_bf16_f32 v75, v30, v31
    buffer_store_dword v75, v3, s[36:39], 0 offen offset:640
    buffer_store_dword v46, v3, s[20:23], 0 offen offset:768
    v_lshlrev_b32 v30, 16, v46
    v_and_b32 v31, 0xffff0000, v46
    v_lshlrev_b32 v32, 16, v56
    v_and_b32 v33, 0xffff0000, v56
    v_fmac_f32 v36, v30, v32
    v_fmac_f32 v37, v31, v33
    v_lshlrev_b32 v32, 16, v66
    v_and_b32 v33, 0xffff0000, v66
    v_add_f32 v30, v30, v32
    v_add_f32 v31, v31, v33
    v_cvt_pk_bf16_f32 v76, v30, v31
    buffer_store_dword v76, v3, s[36:39], 0 offen offset:768
    buffer_store_dword v47, v3, s[20:23], 0 offen offset:896
    v_lshlrev_b32 v30, 16, v47
    v_and_b32 v31, 0xffff0000, v47
    v_lshlrev_b32 v32, 16, v57
    v_and_b32 v33, 0xffff0000, v57
    v_fmac_f32 v36, v30, v32
    v_fmac_f32 v37, v31, v33
    v_lshlrev_b32 v32, 16, v67
    v_and_b32 v33, 0xffff0000, v67
    v_add_f32 v30, v30, v32
    v_add_f32 v31, v31, v33
    v_cvt_pk_bf16_f32 v77, v30, v31
    buffer_store_dword v77, v3, s[36:39], 0 offen offset:896
    buffer_store_dword v48, v3, s[20:23], 0 offen offset:1024
    v_lshlrev_b32 v30, 16, v48
    v_and_b32 v31, 0xffff0000, v48
    v_lshlrev_b32 v32, 16, v58
    v_and_b32 v33, 0xffff0000, v58
    v_fmac_f32 v36, v30, v32
    v_fmac_f32 v37, v31, v33
    v_lshlrev_b32 v32, 16, v68
    v_and_b32 v33, 0xffff0000, v68
    v_add_f32 v30, v30, v32
    v_add_f32 v31, v31, v33
    v_cvt_pk_bf16_f32 v78, v30, v31
    buffer_store_dword v78, v3, s[36:39], 0 offen offset:1024
    v_add_f32 v36, v36, v37
    s_nop 1
    v_add_f32_dpp v36, v36, v36 quad_perm:[1,0,3,2] row_mask:0xf bank_mask:0xf
    s_nop 1
    v_add_f32_dpp v36, v36, v36 quad_perm:[2,3,0,1] row_mask:0xf bank_mask:0xf
    s_nop 1
    v_add_f32_dpp v36, v36, v36 row_half_mirror row_mask:0xf bank_mask:0xf
    s_nop 1
    v_add_f32_dpp v36, v36, v36 row_mirror row_mask:0xf bank_mask:0xf
    v_mov_b32 v37, v36
    s_nop 1
    v_permlane16_swap_b32 v36, v37
    v_add_f32 v36, v36, v37
    v_cvt_pk_bf16_f32 v36, v36, v36
    v_and_b32 v36, 0xffff0000, v36
    v_ashrrev_i32 v37, 31, v36
    v_or_b32 v37, 0x80000000, v37
    v_xor_b32 v36, v36, v37
    v_and_b32 v36, 0xffff0000, v36
    v_sub_u32 v37, 2047, v9
    v_or_b32 v36, v36, v37
    v_lshlrev_b32 v37, 2, v9
    v_cmp_eq_u32 vcc, 0, v2
    s_nop 0
    s_and_saveexec_b64 s[18:19], vcc
    buffer_store_dword v36, v37, s[44:47], 0 offen
K3_END:
    s_endpgm
    .text
    .globl ffn_kernel
    .p2align 8
    .type ffn_kernel,@function
ffn_kernel:
    s_cmp_ge_u32 s2, 288
    s_cbranch_scc1 K4_END
    s_load_dwordx2 s[4:5], s[0:1], 128
    s_load_dwordx4 s[8:11], s[0:1], 88
    s_load_dwordx2 s[12:13], s[0:1], 104
    v_readfirstlane_b32 s44, v0
    s_nop 0
    s_lshr_b32 s44, s44, 6
    s_and_b32 s3, s2, 0xffe0
    s_and_b32 s16, s2, 7
    s_lshl_b32 s16, s16, 2
    s_add_u32 s3, s3, s16
    s_bfe_u32 s16, s2, 0x20003
    s_add_u32 s3, s3, s16
    v_lshlrev_b32 v1, 5, v0
    v_and_b32 v2, 63, v0
    s_waitcnt lgkmcnt(0)
    s_add_u32 s20, s4, 11796480
    s_addc_u32 s21, s5, 0
    s_mov_b32 s22, 8192
    s_mov_b32 s23, 0x00020000
    buffer_load_dwordx4 v[40:43], v1, s[20:23], 0 offen
    buffer_load_dwordx4 v[44:47], v1, s[20:23], 0 offen offset:16
    s_and_b32 s16, s44, 1
    s_cmp_eq_u32 s16, 1
    s_cselect_b32 s24, s10, s8
    s_cselect_b32 s25, s11, s9
    s_mov_b32 s26, 5308416
    s_mov_b32 s27, 0x00020000
    s_mov_b32 s28, s12
    s_mov_b32 s29, s13
    s_mov_b32 s30, 5308416
    s_mov_b32 s31, 0x00020000
    s_add_u32 s32, s4, 7077888
    s_addc_u32 s33, s5, 0
    s_mov_b32 s34, 2359296
    s_mov_b32 s35, 0x00020000
    s_add_u32 s36, s4, 11804928
    s_addc_u32 s37, s5, 0
    s_mov_b32 s38, 5308416
    s_mov_b32 s39, 0x00020000
    s_add_u32 s48, s4, 11804672
    s_addc_u32 s49, s5, 0
    s_mov_b32 s50, 256
    s_mov_b32 s51, 0x00020000
    v_lshrrev_b32 v3, 1, v2
    s_movk_i32 s16, 9216
    v_mul_lo_u32 v3, v3, s16
    v_and_b32 v4, 1, v2
    v_lshl_add_u32 v3, v4, 4, v3
    s_lshr_b32 s17, s44, 1
    s_mul_i32 s18, s17, 2654208
    s_lshl_b32 s19, s3, 5
    s_add_u32 s18, s18, s19
    s_mul_i32 s45, s44, 9216
    s_add_u32 m0, s45, 0
    s_nop 0
    buffer_load_dwordx4 v3, s[24:27], s18 offen lds
    s_add_u32 s18, s18, 294912
    s_add_u32 m0, s45, 1024
    s_nop 0
    buffer_load_dwordx4 v3, s[24:27], s18 offen lds
    s_add_u32 s18, s18, 294912
    s_add_u32 m0, s45, 2048
    s_nop 0
    buffer_load_dwordx4 v3, s[24:27], s18 offen lds
    s_add_u32 s18, s18, 294912
    s_add_u32 m0, s45, 3072
    s_nop 0
    buffer_load_dwordx4 v3, s[24:27], s18 offen lds
    s_add_u32 s18, s18, 294912
    s_add_u32 m0, s45, 4096
    s_nop 0
    buffer_load_dwordx4 v3, s[24:27], s18 offen lds
    s_add_u32 s18, s18, 294912
    s_add_u32 m0, s45, 5120
    s_nop 0
    buffer_load_dwordx4 v3, s[24:27], s18 offen lds
    s_add_u32 s18, s18, 294912
    s_add_u32 m0, s45, 6144
    s_nop 0
    buffer_load_dwordx4 v3, s[24:27], s18 offen lds
    s_add_u32 s18, s18, 294912
    s_add_u32 m0, s45, 7168
    s_nop 0
    buffer_load_dwordx4 v3, s[24:27], s18 offen lds
    s_add_u32 s18, s18, 294912
    s_add_u32 m0, s45, 8192
    s_nop 0
    buffer_load_dwordx4 v3, s[24:27], s18 offen lds
    v_bfe_u32 v5, v2, 1, 4
    s_movk_i32 s16, 1152
    v_mul_lo_u32 v5, v5, s16
    v_lshl_add_u32 v5, v4, 4, v5
    v_lshrrev_b32 v6, 5, v2
    v_lshl_add_u32 v5, v6, 5, v5
    s_mul_i32 s18, s3, 18432
    s_mul_i32 s19, s44, 288
    s_add_u32 s18, s18, s19
    s_mul_i32 s46, s44, 5120
    s_add_u32 m0, s46, 36864
    s_nop 0
    buffer_load_dwordx4 v5, s[28:31], s18 offen lds
    s_add_u32 s18, s18, 64
    s_add_u32 m0, s46, 37888
    s_nop 0
    buffer_load_dwordx4 v5, s[28:31], s18 offen lds
    s_add_u32 s18, s18, 64
    s_add_u32 m0, s46, 38912
    s_nop 0
    buffer_load_dwordx4 v5, s[28:31], s18 offen lds
    s_add_u32 s18, s18, 64
    s_add_u32 m0, s46, 39936
    s_nop 0
    buffer_load_dwordx4 v5, s[28:31], s18 offen lds
    s_add_u32 s18, s18, 64
    s_add_u32 m0, s46, 40960
    s_mov_b32 exec_hi, 0
    buffer_load_dwordx4 v5, s[28:31], s18 offen lds
    s_mov_b64 exec, -1
    s_waitcnt vmcnt(14)
    v_max_u32 v56, v40, v41
    v_min_u32 v41, v40, v41
    v_max_u32 v40, v42, v43
    v_min_u32 v43, v42, v43
    v_max_u32 v42, v44, v45
    v_min_u32 v45, v44, v45
    v_max_u32 v44, v46, v47
    v_min_u32 v47, v46, v47
    v_max_u32 v46, v56, v40
    v_min_u32 v40, v56, v40
    v_max_u32 v56, v41, v43
    v_min_u32 v43, v41, v43
    v_max_u32 v41, v42, v44
    v_min_u32 v44, v42, v44
    v_max_u32 v42, v45, v47
    v_min_u32 v47, v45, v47
    v_max_u32 v45, v56, v40
    v_min_u32 v40, v56, v40
    v_max_u32 v56, v42, v44
    v_min_u32 v44, v42, v44
    v_max_u32 v42, v46, v41
    v_min_u32 v41, v46, v41
    v_max_u32 v46, v43, v47
    v_min_u32 v47, v43, v47
    v_max_u32 v43, v45, v56
    v_min_u32 v56, v45, v56
    v_max_u32 v45, v40, v44
    v_min_u32 v44, v40, v44
    v_max_u32 v40, v43, v41
    v_min_u32 v41, v43, v41
    v_max_u32 v43, v46, v44
    v_min_u32 v44, v46, v44
    v_max_u32 v46, v45, v41
    v_min_u32 v41, v45, v41
    v_max_u32 v45, v43, v56
    v_min_u32 v56, v43, v56
    v_max_u32 v43, v45, v41
    v_min_u32 v41, v45, v41
    v_max_u32_dpp v48, v47, v42 quad_perm:[1,0,3,2] row_mask:0xf bank_mask:0xf
    v_max_u32_dpp v49, v44, v40 quad_perm:[1,0,3,2] row_mask:0xf bank_mask:0xf
    v_max_u32_dpp v50, v56, v46 quad_perm:[1,0,3,2] row_mask:0xf bank_mask:0xf
    v_max_u32_dpp v51, v41, v43 quad_perm:[1,0,3,2] row_mask:0xf bank_mask:0xf
    v_max_u32_dpp v52, v43, v41 quad_perm:[1,0,3,2] row_mask:0xf bank_mask:0xf
    v_max_u32_dpp v53, v46, v56 quad_perm:[1,0,3,2] row_mask:0xf bank_mask:0xf
    v_max_u32_dpp v54, v40, v44 quad_perm:[1,0,3,2] row_mask:0xf bank_mask:0xf
    v_max_u32_dpp v55, v42, v47 quad_perm:[1,0,3,2] row_mask:0xf bank_mask:0xf
    v_max_u32 v45, v48, v52
    v_min_u32 v52, v48, v52
    v_max_u32 v48, v49, v53
    v_min_u32 v53, v49, v53
    v_max_u32 v49, v50, v54
    v_min_u32 v54, v50, v54
    v_max_u32 v50, v51, v55
    v_min_u32 v55, v51, v55
    v_max_u32 v51, v45, v49
    v_min_u32 v49, v45, v49
    v_max_u32 v45, v48, v50
    v_min_u32 v50, v48, v50
    v_max_u32 v48, v52, v54
    v_min_u32 v54, v52, v54
    v_max_u32 v52, v53, v55
    v_min_u32 v55, v53, v55
    v_max_u32 v53, v51, v45
    v_min_u32 v45, v51, v45
    v_max_u32 v51, v49, v50
    v_min_u32 v50, v49, v50
    v_max_u32 v49, v48, v52
    v_min_u32 v52, v48, v52
    v_max_u32 v48, v54, v55
    v_min_u32 v55, v54, v55
    s_nop 1
    v_max_u32_dpp v42, v55, v53 quad_perm:[2,3,0,1] row_mask:0xf bank_mask:0xf
    v_max_u32_dpp v40, v48, v45 quad_perm:[2,3,0,1] row_mask:0xf bank_mask:0xf
    v_max_u32_dpp v46, v52, v51 quad_perm:[2,3,0,1] row_mask:0xf bank_mask:0xf
    v_max_u32_dpp v43, v49, v50 quad_perm:[2,3,0,1] row_mask:0xf bank_mask:0xf
    v_max_u32_dpp v41, v50, v49 quad_perm:[2,3,0,1] row_mask:0xf bank_mask:0xf
    v_max_u32_dpp v56, v51, v52 quad_perm:[2,3,0,1] row_mask:0xf bank_mask:0xf
    v_max_u32_dpp v44, v45, v48 quad_perm:[2,3,0,1] row_mask:0xf bank_mask:0xf
    v_max_u32_dpp v47, v53, v55 quad_perm:[2,3,0,1] row_mask:0xf bank_mask:0xf
    v_max_u32 v54, v42, v41
    v_min_u32 v41, v42, v41
    v_max_u32 v42, v40, v56
    v_min_u32 v56, v40, v56
    v_max_u32 v40, v46, v44
    v_min_u32 v44, v46, v44
    v_max_u32 v46, v43, v47
    v_min_u32 v47, v43, v47
    v_max_u32 v43, v54, v40
    v_min_u32 v40, v54, v40
    v_max_u32 v54, v42, v46
    v_min_u32 v46, v42, v46
    v_max_u32 v42, v41, v44
    v_min_u32 v44, v41, v44
    v_max_u32 v41, v56, v47
    v_min_u32 v47, v56, v47
    v_max_u32 v56, v43, v54
    v_min_u32 v54, v43, v54
    v_max_u32 v43, v40, v46
    v_min_u32 v46, v40, v46
    v_max_u32 v40, v42, v41
    v_min_u32 v41, v42, v41
    v_max_u32 v42, v44, v47
    v_min_u32 v47, v44, v47
    s_nop 1
    v_max_u32_dpp v53, v47, v56 row_half_mirror row_mask:0xf bank_mask:0xf
    v_max_u32_dpp v45, v42, v54 row_half_mirror row_mask:0xf bank_mask:0xf
    v_max_u32_dpp v51, v41, v43 row_half_mirror row_mask:0xf bank_mask:0xf
    v_max_u32_dpp v50, v40, v46 row_half_mirror row_mask:0xf bank_mask:0xf
    v_max_u32_dpp v49, v46, v40 row_half_mirror row_mask:0xf bank_mask:0xf
    v_max_u32_dpp v52, v43, v41 row_half_mirror row_mask:0xf bank_mask:0xf
    v_max_u32_dpp v48, v54, v42 row_half_mirror row_mask:0xf bank_mask:0xf
    v_max_u32_dpp v55, v56, v47 row_half_mirror row_mask:0xf bank_mask:0xf
    v_max_u32 v44, v53, v49
    v_min_u32 v49, v53, v49
    v_max_u32 v53, v45, v52
    v_min_u32 v52, v45, v52
    v_max_u32 v45, v51, v48
    v_min_u32 v48, v51, v48
    v_max_u32 v51, v50, v55
    v_min_u32 v55, v50, v55
    v_max_u32 v50, v44, v45
    v_min_u32 v45, v44, v45
    v_max_u32 v44, v53, v51
    v_min_u32 v51, v53, v51
    v_max_u32 v53, v49, v48
    v_min_u32 v48, v49, v48
    v_max_u32 v49, v52, v55
    v_min_u32 v55, v52, v55
    v_max_u32 v52, v50, v44
    v_min_u32 v44, v50, v44
    v_max_u32 v50, v45, v51
    v_min_u32 v51, v45, v51
    v_max_u32 v45, v53, v49
    v_min_u32 v49, v53, v49
    v_max_u32 v53, v48, v55
    v_min_u32 v55, v48, v55
    s_nop 1
    v_max_u32_dpp v56, v55, v52 row_mirror row_mask:0xf bank_mask:0xf
    v_max_u32_dpp v54, v53, v44 row_mirror row_mask:0xf bank_mask:0xf
    v_max_u32_dpp v43, v49, v50 row_mirror row_mask:0xf bank_mask:0xf
    v_max_u32_dpp v46, v45, v51 row_mirror row_mask:0xf bank_mask:0xf
    v_max_u32_dpp v40, v51, v45 row_mirror row_mask:0xf bank_mask:0xf
    v_max_u32_dpp v41, v50, v49 row_mirror row_mask:0xf bank_mask:0xf
    v_max_u32_dpp v42, v44, v53 row_mirror row_mask:0xf bank_mask:0xf
    v_max_u32_dpp v47, v52, v55 row_mirror row_mask:0xf bank_mask:0xf
    v_max_u32 v48, v56, v40
    v_min_u32 v40, v56, v40
    v_max_u32 v56, v54, v41
    v_min_u32 v41, v54, v41
    v_max_u32 v54, v43, v42
    v_min_u32 v42, v43, v42
    v_max_u32 v43, v46, v47
    v_min_u32 v47, v46, v47
    v_max_u32 v46, v48, v54
    v_min_u32 v54, v48, v54
    v_max_u32 v48, v56, v43
    v_min_u32 v43, v56, v43
    v_max_u32 v56, v40, v42
    v_min_u32 v42, v40, v42
    v_max_u32 v40, v41, v47
    v_min_u32 v47, v41, v47
    v_max_u32 v41, v46, v48
    v_min_u32 v48, v46, v48
    v_max_u32 v46, v54, v43
    v_min_u32 v43, v54, v43
    v_max_u32 v54, v56, v40
    v_min_u32 v40, v56, v40
    v_max_u32 v56, v42, v47
    v_min_u32 v47, v42, v47
    v_mov_b32 v60, v41
    v_mov_b32 v61, v48
    v_mov_b32 v62, v46
    v_mov_b32 v63, v43
    v_mov_b32 v64, v54
    v_mov_b32 v65, v40
    v_mov_b32 v66, v56
    v_mov_b32 v67, v47
    v_lshrrev_b32 v57, 4, v0
    v_lshlrev_b32 v57, 5, v57
    v_and_b32 v58, 15, v0
    v_cmp_eq_u32 vcc, 0, v58
    v_lshlrev_b32 v58, 5, v58
    s_and_saveexec_b64 s[18:19], vcc
    ds_write_b128 v57, v[60:63] offset:61440
    ds_write_b128 v57, v[64:67] offset:61456
    s_mov_b64 exec, s[18:19]
    s_waitcnt lgkmcnt(0)
    s_barrier
    ds_read_b128 v[40:43], v58 offset:61440
    ds_read_b128 v[44:47], v58 offset:61456
    s_waitcnt lgkmcnt(0)
    v_max_u32_dpp v48, v47, v40 quad_perm:[1,0,3,2] row_mask:0xf bank_mask:0xf
    v_max_u32_dpp v49, v46, v41 quad_perm:[1,0,3,2] row_mask:0xf bank_mask:0xf
    v_max_u32_dpp v50, v45, v42 quad_perm:[1,0,3,2] row_mask:0xf bank_mask:0xf
    v_max_u32_dpp v51, v44, v43 quad_perm:[1,0,3,2] row_mask:0xf bank_mask:0xf
    v_max_u32_dpp v52, v43, v44 quad_perm:[1,0,3,2] row_mask:0xf bank_mask:0xf
    v_max_u32_dpp v53, v42, v45 quad_perm:[1,0,3,2] row_mask:0xf bank_mask:0xf
    v_max_u32_dpp v54, v41, v46 quad_perm:[1,0,3,2] row_mask:0xf bank_mask:0xf
    v_max_u32_dpp v55, v40, v47 quad_perm:[1,0,3,2] row_mask:0xf bank_mask:0xf
    v_max_u32 v56, v48, v52
    v_min_u32 v52, v48, v52
    v_max_u32 v48, v49, v53
    v_min_u32 v53, v49, v53
    v_max_u32 v49, v50, v54
    v_min_u32 v54, v50, v54
    v_max_u32 v50, v51, v55
    v_min_u32 v55, v51, v55
    v_max_u32 v51, v56, v49
    v_min_u32 v49, v56, v49
    v_max_u32 v56, v48, v50
    v_min_u32 v50, v48, v50
    v_max_u32 v48, v52, v54
    v_min_u32 v54, v52, v54
    v_max_u32 v52, v53, v55
    v_min_u32 v55, v53, v55
    v_max_u32 v53, v51, v56
    v_min_u32 v56, v51, v56
    v_max_u32 v51, v49, v50
    v_min_u32 v50, v49, v50
    v_max_u32 v49, v48, v52
    v_min_u32 v52, v48, v52
    v_max_u32 v48, v54, v55
    v_min_u32 v55, v54, v55
    s_nop 1
    v_max_u32_dpp v40, v55, v53 quad_perm:[2,3,0,1] row_mask:0xf bank_mask:0xf
    v_max_u32_dpp v41, v48, v56 quad_perm:[2,3,0,1] row_mask:0xf bank_mask:0xf
    v_max_u32_dpp v42, v52, v51 quad_perm:[2,3,0,1] row_mask:0xf bank_mask:0xf
    v_max_u32_dpp v43, v49, v50 quad_perm:[2,3,0,1] row_mask:0xf bank_mask:0xf
    v_max_u32_dpp v44, v50, v49 quad_perm:[2,3,0,1] row_mask:0xf bank_mask:0xf
    v_max_u32_dpp v45, v51, v52 quad_perm:[2,3,0,1] row_mask:0xf bank_mask:0xf
    v_max_u32_dpp v46, v56, v48 quad_perm:[2,3,0,1] row_mask:0xf bank_mask:0xf
    v_max_u32_dpp v47, v53, v55 quad_perm:[2,3,0,1] row_mask:0xf bank_mask:0xf
    v_max_u32 v54, v40, v44
    v_min_u32 v44, v40, v44
    v_max_u32 v40, v41, v45
    v_min_u32 v45, v41, v45
    v_max_u32 v41, v42, v46
    v_min_u32 v46, v42, v46
    v_max_u32 v42, v43, v47
    v_min_u32 v47, v43, v47
    v_max_u32 v43, v54, v41
    v_min_u32 v41, v54, v41
    v_max_u32 v54, v40, v42
    v_min_u32 v42, v40, v42
    v_max_u32 v40, v44, v46
    v_min_u32 v46, v44, v46
    v_max_u32 v44, v45, v47
    v_min_u32 v47, v45, v47
    v_max_u32 v45, v43, v54
    v_min_u32 v54, v43, v54
    v_max_u32 v43, v41, v42
    v_min_u32 v42, v41, v42
    v_max_u32 v41, v40, v44
    v_min_u32 v44, v40, v44
    v_max_u32 v40, v46, v47
    v_min_u32 v47, v46, v47
    s_nop 1
    v_max_u32_dpp v53, v47, v45 row_half_mirror row_mask:0xf bank_mask:0xf
    v_max_u32_dpp v56, v40, v54 row_half_mirror row_mask:0xf bank_mask:0xf
    v_max_u32_dpp v51, v44, v43 row_half_mirror row_mask:0xf bank_mask:0xf
    v_max_u32_dpp v50, v41, v42 row_half_mirror row_mask:0xf bank_mask:0xf
    v_max_u32_dpp v49, v42, v41 row_half_mirror row_mask:0xf bank_mask:0xf
    v_max_u32_dpp v52, v43, v44 row_half_mirror row_mask:0xf bank_mask:0xf
    v_max_u32_dpp v48, v54, v40 row_half_mirror row_mask:0xf bank_mask:0xf
    v_max_u32_dpp v55, v45, v47 row_half_mirror row_mask:0xf bank_mask:0xf
    v_max_u32 v46, v53, v49
    v_min_u32 v49, v53, v49
    v_max_u32 v53, v56, v52
    v_min_u32 v52, v56, v52
    v_max_u32 v56, v51, v48
    v_min_u32 v48, v51, v48
    v_max_u32 v51, v50, v55
    v_min_u32 v55, v50, v55
    v_max_u32 v50, v46, v56
    v_min_u32 v56, v46, v56
    v_max_u32 v46, v53, v51
    v_min_u32 v51, v53, v51
    v_max_u32 v53, v49, v48
    v_min_u32 v48, v49, v48
    v_max_u32 v49, v52, v55
    v_min_u32 v55, v52, v55
    v_max_u32 v52, v50, v46
    v_min_u32 v46, v50, v46
    v_max_u32 v50, v56, v51
    v_min_u32 v51, v56, v51
    v_max_u32 v56, v53, v49
    v_min_u32 v49, v53, v49
    v_max_u32 v53, v48, v55
    v_min_u32 v55, v48, v55
    s_nop 1
    v_max_u32_dpp v45, v55, v52 row_mirror row_mask:0xf bank_mask:0xf
    v_max_u32_dpp v54, v53, v46 row_mirror row_mask:0xf bank_mask:0xf
    v_max_u32_dpp v43, v49, v50 row_mirror row_mask:0xf bank_mask:0xf
    v_max_u32_dpp v42, v56, v51 row_mirror row_mask:0xf bank_mask:0xf
    v_max_u32_dpp v41, v51, v56 row_mirror row_mask:0xf bank_mask:0xf
    v_max_u32_dpp v44, v50, v49 row_mirror row_mask:0xf bank_mask:0xf
    v_max_u32_dpp v40, v46, v53 row_mirror row_mask:0xf bank_mask:0xf
    v_max_u32_dpp v47, v52, v55 row_mirror row_mask:0xf bank_mask:0xf
    v_max_u32 v48, v45, v41
    v_min_u32 v41, v45, v41
    v_max_u32 v45, v54, v44
    v_min_u32 v44, v54, v44
    v_max_u32 v54, v43, v40
    v_min_u32 v40, v43, v40
    v_max_u32 v43, v42, v47
    v_min_u32 v47, v42, v47
    v_max_u32 v42, v48, v54
    v_min_u32 v54, v48, v54
    v_max_u32 v48, v45, v43
    v_min_u32 v43, v45, v43
    v_max_u32 v45, v41, v40
    v_min_u32 v40, v41, v40
    v_max_u32 v41, v44, v47
    v_min_u32 v47, v44, v47
    v_max_u32 v44, v42, v48
    v_min_u32 v48, v42, v48
    v_max_u32 v42, v54, v43
    v_min_u32 v43, v54, v43
    v_max_u32 v54, v45, v41
    v_min_u32 v41, v45, v41
    v_max_u32 v45, v40, v47
    v_min_u32 v47, v40, v47
    v_mov_b32 v7, v44
    s_mov_b32 s52, 0x02020202
    s_mov_b32 s53, 0x02020202
    v_cndmask_b32 v7, v7, v48, s[52:53]
    s_mov_b32 s52, 0x04040404
    s_mov_b32 s53, 0x04040404
    v_cndmask_b32 v7, v7, v42, s[52:53]
    s_mov_b32 s52, 0x08080808
    s_mov_b32 s53, 0x08080808
    v_cndmask_b32 v7, v7, v43, s[52:53]
    s_mov_b32 s52, 0x10101010
    s_mov_b32 s53, 0x10101010
    v_cndmask_b32 v7, v7, v54, s[52:53]
    s_mov_b32 s52, 0x20202020
    s_mov_b32 s53, 0x20202020
    v_cndmask_b32 v7, v7, v41, s[52:53]
    s_mov_b32 s52, 0x40404040
    s_mov_b32 s53, 0x40404040
    v_cndmask_b32 v7, v7, v45, s[52:53]
    s_mov_b32 s52, 0x80808080
    s_mov_b32 s53, 0x80808080
    v_cndmask_b32 v7, v7, v47, s[52:53]
    s_or_b32 s16, s2, s44
    s_cmp_lg_u32 s16, 0
    s_cbranch_scc1 K4_NOSEL
    v_lshlrev_b32 v8, 2, v2
    s_mov_b64 exec, 0xff
    buffer_store_dword v7, v8, s[48:51], 0 offen
    s_mov_b64 exec, -1
K4_NOSEL:
    v_and_b32 v7, 0x7ff, v7
    v_sub_u32 v7, 2047, v7
    s_movk_i32 s16, 1152
    v_mul_lo_u32 v7, v7, s16
    v_lshrrev_b32 v8, 4, v2
    v_lshl_add_u32 v7, v8, 3, v7
    s_mul_i32 s18, s17, 576
    buffer_load_dwordx2 v[72:73], v7, s[32:35], s18 offen offset:0
    buffer_load_dwordx2 v[74:75], v7, s[32:35], s18 offen offset:32
    buffer_load_dwordx2 v[76:77], v7, s[32:35], s18 offen offset:64
    buffer_load_dwordx2 v[78:79], v7, s[32:35], s18 offen offset:96
    buffer_load_dwordx2 v[80:81], v7, s[32:35], s18 offen offset:128
    buffer_load_dwordx2 v[82:83], v7, s[32:35], s18 offen offset:160
    buffer_load_dwordx2 v[84:85], v7, s[32:35], s18 offen offset:192
    buffer_load_dwordx2 v[86:87], v7, s[32:35], s18 offen offset:224
    buffer_load_dwordx2 v[88:89], v7, s[32:35], s18 offen offset:256
    buffer_load_dwordx2 v[90:91], v7, s[32:35], s18 offen offset:288
    buffer_load_dwordx2 v[92:93], v7, s[32:35], s18 offen offset:320
    buffer_load_dwordx2 v[94:95], v7, s[32:35], s18 offen offset:352
    buffer_load_dwordx2 v[96:97], v7, s[32:35], s18 offen offset:384
    buffer_load_dwordx2 v[98:99], v7, s[32:35], s18 offen offset:416
    buffer_load_dwordx2 v[100:101], v7, s[32:35], s18 offen offset:448
    buffer_load_dwordx2 v[102:103], v7, s[32:35], s18 offen offset:480
    buffer_load_dwordx2 v[104:105], v7, s[32:35], s18 offen offset:512
    buffer_load_dwordx2 v[106:107], v7, s[32:35], s18 offen offset:544
    v_lshlrev_b32 v9, 3, v2
    v_add_u32 v10, s45, v9
    v_add_u32 v11, s46, v9
    s_waitcnt vmcnt(18)
    ds_read_b64_tr_b16 v[112:113], v10 offset:0
    ds_read_b64_tr_b16 v[114:115], v10 offset:512
    ds_read_b64_tr_b16 v[116:117], v10 offset:1024
    ds_read_b64_tr_b16 v[118:119], v10 offset:1536
    ds_read_b64_tr_b16 v[120:121], v10 offset:2048
    ds_read_b64_tr_b16 v[122:123], v10 offset:2560
    ds_read_b64_tr_b16 v[124:125], v10 offset:3072
    ds_read_b64_tr_b16 v[126:127], v10 offset:3584
    ds_read_b64_tr_b16 v[128:129], v10 offset:4096
    ds_read_b64_tr_b16 v[130:131], v10 offset:4608
    ds_read_b64_tr_b16 v[132:133], v10 offset:5120
    ds_read_b64_tr_b16 v[134:135], v10 offset:5632
    ds_read_b64_tr_b16 v[136:137], v10 offset:6144
    ds_read_b64_tr_b16 v[138:139], v10 offset:6656
    ds_read_b64_tr_b16 v[140:141], v10 offset:7168
    ds_read_b64_tr_b16 v[142:143], v10 offset:7680
    ds_read_b64_tr_b16 v[144:145], v10 offset:8192
    ds_read_b64_tr_b16 v[146:147], v10 offset:8704
    v_mov_b32 v12, 0
    v_mov_b32 v13, 0
    v_mov_b32 v14, 0
    v_mov_b32 v15, 0
    s_waitcnt lgkmcnt(0)
    s_waitcnt vmcnt(16)
    v_mfma_f32_16x16x32_bf16 v[12:15], v[112:115], v[72:75], v[12:15]
    s_waitcnt vmcnt(14)
    v_mfma_f32_16x16x32_bf16 v[12:15], v[116:119], v[76:79], v[12:15]
    s_waitcnt vmcnt(12)
    v_mfma_f32_16x16x32_bf16 v[12:15], v[120:123], v[80:83], v[12:15]
    s_waitcnt vmcnt(10)
    v_mfma_f32_16x16x32_bf16 v[12:15], v[124:127], v[84:87], v[12:15]
    s_waitcnt vmcnt(8)
    v_mfma_f32_16x16x32_bf16 v[12:15], v[128:131], v[88:91], v[12:15]
    s_waitcnt vmcnt(6)
    v_mfma_f32_16x16x32_bf16 v[12:15], v[132:135], v[92:95], v[12:15]
    s_waitcnt vmcnt(4)
    v_mfma_f32_16x16x32_bf16 v[12:15], v[136:139], v[96:99], v[12:15]
    s_waitcnt vmcnt(2)
    v_mfma_f32_16x16x32_bf16 v[12:15], v[140:143], v[100:103], v[12:15]
    s_waitcnt vmcnt(0)
    v_mfma_f32_16x16x32_bf16 v[12:15], v[144:147], v[104:107], v[12:15]
    ds_read_b64_tr_b16 v[40:41], v11 offset:36864
    ds_read_b64_tr_b16 v[42:43], v11 offset:37376
    ds_read_b64_tr_b16 v[44:45], v11 offset:37888
    ds_read_b64_tr_b16 v[46:47], v11 offset:38400
    ds_read_b64_tr_b16 v[48:49], v11 offset:38912
    ds_read_b64_tr_b16 v[50:51], v11 offset:39424
    ds_read_b64_tr_b16 v[52:53], v11 offset:39936
    ds_read_b64_tr_b16 v[54:55], v11 offset:40448
    ds_read_b64_tr_b16 v[56:57], v11 offset:40960
    v_lshlrev_b32 v16, 4, v0
    v_lshlrev_b32 v17, 4, v2
    ds_write_b128 v16, v[12:15] offset:57344
    s_waitcnt lgkmcnt(0)
    s_barrier
    ds_read_b128 v[20:23], v17 offset:57344
    ds_read_b128 v[24:27], v17 offset:58368
    ds_read_b128 v[28:31], v17 offset:59392
    ds_read_b128 v[32:35], v17 offset:60416
    s_waitcnt lgkmcnt(0)
    v_add_f32 v20, v20, v28
    v_add_f32 v24, v24, v32
    v_add_f32 v21, v21, v29
    v_add_f32 v25, v25, v33
    v_add_f32 v22, v22, v30
    v_add_f32 v26, v26, v34
    v_add_f32 v23, v23, v31
    v_add_f32 v27, v27, v35
    v_cvt_pk_bf16_f32 v21, v20, v21
    v_cvt_pk_bf16_f32 v25, v24, v25
    v_lshlrev_b32 v20, 16, v21
    v_and_b32 v21, 0xffff0000, v21
    v_lshlrev_b32 v24, 16, v25
    v_and_b32 v25, 0xffff0000, v25
    v_cvt_pk_bf16_f32 v23, v22, v23
    v_cvt_pk_bf16_f32 v27, v26, v27
    v_lshlrev_b32 v22, 16, v23
    v_and_b32 v23, 0xffff0000, v23
    v_lshlrev_b32 v26, 16, v27
    v_and_b32 v27, 0xffff0000, v27
    v_mul_f32 v28, 0xbfb8aa3b, v20
    v_mul_f32 v29, 0xbfb8aa3b, v21
    v_mul_f32 v30, 0xbfb8aa3b, v22
    v_mul_f32 v31, 0xbfb8aa3b, v23
    v_exp_f32 v28, v28
    v_exp_f32 v29, v29
    v_exp_f32 v30, v30
    v_exp_f32 v31, v31
    v_add_f32 v28, 1.0, v28
    v_add_f32 v29, 1.0, v29
    v_add_f32 v30, 1.0, v30
    v_add_f32 v31, 1.0, v31
    v_rcp_f32 v28, v28
    v_rcp_f32 v29, v29
    v_rcp_f32 v30, v30
    v_rcp_f32 v31, v31
    v_mul_f32 v20, v20, v28
    v_mul_f32 v21, v21, v29
    v_mul_f32 v22, v22, v30
    v_mul_f32 v23, v23, v31
    v_cvt_pk_bf16_f32 v21, v20, v21
    v_lshlrev_b32 v20, 16, v21
    v_and_b32 v21, 0xffff0000, v21
    v_cvt_pk_bf16_f32 v23, v22, v23
    v_lshlrev_b32 v22, 16, v23
    v_and_b32 v23, 0xffff0000, v23
    v_mul_f32 v20, v20, v24
    v_mul_f32 v21, v21, v25
    v_mul_f32 v22, v22, v26
    v_mul_f32 v23, v23, v27
    v_cvt_pk_bf16_f32 v28, v20, v21
    v_cvt_pk_bf16_f32 v29, v22, v23
    v_and_b32 v18, 15, v2
    s_movk_i32 s16, 2304
    v_mul_lo_u32 v19, v18, s16
    v_lshl_add_u32 v19, v8, 4, v19
    s_mul_i32 s18, s3, 18432
    s_mul_i32 s19, s44, 576
    s_add_u32 s18, s18, s19
    v_mfma_f32_16x16x16_bf16 v[72:75], v[40:41], v[28:29], 0
    v_mfma_f32_16x16x16_bf16 v[76:79], v[42:43], v[28:29], 0
    v_mfma_f32_16x16x16_bf16 v[80:83], v[44:45], v[28:29], 0
    v_mfma_f32_16x16x16_bf16 v[84:87], v[46:47], v[28:29], 0
    v_mfma_f32_16x16x16_bf16 v[88:91], v[48:49], v[28:29], 0
    v_mfma_f32_16x16x16_bf16 v[92:95], v[50:51], v[28:29], 0
    v_mfma_f32_16x16x16_bf16 v[96:99], v[52:53], v[28:29], 0
    v_mfma_f32_16x16x16_bf16 v[100:103], v[54:55], v[28:29], 0
    v_mfma_f32_16x16x16_bf16 v[104:107], v[56:57], v[28:29], 0
    v_cmp_gt_u32 vcc, 8, v18
    s_nop 0
    s_and_saveexec_b64 s[52:53], vcc
    buffer_store_dwordx4 v[72:75], v19, s[36:39], s18 offen offset:0
    buffer_store_dwordx4 v[76:79], v19, s[36:39], s18 offen offset:64
    buffer_store_dwordx4 v[80:83], v19, s[36:39], s18 offen offset:128
    buffer_store_dwordx4 v[84:87], v19, s[36:39], s18 offen offset:192
    buffer_store_dwordx4 v[88:91], v19, s[36:39], s18 offen offset:256
    buffer_store_dwordx4 v[92:95], v19, s[36:39], s18 offen offset:320
    buffer_store_dwordx4 v[96:99], v19, s[36:39], s18 offen offset:384
    buffer_store_dwordx4 v[100:103], v19, s[36:39], s18 offen offset:448
    buffer_store_dwordx4 v[104:107], v19, s[36:39], s18 offen offset:512
K4_END:
    s_endpgm
    .text
    .globl fin_kernel
    .p2align 8
    .type fin_kernel,@function
fin_kernel:
    s_cmp_ge_u32 s2, 288
    s_cbranch_scc1 K5_END
    s_load_dwordx2 s[4:5], s[0:1], 128
    s_load_dwordx2 s[6:7], s[0:1], 112
    s_mul_hi_u32 s16, s2, 119304648
    s_mul_i32 s17, s16, 36
    s_sub_u32 s17, s2, s17
    v_lshrrev_b32 v1, 2, v0
    v_and_b32 v2, 3, v0
    s_mov_b32 s18, 165888
    v_mul_lo_u32 v3, v1, s18
    v_lshl_add_u32 v3, v2, 4, v3
    s_lshl_b32 s19, s2, 6
    s_lshl_b32 s20, s16, 2
    v_mov_b32 v4, s20
    s_waitcnt lgkmcnt(0)
    s_add_u32 s8, s4, 11804928
    s_addc_u32 s9, s5, 0
    s_mov_b32 s10, 5308416
    s_mov_b32 s11, 0x00020000
    s_add_u32 s12, s4, 11804672
    s_addc_u32 s13, s5, 0
    s_mov_b32 s14, 256
    s_mov_b32 s15, 0x00020000
    s_add_u32 s24, s4, 7077888
    s_addc_u32 s25, s5, 0
    s_mov_b32 s26, 2359296
    s_mov_b32 s27, 0x00020000
    s_add_u32 s28, s4, 9437184
    s_addc_u32 s29, s5, 0
    s_mov_b32 s30, 2359296
    s_mov_b32 s31, 0x00020000
    s_mov_b32 s32, s6
    s_mov_b32 s33, s7
    s_mov_b32 s34, 2359296
    s_mov_b32 s35, 0x00020000
    buffer_load_dword v5, v4, s[12:15], 0 offen
    buffer_load_dwordx4 v[12:15], v3, s[8:11], s19 offen
    s_add_u32 s19, s19, 18432
    buffer_load_dwordx4 v[16:19], v3, s[8:11], s19 offen
    s_add_u32 s19, s19, 18432
    buffer_load_dwordx4 v[20:23], v3, s[8:11], s19 offen
    s_add_u32 s19, s19, 18432
    buffer_load_dwordx4 v[24:27], v3, s[8:11], s19 offen
    s_add_u32 s19, s19, 18432
    buffer_load_dwordx4 v[28:31], v3, s[8:11], s19 offen
    s_add_u32 s19, s19, 18432
    buffer_load_dwordx4 v[32:35], v3, s[8:11], s19 offen
    s_add_u32 s19, s19, 18432
    buffer_load_dwordx4 v[36:39], v3, s[8:11], s19 offen
    s_add_u32 s19, s19, 18432
    buffer_load_dwordx4 v[40:43], v3, s[8:11], s19 offen
    s_add_u32 s19, s19, 18432
    buffer_load_dwordx4 v[44:47], v3, s[8:11], s19 offen
    s_waitcnt vmcnt(9)
    v_and_b32 v6, 0x7ff, v5
    v_sub_u32 v6, 2047, v6
    s_movk_i32 s18, 1152
    v_mul_lo_u32 v6, v6, s18
    v_and_b32 v7, 15, v0
    v_lshl_add_u32 v6, v7, 1, v6
    s_lshl_b32 s20, s17, 5
    buffer_load_ushort v8, v6, s[24:27], s20 offen
    buffer_load_ushort v9, v6, s[28:31], s20 offen
    v_and_b32 v5, 0xffff0000, v5
    v_ashrrev_i32 v10, 31, v5
    v_not_b32 v10, v10
    v_or_b32 v10, 0x80000000, v10
    v_xor_b32 v5, v5, v10
    v_and_b32 v5, 0xffff0000, v5
    v_mul_f32 v5, 0xbfb8aa3b, v5
    v_exp_f32 v5, v5
    s_nop 0
    v_add_f32 v5, 1.0, v5
    v_rcp_f32 v5, v5
    s_nop 0
    v_cvt_pk_bf16_f32 v5, v5, v5
    v_lshlrev_b32 v5, 16, v5
    s_waitcnt vmcnt(9)
    v_add_f32 v12, v12, v16
    v_add_f32 v13, v13, v17
    v_add_f32 v14, v14, v18
    v_add_f32 v15, v15, v19
    s_waitcnt vmcnt(8)
    v_add_f32 v12, v12, v20
    v_add_f32 v13, v13, v21
    v_add_f32 v14, v14, v22
    v_add_f32 v15, v15, v23
    s_waitcnt vmcnt(7)
    v_add_f32 v12, v12, v24
    v_add_f32 v13, v13, v25
    v_add_f32 v14, v14, v26
    v_add_f32 v15, v15, v27
    s_waitcnt vmcnt(6)
    v_add_f32 v12, v12, v28
    v_add_f32 v13, v13, v29
    v_add_f32 v14, v14, v30
    v_add_f32 v15, v15, v31
    s_waitcnt vmcnt(5)
    v_add_f32 v12, v12, v32
    v_add_f32 v13, v13, v33
    v_add_f32 v14, v14, v34
    v_add_f32 v15, v15, v35
    s_waitcnt vmcnt(4)
    v_add_f32 v12, v12, v36
    v_add_f32 v13, v13, v37
    v_add_f32 v14, v14, v38
    v_add_f32 v15, v15, v39
    s_waitcnt vmcnt(3)
    v_add_f32 v12, v12, v40
    v_add_f32 v13, v13, v41
    v_add_f32 v14, v14, v42
    v_add_f32 v15, v15, v43
    s_waitcnt vmcnt(2)
    v_add_f32 v12, v12, v44
    v_add_f32 v13, v13, v45
    v_add_f32 v14, v14, v46
    v_add_f32 v15, v15, v47
    v_lshlrev_b32 v10, 4, v0
    ds_write_b128 v10, v[12:15]
    v_lshlrev_b32 v11, 2, v7
    s_waitcnt lgkmcnt(0)
    s_barrier
    v_cmp_gt_u32 vcc, 16, v0
    s_nop 0
    s_and_saveexec_b64 s[36:37], vcc
    s_cbranch_execz K5_END
    ds_read_b32 v12, v11 offset:0
    ds_read_b32 v13, v11 offset:64
    ds_read_b32 v14, v11 offset:128
    ds_read_b32 v15, v11 offset:192
    ds_read_b32 v16, v11 offset:256
    ds_read_b32 v17, v11 offset:320
    ds_read_b32 v18, v11 offset:384
    ds_read_b32 v19, v11 offset:448
    s_waitcnt lgkmcnt(0)
    ds_read_b32 v20, v11 offset:512
    ds_read_b32 v21, v11 offset:576
    ds_read_b32 v22, v11 offset:640
    ds_read_b32 v23, v11 offset:704
    ds_read_b32 v24, v11 offset:768
    ds_read_b32 v25, v11 offset:832
    ds_read_b32 v26, v11 offset:896
    ds_read_b32 v27, v11 offset:960
    s_waitcnt lgkmcnt(0)
    ds_read_b32 v28, v11 offset:1024
    ds_read_b32 v29, v11 offset:1088
    ds_read_b32 v30, v11 offset:1152
    ds_read_b32 v31, v11 offset:1216
    ds_read_b32 v32, v11 offset:1280
    ds_read_b32 v33, v11 offset:1344
    ds_read_b32 v34, v11 offset:1408
    ds_read_b32 v35, v11 offset:1472
    s_waitcnt lgkmcnt(0)
    ds_read_b32 v36, v11 offset:1536
    ds_read_b32 v37, v11 offset:1600
    ds_read_b32 v38, v11 offset:1664
    ds_read_b32 v39, v11 offset:1728
    ds_read_b32 v40, v11 offset:1792
    ds_read_b32 v41, v11 offset:1856
    ds_read_b32 v42, v11 offset:1920
    ds_read_b32 v43, v11 offset:1984
    s_waitcnt lgkmcnt(0)
    v_add_f32 v12, v12, v28
    v_add_f32 v13, v13, v29
    v_add_f32 v14, v14, v30
    v_add_f32 v15, v15, v31
    v_add_f32 v16, v16, v32
    v_add_f32 v17, v17, v33
    v_add_f32 v18, v18, v34
    v_add_f32 v19, v19, v35
    v_add_f32 v20, v20, v36
    v_add_f32 v21, v21, v37
    v_add_f32 v22, v22, v38
    v_add_f32 v23, v23, v39
    v_add_f32 v24, v24, v40
    v_add_f32 v25, v25, v41
    v_add_f32 v26, v26, v42
    v_add_f32 v27, v27, v43
    v_add_f32 v12, v12, v20
    v_add_f32 v13, v13, v21
    v_add_f32 v14, v14, v22
    v_add_f32 v15, v15, v23
    v_add_f32 v16, v16, v24
    v_add_f32 v17, v17, v25
    v_add_f32 v18, v18, v26
    v_add_f32 v19, v19, v27
    v_add_f32 v12, v12, v16
    v_add_f32 v13, v13, v17
    v_add_f32 v14, v14, v18
    v_add_f32 v15, v15, v19
    v_add_f32 v12, v12, v14
    v_add_f32 v13, v13, v15
    v_add_f32 v12, v12, v13
    v_cvt_pk_bf16_f32 v12, v12, v12
    v_lshlrev_b32 v12, 16, v12
    v_mul_f32 v12, v12, v5
    v_cvt_pk_bf16_f32 v12, v12, v12
    v_lshlrev_b32 v12, 16, v12
    s_waitcnt vmcnt(0)
    v_lshlrev_b32 v8, 16, v8
    v_lshlrev_b32 v9, 16, v9
    v_add_f32 v12, v12, v8
    v_cvt_pk_bf16_f32 v12, v12, v12
    v_lshlrev_b32 v12, 16, v12
    v_add_f32 v12, v12, v9
    v_cvt_pk_bf16_f32 v12, v12, v12
    buffer_store_short v12, v6, s[32:35], s20 offen
K5_END:
    s_endpgm
.section .rodata,"a"
.p2align 6
.amdhsa_kernel prep_kernel
  .amdhsa_next_free_vgpr 88
  .amdhsa_next_free_sgpr 102
  .amdhsa_accum_offset 88
  .amdhsa_group_segment_fixed_size 0
  .amdhsa_kernarg_size 136
  .amdhsa_user_sgpr_count 2
  .amdhsa_user_sgpr_kernarg_segment_ptr 1
  .amdhsa_system_sgpr_workgroup_id_x 1
.end_amdhsa_kernel
.section .rodata,"a"
.p2align 6
.amdhsa_kernel conv_kernel
  .amdhsa_next_free_vgpr 172
  .amdhsa_next_free_sgpr 102
  .amdhsa_accum_offset 172
  .amdhsa_group_segment_fixed_size 0
  .amdhsa_kernarg_size 136
  .amdhsa_user_sgpr_count 2
  .amdhsa_user_sgpr_kernarg_segment_ptr 1
  .amdhsa_system_sgpr_workgroup_id_x 1
.end_amdhsa_kernel
.section .rodata,"a"
.p2align 6
.amdhsa_kernel ln2_kernel
  .amdhsa_next_free_vgpr 80
  .amdhsa_next_free_sgpr 102
  .amdhsa_accum_offset 80
  .amdhsa_group_segment_fixed_size 0
  .amdhsa_kernarg_size 136
  .amdhsa_user_sgpr_count 2
  .amdhsa_user_sgpr_kernarg_segment_ptr 1
  .amdhsa_system_sgpr_workgroup_id_x 1
.end_amdhsa_kernel
.section .rodata,"a"
.p2align 6
.amdhsa_kernel ffn_kernel
  .amdhsa_next_free_vgpr 152
  .amdhsa_next_free_sgpr 102
  .amdhsa_accum_offset 152
  .amdhsa_group_segment_fixed_size 0
  .amdhsa_kernarg_size 136
  .amdhsa_user_sgpr_count 2
  .amdhsa_user_sgpr_kernarg_segment_ptr 1
  .amdhsa_system_sgpr_workgroup_id_x 1
.end_amdhsa_kernel
.section .rodata,"a"
.p2align 6
.amdhsa_kernel fin_kernel
  .amdhsa_next_free_vgpr 48
  .amdhsa_next_free_sgpr 102
  .amdhsa_accum_offset 48
  .amdhsa_group_segment_fixed_size 0
  .amdhsa_kernarg_size 136
  .amdhsa_user_sgpr_count 2
  .amdhsa_user_sgpr_kernarg_segment_ptr 1
  .amdhsa_system_sgpr_workgroup_id_x 1
.end_amdhsa_kernel
```

```asm
; @launch grid=(256,1,1) block=(768,1,1) lds=143360
.amdgcn_target "amdgcn-amd-amdhsa--gfx950"
    .text
    .globl sequential_preLN__ssm_conv_s4__moe_arch_mod__prompt_kernel
    .p2align 8
    .type sequential_preLN__ssm_conv_s4__moe_arch_mod__prompt_kernel,@function
sequential_preLN__ssm_conv_s4__moe_arch_mod__prompt_kernel:
    s_cmp_ge_u32 s2, 256
    s_cbranch_scc1 END
    s_load_dwordx16 s[4:19], s[0:1], 0
    s_load_dwordx16 s[20:35], s[0:1], 64
    s_load_dwordx2 s[36:37], s[0:1], 128
    v_lshrrev_b32 v2, 6, v0
    v_and_b32 v1, 63, v0
    v_readfirstlane_b32 s38, v2
    v_lshlrev_b32 v3, 4, v0
    s_and_b32 s52, s2, 7
    s_mul_i32 s52, s52, 24
    s_lshr_b32 s53, s2, 3
    s_add_u32 s52, s52, s53
    s_sub_u32 s53, s2, 192
    v_mov_b32 v4, -1
    v_mov_b32 v8, 0
    v_mov_b32 v5, -1
    v_mov_b32 v9, 0
    v_mov_b32 v6, -1
    v_mov_b32 v10, 0
    v_mov_b32 v7, -1
    v_mov_b32 v11, 0
    v_add_u32 v12, 140288, v3
    v_cmp_gt_u32 vcc, 4, v0
    s_nop 0
    s_and_saveexec_b64 s[70:71], vcc
    ds_write_b128 v12, v[8:11]
    s_mov_b64 exec, s[70:71]
    s_cmp_ge_u32 s2, 192
    s_cbranch_scc1 P_NOUZ
    v_lshrrev_b32 v12, 5, v0
    s_movk_i32 s54, 4608
    v_mul_lo_u32 v12, v12, s54
    v_and_b32 v13, 31, v0
    v_lshl_add_u32 v12, v13, 4, v12
    v_add_u32 v12, 117760, v12
    v_cmp_gt_u32 vcc, 0x60, v0
    s_nop 0
    s_and_saveexec_b64 s[70:71], vcc
    ds_write_b128 v12, v[8:11]
    s_mov_b64 exec, s[70:71]
P_NOUZ:
    s_mul_i32 s54, s52, 12288
    s_add_u32 s54, s54, 65536
    s_movk_i32 s55, 12288
    s_cmp_lt_u32 s2, 192
    s_cbranch_scc1 P_R3
    s_mul_i32 s54, s53, 18432
    s_add_u32 s54, s54, 4784128
    s_movk_i32 s55, 18432
    s_cmp_lt_u32 s2, 240
    s_cbranch_scc1 P_R3
    s_sub_u32 s54, s2, 240
    s_mul_i32 s54, s54, 1152
    s_add_u32 s54, s54, 49152
    s_movk_i32 s55, 1152
    s_cmp_lt_u32 s2, 248
    s_cselect_b32 s55, s55, 0
P_R3:
    s_mul_i32 s56, s2, 9216
    s_add_u32 s56, s56, 2424832
    s_lshl_b32 s57, s2, 5
    s_add_u32 s57, s57, 32768
    s_movk_i32 s58, 8192
    s_movk_i32 s59, 16384
    s_lshl_b32 s64, s2, 3
    s_add_u32 s64, s64, s38
    s_mul_i32 s64, s64, 1152
    v_lshl_add_u32 v2, v1, 3, s64
    v_mov_b32 v20, 0
    v_mov_b32 v21, 0
    v_mov_b32 v22, 0
    v_mov_b32 v23, 0
    v_mov_b32 v24, 0
    v_mov_b32 v25, 0
    s_waitcnt lgkmcnt(0)
    s_load_dword s39, s[36:37], 0
    s_mov_b32 s40, s36
    s_mov_b32 s41, s37
    s_mov_b32 s42, 0x10000000
    s_mov_b32 s43, 0x00020000
    s_cmp_ge_u32 s38, 8
    s_cbranch_scc1 P_NOPOISON
    s_add_u32 s44, s36, s54
    s_addc_u32 s45, s37, 0
    s_mov_b32 s46, s55
    s_mov_b32 s47, 0x00020000
    s_add_u32 s48, s36, s56
    s_addc_u32 s49, s37, 0
    s_mov_b32 s50, 9216
    s_mov_b32 s51, 0x00020000
    s_add_u32 s72, s36, s57
    s_addc_u32 s73, s37, 0
    s_mov_b32 s74, 32
    s_mov_b32 s75, 0x00020000
    buffer_store_dwordx4 v[4:7], v3, s[44:47], 0 offen sc1
    buffer_store_dwordx4 v[4:7], v3, s[44:47], s58 offen sc1
    buffer_store_dwordx4 v[4:7], v3, s[44:47], s59 offen sc1
    buffer_store_dwordx4 v[4:7], v3, s[48:51], 0 offen sc1
    buffer_store_dwordx4 v[4:7], v3, s[48:51], s58 offen sc1
    buffer_store_dwordx4 v[4:7], v3, s[72:75], 0 offen sc1
P_NOPOISON:
    s_cmp_ge_u32 s2, 192
    s_cbranch_scc1 P_NOPARAM
    s_lshr_b32 s65, s38, 2
    s_mul_i32 s66, s52, 3
    s_add_u32 s66, s66, s65
    s_and_b32 s67, s38, 1
    s_lshl_b32 s67, s67, 6
    v_add_u32 v14, s67, v1
    s_lshl_b32 s67, s66, 8
    v_lshl_add_u32 v15, v14, 1, s67
    s_lshl_b32 s67, s66, 1
    v_mov_b32 v16, s67
    global_load_ushort v30, v16, s[18:19]
    global_load_ushort v31, v15, s[6:7]
    global_load_ushort v32, v15, s[8:9]
    global_load_ushort v33, v15, s[10:11]
    global_load_ushort v34, v15, s[12:13]
    global_load_ushort v35, v15, s[14:15]
    global_load_ushort v36, v15, s[16:17]
    global_load_ushort v161, v16, s[20:21]
P_NOPARAM:
    s_cmp_ge_u32 s38, 8
    s_cbranch_scc1 P_NOROW
    s_mov_b32 exec_hi, 0xffff
    global_load_dwordx2 v[20:21], v2, s[4:5]
    global_load_dwordx2 v[22:23], v2, s[4:5] offset:384
    global_load_dwordx2 v[24:25], v2, s[4:5] offset:768
    s_mov_b64 exec, -1
P_NOROW:
    s_cmp_ge_u32 s2, 192
    s_cbranch_scc1 NONCONV
    s_cmp_lt_u32 s38, 4
    s_cbranch_scc1 P_NOCOL
    v_subrev_u32 v17, 0x100, v0
    s_movk_i32 s67, 4608
    v_mul_lo_u32 v17, v17, s67
    s_mul_i32 s67, s52, 6
    s_and_b32 s67, s67, 0xfffc
    v_add_u32 v17, s67, v17
    global_load_dwordx2 v[140:141], v17, s[4:5] offset:0
    global_load_dwordx2 v[142:143], v17, s[4:5] offset:1152
    global_load_dwordx2 v[144:145], v17, s[4:5] offset:2304
    global_load_dwordx2 v[146:147], v17, s[4:5] offset:3456
P_NOCOL:
    v_and_b32 v18, 0xff, v0
    v_lshlrev_b32 v18, 3, v18
    s_mul_i32 s67, s65, 3072
    s_add_u32 s67, s67, 104448
    s_sub_u32 s68, s67, 68096
    v_add_u32 v26, 0, v18
    v_add_u32 v27, 1, v18
    v_cvt_f32_u32 v28, v26
    v_cvt_f32_u32 v29, v27
    v_cvt_pk_bf16_f32 v28, v28, v29
    v_lshrrev_b32 v29, 16, v28
    v_and_b32 v28, 0xffff, v28
    v_lshl_add_u32 v28, v28, 2, s68
    v_lshl_add_u32 v29, v29, 2, s68
    v_lshl_add_u32 v26, v26, 2, s67
    v_lshl_add_u32 v27, v27, 2, s67
    v_cmp_gt_u32 vcc, 0x80, v18
    s_nop 1
    v_cndmask_b32 v150, v28, v26, vcc
    v_cndmask_b32 v151, v29, v27, vcc
    v_add_u32 v26, 2, v18
    v_add_u32 v27, 3, v18
    v_cvt_f32_u32 v28, v26
    v_cvt_f32_u32 v29, v27
    v_cvt_pk_bf16_f32 v28, v28, v29
    v_lshrrev_b32 v29, 16, v28
    v_and_b32 v28, 0xffff, v28
    v_lshl_add_u32 v28, v28, 2, s68
    v_lshl_add_u32 v29, v29, 2, s68
    v_lshl_add_u32 v26, v26, 2, s67
    v_lshl_add_u32 v27, v27, 2, s67
    v_cmp_gt_u32 vcc, 0x80, v18
    s_nop 1
    v_cndmask_b32 v152, v28, v26, vcc
    v_cndmask_b32 v153, v29, v27, vcc
    v_add_u32 v26, 4, v18
    v_add_u32 v27, 5, v18
    v_cvt_f32_u32 v28, v26
    v_cvt_f32_u32 v29, v27
    v_cvt_pk_bf16_f32 v28, v28, v29
    v_lshrrev_b32 v29, 16, v28
    v_and_b32 v28, 0xffff, v28
    v_lshl_add_u32 v28, v28, 2, s68
    v_lshl_add_u32 v29, v29, 2, s68
    v_lshl_add_u32 v26, v26, 2, s67
    v_lshl_add_u32 v27, v27, 2, s67
    v_cmp_gt_u32 vcc, 0x80, v18
    s_nop 1
    v_cndmask_b32 v154, v28, v26, vcc
    v_cndmask_b32 v155, v29, v27, vcc
    v_add_u32 v26, 6, v18
    v_add_u32 v27, 7, v18
    v_cvt_f32_u32 v28, v26
    v_cvt_f32_u32 v29, v27
    v_cvt_pk_bf16_f32 v28, v28, v29
    v_lshrrev_b32 v29, 16, v28
    v_and_b32 v28, 0xffff, v28
    v_lshl_add_u32 v28, v28, 2, s68
    v_lshl_add_u32 v29, v29, 2, s68
    v_lshl_add_u32 v26, v26, 2, s67
    v_lshl_add_u32 v27, v27, 2, s67
    v_cmp_gt_u32 vcc, 0x80, v18
    s_nop 1
    v_cndmask_b32 v156, v28, v26, vcc
    v_cndmask_b32 v157, v29, v27, vcc
    v_add_u32 v26, 8, v18
    v_add_u32 v27, 9, v18
    v_cvt_f32_u32 v28, v26
    v_cvt_f32_u32 v29, v27
    v_cvt_pk_bf16_f32 v28, v28, v29
    v_lshrrev_b32 v29, 16, v28
    v_and_b32 v28, 0xffff, v28
    v_lshl_add_u32 v28, v28, 2, s68
    v_lshl_add_u32 v29, v29, 2, s68
    v_lshl_add_u32 v26, v26, 2, s67
    v_lshl_add_u32 v27, v27, 2, s67
    v_cmp_gt_u32 vcc, 0x80, v18
    s_nop 1
    v_cndmask_b32 v158, v28, v26, vcc
    v_cndmask_b32 v159, v29, v27, vcc
    v_add_u32 v26, 10, v18
    v_add_u32 v27, 11, v18
    v_cvt_f32_u32 v28, v26
    v_cvt_f32_u32 v29, v27
    v_cvt_pk_bf16_f32 v28, v28, v29
    v_lshrrev_b32 v29, 16, v28
    v_and_b32 v28, 0xffff, v28
    v_lshl_add_u32 v28, v28, 2, s68
    v_lshl_add_u32 v29, v29, 2, s68
    v_lshl_add_u32 v26, v26, 2, s67
    v_lshl_add_u32 v27, v27, 2, s67
    v_cmp_gt_u32 vcc, 0x80, v18
    s_nop 1
    v_cndmask_b32 v160, v28, v26, vcc
    s_barrier
    s_cmp_ge_u32 s38, 8
    s_cbranch_scc1 C_NOLN1
    s_cmp_ge_u32 s38, 4
    s_cbranch_scc1 C_W4
    s_waitcnt vmcnt(0)
C_W4:
    s_waitcnt vmcnt(4)
    v_lshlrev_b32 v40, 16, v20
    v_and_b32 v41, 0xffff0000, v20
    v_lshlrev_b32 v42, 16, v21
    v_and_b32 v43, 0xffff0000, v21
    v_lshlrev_b32 v44, 16, v22
    v_and_b32 v45, 0xffff0000, v22
    v_lshlrev_b32 v46, 16, v23
    v_and_b32 v47, 0xffff0000, v23
    v_lshlrev_b32 v48, 16, v24
    v_and_b32 v49, 0xffff0000, v24
    v_lshlrev_b32 v50, 16, v25
    v_and_b32 v51, 0xffff0000, v25
    v_add_f32 v26, v40, v41
    v_add_f32 v27, v42, v43
    v_add_f32 v26, v26, v44
    v_add_f32 v27, v27, v45
    v_add_f32 v26, v26, v46
    v_add_f32 v27, v27, v47
    v_add_f32 v26, v26, v48
    v_add_f32 v27, v27, v49
    v_add_f32 v26, v26, v50
    v_add_f32 v27, v27, v51
    v_add_f32 v26, v26, v27
    s_nop 1
    v_add_f32_dpp v26, v26, v26 quad_perm:[1,0,3,2] row_mask:0xf bank_mask:0xf
    s_nop 1
    v_add_f32_dpp v26, v26, v26 quad_perm:[2,3,0,1] row_mask:0xf bank_mask:0xf
    s_nop 1
    v_add_f32_dpp v26, v26, v26 row_half_mirror row_mask:0xf bank_mask:0xf
    s_nop 1
    v_add_f32_dpp v26, v26, v26 row_mirror row_mask:0xf bank_mask:0xf
    v_mov_b32 v27, v26
    s_nop 1
    v_permlane16_swap_b32 v26, v27
    v_add_f32 v26, v26, v27
    v_mov_b32 v27, v26
    s_nop 1
    v_permlane32_swap_b32 v26, v27
    v_add_f32 v26, v26, v27
    v_mul_f32 v26, 0x3ae38e39, v26
    v_mov_b32 v27, 0
    v_mov_b32 v28, 0
    s_mov_b32 exec_hi, 0xffff
    v_sub_f32 v40, v40, v26
    v_sub_f32 v41, v41, v26
    v_fmac_f32 v27, v40, v40
    v_fmac_f32 v28, v41, v41
    v_sub_f32 v42, v42, v26
    v_sub_f32 v43, v43, v26
    v_fmac_f32 v27, v42, v42
    v_fmac_f32 v28, v43, v43
    v_sub_f32 v44, v44, v26
    v_sub_f32 v45, v45, v26
    v_fmac_f32 v27, v44, v44
    v_fmac_f32 v28, v45, v45
    v_sub_f32 v46, v46, v26
    v_sub_f32 v47, v47, v26
    v_fmac_f32 v27, v46, v46
    v_fmac_f32 v28, v47, v47
    v_sub_f32 v48, v48, v26
    v_sub_f32 v49, v49, v26
    v_fmac_f32 v27, v48, v48
    v_fmac_f32 v28, v49, v49
    v_sub_f32 v50, v50, v26
    v_sub_f32 v51, v51, v26
    v_fmac_f32 v27, v50, v50
    v_fmac_f32 v28, v51, v51
    s_mov_b64 exec, -1
    v_add_f32 v27, v27, v28
    s_nop 1
    v_add_f32_dpp v27, v27, v27 quad_perm:[1,0,3,2] row_mask:0xf bank_mask:0xf
    s_nop 1
    v_add_f32_dpp v27, v27, v27 quad_perm:[2,3,0,1] row_mask:0xf bank_mask:0xf
    s_nop 1
    v_add_f32_dpp v27, v27, v27 row_half_mirror row_mask:0xf bank_mask:0xf
    s_nop 1
    v_add_f32_dpp v27, v27, v27 row_mirror row_mask:0xf bank_mask:0xf
    v_mov_b32 v28, v27
    s_nop 1
    v_permlane16_swap_b32 v27, v28
    v_add_f32 v27, v27, v28
    v_mov_b32 v28, v27
    s_nop 1
    v_permlane32_swap_b32 v27, v28
    v_add_f32 v27, v27, v28
    v_mul_f32 v27, 0x3ae38e39, v27
    v_cvt_pk_bf16_f32 v27, v27, v27
    v_lshlrev_b32 v27, 16, v27
    v_add_f32 v27, 0x3727c5ac, v27
    v_cvt_pk_bf16_f32 v27, v27, v27
    v_lshlrev_b32 v27, 16, v27
    v_sqrt_f32 v27, v27
    s_nop 0
    v_cvt_pk_bf16_f32 v27, v27, v27
    v_lshlrev_b32 v27, 16, v27
    v_cvt_pk_bf16_f32 v26, v26, v27
    s_lshl_b32 s67, s38, 3
    v_mov_b32 v28, s67
    s_waitcnt lgkmcnt(0)
    s_add_u32 s39, s39, 1
    v_mov_b32 v27, s39
    v_mov_b32 v29, 1
    v_mov_b32 v37, 140288
    s_mov_b64 exec, 1
    v_add_u32 v28, 140352, v28
    ds_write_b64 v28, v[26:27]
    ds_add_rtn_u32 v29, v37, v29
    s_waitcnt lgkmcnt(0)
    v_readfirstlane_b32 s67, v29
    s_mov_b64 exec, -1
    s_cmp_lg_u32 s67, 7
    s_cbranch_scc1 LN1_X0
    v_lshlrev_b32 v28, 4, v1
    v_add_u32 v29, 140352, v28
    s_lshl_b32 s67, s2, 6
    s_add_u32 s67, s67, 4096
    s_mov_b64 exec, 0xf
    ds_read_b128 v[40:43], v29
    s_waitcnt lgkmcnt(0)
    buffer_store_dwordx4 v[40:43], v28, s[40:43], s67 offen sc1
    s_mov_b64 exec, -1
LN1_X0:
    s_branch C_KGEN
C_NOLN1:
    s_waitcnt vmcnt(4) lgkmcnt(0)
    s_add_u32 s39, s39, 1
C_KGEN:
    s_mov_b32 s62, 0x3e22f983
    s_mov_b32 s63, 0x31dc9c88
    s_mul_i32 s67, s65, 34816
    v_lshl_add_u32 v4, v14, 2, s67
    v_lshlrev_b32 v30, 16, v30
    s_mov_b32 s68, 0x3fb8aa3b
    s_mov_b32 s69, 0x32a57060
    v_mul_f32 v20, s68, v30
    v_fma_f32 v21, v30, s68, -v20
    v_fmac_f32 v21, s69, v30
    v_exp_f32 v20, v20
    v_mul_f32 v21, 0x3f317218, v21
    v_fma_f32 v20, v20, v21, v20
    v_cvt_pk_bf16_f32 v20, v20, v20
    v_lshlrev_b32 v20, 16, v20
    v_lshlrev_b32 v31, 16, v31
    v_lshlrev_b32 v32, 16, v32
    v_lshlrev_b32 v33, 16, v33
    v_lshlrev_b32 v34, 16, v34
    v_lshlrev_b32 v35, 16, v35
    v_lshlrev_b32 v36, 16, v36
    v_mul_f32 v11, v31, v20
    v_mul_f32 v12, v32, v20
    v_mul_f32 v13, v33, v20
    v_mul_f32 v10, v34, v20
    v_mul_f32 v11, s68, v11
    v_mul_f32 v22, v35, v13
    v_mul_f32 v23, v35, v10
    v_fma_f32 v22, -v36, v10, v22
    v_fmac_f32 v23, v36, v13
    s_mov_b32 s61, 0x43000000
    v_mul_f32 v30, s61, v11
    v_exp_f32 v30, v30
    v_mul_f32 v31, s61, v12
    v_mul_f32 v32, s62, v31
    v_fma_f32 v24, v31, s62, -v32
    v_fmac_f32 v24, s63, v31
    v_fract_f32 v32, v32
    v_add_f32 v32, v32, v24
    v_cos_f32 v24, v32
    v_sin_f32 v25, v32
    v_mul_f32 v24, v24, v30
    v_mul_f32 v25, v25, v30
    s_bitcmp1_b32 s38, 1
    s_cbranch_scc1 C_ROLE1
    s_mov_b32 s61, 0x41000000
    v_mul_f32 v30, s61, v11
    v_exp_f32 v30, v30
    v_mul_f32 v31, s61, v12
    v_mul_f32 v32, s62, v31
    v_fma_f32 v26, v31, s62, -v32
    v_fmac_f32 v26, s63, v31
    v_fract_f32 v32, v32
    v_add_f32 v32, v32, v26
    v_cos_f32 v26, v32
    v_sin_f32 v27, v32
    v_mul_f32 v26, v26, v30
    v_mul_f32 v27, v27, v30
    s_mov_b32 s61, 0x44800000
    v_mul_f32 v30, s61, v11
    v_exp_f32 v30, v30
    v_mul_f32 v31, s61, v12
    v_mul_f32 v32, s62, v31
    v_fma_f32 v28, v31, s62, -v32
    v_fmac_f32 v28, s63, v31
    v_fract_f32 v32, v32
    v_add_f32 v32, v32, v28
    v_cos_f32 v28, v32
    v_sin_f32 v29, v32
    v_mul_f32 v28, v28, v30
    v_mul_f32 v29, v29, v30
    v_mul_f32 v34, v22, v28
    v_mul_f32 v35, v22, v29
    v_fma_f32 v34, -v23, v29, v34
    v_fmac_f32 v35, v23, v28
    v_mov_b32 v36, 1.0
    v_mov_b32 v37, 0
    v_cvt_pk_bf16_f32 v40, v36, -v37
    ds_write_b32 v4, v40 offset:26112
    v_cvt_pk_bf16_f32 v41, v26, -v27
    ds_write_b32 v4, v41 offset:26656
    v_cvt_pk_bf16_f32 v42, v34, v35
    ds_write_b32 v4, v42 offset:17408
    v_mov_b32 v44, v26
    v_mov_b32 v45, v27
    v_mul_f32 v36, v26, v44
    v_mul_f32 v37, v26, v45
    v_fma_f32 v36, -v27, v45, v36
    v_fmac_f32 v37, v27, v44
    v_mul_f32 v38, v34, v24
    v_mul_f32 v39, v34, v25
    v_fma_f32 v38, -v35, v25, v38
    v_fmac_f32 v39, v35, v24
    v_cvt_pk_bf16_f32 v40, v36, -v37
    ds_write_b32 v4, v40 offset:27200
    v_cvt_pk_bf16_f32 v41, v38, v39
    ds_write_b32 v4, v41 offset:17952
    v_mul_f32 v26, v36, v44
    v_mul_f32 v27, v36, v45
    v_fma_f32 v26, -v37, v45, v26
    v_fmac_f32 v27, v37, v44
    v_mul_f32 v34, v38, v24
    v_mul_f32 v35, v38, v25
    v_fma_f32 v34, -v39, v25, v34
    v_fmac_f32 v35, v39, v24
    v_cvt_pk_bf16_f32 v40, v26, -v27
    ds_write_b32 v4, v40 offset:27744
    v_cvt_pk_bf16_f32 v41, v34, v35
    ds_write_b32 v4, v41 offset:18496
    v_mul_f32 v36, v26, v44
    v_mul_f32 v37, v26, v45
    v_fma_f32 v36, -v27, v45, v36
    v_fmac_f32 v37, v27, v44
    v_mul_f32 v38, v34, v24
    v_mul_f32 v39, v34, v25
    v_fma_f32 v38, -v35, v25, v38
    v_fmac_f32 v39, v35, v24
    v_cvt_pk_bf16_f32 v40, v36, -v37
    ds_write_b32 v4, v40 offset:28288
    v_cvt_pk_bf16_f32 v41, v38, v39
    ds_write_b32 v4, v41 offset:19040
    v_mul_f32 v26, v36, v44
    v_mul_f32 v27, v36, v45
    v_fma_f32 v26, -v37, v45, v26
    v_fmac_f32 v27, v37, v44
    v_mul_f32 v34, v38, v24
    v_mul_f32 v35, v38, v25
    v_fma_f32 v34, -v39, v25, v34
    v_fmac_f32 v35, v39, v24
    v_cvt_pk_bf16_f32 v40, v26, -v27
    ds_write_b32 v4, v40 offset:28832
    v_cvt_pk_bf16_f32 v41, v34, v35
    ds_write_b32 v4, v41 offset:19584
    v_mul_f32 v36, v26, v44
    v_mul_f32 v37, v26, v45
    v_fma_f32 v36, -v27, v45, v36
    v_fmac_f32 v37, v27, v44
    v_mul_f32 v38, v34, v24
    v_mul_f32 v39, v34, v25
    v_fma_f32 v38, -v35, v25, v38
    v_fmac_f32 v39, v35, v24
    v_cvt_pk_bf16_f32 v40, v36, -v37
    ds_write_b32 v4, v40 offset:29376
    v_cvt_pk_bf16_f32 v41, v38, v39
    ds_write_b32 v4, v41 offset:20128
    v_mul_f32 v26, v36, v44
    v_mul_f32 v27, v36, v45
    v_fma_f32 v26, -v37, v45, v26
    v_fmac_f32 v27, v37, v44
    v_mul_f32 v34, v38, v24
    v_mul_f32 v35, v38, v25
    v_fma_f32 v34, -v39, v25, v34
    v_fmac_f32 v35, v39, v24
    v_cvt_pk_bf16_f32 v40, v26, -v27
    ds_write_b32 v4, v40 offset:29920
    v_cvt_pk_bf16_f32 v41, v34, v35
    ds_write_b32 v4, v41 offset:20672
    v_mul_f32 v36, v26, v44
    v_mul_f32 v37, v26, v45
    v_fma_f32 v36, -v27, v45, v36
    v_fmac_f32 v37, v27, v44
    v_mul_f32 v38, v34, v24
    v_mul_f32 v39, v34, v25
    v_fma_f32 v38, -v35, v25, v38
    v_fmac_f32 v39, v35, v24
    v_cvt_pk_bf16_f32 v40, v36, -v37
    ds_write_b32 v4, v40 offset:30464
    v_cvt_pk_bf16_f32 v41, v38, v39
    ds_write_b32 v4, v41 offset:21216
    v_mul_f32 v26, v36, v44
    v_mul_f32 v27, v36, v45
    v_fma_f32 v26, -v37, v45, v26
    v_fmac_f32 v27, v37, v44
    v_mul_f32 v34, v38, v24
    v_mul_f32 v35, v38, v25
    v_fma_f32 v34, -v39, v25, v34
    v_fmac_f32 v35, v39, v24
    v_cvt_pk_bf16_f32 v40, v26, -v27
    ds_write_b32 v4, v40 offset:31008
    v_cvt_pk_bf16_f32 v41, v34, v35
    ds_write_b32 v4, v41 offset:21760
    v_mul_f32 v36, v26, v44
    v_mul_f32 v37, v26, v45
    v_fma_f32 v36, -v27, v45, v36
    v_fmac_f32 v37, v27, v44
    v_cvt_pk_bf16_f32 v40, v36, -v37
    ds_write_b32 v4, v40 offset:31552
    v_mul_f32 v26, v36, v44
    v_mul_f32 v27, v36, v45
    v_fma_f32 v26, -v37, v45, v26
    v_fmac_f32 v27, v37, v44
    v_cvt_pk_bf16_f32 v40, v26, -v27
    ds_write_b32 v4, v40 offset:32096
    v_mul_f32 v36, v26, v44
    v_mul_f32 v37, v26, v45
    v_fma_f32 v36, -v27, v45, v36
    v_fmac_f32 v37, v27, v44
    v_cvt_pk_bf16_f32 v40, v36, -v37
    ds_write_b32 v4, v40 offset:32640
    v_mul_f32 v26, v36, v44
    v_mul_f32 v27, v36, v45
    v_fma_f32 v26, -v37, v45, v26
    v_fmac_f32 v27, v37, v44
    v_cvt_pk_bf16_f32 v40, v26, -v27
    ds_write_b32 v4, v40 offset:33184
    v_mul_f32 v36, v26, v44
    v_mul_f32 v37, v26, v45
    v_fma_f32 v36, -v27, v45, v36
    v_fmac_f32 v37, v27, v44
    v_cvt_pk_bf16_f32 v40, v36, -v37
    ds_write_b32 v4, v40 offset:33728
    v_mul_f32 v26, v36, v44
    v_mul_f32 v27, v36, v45
    v_fma_f32 v26, -v37, v45, v26
    v_fmac_f32 v27, v37, v44
    v_cvt_pk_bf16_f32 v40, v26, -v27
    ds_write_b32 v4, v40 offset:34272
    s_branch C_MFMA
C_ROLE1:
    s_mov_b32 s61, 0x3f800000
    v_mul_f32 v30, s61, v11
    v_exp_f32 v30, v30
    v_mul_f32 v31, s61, v12
    v_mul_f32 v32, s62, v31
    v_fma_f32 v26, v31, s62, -v32
    v_fmac_f32 v26, s63, v31
    v_fract_f32 v32, v32
    v_add_f32 v32, v32, v26
    v_cos_f32 v26, v32
    v_sin_f32 v27, v32
    v_mul_f32 v26, v26, v30
    v_mul_f32 v27, v27, v30
    s_mov_b32 s61, 0x40000000
    v_mul_f32 v30, s61, v11
    v_exp_f32 v30, v30
    v_mul_f32 v31, s61, v12
    v_mul_f32 v32, s62, v31
    v_fma_f32 v28, v31, s62, -v32
    v_fmac_f32 v28, s63, v31
    v_fract_f32 v32, v32
    v_add_f32 v32, v32, v28
    v_cos_f32 v28, v32
    v_sin_f32 v29, v32
    v_mul_f32 v28, v28, v30
    v_mul_f32 v29, v29, v30
    s_mov_b32 s61, 0x40800000
    v_mul_f32 v30, s61, v11
    v_exp_f32 v30, v30
    v_mul_f32 v31, s61, v12
    v_mul_f32 v32, s62, v31
    v_fma_f32 v44, v31, s62, -v32
    v_fmac_f32 v44, s63, v31
    v_fract_f32 v32, v32
    v_add_f32 v32, v32, v44
    v_cos_f32 v44, v32
    v_sin_f32 v45, v32
    v_mul_f32 v44, v44, v30
    v_mul_f32 v45, v45, v30
    v_mov_b32 v50, v22
    v_mov_b32 v51, v23
    v_mul_f32 v52, v50, v24
    v_mul_f32 v53, v50, v25
    v_fma_f32 v52, -v51, v25, v52
    v_fmac_f32 v53, v51, v24
    v_mul_f32 v54, v52, v24
    v_mul_f32 v55, v52, v25
    v_fma_f32 v54, -v53, v25, v54
    v_fmac_f32 v55, v53, v24
    v_mul_f32 v56, v54, v24
    v_mul_f32 v57, v54, v25
    v_fma_f32 v56, -v55, v25, v56
    v_fmac_f32 v57, v55, v24
    v_mul_f32 v58, v56, v24
    v_mul_f32 v59, v56, v25
    v_fma_f32 v58, -v57, v25, v58
    v_fmac_f32 v59, v57, v24
    v_mul_f32 v60, v58, v24
    v_mul_f32 v61, v58, v25
    v_fma_f32 v60, -v59, v25, v60
    v_fmac_f32 v61, v59, v24
    v_mul_f32 v62, v60, v24
    v_mul_f32 v63, v60, v25
    v_fma_f32 v62, -v61, v25, v62
    v_fmac_f32 v63, v61, v24
    v_mul_f32 v64, v62, v24
    v_mul_f32 v65, v62, v25
    v_fma_f32 v64, -v63, v25, v64
    v_fmac_f32 v65, v63, v24
    v_cvt_pk_bf16_f32 v40, v50, v51
    ds_write_b32 v4, v40 offset:0
    v_cvt_pk_bf16_f32 v41, v52, v53
    ds_write_b32 v4, v41 offset:4352
    v_cvt_pk_bf16_f32 v40, v54, v55
    ds_write_b32 v4, v40 offset:8704
    v_cvt_pk_bf16_f32 v41, v56, v57
    ds_write_b32 v4, v41 offset:10880
    v_cvt_pk_bf16_f32 v40, v58, v59
    ds_write_b32 v4, v40 offset:13056
    v_cvt_pk_bf16_f32 v41, v60, v61
    ds_write_b32 v4, v41 offset:14144
    v_cvt_pk_bf16_f32 v40, v62, v63
    ds_write_b32 v4, v40 offset:15232
    v_cvt_pk_bf16_f32 v41, v64, v65
    ds_write_b32 v4, v41 offset:16320
    v_mul_f32 v34, v58, v44
    v_mul_f32 v35, v58, v45
    v_fma_f32 v34, -v59, v45, v34
    v_fmac_f32 v35, v59, v44
    v_cvt_pk_bf16_f32 v40, v34, v35
    ds_write_b32 v4, v40 offset:13600
    v_mul_f32 v34, v60, v44
    v_mul_f32 v35, v60, v45
    v_fma_f32 v34, -v61, v45, v34
    v_fmac_f32 v35, v61, v44
    v_cvt_pk_bf16_f32 v41, v34, v35
    ds_write_b32 v4, v41 offset:14688
    v_mul_f32 v34, v62, v44
    v_mul_f32 v35, v62, v45
    v_fma_f32 v34, -v63, v45, v34
    v_fmac_f32 v35, v63, v44
    v_cvt_pk_bf16_f32 v40, v34, v35
    ds_write_b32 v4, v40 offset:15776
    v_mul_f32 v34, v64, v44
    v_mul_f32 v35, v64, v45
    v_fma_f32 v34, -v65, v45, v34
    v_fmac_f32 v35, v65, v44
    v_cvt_pk_bf16_f32 v41, v34, v35
    ds_write_b32 v4, v41 offset:16864
    v_mul_f32 v70, v50, v26
    v_mul_f32 v71, v50, v27
    v_fma_f32 v70, -v51, v27, v70
    v_fmac_f32 v71, v51, v26
    v_mul_f32 v72, v52, v26
    v_mul_f32 v73, v52, v27
    v_fma_f32 v72, -v53, v27, v72
    v_fmac_f32 v73, v53, v26
    v_mul_f32 v74, v54, v28
    v_mul_f32 v75, v54, v29
    v_fma_f32 v74, -v55, v29, v74
    v_fmac_f32 v75, v55, v28
    v_mul_f32 v76, v56, v28
    v_mul_f32 v77, v56, v29
    v_fma_f32 v76, -v57, v29, v76
    v_fmac_f32 v77, v57, v28
    v_cvt_pk_bf16_f32 v40, v70, v71
    ds_write_b32 v4, v40 offset:544
    v_cvt_pk_bf16_f32 v41, v72, v73
    ds_write_b32 v4, v41 offset:4896
    v_cvt_pk_bf16_f32 v40, v74, v75
    ds_write_b32 v4, v40 offset:9248
    v_cvt_pk_bf16_f32 v41, v76, v77
    ds_write_b32 v4, v41 offset:11424
    v_mul_f32 v50, v70, v26
    v_mul_f32 v51, v70, v27
    v_fma_f32 v50, -v71, v27, v50
    v_fmac_f32 v51, v71, v26
    v_mul_f32 v52, v72, v26
    v_mul_f32 v53, v72, v27
    v_fma_f32 v52, -v73, v27, v52
    v_fmac_f32 v53, v73, v26
    v_mul_f32 v54, v74, v28
    v_mul_f32 v55, v74, v29
    v_fma_f32 v54, -v75, v29, v54
    v_fmac_f32 v55, v75, v28
    v_mul_f32 v56, v76, v28
    v_mul_f32 v57, v76, v29
    v_fma_f32 v56, -v77, v29, v56
    v_fmac_f32 v57, v77, v28
    v_cvt_pk_bf16_f32 v40, v50, v51
    ds_write_b32 v4, v40 offset:1088
    v_cvt_pk_bf16_f32 v41, v52, v53
    ds_write_b32 v4, v41 offset:5440
    v_cvt_pk_bf16_f32 v40, v54, v55
    ds_write_b32 v4, v40 offset:9792
    v_cvt_pk_bf16_f32 v41, v56, v57
    ds_write_b32 v4, v41 offset:11968
    v_mul_f32 v70, v50, v26
    v_mul_f32 v71, v50, v27
    v_fma_f32 v70, -v51, v27, v70
    v_fmac_f32 v71, v51, v26
    v_mul_f32 v72, v52, v26
    v_mul_f32 v73, v52, v27
    v_fma_f32 v72, -v53, v27, v72
    v_fmac_f32 v73, v53, v26
    v_mul_f32 v74, v54, v28
    v_mul_f32 v75, v54, v29
    v_fma_f32 v74, -v55, v29, v74
    v_fmac_f32 v75, v55, v28
    v_mul_f32 v76, v56, v28
    v_mul_f32 v77, v56, v29
    v_fma_f32 v76, -v57, v29, v76
    v_fmac_f32 v77, v57, v28
    v_cvt_pk_bf16_f32 v40, v70, v71
    ds_write_b32 v4, v40 offset:1632
    v_cvt_pk_bf16_f32 v41, v72, v73
    ds_write_b32 v4, v41 offset:5984
    v_cvt_pk_bf16_f32 v40, v74, v75
    ds_write_b32 v4, v40 offset:10336
    v_cvt_pk_bf16_f32 v41, v76, v77
    ds_write_b32 v4, v41 offset:12512
    v_mul_f32 v50, v70, v26
    v_mul_f32 v51, v70, v27
    v_fma_f32 v50, -v71, v27, v50
    v_fmac_f32 v51, v71, v26
    v_mul_f32 v52, v72, v26
    v_mul_f32 v53, v72, v27
    v_fma_f32 v52, -v73, v27, v52
    v_fmac_f32 v53, v73, v26
    v_cvt_pk_bf16_f32 v40, v50, v51
    ds_write_b32 v4, v40 offset:2176
    v_cvt_pk_bf16_f32 v41, v52, v53
    ds_write_b32 v4, v41 offset:6528
    v_mul_f32 v70, v50, v26
    v_mul_f32 v71, v50, v27
    v_fma_f32 v70, -v51, v27, v70
    v_fmac_f32 v71, v51, v26
    v_mul_f32 v72, v52, v26
    v_mul_f32 v73, v52, v27
    v_fma_f32 v72, -v53, v27, v72
    v_fmac_f32 v73, v53, v26
    v_cvt_pk_bf16_f32 v40, v70, v71
    ds_write_b32 v4, v40 offset:2720
    v_cvt_pk_bf16_f32 v41, v72, v73
    ds_write_b32 v4, v41 offset:7072
    v_mul_f32 v50, v70, v26
    v_mul_f32 v51, v70, v27
    v_fma_f32 v50, -v71, v27, v50
    v_fmac_f32 v51, v71, v26
    v_mul_f32 v52, v72, v26
    v_mul_f32 v53, v72, v27
    v_fma_f32 v52, -v73, v27, v52
    v_fmac_f32 v53, v73, v26
    v_cvt_pk_bf16_f32 v40, v50, v51
    ds_write_b32 v4, v40 offset:3264
    v_cvt_pk_bf16_f32 v41, v52, v53
    ds_write_b32 v4, v41 offset:7616
    v_mul_f32 v70, v50, v26
    v_mul_f32 v71, v50, v27
    v_fma_f32 v70, -v51, v27, v70
    v_fmac_f32 v71, v51, v26
    v_mul_f32 v72, v52, v26
    v_mul_f32 v73, v52, v27
    v_fma_f32 v72, -v53, v27, v72
    v_fmac_f32 v73, v53, v26
    v_cvt_pk_bf16_f32 v40, v70, v71
    ds_write_b32 v4, v40 offset:3808
    v_cvt_pk_bf16_f32 v41, v72, v73
    ds_write_b32 v4, v41 offset:8160
C_MFMA:
    v_and_b32 v5, 15, v0
    v_bfe_u32 v6, v0, 4, 2
    s_movk_i32 s68, 544
    v_mul_lo_u32 v7, v5, s68
    v_lshl_add_u32 v7, v6, 4, v7
    v_add_u32 v7, s67, v7
    s_and_b32 s69, s38, 3
    s_mul_i32 s68, s69, 8704
    v_add_u32 v8, s68, v7
    s_mul_i32 s67, s65, 3072
    s_add_u32 s67, s67, 104448
    s_waitcnt lgkmcnt(0)
    s_barrier
    s_cmp_ge_u32 s69, 3
    s_cbranch_scc1 C_EXPAND
    ds_read_b128 v[16:19], v8 offset:0
    ds_read_b128 v[20:23], v7 offset:26112
    ds_read_b128 v[24:27], v8 offset:64
    ds_read_b128 v[28:31], v7 offset:26176
    ds_read_b128 v[32:35], v8 offset:128
    ds_read_b128 v[36:39], v7 offset:26240
    ds_read_b128 v[40:43], v8 offset:192
    ds_read_b128 v[44:47], v7 offset:26304
    ds_read_b128 v[48:51], v8 offset:256
    ds_read_b128 v[52:55], v7 offset:26368
    ds_read_b128 v[56:59], v8 offset:320
    ds_read_b128 v[60:63], v7 offset:26432
    ds_read_b128 v[64:67], v8 offset:384
    ds_read_b128 v[68:71], v7 offset:26496
    ds_read_b128 v[72:75], v8 offset:448
    ds_read_b128 v[76:79], v7 offset:26560
    v_mov_b32 v12, 0
    v_mov_b32 v13, 0
    v_mov_b32 v14, 0
    v_mov_b32 v15, 0
    s_waitcnt lgkmcnt(14)
    s_nop 0
    v_mfma_f32_16x16x32_bf16 v[12:15], v[16:19], v[20:23], v[12:15]
    s_waitcnt lgkmcnt(12)
    v_mfma_f32_16x16x32_bf16 v[12:15], v[24:27], v[28:31], v[12:15]
    s_waitcnt lgkmcnt(10)
    v_mfma_f32_16x16x32_bf16 v[12:15], v[32:35], v[36:39], v[12:15]
    s_waitcnt lgkmcnt(8)
    v_mfma_f32_16x16x32_bf16 v[12:15], v[40:43], v[44:47], v[12:15]
    s_waitcnt lgkmcnt(6)
    v_mfma_f32_16x16x32_bf16 v[12:15], v[48:51], v[52:55], v[12:15]
    s_waitcnt lgkmcnt(4)
    v_mfma_f32_16x16x32_bf16 v[12:15], v[56:59], v[60:63], v[12:15]
    s_waitcnt lgkmcnt(2)
    v_mfma_f32_16x16x32_bf16 v[12:15], v[64:67], v[68:71], v[12:15]
    s_waitcnt lgkmcnt(0)
    v_mfma_f32_16x16x32_bf16 v[12:15], v[72:75], v[76:79], v[12:15]
    s_cmp_eq_u32 s69, 1
    s_cbranch_scc1 C_T1
    s_cmp_eq_u32 s69, 2
    s_cbranch_scc1 C_T2
    v_and_b32 v9, 1, v6
    v_lshlrev_b32 v9, 4, v9
    v_lshrrev_b32 v10, 1, v6
    v_lshl_add_u32 v9, v10, 9, v9
    v_lshl_add_u32 v9, v5, 5, v9
    v_add_u32 v9, s67, v9
    s_nop 3
    ds_write_b128 v9, v[12:15]
    s_branch C_EXPAND
C_T1:
    v_lshlrev_b32 v9, 8, v6
    v_add_u32 v9, s67, v9
    v_lshl_add_u32 v10, v5, 4, v9
    v_lshl_add_u32 v11, v5, 3, v9
    v_cmp_gt_u32 vcc, 2, v6
    s_nop 1
    v_cndmask_b32 v9, v11, v10, vcc
    v_mov_b32 v10, 0x80
    v_cndmask_b32 v10, v10, 8, vcc
    v_add_u32 v10, v10, v9
    ds_write_b64 v9, v[12:13] offset:1024
    ds_write_b64 v10, v[14:15] offset:1024
    s_branch C_EXPAND
C_T2:
    v_lshlrev_b32 v9, 8, v6
    v_lshl_add_u32 v9, v5, 2, v9
    v_add_u32 v9, s67, v9
    s_nop 5
    ds_write_b32 v9, v12 offset:2048
    ds_write_b32 v9, v13 offset:2112
    ds_write_b32 v9, v14 offset:2176
    ds_write_b32 v9, v15 offset:2240
C_EXPAND:
    v_and_b32 v9, 0xff, v0
    s_mul_i32 s68, s65, 16640
    v_lshl_add_u32 v9, v9, 4, s68
    v_subrev_u32 v17, 0x100, v0
    v_lshlrev_b32 v17, 5, v17
    s_movk_i32 s64, 4096
    s_waitcnt lgkmcnt(0)
    s_barrier
    ds_read_b32 v20, v150
    ds_read_b32 v21, v151
    ds_read_b32 v22, v152
    ds_read_b32 v23, v153
    ds_read_b32 v24, v154
    ds_read_b32 v25, v155
    ds_read_b32 v26, v156
    ds_read_b32 v27, v157
    ds_read_b32 v28, v158
    ds_read_b32 v29, v159
    ds_read_b32 v30, v160
    s_waitcnt lgkmcnt(0)
    v_cvt_pk_bf16_f32 v32, v20, v21
    v_cvt_pk_bf16_f32 v33, v22, v23
    v_cvt_pk_bf16_f32 v34, v24, v25
    v_cvt_pk_bf16_f32 v35, v26, v27
    ds_write_b128 v9, v[32:35] offset:32
    v_cvt_pk_bf16_f32 v40, v21, v22
    v_cvt_pk_bf16_f32 v41, v23, v24
    v_cvt_pk_bf16_f32 v42, v25, v26
    v_cvt_pk_bf16_f32 v43, v27, v28
    ds_write_b128 v9, v[40:43] offset:4192
    v_cvt_pk_bf16_f32 v36, v22, v23
    v_cvt_pk_bf16_f32 v37, v24, v25
    v_cvt_pk_bf16_f32 v38, v26, v27
    v_cvt_pk_bf16_f32 v39, v28, v29
    ds_write_b128 v9, v[36:39] offset:8352
    v_cvt_pk_bf16_f32 v44, v23, v24
    v_cvt_pk_bf16_f32 v45, v25, v26
    v_cvt_pk_bf16_f32 v46, v27, v28
    v_cvt_pk_bf16_f32 v47, v29, v30
    ds_write_b128 v9, v[44:47] offset:12512
    s_and_b32 s69, s38, 3
    s_cmp_lg_u32 s69, 0
    s_cbranch_scc1 C_NOFRONT
    v_mov_b32 v150, 140304
    v_mov_b32 v151, 140304
    v_mov_b32 v152, 140304
    v_mov_b32 v153, 140304
    v_mov_b32 v154, 140304
    v_mov_b32 v155, 140304
    v_mov_b32 v156, 140304
    v_mov_b32 v157, 140304
    v_mov_b32 v158, 140304
    v_mov_b32 v159, 140304
    v_mov_b32 v160, 140304
    s_mov_b64 exec, 2
    v_mov_b32 v158, s67
    v_mov_b32 v159, s67
    v_add_u32 v159, 4, v159
    v_mov_b32 v160, s67
    v_add_u32 v160, 8, v160
    s_mov_b64 exec, 3
    ds_read_b32 v20, v150
    ds_read_b32 v21, v151
    ds_read_b32 v22, v152
    ds_read_b32 v23, v153
    ds_read_b32 v24, v154
    ds_read_b32 v25, v155
    ds_read_b32 v26, v156
    ds_read_b32 v27, v157
    ds_read_b32 v28, v158
    ds_read_b32 v29, v159
    ds_read_b32 v30, v160
    s_waitcnt lgkmcnt(0)
    v_cvt_pk_bf16_f32 v32, v20, v21
    v_cvt_pk_bf16_f32 v33, v22, v23
    v_cvt_pk_bf16_f32 v34, v24, v25
    v_cvt_pk_bf16_f32 v35, v26, v27
    ds_write_b128 v9, v[32:35] offset:0
    v_cvt_pk_bf16_f32 v40, v21, v22
    v_cvt_pk_bf16_f32 v41, v23, v24
    v_cvt_pk_bf16_f32 v42, v25, v26
    v_cvt_pk_bf16_f32 v43, v27, v28
    ds_write_b128 v9, v[40:43] offset:4160
    v_cvt_pk_bf16_f32 v36, v22, v23
    v_cvt_pk_bf16_f32 v37, v24, v25
    v_cvt_pk_bf16_f32 v38, v26, v27
    v_cvt_pk_bf16_f32 v39, v28, v29
    ds_write_b128 v9, v[36:39] offset:8320
    v_cvt_pk_bf16_f32 v44, v23, v24
    v_cvt_pk_bf16_f32 v45, v25, v26
    v_cvt_pk_bf16_f32 v46, v27, v28
    v_cvt_pk_bf16_f32 v47, v29, v30
    ds_write_b128 v9, v[44:47] offset:12480
    s_mov_b64 exec, -1
C_NOFRONT:
    s_cmp_lt_u32 s38, 4
    s_cbranch_scc1 C_NOU
    s_movk_i32 s60, 4000
C_STP:
    buffer_load_dwordx4 v[20:23], v17, s[40:43], s64 offen sc1
    buffer_load_dwordx4 v[24:27], v17, s[40:43], s64 offen offset:16 sc1
    s_waitcnt vmcnt(0)
    v_xor_b32 v28, s39, v21
    v_xor_b32 v29, s39, v23
    v_xor_b32 v30, s39, v25
    v_xor_b32 v31, s39, v27
    v_or3_b32 v28, v28, v29, v30
    v_or_b32 v28, v28, v31
    v_cmp_ne_u32 vcc, 0, v28
    s_nop 0
    s_and_b64 exec, exec, vcc
    s_cbranch_execz C_STP_D
    s_sub_u32 s60, s60, 1
    s_cmp_lg_u32 s60, 0
    s_sleep 1
    s_cbranch_scc1 C_STP
C_STP_D:
    s_mov_b64 exec, -1
    s_bitcmp1_b32 s52, 0
    s_cselect_b32 s68, 16, 0
    v_alignbit_b32 v32, v141, v140, s68
    v_lshrrev_b32 v36, s68, v141
    v_and_b32 v21, 0xffff0000, v20
    v_lshlrev_b32 v20, 16, v20
    v_rcp_f32 v21, v21
    v_alignbit_b32 v33, v143, v142, s68
    v_lshrrev_b32 v37, s68, v143
    v_and_b32 v23, 0xffff0000, v22
    v_lshlrev_b32 v22, 16, v22
    v_rcp_f32 v23, v23
    v_alignbit_b32 v34, v145, v144, s68
    v_lshrrev_b32 v38, s68, v145
    v_and_b32 v25, 0xffff0000, v24
    v_lshlrev_b32 v24, 16, v24
    v_rcp_f32 v25, v25
    v_alignbit_b32 v35, v147, v146, s68
    v_lshrrev_b32 v39, s68, v147
    v_and_b32 v27, 0xffff0000, v26
    v_lshlrev_b32 v26, 16, v26
    v_rcp_f32 v27, v27
    v_lshlrev_b32 v40, 16, v32
    v_and_b32 v44, 0xffff0000, v32
    v_lshlrev_b32 v48, 16, v36
    v_sub_f32 v40, v40, v20
    v_sub_f32 v44, v44, v20
    v_sub_f32 v48, v48, v20
    v_lshlrev_b32 v41, 16, v33
    v_and_b32 v45, 0xffff0000, v33
    v_lshlrev_b32 v49, 16, v37
    v_sub_f32 v41, v41, v22
    v_sub_f32 v45, v45, v22
    v_sub_f32 v49, v49, v22
    v_lshlrev_b32 v42, 16, v34
    v_and_b32 v46, 0xffff0000, v34
    v_lshlrev_b32 v50, 16, v38
    v_sub_f32 v42, v42, v24
    v_sub_f32 v46, v46, v24
    v_sub_f32 v50, v50, v24
    v_lshlrev_b32 v43, 16, v35
    v_and_b32 v47, 0xffff0000, v35
    v_lshlrev_b32 v51, 16, v39
    v_sub_f32 v43, v43, v26
    v_sub_f32 v47, v47, v26
    v_sub_f32 v51, v51, v26
    v_cvt_pk_bf16_f32 v41, v40, v41
    v_lshlrev_b32 v40, 16, v41
    v_and_b32 v41, 0xffff0000, v41
    v_mul_f32 v40, v40, v21
    v_mul_f32 v41, v41, v23
    v_cvt_pk_bf16_f32 v43, v42, v43
    v_lshlrev_b32 v42, 16, v43
    v_and_b32 v43, 0xffff0000, v43
    v_mul_f32 v42, v42, v25
    v_mul_f32 v43, v43, v27
    v_cvt_pk_bf16_f32 v45, v44, v45
    v_lshlrev_b32 v44, 16, v45
    v_and_b32 v45, 0xffff0000, v45
    v_mul_f32 v44, v44, v21
    v_mul_f32 v45, v45, v23
    v_cvt_pk_bf16_f32 v47, v46, v47
    v_lshlrev_b32 v46, 16, v47
    v_and_b32 v47, 0xffff0000, v47
    v_mul_f32 v46, v46, v25
    v_mul_f32 v47, v47, v27
    v_cvt_pk_bf16_f32 v49, v48, v49
    v_lshlrev_b32 v48, 16, v49
    v_and_b32 v49, 0xffff0000, v49
    v_mul_f32 v48, v48, v21
    v_mul_f32 v49, v49, v23
    v_cvt_pk_bf16_f32 v51, v50, v51
    v_lshlrev_b32 v50, 16, v51
    v_and_b32 v51, 0xffff0000, v51
    v_mul_f32 v50, v50, v25
    v_mul_f32 v51, v51, v27
    v_lshrrev_b32 v17, 2, v17
    v_sub_u32 v17, 117752, v17
    v_cvt_pk_bf16_f32 v32, v43, v42
    v_cvt_pk_bf16_f32 v33, v41, v40
    ds_write_b64 v17, v[32:33] offset:0
    v_cvt_pk_bf16_f32 v34, v47, v46
    v_cvt_pk_bf16_f32 v35, v45, v44
    ds_write_b64 v17, v[34:35] offset:4608
    v_cvt_pk_bf16_f32 v36, v51, v50
    v_cvt_pk_bf16_f32 v37, v49, v48
    ds_write_b64 v17, v[36:37] offset:9216
C_NOU:
    v_add_u32 v7, 1, v5
    v_and_b32 v8, 3, v7
    v_sub_u32 v7, v7, v8
    v_lshl_add_u32 v7, v6, 3, v7
    v_lshlrev_b32 v7, 1, v7
    s_movk_i32 s68, 4160
    v_mul_lo_u32 v8, v8, s68
    v_add_u32 v7, v7, v8
    s_and_b32 s69, s38, 1
    s_lshl_b32 s69, s69, 8
    s_mul_i32 s68, s65, 16640
    s_add_u32 s68, s68, s69
    v_add_u32 v7, s68, v7
    v_lshlrev_b32 v8, 5, v5
    v_sub_u32 v8, 480, v8
    v_lshl_add_u32 v8, v6, 4, v8
    s_mul_i32 s64, s65, 4608
    s_add_u32 s64, s64, 113664
    s_add_u32 s68, s64, s69
    v_add_u32 v8, s68, v8
    v_mov_b32 v144, 0
    v_mov_b32 v145, 0
    v_mov_b32 v146, 0
    v_mov_b32 v147, 0
    v_mov_b32 v148, 0
    v_mov_b32 v149, 0
    v_mov_b32 v150, 0
    v_mov_b32 v151, 0
    v_mov_b32 v152, 0
    v_mov_b32 v153, 0
    v_mov_b32 v154, 0
    v_mov_b32 v155, 0
    v_mov_b32 v156, 0
    v_mov_b32 v157, 0
    v_mov_b32 v158, 0
    v_mov_b32 v159, 0
    s_waitcnt lgkmcnt(0)
    s_barrier
    s_bitcmp1_b32 s38, 1
    s_cbranch_scc1 C_JS1
    ds_read_b64 v[16:17], v7 offset:0
    ds_read_b64 v[18:19], v7 offset:8
    ds_read_b128 v[48:51], v8 offset:3584
    ds_read_b64 v[20:21], v7 offset:512
    ds_read_b64 v[22:23], v7 offset:520
    ds_read_b128 v[52:55], v8 offset:3072
    ds_read_b64 v[24:25], v7 offset:1024
    ds_read_b64 v[26:27], v7 offset:1032
    ds_read_b128 v[56:59], v8 offset:2560
    ds_read_b64 v[28:29], v7 offset:1536
    ds_read_b64 v[30:31], v7 offset:1544
    ds_read_b128 v[60:63], v8 offset:2048
    ds_read_b64 v[32:33], v7 offset:2048
    ds_read_b64 v[34:35], v7 offset:2056
    ds_read_b128 v[64:67], v8 offset:1536
    ds_read_b64 v[36:37], v7 offset:2560
    ds_read_b64 v[38:39], v7 offset:2568
    ds_read_b128 v[68:71], v8 offset:1024
    ds_read_b64 v[40:41], v7 offset:3072
    ds_read_b64 v[42:43], v7 offset:3080
    ds_read_b128 v[72:75], v8 offset:512
    ds_read_b64 v[44:45], v7 offset:3584
    ds_read_b64 v[46:47], v7 offset:3592
    ds_read_b128 v[76:79], v8 offset:0
    s_waitcnt lgkmcnt(15)
    v_mfma_f32_16x16x32_bf16 v[156:159], v[16:19], v[48:51], v[156:159]
    s_waitcnt lgkmcnt(15)
    v_mfma_f32_16x16x32_bf16 v[152:155], v[16:19], v[52:55], v[152:155]
    v_mfma_f32_16x16x32_bf16 v[152:155], v[20:23], v[48:51], v[152:155]
    s_waitcnt lgkmcnt(12)
    v_mfma_f32_16x16x32_bf16 v[148:151], v[28:31], v[60:63], v[148:151]
    s_waitcnt lgkmcnt(9)
    v_mfma_f32_16x16x32_bf16 v[148:151], v[24:27], v[64:67], v[148:151]
    v_mfma_f32_16x16x32_bf16 v[144:147], v[28:31], v[64:67], v[144:147]
    v_mfma_f32_16x16x32_bf16 v[148:151], v[32:35], v[56:59], v[148:151]
    v_mfma_f32_16x16x32_bf16 v[144:147], v[32:35], v[60:63], v[144:147]
    s_waitcnt lgkmcnt(6)
    v_mfma_f32_16x16x32_bf16 v[148:151], v[20:23], v[68:71], v[148:151]
    v_mfma_f32_16x16x32_bf16 v[144:147], v[24:27], v[68:71], v[144:147]
    v_mfma_f32_16x16x32_bf16 v[148:151], v[36:39], v[52:55], v[148:151]
    v_mfma_f32_16x16x32_bf16 v[144:147], v[36:39], v[56:59], v[144:147]
    s_waitcnt lgkmcnt(3)
    v_mfma_f32_16x16x32_bf16 v[148:151], v[16:19], v[72:75], v[148:151]
    v_mfma_f32_16x16x32_bf16 v[144:147], v[20:23], v[72:75], v[144:147]
    v_mfma_f32_16x16x32_bf16 v[148:151], v[40:43], v[48:51], v[148:151]
    v_mfma_f32_16x16x32_bf16 v[144:147], v[40:43], v[52:55], v[144:147]
    s_waitcnt lgkmcnt(0)
    v_mfma_f32_16x16x32_bf16 v[144:147], v[16:19], v[76:79], v[144:147]
    ds_read_b64 v[80:81], v7 offset:64
    ds_read_b64 v[82:83], v7 offset:72
    ds_read_b128 v[112:115], v8 offset:3648
    v_mfma_f32_16x16x32_bf16 v[144:147], v[44:47], v[48:51], v[144:147]
    ds_read_b64 v[84:85], v7 offset:576
    ds_read_b64 v[86:87], v7 offset:584
    ds_read_b128 v[116:119], v8 offset:3136
    ds_read_b64 v[88:89], v7 offset:1088
    ds_read_b64 v[90:91], v7 offset:1096
    ds_read_b128 v[120:123], v8 offset:2624
    ds_read_b64 v[92:93], v7 offset:1600
    ds_read_b64 v[94:95], v7 offset:1608
    ds_read_b128 v[124:127], v8 offset:2112
    ds_read_b64 v[96:97], v7 offset:2112
    ds_read_b64 v[98:99], v7 offset:2120
    ds_read_b128 v[128:131], v8 offset:1600
    ds_read_b64 v[100:101], v7 offset:2624
    ds_read_b64 v[102:103], v7 offset:2632
    ds_read_b128 v[132:135], v8 offset:1088
    ds_read_b64 v[104:105], v7 offset:3136
    ds_read_b64 v[106:107], v7 offset:3144
    ds_read_b128 v[136:139], v8 offset:576
    ds_read_b64 v[108:109], v7 offset:3648
    ds_read_b64 v[110:111], v7 offset:3656
    ds_read_b128 v[140:143], v8 offset:64
    s_waitcnt lgkmcnt(0)
    v_mfma_f32_16x16x32_bf16 v[156:159], v[80:83], v[112:115], v[156:159]
    ds_read_b64 v[16:17], v7 offset:128
    ds_read_b64 v[18:19], v7 offset:136
    v_mfma_f32_16x16x32_bf16 v[152:155], v[80:83], v[116:119], v[152:155]
    ds_read_b128 v[48:51], v8 offset:3712
    ds_read_b64 v[20:21], v7 offset:640
    v_mfma_f32_16x16x32_bf16 v[152:155], v[84:87], v[112:115], v[152:155]
    ds_read_b64 v[22:23], v7 offset:648
    ds_read_b128 v[52:55], v8 offset:3200
    v_mfma_f32_16x16x32_bf16 v[148:151], v[92:95], v[124:127], v[148:151]
    ds_read_b64 v[24:25], v7 offset:1152
    ds_read_b64 v[26:27], v7 offset:1160
    v_mfma_f32_16x16x32_bf16 v[148:151], v[88:91], v[128:131], v[148:151]
    ds_read_b128 v[56:59], v8 offset:2688
    ds_read_b64 v[28:29], v7 offset:1664
    v_mfma_f32_16x16x32_bf16 v[144:147], v[92:95], v[128:131], v[144:147]
    ds_read_b64 v[30:31], v7 offset:1672
    ds_read_b128 v[60:63], v8 offset:2176
    v_mfma_f32_16x16x32_bf16 v[148:151], v[96:99], v[120:123], v[148:151]
    ds_read_b64 v[32:33], v7 offset:2176
    ds_read_b64 v[34:35], v7 offset:2184
    v_mfma_f32_16x16x32_bf16 v[144:147], v[96:99], v[124:127], v[144:147]
    ds_read_b128 v[64:67], v8 offset:1664
    ds_read_b64 v[36:37], v7 offset:2688
    v_mfma_f32_16x16x32_bf16 v[148:151], v[84:87], v[132:135], v[148:151]
    ds_read_b64 v[38:39], v7 offset:2696
    ds_read_b128 v[68:71], v8 offset:1152
    v_mfma_f32_16x16x32_bf16 v[144:147], v[88:91], v[132:135], v[144:147]
    ds_read_b64 v[40:41], v7 offset:3200
    ds_read_b64 v[42:43], v7 offset:3208
    v_mfma_f32_16x16x32_bf16 v[148:151], v[100:103], v[116:119], v[148:151]
    ds_read_b128 v[72:75], v8 offset:640
    ds_read_b64 v[44:45], v7 offset:3712
    v_mfma_f32_16x16x32_bf16 v[144:147], v[100:103], v[120:123], v[144:147]
    ds_read_b64 v[46:47], v7 offset:3720
    ds_read_b128 v[76:79], v8 offset:128
    v_mfma_f32_16x16x32_bf16 v[148:151], v[80:83], v[136:139], v[148:151]
    v_mfma_f32_16x16x32_bf16 v[144:147], v[84:87], v[136:139], v[144:147]
    v_mfma_f32_16x16x32_bf16 v[148:151], v[104:107], v[112:115], v[148:151]
    v_mfma_f32_16x16x32_bf16 v[144:147], v[104:107], v[116:119], v[144:147]
    v_mfma_f32_16x16x32_bf16 v[144:147], v[80:83], v[140:143], v[144:147]
    v_mfma_f32_16x16x32_bf16 v[144:147], v[108:111], v[112:115], v[144:147]
    s_waitcnt lgkmcnt(0)
    v_mfma_f32_16x16x32_bf16 v[156:159], v[16:19], v[48:51], v[156:159]
    ds_read_b64 v[80:81], v7 offset:192
    ds_read_b64 v[82:83], v7 offset:200
    v_mfma_f32_16x16x32_bf16 v[152:155], v[16:19], v[52:55], v[152:155]
    ds_read_b128 v[112:115], v8 offset:3776
    ds_read_b64 v[84:85], v7 offset:704
    v_mfma_f32_16x16x32_bf16 v[152:155], v[20:23], v[48:51], v[152:155]
    ds_read_b64 v[86:87], v7 offset:712
    ds_read_b128 v[116:119], v8 offset:3264
    v_mfma_f32_16x16x32_bf16 v[148:151], v[28:31], v[60:63], v[148:151]
    ds_read_b64 v[88:89], v7 offset:1216
    ds_read_b64 v[90:91], v7 offset:1224
    v_mfma_f32_16x16x32_bf16 v[148:151], v[24:27], v[64:67], v[148:151]
    ds_read_b128 v[120:123], v8 offset:2752
    ds_read_b64 v[92:93], v7 offset:1728
    v_mfma_f32_16x16x32_bf16 v[144:147], v[28:31], v[64:67], v[144:147]
    ds_read_b64 v[94:95], v7 offset:1736
    ds_read_b128 v[124:127], v8 offset:2240
    v_mfma_f32_16x16x32_bf16 v[148:151], v[32:35], v[56:59], v[148:151]
    ds_read_b64 v[96:97], v7 offset:2240
    ds_read_b64 v[98:99], v7 offset:2248
    v_mfma_f32_16x16x32_bf16 v[144:147], v[32:35], v[60:63], v[144:147]
    ds_read_b128 v[128:131], v8 offset:1728
    ds_read_b64 v[100:101], v7 offset:2752
    v_mfma_f32_16x16x32_bf16 v[148:151], v[20:23], v[68:71], v[148:151]
    ds_read_b64 v[102:103], v7 offset:2760
    ds_read_b128 v[132:135], v8 offset:1216
    v_mfma_f32_16x16x32_bf16 v[144:147], v[24:27], v[68:71], v[144:147]
    ds_read_b64 v[104:105], v7 offset:3264
    ds_read_b64 v[106:107], v7 offset:3272
    v_mfma_f32_16x16x32_bf16 v[148:151], v[36:39], v[52:55], v[148:151]
    ds_read_b128 v[136:139], v8 offset:704
    ds_read_b64 v[108:109], v7 offset:3776
    v_mfma_f32_16x16x32_bf16 v[144:147], v[36:39], v[56:59], v[144:147]
    ds_read_b64 v[110:111], v7 offset:3784
    ds_read_b128 v[140:143], v8 offset:192
    v_mfma_f32_16x16x32_bf16 v[148:151], v[16:19], v[72:75], v[148:151]
    v_mfma_f32_16x16x32_bf16 v[144:147], v[20:23], v[72:75], v[144:147]
    v_mfma_f32_16x16x32_bf16 v[148:151], v[40:43], v[48:51], v[148:151]
    v_mfma_f32_16x16x32_bf16 v[144:147], v[40:43], v[52:55], v[144:147]
    v_mfma_f32_16x16x32_bf16 v[144:147], v[16:19], v[76:79], v[144:147]
    v_mfma_f32_16x16x32_bf16 v[144:147], v[44:47], v[48:51], v[144:147]
    s_waitcnt lgkmcnt(0)
    v_mfma_f32_16x16x32_bf16 v[156:159], v[80:83], v[112:115], v[156:159]
    v_mfma_f32_16x16x32_bf16 v[152:155], v[80:83], v[116:119], v[152:155]
    v_mfma_f32_16x16x32_bf16 v[152:155], v[84:87], v[112:115], v[152:155]
    v_mfma_f32_16x16x32_bf16 v[148:151], v[92:95], v[124:127], v[148:151]
    v_mfma_f32_16x16x32_bf16 v[148:151], v[88:91], v[128:131], v[148:151]
    v_mfma_f32_16x16x32_bf16 v[144:147], v[92:95], v[128:131], v[144:147]
    v_mfma_f32_16x16x32_bf16 v[148:151], v[96:99], v[120:123], v[148:151]
    v_mfma_f32_16x16x32_bf16 v[144:147], v[96:99], v[124:127], v[144:147]
    v_mfma_f32_16x16x32_bf16 v[148:151], v[84:87], v[132:135], v[148:151]
    v_mfma_f32_16x16x32_bf16 v[144:147], v[88:91], v[132:135], v[144:147]
    v_mfma_f32_16x16x32_bf16 v[148:151], v[100:103], v[116:119], v[148:151]
    v_mfma_f32_16x16x32_bf16 v[144:147], v[100:103], v[120:123], v[144:147]
    v_mfma_f32_16x16x32_bf16 v[148:151], v[80:83], v[136:139], v[148:151]
    v_mfma_f32_16x16x32_bf16 v[144:147], v[84:87], v[136:139], v[144:147]
    v_mfma_f32_16x16x32_bf16 v[148:151], v[104:107], v[112:115], v[148:151]
    v_mfma_f32_16x16x32_bf16 v[144:147], v[104:107], v[116:119], v[144:147]
    v_mfma_f32_16x16x32_bf16 v[144:147], v[80:83], v[140:143], v[144:147]
    v_mfma_f32_16x16x32_bf16 v[144:147], v[108:111], v[112:115], v[144:147]
    s_bitcmp1_b32 s38, 0
    s_cselect_b32 s66, 1, 7
    s_cselect_b32 s67, 0, 6
    s_branch C_RED
C_JS1:
    ds_read_b64 v[16:17], v7 offset:0
    ds_read_b64 v[18:19], v7 offset:8
    ds_read_b128 v[48:51], v8 offset:3584
    ds_read_b64 v[20:21], v7 offset:512
    ds_read_b64 v[22:23], v7 offset:520
    ds_read_b128 v[52:55], v8 offset:3072
    ds_read_b64 v[24:25], v7 offset:1024
    ds_read_b64 v[26:27], v7 offset:1032
    ds_read_b128 v[56:59], v8 offset:2560
    ds_read_b64 v[28:29], v7 offset:1536
    ds_read_b64 v[30:31], v7 offset:1544
    ds_read_b128 v[60:63], v8 offset:2048
    ds_read_b64 v[32:33], v7 offset:2048
    ds_read_b64 v[34:35], v7 offset:2056
    ds_read_b128 v[64:67], v8 offset:1536
    ds_read_b64 v[36:37], v7 offset:2560
    ds_read_b64 v[38:39], v7 offset:2568
    ds_read_b128 v[68:71], v8 offset:1024
    s_waitcnt lgkmcnt(12)
    v_mfma_f32_16x16x32_bf16 v[156:159], v[20:23], v[52:55], v[156:159]
    s_waitcnt lgkmcnt(9)
    v_mfma_f32_16x16x32_bf16 v[156:159], v[16:19], v[56:59], v[156:159]
    v_mfma_f32_16x16x32_bf16 v[152:155], v[20:23], v[56:59], v[152:155]
    v_mfma_f32_16x16x32_bf16 v[156:159], v[24:27], v[48:51], v[156:159]
    v_mfma_f32_16x16x32_bf16 v[152:155], v[24:27], v[52:55], v[152:155]
    v_mfma_f32_16x16x32_bf16 v[148:151], v[24:27], v[56:59], v[148:151]
    s_waitcnt lgkmcnt(6)
    v_mfma_f32_16x16x32_bf16 v[152:155], v[16:19], v[60:63], v[152:155]
    v_mfma_f32_16x16x32_bf16 v[148:151], v[20:23], v[60:63], v[148:151]
    v_mfma_f32_16x16x32_bf16 v[144:147], v[24:27], v[60:63], v[144:147]
    v_mfma_f32_16x16x32_bf16 v[152:155], v[28:31], v[48:51], v[152:155]
    v_mfma_f32_16x16x32_bf16 v[148:151], v[28:31], v[52:55], v[148:151]
    v_mfma_f32_16x16x32_bf16 v[144:147], v[28:31], v[56:59], v[144:147]
    s_waitcnt lgkmcnt(3)
    v_mfma_f32_16x16x32_bf16 v[148:151], v[16:19], v[64:67], v[148:151]
    v_mfma_f32_16x16x32_bf16 v[144:147], v[20:23], v[64:67], v[144:147]
    v_mfma_f32_16x16x32_bf16 v[148:151], v[32:35], v[48:51], v[148:151]
    v_mfma_f32_16x16x32_bf16 v[144:147], v[32:35], v[52:55], v[144:147]
    s_waitcnt lgkmcnt(0)
    v_mfma_f32_16x16x32_bf16 v[144:147], v[16:19], v[68:71], v[144:147]
    ds_read_b64 v[80:81], v7 offset:64
    ds_read_b64 v[82:83], v7 offset:72
    ds_read_b128 v[112:115], v8 offset:3648
    v_mfma_f32_16x16x32_bf16 v[144:147], v[36:39], v[48:51], v[144:147]
    ds_read_b64 v[84:85], v7 offset:576
    ds_read_b64 v[86:87], v7 offset:584
    ds_read_b128 v[116:119], v8 offset:3136
    ds_read_b64 v[88:89], v7 offset:1088
    ds_read_b64 v[90:91], v7 offset:1096
    ds_read_b128 v[120:123], v8 offset:2624
    ds_read_b64 v[92:93], v7 offset:1600
    ds_read_b64 v[94:95], v7 offset:1608
    ds_read_b128 v[124:127], v8 offset:2112
    ds_read_b64 v[96:97], v7 offset:2112
    ds_read_b64 v[98:99], v7 offset:2120
    ds_read_b128 v[128:131], v8 offset:1600
    ds_read_b64 v[100:101], v7 offset:2624
    ds_read_b64 v[102:103], v7 offset:2632
    ds_read_b128 v[132:135], v8 offset:1088
    s_waitcnt lgkmcnt(0)
    v_mfma_f32_16x16x32_bf16 v[156:159], v[84:87], v[116:119], v[156:159]
    ds_read_b64 v[16:17], v7 offset:128
    ds_read_b64 v[18:19], v7 offset:136
    v_mfma_f32_16x16x32_bf16 v[156:159], v[80:83], v[120:123], v[156:159]
    ds_read_b128 v[48:51], v8 offset:3712
    ds_read_b64 v[20:21], v7 offset:640
    v_mfma_f32_16x16x32_bf16 v[152:155], v[84:87], v[120:123], v[152:155]
    ds_read_b64 v[22:23], v7 offset:648
    ds_read_b128 v[52:55], v8 offset:3200
    v_mfma_f32_16x16x32_bf16 v[156:159], v[88:91], v[112:115], v[156:159]
    ds_read_b64 v[24:25], v7 offset:1152
    ds_read_b64 v[26:27], v7 offset:1160
    v_mfma_f32_16x16x32_bf16 v[152:155], v[88:91], v[116:119], v[152:155]
    ds_read_b128 v[56:59], v8 offset:2688
    ds_read_b64 v[28:29], v7 offset:1664
    v_mfma_f32_16x16x32_bf16 v[148:151], v[88:91], v[120:123], v[148:151]
    ds_read_b64 v[30:31], v7 offset:1672
    ds_read_b128 v[60:63], v8 offset:2176
    v_mfma_f32_16x16x32_bf16 v[152:155], v[80:83], v[124:127], v[152:155]
    ds_read_b64 v[32:33], v7 offset:2176
    ds_read_b64 v[34:35], v7 offset:2184
    v_mfma_f32_16x16x32_bf16 v[148:151], v[84:87], v[124:127], v[148:151]
    ds_read_b128 v[64:67], v8 offset:1664
    ds_read_b64 v[36:37], v7 offset:2688
    v_mfma_f32_16x16x32_bf16 v[144:147], v[88:91], v[124:127], v[144:147]
    ds_read_b64 v[38:39], v7 offset:2696
    ds_read_b128 v[68:71], v8 offset:1152
    v_mfma_f32_16x16x32_bf16 v[152:155], v[92:95], v[112:115], v[152:155]
    v_mfma_f32_16x16x32_bf16 v[148:151], v[92:95], v[116:119], v[148:151]
    v_mfma_f32_16x16x32_bf16 v[144:147], v[92:95], v[120:123], v[144:147]
    v_mfma_f32_16x16x32_bf16 v[148:151], v[80:83], v[128:131], v[148:151]
    v_mfma_f32_16x16x32_bf16 v[144:147], v[84:87], v[128:131], v[144:147]
    v_mfma_f32_16x16x32_bf16 v[148:151], v[96:99], v[112:115], v[148:151]
    v_mfma_f32_16x16x32_bf16 v[144:147], v[96:99], v[116:119], v[144:147]
    v_mfma_f32_16x16x32_bf16 v[144:147], v[80:83], v[132:135], v[144:147]
    v_mfma_f32_16x16x32_bf16 v[144:147], v[100:103], v[112:115], v[144:147]
    s_waitcnt lgkmcnt(0)
    v_mfma_f32_16x16x32_bf16 v[156:159], v[20:23], v[52:55], v[156:159]
    ds_read_b64 v[80:81], v7 offset:192
    ds_read_b64 v[82:83], v7 offset:200
    v_mfma_f32_16x16x32_bf16 v[156:159], v[16:19], v[56:59], v[156:159]
    ds_read_b128 v[112:115], v8 offset:3776
    ds_read_b64 v[84:85], v7 offset:704
    v_mfma_f32_16x16x32_bf16 v[152:155], v[20:23], v[56:59], v[152:155]
    ds_read_b64 v[86:87], v7 offset:712
    ds_read_b128 v[116:119], v8 offset:3264
    v_mfma_f32_16x16x32_bf16 v[156:159], v[24:27], v[48:51], v[156:159]
    ds_read_b64 v[88:89], v7 offset:1216
    ds_read_b64 v[90:91], v7 offset:1224
    v_mfma_f32_16x16x32_bf16 v[152:155], v[24:27], v[52:55], v[152:155]
    ds_read_b128 v[120:123], v8 offset:2752
    ds_read_b64 v[92:93], v7 offset:1728
    v_mfma_f32_16x16x32_bf16 v[148:151], v[24:27], v[56:59], v[148:151]
    ds_read_b64 v[94:95], v7 offset:1736
    ds_read_b128 v[124:127], v8 offset:2240
    v_mfma_f32_16x16x32_bf16 v[152:155], v[16:19], v[60:63], v[152:155]
    ds_read_b64 v[96:97], v7 offset:2240
    ds_read_b64 v[98:99], v7 offset:2248
    v_mfma_f32_16x16x32_bf16 v[148:151], v[20:23], v[60:63], v[148:151]
    ds_read_b128 v[128:131], v8 offset:1728
    ds_read_b64 v[100:101], v7 offset:2752
    v_mfma_f32_16x16x32_bf16 v[144:147], v[24:27], v[60:63], v[144:147]
    ds_read_b64 v[102:103], v7 offset:2760
    ds_read_b128 v[132:135], v8 offset:1216
    v_mfma_f32_16x16x32_bf16 v[152:155], v[28:31], v[48:51], v[152:155]
    v_mfma_f32_16x16x32_bf16 v[148:151], v[28:31], v[52:55], v[148:151]
    v_mfma_f32_16x16x32_bf16 v[144:147], v[28:31], v[56:59], v[144:147]
    v_mfma_f32_16x16x32_bf16 v[148:151], v[16:19], v[64:67], v[148:151]
    v_mfma_f32_16x16x32_bf16 v[144:147], v[20:23], v[64:67], v[144:147]
    v_mfma_f32_16x16x32_bf16 v[148:151], v[32:35], v[48:51], v[148:151]
    v_mfma_f32_16x16x32_bf16 v[144:147], v[32:35], v[52:55], v[144:147]
    v_mfma_f32_16x16x32_bf16 v[144:147], v[16:19], v[68:71], v[144:147]
    v_mfma_f32_16x16x32_bf16 v[144:147], v[36:39], v[48:51], v[144:147]
    s_waitcnt lgkmcnt(0)
    v_mfma_f32_16x16x32_bf16 v[156:159], v[84:87], v[116:119], v[156:159]
    v_mfma_f32_16x16x32_bf16 v[156:159], v[80:83], v[120:123], v[156:159]
    v_mfma_f32_16x16x32_bf16 v[152:155], v[84:87], v[120:123], v[152:155]
    v_mfma_f32_16x16x32_bf16 v[156:159], v[88:91], v[112:115], v[156:159]
    v_mfma_f32_16x16x32_bf16 v[152:155], v[88:91], v[116:119], v[152:155]
    v_mfma_f32_16x16x32_bf16 v[148:151], v[88:91], v[120:123], v[148:151]
    v_mfma_f32_16x16x32_bf16 v[152:155], v[80:83], v[124:127], v[152:155]
    v_mfma_f32_16x16x32_bf16 v[148:151], v[84:87], v[124:127], v[148:151]
    v_mfma_f32_16x16x32_bf16 v[144:147], v[88:91], v[124:127], v[144:147]
    v_mfma_f32_16x16x32_bf16 v[152:155], v[92:95], v[112:115], v[152:155]
    v_mfma_f32_16x16x32_bf16 v[148:151], v[92:95], v[116:119], v[148:151]
    v_mfma_f32_16x16x32_bf16 v[144:147], v[92:95], v[120:123], v[144:147]
    v_mfma_f32_16x16x32_bf16 v[148:151], v[80:83], v[128:131], v[148:151]
    v_mfma_f32_16x16x32_bf16 v[144:147], v[84:87], v[128:131], v[144:147]
    v_mfma_f32_16x16x32_bf16 v[148:151], v[96:99], v[112:115], v[148:151]
    v_mfma_f32_16x16x32_bf16 v[144:147], v[96:99], v[116:119], v[144:147]
    v_mfma_f32_16x16x32_bf16 v[144:147], v[80:83], v[132:135], v[144:147]
    v_mfma_f32_16x16x32_bf16 v[144:147], v[100:103], v[112:115], v[144:147]
    s_bitcmp1_b32 s38, 0
    s_cselect_b32 s66, 3, 5
    s_cselect_b32 s67, 2, 4
C_RED:
    s_lshl_b32 s68, s38, 11
    s_add_u32 s68, s68, 49920
    v_lshl_add_u32 v9, v1, 4, s68
    s_xor_b32 s69, s38, 1
    s_lshl_b32 s69, s69, 11
    s_add_u32 s69, s69, 49920
    v_lshl_add_u32 v10, v1, 4, s69
    s_bitcmp1_b32 s38, 0
    s_cbranch_scc1 C_RH1
    ds_write_b128 v9, v[152:155]
    ds_write_b128 v9, v[156:159] offset:1024
    v_mov_b32 v16, v144
    v_mov_b32 v17, v145
    v_mov_b32 v18, v146
    v_mov_b32 v19, v147
    v_mov_b32 v20, v148
    v_mov_b32 v21, v149
    v_mov_b32 v22, v150
    v_mov_b32 v23, v151
    s_branch C_RH2
C_RH1:
    ds_write_b128 v9, v[144:147]
    ds_write_b128 v9, v[148:151] offset:1024
    v_mov_b32 v16, v152
    v_mov_b32 v17, v153
    v_mov_b32 v18, v154
    v_mov_b32 v19, v155
    v_mov_b32 v20, v156
    v_mov_b32 v21, v157
    v_mov_b32 v22, v158
    v_mov_b32 v23, v159
C_RH2:
    v_lshlrev_b32 v11, 5, v5
    v_lshl_add_u32 v11, v6, 3, v11
    s_add_u32 s64, s64, 4088
    s_lshl_b32 s68, s66, 9
    s_sub_u32 s68, s64, s68
    v_sub_u32 v12, s68, v11
    s_lshl_b32 s68, s67, 9
    s_sub_u32 s68, s64, s68
    v_sub_u32 v13, s68, v11
    v_lshrrev_b32 v14, 1, v6
    v_lshl_add_u32 v14, v5, 1, v14
    v_mul_u32_u24 v14, 48, v14
    v_and_b32 v15, 1, v6
    v_lshl_add_u32 v14, v15, 3, v14
    s_lshl_b32 s68, s65, 4
    s_add_u32 s68, s68, 74496
    s_mul_i32 s69, s66, 1536
    s_add_u32 s69, s69, s68
    v_add_u32 v15, s69, v14
    s_mul_i32 s69, s67, 1536
    s_add_u32 s69, s69, s68
    v_add_u32 v14, s69, v14
    v_lshlrev_b32 v161, 16, v161
    ds_read_b64 v[32:33], v12
    ds_read_b64 v[34:35], v13
    s_waitcnt lgkmcnt(0)
    s_barrier
    ds_read_b128 v[24:27], v10
    ds_read_b128 v[28:31], v10 offset:1024
    v_and_b32 v40, 0xffff0000, v33
    v_lshlrev_b32 v41, 16, v33
    v_and_b32 v42, 0xffff0000, v32
    v_lshlrev_b32 v43, 16, v32
    v_mul_f32 v40, v40, v161
    v_mul_f32 v41, v41, v161
    v_mul_f32 v42, v42, v161
    v_mul_f32 v43, v43, v161
    v_cvt_pk_bf16_f32 v41, v40, v41
    v_cvt_pk_bf16_f32 v43, v42, v43
    v_lshlrev_b32 v40, 16, v41
    v_and_b32 v41, 0xffff0000, v41
    v_lshlrev_b32 v42, 16, v43
    v_and_b32 v43, 0xffff0000, v43
    v_and_b32 v44, 0xffff0000, v35
    v_lshlrev_b32 v45, 16, v35
    v_and_b32 v46, 0xffff0000, v34
    v_lshlrev_b32 v47, 16, v34
    v_mul_f32 v44, v44, v161
    v_mul_f32 v45, v45, v161
    v_mul_f32 v46, v46, v161
    v_mul_f32 v47, v47, v161
    v_cvt_pk_bf16_f32 v45, v44, v45
    v_cvt_pk_bf16_f32 v47, v46, v47
    v_lshlrev_b32 v44, 16, v45
    v_and_b32 v45, 0xffff0000, v45
    v_lshlrev_b32 v46, 16, v47
    v_and_b32 v47, 0xffff0000, v47
    s_waitcnt lgkmcnt(1)
    v_add_f32 v16, v16, v24
    v_add_f32 v17, v17, v25
    v_add_f32 v18, v18, v26
    v_add_f32 v19, v19, v27
    v_cvt_pk_bf16_f32 v17, v16, v17
    v_cvt_pk_bf16_f32 v19, v18, v19
    v_lshlrev_b32 v16, 16, v17
    v_and_b32 v17, 0xffff0000, v17
    v_lshlrev_b32 v18, 16, v19
    v_and_b32 v19, 0xffff0000, v19
    v_add_f32 v16, v16, v40
    v_add_f32 v17, v17, v41
    v_add_f32 v18, v18, v42
    v_add_f32 v19, v19, v43
    v_cvt_pk_bf16_f32 v36, v16, v17
    v_cvt_pk_bf16_f32 v37, v18, v19
    v_min_u32 v36, -2, v36
    v_min_u32 v37, -2, v37
    ds_write_b64 v15, v[36:37]
    s_waitcnt lgkmcnt(0)
    v_add_f32 v20, v20, v28
    v_add_f32 v21, v21, v29
    v_add_f32 v22, v22, v30
    v_add_f32 v23, v23, v31
    v_cvt_pk_bf16_f32 v21, v20, v21
    v_cvt_pk_bf16_f32 v23, v22, v23
    v_lshlrev_b32 v20, 16, v21
    v_and_b32 v21, 0xffff0000, v21
    v_lshlrev_b32 v22, 16, v23
    v_and_b32 v23, 0xffff0000, v23
    v_add_f32 v20, v20, v44
    v_add_f32 v21, v21, v45
    v_add_f32 v22, v22, v46
    v_add_f32 v23, v23, v47
    v_cvt_pk_bf16_f32 v38, v20, v21
    v_cvt_pk_bf16_f32 v39, v22, v23
    v_min_u32 v38, -2, v38
    v_min_u32 v39, -2, v39
    ds_write_b64 v14, v[38:39]
    v_add_u32 v9, 74496, v3
    s_mul_i32 s68, s52, 12288
    s_add_u32 s68, s68, 65536
    s_waitcnt lgkmcnt(0)
    s_barrier
    ds_read_b128 v[16:19], v9
    s_waitcnt lgkmcnt(0)
    buffer_store_dwordx4 v[16:19], v3, s[40:43], s68 offen sc1
    s_cmp_lg_u32 s2, 0
    s_cbranch_scc1 C_NOEP
    s_cmp_lg_u32 s38, 11
    s_cbranch_scc1 C_NOEP
    v_mov_b32 v20, s39
    v_mov_b32 v21, 0
    s_mov_b64 exec, 1
    buffer_store_dword v20, v21, s[40:43], 0 offen sc1
    s_mov_b64 exec, -1
C_NOEP:
    s_movk_i32 s69, 16
    s_branch LN2
NONCONV:
    s_barrier
    s_cmp_ge_u32 s38, 8
    s_cbranch_scc1 N_NOLN1
    s_waitcnt vmcnt(0)
    v_lshlrev_b32 v40, 16, v20
    v_and_b32 v41, 0xffff0000, v20
    v_lshlrev_b32 v42, 16, v21
    v_and_b32 v43, 0xffff0000, v21
    v_lshlrev_b32 v44, 16, v22
    v_and_b32 v45, 0xffff0000, v22
    v_lshlrev_b32 v46, 16, v23
    v_and_b32 v47, 0xffff0000, v23
    v_lshlrev_b32 v48, 16, v24
    v_and_b32 v49, 0xffff0000, v24
    v_lshlrev_b32 v50, 16, v25
    v_and_b32 v51, 0xffff0000, v25
    v_add_f32 v26, v40, v41
    v_add_f32 v27, v42, v43
    v_add_f32 v26, v26, v44
    v_add_f32 v27, v27, v45
    v_add_f32 v26, v26, v46
    v_add_f32 v27, v27, v47
    v_add_f32 v26, v26, v48
    v_add_f32 v27, v27, v49
    v_add_f32 v26, v26, v50
    v_add_f32 v27, v27, v51
    v_add_f32 v26, v26, v27
    s_nop 1
    v_add_f32_dpp v26, v26, v26 quad_perm:[1,0,3,2] row_mask:0xf bank_mask:0xf
    s_nop 1
    v_add_f32_dpp v26, v26, v26 quad_perm:[2,3,0,1] row_mask:0xf bank_mask:0xf
    s_nop 1
    v_add_f32_dpp v26, v26, v26 row_half_mirror row_mask:0xf bank_mask:0xf
    s_nop 1
    v_add_f32_dpp v26, v26, v26 row_mirror row_mask:0xf bank_mask:0xf
    v_mov_b32 v27, v26
    s_nop 1
    v_permlane16_swap_b32 v26, v27
    v_add_f32 v26, v26, v27
    v_mov_b32 v27, v26
    s_nop 1
    v_permlane32_swap_b32 v26, v27
    v_add_f32 v26, v26, v27
    v_mul_f32 v26, 0x3ae38e39, v26
    v_mov_b32 v27, 0
    v_mov_b32 v28, 0
    s_mov_b32 exec_hi, 0xffff
    v_sub_f32 v40, v40, v26
    v_sub_f32 v41, v41, v26
    v_fmac_f32 v27, v40, v40
    v_fmac_f32 v28, v41, v41
    v_sub_f32 v42, v42, v26
    v_sub_f32 v43, v43, v26
    v_fmac_f32 v27, v42, v42
    v_fmac_f32 v28, v43, v43
    v_sub_f32 v44, v44, v26
    v_sub_f32 v45, v45, v26
    v_fmac_f32 v27, v44, v44
    v_fmac_f32 v28, v45, v45
    v_sub_f32 v46, v46, v26
    v_sub_f32 v47, v47, v26
    v_fmac_f32 v27, v46, v46
    v_fmac_f32 v28, v47, v47
    v_sub_f32 v48, v48, v26
    v_sub_f32 v49, v49, v26
    v_fmac_f32 v27, v48, v48
    v_fmac_f32 v28, v49, v49
    v_sub_f32 v50, v50, v26
    v_sub_f32 v51, v51, v26
    v_fmac_f32 v27, v50, v50
    v_fmac_f32 v28, v51, v51
    s_mov_b64 exec, -1
    v_add_f32 v27, v27, v28
    s_nop 1
    v_add_f32_dpp v27, v27, v27 quad_perm:[1,0,3,2] row_mask:0xf bank_mask:0xf
    s_nop 1
    v_add_f32_dpp v27, v27, v27 quad_perm:[2,3,0,1] row_mask:0xf bank_mask:0xf
    s_nop 1
    v_add_f32_dpp v27, v27, v27 row_half_mirror row_mask:0xf bank_mask:0xf
    s_nop 1
    v_add_f32_dpp v27, v27, v27 row_mirror row_mask:0xf bank_mask:0xf
    v_mov_b32 v28, v27
    s_nop 1
    v_permlane16_swap_b32 v27, v28
    v_add_f32 v27, v27, v28
    v_mov_b32 v28, v27
    s_nop 1
    v_permlane32_swap_b32 v27, v28
    v_add_f32 v27, v27, v28
    v_mul_f32 v27, 0x3ae38e39, v27
    v_cvt_pk_bf16_f32 v27, v27, v27
    v_lshlrev_b32 v27, 16, v27
    v_add_f32 v27, 0x3727c5ac, v27
    v_cvt_pk_bf16_f32 v27, v27, v27
    v_lshlrev_b32 v27, 16, v27
    v_sqrt_f32 v27, v27
    s_nop 0
    v_cvt_pk_bf16_f32 v27, v27, v27
    v_lshlrev_b32 v27, 16, v27
    v_cvt_pk_bf16_f32 v26, v26, v27
    s_lshl_b32 s67, s38, 3
    v_mov_b32 v28, s67
    s_waitcnt lgkmcnt(0)
    s_add_u32 s39, s39, 1
    v_mov_b32 v27, s39
    v_mov_b32 v29, 1
    v_mov_b32 v37, 140288
    s_mov_b64 exec, 1
    v_add_u32 v28, 140352, v28
    ds_write_b64 v28, v[26:27]
    ds_add_rtn_u32 v29, v37, v29
    s_waitcnt lgkmcnt(0)
    v_readfirstlane_b32 s67, v29
    s_mov_b64 exec, -1
    s_cmp_lg_u32 s67, 7
    s_cbranch_scc1 LN1_X1
    v_lshlrev_b32 v28, 4, v1
    v_add_u32 v29, 140352, v28
    s_lshl_b32 s67, s2, 6
    s_add_u32 s67, s67, 4096
    s_mov_b64 exec, 0xf
    ds_read_b128 v[40:43], v29
    s_waitcnt lgkmcnt(0)
    buffer_store_dwordx4 v[40:43], v28, s[40:43], s67 offen sc1
    s_mov_b64 exec, -1
LN1_X1:
    s_branch N_W
N_NOLN1:
    s_waitcnt lgkmcnt(0)
    s_add_u32 s39, s39, 1
N_W:
    s_cmp_ge_u32 s2, 240
    s_cbranch_scc1 N_CHECK
    v_and_b32 v5, 15, v0
    v_bfe_u32 v6, v0, 4, 2
    s_cmp_ge_u32 s38, 9
    s_cbranch_scc1 N_WD
    s_mul_i32 s64, s38, 43
    s_lshr_b32 s64, s64, 7
    s_mul_i32 s65, s64, 3
    s_sub_u32 s65, s38, s65
    s_mul_i32 s66, s53, 192
    s_lshl_b32 s67, s64, 6
    s_add_u32 s66, s66, s67
    s_mul_i32 s67, s65, 1769472
    s_add_u32 s66, s66, s67
    v_and_b32 v7, 7, v5
    s_mov_b32 s67, 73728
    v_mul_lo_u32 v8, v6, s67
    v_lshl_add_u32 v8, v7, 3, v8
    v_add_u32 v8, s66, v8
    v_cmp_gt_u32 vcc, 8, v5
    v_mov_b32 v10, s28
    v_mov_b32 v11, s26
    v_cndmask_b32 v10, v10, v11, vcc
    v_mov_b32 v11, s29
    v_mov_b32 v12, s27
    v_cndmask_b32 v11, v11, v12, vcc
    v_add_co_u32 v10, vcc, v10, v8
    s_nop 1
    v_addc_co_u32 v11, vcc, 0, v11, vcc
    s_movk_i32 s66, 9216
    s_mov_b32 s67, 230400
    global_load_dwordx2 v[72:73], v[10:11], off
    v_add_co_u32 v10, vcc, s66, v10
    s_nop 1
    v_addc_co_u32 v11, vcc, 0, v11, vcc
    global_load_dwordx2 v[74:75], v[10:11], off
    v_add_co_u32 v10, vcc, s66, v10
    s_nop 1
    v_addc_co_u32 v11, vcc, 0, v11, vcc
    global_load_dwordx2 v[76:77], v[10:11], off
    v_add_co_u32 v10, vcc, s66, v10
    s_nop 1
    v_addc_co_u32 v11, vcc, 0, v11, vcc
    global_load_dwordx2 v[78:79], v[10:11], off
    v_add_co_u32 v10, vcc, s66, v10
    s_nop 1
    v_addc_co_u32 v11, vcc, 0, v11, vcc
    global_load_dwordx2 v[80:81], v[10:11], off
    v_add_co_u32 v10, vcc, s66, v10
    s_nop 1
    v_addc_co_u32 v11, vcc, 0, v11, vcc
    global_load_dwordx2 v[82:83], v[10:11], off
    v_add_co_u32 v10, vcc, s66, v10
    s_nop 1
    v_addc_co_u32 v11, vcc, 0, v11, vcc
    global_load_dwordx2 v[84:85], v[10:11], off
    v_add_co_u32 v10, vcc, s66, v10
    s_nop 1
    v_addc_co_u32 v11, vcc, 0, v11, vcc
    global_load_dwordx2 v[86:87], v[10:11], off
    v_add_co_u32 v10, vcc, s67, v10
    s_nop 1
    v_addc_co_u32 v11, vcc, 0, v11, vcc
    global_load_dwordx2 v[88:89], v[10:11], off
    v_add_co_u32 v10, vcc, s66, v10
    s_nop 1
    v_addc_co_u32 v11, vcc, 0, v11, vcc
    global_load_dwordx2 v[90:91], v[10:11], off
    v_add_co_u32 v10, vcc, s66, v10
    s_nop 1
    v_addc_co_u32 v11, vcc, 0, v11, vcc
    global_load_dwordx2 v[92:93], v[10:11], off
    v_add_co_u32 v10, vcc, s66, v10
    s_nop 1
    v_addc_co_u32 v11, vcc, 0, v11, vcc
    global_load_dwordx2 v[94:95], v[10:11], off
    v_add_co_u32 v10, vcc, s66, v10
    s_nop 1
    v_addc_co_u32 v11, vcc, 0, v11, vcc
    global_load_dwordx2 v[96:97], v[10:11], off
    v_add_co_u32 v10, vcc, s66, v10
    s_nop 1
    v_addc_co_u32 v11, vcc, 0, v11, vcc
    global_load_dwordx2 v[98:99], v[10:11], off
    v_add_co_u32 v10, vcc, s66, v10
    s_nop 1
    v_addc_co_u32 v11, vcc, 0, v11, vcc
    global_load_dwordx2 v[100:101], v[10:11], off
    v_add_co_u32 v10, vcc, s66, v10
    s_nop 1
    v_addc_co_u32 v11, vcc, 0, v11, vcc
    global_load_dwordx2 v[102:103], v[10:11], off
    v_add_co_u32 v10, vcc, s67, v10
    s_nop 1
    v_addc_co_u32 v11, vcc, 0, v11, vcc
    global_load_dwordx2 v[104:105], v[10:11], off
    v_add_co_u32 v10, vcc, s66, v10
    s_nop 1
    v_addc_co_u32 v11, vcc, 0, v11, vcc
    global_load_dwordx2 v[106:107], v[10:11], off
    v_add_co_u32 v10, vcc, s66, v10
    s_nop 1
    v_addc_co_u32 v11, vcc, 0, v11, vcc
    global_load_dwordx2 v[108:109], v[10:11], off
    v_add_co_u32 v10, vcc, s66, v10
    s_nop 1
    v_addc_co_u32 v11, vcc, 0, v11, vcc
    global_load_dwordx2 v[110:111], v[10:11], off
    v_add_co_u32 v10, vcc, s66, v10
    s_nop 1
    v_addc_co_u32 v11, vcc, 0, v11, vcc
    global_load_dwordx2 v[112:113], v[10:11], off
    v_add_co_u32 v10, vcc, s66, v10
    s_nop 1
    v_addc_co_u32 v11, vcc, 0, v11, vcc
    global_load_dwordx2 v[114:115], v[10:11], off
    v_add_co_u32 v10, vcc, s66, v10
    s_nop 1
    v_addc_co_u32 v11, vcc, 0, v11, vcc
    global_load_dwordx2 v[116:117], v[10:11], off
    v_add_co_u32 v10, vcc, s66, v10
    s_nop 1
    v_addc_co_u32 v11, vcc, 0, v11, vcc
    global_load_dwordx2 v[118:119], v[10:11], off
    v_add_co_u32 v10, vcc, s67, v10
    s_nop 1
    v_addc_co_u32 v11, vcc, 0, v11, vcc
    global_load_dwordx2 v[120:121], v[10:11], off
    v_add_co_u32 v10, vcc, s66, v10
    s_nop 1
    v_addc_co_u32 v11, vcc, 0, v11, vcc
    global_load_dwordx2 v[122:123], v[10:11], off
    v_add_co_u32 v10, vcc, s66, v10
    s_nop 1
    v_addc_co_u32 v11, vcc, 0, v11, vcc
    global_load_dwordx2 v[124:125], v[10:11], off
    v_add_co_u32 v10, vcc, s66, v10
    s_nop 1
    v_addc_co_u32 v11, vcc, 0, v11, vcc
    global_load_dwordx2 v[126:127], v[10:11], off
    v_add_co_u32 v10, vcc, s66, v10
    s_nop 1
    v_addc_co_u32 v11, vcc, 0, v11, vcc
    global_load_dwordx2 v[128:129], v[10:11], off
    v_add_co_u32 v10, vcc, s66, v10
    s_nop 1
    v_addc_co_u32 v11, vcc, 0, v11, vcc
    global_load_dwordx2 v[130:131], v[10:11], off
    v_add_co_u32 v10, vcc, s66, v10
    s_nop 1
    v_addc_co_u32 v11, vcc, 0, v11, vcc
    global_load_dwordx2 v[132:133], v[10:11], off
    v_add_co_u32 v10, vcc, s66, v10
    s_nop 1
    v_addc_co_u32 v11, vcc, 0, v11, vcc
    global_load_dwordx2 v[134:135], v[10:11], off
    v_add_co_u32 v10, vcc, s67, v10
    s_nop 1
    v_addc_co_u32 v11, vcc, 0, v11, vcc
    global_load_dwordx2 v[136:137], v[10:11], off
    v_add_co_u32 v10, vcc, s66, v10
    s_nop 1
    v_addc_co_u32 v11, vcc, 0, v11, vcc
    global_load_dwordx2 v[138:139], v[10:11], off
    v_add_co_u32 v10, vcc, s66, v10
    s_nop 1
    v_addc_co_u32 v11, vcc, 0, v11, vcc
    global_load_dwordx2 v[140:141], v[10:11], off
    v_add_co_u32 v10, vcc, s66, v10
    s_nop 1
    v_addc_co_u32 v11, vcc, 0, v11, vcc
    global_load_dwordx2 v[142:143], v[10:11], off
    v_add_co_u32 v10, vcc, s66, v10
    s_nop 1
    v_addc_co_u32 v11, vcc, 0, v11, vcc
    global_load_dwordx2 v[144:145], v[10:11], off
    v_add_co_u32 v10, vcc, s66, v10
    s_nop 1
    v_addc_co_u32 v11, vcc, 0, v11, vcc
    global_load_dwordx2 v[146:147], v[10:11], off
    v_add_co_u32 v10, vcc, s66, v10
    s_nop 1
    v_addc_co_u32 v11, vcc, 0, v11, vcc
    global_load_dwordx2 v[148:149], v[10:11], off
    v_add_co_u32 v10, vcc, s66, v10
    s_nop 1
    v_addc_co_u32 v11, vcc, 0, v11, vcc
    global_load_dwordx2 v[150:151], v[10:11], off
    v_add_co_u32 v10, vcc, s67, v10
    s_nop 1
    v_addc_co_u32 v11, vcc, 0, v11, vcc
    global_load_dwordx2 v[152:153], v[10:11], off
    v_add_co_u32 v10, vcc, s66, v10
    s_nop 1
    v_addc_co_u32 v11, vcc, 0, v11, vcc
    global_load_dwordx2 v[154:155], v[10:11], off
    v_add_co_u32 v10, vcc, s66, v10
    s_nop 1
    v_addc_co_u32 v11, vcc, 0, v11, vcc
    global_load_dwordx2 v[156:157], v[10:11], off
    v_add_co_u32 v10, vcc, s66, v10
    s_nop 1
    v_addc_co_u32 v11, vcc, 0, v11, vcc
    global_load_dwordx2 v[158:159], v[10:11], off
    v_add_co_u32 v10, vcc, s66, v10
    s_nop 1
    v_addc_co_u32 v11, vcc, 0, v11, vcc
    global_load_dwordx2 v[160:161], v[10:11], off
    v_add_co_u32 v10, vcc, s66, v10
    s_nop 1
    v_addc_co_u32 v11, vcc, 0, v11, vcc
    global_load_dwordx2 v[162:163], v[10:11], off
    v_add_co_u32 v10, vcc, s66, v10
    s_nop 1
    v_addc_co_u32 v11, vcc, 0, v11, vcc
    global_load_dwordx2 v[164:165], v[10:11], off
    v_add_co_u32 v10, vcc, s66, v10
    s_nop 1
    v_addc_co_u32 v11, vcc, 0, v11, vcc
    global_load_dwordx2 v[166:167], v[10:11], off
    s_mov_b32 s66, 0x05040100
    s_mov_b32 s67, 0x07060302
    s_waitcnt vmcnt(40)
    v_perm_b32 v56, v74, v72, s66
    v_perm_b32 v60, v74, v72, s67
    v_perm_b32 v64, v75, v73, s66
    v_perm_b32 v68, v75, v73, s67
    v_perm_b32 v57, v78, v76, s66
    v_perm_b32 v61, v78, v76, s67
    v_perm_b32 v65, v79, v77, s66
    v_perm_b32 v69, v79, v77, s67
    v_perm_b32 v58, v82, v80, s66
    v_perm_b32 v62, v82, v80, s67
    v_perm_b32 v66, v83, v81, s66
    v_perm_b32 v70, v83, v81, s67
    v_perm_b32 v59, v86, v84, s66
    v_perm_b32 v63, v86, v84, s67
    v_perm_b32 v67, v87, v85, s66
    v_perm_b32 v71, v87, v85, s67
    s_waitcnt vmcnt(32)
    v_perm_b32 v72, v90, v88, s66
    v_perm_b32 v76, v90, v88, s67
    v_perm_b32 v80, v91, v89, s66
    v_perm_b32 v84, v91, v89, s67
    v_perm_b32 v73, v94, v92, s66
    v_perm_b32 v77, v94, v92, s67
    v_perm_b32 v81, v95, v93, s66
    v_perm_b32 v85, v95, v93, s67
    v_perm_b32 v74, v98, v96, s66
    v_perm_b32 v78, v98, v96, s67
    v_perm_b32 v82, v99, v97, s66
    v_perm_b32 v86, v99, v97, s67
    v_perm_b32 v75, v102, v100, s66
    v_perm_b32 v79, v102, v100, s67
    v_perm_b32 v83, v103, v101, s66
    v_perm_b32 v87, v103, v101, s67
    s_waitcnt vmcnt(24)
    v_perm_b32 v88, v106, v104, s66
    v_perm_b32 v92, v106, v104, s67
    v_perm_b32 v96, v107, v105, s66
    v_perm_b32 v100, v107, v105, s67
    v_perm_b32 v89, v110, v108, s66
    v_perm_b32 v93, v110, v108, s67
    v_perm_b32 v97, v111, v109, s66
    v_perm_b32 v101, v111, v109, s67
    v_perm_b32 v90, v114, v112, s66
    v_perm_b32 v94, v114, v112, s67
    v_perm_b32 v98, v115, v113, s66
    v_perm_b32 v102, v115, v113, s67
    v_perm_b32 v91, v118, v116, s66
    v_perm_b32 v95, v118, v116, s67
    v_perm_b32 v99, v119, v117, s66
    v_perm_b32 v103, v119, v117, s67
    s_waitcnt vmcnt(16)
    v_perm_b32 v104, v122, v120, s66
    v_perm_b32 v108, v122, v120, s67
    v_perm_b32 v112, v123, v121, s66
    v_perm_b32 v116, v123, v121, s67
    v_perm_b32 v105, v126, v124, s66
    v_perm_b32 v109, v126, v124, s67
    v_perm_b32 v113, v127, v125, s66
    v_perm_b32 v117, v127, v125, s67
    v_perm_b32 v106, v130, v128, s66
    v_perm_b32 v110, v130, v128, s67
    v_perm_b32 v114, v131, v129, s66
    v_perm_b32 v118, v131, v129, s67
    v_perm_b32 v107, v134, v132, s66
    v_perm_b32 v111, v134, v132, s67
    v_perm_b32 v115, v135, v133, s66
    v_perm_b32 v119, v135, v133, s67
    s_waitcnt vmcnt(8)
    v_perm_b32 v120, v138, v136, s66
    v_perm_b32 v124, v138, v136, s67
    v_perm_b32 v128, v139, v137, s66
    v_perm_b32 v132, v139, v137, s67
    v_perm_b32 v121, v142, v140, s66
    v_perm_b32 v125, v142, v140, s67
    v_perm_b32 v129, v143, v141, s66
    v_perm_b32 v133, v143, v141, s67
    v_perm_b32 v122, v146, v144, s66
    v_perm_b32 v126, v146, v144, s67
    v_perm_b32 v130, v147, v145, s66
    v_perm_b32 v134, v147, v145, s67
    v_perm_b32 v123, v150, v148, s66
    v_perm_b32 v127, v150, v148, s67
    v_perm_b32 v131, v151, v149, s66
    v_perm_b32 v135, v151, v149, s67
    s_waitcnt vmcnt(0)
    v_perm_b32 v136, v154, v152, s66
    v_perm_b32 v140, v154, v152, s67
    v_perm_b32 v144, v155, v153, s66
    v_perm_b32 v148, v155, v153, s67
    v_perm_b32 v137, v158, v156, s66
    v_perm_b32 v141, v158, v156, s67
    v_perm_b32 v145, v159, v157, s66
    v_perm_b32 v149, v159, v157, s67
    v_perm_b32 v138, v162, v160, s66
    v_perm_b32 v142, v162, v160, s67
    v_perm_b32 v146, v163, v161, s66
    v_perm_b32 v150, v163, v161, s67
    v_perm_b32 v139, v166, v164, s66
    v_perm_b32 v143, v166, v164, s67
    v_perm_b32 v147, v167, v165, s66
    v_perm_b32 v151, v167, v165, s67
    s_branch N_CHECK
N_WD:
    v_lshrrev_b32 v7, 3, v1
    v_bfe_u32 v8, v1, 1, 2
    v_xor_b32 v8, v8, v6
    v_and_b32 v9, 1, v1
    v_lshl_add_u32 v8, v8, 1, v9
    s_movk_i32 s66, 1152
    v_mul_lo_u32 v7, v7, s66
    v_lshl_add_u32 v7, v8, 4, v7
    s_mov_b32 s44, s30
    s_mov_b32 s45, s31
    s_mov_b32 s46, 5308416
    s_mov_b32 s47, 0x00020000
    s_sub_u32 s64, s38, 9
    s_mul_i32 s65, s53, 110592
    s_mul_i32 s66, s64, 384
    s_add_u32 s65, s65, s66
    s_mul_i32 s66, s64, 36864
    s_add_u32 m0, s66, 0
    s_add_u32 s67, s65, 0
    buffer_load_dwordx4 v7, s[44:47], s67 offen lds
    s_add_u32 m0, s66, 1024
    s_add_u32 s67, s65, 9216
    buffer_load_dwordx4 v7, s[44:47], s67 offen lds
    s_add_u32 m0, s66, 2048
    s_add_u32 s67, s65, 18432
    buffer_load_dwordx4 v7, s[44:47], s67 offen lds
    s_add_u32 m0, s66, 3072
    s_add_u32 s67, s65, 27648
    buffer_load_dwordx4 v7, s[44:47], s67 offen lds
    s_add_u32 m0, s66, 4096
    s_add_u32 s67, s65, 36864
    buffer_load_dwordx4 v7, s[44:47], s67 offen lds
    s_add_u32 m0, s66, 5120
    s_add_u32 s67, s65, 46080
    buffer_load_dwordx4 v7, s[44:47], s67 offen lds
    s_add_u32 m0, s66, 6144
    s_add_u32 s67, s65, 55296
    buffer_load_dwordx4 v7, s[44:47], s67 offen lds
    s_add_u32 m0, s66, 7168
    s_add_u32 s67, s65, 64512
    buffer_load_dwordx4 v7, s[44:47], s67 offen lds
    s_add_u32 m0, s66, 8192
    s_add_u32 s67, s65, 73728
    buffer_load_dwordx4 v7, s[44:47], s67 offen lds
    s_add_u32 m0, s66, 9216
    s_add_u32 s67, s65, 82944
    buffer_load_dwordx4 v7, s[44:47], s67 offen lds
    s_add_u32 m0, s66, 10240
    s_add_u32 s67, s65, 92160
    buffer_load_dwordx4 v7, s[44:47], s67 offen lds
    s_add_u32 m0, s66, 11264
    s_add_u32 s67, s65, 101376
    buffer_load_dwordx4 v7, s[44:47], s67 offen lds
    s_add_u32 m0, s66, 12288
    s_add_u32 s67, s65, 128
    buffer_load_dwordx4 v7, s[44:47], s67 offen lds
    s_add_u32 m0, s66, 13312
    s_add_u32 s67, s65, 9344
    buffer_load_dwordx4 v7, s[44:47], s67 offen lds
    s_add_u32 m0, s66, 14336
    s_add_u32 s67, s65, 18560
    buffer_load_dwordx4 v7, s[44:47], s67 offen lds
    s_add_u32 m0, s66, 15360
    s_add_u32 s67, s65, 27776
    buffer_load_dwordx4 v7, s[44:47], s67 offen lds
    s_add_u32 m0, s66, 16384
    s_add_u32 s67, s65, 36992
    buffer_load_dwordx4 v7, s[44:47], s67 offen lds
    s_add_u32 m0, s66, 17408
    s_add_u32 s67, s65, 46208
    buffer_load_dwordx4 v7, s[44:47], s67 offen lds
    s_add_u32 m0, s66, 18432
    s_add_u32 s67, s65, 55424
    buffer_load_dwordx4 v7, s[44:47], s67 offen lds
    s_add_u32 m0, s66, 19456
    s_add_u32 s67, s65, 64640
    buffer_load_dwordx4 v7, s[44:47], s67 offen lds
    s_add_u32 m0, s66, 20480
    s_add_u32 s67, s65, 73856
    buffer_load_dwordx4 v7, s[44:47], s67 offen lds
    s_add_u32 m0, s66, 21504
    s_add_u32 s67, s65, 83072
    buffer_load_dwordx4 v7, s[44:47], s67 offen lds
    s_add_u32 m0, s66, 22528
    s_add_u32 s67, s65, 92288
    buffer_load_dwordx4 v7, s[44:47], s67 offen lds
    s_add_u32 m0, s66, 23552
    s_add_u32 s67, s65, 101504
    buffer_load_dwordx4 v7, s[44:47], s67 offen lds
    s_add_u32 m0, s66, 24576
    s_add_u32 s67, s65, 256
    buffer_load_dwordx4 v7, s[44:47], s67 offen lds
    s_add_u32 m0, s66, 25600
    s_add_u32 s67, s65, 9472
    buffer_load_dwordx4 v7, s[44:47], s67 offen lds
    s_add_u32 m0, s66, 26624
    s_add_u32 s67, s65, 18688
    buffer_load_dwordx4 v7, s[44:47], s67 offen lds
    s_add_u32 m0, s66, 27648
    s_add_u32 s67, s65, 27904
    buffer_load_dwordx4 v7, s[44:47], s67 offen lds
    s_add_u32 m0, s66, 28672
    s_add_u32 s67, s65, 37120
    buffer_load_dwordx4 v7, s[44:47], s67 offen lds
    s_add_u32 m0, s66, 29696
    s_add_u32 s67, s65, 46336
    buffer_load_dwordx4 v7, s[44:47], s67 offen lds
    s_add_u32 m0, s66, 30720
    s_add_u32 s67, s65, 55552
    buffer_load_dwordx4 v7, s[44:47], s67 offen lds
    s_add_u32 m0, s66, 31744
    s_add_u32 s67, s65, 64768
    buffer_load_dwordx4 v7, s[44:47], s67 offen lds
    s_add_u32 m0, s66, 32768
    s_add_u32 s67, s65, 73984
    buffer_load_dwordx4 v7, s[44:47], s67 offen lds
    s_add_u32 m0, s66, 33792
    s_add_u32 s67, s65, 83200
    buffer_load_dwordx4 v7, s[44:47], s67 offen lds
    s_add_u32 m0, s66, 34816
    s_add_u32 s67, s65, 92416
    buffer_load_dwordx4 v7, s[44:47], s67 offen lds
    s_add_u32 m0, s66, 35840
    s_add_u32 s67, s65, 101632
    buffer_load_dwordx4 v7, s[44:47], s67 offen lds
N_CHECK:
    s_sleep 40
    s_cmp_lt_u32 s38, 4
    s_cbranch_scc1 N_NOCHK
    v_subrev_u32 v17, 0x100, v0
    v_lshlrev_b32 v17, 5, v17
    s_movk_i32 s64, 4096
    s_movk_i32 s60, 4000
N_STP:
    buffer_load_dwordx4 v[20:23], v17, s[40:43], s64 offen sc1
    buffer_load_dwordx4 v[24:27], v17, s[40:43], s64 offen offset:16 sc1
    s_waitcnt vmcnt(0)
    v_xor_b32 v28, s39, v21
    v_xor_b32 v29, s39, v23
    v_xor_b32 v30, s39, v25
    v_xor_b32 v31, s39, v27
    v_or3_b32 v28, v28, v29, v30
    v_or_b32 v28, v28, v31
    v_cmp_ne_u32 vcc, 0, v28
    s_nop 0
    s_and_b64 exec, exec, vcc
    s_cbranch_execz N_STP_D
    s_sub_u32 s60, s60, 1
    s_cmp_lg_u32 s60, 0
    s_sleep 1
    s_cbranch_scc1 N_STP
N_STP_D:
    s_mov_b64 exec, -1
N_NOCHK:
    s_barrier
    s_movk_i32 s69, 40
LN2:
    v_and_b32 v4, 7, v1
    v_lshrrev_b32 v5, 3, v1
    s_lshl_b32 s64, s2, 3
    v_add_u32 v6, s64, v4
    s_movk_i32 s65, 1152
    v_mul_lo_u32 v7, v6, s65
    s_lshl_b32 s65, s38, 7
    v_lshl_add_u32 v8, v5, 4, s65
    v_add_u32 v7, v7, v8
    s_cmp_ge_u32 s38, 9
    s_cbranch_scc1 L_IDLE
    global_load_dwordx4 v[12:15], v7, s[4:5]
    global_load_dwordx4 v[16:19], v8, s[24:25]
    s_mov_b32 s65, 43691
    v_mul_u32_u24 v9, s65, v0
    v_lshrrev_b32 v9, 17, v9
    v_mul_u32_u24 v10, 3, v9
    v_sub_u32 v10, v0, v10
    s_movk_i32 s65, 12288
    v_mul_lo_u32 v9, v9, s65
    v_lshl_add_u32 v9, v10, 4, v9
    s_mul_i32 s65, s2, 48
    s_add_u32 s65, s65, 65536
    v_bfe_u32 v10, v1, 2, 2
    v_bfe_u32 v11, v1, 1, 1
    v_lshl_add_u32 v10, v11, 3, v10
    v_lshrrev_b32 v11, 4, v1
    v_lshl_add_u32 v10, v11, 4, v10
    v_lshlrev_b32 v10, 4, v10
    v_and_b32 v11, 1, v1
    v_lshl_add_u32 v10, v11, 3, v10
    s_lshl_b32 s66, s38, 10
    s_add_u32 s66, s66, 131072
    v_add_u32 v10, s66, v10
    v_add_u32 v11, 131072, v3
L_DLY:
    s_sleep 1
    s_sub_u32 s69, s69, 1
    s_cmp_gt_i32 s69, 0
    s_cbranch_scc1 L_DLY
    s_movk_i32 s60, 4000
L_YP:
    buffer_load_dwordx4 v[20:23], v9, s[40:43], s65 offen sc1
    s_waitcnt vmcnt(0)
    v_max_u32 v28, v20, v21
    v_max3_u32 v28, v28, v22, v23
    v_cmp_eq_u32 vcc, -1, v28
    s_nop 0
    s_and_b64 exec, exec, vcc
    s_cbranch_execz L_YP_D
    s_sub_u32 s60, s60, 1
    s_cmp_lg_u32 s60, 0
    s_sleep 1
    s_cbranch_scc1 L_YP
L_YP_D:
    s_mov_b64 exec, -1
    ds_write_b128 v11, v[20:23]
    s_waitcnt lgkmcnt(0)
    s_barrier
    ds_read_b64_tr_b16 v[20:21], v10
    ds_read_b64_tr_b16 v[22:23], v10 offset:64
    v_lshlrev_b32 v32, 16, v12
    v_and_b32 v33, 0xffff0000, v12
    v_lshlrev_b32 v34, 16, v13
    v_and_b32 v35, 0xffff0000, v13
    v_lshlrev_b32 v36, 16, v14
    v_and_b32 v37, 0xffff0000, v14
    v_lshlrev_b32 v38, 16, v15
    v_and_b32 v39, 0xffff0000, v15
    s_lshl_b32 s66, s38, 5
    s_add_u32 s66, s66, 140544
    v_lshl_add_u32 v9, v4, 2, s66
    v_lshlrev_b32 v11, 2, v4
    v_add_u32 v11, 140544, v11
    s_waitcnt lgkmcnt(0)
    v_lshlrev_b32 v24, 16, v20
    v_and_b32 v25, 0xffff0000, v20
    v_add_f32 v32, v32, v24
    v_add_f32 v33, v33, v25
    v_cvt_pk_bf16_f32 v12, v32, v33
    v_lshlrev_b32 v32, 16, v12
    v_and_b32 v33, 0xffff0000, v12
    v_lshlrev_b32 v24, 16, v21
    v_and_b32 v25, 0xffff0000, v21
    v_add_f32 v34, v34, v24
    v_add_f32 v35, v35, v25
    v_cvt_pk_bf16_f32 v13, v34, v35
    v_lshlrev_b32 v34, 16, v13
    v_and_b32 v35, 0xffff0000, v13
    v_lshlrev_b32 v24, 16, v22
    v_and_b32 v25, 0xffff0000, v22
    v_add_f32 v36, v36, v24
    v_add_f32 v37, v37, v25
    v_cvt_pk_bf16_f32 v14, v36, v37
    v_lshlrev_b32 v36, 16, v14
    v_and_b32 v37, 0xffff0000, v14
    v_lshlrev_b32 v24, 16, v23
    v_and_b32 v25, 0xffff0000, v23
    v_add_f32 v38, v38, v24
    v_add_f32 v39, v39, v25
    v_cvt_pk_bf16_f32 v15, v38, v39
    v_lshlrev_b32 v38, 16, v15
    v_and_b32 v39, 0xffff0000, v15
    v_add_f32 v24, v32, v33
    v_add_f32 v25, v34, v35
    v_add_f32 v26, v36, v37
    v_add_f32 v27, v38, v39
    v_add_f32 v24, v24, v25
    v_add_f32 v26, v26, v27
    v_add_f32 v24, v24, v26
    s_nop 1
    v_add_f32_dpp v24, v24, v24 row_ror:8 row_mask:0xf bank_mask:0xf
    v_mov_b32 v25, v24
    s_nop 1
    v_permlane16_swap_b32 v24, v25
    v_add_f32 v24, v24, v25
    v_mov_b32 v25, v24
    s_nop 1
    v_permlane32_swap_b32 v24, v25
    v_add_f32 v24, v24, v25
    s_mov_b64 exec, 0xff
    ds_write_b32 v9, v24 offset:0
    s_mov_b64 exec, -1
    s_waitcnt lgkmcnt(0)
    s_barrier
    ds_read_b32 v40, v11 offset:0
    ds_read_b32 v41, v11 offset:32
    ds_read_b32 v42, v11 offset:64
    ds_read_b32 v43, v11 offset:96
    ds_read_b32 v44, v11 offset:128
    ds_read_b32 v45, v11 offset:160
    ds_read_b32 v46, v11 offset:192
    ds_read_b32 v47, v11 offset:224
    ds_read_b32 v48, v11 offset:256
    s_waitcnt lgkmcnt(0)
    v_add_f32 v40, v40, v41
    v_add_f32 v42, v42, v43
    v_add_f32 v44, v44, v45
    v_add_f32 v46, v46, v47
    v_add_f32 v40, v40, v42
    v_add_f32 v44, v44, v46
    v_add_f32 v40, v40, v48
    v_add_f32 v24, v40, v44
    v_mul_f32 v24, 0x3ae38e39, v24
    v_sub_f32 v28, v32, v24
    v_sub_f32 v29, v33, v24
    v_mul_f32 v26, v28, v28
    v_mul_f32 v27, v29, v29
    v_sub_f32 v28, v34, v24
    v_sub_f32 v29, v35, v24
    v_fmac_f32 v26, v28, v28
    v_fmac_f32 v27, v29, v29
    v_sub_f32 v28, v36, v24
    v_sub_f32 v29, v37, v24
    v_fmac_f32 v26, v28, v28
    v_fmac_f32 v27, v29, v29
    v_sub_f32 v28, v38, v24
    v_sub_f32 v29, v39, v24
    v_fmac_f32 v26, v28, v28
    v_fmac_f32 v27, v29, v29
    v_add_f32 v26, v26, v27
    v_cvt_pk_bf16_f32 v24, v24, v24
    v_lshlrev_b32 v24, 16, v24
    v_add_f32_dpp v26, v26, v26 row_ror:8 row_mask:0xf bank_mask:0xf
    v_mov_b32 v25, v26
    s_nop 1
    v_permlane16_swap_b32 v26, v25
    v_add_f32 v26, v26, v25
    v_mov_b32 v25, v26
    s_nop 1
    v_permlane32_swap_b32 v26, v25
    v_add_f32 v26, v26, v25
    s_mov_b64 exec, 0xff
    ds_write_b32 v9, v26 offset:320
    s_mov_b64 exec, -1
    s_waitcnt lgkmcnt(0)
    s_barrier
    ds_read_b32 v40, v11 offset:320
    ds_read_b32 v41, v11 offset:352
    ds_read_b32 v42, v11 offset:384
    ds_read_b32 v43, v11 offset:416
    ds_read_b32 v44, v11 offset:448
    ds_read_b32 v45, v11 offset:480
    ds_read_b32 v46, v11 offset:512
    ds_read_b32 v47, v11 offset:544
    ds_read_b32 v48, v11 offset:576
    s_waitcnt lgkmcnt(0)
    v_add_f32 v40, v40, v41
    v_add_f32 v42, v42, v43
    v_add_f32 v44, v44, v45
    v_add_f32 v46, v46, v47
    v_add_f32 v40, v40, v42
    v_add_f32 v44, v44, v46
    v_add_f32 v40, v40, v48
    v_add_f32 v26, v40, v44
    v_mul_f32 v26, 0x3ae38e39, v26
    v_cvt_pk_bf16_f32 v26, v26, v26
    v_lshlrev_b32 v26, 16, v26
    v_add_f32 v26, 0x3727c5ac, v26
    v_cvt_pk_bf16_f32 v26, v26, v26
    v_lshlrev_b32 v26, 16, v26
    v_sqrt_f32 v26, v26
    s_nop 0
    v_cvt_pk_bf16_f32 v26, v26, v26
    v_lshlrev_b32 v26, 16, v26
    v_rcp_f32 v26, v26
    s_mov_b32 s65, 2424832
    v_sub_f32 v28, v32, v24
    v_sub_f32 v29, v33, v24
    v_cvt_pk_bf16_f32 v29, v28, v29
    v_lshlrev_b32 v28, 16, v29
    v_and_b32 v29, 0xffff0000, v29
    v_mul_f32 v28, v28, v26
    v_mul_f32 v29, v29, v26
    v_cvt_pk_bf16_f32 v20, v28, v29
    v_min_u32 v20, -2, v20
    v_sub_f32 v28, v34, v24
    v_sub_f32 v29, v35, v24
    v_cvt_pk_bf16_f32 v29, v28, v29
    v_lshlrev_b32 v28, 16, v29
    v_and_b32 v29, 0xffff0000, v29
    v_mul_f32 v28, v28, v26
    v_mul_f32 v29, v29, v26
    v_cvt_pk_bf16_f32 v21, v28, v29
    v_min_u32 v21, -2, v21
    v_sub_f32 v28, v36, v24
    v_sub_f32 v29, v37, v24
    v_cvt_pk_bf16_f32 v29, v28, v29
    v_lshlrev_b32 v28, 16, v29
    v_and_b32 v29, 0xffff0000, v29
    v_mul_f32 v28, v28, v26
    v_mul_f32 v29, v29, v26
    v_cvt_pk_bf16_f32 v22, v28, v29
    v_min_u32 v22, -2, v22
    v_sub_f32 v28, v38, v24
    v_sub_f32 v29, v39, v24
    v_cvt_pk_bf16_f32 v29, v28, v29
    v_lshlrev_b32 v28, 16, v29
    v_and_b32 v29, 0xffff0000, v29
    v_mul_f32 v28, v28, v26
    v_mul_f32 v29, v29, v26
    v_cvt_pk_bf16_f32 v23, v28, v29
    v_min_u32 v23, -2, v23
    buffer_store_dwordx4 v[20:23], v7, s[40:43], s65 offen sc1
    v_mov_b32 v24, 0
    v_mov_b32 v26, 0
    v_lshlrev_b32 v28, 16, v20
    v_and_b32 v29, 0xffff0000, v20
    v_lshlrev_b32 v30, 16, v16
    v_and_b32 v31, 0xffff0000, v16
    v_fmac_f32 v24, v28, v30
    v_fmac_f32 v26, v29, v31
    v_add_f32 v28, v28, v32
    v_add_f32 v29, v29, v33
    v_cvt_pk_bf16_f32 v16, v28, v29
    v_lshlrev_b32 v28, 16, v21
    v_and_b32 v29, 0xffff0000, v21
    v_lshlrev_b32 v30, 16, v17
    v_and_b32 v31, 0xffff0000, v17
    v_fmac_f32 v24, v28, v30
    v_fmac_f32 v26, v29, v31
    v_add_f32 v28, v28, v34
    v_add_f32 v29, v29, v35
    v_cvt_pk_bf16_f32 v17, v28, v29
    v_lshlrev_b32 v28, 16, v22
    v_and_b32 v29, 0xffff0000, v22
    v_lshlrev_b32 v30, 16, v18
    v_and_b32 v31, 0xffff0000, v18
    v_fmac_f32 v24, v28, v30
    v_fmac_f32 v26, v29, v31
    v_add_f32 v28, v28, v36
    v_add_f32 v29, v29, v37
    v_cvt_pk_bf16_f32 v18, v28, v29
    v_lshlrev_b32 v28, 16, v23
    v_and_b32 v29, 0xffff0000, v23
    v_lshlrev_b32 v30, 16, v19
    v_and_b32 v31, 0xffff0000, v19
    v_fmac_f32 v24, v28, v30
    v_fmac_f32 v26, v29, v31
    v_add_f32 v28, v28, v38
    v_add_f32 v29, v29, v39
    v_cvt_pk_bf16_f32 v19, v28, v29
    v_add_f32 v24, v24, v26
    s_nop 1
    v_add_f32_dpp v24, v24, v24 row_ror:8 row_mask:0xf bank_mask:0xf
    v_mov_b32 v25, v24
    s_nop 1
    v_permlane16_swap_b32 v24, v25
    v_add_f32 v24, v24, v25
    v_mov_b32 v25, v24
    s_nop 1
    v_permlane32_swap_b32 v24, v25
    v_add_f32 v24, v24, v25
    s_mov_b64 exec, 0xff
    ds_write_b32 v9, v24 offset:640
    s_mov_b64 exec, -1
    s_waitcnt lgkmcnt(0)
    s_barrier
    ds_read_b32 v40, v11 offset:640
    ds_read_b32 v41, v11 offset:672
    ds_read_b32 v42, v11 offset:704
    ds_read_b32 v43, v11 offset:736
    ds_read_b32 v44, v11 offset:768
    ds_read_b32 v45, v11 offset:800
    ds_read_b32 v46, v11 offset:832
    ds_read_b32 v47, v11 offset:864
    ds_read_b32 v48, v11 offset:896
    s_waitcnt lgkmcnt(0)
    v_add_f32 v40, v40, v41
    v_add_f32 v42, v42, v43
    v_add_f32 v44, v44, v45
    v_add_f32 v46, v46, v47
    v_add_f32 v40, v40, v42
    v_add_f32 v44, v44, v46
    v_add_f32 v40, v40, v48
    v_add_f32 v24, v40, v44
    s_cmp_lg_u32 s38, 0
    s_cbranch_scc1 L_KEYD
    v_cvt_pk_bf16_f32 v24, v24, v24
    v_and_b32 v24, 0xffff0000, v24
    v_ashrrev_i32 v25, 31, v24
    v_or_b32 v25, 0x80000000, v25
    v_xor_b32 v24, v24, v25
    v_and_b32 v24, 0xffff0000, v24
    v_sub_u32 v25, 0x7ff, v6
    v_or_b32 v24, v24, v25
    s_nop 1
    v_mov_b32_dpp v25, v24 row_shl:1 row_mask:0xf bank_mask:0xf
    v_mov_b32_dpp v26, v24 row_shl:2 row_mask:0xf bank_mask:0xf
    v_mov_b32_dpp v27, v24 row_shl:3 row_mask:0xf bank_mask:0xf
    v_lshlrev_b32 v28, 2, v6
    s_mov_b32 s65, 32768
    s_mov_b64 exec, 0x11
    buffer_store_dwordx4 v[24:27], v28, s[40:43], s65 offen sc1
    s_mov_b64 exec, -1
    s_branch L_KEYD
L_IDLE:
    s_barrier
    s_barrier
    s_barrier
    s_barrier
L_KEYD:
    v_and_b32 v10, 15, v1
    v_lshlrev_b32 v10, 5, v10
    v_add_u32 v10, 141568, v10
    s_cmp_ge_u32 s38, 4
    s_cbranch_scc1 T_S2
    v_lshlrev_b32 v9, 5, v0
    s_mov_b32 s65, 32768
    v_lshrrev_b32 v11, 4, v0
    v_lshlrev_b32 v11, 5, v11
    v_add_u32 v11, 141568, v11
    s_sleep 12
    s_movk_i32 s60, 4000
T_KP:
    buffer_load_dwordx4 v[24:27], v9, s[40:43], s65 offen sc1
    buffer_load_dwordx4 v[28:31], v9, s[40:43], s65 offen offset:16 sc1
    s_waitcnt vmcnt(0)
    v_max3_u32 v44, v24, v25, v26
    v_max3_u32 v45, v27, v28, v29
    v_max3_u32 v44, v44, v30, v31
    v_max_u32 v44, v44, v45
    v_cmp_eq_u32 vcc, -1, v44
    s_nop 0
    s_and_b64 exec, exec, vcc
    s_cbranch_execz T_KP_D
    s_sub_u32 s60, s60, 1
    s_cmp_lg_u32 s60, 0
    s_sleep 1
    s_cbranch_scc1 T_KP
T_KP_D:
    s_mov_b64 exec, -1
    v_max_u32 v40, v24, v25
    v_min_u32 v25, v24, v25
    v_max_u32 v24, v26, v27
    v_min_u32 v27, v26, v27
    v_max_u32 v26, v28, v29
    v_min_u32 v29, v28, v29
    v_max_u32 v28, v30, v31
    v_min_u32 v31, v30, v31
    v_max_u32 v30, v40, v24
    v_min_u32 v24, v40, v24
    v_max_u32 v40, v25, v27
    v_min_u32 v27, v25, v27
    v_max_u32 v25, v26, v28
    v_min_u32 v28, v26, v28
    v_max_u32 v26, v29, v31
    v_min_u32 v31, v29, v31
    v_max_u32 v29, v40, v24
    v_min_u32 v24, v40, v24
    v_max_u32 v40, v26, v28
    v_min_u32 v28, v26, v28
    v_max_u32 v26, v30, v25
    v_min_u32 v25, v30, v25
    v_max_u32 v30, v27, v31
    v_min_u32 v31, v27, v31
    v_max_u32 v27, v29, v40
    v_min_u32 v40, v29, v40
    v_max_u32 v29, v24, v28
    v_min_u32 v28, v24, v28
    v_max_u32 v24, v27, v25
    v_min_u32 v25, v27, v25
    v_max_u32 v27, v30, v28
    v_min_u32 v28, v30, v28
    v_max_u32 v30, v29, v25
    v_min_u32 v25, v29, v25
    v_max_u32 v29, v27, v40
    v_min_u32 v40, v27, v40
    v_max_u32 v27, v29, v25
    v_min_u32 v25, v29, v25
    v_max_u32_dpp v32, v31, v26 quad_perm:[1,0,3,2] row_mask:0xf bank_mask:0xf
    v_max_u32_dpp v33, v28, v24 quad_perm:[1,0,3,2] row_mask:0xf bank_mask:0xf
    v_max_u32_dpp v34, v40, v30 quad_perm:[1,0,3,2] row_mask:0xf bank_mask:0xf
    v_max_u32_dpp v35, v25, v27 quad_perm:[1,0,3,2] row_mask:0xf bank_mask:0xf
    v_max_u32_dpp v36, v27, v25 quad_perm:[1,0,3,2] row_mask:0xf bank_mask:0xf
    v_max_u32_dpp v37, v30, v40 quad_perm:[1,0,3,2] row_mask:0xf bank_mask:0xf
    v_max_u32_dpp v38, v24, v28 quad_perm:[1,0,3,2] row_mask:0xf bank_mask:0xf
    v_max_u32_dpp v39, v26, v31 quad_perm:[1,0,3,2] row_mask:0xf bank_mask:0xf
    v_max_u32 v29, v32, v36
    v_min_u32 v36, v32, v36
    v_max_u32 v32, v33, v37
    v_min_u32 v37, v33, v37
    v_max_u32 v33, v34, v38
    v_min_u32 v38, v34, v38
    v_max_u32 v34, v35, v39
    v_min_u32 v39, v35, v39
    v_max_u32 v35, v29, v33
    v_min_u32 v33, v29, v33
    v_max_u32 v29, v32, v34
    v_min_u32 v34, v32, v34
    v_max_u32 v32, v36, v38
    v_min_u32 v38, v36, v38
    v_max_u32 v36, v37, v39
    v_min_u32 v39, v37, v39
    v_max_u32 v37, v35, v29
    v_min_u32 v29, v35, v29
    v_max_u32 v35, v33, v34
    v_min_u32 v34, v33, v34
    v_max_u32 v33, v32, v36
    v_min_u32 v36, v32, v36
    v_max_u32 v32, v38, v39
    v_min_u32 v39, v38, v39
    s_nop 1
    v_max_u32_dpp v26, v39, v37 quad_perm:[2,3,0,1] row_mask:0xf bank_mask:0xf
    v_max_u32_dpp v24, v32, v29 quad_perm:[2,3,0,1] row_mask:0xf bank_mask:0xf
    v_max_u32_dpp v30, v36, v35 quad_perm:[2,3,0,1] row_mask:0xf bank_mask:0xf
    v_max_u32_dpp v27, v33, v34 quad_perm:[2,3,0,1] row_mask:0xf bank_mask:0xf
    v_max_u32_dpp v25, v34, v33 quad_perm:[2,3,0,1] row_mask:0xf bank_mask:0xf
    v_max_u32_dpp v40, v35, v36 quad_perm:[2,3,0,1] row_mask:0xf bank_mask:0xf
    v_max_u32_dpp v28, v29, v32 quad_perm:[2,3,0,1] row_mask:0xf bank_mask:0xf
    v_max_u32_dpp v31, v37, v39 quad_perm:[2,3,0,1] row_mask:0xf bank_mask:0xf
    v_max_u32 v38, v26, v25
    v_min_u32 v25, v26, v25
    v_max_u32 v26, v24, v40
    v_min_u32 v40, v24, v40
    v_max_u32 v24, v30, v28
    v_min_u32 v28, v30, v28
    v_max_u32 v30, v27, v31
    v_min_u32 v31, v27, v31
    v_max_u32 v27, v38, v24
    v_min_u32 v24, v38, v24
    v_max_u32 v38, v26, v30
    v_min_u32 v30, v26, v30
    v_max_u32 v26, v25, v28
    v_min_u32 v28, v25, v28
    v_max_u32 v25, v40, v31
    v_min_u32 v31, v40, v31
    v_max_u32 v40, v27, v38
    v_min_u32 v38, v27, v38
    v_max_u32 v27, v24, v30
    v_min_u32 v30, v24, v30
    v_max_u32 v24, v26, v25
    v_min_u32 v25, v26, v25
    v_max_u32 v26, v28, v31
    v_min_u32 v31, v28, v31
    s_nop 1
    v_max_u32_dpp v37, v31, v40 row_half_mirror row_mask:0xf bank_mask:0xf
    v_max_u32_dpp v29, v26, v38 row_half_mirror row_mask:0xf bank_mask:0xf
    v_max_u32_dpp v35, v25, v27 row_half_mirror row_mask:0xf bank_mask:0xf
    v_max_u32_dpp v34, v24, v30 row_half_mirror row_mask:0xf bank_mask:0xf
    v_max_u32_dpp v33, v30, v24 row_half_mirror row_mask:0xf bank_mask:0xf
    v_max_u32_dpp v36, v27, v25 row_half_mirror row_mask:0xf bank_mask:0xf
    v_max_u32_dpp v32, v38, v26 row_half_mirror row_mask:0xf bank_mask:0xf
    v_max_u32_dpp v39, v40, v31 row_half_mirror row_mask:0xf bank_mask:0xf
    v_max_u32 v28, v37, v33
    v_min_u32 v33, v37, v33
    v_max_u32 v37, v29, v36
    v_min_u32 v36, v29, v36
    v_max_u32 v29, v35, v32
    v_min_u32 v32, v35, v32
    v_max_u32 v35, v34, v39
    v_min_u32 v39, v34, v39
    v_max_u32 v34, v28, v29
    v_min_u32 v29, v28, v29
    v_max_u32 v28, v37, v35
    v_min_u32 v35, v37, v35
    v_max_u32 v37, v33, v32
    v_min_u32 v32, v33, v32
    v_max_u32 v33, v36, v39
    v_min_u32 v39, v36, v39
    v_max_u32 v36, v34, v28
    v_min_u32 v28, v34, v28
    v_max_u32 v34, v29, v35
    v_min_u32 v35, v29, v35
    v_max_u32 v29, v37, v33
    v_min_u32 v33, v37, v33
    v_max_u32 v37, v32, v39
    v_min_u32 v39, v32, v39
    s_nop 1
    v_max_u32_dpp v40, v39, v36 row_mirror row_mask:0xf bank_mask:0xf
    v_max_u32_dpp v38, v37, v28 row_mirror row_mask:0xf bank_mask:0xf
    v_max_u32_dpp v27, v33, v34 row_mirror row_mask:0xf bank_mask:0xf
    v_max_u32_dpp v30, v29, v35 row_mirror row_mask:0xf bank_mask:0xf
    v_max_u32_dpp v24, v35, v29 row_mirror row_mask:0xf bank_mask:0xf
    v_max_u32_dpp v25, v34, v33 row_mirror row_mask:0xf bank_mask:0xf
    v_max_u32_dpp v26, v28, v37 row_mirror row_mask:0xf bank_mask:0xf
    v_max_u32_dpp v31, v36, v39 row_mirror row_mask:0xf bank_mask:0xf
    v_max_u32 v32, v40, v24
    v_min_u32 v24, v40, v24
    v_max_u32 v40, v38, v25
    v_min_u32 v25, v38, v25
    v_max_u32 v38, v27, v26
    v_min_u32 v26, v27, v26
    v_max_u32 v27, v30, v31
    v_min_u32 v31, v30, v31
    v_max_u32 v30, v32, v38
    v_min_u32 v38, v32, v38
    v_max_u32 v32, v40, v27
    v_min_u32 v27, v40, v27
    v_max_u32 v40, v24, v26
    v_min_u32 v26, v24, v26
    v_max_u32 v24, v25, v31
    v_min_u32 v31, v25, v31
    v_max_u32 v25, v30, v32
    v_min_u32 v32, v30, v32
    v_max_u32 v30, v38, v27
    v_min_u32 v27, v38, v27
    v_max_u32 v38, v40, v24
    v_min_u32 v24, v40, v24
    v_max_u32 v40, v26, v31
    v_min_u32 v31, v26, v31
    v_mov_b32 v44, v25
    v_mov_b32 v45, v32
    v_mov_b32 v46, v30
    v_mov_b32 v47, v27
    v_mov_b32 v48, v38
    v_mov_b32 v49, v24
    v_mov_b32 v50, v40
    v_mov_b32 v51, v31
    s_mov_b32 exec_lo, 0x00010001
    s_mov_b32 exec_hi, 0x00010001
    ds_write_b128 v11, v[44:47]
    ds_write_b128 v11, v[48:51] offset:16
    s_mov_b64 exec, -1
    s_waitcnt lgkmcnt(0)
T_S2:
    s_barrier
    ds_read_b128 v[24:27], v10
    ds_read_b128 v[28:31], v10 offset:16
    s_waitcnt lgkmcnt(0)
    v_max_u32_dpp v32, v31, v24 quad_perm:[1,0,3,2] row_mask:0xf bank_mask:0xf
    v_max_u32_dpp v33, v30, v25 quad_perm:[1,0,3,2] row_mask:0xf bank_mask:0xf
    v_max_u32_dpp v34, v29, v26 quad_perm:[1,0,3,2] row_mask:0xf bank_mask:0xf
    v_max_u32_dpp v35, v28, v27 quad_perm:[1,0,3,2] row_mask:0xf bank_mask:0xf
    v_max_u32_dpp v36, v27, v28 quad_perm:[1,0,3,2] row_mask:0xf bank_mask:0xf
    v_max_u32_dpp v37, v26, v29 quad_perm:[1,0,3,2] row_mask:0xf bank_mask:0xf
    v_max_u32_dpp v38, v25, v30 quad_perm:[1,0,3,2] row_mask:0xf bank_mask:0xf
    v_max_u32_dpp v39, v24, v31 quad_perm:[1,0,3,2] row_mask:0xf bank_mask:0xf
    v_max_u32 v40, v32, v36
    v_min_u32 v36, v32, v36
    v_max_u32 v32, v33, v37
    v_min_u32 v37, v33, v37
    v_max_u32 v33, v34, v38
    v_min_u32 v38, v34, v38
    v_max_u32 v34, v35, v39
    v_min_u32 v39, v35, v39
    v_max_u32 v35, v40, v33
    v_min_u32 v33, v40, v33
    v_max_u32 v40, v32, v34
    v_min_u32 v34, v32, v34
    v_max_u32 v32, v36, v38
    v_min_u32 v38, v36, v38
    v_max_u32 v36, v37, v39
    v_min_u32 v39, v37, v39
    v_max_u32 v37, v35, v40
    v_min_u32 v40, v35, v40
    v_max_u32 v35, v33, v34
    v_min_u32 v34, v33, v34
    v_max_u32 v33, v32, v36
    v_min_u32 v36, v32, v36
    v_max_u32 v32, v38, v39
    v_min_u32 v39, v38, v39
    s_nop 1
    v_max_u32_dpp v24, v39, v37 quad_perm:[2,3,0,1] row_mask:0xf bank_mask:0xf
    v_max_u32_dpp v25, v32, v40 quad_perm:[2,3,0,1] row_mask:0xf bank_mask:0xf
    v_max_u32_dpp v26, v36, v35 quad_perm:[2,3,0,1] row_mask:0xf bank_mask:0xf
    v_max_u32_dpp v27, v33, v34 quad_perm:[2,3,0,1] row_mask:0xf bank_mask:0xf
    v_max_u32_dpp v28, v34, v33 quad_perm:[2,3,0,1] row_mask:0xf bank_mask:0xf
    v_max_u32_dpp v29, v35, v36 quad_perm:[2,3,0,1] row_mask:0xf bank_mask:0xf
    v_max_u32_dpp v30, v40, v32 quad_perm:[2,3,0,1] row_mask:0xf bank_mask:0xf
    v_max_u32_dpp v31, v37, v39 quad_perm:[2,3,0,1] row_mask:0xf bank_mask:0xf
    v_max_u32 v38, v24, v28
    v_min_u32 v28, v24, v28
    v_max_u32 v24, v25, v29
    v_min_u32 v29, v25, v29
    v_max_u32 v25, v26, v30
    v_min_u32 v30, v26, v30
    v_max_u32 v26, v27, v31
    v_min_u32 v31, v27, v31
    v_max_u32 v27, v38, v25
    v_min_u32 v25, v38, v25
    v_max_u32 v38, v24, v26
    v_min_u32 v26, v24, v26
    v_max_u32 v24, v28, v30
    v_min_u32 v30, v28, v30
    v_max_u32 v28, v29, v31
    v_min_u32 v31, v29, v31
    v_max_u32 v29, v27, v38
    v_min_u32 v38, v27, v38
    v_max_u32 v27, v25, v26
    v_min_u32 v26, v25, v26
    v_max_u32 v25, v24, v28
    v_min_u32 v28, v24, v28
    v_max_u32 v24, v30, v31
    v_min_u32 v31, v30, v31
    s_nop 1
    v_max_u32_dpp v37, v31, v29 row_half_mirror row_mask:0xf bank_mask:0xf
    v_max_u32_dpp v40, v24, v38 row_half_mirror row_mask:0xf bank_mask:0xf
    v_max_u32_dpp v35, v28, v27 row_half_mirror row_mask:0xf bank_mask:0xf
    v_max_u32_dpp v34, v25, v26 row_half_mirror row_mask:0xf bank_mask:0xf
    v_max_u32_dpp v33, v26, v25 row_half_mirror row_mask:0xf bank_mask:0xf
    v_max_u32_dpp v36, v27, v28 row_half_mirror row_mask:0xf bank_mask:0xf
    v_max_u32_dpp v32, v38, v24 row_half_mirror row_mask:0xf bank_mask:0xf
    v_max_u32_dpp v39, v29, v31 row_half_mirror row_mask:0xf bank_mask:0xf
    v_max_u32 v30, v37, v33
    v_min_u32 v33, v37, v33
    v_max_u32 v37, v40, v36
    v_min_u32 v36, v40, v36
    v_max_u32 v40, v35, v32
    v_min_u32 v32, v35, v32
    v_max_u32 v35, v34, v39
    v_min_u32 v39, v34, v39
    v_max_u32 v34, v30, v40
    v_min_u32 v40, v30, v40
    v_max_u32 v30, v37, v35
    v_min_u32 v35, v37, v35
    v_max_u32 v37, v33, v32
    v_min_u32 v32, v33, v32
    v_max_u32 v33, v36, v39
    v_min_u32 v39, v36, v39
    v_max_u32 v36, v34, v30
    v_min_u32 v30, v34, v30
    v_max_u32 v34, v40, v35
    v_min_u32 v35, v40, v35
    v_max_u32 v40, v37, v33
    v_min_u32 v33, v37, v33
    v_max_u32 v37, v32, v39
    v_min_u32 v39, v32, v39
    s_nop 1
    v_max_u32_dpp v29, v39, v36 row_mirror row_mask:0xf bank_mask:0xf
    v_max_u32_dpp v38, v37, v30 row_mirror row_mask:0xf bank_mask:0xf
    v_max_u32_dpp v27, v33, v34 row_mirror row_mask:0xf bank_mask:0xf
    v_max_u32_dpp v26, v40, v35 row_mirror row_mask:0xf bank_mask:0xf
    v_max_u32_dpp v25, v35, v40 row_mirror row_mask:0xf bank_mask:0xf
    v_max_u32_dpp v28, v34, v33 row_mirror row_mask:0xf bank_mask:0xf
    v_max_u32_dpp v24, v30, v37 row_mirror row_mask:0xf bank_mask:0xf
    v_max_u32_dpp v31, v36, v39 row_mirror row_mask:0xf bank_mask:0xf
    v_max_u32 v32, v29, v25
    v_min_u32 v25, v29, v25
    v_max_u32 v29, v38, v28
    v_min_u32 v28, v38, v28
    v_max_u32 v38, v27, v24
    v_min_u32 v24, v27, v24
    v_max_u32 v27, v26, v31
    v_min_u32 v31, v26, v31
    v_max_u32 v26, v32, v38
    v_min_u32 v38, v32, v38
    v_max_u32 v32, v29, v27
    v_min_u32 v27, v29, v27
    v_max_u32 v29, v25, v24
    v_min_u32 v24, v25, v24
    v_max_u32 v25, v28, v31
    v_min_u32 v31, v28, v31
    v_max_u32 v28, v26, v32
    v_min_u32 v32, v26, v32
    v_max_u32 v26, v38, v27
    v_min_u32 v27, v38, v27
    v_max_u32 v38, v29, v25
    v_min_u32 v25, v29, v25
    v_max_u32 v29, v24, v31
    v_min_u32 v31, v24, v31
    v_readfirstlane_b32 s44, v28
    v_readfirstlane_b32 s45, v32
    v_readfirstlane_b32 s46, v26
    v_readfirstlane_b32 s47, v27
    v_readfirstlane_b32 s48, v38
    v_readfirstlane_b32 s49, v25
    v_readfirstlane_b32 s50, v29
    v_readfirstlane_b32 s51, v31
    s_cmp_ge_u32 s38, 9
    s_cbranch_scc1 O_DONE
    v_sub_u32 v9, 0x7ff, v6
    v_mov_b32 v10, -1
    s_and_b32 s64, s44, 0x7ff
    v_cmp_eq_u32 vcc, s64, v9
    s_nop 1
    v_cndmask_b32 v10, v10, 0, vcc
    s_and_b32 s64, s45, 0x7ff
    v_cmp_eq_u32 vcc, s64, v9
    s_nop 1
    v_cndmask_b32 v10, v10, 1, vcc
    s_and_b32 s64, s46, 0x7ff
    v_cmp_eq_u32 vcc, s64, v9
    s_nop 1
    v_cndmask_b32 v10, v10, 2, vcc
    s_and_b32 s64, s47, 0x7ff
    v_cmp_eq_u32 vcc, s64, v9
    s_nop 1
    v_cndmask_b32 v10, v10, 3, vcc
    s_and_b32 s64, s48, 0x7ff
    v_cmp_eq_u32 vcc, s64, v9
    s_nop 1
    v_cndmask_b32 v10, v10, 4, vcc
    s_and_b32 s64, s49, 0x7ff
    v_cmp_eq_u32 vcc, s64, v9
    s_nop 1
    v_cndmask_b32 v10, v10, 5, vcc
    s_and_b32 s64, s50, 0x7ff
    v_cmp_eq_u32 vcc, s64, v9
    s_nop 1
    v_cndmask_b32 v10, v10, 6, vcc
    s_and_b32 s64, s51, 0x7ff
    v_cmp_eq_u32 vcc, s64, v9
    s_nop 1
    v_cndmask_b32 v10, v10, 7, vcc
    s_mov_b32 s72, s32
    s_mov_b32 s73, s33
    s_mov_b32 s74, 2359296
    s_mov_b32 s75, 0x00020000
    s_movk_i32 s64, 1152
    v_mul_lo_u32 v11, v10, s64
    v_add_u32 v11, v11, v8
    s_mov_b32 s65, 49152
    v_min_u32 v12, -2, v12
    v_min_u32 v13, -2, v13
    v_min_u32 v14, -2, v14
    v_min_u32 v15, -2, v15
    v_cmp_gt_i32 vcc, 0, v10
    s_nop 0
    s_and_saveexec_b64 s[70:71], vcc
    buffer_store_dwordx4 v[16:19], v7, s[72:75], 0 offen
    s_xor_b64 exec, exec, s[70:71]
    s_cbranch_execz O_NOSEL
    buffer_store_dwordx4 v[12:15], v11, s[40:43], s65 offen sc1
O_NOSEL:
    s_mov_b64 exec, -1
O_DONE:
    s_cmp_lt_u32 s2, 144
    s_cbranch_scc1 FINAL
    s_cmp_lt_u32 s2, 192
    s_cbranch_scc1 END
    s_cmp_ge_u32 s2, 240
    s_cbranch_scc1 END
    v_and_b32 v5, 15, v1
    v_lshrrev_b32 v6, 4, v1
    s_cmp_ge_u32 s38, 9
    s_cbranch_scc1 F_WAITD
    v_mov_b32 v7, s44
    s_mov_b32 s66, 0x02020202
    s_mov_b32 s67, 0x02020202
    v_mov_b32 v8, s45
    v_cndmask_b32 v7, v7, v8, s[66:67]
    s_mov_b32 s66, 0x04040404
    s_mov_b32 s67, 0x04040404
    v_mov_b32 v8, s46
    v_cndmask_b32 v7, v7, v8, s[66:67]
    s_mov_b32 s66, 0x08080808
    s_mov_b32 s67, 0x08080808
    v_mov_b32 v8, s47
    v_cndmask_b32 v7, v7, v8, s[66:67]
    s_mov_b32 s66, 0x10101010
    s_mov_b32 s67, 0x10101010
    v_mov_b32 v8, s48
    v_cndmask_b32 v7, v7, v8, s[66:67]
    s_mov_b32 s66, 0x20202020
    s_mov_b32 s67, 0x20202020
    v_mov_b32 v8, s49
    v_cndmask_b32 v7, v7, v8, s[66:67]
    s_mov_b32 s66, 0x40404040
    s_mov_b32 s67, 0x40404040
    v_mov_b32 v8, s50
    v_cndmask_b32 v7, v7, v8, s[66:67]
    s_mov_b32 s66, 0x80808080
    s_mov_b32 s67, 0x80808080
    v_mov_b32 v8, s51
    v_cndmask_b32 v7, v7, v8, s[66:67]
    v_and_b32 v7, 0x7ff, v7
    v_sub_u32 v7, 0x7ff, v7
    s_movk_i32 s64, 1152
    v_mul_lo_u32 v7, v7, s64
    v_lshl_add_u32 v7, v6, 4, v7
    s_mul_i32 s64, s38, 43
    s_lshr_b32 s64, s64, 7
    s_mul_i32 s65, s64, 3
    s_sub_u32 s65, s38, s65
    s_mul_i32 s65, s65, 384
    s_add_u32 s65, s65, 2424832
    s_movk_i32 s60, 4000
F_ZP:
    buffer_load_dwordx4 v[8:11], v7, s[40:43], s65 offen offset:0 sc1
    buffer_load_dwordx4 v[12:15], v7, s[40:43], s65 offen offset:64 sc1
    buffer_load_dwordx4 v[16:19], v7, s[40:43], s65 offen offset:128 sc1
    buffer_load_dwordx4 v[20:23], v7, s[40:43], s65 offen offset:192 sc1
    buffer_load_dwordx4 v[24:27], v7, s[40:43], s65 offen offset:256 sc1
    buffer_load_dwordx4 v[28:31], v7, s[40:43], s65 offen offset:320 sc1
    s_waitcnt vmcnt(0)
    v_max3_u32 v48, v8, v9, v10
    v_max3_u32 v49, v11, v12, v13
    v_max3_u32 v48, v48, v14, v15
    v_max3_u32 v49, v49, v16, v17
    v_max3_u32 v48, v48, v18, v19
    v_max3_u32 v48, v48, v20, v21
    v_max3_u32 v49, v49, v22, v23
    v_max3_u32 v48, v48, v24, v25
    v_max3_u32 v48, v48, v26, v27
    v_max3_u32 v49, v49, v28, v29
    v_max3_u32 v48, v48, v30, v31
    v_max_u32 v48, v48, v49
    v_cmp_eq_u32 vcc, -1, v48
    s_nop 0
    s_and_b64 exec, exec, vcc
    s_cbranch_execz F_ZP_D
    s_sub_u32 s60, s60, 1
    s_cmp_lg_u32 s60, 0
    s_sleep 1
    s_cbranch_scc1 F_ZP
F_ZP_D:
    s_mov_b64 exec, -1
    v_mfma_f32_16x16x32_bf16 v[32:35], v[56:59], v[8:11], 0
    v_mfma_f32_16x16x32_bf16 v[36:39], v[60:63], v[8:11], 0
    v_mfma_f32_16x16x32_bf16 v[40:43], v[64:67], v[8:11], 0
    v_mfma_f32_16x16x32_bf16 v[44:47], v[68:71], v[8:11], 0
    v_mfma_f32_16x16x32_bf16 v[32:35], v[72:75], v[12:15], v[32:35]
    v_mfma_f32_16x16x32_bf16 v[36:39], v[76:79], v[12:15], v[36:39]
    v_mfma_f32_16x16x32_bf16 v[40:43], v[80:83], v[12:15], v[40:43]
    v_mfma_f32_16x16x32_bf16 v[44:47], v[84:87], v[12:15], v[44:47]
    v_mfma_f32_16x16x32_bf16 v[32:35], v[88:91], v[16:19], v[32:35]
    v_mfma_f32_16x16x32_bf16 v[36:39], v[92:95], v[16:19], v[36:39]
    v_mfma_f32_16x16x32_bf16 v[40:43], v[96:99], v[16:19], v[40:43]
    v_mfma_f32_16x16x32_bf16 v[44:47], v[100:103], v[16:19], v[44:47]
    v_mfma_f32_16x16x32_bf16 v[32:35], v[104:107], v[20:23], v[32:35]
    v_mfma_f32_16x16x32_bf16 v[36:39], v[108:111], v[20:23], v[36:39]
    v_mfma_f32_16x16x32_bf16 v[40:43], v[112:115], v[20:23], v[40:43]
    v_mfma_f32_16x16x32_bf16 v[44:47], v[116:119], v[20:23], v[44:47]
    v_mfma_f32_16x16x32_bf16 v[32:35], v[120:123], v[24:27], v[32:35]
    v_mfma_f32_16x16x32_bf16 v[36:39], v[124:127], v[24:27], v[36:39]
    v_mfma_f32_16x16x32_bf16 v[40:43], v[128:131], v[24:27], v[40:43]
    v_mfma_f32_16x16x32_bf16 v[44:47], v[132:135], v[24:27], v[44:47]
    v_mfma_f32_16x16x32_bf16 v[32:35], v[136:139], v[28:31], v[32:35]
    v_mfma_f32_16x16x32_bf16 v[36:39], v[140:143], v[28:31], v[36:39]
    v_mfma_f32_16x16x32_bf16 v[40:43], v[144:147], v[28:31], v[40:43]
    v_mfma_f32_16x16x32_bf16 v[44:47], v[148:151], v[28:31], v[44:47]
    s_lshl_b32 s66, s38, 11
    s_add_u32 s66, s66, 110592
    v_lshlrev_b32 v7, 7, v6
    v_lshl_add_u32 v7, v5, 4, v7
    v_add_u32 v7, s66, v7
    s_mov_b32 exec_lo, 0x00ff00ff
    s_mov_b32 exec_hi, 0x00ff00ff
    ds_write_b128 v7, v[32:35] offset:0
    ds_write_b128 v7, v[36:39] offset:512
    ds_write_b128 v7, v[40:43] offset:1024
    ds_write_b128 v7, v[44:47] offset:1536
    s_mov_b64 exec, -1
F_WAITD:
    s_lshr_b32 s64, s38, 2
    s_and_b32 s65, s38, 3
    s_mul_i32 s66, s64, 6144
    s_lshl_b32 s67, s65, 9
    s_add_u32 s66, s66, s67
    s_add_u32 s66, s66, 110592
    v_and_b32 v8, 7, v1
    v_bfe_u32 v9, v1, 3, 2
    v_lshrrev_b32 v10, 5, v1
    v_lshlrev_b32 v11, 4, v8
    v_lshl_add_u32 v11, v9, 2, v11
    v_lshl_add_u32 v11, v10, 7, v11
    v_add_u32 v11, s66, v11
    v_mul_u32_u24 v12, 208, v8
    v_lshl_add_u32 v12, v10, 5, v12
    v_lshl_add_u32 v12, v9, 3, v12
    s_lshl_b32 s66, s64, 6
    s_lshl_b32 s67, s65, 1
    s_add_u32 s66, s66, s67
    s_add_u32 s66, s66, 129024
    v_add_u32 v12, s66, v12
    s_waitcnt vmcnt(0) lgkmcnt(0)
    s_barrier
    ds_read_b32 v16, v11 offset:0
    ds_read_b32 v20, v11 offset:256
    ds_read_b32 v17, v11 offset:2048
    ds_read_b32 v21, v11 offset:2304
    ds_read_b32 v18, v11 offset:4096
    ds_read_b32 v22, v11 offset:4352
    v_lshrrev_b32 v13, 2, v5
    v_lshl_add_u32 v13, v6, 2, v13
    v_bfe_u32 v14, v13, 1, 2
    v_lshlrev_b32 v13, 7, v13
    v_and_b32 v15, 3, v5
    v_lshl_add_u32 v13, v15, 3, v13
    s_mul_i32 s66, s38, 12288
    v_add_u32 v13, s66, v13
    v_xor_b32 v15, 0, v14
    v_lshl_add_u32 v24, v15, 5, v13
    v_xor_b32 v15, 1, v14
    v_lshl_add_u32 v25, v15, 5, v13
    v_xor_b32 v15, 2, v14
    v_lshl_add_u32 v26, v15, 5, v13
    v_xor_b32 v15, 3, v14
    v_lshl_add_u32 v27, v15, 5, v13
    v_and_b32 v28, 7, v5
    v_mul_u32_u24 v28, 208, v28
    v_lshl_add_u32 v28, v6, 3, v28
    v_add_u32 v28, 129024, v28
    s_waitcnt lgkmcnt(0)
    v_add_f32 v16, v16, v17
    v_add_f32 v20, v20, v21
    v_add_f32 v16, v16, v18
    v_add_f32 v20, v20, v22
    v_cvt_pk_bf16_f32 v20, v16, v20
    v_lshlrev_b32 v16, 16, v20
    v_and_b32 v20, 0xffff0000, v20
    v_mul_f32 v17, 0xbfb8aa3b, v16
    v_exp_f32 v17, v17
    s_nop 0
    v_add_f32 v17, 1.0, v17
    v_rcp_f32 v17, v17
    s_nop 0
    v_mul_f32 v16, v16, v17
    v_cvt_pk_bf16_f32 v16, v16, v16
    v_lshlrev_b32 v16, 16, v16
    v_mul_f32 v16, v16, v20
    v_cvt_pk_bf16_f32 v16, v16, v16
    ds_write_b16 v12, v16
    s_cmp_ge_u32 s38, 9
    s_cbranch_scc1 F_NOA
    ds_read_b64_tr_b16 v[56:57], v24 offset:0
    ds_read_b64_tr_b16 v[58:59], v24 offset:2048
    ds_read_b64_tr_b16 v[60:61], v25 offset:0
    ds_read_b64_tr_b16 v[62:63], v25 offset:2048
    ds_read_b64_tr_b16 v[64:65], v26 offset:0
    ds_read_b64_tr_b16 v[66:67], v26 offset:2048
    ds_read_b64_tr_b16 v[68:69], v27 offset:0
    ds_read_b64_tr_b16 v[70:71], v27 offset:2048
    ds_read_b64_tr_b16 v[72:73], v24 offset:4096
    ds_read_b64_tr_b16 v[74:75], v24 offset:6144
    ds_read_b64_tr_b16 v[76:77], v25 offset:4096
    ds_read_b64_tr_b16 v[78:79], v25 offset:6144
    ds_read_b64_tr_b16 v[80:81], v26 offset:4096
    ds_read_b64_tr_b16 v[82:83], v26 offset:6144
    ds_read_b64_tr_b16 v[84:85], v27 offset:4096
    ds_read_b64_tr_b16 v[86:87], v27 offset:6144
    ds_read_b64_tr_b16 v[88:89], v24 offset:8192
    ds_read_b64_tr_b16 v[90:91], v24 offset:10240
    ds_read_b64_tr_b16 v[92:93], v25 offset:8192
    ds_read_b64_tr_b16 v[94:95], v25 offset:10240
    ds_read_b64_tr_b16 v[96:97], v26 offset:8192
    ds_read_b64_tr_b16 v[98:99], v26 offset:10240
    ds_read_b64_tr_b16 v[100:101], v27 offset:8192
    ds_read_b64_tr_b16 v[102:103], v27 offset:10240
F_NOA:
    s_waitcnt lgkmcnt(0)
    s_barrier
    s_cmp_ge_u32 s38, 9
    s_cbranch_scc1 END
    ds_read_b64 v[8:9], v28 offset:0
    ds_read_b64 v[10:11], v28 offset:32
    ds_read_b64 v[12:13], v28 offset:64
    ds_read_b64 v[14:15], v28 offset:96
    ds_read_b64 v[16:17], v28 offset:128
    ds_read_b64 v[18:19], v28 offset:160
    v_and_b32 v20, 7, v5
    s_movk_i32 s66, 2304
    v_mul_lo_u32 v20, v20, s66
    v_lshrrev_b32 v21, 3, v5
    v_lshl_add_u32 v20, v21, 6, v20
    v_lshl_add_u32 v20, v6, 4, v20
    s_mul_i32 s66, s53, 18432
    s_lshl_b32 s67, s38, 8
    s_add_u32 s66, s66, s67
    s_add_u32 s66, s66, 4784128
    s_waitcnt lgkmcnt(4)
    v_mfma_f32_16x16x32_bf16 v[32:35], v[56:59], v[8:11], 0
    v_mfma_f32_16x16x32_bf16 v[36:39], v[60:63], v[8:11], 0
    v_mfma_f32_16x16x32_bf16 v[40:43], v[64:67], v[8:11], 0
    v_mfma_f32_16x16x32_bf16 v[44:47], v[68:71], v[8:11], 0
    s_waitcnt lgkmcnt(2)
    v_mfma_f32_16x16x32_bf16 v[32:35], v[72:75], v[12:15], v[32:35]
    v_mfma_f32_16x16x32_bf16 v[36:39], v[76:79], v[12:15], v[36:39]
    v_mfma_f32_16x16x32_bf16 v[40:43], v[80:83], v[12:15], v[40:43]
    v_mfma_f32_16x16x32_bf16 v[44:47], v[84:87], v[12:15], v[44:47]
    s_waitcnt lgkmcnt(0)
    v_mfma_f32_16x16x32_bf16 v[32:35], v[88:91], v[16:19], v[32:35]
    v_mfma_f32_16x16x32_bf16 v[36:39], v[92:95], v[16:19], v[36:39]
    v_mfma_f32_16x16x32_bf16 v[40:43], v[96:99], v[16:19], v[40:43]
    v_mfma_f32_16x16x32_bf16 v[44:47], v[100:103], v[16:19], v[44:47]
    s_nop 5
    v_mov_b32_dpp v32, v36 row_shr:8 row_mask:0xf bank_mask:0xf
    v_mov_b32_dpp v33, v37 row_shr:8 row_mask:0xf bank_mask:0xf
    v_mov_b32_dpp v34, v38 row_shr:8 row_mask:0xf bank_mask:0xf
    v_mov_b32_dpp v35, v39 row_shr:8 row_mask:0xf bank_mask:0xf
    v_min_u32 v32, -2, v32
    v_min_u32 v33, -2, v33
    v_min_u32 v34, -2, v34
    v_min_u32 v35, -2, v35
    buffer_store_dwordx4 v[32:35], v20, s[40:43], s66 offen offset:0 sc1
    v_mov_b32_dpp v40, v44 row_shr:8 row_mask:0xf bank_mask:0xf
    v_mov_b32_dpp v41, v45 row_shr:8 row_mask:0xf bank_mask:0xf
    v_mov_b32_dpp v42, v46 row_shr:8 row_mask:0xf bank_mask:0xf
    v_mov_b32_dpp v43, v47 row_shr:8 row_mask:0xf bank_mask:0xf
    v_min_u32 v40, -2, v40
    v_min_u32 v41, -2, v41
    v_min_u32 v42, -2, v42
    v_min_u32 v43, -2, v43
    buffer_store_dwordx4 v[40:43], v20, s[40:43], s66 offen offset:128 sc1
    s_branch END
FINAL:
    s_cmp_ge_u32 s38, 7
    s_cbranch_scc1 END
    s_mul_i32 s64, s2, 3641
    s_lshr_b32 s64, s64, 16
    s_mul_i32 s65, s64, 18
    s_sub_u32 s65, s2, s65
    s_mov_b32 s66, s44
    s_cmp_eq_u32 s64, 1
    s_cselect_b32 s66, s45, s66
    s_cmp_eq_u32 s64, 2
    s_cselect_b32 s66, s46, s66
    s_cmp_eq_u32 s64, 3
    s_cselect_b32 s66, s47, s66
    s_cmp_eq_u32 s64, 4
    s_cselect_b32 s66, s48, s66
    s_cmp_eq_u32 s64, 5
    s_cselect_b32 s66, s49, s66
    s_cmp_eq_u32 s64, 6
    s_cselect_b32 s66, s50, s66
    s_cmp_eq_u32 s64, 7
    s_cselect_b32 s66, s51, s66
    s_and_b32 s67, s66, 0x7ff
    s_sub_u32 s67, 0x7ff, s67
    s_mul_i32 s67, s67, 1152
    s_lshl_b32 s68, s65, 6
    s_add_u32 s67, s67, s68
    s_cmp_eq_u32 s38, 6
    s_cbranch_scc1 FN_HZ
    v_lshrrev_b32 v4, 3, v0
    s_movk_i32 s68, 18432
    v_mul_lo_u32 v4, v4, s68
    v_and_b32 v5, 7, v0
    v_lshl_add_u32 v4, v5, 4, v4
    s_mul_i32 s68, s64, 2304
    s_lshl_b32 s69, s65, 7
    s_add_u32 s68, s68, s69
    s_add_u32 s68, s68, 4784128
    s_lshl_b32 s69, s38, 7
    s_add_u32 s69, s69, 142080
    v_lshl_add_u32 v6, v5, 4, s69
    s_sleep 20
    s_movk_i32 s60, 4000
FN_PP:
    buffer_load_dwordx4 v[20:23], v4, s[40:43], s68 offen sc1
    s_waitcnt vmcnt(0)
    v_max_u32 v28, v20, v21
    v_max3_u32 v28, v28, v22, v23
    v_cmp_eq_u32 vcc, -1, v28
    s_nop 0
    s_and_b64 exec, exec, vcc
    s_cbranch_execz FN_PP_D
    s_sub_u32 s60, s60, 1
    s_cmp_lg_u32 s60, 0
    s_sleep 1
    s_cbranch_scc1 FN_PP
FN_PP_D:
    s_mov_b64 exec, -1
    v_add_f32_dpp v20, v20, v20 row_ror:8 row_mask:0xf bank_mask:0xf
    v_add_f32_dpp v21, v21, v21 row_ror:8 row_mask:0xf bank_mask:0xf
    v_add_f32_dpp v22, v22, v22 row_ror:8 row_mask:0xf bank_mask:0xf
    v_add_f32_dpp v23, v23, v23 row_ror:8 row_mask:0xf bank_mask:0xf
    v_mov_b32 v24, v20
    v_mov_b32 v25, v21
    v_mov_b32 v26, v22
    v_mov_b32 v27, v23
    v_permlane16_swap_b32 v20, v24
    v_permlane16_swap_b32 v21, v25
    v_permlane16_swap_b32 v22, v26
    v_permlane16_swap_b32 v23, v27
    v_add_f32 v20, v20, v24
    v_add_f32 v21, v21, v25
    v_add_f32 v22, v22, v26
    v_add_f32 v23, v23, v27
    v_mov_b32 v24, v20
    v_mov_b32 v25, v21
    v_mov_b32 v26, v22
    v_mov_b32 v27, v23
    v_permlane32_swap_b32 v20, v24
    v_permlane32_swap_b32 v21, v25
    v_permlane32_swap_b32 v22, v26
    v_permlane32_swap_b32 v23, v27
    v_add_f32 v20, v20, v24
    v_add_f32 v21, v21, v25
    v_add_f32 v22, v22, v26
    v_add_f32 v23, v23, v27
    s_mov_b64 exec, 0xff
    ds_write_b128 v6, v[20:23]
    s_mov_b64 exec, -1
    s_branch FN_B
FN_HZ:
    s_add_u32 s68, s67, 2424832
    s_mul_i32 s69, s64, 1152
    s_lshl_b32 s65, s65, 6
    s_add_u32 s69, s69, s65
    s_add_u32 s69, s69, 49088
    v_mov_b32 v4, s68
    v_mov_b32 v5, s69
    v_cmp_gt_u32 vcc, 4, v1
    s_nop 1
    v_cndmask_b32 v4, v5, v4, vcc
    v_lshl_add_u32 v4, v1, 4, v4
    v_lshlrev_b32 v6, 4, v1
    v_add_u32 v6, 142848, v6
    s_sleep 20
    s_mov_b64 exec, 0xff
    s_movk_i32 s60, 4000
FN_HP:
    buffer_load_dwordx4 v[20:23], v4, s[40:43], 0 offen sc1
    s_waitcnt vmcnt(0)
    v_max_u32 v28, v20, v21
    v_max3_u32 v28, v28, v22, v23
    v_cmp_eq_u32 vcc, -1, v28
    s_nop 0
    s_and_b64 exec, exec, vcc
    s_cbranch_execz FN_HP_D
    s_sub_u32 s60, s60, 1
    s_cmp_lg_u32 s60, 0
    s_sleep 1
    s_cbranch_scc1 FN_HP
FN_HP_D:
    s_mov_b64 exec, 0xff
    ds_write_b128 v6, v[20:23]
    s_mov_b64 exec, -1
FN_B:
    s_waitcnt lgkmcnt(0)
    s_barrier
    s_cmp_lg_u32 s38, 0
    s_cbranch_scc1 END
    v_and_b32 v4, 31, v1
    v_lshlrev_b32 v5, 2, v4
    v_add_u32 v5, 142080, v5
    v_lshlrev_b32 v6, 1, v4
    v_add_u32 v7, 142848, v6
    ds_read_b32 v8, v5 offset:0
    ds_read_b32 v9, v5 offset:128
    ds_read_b32 v10, v5 offset:256
    ds_read_b32 v11, v5 offset:384
    ds_read_b32 v12, v5 offset:512
    ds_read_b32 v13, v5 offset:640
    ds_read_u16 v14, v7
    ds_read_u16 v15, v7 offset:64
    s_and_b32 s66, s66, 0xffff0000
    s_ashr_i32 s68, s66, 31
    s_not_b32 s68, s68
    s_or_b32 s68, s68, 0x80000000
    s_xor_b32 s66, s66, s68
    s_and_b32 s66, s66, 0xffff0000
    v_mov_b32 v16, s66
    v_mul_f32 v16, 0xbfb8aa3b, v16
    v_exp_f32 v16, v16
    s_nop 0
    v_add_f32 v16, 1.0, v16
    v_rcp_f32 v16, v16
    s_nop 0
    v_cvt_pk_bf16_f32 v16, v16, v16
    v_lshlrev_b32 v16, 16, v16
    s_mov_b32 s72, s32
    s_mov_b32 s73, s33
    s_mov_b32 s74, 2359296
    s_mov_b32 s75, 0x00020000
    s_waitcnt lgkmcnt(0)
    v_add_f32 v8, v8, v9
    v_add_f32 v10, v10, v11
    v_add_f32 v12, v12, v13
    v_add_f32 v8, v8, v10
    v_add_f32 v8, v8, v12
    v_cvt_pk_bf16_f32 v8, v8, v8
    v_lshlrev_b32 v8, 16, v8
    v_mul_f32 v8, v8, v16
    v_cvt_pk_bf16_f32 v8, v8, v8
    v_lshlrev_b32 v8, 16, v8
    v_lshlrev_b32 v14, 16, v14
    v_lshlrev_b32 v15, 16, v15
    v_add_f32 v8, v8, v14
    v_cvt_pk_bf16_f32 v8, v8, v8
    v_lshlrev_b32 v8, 16, v8
    v_add_f32 v8, v8, v15
    v_cvt_pk_bf16_f32 v8, v8, v8
    s_mov_b32 exec_hi, 0
    buffer_store_short v8, v6, s[72:75], s67 offen
    s_mov_b64 exec, -1
END:
    s_endpgm
.section .rodata,"a"
.p2align 6
.amdhsa_kernel sequential_preLN__ssm_conv_s4__moe_arch_mod__prompt_kernel
  .amdhsa_next_free_vgpr 168
  .amdhsa_next_free_sgpr 102
  .amdhsa_accum_offset 168
  .amdhsa_group_segment_fixed_size 0
  .amdhsa_kernarg_size 136
  .amdhsa_user_sgpr_count 2
  .amdhsa_user_sgpr_kernarg_segment_ptr 1
  .amdhsa_system_sgpr_workgroup_id_x 1
.end_amdhsa_kernel
```

```asm
; @launch grid=(240,1,1) block=(768,1,1) lds=135168
.amdgcn_target "amdgcn-amd-amdhsa--gfx950"
    .text
    .globl sequential_preLN__ssm_conv_s4__moe_arch_mod__prompt_kernel
    .p2align 8
    .type sequential_preLN__ssm_conv_s4__moe_arch_mod__prompt_kernel,@function
sequential_preLN__ssm_conv_s4__moe_arch_mod__prompt_kernel:
    s_cmp_ge_u32 s2, 240
    s_cbranch_scc1 END
    s_load_dwordx16 s[4:19], s[0:1], 0
    s_load_dwordx16 s[20:35], s[0:1], 64
    s_load_dwordx2 s[36:37], s[0:1], 128
    v_lshrrev_b32 v2, 6, v0
    v_and_b32 v1, 63, v0
    v_readfirstlane_b32 s38, v2
    v_lshlrev_b32 v3, 4, v0
    s_and_b32 s52, s2, 7
    s_mul_i32 s52, s52, 24
    s_lshr_b32 s53, s2, 3
    s_add_u32 s52, s52, s53
    s_and_b32 s54, s2, 7
    s_mul_i32 s54, s54, 6
    s_sub_u32 s53, s53, 24
    s_add_u32 s53, s53, s54
    v_mov_b32 v164, -1
    v_mov_b32 v8, 0
    v_mov_b32 v165, -1
    v_mov_b32 v9, 0
    v_mov_b32 v166, -1
    v_mov_b32 v10, 0
    v_mov_b32 v167, -1
    v_mov_b32 v11, 0
    s_mov_b32 s42, 0x10000000
    s_mov_b32 s43, 0x00020000
    s_cmp_ge_u32 s2, 192
    s_cbranch_scc1 FFN0
    v_add_u32 v12, 131072, v3
    v_cmp_gt_u32 vcc, 4, v0
    s_nop 0
    s_and_saveexec_b64 s[70:71], vcc
    ds_write_b128 v12, v[8:11]
    s_mov_b64 exec, s[70:71]
    v_lshrrev_b32 v12, 5, v0
    s_movk_i32 s54, 4608
    v_mul_lo_u32 v12, v12, s54
    v_and_b32 v13, 31, v0
    v_lshl_add_u32 v12, v13, 4, v12
    v_add_u32 v12, 117760, v12
    v_cmp_gt_u32 vcc, 0x60, v0
    s_nop 0
    s_and_saveexec_b64 s[70:71], vcc
    ds_write_b128 v12, v[8:11]
    s_mov_b64 exec, s[70:71]
    s_lshr_b32 s65, s38, 2
    s_mul_i32 s66, s52, 3
    s_add_u32 s66, s66, s65
    s_and_b32 s67, s38, 1
    s_lshl_b32 s67, s67, 6
    v_add_u32 v14, s67, v1
    s_lshl_b32 s67, s66, 8
    v_lshl_add_u32 v15, v14, 1, s67
    s_lshl_b32 s67, s66, 1
    v_mov_b32 v16, s67
    s_lshl_b32 s64, s2, 4
    s_lshl_b32 s67, s38, 1
    s_add_u32 s64, s64, s67
    v_lshrrev_b32 v2, 5, v1
    v_add_u32 v2, s64, v2
    s_movk_i32 s67, 1152
    v_mul_lo_u32 v2, v2, s67
    v_lshl_add_u32 v2, v13, 2, v2
    v_subrev_u32 v17, 0x100, v0
    s_movk_i32 s67, 4608
    v_mul_lo_u32 v17, v17, s67
    s_mul_i32 s67, s52, 6
    s_and_b32 s67, s67, 0xfffc
    v_add_u32 v17, s67, v17
    s_lshr_b32 s59, s2, 7
    s_lshr_b32 s58, s38, 3
    s_or_b32 s59, s59, s58
    s_lshl_b32 s57, s2, 6
    s_add_u32 s57, s57, 32768
    s_waitcnt lgkmcnt(0)
    global_load_dword v9, v8, s[36:37] offset:0
    s_mov_b32 s40, s36
    s_mov_b32 s41, s37
    global_load_ushort v30, v16, s[18:19]
    global_load_ushort v31, v15, s[6:7]
    global_load_ushort v32, v15, s[8:9]
    global_load_ushort v33, v15, s[10:11]
    global_load_ushort v34, v15, s[12:13]
    global_load_ushort v35, v15, s[14:15]
    global_load_ushort v36, v15, s[16:17]
    global_load_ushort v161, v16, s[20:21]
    s_cmp_lg_u32 s59, 0
    s_cbranch_scc1 P_NOROW
    global_load_dword v60, v2, s[4:5] offset:0
    global_load_dword v61, v2, s[4:5] offset:128
    global_load_dword v62, v2, s[4:5] offset:256
    global_load_dword v63, v2, s[4:5] offset:384
    global_load_dword v64, v2, s[4:5] offset:512
    global_load_dword v65, v2, s[4:5] offset:640
    global_load_dword v66, v2, s[4:5] offset:768
    global_load_dword v67, v2, s[4:5] offset:896
    global_load_dword v68, v2, s[4:5] offset:1024
    s_add_u32 s72, s36, s57
    s_addc_u32 s73, s37, 0
    s_mov_b32 s74, 64
    s_mov_b32 s75, 0x00020000
    buffer_store_dwordx4 v[164:167], v3, s[72:75], 0 offen sc1
P_NOROW:
    v_and_b32 v18, 0xff, v0
    v_lshlrev_b32 v18, 3, v18
    s_mul_i32 s67, s65, 3072
    s_add_u32 s67, s67, 104448
    s_sub_u32 s68, s67, 68096
    v_cmp_gt_u32 vcc, 0x80, v18
    v_add_u32 v26, 0, v18
    v_add_u32 v27, 1, v18
    v_cvt_f32_u32 v28, v26
    v_cvt_f32_u32 v29, v27
    v_cvt_pk_bf16_f32 v28, v28, v29
    v_lshrrev_b32 v29, 16, v28
    v_and_b32 v28, 0xffff, v28
    v_lshl_add_u32 v28, v28, 2, s68
    v_lshl_add_u32 v29, v29, 2, s68
    v_lshl_add_u32 v26, v26, 2, s67
    v_lshl_add_u32 v27, v27, 2, s67
    v_cndmask_b32 v150, v28, v26, vcc
    v_cndmask_b32 v151, v29, v27, vcc
    v_add_u32 v26, 2, v18
    v_add_u32 v27, 3, v18
    v_cvt_f32_u32 v28, v26
    v_cvt_f32_u32 v29, v27
    v_cvt_pk_bf16_f32 v28, v28, v29
    v_lshrrev_b32 v29, 16, v28
    v_and_b32 v28, 0xffff, v28
    v_lshl_add_u32 v28, v28, 2, s68
    v_lshl_add_u32 v29, v29, 2, s68
    v_lshl_add_u32 v26, v26, 2, s67
    v_lshl_add_u32 v27, v27, 2, s67
    v_cndmask_b32 v152, v28, v26, vcc
    v_cndmask_b32 v153, v29, v27, vcc
    v_add_u32 v26, 4, v18
    v_add_u32 v27, 5, v18
    v_cvt_f32_u32 v28, v26
    v_cvt_f32_u32 v29, v27
    v_cvt_pk_bf16_f32 v28, v28, v29
    v_lshrrev_b32 v29, 16, v28
    v_and_b32 v28, 0xffff, v28
    v_lshl_add_u32 v28, v28, 2, s68
    v_lshl_add_u32 v29, v29, 2, s68
    v_lshl_add_u32 v26, v26, 2, s67
    v_lshl_add_u32 v27, v27, 2, s67
    v_cndmask_b32 v154, v28, v26, vcc
    v_cndmask_b32 v155, v29, v27, vcc
    v_add_u32 v26, 6, v18
    v_add_u32 v27, 7, v18
    v_cvt_f32_u32 v28, v26
    v_cvt_f32_u32 v29, v27
    v_cvt_pk_bf16_f32 v28, v28, v29
    v_lshrrev_b32 v29, 16, v28
    v_and_b32 v28, 0xffff, v28
    v_lshl_add_u32 v28, v28, 2, s68
    v_lshl_add_u32 v29, v29, 2, s68
    v_lshl_add_u32 v26, v26, 2, s67
    v_lshl_add_u32 v27, v27, 2, s67
    v_cndmask_b32 v156, v28, v26, vcc
    v_cndmask_b32 v157, v29, v27, vcc
    v_add_u32 v26, 8, v18
    v_add_u32 v27, 9, v18
    v_cvt_f32_u32 v28, v26
    v_cvt_f32_u32 v29, v27
    v_cvt_pk_bf16_f32 v28, v28, v29
    v_lshrrev_b32 v29, 16, v28
    v_and_b32 v28, 0xffff, v28
    v_lshl_add_u32 v28, v28, 2, s68
    v_lshl_add_u32 v29, v29, 2, s68
    v_lshl_add_u32 v26, v26, 2, s67
    v_lshl_add_u32 v27, v27, 2, s67
    v_cndmask_b32 v158, v28, v26, vcc
    v_cndmask_b32 v159, v29, v27, vcc
    v_add_u32 v26, 10, v18
    v_add_u32 v27, 11, v18
    v_cvt_f32_u32 v28, v26
    v_cvt_f32_u32 v29, v27
    v_cvt_pk_bf16_f32 v28, v28, v29
    v_lshrrev_b32 v29, 16, v28
    v_and_b32 v28, 0xffff, v28
    v_lshl_add_u32 v28, v28, 2, s68
    v_lshl_add_u32 v29, v29, 2, s68
    v_lshl_add_u32 v26, v26, 2, s67
    v_lshl_add_u32 v27, v27, 2, s67
    v_cndmask_b32 v160, v28, v26, vcc
    s_barrier
    s_waitcnt vmcnt(0) lgkmcnt(0)
C_W1:
    v_readfirstlane_b32 s39, v9
    s_nop 0
    s_add_u32 s39, s39, 1
    s_cmp_lg_u32 s59, 0
    s_cbranch_scc1 C_KGEN
    v_lshlrev_b32 v70, 16, v60
    v_and_b32 v71, 0xffff0000, v60
    v_lshlrev_b32 v72, 16, v61
    v_and_b32 v73, 0xffff0000, v61
    v_lshlrev_b32 v74, 16, v62
    v_and_b32 v75, 0xffff0000, v62
    v_lshlrev_b32 v76, 16, v63
    v_and_b32 v77, 0xffff0000, v63
    v_lshlrev_b32 v78, 16, v64
    v_and_b32 v79, 0xffff0000, v64
    v_lshlrev_b32 v80, 16, v65
    v_and_b32 v81, 0xffff0000, v65
    v_lshlrev_b32 v82, 16, v66
    v_and_b32 v83, 0xffff0000, v66
    v_lshlrev_b32 v84, 16, v67
    v_and_b32 v85, 0xffff0000, v67
    v_lshlrev_b32 v86, 16, v68
    v_and_b32 v87, 0xffff0000, v68
    v_add_f32 v26, v70, v71
    v_add_f32 v27, v72, v73
    v_add_f32 v26, v26, v74
    v_add_f32 v27, v27, v75
    v_add_f32 v26, v26, v76
    v_add_f32 v27, v27, v77
    v_add_f32 v26, v26, v78
    v_add_f32 v27, v27, v79
    v_add_f32 v26, v26, v80
    v_add_f32 v27, v27, v81
    v_add_f32 v26, v26, v82
    v_add_f32 v27, v27, v83
    v_add_f32 v26, v26, v84
    v_add_f32 v27, v27, v85
    v_add_f32 v26, v26, v86
    v_add_f32 v27, v27, v87
    v_add_f32 v26, v26, v27
    s_nop 1
    v_add_f32_dpp v26, v26, v26 quad_perm:[1,0,3,2] row_mask:0xf bank_mask:0xf
    s_nop 1
    v_add_f32_dpp v26, v26, v26 quad_perm:[2,3,0,1] row_mask:0xf bank_mask:0xf
    s_nop 1
    v_add_f32_dpp v26, v26, v26 row_half_mirror row_mask:0xf bank_mask:0xf
    s_nop 1
    v_add_f32_dpp v26, v26, v26 row_mirror row_mask:0xf bank_mask:0xf
    v_mov_b32 v27, v26
    s_nop 1
    v_permlane16_swap_b32 v26, v27
    v_add_f32 v26, v26, v27
    v_mul_f32 v26, 0x3ae38e39, v26
    v_sub_f32 v70, v70, v26
    v_sub_f32 v71, v71, v26
    v_mul_f32 v27, v70, v70
    v_mul_f32 v28, v71, v71
    v_sub_f32 v72, v72, v26
    v_sub_f32 v73, v73, v26
    v_fmac_f32 v27, v72, v72
    v_fmac_f32 v28, v73, v73
    v_sub_f32 v74, v74, v26
    v_sub_f32 v75, v75, v26
    v_fmac_f32 v27, v74, v74
    v_fmac_f32 v28, v75, v75
    v_sub_f32 v76, v76, v26
    v_sub_f32 v77, v77, v26
    v_fmac_f32 v27, v76, v76
    v_fmac_f32 v28, v77, v77
    v_sub_f32 v78, v78, v26
    v_sub_f32 v79, v79, v26
    v_fmac_f32 v27, v78, v78
    v_fmac_f32 v28, v79, v79
    v_sub_f32 v80, v80, v26
    v_sub_f32 v81, v81, v26
    v_fmac_f32 v27, v80, v80
    v_fmac_f32 v28, v81, v81
    v_sub_f32 v82, v82, v26
    v_sub_f32 v83, v83, v26
    v_fmac_f32 v27, v82, v82
    v_fmac_f32 v28, v83, v83
    v_sub_f32 v84, v84, v26
    v_sub_f32 v85, v85, v26
    v_fmac_f32 v27, v84, v84
    v_fmac_f32 v28, v85, v85
    v_sub_f32 v86, v86, v26
    v_sub_f32 v87, v87, v26
    v_fmac_f32 v27, v86, v86
    v_fmac_f32 v28, v87, v87
    v_add_f32 v27, v27, v28
    s_nop 1
    v_add_f32_dpp v27, v27, v27 quad_perm:[1,0,3,2] row_mask:0xf bank_mask:0xf
    s_nop 1
    v_add_f32_dpp v27, v27, v27 quad_perm:[2,3,0,1] row_mask:0xf bank_mask:0xf
    s_nop 1
    v_add_f32_dpp v27, v27, v27 row_half_mirror row_mask:0xf bank_mask:0xf
    s_nop 1
    v_add_f32_dpp v27, v27, v27 row_mirror row_mask:0xf bank_mask:0xf
    v_mov_b32 v28, v27
    s_nop 1
    v_permlane16_swap_b32 v27, v28
    v_add_f32 v27, v27, v28
    v_mul_f32 v27, 0x3ae38e39, v27
    v_cvt_pk_bf16_f32 v27, v27, v27
    v_lshlrev_b32 v27, 16, v27
    v_add_f32 v27, 0x3727c5ac, v27
    v_cvt_pk_bf16_f32 v27, v27, v27
    v_lshlrev_b32 v27, 16, v27
    v_sqrt_f32 v27, v27
    s_nop 0
    v_cvt_pk_bf16_f32 v27, v27, v27
    v_lshlrev_b32 v27, 16, v27
    v_cvt_pk_bf16_f32 v26, v26, v27
    s_lshl_b32 s67, s38, 4
    s_add_u32 s67, s67, 131200
    v_lshrrev_b32 v28, 5, v1
    v_lshl_add_u32 v28, v28, 3, s67
    v_mov_b32 v27, s39
    v_mov_b32 v29, 1
    v_mov_b32 v37, 131072
    s_mov_b32 exec_lo, 1
    s_mov_b32 exec_hi, 1
    ds_write_b64 v28, v[26:27]
    s_mov_b32 exec_hi, 0
    ds_add_rtn_u32 v29, v37, v29
    s_mov_b64 exec, -1
    v_lshlrev_b32 v28, 4, v1
    v_add_u32 v37, 131200, v28
    s_lshl_b32 s68, s2, 7
    s_add_u32 s68, s68, 4096
    s_waitcnt lgkmcnt(0)
    v_readfirstlane_b32 s67, v29
    s_nop 0
    s_cmp_lg_u32 s67, 7
    s_cbranch_scc1 C_KGEN
    s_mov_b64 exec, 0xff
    ds_read_b128 v[40:43], v37
    s_waitcnt lgkmcnt(0)
    buffer_store_dwordx4 v[40:43], v28, s[40:43], s68 offen sc1
    s_mov_b64 exec, -1
C_KGEN:
    s_cmp_lt_u32 s38, 4
    s_cbranch_scc1 P_NOCOL
    global_load_dwordx2 v[140:141], v17, s[4:5] offset:0 sc1
    global_load_dwordx2 v[142:143], v17, s[4:5] offset:1152 sc1
    global_load_dwordx2 v[144:145], v17, s[4:5] offset:2304 sc1
    global_load_dwordx2 v[146:147], v17, s[4:5] offset:3456 sc1
P_NOCOL:
    s_mov_b32 s62, 0x3e22f983
    s_mov_b32 s63, 0x31dc9c88
    s_mul_i32 s67, s65, 34816
    v_lshl_add_u32 v4, v14, 2, s67
    v_lshlrev_b32 v30, 16, v30
    s_mov_b32 s68, 0x3fb8aa3b
    s_mov_b32 s69, 0x32a57060
    v_mul_f32 v20, s68, v30
    v_fma_f32 v21, v30, s68, -v20
    v_fmac_f32 v21, s69, v30
    v_exp_f32 v20, v20
    v_mul_f32 v21, 0x3f317218, v21
    v_fma_f32 v20, v20, v21, v20
    v_cvt_pk_bf16_f32 v20, v20, v20
    v_lshlrev_b32 v20, 16, v20
    v_lshlrev_b32 v31, 16, v31
    v_lshlrev_b32 v32, 16, v32
    v_lshlrev_b32 v33, 16, v33
    v_lshlrev_b32 v34, 16, v34
    v_lshlrev_b32 v35, 16, v35
    v_lshlrev_b32 v36, 16, v36
    v_mul_f32 v11, v31, v20
    v_mul_f32 v12, v32, v20
    v_mul_f32 v13, v33, v20
    v_mul_f32 v10, v34, v20
    v_mul_f32 v11, s68, v11
    v_mul_f32 v22, v35, v13
    v_mul_f32 v23, v35, v10
    v_fma_f32 v22, -v36, v10, v22
    v_fmac_f32 v23, v36, v13
    s_mov_b32 s61, 0x43000000
    v_mul_f32 v30, s61, v11
    v_exp_f32 v30, v30
    v_mul_f32 v31, s61, v12
    v_mul_f32 v32, s62, v31
    v_fma_f32 v24, v31, s62, -v32
    v_fmac_f32 v24, s63, v31
    v_fract_f32 v32, v32
    v_add_f32 v32, v32, v24
    v_cos_f32 v24, v32
    v_sin_f32 v25, v32
    v_mul_f32 v24, v24, v30
    v_mul_f32 v25, v25, v30
    s_bitcmp1_b32 s38, 1
    s_cbranch_scc1 C_ROLE1
    s_mov_b32 s61, 0x41000000
    v_mul_f32 v30, s61, v11
    v_exp_f32 v30, v30
    v_mul_f32 v31, s61, v12
    v_mul_f32 v32, s62, v31
    v_fma_f32 v26, v31, s62, -v32
    v_fmac_f32 v26, s63, v31
    v_fract_f32 v32, v32
    v_add_f32 v32, v32, v26
    v_cos_f32 v26, v32
    v_sin_f32 v27, v32
    v_mul_f32 v26, v26, v30
    v_mul_f32 v27, v27, v30
    s_mov_b32 s61, 0x44800000
    v_mul_f32 v30, s61, v11
    v_exp_f32 v30, v30
    v_mul_f32 v31, s61, v12
    v_mul_f32 v32, s62, v31
    v_fma_f32 v28, v31, s62, -v32
    v_fmac_f32 v28, s63, v31
    v_fract_f32 v32, v32
    v_add_f32 v32, v32, v28
    v_cos_f32 v28, v32
    v_sin_f32 v29, v32
    v_mul_f32 v28, v28, v30
    v_mul_f32 v29, v29, v30
    v_mul_f32 v34, v22, v28
    v_mul_f32 v35, v22, v29
    v_fma_f32 v34, -v23, v29, v34
    v_fmac_f32 v35, v23, v28
    v_mov_b32 v36, 1.0
    v_mov_b32 v37, 0
    v_cvt_pk_bf16_f32 v40, v36, -v37
    ds_write_b32 v4, v40 offset:26112
    v_cvt_pk_bf16_f32 v41, v26, -v27
    ds_write_b32 v4, v41 offset:26656
    v_cvt_pk_bf16_f32 v42, v34, v35
    ds_write_b32 v4, v42 offset:17408
    v_mov_b32 v44, v26
    v_mov_b32 v45, v27
    v_mul_f32 v36, v26, v44
    v_mul_f32 v37, v26, v45
    v_fma_f32 v36, -v27, v45, v36
    v_fmac_f32 v37, v27, v44
    v_mul_f32 v38, v34, v24
    v_mul_f32 v39, v34, v25
    v_fma_f32 v38, -v35, v25, v38
    v_fmac_f32 v39, v35, v24
    v_cvt_pk_bf16_f32 v40, v36, -v37
    ds_write_b32 v4, v40 offset:27200
    v_cvt_pk_bf16_f32 v41, v38, v39
    ds_write_b32 v4, v41 offset:17952
    v_mul_f32 v26, v36, v44
    v_mul_f32 v27, v36, v45
    v_fma_f32 v26, -v37, v45, v26
    v_fmac_f32 v27, v37, v44
    v_mul_f32 v34, v38, v24
    v_mul_f32 v35, v38, v25
    v_fma_f32 v34, -v39, v25, v34
    v_fmac_f32 v35, v39, v24
    v_cvt_pk_bf16_f32 v40, v26, -v27
    ds_write_b32 v4, v40 offset:27744
    v_cvt_pk_bf16_f32 v41, v34, v35
    ds_write_b32 v4, v41 offset:18496
    v_mul_f32 v36, v26, v44
    v_mul_f32 v37, v26, v45
    v_fma_f32 v36, -v27, v45, v36
    v_fmac_f32 v37, v27, v44
    v_mul_f32 v38, v34, v24
    v_mul_f32 v39, v34, v25
    v_fma_f32 v38, -v35, v25, v38
    v_fmac_f32 v39, v35, v24
    v_cvt_pk_bf16_f32 v40, v36, -v37
    ds_write_b32 v4, v40 offset:28288
    v_cvt_pk_bf16_f32 v41, v38, v39
    ds_write_b32 v4, v41 offset:19040
    v_mul_f32 v26, v36, v44
    v_mul_f32 v27, v36, v45
    v_fma_f32 v26, -v37, v45, v26
    v_fmac_f32 v27, v37, v44
    v_mul_f32 v34, v38, v24
    v_mul_f32 v35, v38, v25
    v_fma_f32 v34, -v39, v25, v34
    v_fmac_f32 v35, v39, v24
    v_cvt_pk_bf16_f32 v40, v26, -v27
    ds_write_b32 v4, v40 offset:28832
    v_cvt_pk_bf16_f32 v41, v34, v35
    ds_write_b32 v4, v41 offset:19584
    v_mul_f32 v36, v26, v44
    v_mul_f32 v37, v26, v45
    v_fma_f32 v36, -v27, v45, v36
    v_fmac_f32 v37, v27, v44
    v_mul_f32 v38, v34, v24
    v_mul_f32 v39, v34, v25
    v_fma_f32 v38, -v35, v25, v38
    v_fmac_f32 v39, v35, v24
    v_cvt_pk_bf16_f32 v40, v36, -v37
    ds_write_b32 v4, v40 offset:29376
    v_cvt_pk_bf16_f32 v41, v38, v39
    ds_write_b32 v4, v41 offset:20128
    v_mul_f32 v26, v36, v44
    v_mul_f32 v27, v36, v45
    v_fma_f32 v26, -v37, v45, v26
    v_fmac_f32 v27, v37, v44
    v_mul_f32 v34, v38, v24
    v_mul_f32 v35, v38, v25
    v_fma_f32 v34, -v39, v25, v34
    v_fmac_f32 v35, v39, v24
    v_cvt_pk_bf16_f32 v40, v26, -v27
    ds_write_b32 v4, v40 offset:29920
    v_cvt_pk_bf16_f32 v41, v34, v35
    ds_write_b32 v4, v41 offset:20672
    v_mul_f32 v36, v26, v44
    v_mul_f32 v37, v26, v45
    v_fma_f32 v36, -v27, v45, v36
    v_fmac_f32 v37, v27, v44
    v_mul_f32 v38, v34, v24
    v_mul_f32 v39, v34, v25
    v_fma_f32 v38, -v35, v25, v38
    v_fmac_f32 v39, v35, v24
    v_cvt_pk_bf16_f32 v40, v36, -v37
    ds_write_b32 v4, v40 offset:30464
    v_cvt_pk_bf16_f32 v41, v38, v39
    ds_write_b32 v4, v41 offset:21216
    v_mul_f32 v26, v36, v44
    v_mul_f32 v27, v36, v45
    v_fma_f32 v26, -v37, v45, v26
    v_fmac_f32 v27, v37, v44
    v_mul_f32 v34, v38, v24
    v_mul_f32 v35, v38, v25
    v_fma_f32 v34, -v39, v25, v34
    v_fmac_f32 v35, v39, v24
    v_cvt_pk_bf16_f32 v40, v26, -v27
    ds_write_b32 v4, v40 offset:31008
    v_cvt_pk_bf16_f32 v41, v34, v35
    ds_write_b32 v4, v41 offset:21760
    v_mul_f32 v36, v26, v44
    v_mul_f32 v37, v26, v45
    v_fma_f32 v36, -v27, v45, v36
    v_fmac_f32 v37, v27, v44
    v_cvt_pk_bf16_f32 v40, v36, -v37
    ds_write_b32 v4, v40 offset:31552
    v_mul_f32 v26, v36, v44
    v_mul_f32 v27, v36, v45
    v_fma_f32 v26, -v37, v45, v26
    v_fmac_f32 v27, v37, v44
    v_cvt_pk_bf16_f32 v40, v26, -v27
    ds_write_b32 v4, v40 offset:32096
    v_mul_f32 v36, v26, v44
    v_mul_f32 v37, v26, v45
    v_fma_f32 v36, -v27, v45, v36
    v_fmac_f32 v37, v27, v44
    v_cvt_pk_bf16_f32 v40, v36, -v37
    ds_write_b32 v4, v40 offset:32640
    v_mul_f32 v26, v36, v44
    v_mul_f32 v27, v36, v45
    v_fma_f32 v26, -v37, v45, v26
    v_fmac_f32 v27, v37, v44
    v_cvt_pk_bf16_f32 v40, v26, -v27
    ds_write_b32 v4, v40 offset:33184
    v_mul_f32 v36, v26, v44
    v_mul_f32 v37, v26, v45
    v_fma_f32 v36, -v27, v45, v36
    v_fmac_f32 v37, v27, v44
    v_cvt_pk_bf16_f32 v40, v36, -v37
    ds_write_b32 v4, v40 offset:33728
    v_mul_f32 v26, v36, v44
    v_mul_f32 v27, v36, v45
    v_fma_f32 v26, -v37, v45, v26
    v_fmac_f32 v27, v37, v44
    v_cvt_pk_bf16_f32 v40, v26, -v27
    ds_write_b32 v4, v40 offset:34272
    s_branch C_MFMA
C_ROLE1:
    s_mov_b32 s61, 0x3f800000
    v_mul_f32 v30, s61, v11
    v_exp_f32 v30, v30
    v_mul_f32 v31, s61, v12
    v_mul_f32 v32, s62, v31
    v_fma_f32 v26, v31, s62, -v32
    v_fmac_f32 v26, s63, v31
    v_fract_f32 v32, v32
    v_add_f32 v32, v32, v26
    v_cos_f32 v26, v32
    v_sin_f32 v27, v32
    v_mul_f32 v26, v26, v30
    v_mul_f32 v27, v27, v30
    s_mov_b32 s61, 0x40000000
    v_mul_f32 v30, s61, v11
    v_exp_f32 v30, v30
    v_mul_f32 v31, s61, v12
    v_mul_f32 v32, s62, v31
    v_fma_f32 v28, v31, s62, -v32
    v_fmac_f32 v28, s63, v31
    v_fract_f32 v32, v32
    v_add_f32 v32, v32, v28
    v_cos_f32 v28, v32
    v_sin_f32 v29, v32
    v_mul_f32 v28, v28, v30
    v_mul_f32 v29, v29, v30
    s_mov_b32 s61, 0x40800000
    v_mul_f32 v30, s61, v11
    v_exp_f32 v30, v30
    v_mul_f32 v31, s61, v12
    v_mul_f32 v32, s62, v31
    v_fma_f32 v44, v31, s62, -v32
    v_fmac_f32 v44, s63, v31
    v_fract_f32 v32, v32
    v_add_f32 v32, v32, v44
    v_cos_f32 v44, v32
    v_sin_f32 v45, v32
    v_mul_f32 v44, v44, v30
    v_mul_f32 v45, v45, v30
    v_mov_b32 v50, v22
    v_mov_b32 v51, v23
    v_mul_f32 v52, v50, v24
    v_mul_f32 v53, v50, v25
    v_fma_f32 v52, -v51, v25, v52
    v_fmac_f32 v53, v51, v24
    v_mul_f32 v54, v52, v24
    v_mul_f32 v55, v52, v25
    v_fma_f32 v54, -v53, v25, v54
    v_fmac_f32 v55, v53, v24
    v_mul_f32 v56, v54, v24
    v_mul_f32 v57, v54, v25
    v_fma_f32 v56, -v55, v25, v56
    v_fmac_f32 v57, v55, v24
    v_mul_f32 v58, v56, v24
    v_mul_f32 v59, v56, v25
    v_fma_f32 v58, -v57, v25, v58
    v_fmac_f32 v59, v57, v24
    v_mul_f32 v60, v58, v24
    v_mul_f32 v61, v58, v25
    v_fma_f32 v60, -v59, v25, v60
    v_fmac_f32 v61, v59, v24
    v_mul_f32 v62, v60, v24
    v_mul_f32 v63, v60, v25
    v_fma_f32 v62, -v61, v25, v62
    v_fmac_f32 v63, v61, v24
    v_mul_f32 v64, v62, v24
    v_mul_f32 v65, v62, v25
    v_fma_f32 v64, -v63, v25, v64
    v_fmac_f32 v65, v63, v24
    v_cvt_pk_bf16_f32 v40, v50, v51
    ds_write_b32 v4, v40 offset:0
    v_cvt_pk_bf16_f32 v41, v52, v53
    ds_write_b32 v4, v41 offset:4352
    v_cvt_pk_bf16_f32 v40, v54, v55
    ds_write_b32 v4, v40 offset:8704
    v_cvt_pk_bf16_f32 v41, v56, v57
    ds_write_b32 v4, v41 offset:10880
    v_cvt_pk_bf16_f32 v40, v58, v59
    ds_write_b32 v4, v40 offset:13056
    v_cvt_pk_bf16_f32 v41, v60, v61
    ds_write_b32 v4, v41 offset:14144
    v_cvt_pk_bf16_f32 v40, v62, v63
    ds_write_b32 v4, v40 offset:15232
    v_cvt_pk_bf16_f32 v41, v64, v65
    ds_write_b32 v4, v41 offset:16320
    v_mul_f32 v34, v58, v44
    v_mul_f32 v35, v58, v45
    v_fma_f32 v34, -v59, v45, v34
    v_fmac_f32 v35, v59, v44
    v_cvt_pk_bf16_f32 v40, v34, v35
    ds_write_b32 v4, v40 offset:13600
    v_mul_f32 v34, v60, v44
    v_mul_f32 v35, v60, v45
    v_fma_f32 v34, -v61, v45, v34
    v_fmac_f32 v35, v61, v44
    v_cvt_pk_bf16_f32 v41, v34, v35
    ds_write_b32 v4, v41 offset:14688
    v_mul_f32 v34, v62, v44
    v_mul_f32 v35, v62, v45
    v_fma_f32 v34, -v63, v45, v34
    v_fmac_f32 v35, v63, v44
    v_cvt_pk_bf16_f32 v40, v34, v35
    ds_write_b32 v4, v40 offset:15776
    v_mul_f32 v34, v64, v44
    v_mul_f32 v35, v64, v45
    v_fma_f32 v34, -v65, v45, v34
    v_fmac_f32 v35, v65, v44
    v_cvt_pk_bf16_f32 v41, v34, v35
    ds_write_b32 v4, v41 offset:16864
    v_mul_f32 v70, v50, v26
    v_mul_f32 v71, v50, v27
    v_fma_f32 v70, -v51, v27, v70
    v_fmac_f32 v71, v51, v26
    v_mul_f32 v72, v52, v26
    v_mul_f32 v73, v52, v27
    v_fma_f32 v72, -v53, v27, v72
    v_fmac_f32 v73, v53, v26
    v_mul_f32 v74, v54, v28
    v_mul_f32 v75, v54, v29
    v_fma_f32 v74, -v55, v29, v74
    v_fmac_f32 v75, v55, v28
    v_mul_f32 v76, v56, v28
    v_mul_f32 v77, v56, v29
    v_fma_f32 v76, -v57, v29, v76
    v_fmac_f32 v77, v57, v28
    v_cvt_pk_bf16_f32 v40, v70, v71
    ds_write_b32 v4, v40 offset:544
    v_cvt_pk_bf16_f32 v41, v72, v73
    ds_write_b32 v4, v41 offset:4896
    v_cvt_pk_bf16_f32 v40, v74, v75
    ds_write_b32 v4, v40 offset:9248
    v_cvt_pk_bf16_f32 v41, v76, v77
    ds_write_b32 v4, v41 offset:11424
    v_mul_f32 v50, v70, v26
    v_mul_f32 v51, v70, v27
    v_fma_f32 v50, -v71, v27, v50
    v_fmac_f32 v51, v71, v26
    v_mul_f32 v52, v72, v26
    v_mul_f32 v53, v72, v27
    v_fma_f32 v52, -v73, v27, v52
    v_fmac_f32 v53, v73, v26
    v_mul_f32 v54, v74, v28
    v_mul_f32 v55, v74, v29
    v_fma_f32 v54, -v75, v29, v54
    v_fmac_f32 v55, v75, v28
    v_mul_f32 v56, v76, v28
    v_mul_f32 v57, v76, v29
    v_fma_f32 v56, -v77, v29, v56
    v_fmac_f32 v57, v77, v28
    v_cvt_pk_bf16_f32 v40, v50, v51
    ds_write_b32 v4, v40 offset:1088
    v_cvt_pk_bf16_f32 v41, v52, v53
    ds_write_b32 v4, v41 offset:5440
    v_cvt_pk_bf16_f32 v40, v54, v55
    ds_write_b32 v4, v40 offset:9792
    v_cvt_pk_bf16_f32 v41, v56, v57
    ds_write_b32 v4, v41 offset:11968
    v_mul_f32 v70, v50, v26
    v_mul_f32 v71, v50, v27
    v_fma_f32 v70, -v51, v27, v70
    v_fmac_f32 v71, v51, v26
    v_mul_f32 v72, v52, v26
    v_mul_f32 v73, v52, v27
    v_fma_f32 v72, -v53, v27, v72
    v_fmac_f32 v73, v53, v26
    v_mul_f32 v74, v54, v28
    v_mul_f32 v75, v54, v29
    v_fma_f32 v74, -v55, v29, v74
    v_fmac_f32 v75, v55, v28
    v_mul_f32 v76, v56, v28
    v_mul_f32 v77, v56, v29
    v_fma_f32 v76, -v57, v29, v76
    v_fmac_f32 v77, v57, v28
    v_cvt_pk_bf16_f32 v40, v70, v71
    ds_write_b32 v4, v40 offset:1632
    v_cvt_pk_bf16_f32 v41, v72, v73
    ds_write_b32 v4, v41 offset:5984
    v_cvt_pk_bf16_f32 v40, v74, v75
    ds_write_b32 v4, v40 offset:10336
    v_cvt_pk_bf16_f32 v41, v76, v77
    ds_write_b32 v4, v41 offset:12512
    v_mul_f32 v50, v70, v26
    v_mul_f32 v51, v70, v27
    v_fma_f32 v50, -v71, v27, v50
    v_fmac_f32 v51, v71, v26
    v_mul_f32 v52, v72, v26
    v_mul_f32 v53, v72, v27
    v_fma_f32 v52, -v73, v27, v52
    v_fmac_f32 v53, v73, v26
    v_cvt_pk_bf16_f32 v40, v50, v51
    ds_write_b32 v4, v40 offset:2176
    v_cvt_pk_bf16_f32 v41, v52, v53
    ds_write_b32 v4, v41 offset:6528
    v_mul_f32 v70, v50, v26
    v_mul_f32 v71, v50, v27
    v_fma_f32 v70, -v51, v27, v70
    v_fmac_f32 v71, v51, v26
    v_mul_f32 v72, v52, v26
    v_mul_f32 v73, v52, v27
    v_fma_f32 v72, -v53, v27, v72
    v_fmac_f32 v73, v53, v26
    v_cvt_pk_bf16_f32 v40, v70, v71
    ds_write_b32 v4, v40 offset:2720
    v_cvt_pk_bf16_f32 v41, v72, v73
    ds_write_b32 v4, v41 offset:7072
    v_mul_f32 v50, v70, v26
    v_mul_f32 v51, v70, v27
    v_fma_f32 v50, -v71, v27, v50
    v_fmac_f32 v51, v71, v26
    v_mul_f32 v52, v72, v26
    v_mul_f32 v53, v72, v27
    v_fma_f32 v52, -v73, v27, v52
    v_fmac_f32 v53, v73, v26
    v_cvt_pk_bf16_f32 v40, v50, v51
    ds_write_b32 v4, v40 offset:3264
    v_cvt_pk_bf16_f32 v41, v52, v53
    ds_write_b32 v4, v41 offset:7616
    v_mul_f32 v70, v50, v26
    v_mul_f32 v71, v50, v27
    v_fma_f32 v70, -v51, v27, v70
    v_fmac_f32 v71, v51, v26
    v_mul_f32 v72, v52, v26
    v_mul_f32 v73, v52, v27
    v_fma_f32 v72, -v53, v27, v72
    v_fmac_f32 v73, v53, v26
    v_cvt_pk_bf16_f32 v40, v70, v71
    ds_write_b32 v4, v40 offset:3808
    v_cvt_pk_bf16_f32 v41, v72, v73
    ds_write_b32 v4, v41 offset:8160
C_MFMA:
    v_and_b32 v5, 15, v0
    v_bfe_u32 v6, v0, 4, 2
    s_movk_i32 s68, 544
    v_mul_lo_u32 v7, v5, s68
    v_lshl_add_u32 v7, v6, 4, v7
    v_add_u32 v7, s67, v7
    s_and_b32 s69, s38, 3
    s_mul_i32 s68, s69, 8704
    v_add_u32 v8, s68, v7
    s_mul_i32 s67, s65, 3072
    s_add_u32 s67, s67, 104448
    s_waitcnt lgkmcnt(0)
    s_barrier
    s_cmp_ge_u32 s69, 3
    s_cbranch_scc1 C_EXPAND
    ds_read_b128 v[16:19], v8 offset:0
    ds_read_b128 v[20:23], v7 offset:26112
    ds_read_b128 v[24:27], v8 offset:64
    ds_read_b128 v[28:31], v7 offset:26176
    ds_read_b128 v[32:35], v8 offset:128
    ds_read_b128 v[36:39], v7 offset:26240
    ds_read_b128 v[40:43], v8 offset:192
    ds_read_b128 v[44:47], v7 offset:26304
    ds_read_b128 v[48:51], v8 offset:256
    ds_read_b128 v[52:55], v7 offset:26368
    ds_read_b128 v[56:59], v8 offset:320
    ds_read_b128 v[60:63], v7 offset:26432
    ds_read_b128 v[64:67], v8 offset:384
    ds_read_b128 v[68:71], v7 offset:26496
    ds_read_b128 v[72:75], v8 offset:448
    ds_read_b128 v[76:79], v7 offset:26560
    v_mov_b32 v12, 0
    v_mov_b32 v13, 0
    v_mov_b32 v14, 0
    v_mov_b32 v15, 0
    s_waitcnt lgkmcnt(14)
    s_nop 0
    v_mfma_f32_16x16x32_bf16 v[12:15], v[16:19], v[20:23], v[12:15]
    s_waitcnt lgkmcnt(12)
    v_mfma_f32_16x16x32_bf16 v[12:15], v[24:27], v[28:31], v[12:15]
    s_waitcnt lgkmcnt(10)
    v_mfma_f32_16x16x32_bf16 v[12:15], v[32:35], v[36:39], v[12:15]
    s_waitcnt lgkmcnt(8)
    v_mfma_f32_16x16x32_bf16 v[12:15], v[40:43], v[44:47], v[12:15]
    s_waitcnt lgkmcnt(6)
    v_mfma_f32_16x16x32_bf16 v[12:15], v[48:51], v[52:55], v[12:15]
    s_waitcnt lgkmcnt(4)
    v_mfma_f32_16x16x32_bf16 v[12:15], v[56:59], v[60:63], v[12:15]
    s_waitcnt lgkmcnt(2)
    v_mfma_f32_16x16x32_bf16 v[12:15], v[64:67], v[68:71], v[12:15]
    s_waitcnt lgkmcnt(0)
    v_mfma_f32_16x16x32_bf16 v[12:15], v[72:75], v[76:79], v[12:15]
    s_cmp_eq_u32 s69, 1
    s_cbranch_scc1 C_T1
    s_cmp_eq_u32 s69, 2
    s_cbranch_scc1 C_T2
    v_and_b32 v9, 1, v6
    v_lshlrev_b32 v9, 4, v9
    v_lshrrev_b32 v10, 1, v6
    v_lshl_add_u32 v9, v10, 9, v9
    v_lshl_add_u32 v9, v5, 5, v9
    v_add_u32 v9, s67, v9
    s_nop 3
    ds_write_b128 v9, v[12:15]
    s_branch C_EXPAND
C_T1:
    v_lshlrev_b32 v9, 8, v6
    v_add_u32 v9, s67, v9
    v_lshl_add_u32 v10, v5, 4, v9
    v_lshl_add_u32 v11, v5, 3, v9
    v_cmp_gt_u32 vcc, 2, v6
    s_nop 1
    v_cndmask_b32 v9, v11, v10, vcc
    v_mov_b32 v10, 0x80
    v_cndmask_b32 v10, v10, 8, vcc
    v_add_u32 v10, v10, v9
    ds_write_b64 v9, v[12:13] offset:1024
    ds_write_b64 v10, v[14:15] offset:1024
    s_branch C_EXPAND
C_T2:
    v_lshlrev_b32 v9, 8, v6
    v_lshl_add_u32 v9, v5, 2, v9
    v_add_u32 v9, s67, v9
    s_nop 5
    ds_write_b32 v9, v12 offset:2048
    ds_write_b32 v9, v13 offset:2112
    ds_write_b32 v9, v14 offset:2176
    ds_write_b32 v9, v15 offset:2240
C_EXPAND:
    v_and_b32 v9, 0xff, v0
    s_mul_i32 s68, s65, 16640
    v_lshl_add_u32 v9, v9, 4, s68
    v_subrev_u32 v17, 0x100, v0
    v_lshlrev_b32 v17, 5, v17
    s_movk_i32 s64, 4096
    s_waitcnt lgkmcnt(0)
    s_barrier
    ds_read_b32 v20, v150
    ds_read_b32 v21, v151
    ds_read_b32 v22, v152
    ds_read_b32 v23, v153
    ds_read_b32 v24, v154
    ds_read_b32 v25, v155
    ds_read_b32 v26, v156
    ds_read_b32 v27, v157
    ds_read_b32 v28, v158
    ds_read_b32 v29, v159
    ds_read_b32 v30, v160
    s_waitcnt lgkmcnt(0)
    v_cvt_pk_bf16_f32 v32, v20, v21
    v_cvt_pk_bf16_f32 v33, v22, v23
    v_cvt_pk_bf16_f32 v34, v24, v25
    v_cvt_pk_bf16_f32 v35, v26, v27
    ds_write_b128 v9, v[32:35] offset:32
    v_cvt_pk_bf16_f32 v40, v21, v22
    v_cvt_pk_bf16_f32 v41, v23, v24
    v_cvt_pk_bf16_f32 v42, v25, v26
    v_cvt_pk_bf16_f32 v43, v27, v28
    ds_write_b128 v9, v[40:43] offset:4192
    v_cvt_pk_bf16_f32 v36, v22, v23
    v_cvt_pk_bf16_f32 v37, v24, v25
    v_cvt_pk_bf16_f32 v38, v26, v27
    v_cvt_pk_bf16_f32 v39, v28, v29
    ds_write_b128 v9, v[36:39] offset:8352
    v_cvt_pk_bf16_f32 v44, v23, v24
    v_cvt_pk_bf16_f32 v45, v25, v26
    v_cvt_pk_bf16_f32 v46, v27, v28
    v_cvt_pk_bf16_f32 v47, v29, v30
    ds_write_b128 v9, v[44:47] offset:12512
    s_and_b32 s69, s38, 3
    s_cmp_lg_u32 s69, 0
    s_cbranch_scc1 C_NOFRONT
    v_mov_b32 v150, 131088
    v_mov_b32 v151, 131088
    v_mov_b32 v152, 131088
    v_mov_b32 v153, 131088
    v_mov_b32 v154, 131088
    v_mov_b32 v155, 131088
    v_mov_b32 v156, 131088
    v_mov_b32 v157, 131088
    v_mov_b32 v158, 131088
    v_mov_b32 v159, 131088
    v_mov_b32 v160, 131088
    s_mov_b64 exec, 2
    v_mov_b32 v158, s67
    v_mov_b32 v159, s67
    v_add_u32 v159, 4, v159
    v_mov_b32 v160, s67
    v_add_u32 v160, 8, v160
    s_mov_b64 exec, 3
    ds_read_b32 v20, v150
    ds_read_b32 v21, v151
    ds_read_b32 v22, v152
    ds_read_b32 v23, v153
    ds_read_b32 v24, v154
    ds_read_b32 v25, v155
    ds_read_b32 v26, v156
    ds_read_b32 v27, v157
    ds_read_b32 v28, v158
    ds_read_b32 v29, v159
    ds_read_b32 v30, v160
    s_waitcnt lgkmcnt(0)
    v_cvt_pk_bf16_f32 v32, v20, v21
    v_cvt_pk_bf16_f32 v33, v22, v23
    v_cvt_pk_bf16_f32 v34, v24, v25
    v_cvt_pk_bf16_f32 v35, v26, v27
    ds_write_b128 v9, v[32:35] offset:0
    v_cvt_pk_bf16_f32 v40, v21, v22
    v_cvt_pk_bf16_f32 v41, v23, v24
    v_cvt_pk_bf16_f32 v42, v25, v26
    v_cvt_pk_bf16_f32 v43, v27, v28
    ds_write_b128 v9, v[40:43] offset:4160
    v_cvt_pk_bf16_f32 v36, v22, v23
    v_cvt_pk_bf16_f32 v37, v24, v25
    v_cvt_pk_bf16_f32 v38, v26, v27
    v_cvt_pk_bf16_f32 v39, v28, v29
    ds_write_b128 v9, v[36:39] offset:8320
    v_cvt_pk_bf16_f32 v44, v23, v24
    v_cvt_pk_bf16_f32 v45, v25, v26
    v_cvt_pk_bf16_f32 v46, v27, v28
    v_cvt_pk_bf16_f32 v47, v29, v30
    ds_write_b128 v9, v[44:47] offset:12480
    s_mov_b64 exec, -1
C_NOFRONT:
    s_cmp_lt_u32 s38, 4
    s_cbranch_scc1 C_NOU
    s_movk_i32 s60, 4000
C_STP:
    buffer_load_dwordx4 v[20:23], v17, s[40:43], s64 offen sc1
    buffer_load_dwordx4 v[24:27], v17, s[40:43], s64 offen offset:16 sc1
    s_waitcnt vmcnt(0)
    v_xor_b32 v28, s39, v21
    v_xor_b32 v29, s39, v23
    v_xor_b32 v30, s39, v25
    v_xor_b32 v31, s39, v27
    v_or3_b32 v28, v28, v29, v30
    v_or_b32 v28, v28, v31
    v_cmp_ne_u32 vcc, 0, v28
    s_nop 0
    s_and_b64 exec, exec, vcc
    s_cbranch_execz C_STP_D
    s_sub_u32 s60, s60, 1
    s_cmp_gt_i32 s60, 0
    s_sleep 1
    s_cbranch_scc1 C_STP
C_STP_D:
    s_mov_b64 exec, -1
    s_bitcmp1_b32 s52, 0
    s_cselect_b32 s68, 16, 0
    v_alignbit_b32 v32, v141, v140, s68
    v_lshrrev_b32 v36, s68, v141
    v_and_b32 v21, 0xffff0000, v20
    v_lshlrev_b32 v20, 16, v20
    v_rcp_f32 v21, v21
    v_alignbit_b32 v33, v143, v142, s68
    v_lshrrev_b32 v37, s68, v143
    v_and_b32 v23, 0xffff0000, v22
    v_lshlrev_b32 v22, 16, v22
    v_rcp_f32 v23, v23
    v_alignbit_b32 v34, v145, v144, s68
    v_lshrrev_b32 v38, s68, v145
    v_and_b32 v25, 0xffff0000, v24
    v_lshlrev_b32 v24, 16, v24
    v_rcp_f32 v25, v25
    v_alignbit_b32 v35, v147, v146, s68
    v_lshrrev_b32 v39, s68, v147
    v_and_b32 v27, 0xffff0000, v26
    v_lshlrev_b32 v26, 16, v26
    v_rcp_f32 v27, v27
    v_lshlrev_b32 v40, 16, v32
    v_and_b32 v44, 0xffff0000, v32
    v_lshlrev_b32 v48, 16, v36
    v_sub_f32 v40, v40, v20
    v_sub_f32 v44, v44, v20
    v_sub_f32 v48, v48, v20
    v_lshlrev_b32 v41, 16, v33
    v_and_b32 v45, 0xffff0000, v33
    v_lshlrev_b32 v49, 16, v37
    v_sub_f32 v41, v41, v22
    v_sub_f32 v45, v45, v22
    v_sub_f32 v49, v49, v22
    v_lshlrev_b32 v42, 16, v34
    v_and_b32 v46, 0xffff0000, v34
    v_lshlrev_b32 v50, 16, v38
    v_sub_f32 v42, v42, v24
    v_sub_f32 v46, v46, v24
    v_sub_f32 v50, v50, v24
    v_lshlrev_b32 v43, 16, v35
    v_and_b32 v47, 0xffff0000, v35
    v_lshlrev_b32 v51, 16, v39
    v_sub_f32 v43, v43, v26
    v_sub_f32 v47, v47, v26
    v_sub_f32 v51, v51, v26
    v_cvt_pk_bf16_f32 v41, v40, v41
    v_lshlrev_b32 v40, 16, v41
    v_and_b32 v41, 0xffff0000, v41
    v_mul_f32 v40, v40, v21
    v_mul_f32 v41, v41, v23
    v_cvt_pk_bf16_f32 v43, v42, v43
    v_lshlrev_b32 v42, 16, v43
    v_and_b32 v43, 0xffff0000, v43
    v_mul_f32 v42, v42, v25
    v_mul_f32 v43, v43, v27
    v_cvt_pk_bf16_f32 v45, v44, v45
    v_lshlrev_b32 v44, 16, v45
    v_and_b32 v45, 0xffff0000, v45
    v_mul_f32 v44, v44, v21
    v_mul_f32 v45, v45, v23
    v_cvt_pk_bf16_f32 v47, v46, v47
    v_lshlrev_b32 v46, 16, v47
    v_and_b32 v47, 0xffff0000, v47
    v_mul_f32 v46, v46, v25
    v_mul_f32 v47, v47, v27
    v_cvt_pk_bf16_f32 v49, v48, v49
    v_lshlrev_b32 v48, 16, v49
    v_and_b32 v49, 0xffff0000, v49
    v_mul_f32 v48, v48, v21
    v_mul_f32 v49, v49, v23
    v_cvt_pk_bf16_f32 v51, v50, v51
    v_lshlrev_b32 v50, 16, v51
    v_and_b32 v51, 0xffff0000, v51
    v_mul_f32 v50, v50, v25
    v_mul_f32 v51, v51, v27
    v_lshrrev_b32 v17, 2, v17
    v_sub_u32 v17, 117752, v17
    v_cvt_pk_bf16_f32 v32, v43, v42
    v_cvt_pk_bf16_f32 v33, v41, v40
    ds_write_b64 v17, v[32:33] offset:0
    v_cvt_pk_bf16_f32 v34, v47, v46
    v_cvt_pk_bf16_f32 v35, v45, v44
    ds_write_b64 v17, v[34:35] offset:4608
    v_cvt_pk_bf16_f32 v36, v51, v50
    v_cvt_pk_bf16_f32 v37, v49, v48
    ds_write_b64 v17, v[36:37] offset:9216
C_NOU:
    v_add_u32 v7, 1, v5
    v_and_b32 v8, 3, v7
    v_sub_u32 v7, v7, v8
    v_lshl_add_u32 v7, v6, 3, v7
    v_lshlrev_b32 v7, 1, v7
    s_movk_i32 s68, 4160
    v_mul_lo_u32 v8, v8, s68
    v_add_u32 v7, v7, v8
    s_and_b32 s69, s38, 1
    s_lshl_b32 s69, s69, 8
    s_mul_i32 s68, s65, 16640
    s_add_u32 s68, s68, s69
    v_add_u32 v7, s68, v7
    v_lshlrev_b32 v8, 5, v5
    v_sub_u32 v8, 480, v8
    v_lshl_add_u32 v8, v6, 4, v8
    s_mul_i32 s64, s65, 4608
    s_add_u32 s64, s64, 113664
    s_add_u32 s68, s64, s69
    v_add_u32 v8, s68, v8
    v_mov_b32 v144, 0
    v_mov_b32 v145, 0
    v_mov_b32 v146, 0
    v_mov_b32 v147, 0
    v_mov_b32 v148, 0
    v_mov_b32 v149, 0
    v_mov_b32 v150, 0
    v_mov_b32 v151, 0
    v_mov_b32 v152, 0
    v_mov_b32 v153, 0
    v_mov_b32 v154, 0
    v_mov_b32 v155, 0
    v_mov_b32 v156, 0
    v_mov_b32 v157, 0
    v_mov_b32 v158, 0
    v_mov_b32 v159, 0
    s_waitcnt lgkmcnt(0)
    s_barrier
    s_mul_i32 s54, s52, 12288
    s_add_u32 s54, s54, 65536
    buffer_store_dwordx4 v[164:167], v3, s[40:43], s54 offen sc1
    s_cmp_ge_u32 s2, 128
    s_cbranch_scc1 C_NOZP
    s_mul_i32 s56, s2, 18432
    s_add_u32 s56, s56, 2424832
    s_add_u32 s72, s36, s56
    s_addc_u32 s73, s37, 0
    s_mov_b32 s74, 18432
    s_mov_b32 s75, 0x00020000
    s_movk_i32 s56, 12288
    buffer_store_dwordx4 v[164:167], v3, s[72:75], 0 offen sc1
    buffer_store_dwordx4 v[164:167], v3, s[72:75], s56 offen sc1
    s_cmp_ge_u32 s2, 8
    s_cbranch_scc1 C_NOZP
    s_mul_i32 s56, s2, 1152
    s_add_u32 s56, s56, 49152
    s_add_u32 s72, s36, s56
    s_addc_u32 s73, s37, 0
    s_mov_b32 s74, 1152
    s_mov_b32 s75, 0x00020000
    buffer_store_dwordx4 v[164:167], v3, s[72:75], 0 offen sc1
C_NOZP:
    s_bitcmp1_b32 s38, 1
    s_cbranch_scc1 C_JS1
    ds_read_b64 v[16:17], v7 offset:0
    ds_read_b64 v[18:19], v7 offset:8
    ds_read_b128 v[48:51], v8 offset:3584
    ds_read_b64 v[20:21], v7 offset:512
    ds_read_b64 v[22:23], v7 offset:520
    ds_read_b128 v[52:55], v8 offset:3072
    ds_read_b64 v[24:25], v7 offset:1024
    ds_read_b64 v[26:27], v7 offset:1032
    ds_read_b128 v[56:59], v8 offset:2560
    ds_read_b64 v[28:29], v7 offset:1536
    ds_read_b64 v[30:31], v7 offset:1544
    ds_read_b128 v[60:63], v8 offset:2048
    ds_read_b64 v[32:33], v7 offset:2048
    ds_read_b64 v[34:35], v7 offset:2056
    ds_read_b128 v[64:67], v8 offset:1536
    ds_read_b64 v[36:37], v7 offset:2560
    ds_read_b64 v[38:39], v7 offset:2568
    ds_read_b128 v[68:71], v8 offset:1024
    ds_read_b64 v[40:41], v7 offset:3072
    ds_read_b64 v[42:43], v7 offset:3080
    ds_read_b128 v[72:75], v8 offset:512
    ds_read_b64 v[44:45], v7 offset:3584
    ds_read_b64 v[46:47], v7 offset:3592
    ds_read_b128 v[76:79], v8 offset:0
    s_waitcnt lgkmcnt(15)
    v_mfma_f32_16x16x32_bf16 v[156:159], v[16:19], v[48:51], v[156:159]
    s_waitcnt lgkmcnt(15)
    v_mfma_f32_16x16x32_bf16 v[152:155], v[16:19], v[52:55], v[152:155]
    v_mfma_f32_16x16x32_bf16 v[152:155], v[20:23], v[48:51], v[152:155]
    s_waitcnt lgkmcnt(12)
    v_mfma_f32_16x16x32_bf16 v[148:151], v[28:31], v[60:63], v[148:151]
    s_waitcnt lgkmcnt(9)
    v_mfma_f32_16x16x32_bf16 v[148:151], v[24:27], v[64:67], v[148:151]
    v_mfma_f32_16x16x32_bf16 v[144:147], v[28:31], v[64:67], v[144:147]
    v_mfma_f32_16x16x32_bf16 v[148:151], v[32:35], v[56:59], v[148:151]
    v_mfma_f32_16x16x32_bf16 v[144:147], v[32:35], v[60:63], v[144:147]
    s_waitcnt lgkmcnt(6)
    v_mfma_f32_16x16x32_bf16 v[148:151], v[20:23], v[68:71], v[148:151]
    v_mfma_f32_16x16x32_bf16 v[144:147], v[24:27], v[68:71], v[144:147]
    v_mfma_f32_16x16x32_bf16 v[148:151], v[36:39], v[52:55], v[148:151]
    v_mfma_f32_16x16x32_bf16 v[144:147], v[36:39], v[56:59], v[144:147]
    s_waitcnt lgkmcnt(3)
    v_mfma_f32_16x16x32_bf16 v[148:151], v[16:19], v[72:75], v[148:151]
    v_mfma_f32_16x16x32_bf16 v[144:147], v[20:23], v[72:75], v[144:147]
    v_mfma_f32_16x16x32_bf16 v[148:151], v[40:43], v[48:51], v[148:151]
    v_mfma_f32_16x16x32_bf16 v[144:147], v[40:43], v[52:55], v[144:147]
    s_waitcnt lgkmcnt(0)
    v_mfma_f32_16x16x32_bf16 v[144:147], v[16:19], v[76:79], v[144:147]
    ds_read_b64 v[80:81], v7 offset:64
    ds_read_b64 v[82:83], v7 offset:72
    ds_read_b128 v[112:115], v8 offset:3648
    v_mfma_f32_16x16x32_bf16 v[144:147], v[44:47], v[48:51], v[144:147]
    ds_read_b64 v[84:85], v7 offset:576
    ds_read_b64 v[86:87], v7 offset:584
    ds_read_b128 v[116:119], v8 offset:3136
    ds_read_b64 v[88:89], v7 offset:1088
    ds_read_b64 v[90:91], v7 offset:1096
    ds_read_b128 v[120:123], v8 offset:2624
    ds_read_b64 v[92:93], v7 offset:1600
    ds_read_b64 v[94:95], v7 offset:1608
    ds_read_b128 v[124:127], v8 offset:2112
    ds_read_b64 v[96:97], v7 offset:2112
    ds_read_b64 v[98:99], v7 offset:2120
    ds_read_b128 v[128:131], v8 offset:1600
    ds_read_b64 v[100:101], v7 offset:2624
    ds_read_b64 v[102:103], v7 offset:2632
    ds_read_b128 v[132:135], v8 offset:1088
    ds_read_b64 v[104:105], v7 offset:3136
    ds_read_b64 v[106:107], v7 offset:3144
    ds_read_b128 v[136:139], v8 offset:576
    ds_read_b64 v[108:109], v7 offset:3648
    ds_read_b64 v[110:111], v7 offset:3656
    ds_read_b128 v[140:143], v8 offset:64
    s_waitcnt lgkmcnt(0)
    v_mfma_f32_16x16x32_bf16 v[156:159], v[80:83], v[112:115], v[156:159]
    ds_read_b64 v[16:17], v7 offset:128
    ds_read_b64 v[18:19], v7 offset:136
    v_mfma_f32_16x16x32_bf16 v[152:155], v[80:83], v[116:119], v[152:155]
    ds_read_b128 v[48:51], v8 offset:3712
    ds_read_b64 v[20:21], v7 offset:640
    v_mfma_f32_16x16x32_bf16 v[152:155], v[84:87], v[112:115], v[152:155]
    ds_read_b64 v[22:23], v7 offset:648
    ds_read_b128 v[52:55], v8 offset:3200
    v_mfma_f32_16x16x32_bf16 v[148:151], v[92:95], v[124:127], v[148:151]
    ds_read_b64 v[24:25], v7 offset:1152
    ds_read_b64 v[26:27], v7 offset:1160
    v_mfma_f32_16x16x32_bf16 v[148:151], v[88:91], v[128:131], v[148:151]
    ds_read_b128 v[56:59], v8 offset:2688
    ds_read_b64 v[28:29], v7 offset:1664
    v_mfma_f32_16x16x32_bf16 v[144:147], v[92:95], v[128:131], v[144:147]
    ds_read_b64 v[30:31], v7 offset:1672
    ds_read_b128 v[60:63], v8 offset:2176
    v_mfma_f32_16x16x32_bf16 v[148:151], v[96:99], v[120:123], v[148:151]
    ds_read_b64 v[32:33], v7 offset:2176
    ds_read_b64 v[34:35], v7 offset:2184
    v_mfma_f32_16x16x32_bf16 v[144:147], v[96:99], v[124:127], v[144:147]
    ds_read_b128 v[64:67], v8 offset:1664
    ds_read_b64 v[36:37], v7 offset:2688
    v_mfma_f32_16x16x32_bf16 v[148:151], v[84:87], v[132:135], v[148:151]
    ds_read_b64 v[38:39], v7 offset:2696
    ds_read_b128 v[68:71], v8 offset:1152
    v_mfma_f32_16x16x32_bf16 v[144:147], v[88:91], v[132:135], v[144:147]
    ds_read_b64 v[40:41], v7 offset:3200
    ds_read_b64 v[42:43], v7 offset:3208
    v_mfma_f32_16x16x32_bf16 v[148:151], v[100:103], v[116:119], v[148:151]
    ds_read_b128 v[72:75], v8 offset:640
    ds_read_b64 v[44:45], v7 offset:3712
    v_mfma_f32_16x16x32_bf16 v[144:147], v[100:103], v[120:123], v[144:147]
    ds_read_b64 v[46:47], v7 offset:3720
    ds_read_b128 v[76:79], v8 offset:128
    v_mfma_f32_16x16x32_bf16 v[148:151], v[80:83], v[136:139], v[148:151]
    v_mfma_f32_16x16x32_bf16 v[144:147], v[84:87], v[136:139], v[144:147]
    v_mfma_f32_16x16x32_bf16 v[148:151], v[104:107], v[112:115], v[148:151]
    v_mfma_f32_16x16x32_bf16 v[144:147], v[104:107], v[116:119], v[144:147]
    v_mfma_f32_16x16x32_bf16 v[144:147], v[80:83], v[140:143], v[144:147]
    v_mfma_f32_16x16x32_bf16 v[144:147], v[108:111], v[112:115], v[144:147]
    s_waitcnt lgkmcnt(0)
    v_mfma_f32_16x16x32_bf16 v[156:159], v[16:19], v[48:51], v[156:159]
    ds_read_b64 v[80:81], v7 offset:192
    ds_read_b64 v[82:83], v7 offset:200
    v_mfma_f32_16x16x32_bf16 v[152:155], v[16:19], v[52:55], v[152:155]
    ds_read_b128 v[112:115], v8 offset:3776
    ds_read_b64 v[84:85], v7 offset:704
    v_mfma_f32_16x16x32_bf16 v[152:155], v[20:23], v[48:51], v[152:155]
    ds_read_b64 v[86:87], v7 offset:712
    ds_read_b128 v[116:119], v8 offset:3264
    v_mfma_f32_16x16x32_bf16 v[148:151], v[28:31], v[60:63], v[148:151]
    ds_read_b64 v[88:89], v7 offset:1216
    ds_read_b64 v[90:91], v7 offset:1224
    v_mfma_f32_16x16x32_bf16 v[148:151], v[24:27], v[64:67], v[148:151]
    ds_read_b128 v[120:123], v8 offset:2752
    ds_read_b64 v[92:93], v7 offset:1728
    v_mfma_f32_16x16x32_bf16 v[144:147], v[28:31], v[64:67], v[144:147]
    ds_read_b64 v[94:95], v7 offset:1736
    ds_read_b128 v[124:127], v8 offset:2240
    v_mfma_f32_16x16x32_bf16 v[148:151], v[32:35], v[56:59], v[148:151]
    ds_read_b64 v[96:97], v7 offset:2240
    ds_read_b64 v[98:99], v7 offset:2248
    v_mfma_f32_16x16x32_bf16 v[144:147], v[32:35], v[60:63], v[144:147]
    ds_read_b128 v[128:131], v8 offset:1728
    ds_read_b64 v[100:101], v7 offset:2752
    v_mfma_f32_16x16x32_bf16 v[148:151], v[20:23], v[68:71], v[148:151]
    ds_read_b64 v[102:103], v7 offset:2760
    ds_read_b128 v[132:135], v8 offset:1216
    v_mfma_f32_16x16x32_bf16 v[144:147], v[24:27], v[68:71], v[144:147]
    ds_read_b64 v[104:105], v7 offset:3264
    ds_read_b64 v[106:107], v7 offset:3272
    v_mfma_f32_16x16x32_bf16 v[148:151], v[36:39], v[52:55], v[148:151]
    ds_read_b128 v[136:139], v8 offset:704
    ds_read_b64 v[108:109], v7 offset:3776
    v_mfma_f32_16x16x32_bf16 v[144:147], v[36:39], v[56:59], v[144:147]
    ds_read_b64 v[110:111], v7 offset:3784
    ds_read_b128 v[140:143], v8 offset:192
    v_mfma_f32_16x16x32_bf16 v[148:151], v[16:19], v[72:75], v[148:151]
    v_mfma_f32_16x16x32_bf16 v[144:147], v[20:23], v[72:75], v[144:147]
    v_mfma_f32_16x16x32_bf16 v[148:151], v[40:43], v[48:51], v[148:151]
    v_mfma_f32_16x16x32_bf16 v[144:147], v[40:43], v[52:55], v[144:147]
    v_mfma_f32_16x16x32_bf16 v[144:147], v[16:19], v[76:79], v[144:147]
    v_mfma_f32_16x16x32_bf16 v[144:147], v[44:47], v[48:51], v[144:147]
    s_waitcnt lgkmcnt(0)
    v_mfma_f32_16x16x32_bf16 v[156:159], v[80:83], v[112:115], v[156:159]
    v_mfma_f32_16x16x32_bf16 v[152:155], v[80:83], v[116:119], v[152:155]
    v_mfma_f32_16x16x32_bf16 v[152:155], v[84:87], v[112:115], v[152:155]
    v_mfma_f32_16x16x32_bf16 v[148:151], v[92:95], v[124:127], v[148:151]
    v_mfma_f32_16x16x32_bf16 v[148:151], v[88:91], v[128:131], v[148:151]
    v_mfma_f32_16x16x32_bf16 v[144:147], v[92:95], v[128:131], v[144:147]
    v_mfma_f32_16x16x32_bf16 v[148:151], v[96:99], v[120:123], v[148:151]
    v_mfma_f32_16x16x32_bf16 v[144:147], v[96:99], v[124:127], v[144:147]
    v_mfma_f32_16x16x32_bf16 v[148:151], v[84:87], v[132:135], v[148:151]
    v_mfma_f32_16x16x32_bf16 v[144:147], v[88:91], v[132:135], v[144:147]
    v_mfma_f32_16x16x32_bf16 v[148:151], v[100:103], v[116:119], v[148:151]
    v_mfma_f32_16x16x32_bf16 v[144:147], v[100:103], v[120:123], v[144:147]
    v_mfma_f32_16x16x32_bf16 v[148:151], v[80:83], v[136:139], v[148:151]
    v_mfma_f32_16x16x32_bf16 v[144:147], v[84:87], v[136:139], v[144:147]
    v_mfma_f32_16x16x32_bf16 v[148:151], v[104:107], v[112:115], v[148:151]
    v_mfma_f32_16x16x32_bf16 v[144:147], v[104:107], v[116:119], v[144:147]
    v_mfma_f32_16x16x32_bf16 v[144:147], v[80:83], v[140:143], v[144:147]
    v_mfma_f32_16x16x32_bf16 v[144:147], v[108:111], v[112:115], v[144:147]
    s_bitcmp1_b32 s38, 0
    s_cselect_b32 s66, 1, 7
    s_cselect_b32 s67, 0, 6
    s_branch C_RED
C_JS1:
    ds_read_b64 v[16:17], v7 offset:0
    ds_read_b64 v[18:19], v7 offset:8
    ds_read_b128 v[48:51], v8 offset:3584
    ds_read_b64 v[20:21], v7 offset:512
    ds_read_b64 v[22:23], v7 offset:520
    ds_read_b128 v[52:55], v8 offset:3072
    ds_read_b64 v[24:25], v7 offset:1024
    ds_read_b64 v[26:27], v7 offset:1032
    ds_read_b128 v[56:59], v8 offset:2560
    ds_read_b64 v[28:29], v7 offset:1536
    ds_read_b64 v[30:31], v7 offset:1544
    ds_read_b128 v[60:63], v8 offset:2048
    ds_read_b64 v[32:33], v7 offset:2048
    ds_read_b64 v[34:35], v7 offset:2056
    ds_read_b128 v[64:67], v8 offset:1536
    ds_read_b64 v[36:37], v7 offset:2560
    ds_read_b64 v[38:39], v7 offset:2568
    ds_read_b128 v[68:71], v8 offset:1024
    s_waitcnt lgkmcnt(12)
    v_mfma_f32_16x16x32_bf16 v[156:159], v[20:23], v[52:55], v[156:159]
    s_waitcnt lgkmcnt(9)
    v_mfma_f32_16x16x32_bf16 v[156:159], v[16:19], v[56:59], v[156:159]
    v_mfma_f32_16x16x32_bf16 v[152:155], v[20:23], v[56:59], v[152:155]
    v_mfma_f32_16x16x32_bf16 v[156:159], v[24:27], v[48:51], v[156:159]
    v_mfma_f32_16x16x32_bf16 v[152:155], v[24:27], v[52:55], v[152:155]
    v_mfma_f32_16x16x32_bf16 v[148:151], v[24:27], v[56:59], v[148:151]
    s_waitcnt lgkmcnt(6)
    v_mfma_f32_16x16x32_bf16 v[152:155], v[16:19], v[60:63], v[152:155]
    v_mfma_f32_16x16x32_bf16 v[148:151], v[20:23], v[60:63], v[148:151]
    v_mfma_f32_16x16x32_bf16 v[144:147], v[24:27], v[60:63], v[144:147]
    v_mfma_f32_16x16x32_bf16 v[152:155], v[28:31], v[48:51], v[152:155]
    v_mfma_f32_16x16x32_bf16 v[148:151], v[28:31], v[52:55], v[148:151]
    v_mfma_f32_16x16x32_bf16 v[144:147], v[28:31], v[56:59], v[144:147]
    s_waitcnt lgkmcnt(3)
    v_mfma_f32_16x16x32_bf16 v[148:151], v[16:19], v[64:67], v[148:151]
    v_mfma_f32_16x16x32_bf16 v[144:147], v[20:23], v[64:67], v[144:147]
    v_mfma_f32_16x16x32_bf16 v[148:151], v[32:35], v[48:51], v[148:151]
    v_mfma_f32_16x16x32_bf16 v[144:147], v[32:35], v[52:55], v[144:147]
    s_waitcnt lgkmcnt(0)
    v_mfma_f32_16x16x32_bf16 v[144:147], v[16:19], v[68:71], v[144:147]
    ds_read_b64 v[80:81], v7 offset:64
    ds_read_b64 v[82:83], v7 offset:72
    ds_read_b128 v[112:115], v8 offset:3648
    v_mfma_f32_16x16x32_bf16 v[144:147], v[36:39], v[48:51], v[144:147]
    ds_read_b64 v[84:85], v7 offset:576
    ds_read_b64 v[86:87], v7 offset:584
    ds_read_b128 v[116:119], v8 offset:3136
    ds_read_b64 v[88:89], v7 offset:1088
    ds_read_b64 v[90:91], v7 offset:1096
    ds_read_b128 v[120:123], v8 offset:2624
    ds_read_b64 v[92:93], v7 offset:1600
    ds_read_b64 v[94:95], v7 offset:1608
    ds_read_b128 v[124:127], v8 offset:2112
    ds_read_b64 v[96:97], v7 offset:2112
    ds_read_b64 v[98:99], v7 offset:2120
    ds_read_b128 v[128:131], v8 offset:1600
    ds_read_b64 v[100:101], v7 offset:2624
    ds_read_b64 v[102:103], v7 offset:2632
    ds_read_b128 v[132:135], v8 offset:1088
    s_waitcnt lgkmcnt(0)
    v_mfma_f32_16x16x32_bf16 v[156:159], v[84:87], v[116:119], v[156:159]
    ds_read_b64 v[16:17], v7 offset:128
    ds_read_b64 v[18:19], v7 offset:136
    v_mfma_f32_16x16x32_bf16 v[156:159], v[80:83], v[120:123], v[156:159]
    ds_read_b128 v[48:51], v8 offset:3712
    ds_read_b64 v[20:21], v7 offset:640
    v_mfma_f32_16x16x32_bf16 v[152:155], v[84:87], v[120:123], v[152:155]
    ds_read_b64 v[22:23], v7 offset:648
    ds_read_b128 v[52:55], v8 offset:3200
    v_mfma_f32_16x16x32_bf16 v[156:159], v[88:91], v[112:115], v[156:159]
    ds_read_b64 v[24:25], v7 offset:1152
    ds_read_b64 v[26:27], v7 offset:1160
    v_mfma_f32_16x16x32_bf16 v[152:155], v[88:91], v[116:119], v[152:155]
    ds_read_b128 v[56:59], v8 offset:2688
    ds_read_b64 v[28:29], v7 offset:1664
    v_mfma_f32_16x16x32_bf16 v[148:151], v[88:91], v[120:123], v[148:151]
    ds_read_b64 v[30:31], v7 offset:1672
    ds_read_b128 v[60:63], v8 offset:2176
    v_mfma_f32_16x16x32_bf16 v[152:155], v[80:83], v[124:127], v[152:155]
    ds_read_b64 v[32:33], v7 offset:2176
    ds_read_b64 v[34:35], v7 offset:2184
    v_mfma_f32_16x16x32_bf16 v[148:151], v[84:87], v[124:127], v[148:151]
    ds_read_b128 v[64:67], v8 offset:1664
    ds_read_b64 v[36:37], v7 offset:2688
    v_mfma_f32_16x16x32_bf16 v[144:147], v[88:91], v[124:127], v[144:147]
    ds_read_b64 v[38:39], v7 offset:2696
    ds_read_b128 v[68:71], v8 offset:1152
    v_mfma_f32_16x16x32_bf16 v[152:155], v[92:95], v[112:115], v[152:155]
    v_mfma_f32_16x16x32_bf16 v[148:151], v[92:95], v[116:119], v[148:151]
    v_mfma_f32_16x16x32_bf16 v[144:147], v[92:95], v[120:123], v[144:147]
    v_mfma_f32_16x16x32_bf16 v[148:151], v[80:83], v[128:131], v[148:151]
    v_mfma_f32_16x16x32_bf16 v[144:147], v[84:87], v[128:131], v[144:147]
    v_mfma_f32_16x16x32_bf16 v[148:151], v[96:99], v[112:115], v[148:151]
    v_mfma_f32_16x16x32_bf16 v[144:147], v[96:99], v[116:119], v[144:147]
    v_mfma_f32_16x16x32_bf16 v[144:147], v[80:83], v[132:135], v[144:147]
    v_mfma_f32_16x16x32_bf16 v[144:147], v[100:103], v[112:115], v[144:147]
    s_waitcnt lgkmcnt(0)
    v_mfma_f32_16x16x32_bf16 v[156:159], v[20:23], v[52:55], v[156:159]
    ds_read_b64 v[80:81], v7 offset:192
    ds_read_b64 v[82:83], v7 offset:200
    v_mfma_f32_16x16x32_bf16 v[156:159], v[16:19], v[56:59], v[156:159]
    ds_read_b128 v[112:115], v8 offset:3776
    ds_read_b64 v[84:85], v7 offset:704
    v_mfma_f32_16x16x32_bf16 v[152:155], v[20:23], v[56:59], v[152:155]
    ds_read_b64 v[86:87], v7 offset:712
    ds_read_b128 v[116:119], v8 offset:3264
    v_mfma_f32_16x16x32_bf16 v[156:159], v[24:27], v[48:51], v[156:159]
    ds_read_b64 v[88:89], v7 offset:1216
    ds_read_b64 v[90:91], v7 offset:1224
    v_mfma_f32_16x16x32_bf16 v[152:155], v[24:27], v[52:55], v[152:155]
    ds_read_b128 v[120:123], v8 offset:2752
    ds_read_b64 v[92:93], v7 offset:1728
    v_mfma_f32_16x16x32_bf16 v[148:151], v[24:27], v[56:59], v[148:151]
    ds_read_b64 v[94:95], v7 offset:1736
    ds_read_b128 v[124:127], v8 offset:2240
    v_mfma_f32_16x16x32_bf16 v[152:155], v[16:19], v[60:63], v[152:155]
    ds_read_b64 v[96:97], v7 offset:2240
    ds_read_b64 v[98:99], v7 offset:2248
    v_mfma_f32_16x16x32_bf16 v[148:151], v[20:23], v[60:63], v[148:151]
    ds_read_b128 v[128:131], v8 offset:1728
    ds_read_b64 v[100:101], v7 offset:2752
    v_mfma_f32_16x16x32_bf16 v[144:147], v[24:27], v[60:63], v[144:147]
    ds_read_b64 v[102:103], v7 offset:2760
    ds_read_b128 v[132:135], v8 offset:1216
    v_mfma_f32_16x16x32_bf16 v[152:155], v[28:31], v[48:51], v[152:155]
    v_mfma_f32_16x16x32_bf16 v[148:151], v[28:31], v[52:55], v[148:151]
    v_mfma_f32_16x16x32_bf16 v[144:147], v[28:31], v[56:59], v[144:147]
    v_mfma_f32_16x16x32_bf16 v[148:151], v[16:19], v[64:67], v[148:151]
    v_mfma_f32_16x16x32_bf16 v[144:147], v[20:23], v[64:67], v[144:147]
    v_mfma_f32_16x16x32_bf16 v[148:151], v[32:35], v[48:51], v[148:151]
    v_mfma_f32_16x16x32_bf16 v[144:147], v[32:35], v[52:55], v[144:147]
    v_mfma_f32_16x16x32_bf16 v[144:147], v[16:19], v[68:71], v[144:147]
    v_mfma_f32_16x16x32_bf16 v[144:147], v[36:39], v[48:51], v[144:147]
    s_waitcnt lgkmcnt(0)
    v_mfma_f32_16x16x32_bf16 v[156:159], v[84:87], v[116:119], v[156:159]
    v_mfma_f32_16x16x32_bf16 v[156:159], v[80:83], v[120:123], v[156:159]
    v_mfma_f32_16x16x32_bf16 v[152:155], v[84:87], v[120:123], v[152:155]
    v_mfma_f32_16x16x32_bf16 v[156:159], v[88:91], v[112:115], v[156:159]
    v_mfma_f32_16x16x32_bf16 v[152:155], v[88:91], v[116:119], v[152:155]
    v_mfma_f32_16x16x32_bf16 v[148:151], v[88:91], v[120:123], v[148:151]
    v_mfma_f32_16x16x32_bf16 v[152:155], v[80:83], v[124:127], v[152:155]
    v_mfma_f32_16x16x32_bf16 v[148:151], v[84:87], v[124:127], v[148:151]
    v_mfma_f32_16x16x32_bf16 v[144:147], v[88:91], v[124:127], v[144:147]
    v_mfma_f32_16x16x32_bf16 v[152:155], v[92:95], v[112:115], v[152:155]
    v_mfma_f32_16x16x32_bf16 v[148:151], v[92:95], v[116:119], v[148:151]
    v_mfma_f32_16x16x32_bf16 v[144:147], v[92:95], v[120:123], v[144:147]
    v_mfma_f32_16x16x32_bf16 v[148:151], v[80:83], v[128:131], v[148:151]
    v_mfma_f32_16x16x32_bf16 v[144:147], v[84:87], v[128:131], v[144:147]
    v_mfma_f32_16x16x32_bf16 v[148:151], v[96:99], v[112:115], v[148:151]
    v_mfma_f32_16x16x32_bf16 v[144:147], v[96:99], v[116:119], v[144:147]
    v_mfma_f32_16x16x32_bf16 v[144:147], v[80:83], v[132:135], v[144:147]
    v_mfma_f32_16x16x32_bf16 v[144:147], v[100:103], v[112:115], v[144:147]
    s_bitcmp1_b32 s38, 0
    s_cselect_b32 s66, 3, 5
    s_cselect_b32 s67, 2, 4
C_RED:
    s_lshl_b32 s68, s38, 11
    s_add_u32 s68, s68, 49920
    v_lshl_add_u32 v9, v1, 4, s68
    s_xor_b32 s69, s38, 1
    s_lshl_b32 s69, s69, 11
    s_add_u32 s69, s69, 49920
    v_lshl_add_u32 v10, v1, 4, s69
    s_bitcmp1_b32 s38, 0
    s_cbranch_scc1 C_RH1
    ds_write_b128 v9, v[152:155]
    ds_write_b128 v9, v[156:159] offset:1024
    v_mov_b32 v16, v144
    v_mov_b32 v17, v145
    v_mov_b32 v18, v146
    v_mov_b32 v19, v147
    v_mov_b32 v20, v148
    v_mov_b32 v21, v149
    v_mov_b32 v22, v150
    v_mov_b32 v23, v151
    s_branch C_RH2
C_RH1:
    ds_write_b128 v9, v[144:147]
    ds_write_b128 v9, v[148:151] offset:1024
    v_mov_b32 v16, v152
    v_mov_b32 v17, v153
    v_mov_b32 v18, v154
    v_mov_b32 v19, v155
    v_mov_b32 v20, v156
    v_mov_b32 v21, v157
    v_mov_b32 v22, v158
    v_mov_b32 v23, v159
C_RH2:
    v_lshlrev_b32 v11, 5, v5
    v_lshl_add_u32 v11, v6, 3, v11
    s_add_u32 s64, s64, 4088
    s_lshl_b32 s68, s66, 9
    s_sub_u32 s68, s64, s68
    v_sub_u32 v12, s68, v11
    s_lshl_b32 s68, s67, 9
    s_sub_u32 s68, s64, s68
    v_sub_u32 v13, s68, v11
    v_lshrrev_b32 v14, 1, v6
    v_lshl_add_u32 v14, v5, 1, v14
    v_mul_u32_u24 v14, 48, v14
    v_and_b32 v15, 1, v6
    v_lshl_add_u32 v14, v15, 3, v14
    s_lshl_b32 s68, s65, 4
    s_add_u32 s68, s68, 74496
    s_mul_i32 s69, s66, 1536
    s_add_u32 s69, s69, s68
    v_add_u32 v15, s69, v14
    s_mul_i32 s69, s67, 1536
    s_add_u32 s69, s69, s68
    v_add_u32 v14, s69, v14
    v_lshlrev_b32 v161, 16, v161
    ds_read_b64 v[32:33], v12
    ds_read_b64 v[34:35], v13
    s_waitcnt vmcnt(0) lgkmcnt(0)
    s_barrier
    s_cmp_lg_u32 s38, 11
    s_cbranch_scc1 C_NOYF
    s_lshl_b32 s68, s52, 2
    s_add_u32 s68, s68, 1024
    v_mov_b32 v162, s39
    v_mov_b32 v160, 0
    s_mov_b64 exec, 1
    buffer_store_dword v162, v160, s[40:43], s68 offen sc1
    s_mov_b64 exec, -1
C_NOYF:
    ds_read_b128 v[24:27], v10
    ds_read_b128 v[28:31], v10 offset:1024
    v_and_b32 v40, 0xffff0000, v33
    v_lshlrev_b32 v41, 16, v33
    v_and_b32 v42, 0xffff0000, v32
    v_lshlrev_b32 v43, 16, v32
    v_mul_f32 v40, v40, v161
    v_mul_f32 v41, v41, v161
    v_mul_f32 v42, v42, v161
    v_mul_f32 v43, v43, v161
    v_cvt_pk_bf16_f32 v41, v40, v41
    v_cvt_pk_bf16_f32 v43, v42, v43
    v_lshlrev_b32 v40, 16, v41
    v_and_b32 v41, 0xffff0000, v41
    v_lshlrev_b32 v42, 16, v43
    v_and_b32 v43, 0xffff0000, v43
    v_and_b32 v44, 0xffff0000, v35
    v_lshlrev_b32 v45, 16, v35
    v_and_b32 v46, 0xffff0000, v34
    v_lshlrev_b32 v47, 16, v34
    v_mul_f32 v44, v44, v161
    v_mul_f32 v45, v45, v161
    v_mul_f32 v46, v46, v161
    v_mul_f32 v47, v47, v161
    v_cvt_pk_bf16_f32 v45, v44, v45
    v_cvt_pk_bf16_f32 v47, v46, v47
    v_lshlrev_b32 v44, 16, v45
    v_and_b32 v45, 0xffff0000, v45
    v_lshlrev_b32 v46, 16, v47
    v_and_b32 v47, 0xffff0000, v47
    s_waitcnt lgkmcnt(1)
    v_add_f32 v16, v16, v24
    v_add_f32 v17, v17, v25
    v_add_f32 v18, v18, v26
    v_add_f32 v19, v19, v27
    v_cvt_pk_bf16_f32 v17, v16, v17
    v_cvt_pk_bf16_f32 v19, v18, v19
    v_lshlrev_b32 v16, 16, v17
    v_and_b32 v17, 0xffff0000, v17
    v_lshlrev_b32 v18, 16, v19
    v_and_b32 v19, 0xffff0000, v19
    v_add_f32 v16, v16, v40
    v_add_f32 v17, v17, v41
    v_add_f32 v18, v18, v42
    v_add_f32 v19, v19, v43
    v_cvt_pk_bf16_f32 v36, v16, v17
    v_cvt_pk_bf16_f32 v37, v18, v19
    v_min_u32 v36, -2, v36
    v_min_u32 v37, -2, v37
    ds_write_b64 v15, v[36:37]
    s_waitcnt lgkmcnt(0)
    v_add_f32 v20, v20, v28
    v_add_f32 v21, v21, v29
    v_add_f32 v22, v22, v30
    v_add_f32 v23, v23, v31
    v_cvt_pk_bf16_f32 v21, v20, v21
    v_cvt_pk_bf16_f32 v23, v22, v23
    v_lshlrev_b32 v20, 16, v21
    v_and_b32 v21, 0xffff0000, v21
    v_lshlrev_b32 v22, 16, v23
    v_and_b32 v23, 0xffff0000, v23
    v_add_f32 v20, v20, v44
    v_add_f32 v21, v21, v45
    v_add_f32 v22, v22, v46
    v_add_f32 v23, v23, v47
    v_cvt_pk_bf16_f32 v38, v20, v21
    v_cvt_pk_bf16_f32 v39, v22, v23
    v_min_u32 v38, -2, v38
    v_min_u32 v39, -2, v39
    ds_write_b64 v14, v[38:39]
    v_add_u32 v9, 74496, v3
    s_mul_i32 s68, s52, 12288
    s_add_u32 s68, s68, 65536
    s_waitcnt lgkmcnt(0)
    s_barrier
    ds_read_b128 v[16:19], v9
    s_waitcnt lgkmcnt(0)
    buffer_store_dwordx4 v[16:19], v3, s[40:43], s68 offen sc1
    s_cmp_ge_u32 s2, 128
    s_cbranch_scc1 TOP8
    s_cmp_ge_u32 s38, 9
    s_cbranch_scc1 L_IDLE
    s_mov_b32 s65, 43691
    v_mul_u32_u24 v9, s65, v0
    v_lshrrev_b32 v9, 17, v9
    v_lshlrev_b32 v11, 2, v9
    s_lshl_b32 s64, s2, 4
    v_add_u32 v4, s64, v5
    s_movk_i32 s65, 1152
    v_mul_lo_u32 v7, v4, s65
    s_lshl_b32 s65, s38, 7
    v_lshl_add_u32 v8, v6, 5, s65
    v_add_u32 v7, v7, v8
    global_load_dwordx4 v[12:15], v7, s[4:5]
    global_load_dwordx4 v[16:19], v7, s[4:5] offset:16
    global_load_dwordx4 v[20:23], v8, s[24:25]
    global_load_dwordx4 v[24:27], v8, s[24:25] offset:16
    v_mul_u32_u24 v10, 3, v9
    v_sub_u32 v10, v0, v10
    s_movk_i32 s65, 12288
    v_mul_lo_u32 v9, v9, s65
    v_lshl_add_u32 v9, v10, 4, v9
    s_mul_i32 s65, s2, 96
    s_add_u32 s65, s65, 65536
    v_lshrrev_b32 v10, 2, v5
    v_lshl_add_u32 v10, v6, 4, v10
    v_lshlrev_b32 v10, 5, v10
    v_and_b32 v36, 3, v5
    v_lshl_add_u32 v10, v36, 3, v10
    s_lshl_b32 s66, s38, 11
    v_add_u32 v10, s66, v10
    s_movk_i32 s66, 1024
    s_movk_i32 s60, 4000
L_YF:
    buffer_load_dword v28, v11, s[40:43], s66 offen sc1
    s_waitcnt vmcnt(0)
    v_cmp_ne_u32 vcc, s39, v28
    s_nop 0
    s_and_b64 exec, exec, vcc
    s_cbranch_execz L_YF_D
    s_sub_u32 s60, s60, 1
    s_cmp_gt_i32 s60, 0
    s_sleep 1
    s_cbranch_scc1 L_YF
L_YF_D:
    s_mov_b64 exec, -1
    v_lshlrev_b32 v11, 5, v0
    s_movk_i32 s60, 4000
L_YP:
    buffer_load_dwordx4 v[28:31], v9, s[40:43], s65 offen sc1
    buffer_load_dwordx4 v[32:35], v9, s[40:43], s65 offen offset:48 sc1
    s_waitcnt vmcnt(0)
    v_max3_u32 v36, v28, v29, v30
    v_max3_u32 v37, v31, v32, v33
    v_max3_u32 v36, v36, v34, v35
    v_max_u32 v36, v36, v37
    v_cmp_eq_u32 vcc, -1, v36
    s_nop 0
    s_and_b64 exec, exec, vcc
    s_cbranch_execz L_YP_D
    s_sub_u32 s60, s60, 1
    s_cmp_gt_i32 s60, 0
    s_sleep 1
    s_cbranch_scc1 L_YP
L_YP_D:
    s_mov_b64 exec, -1
    ds_write_b128 v11, v[28:31] offset:0
    ds_write_b128 v11, v[32:35] offset:16
    v_lshlrev_b32 v40, 16, v12
    v_and_b32 v41, 0xffff0000, v12
    v_lshlrev_b32 v42, 16, v13
    v_and_b32 v43, 0xffff0000, v13
    v_lshlrev_b32 v44, 16, v14
    v_and_b32 v45, 0xffff0000, v14
    v_lshlrev_b32 v46, 16, v15
    v_and_b32 v47, 0xffff0000, v15
    v_lshlrev_b32 v48, 16, v16
    v_and_b32 v49, 0xffff0000, v16
    v_lshlrev_b32 v50, 16, v17
    v_and_b32 v51, 0xffff0000, v17
    v_lshlrev_b32 v52, 16, v18
    v_and_b32 v53, 0xffff0000, v18
    v_lshlrev_b32 v54, 16, v19
    v_and_b32 v55, 0xffff0000, v19
    v_mul_u32_u24 v11, 80, v5
    v_add_u32 v11, 131328, v11
    s_lshl_b32 s66, s38, 3
    v_add_u32 v9, s66, v11
    s_waitcnt lgkmcnt(0)
    s_barrier
    ds_read_b64_tr_b16 v[28:29], v10 offset:0
    ds_read_b64_tr_b16 v[30:31], v10 offset:128
    ds_read_b64_tr_b16 v[32:33], v10 offset:256
    ds_read_b64_tr_b16 v[34:35], v10 offset:384
    s_waitcnt lgkmcnt(3)
    v_lshlrev_b32 v36, 16, v28
    v_and_b32 v37, 0xffff0000, v28
    v_add_f32 v40, v40, v36
    v_add_f32 v41, v41, v37
    v_cvt_pk_bf16_f32 v12, v40, v41
    v_lshlrev_b32 v40, 16, v12
    v_and_b32 v41, 0xffff0000, v12
    v_lshlrev_b32 v36, 16, v29
    v_and_b32 v37, 0xffff0000, v29
    v_add_f32 v42, v42, v36
    v_add_f32 v43, v43, v37
    v_cvt_pk_bf16_f32 v13, v42, v43
    v_lshlrev_b32 v42, 16, v13
    v_and_b32 v43, 0xffff0000, v13
    s_waitcnt lgkmcnt(2)
    v_lshlrev_b32 v36, 16, v30
    v_and_b32 v37, 0xffff0000, v30
    v_add_f32 v44, v44, v36
    v_add_f32 v45, v45, v37
    v_cvt_pk_bf16_f32 v14, v44, v45
    v_lshlrev_b32 v44, 16, v14
    v_and_b32 v45, 0xffff0000, v14
    v_lshlrev_b32 v36, 16, v31
    v_and_b32 v37, 0xffff0000, v31
    v_add_f32 v46, v46, v36
    v_add_f32 v47, v47, v37
    v_cvt_pk_bf16_f32 v15, v46, v47
    v_lshlrev_b32 v46, 16, v15
    v_and_b32 v47, 0xffff0000, v15
    s_waitcnt lgkmcnt(1)
    v_lshlrev_b32 v36, 16, v32
    v_and_b32 v37, 0xffff0000, v32
    v_add_f32 v48, v48, v36
    v_add_f32 v49, v49, v37
    v_cvt_pk_bf16_f32 v16, v48, v49
    v_lshlrev_b32 v48, 16, v16
    v_and_b32 v49, 0xffff0000, v16
    v_lshlrev_b32 v36, 16, v33
    v_and_b32 v37, 0xffff0000, v33
    v_add_f32 v50, v50, v36
    v_add_f32 v51, v51, v37
    v_cvt_pk_bf16_f32 v17, v50, v51
    v_lshlrev_b32 v50, 16, v17
    v_and_b32 v51, 0xffff0000, v17
    s_waitcnt lgkmcnt(0)
    v_lshlrev_b32 v36, 16, v34
    v_and_b32 v37, 0xffff0000, v34
    v_add_f32 v52, v52, v36
    v_add_f32 v53, v53, v37
    v_cvt_pk_bf16_f32 v18, v52, v53
    v_lshlrev_b32 v52, 16, v18
    v_and_b32 v53, 0xffff0000, v18
    v_lshlrev_b32 v36, 16, v35
    v_and_b32 v37, 0xffff0000, v35
    v_add_f32 v54, v54, v36
    v_add_f32 v55, v55, v37
    v_cvt_pk_bf16_f32 v19, v54, v55
    v_lshlrev_b32 v54, 16, v19
    v_and_b32 v55, 0xffff0000, v19
    v_add_f32 v28, v40, v44
    v_add_f32 v32, v48, v52
    v_add_f32 v29, v41, v45
    v_add_f32 v33, v49, v53
    v_add_f32 v30, v42, v46
    v_add_f32 v34, v50, v54
    v_add_f32 v31, v43, v47
    v_add_f32 v35, v51, v55
    v_add_f32 v28, v28, v32
    v_add_f32 v29, v29, v33
    v_add_f32 v30, v30, v34
    v_add_f32 v31, v31, v35
    v_add_f32 v28, v28, v29
    v_add_f32 v30, v30, v31
    v_add_f32 v28, v28, v30
    v_mov_b32 v30, v28
    s_nop 1
    v_permlane16_swap_b32 v28, v30
    v_add_f32 v28, v28, v30
    v_mov_b32 v30, v28
    s_nop 1
    v_permlane32_swap_b32 v28, v30
    v_add_f32 v28, v28, v30
    v_mul_f32 v28, 0x3c800000, v28
    v_sub_f32 v36, v40, v28
    v_sub_f32 v37, v41, v28
    v_sub_f32 v38, v42, v28
    v_sub_f32 v39, v43, v28
    v_mul_f32 v30, v36, v36
    v_mul_f32 v31, v37, v37
    v_mul_f32 v32, v38, v38
    v_mul_f32 v33, v39, v39
    v_sub_f32 v36, v44, v28
    v_sub_f32 v37, v45, v28
    v_sub_f32 v38, v46, v28
    v_sub_f32 v39, v47, v28
    v_fmac_f32 v30, v36, v36
    v_fmac_f32 v31, v37, v37
    v_fmac_f32 v32, v38, v38
    v_fmac_f32 v33, v39, v39
    v_sub_f32 v36, v48, v28
    v_sub_f32 v37, v49, v28
    v_sub_f32 v38, v50, v28
    v_sub_f32 v39, v51, v28
    v_fmac_f32 v30, v36, v36
    v_fmac_f32 v31, v37, v37
    v_fmac_f32 v32, v38, v38
    v_fmac_f32 v33, v39, v39
    v_sub_f32 v36, v52, v28
    v_sub_f32 v37, v53, v28
    v_sub_f32 v38, v54, v28
    v_sub_f32 v39, v55, v28
    v_fmac_f32 v30, v36, v36
    v_fmac_f32 v31, v37, v37
    v_fmac_f32 v32, v38, v38
    v_fmac_f32 v33, v39, v39
    v_add_f32 v30, v30, v31
    v_add_f32 v32, v32, v33
    v_add_f32 v29, v30, v32
    v_mov_b32 v30, v29
    s_nop 1
    v_permlane16_swap_b32 v29, v30
    v_add_f32 v29, v29, v30
    v_mov_b32 v30, v29
    s_nop 1
    v_permlane32_swap_b32 v29, v30
    v_add_f32 v29, v29, v30
    s_mov_b64 exec, 0xffff
    ds_write_b64 v9, v[28:29]
    s_mov_b64 exec, -1
    v_mul_u32_u24 v9, 48, v5
    v_add_u32 v9, 132608, v9
    s_lshl_b32 s66, s38, 2
    v_add_u32 v10, s66, v9
    s_mov_b32 s65, 2424832
    s_waitcnt lgkmcnt(0)
    s_barrier
    ds_read_b128 v[60:63], v11 offset:0
    ds_read_b128 v[64:67], v11 offset:16
    ds_read_b128 v[68:71], v11 offset:32
    ds_read_b128 v[72:75], v11 offset:48
    ds_read_b64 v[76:77], v11 offset:64
    s_waitcnt lgkmcnt(0)
    v_add_f32 v28, v60, v62
    v_add_f32 v29, v64, v66
    v_add_f32 v30, v68, v70
    v_add_f32 v31, v72, v74
    v_add_f32 v32, v61, v63
    v_add_f32 v33, v65, v67
    v_add_f32 v34, v69, v71
    v_add_f32 v35, v73, v75
    v_add_f32 v28, v28, v29
    v_add_f32 v30, v30, v31
    v_add_f32 v32, v32, v33
    v_add_f32 v34, v34, v35
    v_add_f32 v28, v28, v76
    v_add_f32 v32, v32, v77
    v_add_f32 v28, v28, v30
    v_add_f32 v32, v32, v34
    v_mul_f32 v28, 0x3de38e39, v28
    v_sub_f32 v60, v60, v28
    v_sub_f32 v62, v62, v28
    v_sub_f32 v64, v64, v28
    v_sub_f32 v66, v66, v28
    v_sub_f32 v68, v68, v28
    v_sub_f32 v70, v70, v28
    v_sub_f32 v72, v72, v28
    v_sub_f32 v74, v74, v28
    v_sub_f32 v76, v76, v28
    v_mul_f32 v33, v60, v60
    v_mul_f32 v34, v62, v62
    v_mul_f32 v35, v64, v64
    v_fmac_f32 v33, v66, v66
    v_fmac_f32 v34, v68, v68
    v_fmac_f32 v35, v70, v70
    v_fmac_f32 v33, v72, v72
    v_fmac_f32 v34, v74, v74
    v_fmac_f32 v35, v76, v76
    v_cvt_pk_bf16_f32 v28, v28, v28
    v_lshlrev_b32 v28, 16, v28
    v_add_f32 v33, v33, v34
    v_add_f32 v33, v33, v35
    v_mul_f32 v38, 0x3ae38e39, v32
    v_fmac_f32 v38, 0x3de38e39, v33
    v_mov_b32 v39, v28
    v_cvt_pk_bf16_f32 v38, v38, v38
    v_lshlrev_b32 v38, 16, v38
    v_add_f32 v38, 0x3727c5ac, v38
    v_cvt_pk_bf16_f32 v38, v38, v38
    v_lshlrev_b32 v38, 16, v38
    v_sqrt_f32 v38, v38
    s_nop 0
    v_cvt_pk_bf16_f32 v38, v38, v38
    v_lshlrev_b32 v38, 16, v38
    v_rcp_f32 v38, v38
    v_sub_f32 v36, v40, v39
    v_sub_f32 v37, v41, v39
    v_cvt_pk_bf16_f32 v37, v36, v37
    v_lshlrev_b32 v36, 16, v37
    v_and_b32 v37, 0xffff0000, v37
    v_mul_f32 v36, v36, v38
    v_mul_f32 v37, v37, v38
    v_cvt_pk_bf16_f32 v28, v36, v37
    v_min_u32 v28, -2, v28
    v_sub_f32 v36, v42, v39
    v_sub_f32 v37, v43, v39
    v_cvt_pk_bf16_f32 v37, v36, v37
    v_lshlrev_b32 v36, 16, v37
    v_and_b32 v37, 0xffff0000, v37
    v_mul_f32 v36, v36, v38
    v_mul_f32 v37, v37, v38
    v_cvt_pk_bf16_f32 v29, v36, v37
    v_min_u32 v29, -2, v29
    v_sub_f32 v36, v44, v39
    v_sub_f32 v37, v45, v39
    v_cvt_pk_bf16_f32 v37, v36, v37
    v_lshlrev_b32 v36, 16, v37
    v_and_b32 v37, 0xffff0000, v37
    v_mul_f32 v36, v36, v38
    v_mul_f32 v37, v37, v38
    v_cvt_pk_bf16_f32 v30, v36, v37
    v_min_u32 v30, -2, v30
    v_sub_f32 v36, v46, v39
    v_sub_f32 v37, v47, v39
    v_cvt_pk_bf16_f32 v37, v36, v37
    v_lshlrev_b32 v36, 16, v37
    v_and_b32 v37, 0xffff0000, v37
    v_mul_f32 v36, v36, v38
    v_mul_f32 v37, v37, v38
    v_cvt_pk_bf16_f32 v31, v36, v37
    v_min_u32 v31, -2, v31
    buffer_store_dwordx4 v[28:31], v7, s[40:43], s65 offen sc1
    v_sub_f32 v36, v48, v39
    v_sub_f32 v37, v49, v39
    v_cvt_pk_bf16_f32 v37, v36, v37
    v_lshlrev_b32 v36, 16, v37
    v_and_b32 v37, 0xffff0000, v37
    v_mul_f32 v36, v36, v38
    v_mul_f32 v37, v37, v38
    v_cvt_pk_bf16_f32 v32, v36, v37
    v_min_u32 v32, -2, v32
    v_sub_f32 v36, v50, v39
    v_sub_f32 v37, v51, v39
    v_cvt_pk_bf16_f32 v37, v36, v37
    v_lshlrev_b32 v36, 16, v37
    v_and_b32 v37, 0xffff0000, v37
    v_mul_f32 v36, v36, v38
    v_mul_f32 v37, v37, v38
    v_cvt_pk_bf16_f32 v33, v36, v37
    v_min_u32 v33, -2, v33
    v_sub_f32 v36, v52, v39
    v_sub_f32 v37, v53, v39
    v_cvt_pk_bf16_f32 v37, v36, v37
    v_lshlrev_b32 v36, 16, v37
    v_and_b32 v37, 0xffff0000, v37
    v_mul_f32 v36, v36, v38
    v_mul_f32 v37, v37, v38
    v_cvt_pk_bf16_f32 v34, v36, v37
    v_min_u32 v34, -2, v34
    v_sub_f32 v36, v54, v39
    v_sub_f32 v37, v55, v39
    v_cvt_pk_bf16_f32 v37, v36, v37
    v_lshlrev_b32 v36, 16, v37
    v_and_b32 v37, 0xffff0000, v37
    v_mul_f32 v36, v36, v38
    v_mul_f32 v37, v37, v38
    v_cvt_pk_bf16_f32 v35, v36, v37
    v_min_u32 v35, -2, v35
    buffer_store_dwordx4 v[32:35], v7, s[40:43], s65 offen offset:16 sc1
    v_lshlrev_b32 v60, 16, v28
    v_and_b32 v61, 0xffff0000, v28
    v_lshlrev_b32 v36, 16, v20
    v_and_b32 v37, 0xffff0000, v20
    v_mul_f32 v38, v60, v36
    v_mul_f32 v39, v61, v37
    v_lshlrev_b32 v62, 16, v29
    v_and_b32 v63, 0xffff0000, v29
    v_lshlrev_b32 v36, 16, v21
    v_and_b32 v37, 0xffff0000, v21
    v_fmac_f32 v38, v62, v36
    v_fmac_f32 v39, v63, v37
    v_lshlrev_b32 v64, 16, v30
    v_and_b32 v65, 0xffff0000, v30
    v_lshlrev_b32 v36, 16, v22
    v_and_b32 v37, 0xffff0000, v22
    v_fmac_f32 v38, v64, v36
    v_fmac_f32 v39, v65, v37
    v_lshlrev_b32 v66, 16, v31
    v_and_b32 v67, 0xffff0000, v31
    v_lshlrev_b32 v36, 16, v23
    v_and_b32 v37, 0xffff0000, v23
    v_fmac_f32 v38, v66, v36
    v_fmac_f32 v39, v67, v37
    v_lshlrev_b32 v68, 16, v32
    v_and_b32 v69, 0xffff0000, v32
    v_lshlrev_b32 v36, 16, v24
    v_and_b32 v37, 0xffff0000, v24
    v_fmac_f32 v38, v68, v36
    v_fmac_f32 v39, v69, v37
    v_lshlrev_b32 v70, 16, v33
    v_and_b32 v71, 0xffff0000, v33
    v_lshlrev_b32 v36, 16, v25
    v_and_b32 v37, 0xffff0000, v25
    v_fmac_f32 v38, v70, v36
    v_fmac_f32 v39, v71, v37
    v_lshlrev_b32 v72, 16, v34
    v_and_b32 v73, 0xffff0000, v34
    v_lshlrev_b32 v36, 16, v26
    v_and_b32 v37, 0xffff0000, v26
    v_fmac_f32 v38, v72, v36
    v_fmac_f32 v39, v73, v37
    v_lshlrev_b32 v74, 16, v35
    v_and_b32 v75, 0xffff0000, v35
    v_lshlrev_b32 v36, 16, v27
    v_and_b32 v37, 0xffff0000, v27
    v_fmac_f32 v38, v74, v36
    v_fmac_f32 v39, v75, v37
    v_add_f32 v38, v38, v39
    v_mov_b32 v39, v38
    s_nop 1
    v_permlane16_swap_b32 v38, v39
    v_add_f32 v38, v38, v39
    v_mov_b32 v39, v38
    s_nop 1
    v_permlane32_swap_b32 v38, v39
    v_add_f32 v38, v38, v39
    s_mov_b64 exec, 0xffff
    ds_write_b32 v10, v38
    s_mov_b64 exec, -1
    s_waitcnt lgkmcnt(0)
    s_barrier
    s_cmp_lg_u32 s38, 0
    s_cbranch_scc1 L_OUT
    ds_read_b128 v[28:31], v9
    ds_read_b128 v[32:35], v9 offset:16
    ds_read_b32 v36, v9 offset:32
    v_sub_u32 v37, 0x7ff, v4
    v_lshlrev_b32 v38, 2, v4
    s_mov_b32 s65, 32768
    s_waitcnt lgkmcnt(0)
    v_add_f32 v28, v28, v29
    v_add_f32 v30, v30, v31
    v_add_f32 v32, v32, v33
    v_add_f32 v34, v34, v35
    v_add_f32 v28, v28, v30
    v_add_f32 v32, v32, v34
    v_add_f32 v28, v28, v36
    v_add_f32 v28, v28, v32
    v_cvt_pk_bf16_f32 v28, v28, v28
    v_ashrrev_i32 v29, 31, v28
    v_or_b32 v29, 0x80000000, v29
    v_xor_b32 v28, v28, v29
    v_and_b32 v28, 0xffff0000, v28
    v_or_b32 v28, v28, v37
    s_nop 1
    v_mov_b32_dpp v29, v28 row_shl:1 row_mask:0xf bank_mask:0xf
    v_mov_b32_dpp v30, v28 row_shl:2 row_mask:0xf bank_mask:0xf
    v_mov_b32_dpp v31, v28 row_shl:3 row_mask:0xf bank_mask:0xf
    s_mov_b64 exec, 0x1111
    buffer_store_dwordx4 v[28:31], v38, s[40:43], s65 offen sc1
    s_mov_b64 exec, -1
L_OUT:
    v_add_f32 v36, v60, v40
    v_add_f32 v37, v61, v41
    v_cvt_pk_bf16_f32 v20, v36, v37
    v_min_u32 v12, -2, v12
    v_add_f32 v36, v62, v42
    v_add_f32 v37, v63, v43
    v_cvt_pk_bf16_f32 v21, v36, v37
    v_min_u32 v13, -2, v13
    v_add_f32 v36, v64, v44
    v_add_f32 v37, v65, v45
    v_cvt_pk_bf16_f32 v22, v36, v37
    v_min_u32 v14, -2, v14
    v_add_f32 v36, v66, v46
    v_add_f32 v37, v67, v47
    v_cvt_pk_bf16_f32 v23, v36, v37
    v_min_u32 v15, -2, v15
    v_add_f32 v36, v68, v48
    v_add_f32 v37, v69, v49
    v_cvt_pk_bf16_f32 v24, v36, v37
    v_min_u32 v16, -2, v16
    v_add_f32 v36, v70, v50
    v_add_f32 v37, v71, v51
    v_cvt_pk_bf16_f32 v25, v36, v37
    v_min_u32 v17, -2, v17
    v_add_f32 v36, v72, v52
    v_add_f32 v37, v73, v53
    v_cvt_pk_bf16_f32 v26, v36, v37
    v_min_u32 v18, -2, v18
    v_add_f32 v36, v74, v54
    v_add_f32 v37, v75, v55
    v_cvt_pk_bf16_f32 v27, v36, v37
    v_min_u32 v19, -2, v19
    s_branch TOP8
L_IDLE:
    s_barrier
    s_barrier
    s_barrier
    s_branch TOP8
FFN0:
    s_mul_i32 s54, s53, 18432
    s_add_u32 s54, s54, 4784128
    s_movk_i32 s55, 12288
    v_and_b32 v5, 15, v0
    v_bfe_u32 v6, v0, 4, 2
    s_waitcnt lgkmcnt(0)
    global_load_dword v9, v8, s[36:37] offset:0
    s_mov_b32 s40, s36
    s_mov_b32 s41, s37
    s_add_u32 s72, s36, s54
    s_addc_u32 s73, s37, 0
    s_mov_b32 s74, 18432
    s_mov_b32 s75, 0x00020000
    buffer_store_dwordx4 v[164:167], v3, s[72:75], 0 offen sc1
    buffer_store_dwordx4 v[164:167], v3, s[72:75], s55 offen sc1
    s_lshl_b32 s68, s53, 2
    s_add_u32 s68, s68, 2048
    s_waitcnt vmcnt(0) lgkmcnt(0)
    v_readfirstlane_b32 s39, v9
    s_nop 0
    s_add_u32 s39, s39, 1
    s_barrier
    s_cmp_ge_u32 s38, 9
    s_cbranch_scc1 N_WD
    s_mul_i32 s64, s38, 43
    s_lshr_b32 s64, s64, 7
    s_mul_i32 s65, s64, 3
    s_sub_u32 s65, s38, s65
    s_mul_i32 s66, s53, 192
    s_lshl_b32 s67, s64, 6
    s_add_u32 s66, s66, s67
    s_mul_i32 s67, s65, 1769472
    s_add_u32 s66, s66, s67
    v_and_b32 v7, 7, v5
    s_mov_b32 s67, 73728
    v_mul_lo_u32 v8, v6, s67
    v_lshl_add_u32 v8, v7, 3, v8
    v_add_u32 v8, s66, v8
    v_cmp_gt_u32 vcc, 8, v5
    v_mov_b32 v10, s28
    v_mov_b32 v11, s26
    v_cndmask_b32 v10, v10, v11, vcc
    v_mov_b32 v11, s29
    v_mov_b32 v12, s27
    v_cndmask_b32 v11, v11, v12, vcc
    v_add_co_u32 v10, vcc, v10, v8
    s_nop 1
    v_addc_co_u32 v11, vcc, 0, v11, vcc
    s_movk_i32 s66, 9216
    s_mov_b32 s67, 230400
    global_load_dwordx2 v[72:73], v[10:11], off
    v_add_co_u32 v10, vcc, s66, v10
    s_nop 1
    v_addc_co_u32 v11, vcc, 0, v11, vcc
    global_load_dwordx2 v[74:75], v[10:11], off
    v_add_co_u32 v10, vcc, s66, v10
    s_nop 1
    v_addc_co_u32 v11, vcc, 0, v11, vcc
    global_load_dwordx2 v[76:77], v[10:11], off
    v_add_co_u32 v10, vcc, s66, v10
    s_nop 1
    v_addc_co_u32 v11, vcc, 0, v11, vcc
    global_load_dwordx2 v[78:79], v[10:11], off
    v_add_co_u32 v10, vcc, s66, v10
    s_nop 1
    v_addc_co_u32 v11, vcc, 0, v11, vcc
    global_load_dwordx2 v[80:81], v[10:11], off
    v_add_co_u32 v10, vcc, s66, v10
    s_nop 1
    v_addc_co_u32 v11, vcc, 0, v11, vcc
    global_load_dwordx2 v[82:83], v[10:11], off
    v_add_co_u32 v10, vcc, s66, v10
    s_nop 1
    v_addc_co_u32 v11, vcc, 0, v11, vcc
    global_load_dwordx2 v[84:85], v[10:11], off
    v_add_co_u32 v10, vcc, s66, v10
    s_nop 1
    v_addc_co_u32 v11, vcc, 0, v11, vcc
    global_load_dwordx2 v[86:87], v[10:11], off
    v_add_co_u32 v10, vcc, s67, v10
    s_nop 1
    v_addc_co_u32 v11, vcc, 0, v11, vcc
    global_load_dwordx2 v[88:89], v[10:11], off
    v_add_co_u32 v10, vcc, s66, v10
    s_nop 1
    v_addc_co_u32 v11, vcc, 0, v11, vcc
    global_load_dwordx2 v[90:91], v[10:11], off
    v_add_co_u32 v10, vcc, s66, v10
    s_nop 1
    v_addc_co_u32 v11, vcc, 0, v11, vcc
    global_load_dwordx2 v[92:93], v[10:11], off
    v_add_co_u32 v10, vcc, s66, v10
    s_nop 1
    v_addc_co_u32 v11, vcc, 0, v11, vcc
    global_load_dwordx2 v[94:95], v[10:11], off
    v_add_co_u32 v10, vcc, s66, v10
    s_nop 1
    v_addc_co_u32 v11, vcc, 0, v11, vcc
    global_load_dwordx2 v[96:97], v[10:11], off
    v_add_co_u32 v10, vcc, s66, v10
    s_nop 1
    v_addc_co_u32 v11, vcc, 0, v11, vcc
    global_load_dwordx2 v[98:99], v[10:11], off
    v_add_co_u32 v10, vcc, s66, v10
    s_nop 1
    v_addc_co_u32 v11, vcc, 0, v11, vcc
    global_load_dwordx2 v[100:101], v[10:11], off
    v_add_co_u32 v10, vcc, s66, v10
    s_nop 1
    v_addc_co_u32 v11, vcc, 0, v11, vcc
    global_load_dwordx2 v[102:103], v[10:11], off
    v_add_co_u32 v10, vcc, s67, v10
    s_nop 1
    v_addc_co_u32 v11, vcc, 0, v11, vcc
    global_load_dwordx2 v[104:105], v[10:11], off
    v_add_co_u32 v10, vcc, s66, v10
    s_nop 1
    v_addc_co_u32 v11, vcc, 0, v11, vcc
    global_load_dwordx2 v[106:107], v[10:11], off
    v_add_co_u32 v10, vcc, s66, v10
    s_nop 1
    v_addc_co_u32 v11, vcc, 0, v11, vcc
    global_load_dwordx2 v[108:109], v[10:11], off
    v_add_co_u32 v10, vcc, s66, v10
    s_nop 1
    v_addc_co_u32 v11, vcc, 0, v11, vcc
    global_load_dwordx2 v[110:111], v[10:11], off
    v_add_co_u32 v10, vcc, s66, v10
    s_nop 1
    v_addc_co_u32 v11, vcc, 0, v11, vcc
    global_load_dwordx2 v[112:113], v[10:11], off
    v_add_co_u32 v10, vcc, s66, v10
    s_nop 1
    v_addc_co_u32 v11, vcc, 0, v11, vcc
    global_load_dwordx2 v[114:115], v[10:11], off
    v_add_co_u32 v10, vcc, s66, v10
    s_nop 1
    v_addc_co_u32 v11, vcc, 0, v11, vcc
    global_load_dwordx2 v[116:117], v[10:11], off
    v_add_co_u32 v10, vcc, s66, v10
    s_nop 1
    v_addc_co_u32 v11, vcc, 0, v11, vcc
    global_load_dwordx2 v[118:119], v[10:11], off
    v_add_co_u32 v10, vcc, s67, v10
    s_nop 1
    v_addc_co_u32 v11, vcc, 0, v11, vcc
    global_load_dwordx2 v[120:121], v[10:11], off
    v_add_co_u32 v10, vcc, s66, v10
    s_nop 1
    v_addc_co_u32 v11, vcc, 0, v11, vcc
    global_load_dwordx2 v[122:123], v[10:11], off
    v_add_co_u32 v10, vcc, s66, v10
    s_nop 1
    v_addc_co_u32 v11, vcc, 0, v11, vcc
    global_load_dwordx2 v[124:125], v[10:11], off
    v_add_co_u32 v10, vcc, s66, v10
    s_nop 1
    v_addc_co_u32 v11, vcc, 0, v11, vcc
    global_load_dwordx2 v[126:127], v[10:11], off
    v_add_co_u32 v10, vcc, s66, v10
    s_nop 1
    v_addc_co_u32 v11, vcc, 0, v11, vcc
    global_load_dwordx2 v[128:129], v[10:11], off
    v_add_co_u32 v10, vcc, s66, v10
    s_nop 1
    v_addc_co_u32 v11, vcc, 0, v11, vcc
    global_load_dwordx2 v[130:131], v[10:11], off
    v_add_co_u32 v10, vcc, s66, v10
    s_nop 1
    v_addc_co_u32 v11, vcc, 0, v11, vcc
    global_load_dwordx2 v[132:133], v[10:11], off
    v_add_co_u32 v10, vcc, s66, v10
    s_nop 1
    v_addc_co_u32 v11, vcc, 0, v11, vcc
    global_load_dwordx2 v[134:135], v[10:11], off
    v_add_co_u32 v10, vcc, s67, v10
    s_nop 1
    v_addc_co_u32 v11, vcc, 0, v11, vcc
    global_load_dwordx2 v[136:137], v[10:11], off
    v_add_co_u32 v10, vcc, s66, v10
    s_nop 1
    v_addc_co_u32 v11, vcc, 0, v11, vcc
    global_load_dwordx2 v[138:139], v[10:11], off
    v_add_co_u32 v10, vcc, s66, v10
    s_nop 1
    v_addc_co_u32 v11, vcc, 0, v11, vcc
    global_load_dwordx2 v[140:141], v[10:11], off
    v_add_co_u32 v10, vcc, s66, v10
    s_nop 1
    v_addc_co_u32 v11, vcc, 0, v11, vcc
    global_load_dwordx2 v[142:143], v[10:11], off
    v_add_co_u32 v10, vcc, s66, v10
    s_nop 1
    v_addc_co_u32 v11, vcc, 0, v11, vcc
    global_load_dwordx2 v[144:145], v[10:11], off
    v_add_co_u32 v10, vcc, s66, v10
    s_nop 1
    v_addc_co_u32 v11, vcc, 0, v11, vcc
    global_load_dwordx2 v[146:147], v[10:11], off
    v_add_co_u32 v10, vcc, s66, v10
    s_nop 1
    v_addc_co_u32 v11, vcc, 0, v11, vcc
    global_load_dwordx2 v[148:149], v[10:11], off
    v_add_co_u32 v10, vcc, s66, v10
    s_nop 1
    v_addc_co_u32 v11, vcc, 0, v11, vcc
    global_load_dwordx2 v[150:151], v[10:11], off
    v_add_co_u32 v10, vcc, s67, v10
    s_nop 1
    v_addc_co_u32 v11, vcc, 0, v11, vcc
    global_load_dwordx2 v[152:153], v[10:11], off
    v_add_co_u32 v10, vcc, s66, v10
    s_nop 1
    v_addc_co_u32 v11, vcc, 0, v11, vcc
    global_load_dwordx2 v[154:155], v[10:11], off
    v_add_co_u32 v10, vcc, s66, v10
    s_nop 1
    v_addc_co_u32 v11, vcc, 0, v11, vcc
    global_load_dwordx2 v[156:157], v[10:11], off
    v_add_co_u32 v10, vcc, s66, v10
    s_nop 1
    v_addc_co_u32 v11, vcc, 0, v11, vcc
    global_load_dwordx2 v[158:159], v[10:11], off
    v_add_co_u32 v10, vcc, s66, v10
    s_nop 1
    v_addc_co_u32 v11, vcc, 0, v11, vcc
    global_load_dwordx2 v[160:161], v[10:11], off
    v_add_co_u32 v10, vcc, s66, v10
    s_nop 1
    v_addc_co_u32 v11, vcc, 0, v11, vcc
    global_load_dwordx2 v[162:163], v[10:11], off
    v_add_co_u32 v10, vcc, s66, v10
    s_nop 1
    v_addc_co_u32 v11, vcc, 0, v11, vcc
    global_load_dwordx2 v[164:165], v[10:11], off
    v_add_co_u32 v10, vcc, s66, v10
    s_nop 1
    v_addc_co_u32 v11, vcc, 0, v11, vcc
    global_load_dwordx2 v[166:167], v[10:11], off
    s_mov_b32 s66, 0x05040100
    s_mov_b32 s67, 0x07060302
    s_waitcnt vmcnt(40)
    v_perm_b32 v56, v74, v72, s66
    v_perm_b32 v60, v74, v72, s67
    v_perm_b32 v64, v75, v73, s66
    v_perm_b32 v68, v75, v73, s67
    v_perm_b32 v57, v78, v76, s66
    v_perm_b32 v61, v78, v76, s67
    v_perm_b32 v65, v79, v77, s66
    v_perm_b32 v69, v79, v77, s67
    v_perm_b32 v58, v82, v80, s66
    v_perm_b32 v62, v82, v80, s67
    v_perm_b32 v66, v83, v81, s66
    v_perm_b32 v70, v83, v81, s67
    v_perm_b32 v59, v86, v84, s66
    v_perm_b32 v63, v86, v84, s67
    v_perm_b32 v67, v87, v85, s66
    v_perm_b32 v71, v87, v85, s67
    s_waitcnt vmcnt(32)
    v_perm_b32 v72, v90, v88, s66
    v_perm_b32 v76, v90, v88, s67
    v_perm_b32 v80, v91, v89, s66
    v_perm_b32 v84, v91, v89, s67
    v_perm_b32 v73, v94, v92, s66
    v_perm_b32 v77, v94, v92, s67
    v_perm_b32 v81, v95, v93, s66
    v_perm_b32 v85, v95, v93, s67
    v_perm_b32 v74, v98, v96, s66
    v_perm_b32 v78, v98, v96, s67
    v_perm_b32 v82, v99, v97, s66
    v_perm_b32 v86, v99, v97, s67
    v_perm_b32 v75, v102, v100, s66
    v_perm_b32 v79, v102, v100, s67
    v_perm_b32 v83, v103, v101, s66
    v_perm_b32 v87, v103, v101, s67
    s_waitcnt vmcnt(24)
    v_perm_b32 v88, v106, v104, s66
    v_perm_b32 v92, v106, v104, s67
    v_perm_b32 v96, v107, v105, s66
    v_perm_b32 v100, v107, v105, s67
    v_perm_b32 v89, v110, v108, s66
    v_perm_b32 v93, v110, v108, s67
    v_perm_b32 v97, v111, v109, s66
    v_perm_b32 v101, v111, v109, s67
    v_perm_b32 v90, v114, v112, s66
    v_perm_b32 v94, v114, v112, s67
    v_perm_b32 v98, v115, v113, s66
    v_perm_b32 v102, v115, v113, s67
    v_perm_b32 v91, v118, v116, s66
    v_perm_b32 v95, v118, v116, s67
    v_perm_b32 v99, v119, v117, s66
    v_perm_b32 v103, v119, v117, s67
    s_waitcnt vmcnt(16)
    v_perm_b32 v104, v122, v120, s66
    v_perm_b32 v108, v122, v120, s67
    v_perm_b32 v112, v123, v121, s66
    v_perm_b32 v116, v123, v121, s67
    v_perm_b32 v105, v126, v124, s66
    v_perm_b32 v109, v126, v124, s67
    v_perm_b32 v113, v127, v125, s66
    v_perm_b32 v117, v127, v125, s67
    v_perm_b32 v106, v130, v128, s66
    v_perm_b32 v110, v130, v128, s67
    v_perm_b32 v114, v131, v129, s66
    v_perm_b32 v118, v131, v129, s67
    v_perm_b32 v107, v134, v132, s66
    v_perm_b32 v111, v134, v132, s67
    v_perm_b32 v115, v135, v133, s66
    v_perm_b32 v119, v135, v133, s67
    s_waitcnt vmcnt(8)
    v_perm_b32 v120, v138, v136, s66
    v_perm_b32 v124, v138, v136, s67
    v_perm_b32 v128, v139, v137, s66
    v_perm_b32 v132, v139, v137, s67
    v_perm_b32 v121, v142, v140, s66
    v_perm_b32 v125, v142, v140, s67
    v_perm_b32 v129, v143, v141, s66
    v_perm_b32 v133, v143, v141, s67
    v_perm_b32 v122, v146, v144, s66
    v_perm_b32 v126, v146, v144, s67
    v_perm_b32 v130, v147, v145, s66
    v_perm_b32 v134, v147, v145, s67
    v_perm_b32 v123, v150, v148, s66
    v_perm_b32 v127, v150, v148, s67
    v_perm_b32 v131, v151, v149, s66
    v_perm_b32 v135, v151, v149, s67
    s_waitcnt vmcnt(0)
    v_perm_b32 v136, v154, v152, s66
    v_perm_b32 v140, v154, v152, s67
    v_perm_b32 v144, v155, v153, s66
    v_perm_b32 v148, v155, v153, s67
    v_perm_b32 v137, v158, v156, s66
    v_perm_b32 v141, v158, v156, s67
    v_perm_b32 v145, v159, v157, s66
    v_perm_b32 v149, v159, v157, s67
    v_perm_b32 v138, v162, v160, s66
    v_perm_b32 v142, v162, v160, s67
    v_perm_b32 v146, v163, v161, s66
    v_perm_b32 v150, v163, v161, s67
    v_perm_b32 v139, v166, v164, s66
    v_perm_b32 v143, v166, v164, s67
    v_perm_b32 v147, v167, v165, s66
    v_perm_b32 v151, v167, v165, s67
    s_branch N_CHECK
N_WD:
    s_cmp_lg_u32 s38, 9
    s_cbranch_scc1 N_NOPF
    v_mov_b32 v8, s39
    v_mov_b32 v9, 0
    s_mov_b64 exec, 1
    buffer_store_dword v8, v9, s[40:43], s68 offen sc1
    s_mov_b64 exec, -1
N_NOPF:
    v_lshrrev_b32 v7, 3, v1
    v_bfe_u32 v10, v1, 1, 2
    v_xor_b32 v10, v10, v6
    v_and_b32 v11, 1, v1
    v_lshl_add_u32 v10, v10, 1, v11
    s_movk_i32 s66, 1152
    v_mul_lo_u32 v7, v7, s66
    v_lshl_add_u32 v7, v10, 4, v7
    s_mov_b32 s44, s30
    s_mov_b32 s45, s31
    s_mov_b32 s46, 5308416
    s_mov_b32 s47, 0x00020000
    s_sub_u32 s64, s38, 9
    s_mul_i32 s65, s53, 110592
    s_mul_i32 s66, s64, 384
    s_add_u32 s65, s65, s66
    s_mul_i32 s66, s64, 36864
    s_add_u32 m0, s66, 0
    s_add_u32 s67, s65, 0
    buffer_load_dwordx4 v7, s[44:47], s67 offen lds
    s_add_u32 m0, s66, 1024
    s_add_u32 s67, s65, 9216
    buffer_load_dwordx4 v7, s[44:47], s67 offen lds
    s_add_u32 m0, s66, 2048
    s_add_u32 s67, s65, 18432
    buffer_load_dwordx4 v7, s[44:47], s67 offen lds
    s_add_u32 m0, s66, 3072
    s_add_u32 s67, s65, 27648
    buffer_load_dwordx4 v7, s[44:47], s67 offen lds
    s_add_u32 m0, s66, 4096
    s_add_u32 s67, s65, 36864
    buffer_load_dwordx4 v7, s[44:47], s67 offen lds
    s_add_u32 m0, s66, 5120
    s_add_u32 s67, s65, 46080
    buffer_load_dwordx4 v7, s[44:47], s67 offen lds
    s_add_u32 m0, s66, 6144
    s_add_u32 s67, s65, 55296
    buffer_load_dwordx4 v7, s[44:47], s67 offen lds
    s_add_u32 m0, s66, 7168
    s_add_u32 s67, s65, 64512
    buffer_load_dwordx4 v7, s[44:47], s67 offen lds
    s_add_u32 m0, s66, 8192
    s_add_u32 s67, s65, 73728
    buffer_load_dwordx4 v7, s[44:47], s67 offen lds
    s_add_u32 m0, s66, 9216
    s_add_u32 s67, s65, 82944
    buffer_load_dwordx4 v7, s[44:47], s67 offen lds
    s_add_u32 m0, s66, 10240
    s_add_u32 s67, s65, 92160
    buffer_load_dwordx4 v7, s[44:47], s67 offen lds
    s_add_u32 m0, s66, 11264
    s_add_u32 s67, s65, 101376
    buffer_load_dwordx4 v7, s[44:47], s67 offen lds
    s_add_u32 m0, s66, 12288
    s_add_u32 s67, s65, 128
    buffer_load_dwordx4 v7, s[44:47], s67 offen lds
    s_add_u32 m0, s66, 13312
    s_add_u32 s67, s65, 9344
    buffer_load_dwordx4 v7, s[44:47], s67 offen lds
    s_add_u32 m0, s66, 14336
    s_add_u32 s67, s65, 18560
    buffer_load_dwordx4 v7, s[44:47], s67 offen lds
    s_add_u32 m0, s66, 15360
    s_add_u32 s67, s65, 27776
    buffer_load_dwordx4 v7, s[44:47], s67 offen lds
    s_add_u32 m0, s66, 16384
    s_add_u32 s67, s65, 36992
    buffer_load_dwordx4 v7, s[44:47], s67 offen lds
    s_add_u32 m0, s66, 17408
    s_add_u32 s67, s65, 46208
    buffer_load_dwordx4 v7, s[44:47], s67 offen lds
    s_add_u32 m0, s66, 18432
    s_add_u32 s67, s65, 55424
    buffer_load_dwordx4 v7, s[44:47], s67 offen lds
    s_add_u32 m0, s66, 19456
    s_add_u32 s67, s65, 64640
    buffer_load_dwordx4 v7, s[44:47], s67 offen lds
    s_add_u32 m0, s66, 20480
    s_add_u32 s67, s65, 73856
    buffer_load_dwordx4 v7, s[44:47], s67 offen lds
    s_add_u32 m0, s66, 21504
    s_add_u32 s67, s65, 83072
    buffer_load_dwordx4 v7, s[44:47], s67 offen lds
    s_add_u32 m0, s66, 22528
    s_add_u32 s67, s65, 92288
    buffer_load_dwordx4 v7, s[44:47], s67 offen lds
    s_add_u32 m0, s66, 23552
    s_add_u32 s67, s65, 101504
    buffer_load_dwordx4 v7, s[44:47], s67 offen lds
    s_add_u32 m0, s66, 24576
    s_add_u32 s67, s65, 256
    buffer_load_dwordx4 v7, s[44:47], s67 offen lds
    s_add_u32 m0, s66, 25600
    s_add_u32 s67, s65, 9472
    buffer_load_dwordx4 v7, s[44:47], s67 offen lds
    s_add_u32 m0, s66, 26624
    s_add_u32 s67, s65, 18688
    buffer_load_dwordx4 v7, s[44:47], s67 offen lds
    s_add_u32 m0, s66, 27648
    s_add_u32 s67, s65, 27904
    buffer_load_dwordx4 v7, s[44:47], s67 offen lds
    s_add_u32 m0, s66, 28672
    s_add_u32 s67, s65, 37120
    buffer_load_dwordx4 v7, s[44:47], s67 offen lds
    s_add_u32 m0, s66, 29696
    s_add_u32 s67, s65, 46336
    buffer_load_dwordx4 v7, s[44:47], s67 offen lds
    s_add_u32 m0, s66, 30720
    s_add_u32 s67, s65, 55552
    buffer_load_dwordx4 v7, s[44:47], s67 offen lds
    s_add_u32 m0, s66, 31744
    s_add_u32 s67, s65, 64768
    buffer_load_dwordx4 v7, s[44:47], s67 offen lds
    s_add_u32 m0, s66, 32768
    s_add_u32 s67, s65, 73984
    buffer_load_dwordx4 v7, s[44:47], s67 offen lds
    s_add_u32 m0, s66, 33792
    s_add_u32 s67, s65, 83200
    buffer_load_dwordx4 v7, s[44:47], s67 offen lds
    s_add_u32 m0, s66, 34816
    s_add_u32 s67, s65, 92416
    buffer_load_dwordx4 v7, s[44:47], s67 offen lds
    s_add_u32 m0, s66, 35840
    s_add_u32 s67, s65, 101632
    buffer_load_dwordx4 v7, s[44:47], s67 offen lds
N_CHECK:
    s_cmp_ge_u32 s38, 4
    s_cbranch_scc1 TOP8
    v_lshlrev_b32 v9, 6, v0
    s_movk_i32 s64, 4100
    s_movk_i32 s60, 4000
N_STP:
    buffer_load_dword v10, v9, s[40:43], s64 offen sc1
    s_waitcnt vmcnt(0)
    v_cmp_ne_u32 vcc, s39, v10
    s_nop 0
    s_and_b64 exec, exec, vcc
    s_cbranch_execz N_STP_D
    s_sub_u32 s60, s60, 1
    s_cmp_gt_i32 s60, 0
    s_sleep 1
    s_cbranch_scc1 N_STP
N_STP_D:
    s_mov_b64 exec, -1
    s_lshl_b32 s64, s53, 2
    s_add_u32 s64, s64, s38
    s_mul_i32 s64, s64, 11520
    s_add_u32 s64, s64, 2424832
    v_mov_b32 v9, 0
    s_mov_b64 exec, 1
    s_movk_i32 s60, 4000
N_ZH:
    buffer_load_dword v10, v9, s[40:43], s64 offen sc1
    s_waitcnt vmcnt(0)
    v_cmp_eq_u32 vcc, -1, v10
    s_nop 0
    s_and_b64 exec, exec, vcc
    s_cbranch_execz N_ZH_D
    s_sub_u32 s60, s60, 1
    s_cmp_gt_i32 s60, 0
    s_sleep 1
    s_cbranch_scc1 N_ZH
N_ZH_D:
    s_mov_b64 exec, -1
TOP8:
    v_and_b32 v10, 15, v1
    v_lshlrev_b32 v10, 5, v10
    v_add_u32 v10, 133376, v10
    s_cmp_ge_u32 s38, 4
    s_cbranch_scc1 T_S2
    v_lshlrev_b32 v9, 5, v0
    s_mov_b32 s65, 32768
    v_lshrrev_b32 v11, 4, v0
    v_lshlrev_b32 v11, 5, v11
    v_add_u32 v11, 133376, v11
    s_cmp_ge_u32 s2, 192
    s_cselect_b64 exec, -1, 1
    s_movk_i32 s60, 4000
    s_cmp_lt_u32 s2, 192
    s_cselect_b32 s61, 0, 1
T_KP:
    buffer_load_dwordx4 v[28:31], v9, s[40:43], s65 offen sc1
    buffer_load_dwordx4 v[32:35], v9, s[40:43], s65 offen offset:16 sc1
    s_waitcnt vmcnt(0)
    v_max3_u32 v45, v28, v29, v30
    v_max3_u32 v46, v31, v32, v33
    v_max3_u32 v45, v45, v34, v35
    v_max_u32 v45, v45, v46
    v_cmp_eq_u32 vcc, -1, v45
    s_nop 0
    s_and_b64 exec, exec, vcc
    s_cbranch_execz T_KP_D
    s_sub_u32 s60, s60, 1
    s_cmp_gt_i32 s60, 0
    s_sleep 2
    s_cbranch_scc1 T_KP
T_KP_D:
    s_mov_b64 exec, -1
    s_xor_b32 s61, s61, 1
    s_cbranch_scc1 T_KP
    v_max_u32 v44, v28, v29
    v_min_u32 v29, v28, v29
    v_max_u32 v28, v30, v31
    v_min_u32 v31, v30, v31
    v_max_u32 v30, v32, v33
    v_min_u32 v33, v32, v33
    v_max_u32 v32, v34, v35
    v_min_u32 v35, v34, v35
    v_max_u32 v34, v44, v28
    v_min_u32 v28, v44, v28
    v_max_u32 v44, v29, v31
    v_min_u32 v31, v29, v31
    v_max_u32 v29, v30, v32
    v_min_u32 v32, v30, v32
    v_max_u32 v30, v33, v35
    v_min_u32 v35, v33, v35
    v_max_u32 v33, v44, v28
    v_min_u32 v28, v44, v28
    v_max_u32 v44, v30, v32
    v_min_u32 v32, v30, v32
    v_max_u32 v30, v34, v29
    v_min_u32 v29, v34, v29
    v_max_u32 v34, v31, v35
    v_min_u32 v35, v31, v35
    v_max_u32 v31, v33, v44
    v_min_u32 v44, v33, v44
    v_max_u32 v33, v28, v32
    v_min_u32 v32, v28, v32
    v_max_u32 v28, v31, v29
    v_min_u32 v29, v31, v29
    v_max_u32 v31, v34, v32
    v_min_u32 v32, v34, v32
    v_max_u32 v34, v33, v29
    v_min_u32 v29, v33, v29
    v_max_u32 v33, v31, v44
    v_min_u32 v44, v31, v44
    v_max_u32 v31, v33, v29
    v_min_u32 v29, v33, v29
    v_max_u32_dpp v36, v35, v30 quad_perm:[1,0,3,2] row_mask:0xf bank_mask:0xf
    v_max_u32_dpp v37, v32, v28 quad_perm:[1,0,3,2] row_mask:0xf bank_mask:0xf
    v_max_u32_dpp v38, v44, v34 quad_perm:[1,0,3,2] row_mask:0xf bank_mask:0xf
    v_max_u32_dpp v39, v29, v31 quad_perm:[1,0,3,2] row_mask:0xf bank_mask:0xf
    v_max_u32_dpp v40, v31, v29 quad_perm:[1,0,3,2] row_mask:0xf bank_mask:0xf
    v_max_u32_dpp v41, v34, v44 quad_perm:[1,0,3,2] row_mask:0xf bank_mask:0xf
    v_max_u32_dpp v42, v28, v32 quad_perm:[1,0,3,2] row_mask:0xf bank_mask:0xf
    v_max_u32_dpp v43, v30, v35 quad_perm:[1,0,3,2] row_mask:0xf bank_mask:0xf
    v_max_u32 v33, v36, v40
    v_min_u32 v40, v36, v40
    v_max_u32 v36, v37, v41
    v_min_u32 v41, v37, v41
    v_max_u32 v37, v38, v42
    v_min_u32 v42, v38, v42
    v_max_u32 v38, v39, v43
    v_min_u32 v43, v39, v43
    v_max_u32 v39, v33, v37
    v_min_u32 v37, v33, v37
    v_max_u32 v33, v36, v38
    v_min_u32 v38, v36, v38
    v_max_u32 v36, v40, v42
    v_min_u32 v42, v40, v42
    v_max_u32 v40, v41, v43
    v_min_u32 v43, v41, v43
    v_max_u32 v41, v39, v33
    v_min_u32 v33, v39, v33
    v_max_u32 v39, v37, v38
    v_min_u32 v38, v37, v38
    v_max_u32 v37, v36, v40
    v_min_u32 v40, v36, v40
    v_max_u32 v36, v42, v43
    v_min_u32 v43, v42, v43
    s_nop 1
    v_max_u32_dpp v30, v43, v41 quad_perm:[2,3,0,1] row_mask:0xf bank_mask:0xf
    v_max_u32_dpp v28, v36, v33 quad_perm:[2,3,0,1] row_mask:0xf bank_mask:0xf
    v_max_u32_dpp v34, v40, v39 quad_perm:[2,3,0,1] row_mask:0xf bank_mask:0xf
    v_max_u32_dpp v31, v37, v38 quad_perm:[2,3,0,1] row_mask:0xf bank_mask:0xf
    v_max_u32_dpp v29, v38, v37 quad_perm:[2,3,0,1] row_mask:0xf bank_mask:0xf
    v_max_u32_dpp v44, v39, v40 quad_perm:[2,3,0,1] row_mask:0xf bank_mask:0xf
    v_max_u32_dpp v32, v33, v36 quad_perm:[2,3,0,1] row_mask:0xf bank_mask:0xf
    v_max_u32_dpp v35, v41, v43 quad_perm:[2,3,0,1] row_mask:0xf bank_mask:0xf
    v_max_u32 v42, v30, v29
    v_min_u32 v29, v30, v29
    v_max_u32 v30, v28, v44
    v_min_u32 v44, v28, v44
    v_max_u32 v28, v34, v32
    v_min_u32 v32, v34, v32
    v_max_u32 v34, v31, v35
    v_min_u32 v35, v31, v35
    v_max_u32 v31, v42, v28
    v_min_u32 v28, v42, v28
    v_max_u32 v42, v30, v34
    v_min_u32 v34, v30, v34
    v_max_u32 v30, v29, v32
    v_min_u32 v32, v29, v32
    v_max_u32 v29, v44, v35
    v_min_u32 v35, v44, v35
    v_max_u32 v44, v31, v42
    v_min_u32 v42, v31, v42
    v_max_u32 v31, v28, v34
    v_min_u32 v34, v28, v34
    v_max_u32 v28, v30, v29
    v_min_u32 v29, v30, v29
    v_max_u32 v30, v32, v35
    v_min_u32 v35, v32, v35
    s_nop 1
    v_max_u32_dpp v41, v35, v44 row_half_mirror row_mask:0xf bank_mask:0xf
    v_max_u32_dpp v33, v30, v42 row_half_mirror row_mask:0xf bank_mask:0xf
    v_max_u32_dpp v39, v29, v31 row_half_mirror row_mask:0xf bank_mask:0xf
    v_max_u32_dpp v38, v28, v34 row_half_mirror row_mask:0xf bank_mask:0xf
    v_max_u32_dpp v37, v34, v28 row_half_mirror row_mask:0xf bank_mask:0xf
    v_max_u32_dpp v40, v31, v29 row_half_mirror row_mask:0xf bank_mask:0xf
    v_max_u32_dpp v36, v42, v30 row_half_mirror row_mask:0xf bank_mask:0xf
    v_max_u32_dpp v43, v44, v35 row_half_mirror row_mask:0xf bank_mask:0xf
    v_max_u32 v32, v41, v37
    v_min_u32 v37, v41, v37
    v_max_u32 v41, v33, v40
    v_min_u32 v40, v33, v40
    v_max_u32 v33, v39, v36
    v_min_u32 v36, v39, v36
    v_max_u32 v39, v38, v43
    v_min_u32 v43, v38, v43
    v_max_u32 v38, v32, v33
    v_min_u32 v33, v32, v33
    v_max_u32 v32, v41, v39
    v_min_u32 v39, v41, v39
    v_max_u32 v41, v37, v36
    v_min_u32 v36, v37, v36
    v_max_u32 v37, v40, v43
    v_min_u32 v43, v40, v43
    v_max_u32 v40, v38, v32
    v_min_u32 v32, v38, v32
    v_max_u32 v38, v33, v39
    v_min_u32 v39, v33, v39
    v_max_u32 v33, v41, v37
    v_min_u32 v37, v41, v37
    v_max_u32 v41, v36, v43
    v_min_u32 v43, v36, v43
    s_nop 1
    v_max_u32_dpp v44, v43, v40 row_mirror row_mask:0xf bank_mask:0xf
    v_max_u32_dpp v42, v41, v32 row_mirror row_mask:0xf bank_mask:0xf
    v_max_u32_dpp v31, v37, v38 row_mirror row_mask:0xf bank_mask:0xf
    v_max_u32_dpp v34, v33, v39 row_mirror row_mask:0xf bank_mask:0xf
    v_max_u32_dpp v28, v39, v33 row_mirror row_mask:0xf bank_mask:0xf
    v_max_u32_dpp v29, v38, v37 row_mirror row_mask:0xf bank_mask:0xf
    v_max_u32_dpp v30, v32, v41 row_mirror row_mask:0xf bank_mask:0xf
    v_max_u32_dpp v35, v40, v43 row_mirror row_mask:0xf bank_mask:0xf
    v_max_u32 v36, v44, v28
    v_min_u32 v28, v44, v28
    v_max_u32 v44, v42, v29
    v_min_u32 v29, v42, v29
    v_max_u32 v42, v31, v30
    v_min_u32 v30, v31, v30
    v_max_u32 v31, v34, v35
    v_min_u32 v35, v34, v35
    v_max_u32 v34, v36, v42
    v_min_u32 v42, v36, v42
    v_max_u32 v36, v44, v31
    v_min_u32 v31, v44, v31
    v_max_u32 v44, v28, v30
    v_min_u32 v30, v28, v30
    v_max_u32 v28, v29, v35
    v_min_u32 v35, v29, v35
    v_max_u32 v29, v34, v36
    v_min_u32 v36, v34, v36
    v_max_u32 v34, v42, v31
    v_min_u32 v31, v42, v31
    v_max_u32 v42, v44, v28
    v_min_u32 v28, v44, v28
    v_max_u32 v44, v30, v35
    v_min_u32 v35, v30, v35
    v_mov_b32 v48, v29
    v_mov_b32 v49, v36
    v_mov_b32 v50, v34
    v_mov_b32 v51, v31
    v_mov_b32 v52, v42
    v_mov_b32 v53, v28
    v_mov_b32 v54, v44
    v_mov_b32 v55, v35
    s_mov_b32 exec_lo, 0x00010001
    s_mov_b32 exec_hi, 0x00010001
    ds_write_b128 v11, v[48:51]
    ds_write_b128 v11, v[52:55] offset:16
    s_mov_b64 exec, -1
    s_waitcnt lgkmcnt(0)
T_S2:
    s_barrier
    ds_read_b128 v[28:31], v10
    ds_read_b128 v[32:35], v10 offset:16
    s_waitcnt lgkmcnt(0)
    v_max_u32_dpp v36, v35, v28 quad_perm:[1,0,3,2] row_mask:0xf bank_mask:0xf
    v_max_u32_dpp v37, v34, v29 quad_perm:[1,0,3,2] row_mask:0xf bank_mask:0xf
    v_max_u32_dpp v38, v33, v30 quad_perm:[1,0,3,2] row_mask:0xf bank_mask:0xf
    v_max_u32_dpp v39, v32, v31 quad_perm:[1,0,3,2] row_mask:0xf bank_mask:0xf
    v_max_u32_dpp v40, v31, v32 quad_perm:[1,0,3,2] row_mask:0xf bank_mask:0xf
    v_max_u32_dpp v41, v30, v33 quad_perm:[1,0,3,2] row_mask:0xf bank_mask:0xf
    v_max_u32_dpp v42, v29, v34 quad_perm:[1,0,3,2] row_mask:0xf bank_mask:0xf
    v_max_u32_dpp v43, v28, v35 quad_perm:[1,0,3,2] row_mask:0xf bank_mask:0xf
    v_max_u32 v44, v36, v40
    v_min_u32 v40, v36, v40
    v_max_u32 v36, v37, v41
    v_min_u32 v41, v37, v41
    v_max_u32 v37, v38, v42
    v_min_u32 v42, v38, v42
    v_max_u32 v38, v39, v43
    v_min_u32 v43, v39, v43
    v_max_u32 v39, v44, v37
    v_min_u32 v37, v44, v37
    v_max_u32 v44, v36, v38
    v_min_u32 v38, v36, v38
    v_max_u32 v36, v40, v42
    v_min_u32 v42, v40, v42
    v_max_u32 v40, v41, v43
    v_min_u32 v43, v41, v43
    v_max_u32 v41, v39, v44
    v_min_u32 v44, v39, v44
    v_max_u32 v39, v37, v38
    v_min_u32 v38, v37, v38
    v_max_u32 v37, v36, v40
    v_min_u32 v40, v36, v40
    v_max_u32 v36, v42, v43
    v_min_u32 v43, v42, v43
    s_nop 1
    v_max_u32_dpp v28, v43, v41 quad_perm:[2,3,0,1] row_mask:0xf bank_mask:0xf
    v_max_u32_dpp v29, v36, v44 quad_perm:[2,3,0,1] row_mask:0xf bank_mask:0xf
    v_max_u32_dpp v30, v40, v39 quad_perm:[2,3,0,1] row_mask:0xf bank_mask:0xf
    v_max_u32_dpp v31, v37, v38 quad_perm:[2,3,0,1] row_mask:0xf bank_mask:0xf
    v_max_u32_dpp v32, v38, v37 quad_perm:[2,3,0,1] row_mask:0xf bank_mask:0xf
    v_max_u32_dpp v33, v39, v40 quad_perm:[2,3,0,1] row_mask:0xf bank_mask:0xf
    v_max_u32_dpp v34, v44, v36 quad_perm:[2,3,0,1] row_mask:0xf bank_mask:0xf
    v_max_u32_dpp v35, v41, v43 quad_perm:[2,3,0,1] row_mask:0xf bank_mask:0xf
    v_max_u32 v42, v28, v32
    v_min_u32 v32, v28, v32
    v_max_u32 v28, v29, v33
    v_min_u32 v33, v29, v33
    v_max_u32 v29, v30, v34
    v_min_u32 v34, v30, v34
    v_max_u32 v30, v31, v35
    v_min_u32 v35, v31, v35
    v_max_u32 v31, v42, v29
    v_min_u32 v29, v42, v29
    v_max_u32 v42, v28, v30
    v_min_u32 v30, v28, v30
    v_max_u32 v28, v32, v34
    v_min_u32 v34, v32, v34
    v_max_u32 v32, v33, v35
    v_min_u32 v35, v33, v35
    v_max_u32 v33, v31, v42
    v_min_u32 v42, v31, v42
    v_max_u32 v31, v29, v30
    v_min_u32 v30, v29, v30
    v_max_u32 v29, v28, v32
    v_min_u32 v32, v28, v32
    v_max_u32 v28, v34, v35
    v_min_u32 v35, v34, v35
    s_nop 1
    v_max_u32_dpp v41, v35, v33 row_half_mirror row_mask:0xf bank_mask:0xf
    v_max_u32_dpp v44, v28, v42 row_half_mirror row_mask:0xf bank_mask:0xf
    v_max_u32_dpp v39, v32, v31 row_half_mirror row_mask:0xf bank_mask:0xf
    v_max_u32_dpp v38, v29, v30 row_half_mirror row_mask:0xf bank_mask:0xf
    v_max_u32_dpp v37, v30, v29 row_half_mirror row_mask:0xf bank_mask:0xf
    v_max_u32_dpp v40, v31, v32 row_half_mirror row_mask:0xf bank_mask:0xf
    v_max_u32_dpp v36, v42, v28 row_half_mirror row_mask:0xf bank_mask:0xf
    v_max_u32_dpp v43, v33, v35 row_half_mirror row_mask:0xf bank_mask:0xf
    v_max_u32 v34, v41, v37
    v_min_u32 v37, v41, v37
    v_max_u32 v41, v44, v40
    v_min_u32 v40, v44, v40
    v_max_u32 v44, v39, v36
    v_min_u32 v36, v39, v36
    v_max_u32 v39, v38, v43
    v_min_u32 v43, v38, v43
    v_max_u32 v38, v34, v44
    v_min_u32 v44, v34, v44
    v_max_u32 v34, v41, v39
    v_min_u32 v39, v41, v39
    v_max_u32 v41, v37, v36
    v_min_u32 v36, v37, v36
    v_max_u32 v37, v40, v43
    v_min_u32 v43, v40, v43
    v_max_u32 v40, v38, v34
    v_min_u32 v34, v38, v34
    v_max_u32 v38, v44, v39
    v_min_u32 v39, v44, v39
    v_max_u32 v44, v41, v37
    v_min_u32 v37, v41, v37
    v_max_u32 v41, v36, v43
    v_min_u32 v43, v36, v43
    s_nop 1
    v_max_u32_dpp v33, v43, v40 row_mirror row_mask:0xf bank_mask:0xf
    v_max_u32_dpp v42, v41, v34 row_mirror row_mask:0xf bank_mask:0xf
    v_max_u32_dpp v31, v37, v38 row_mirror row_mask:0xf bank_mask:0xf
    v_max_u32_dpp v30, v44, v39 row_mirror row_mask:0xf bank_mask:0xf
    v_max_u32_dpp v29, v39, v44 row_mirror row_mask:0xf bank_mask:0xf
    v_max_u32_dpp v32, v38, v37 row_mirror row_mask:0xf bank_mask:0xf
    v_max_u32_dpp v28, v34, v41 row_mirror row_mask:0xf bank_mask:0xf
    v_max_u32_dpp v35, v40, v43 row_mirror row_mask:0xf bank_mask:0xf
    v_readfirstlane_b32 s44, v33
    v_readfirstlane_b32 s45, v42
    v_readfirstlane_b32 s46, v31
    v_readfirstlane_b32 s47, v30
    v_readfirstlane_b32 s48, v29
    v_readfirstlane_b32 s49, v32
    v_readfirstlane_b32 s50, v28
    v_readfirstlane_b32 s51, v35
    s_cmp_ge_u32 s2, 192
    s_cbranch_scc1 FFN1
    s_cmp_ge_u32 s2, 144
    s_cbranch_scc1 END
    s_cmp_ge_u32 s2, 128
    s_cbranch_scc1 FINAL
    s_cmp_ge_u32 s38, 9
    s_cbranch_scc1 END
    v_sub_u32 v9, 0x7ff, v4
    v_mov_b32 v10, -1
    s_and_b32 s64, s44, 0x7ff
    v_cmp_eq_u32 vcc, s64, v9
    s_nop 1
    v_cndmask_b32 v10, v10, 0, vcc
    s_and_b32 s64, s45, 0x7ff
    v_cmp_eq_u32 vcc, s64, v9
    s_nop 1
    v_cndmask_b32 v10, v10, 1, vcc
    s_and_b32 s64, s46, 0x7ff
    v_cmp_eq_u32 vcc, s64, v9
    s_nop 1
    v_cndmask_b32 v10, v10, 2, vcc
    s_and_b32 s64, s47, 0x7ff
    v_cmp_eq_u32 vcc, s64, v9
    s_nop 1
    v_cndmask_b32 v10, v10, 3, vcc
    s_and_b32 s64, s48, 0x7ff
    v_cmp_eq_u32 vcc, s64, v9
    s_nop 1
    v_cndmask_b32 v10, v10, 4, vcc
    s_and_b32 s64, s49, 0x7ff
    v_cmp_eq_u32 vcc, s64, v9
    s_nop 1
    v_cndmask_b32 v10, v10, 5, vcc
    s_and_b32 s64, s50, 0x7ff
    v_cmp_eq_u32 vcc, s64, v9
    s_nop 1
    v_cndmask_b32 v10, v10, 6, vcc
    s_and_b32 s64, s51, 0x7ff
    v_cmp_eq_u32 vcc, s64, v9
    s_nop 1
    v_cndmask_b32 v10, v10, 7, vcc
    s_mov_b32 s72, s32
    s_mov_b32 s73, s33
    s_mov_b32 s74, 2359296
    s_mov_b32 s75, 0x00020000
    s_movk_i32 s64, 1152
    v_mul_lo_u32 v11, v10, s64
    v_add_u32 v11, v11, v8
    s_mov_b32 s65, 49152
    v_cmp_le_i32 vcc, 0, v10
    s_nop 0
    s_and_saveexec_b64 s[70:71], vcc
    s_cbranch_execz O_NOSEL
    buffer_store_dwordx4 v[12:15], v11, s[40:43], s65 offen sc1
    buffer_store_dwordx4 v[16:19], v11, s[40:43], s65 offen offset:16 sc1
O_NOSEL:
    s_xor_b64 exec, exec, s[70:71]
    buffer_store_dwordx4 v[20:23], v7, s[72:75], 0 offen
    buffer_store_dwordx4 v[24:27], v7, s[72:75], 0 offen offset:16
    s_mov_b64 exec, -1
    s_branch FINAL
FFN1:
    v_and_b32 v5, 15, v1
    v_lshrrev_b32 v6, 4, v1
    s_cmp_ge_u32 s38, 9
    s_cbranch_scc1 F_WAITD
    v_mov_b32 v7, s44
    s_mov_b32 s66, 0x02020202
    s_mov_b32 s67, 0x02020202
    v_mov_b32 v8, s45
    v_cndmask_b32 v7, v7, v8, s[66:67]
    s_mov_b32 s66, 0x04040404
    s_mov_b32 s67, 0x04040404
    v_mov_b32 v8, s46
    v_cndmask_b32 v7, v7, v8, s[66:67]
    s_mov_b32 s66, 0x08080808
    s_mov_b32 s67, 0x08080808
    v_mov_b32 v8, s47
    v_cndmask_b32 v7, v7, v8, s[66:67]
    s_mov_b32 s66, 0x10101010
    s_mov_b32 s67, 0x10101010
    v_mov_b32 v8, s48
    v_cndmask_b32 v7, v7, v8, s[66:67]
    s_mov_b32 s66, 0x20202020
    s_mov_b32 s67, 0x20202020
    v_mov_b32 v8, s49
    v_cndmask_b32 v7, v7, v8, s[66:67]
    s_mov_b32 s66, 0x40404040
    s_mov_b32 s67, 0x40404040
    v_mov_b32 v8, s50
    v_cndmask_b32 v7, v7, v8, s[66:67]
    s_mov_b32 s66, 0x80808080
    s_mov_b32 s67, 0x80808080
    v_mov_b32 v8, s51
    v_cndmask_b32 v7, v7, v8, s[66:67]
    v_and_b32 v7, 0x7ff, v7
    v_sub_u32 v7, 0x7ff, v7
    s_movk_i32 s64, 1152
    v_mul_lo_u32 v7, v7, s64
    v_lshl_add_u32 v7, v6, 4, v7
    s_mul_i32 s64, s38, 43
    s_lshr_b32 s64, s64, 7
    s_mul_i32 s65, s64, 3
    s_sub_u32 s65, s38, s65
    s_mul_i32 s65, s65, 384
    s_add_u32 s65, s65, 2424832
    s_movk_i32 s60, 4000
F_ZP:
    buffer_load_dwordx4 v[8:11], v7, s[40:43], s65 offen offset:0 sc1
    buffer_load_dwordx4 v[12:15], v7, s[40:43], s65 offen offset:64 sc1
    buffer_load_dwordx4 v[16:19], v7, s[40:43], s65 offen offset:128 sc1
    buffer_load_dwordx4 v[20:23], v7, s[40:43], s65 offen offset:192 sc1
    buffer_load_dwordx4 v[24:27], v7, s[40:43], s65 offen offset:256 sc1
    buffer_load_dwordx4 v[28:31], v7, s[40:43], s65 offen offset:320 sc1
    s_waitcnt vmcnt(0)
    v_max3_u32 v48, v8, v9, v10
    v_max3_u32 v49, v11, v12, v13
    v_max3_u32 v48, v48, v14, v15
    v_max3_u32 v49, v49, v16, v17
    v_max3_u32 v48, v48, v18, v19
    v_max3_u32 v48, v48, v20, v21
    v_max3_u32 v49, v49, v22, v23
    v_max3_u32 v48, v48, v24, v25
    v_max3_u32 v48, v48, v26, v27
    v_max3_u32 v49, v49, v28, v29
    v_max3_u32 v48, v48, v30, v31
    v_max_u32 v48, v48, v49
    v_cmp_eq_u32 vcc, -1, v48
    s_nop 0
    s_and_b64 exec, exec, vcc
    s_cbranch_execz F_ZP_D
    s_sub_u32 s60, s60, 1
    s_cmp_gt_i32 s60, 0
    s_sleep 1
    s_cbranch_scc1 F_ZP
F_ZP_D:
    s_mov_b64 exec, -1
    v_mfma_f32_16x16x32_bf16 v[32:35], v[56:59], v[8:11], 0
    v_mfma_f32_16x16x32_bf16 v[36:39], v[60:63], v[8:11], 0
    v_mfma_f32_16x16x32_bf16 v[40:43], v[64:67], v[8:11], 0
    v_mfma_f32_16x16x32_bf16 v[44:47], v[68:71], v[8:11], 0
    v_mfma_f32_16x16x32_bf16 v[32:35], v[72:75], v[12:15], v[32:35]
    v_mfma_f32_16x16x32_bf16 v[36:39], v[76:79], v[12:15], v[36:39]
    v_mfma_f32_16x16x32_bf16 v[40:43], v[80:83], v[12:15], v[40:43]
    v_mfma_f32_16x16x32_bf16 v[44:47], v[84:87], v[12:15], v[44:47]
    v_mfma_f32_16x16x32_bf16 v[32:35], v[88:91], v[16:19], v[32:35]
    v_mfma_f32_16x16x32_bf16 v[36:39], v[92:95], v[16:19], v[36:39]
    v_mfma_f32_16x16x32_bf16 v[40:43], v[96:99], v[16:19], v[40:43]
    v_mfma_f32_16x16x32_bf16 v[44:47], v[100:103], v[16:19], v[44:47]
    v_mfma_f32_16x16x32_bf16 v[32:35], v[104:107], v[20:23], v[32:35]
    v_mfma_f32_16x16x32_bf16 v[36:39], v[108:111], v[20:23], v[36:39]
    v_mfma_f32_16x16x32_bf16 v[40:43], v[112:115], v[20:23], v[40:43]
    v_mfma_f32_16x16x32_bf16 v[44:47], v[116:119], v[20:23], v[44:47]
    v_mfma_f32_16x16x32_bf16 v[32:35], v[120:123], v[24:27], v[32:35]
    v_mfma_f32_16x16x32_bf16 v[36:39], v[124:127], v[24:27], v[36:39]
    v_mfma_f32_16x16x32_bf16 v[40:43], v[128:131], v[24:27], v[40:43]
    v_mfma_f32_16x16x32_bf16 v[44:47], v[132:135], v[24:27], v[44:47]
    v_mfma_f32_16x16x32_bf16 v[32:35], v[136:139], v[28:31], v[32:35]
    v_mfma_f32_16x16x32_bf16 v[36:39], v[140:143], v[28:31], v[36:39]
    v_mfma_f32_16x16x32_bf16 v[40:43], v[144:147], v[28:31], v[40:43]
    v_mfma_f32_16x16x32_bf16 v[44:47], v[148:151], v[28:31], v[44:47]
    s_lshl_b32 s66, s38, 11
    s_add_u32 s66, s66, 110592
    v_lshlrev_b32 v7, 7, v6
    v_lshl_add_u32 v7, v5, 4, v7
    v_add_u32 v7, s66, v7
    s_mov_b32 exec_lo, 0x00ff00ff
    s_mov_b32 exec_hi, 0x00ff00ff
    ds_write_b128 v7, v[32:35] offset:0
    ds_write_b128 v7, v[36:39] offset:512
    ds_write_b128 v7, v[40:43] offset:1024
    ds_write_b128 v7, v[44:47] offset:1536
    s_mov_b64 exec, -1
F_WAITD:
    s_lshr_b32 s64, s38, 2
    s_and_b32 s65, s38, 3
    s_mul_i32 s66, s64, 6144
    s_lshl_b32 s67, s65, 9
    s_add_u32 s66, s66, s67
    s_add_u32 s66, s66, 110592
    v_and_b32 v8, 7, v1
    v_bfe_u32 v9, v1, 3, 2
    v_lshrrev_b32 v10, 5, v1
    v_lshlrev_b32 v11, 4, v8
    v_lshl_add_u32 v11, v9, 2, v11
    v_lshl_add_u32 v11, v10, 7, v11
    v_add_u32 v11, s66, v11
    v_mul_u32_u24 v12, 208, v8
    v_lshl_add_u32 v12, v10, 5, v12
    v_lshl_add_u32 v12, v9, 3, v12
    s_lshl_b32 s66, s64, 6
    s_lshl_b32 s67, s65, 1
    s_add_u32 s66, s66, s67
    s_add_u32 s66, s66, 129024
    v_add_u32 v12, s66, v12
    s_waitcnt vmcnt(0) lgkmcnt(0)
    s_barrier
    ds_read_b32 v16, v11 offset:0
    ds_read_b32 v20, v11 offset:256
    ds_read_b32 v17, v11 offset:2048
    ds_read_b32 v21, v11 offset:2304
    ds_read_b32 v18, v11 offset:4096
    ds_read_b32 v22, v11 offset:4352
    v_lshrrev_b32 v13, 2, v5
    v_lshl_add_u32 v13, v6, 2, v13
    v_bfe_u32 v14, v13, 1, 2
    v_lshlrev_b32 v13, 7, v13
    v_and_b32 v15, 3, v5
    v_lshl_add_u32 v13, v15, 3, v13
    s_mul_i32 s66, s38, 12288
    v_add_u32 v13, s66, v13
    v_xor_b32 v15, 0, v14
    v_lshl_add_u32 v24, v15, 5, v13
    v_xor_b32 v15, 1, v14
    v_lshl_add_u32 v25, v15, 5, v13
    v_xor_b32 v15, 2, v14
    v_lshl_add_u32 v26, v15, 5, v13
    v_xor_b32 v15, 3, v14
    v_lshl_add_u32 v27, v15, 5, v13
    v_and_b32 v28, 7, v5
    v_mul_u32_u24 v28, 208, v28
    v_lshl_add_u32 v28, v6, 3, v28
    v_add_u32 v28, 129024, v28
    s_waitcnt lgkmcnt(0)
    v_add_f32 v16, v16, v17
    v_add_f32 v20, v20, v21
    v_add_f32 v16, v16, v18
    v_add_f32 v20, v20, v22
    v_cvt_pk_bf16_f32 v20, v16, v20
    v_lshlrev_b32 v16, 16, v20
    v_and_b32 v20, 0xffff0000, v20
    v_mul_f32 v17, 0xbfb8aa3b, v16
    v_exp_f32 v17, v17
    s_nop 0
    v_add_f32 v17, 1.0, v17
    v_rcp_f32 v17, v17
    s_nop 0
    v_mul_f32 v16, v16, v17
    v_cvt_pk_bf16_f32 v16, v16, v16
    v_lshlrev_b32 v16, 16, v16
    v_mul_f32 v16, v16, v20
    v_cvt_pk_bf16_f32 v16, v16, v16
    ds_write_b16 v12, v16
    s_cmp_ge_u32 s38, 9
    s_cbranch_scc1 F_NOA
    ds_read_b64_tr_b16 v[56:57], v24 offset:0
    ds_read_b64_tr_b16 v[58:59], v24 offset:2048
    ds_read_b64_tr_b16 v[60:61], v25 offset:0
    ds_read_b64_tr_b16 v[62:63], v25 offset:2048
    ds_read_b64_tr_b16 v[64:65], v26 offset:0
    ds_read_b64_tr_b16 v[66:67], v26 offset:2048
    ds_read_b64_tr_b16 v[68:69], v27 offset:0
    ds_read_b64_tr_b16 v[70:71], v27 offset:2048
    ds_read_b64_tr_b16 v[72:73], v24 offset:4096
    ds_read_b64_tr_b16 v[74:75], v24 offset:6144
    ds_read_b64_tr_b16 v[76:77], v25 offset:4096
    ds_read_b64_tr_b16 v[78:79], v25 offset:6144
    ds_read_b64_tr_b16 v[80:81], v26 offset:4096
    ds_read_b64_tr_b16 v[82:83], v26 offset:6144
    ds_read_b64_tr_b16 v[84:85], v27 offset:4096
    ds_read_b64_tr_b16 v[86:87], v27 offset:6144
    ds_read_b64_tr_b16 v[88:89], v24 offset:8192
    ds_read_b64_tr_b16 v[90:91], v24 offset:10240
    ds_read_b64_tr_b16 v[92:93], v25 offset:8192
    ds_read_b64_tr_b16 v[94:95], v25 offset:10240
    ds_read_b64_tr_b16 v[96:97], v26 offset:8192
    ds_read_b64_tr_b16 v[98:99], v26 offset:10240
    ds_read_b64_tr_b16 v[100:101], v27 offset:8192
    ds_read_b64_tr_b16 v[102:103], v27 offset:10240
F_NOA:
    s_waitcnt lgkmcnt(0)
    s_barrier
    s_cmp_ge_u32 s38, 9
    s_cbranch_scc1 END
    ds_read_b64 v[8:9], v28 offset:0
    ds_read_b64 v[10:11], v28 offset:32
    ds_read_b64 v[12:13], v28 offset:64
    ds_read_b64 v[14:15], v28 offset:96
    ds_read_b64 v[16:17], v28 offset:128
    ds_read_b64 v[18:19], v28 offset:160
    v_and_b32 v20, 7, v5
    s_movk_i32 s66, 2304
    v_mul_lo_u32 v20, v20, s66
    v_lshrrev_b32 v21, 3, v5
    v_lshl_add_u32 v20, v21, 6, v20
    v_lshl_add_u32 v20, v6, 4, v20
    s_mul_i32 s66, s53, 18432
    s_lshl_b32 s67, s38, 8
    s_add_u32 s66, s66, s67
    s_add_u32 s66, s66, 4784128
    s_waitcnt lgkmcnt(4)
    v_mfma_f32_16x16x32_bf16 v[32:35], v[56:59], v[8:11], 0
    v_mfma_f32_16x16x32_bf16 v[36:39], v[60:63], v[8:11], 0
    v_mfma_f32_16x16x32_bf16 v[40:43], v[64:67], v[8:11], 0
    v_mfma_f32_16x16x32_bf16 v[44:47], v[68:71], v[8:11], 0
    s_waitcnt lgkmcnt(2)
    v_mfma_f32_16x16x32_bf16 v[32:35], v[72:75], v[12:15], v[32:35]
    v_mfma_f32_16x16x32_bf16 v[36:39], v[76:79], v[12:15], v[36:39]
    v_mfma_f32_16x16x32_bf16 v[40:43], v[80:83], v[12:15], v[40:43]
    v_mfma_f32_16x16x32_bf16 v[44:47], v[84:87], v[12:15], v[44:47]
    s_waitcnt lgkmcnt(0)
    v_mfma_f32_16x16x32_bf16 v[32:35], v[88:91], v[16:19], v[32:35]
    v_mfma_f32_16x16x32_bf16 v[36:39], v[92:95], v[16:19], v[36:39]
    v_mfma_f32_16x16x32_bf16 v[40:43], v[96:99], v[16:19], v[40:43]
    v_mfma_f32_16x16x32_bf16 v[44:47], v[100:103], v[16:19], v[44:47]
    s_nop 5
    v_mov_b32_dpp v32, v36 row_shr:8 row_mask:0xf bank_mask:0xf
    v_mov_b32_dpp v33, v37 row_shr:8 row_mask:0xf bank_mask:0xf
    v_mov_b32_dpp v34, v38 row_shr:8 row_mask:0xf bank_mask:0xf
    v_mov_b32_dpp v35, v39 row_shr:8 row_mask:0xf bank_mask:0xf
    v_min_u32 v32, -2, v32
    v_min_u32 v33, -2, v33
    v_min_u32 v34, -2, v34
    v_min_u32 v35, -2, v35
    buffer_store_dwordx4 v[32:35], v20, s[40:43], s66 offen offset:0 sc1
    v_mov_b32_dpp v40, v44 row_shr:8 row_mask:0xf bank_mask:0xf
    v_mov_b32_dpp v41, v45 row_shr:8 row_mask:0xf bank_mask:0xf
    v_mov_b32_dpp v42, v46 row_shr:8 row_mask:0xf bank_mask:0xf
    v_mov_b32_dpp v43, v47 row_shr:8 row_mask:0xf bank_mask:0xf
    v_min_u32 v40, -2, v40
    v_min_u32 v41, -2, v41
    v_min_u32 v42, -2, v42
    v_min_u32 v43, -2, v43
    buffer_store_dwordx4 v[40:43], v20, s[40:43], s66 offen offset:128 sc1
    s_branch END
FINAL:
    s_cmp_ge_u32 s38, 7
    s_cbranch_scc1 END
    s_mul_i32 s64, s2, 3641
    s_lshr_b32 s64, s64, 16
    s_mul_i32 s65, s64, 18
    s_sub_u32 s65, s2, s65
    s_mov_b32 s66, s44
    s_cmp_eq_u32 s64, 1
    s_cselect_b32 s66, s45, s66
    s_cmp_eq_u32 s64, 2
    s_cselect_b32 s66, s46, s66
    s_cmp_eq_u32 s64, 3
    s_cselect_b32 s66, s47, s66
    s_cmp_eq_u32 s64, 4
    s_cselect_b32 s66, s48, s66
    s_cmp_eq_u32 s64, 5
    s_cselect_b32 s66, s49, s66
    s_cmp_eq_u32 s64, 6
    s_cselect_b32 s66, s50, s66
    s_cmp_eq_u32 s64, 7
    s_cselect_b32 s66, s51, s66
    s_and_b32 s67, s66, 0x7ff
    s_sub_u32 s67, 0x7ff, s67
    s_mul_i32 s67, s67, 1152
    s_lshl_b32 s68, s65, 6
    s_add_u32 s67, s67, s68
    s_cmp_eq_u32 s38, 6
    s_cbranch_scc1 FN_HZ
    v_lshrrev_b32 v4, 3, v0
    v_lshlrev_b32 v7, 2, v4
    s_movk_i32 s68, 18432
    v_mul_lo_u32 v4, v4, s68
    v_and_b32 v5, 7, v0
    v_lshl_add_u32 v4, v5, 4, v4
    s_mul_i32 s68, s64, 2304
    s_lshl_b32 s69, s65, 7
    s_add_u32 s68, s68, s69
    s_add_u32 s68, s68, 4784128
    s_lshl_b32 s69, s38, 7
    s_add_u32 s69, s69, 133888
    v_lshl_add_u32 v6, v5, 4, s69
    s_movk_i32 s69, 2048
    s_movk_i32 s60, 4000
FN_PF:
    buffer_load_dword v20, v7, s[40:43], s69 offen sc1
    s_waitcnt vmcnt(0)
    v_cmp_ne_u32 vcc, s39, v20
    s_nop 0
    s_and_b64 exec, exec, vcc
    s_cbranch_execz FN_PF_D
    s_sub_u32 s60, s60, 1
    s_cmp_gt_i32 s60, 0
    s_sleep 1
    s_cbranch_scc1 FN_PF
FN_PF_D:
    s_mov_b64 exec, -1
    s_mov_b64 exec, 1
    s_movk_i32 s60, 4000
    s_mov_b32 s61, 0
FN_PP:
    buffer_load_dwordx4 v[20:23], v4, s[40:43], s68 offen sc1
    s_waitcnt vmcnt(0)
    v_max_u32 v28, v20, v21
    v_max3_u32 v28, v28, v22, v23
    v_cmp_eq_u32 vcc, -1, v28
    s_nop 0
    s_and_b64 exec, exec, vcc
    s_cbranch_execz FN_PP_D
    s_sub_u32 s60, s60, 1
    s_cmp_gt_i32 s60, 0
    s_sleep 2
    s_cbranch_scc1 FN_PP
FN_PP_D:
    s_mov_b64 exec, -1
    s_xor_b32 s61, s61, 1
    s_cbranch_scc1 FN_PP
    v_add_f32_dpp v20, v20, v20 row_ror:8 row_mask:0xf bank_mask:0xf
    v_add_f32_dpp v21, v21, v21 row_ror:8 row_mask:0xf bank_mask:0xf
    v_add_f32_dpp v22, v22, v22 row_ror:8 row_mask:0xf bank_mask:0xf
    v_add_f32_dpp v23, v23, v23 row_ror:8 row_mask:0xf bank_mask:0xf
    v_mov_b32 v24, v20
    v_mov_b32 v25, v21
    v_mov_b32 v26, v22
    v_mov_b32 v27, v23
    v_permlane16_swap_b32 v20, v24
    v_permlane16_swap_b32 v21, v25
    v_permlane16_swap_b32 v22, v26
    v_permlane16_swap_b32 v23, v27
    v_add_f32 v20, v20, v24
    v_add_f32 v21, v21, v25
    v_add_f32 v22, v22, v26
    v_add_f32 v23, v23, v27
    v_mov_b32 v24, v20
    v_mov_b32 v25, v21
    v_mov_b32 v26, v22
    v_mov_b32 v27, v23
    v_permlane32_swap_b32 v20, v24
    v_permlane32_swap_b32 v21, v25
    v_permlane32_swap_b32 v22, v26
    v_permlane32_swap_b32 v23, v27
    v_add_f32 v20, v20, v24
    v_add_f32 v21, v21, v25
    v_add_f32 v22, v22, v26
    v_add_f32 v23, v23, v27
    s_mov_b64 exec, 0xff
    ds_write_b128 v6, v[20:23]
    s_mov_b64 exec, -1
    s_branch FN_B
FN_HZ:
    s_add_u32 s68, s67, 2424832
    s_mul_i32 s69, s64, 1152
    s_lshl_b32 s65, s65, 6
    s_add_u32 s69, s69, s65
    s_add_u32 s69, s69, 49088
    v_mov_b32 v4, s68
    v_mov_b32 v5, s69
    v_cmp_gt_u32 vcc, 4, v1
    s_nop 1
    v_cndmask_b32 v4, v5, v4, vcc
    v_lshl_add_u32 v4, v1, 4, v4
    v_lshlrev_b32 v6, 4, v1
    v_add_u32 v6, 134656, v6
    s_mov_b64 exec, 0xff
    s_movk_i32 s60, 4000
FN_HP:
    buffer_load_dwordx4 v[20:23], v4, s[40:43], 0 offen sc1
    s_waitcnt vmcnt(0)
    v_max_u32 v28, v20, v21
    v_max3_u32 v28, v28, v22, v23
    v_cmp_eq_u32 vcc, -1, v28
    s_nop 0
    s_and_b64 exec, exec, vcc
    s_cbranch_execz FN_HP_D
    s_sub_u32 s60, s60, 1
    s_cmp_gt_i32 s60, 0
    s_sleep 1
    s_cbranch_scc1 FN_HP
FN_HP_D:
    s_mov_b64 exec, 0xff
    ds_write_b128 v6, v[20:23]
    s_mov_b64 exec, -1
FN_B:
    s_waitcnt lgkmcnt(0)
    s_barrier
    s_cmp_lg_u32 s38, 0
    s_cbranch_scc1 END
    v_and_b32 v4, 31, v1
    v_lshlrev_b32 v5, 2, v4
    v_add_u32 v5, 133888, v5
    v_lshlrev_b32 v6, 1, v4
    v_add_u32 v7, 134656, v6
    ds_read_b32 v8, v5 offset:0
    ds_read_b32 v9, v5 offset:128
    ds_read_b32 v10, v5 offset:256
    ds_read_b32 v11, v5 offset:384
    ds_read_b32 v12, v5 offset:512
    ds_read_b32 v13, v5 offset:640
    ds_read_u16 v14, v7
    ds_read_u16 v15, v7 offset:64
    s_and_b32 s66, s66, 0xffff0000
    s_ashr_i32 s68, s66, 31
    s_not_b32 s68, s68
    s_or_b32 s68, s68, 0x80000000
    s_xor_b32 s66, s66, s68
    s_and_b32 s66, s66, 0xffff0000
    v_mov_b32 v16, s66
    v_mul_f32 v16, 0xbfb8aa3b, v16
    v_exp_f32 v16, v16
    s_nop 0
    v_add_f32 v16, 1.0, v16
    v_rcp_f32 v16, v16
    s_nop 0
    v_cvt_pk_bf16_f32 v16, v16, v16
    v_lshlrev_b32 v16, 16, v16
    s_mov_b32 s72, s32
    s_mov_b32 s73, s33
    s_mov_b32 s74, 2359296
    s_mov_b32 s75, 0x00020000
    s_waitcnt lgkmcnt(0)
    v_add_f32 v8, v8, v9
    v_add_f32 v10, v10, v11
    v_add_f32 v12, v12, v13
    v_add_f32 v8, v8, v10
    v_add_f32 v8, v8, v12
    v_cvt_pk_bf16_f32 v8, v8, v8
    v_lshlrev_b32 v8, 16, v8
    v_mul_f32 v8, v8, v16
    v_cvt_pk_bf16_f32 v8, v8, v8
    v_lshlrev_b32 v8, 16, v8
    v_lshlrev_b32 v14, 16, v14
    v_lshlrev_b32 v15, 16, v15
    v_add_f32 v8, v8, v14
    v_cvt_pk_bf16_f32 v8, v8, v8
    v_lshlrev_b32 v8, 16, v8
    v_add_f32 v8, v8, v15
    v_cvt_pk_bf16_f32 v8, v8, v8
    s_mov_b32 exec_hi, 0
    buffer_store_short v8, v6, s[72:75], s67 offen
    s_cmp_lg_u32 s2, 0
    s_cbranch_scc1 FN_NOEP
    v_mov_b32 v20, s39
    v_mov_b32 v21, 0
    s_mov_b64 exec, 1
    buffer_store_dword v20, v21, s[40:43], 0 offen sc1
FN_NOEP:
    s_mov_b64 exec, -1
END:
    s_endpgm
.section .rodata,"a"
.p2align 6
.amdhsa_kernel sequential_preLN__ssm_conv_s4__moe_arch_mod__prompt_kernel
  .amdhsa_next_free_vgpr 168
  .amdhsa_next_free_sgpr 102
  .amdhsa_accum_offset 168
  .amdhsa_group_segment_fixed_size 0
  .amdhsa_kernarg_size 136
  .amdhsa_user_sgpr_count 2
  .amdhsa_user_sgpr_kernarg_segment_ptr 1
  .amdhsa_system_sgpr_workgroup_id_x 1
.end_amdhsa_kernel
```

```asm
; @launch grid=(256,1,1) block=(768,1,1) lds=163840
.amdgcn_target "amdgcn-amd-amdhsa--gfx950"
    .text
    .globl sequential_preLN__ssm_conv_s4__moe_arch_mod__prompt_kernel
    .p2align 8
    .type sequential_preLN__ssm_conv_s4__moe_arch_mod__prompt_kernel,@function
sequential_preLN__ssm_conv_s4__moe_arch_mod__prompt_kernel:
    s_cmp_ge_u32 s2, 256
    s_cbranch_scc1 END
    s_load_dwordx16 s[4:19], s[0:1], 0
    s_load_dwordx2 s[36:37], s[0:1], 128
    s_load_dwordx16 s[20:35], s[0:1], 64
    v_lshrrev_b32 v2, 6, v0
    v_and_b32 v1, 63, v0
    v_readfirstlane_b32 s38, v2
    v_lshlrev_b32 v3, 4, v1
    s_mov_b32 s42, 0x10000000
    s_mov_b32 s43, 0x00020000
    s_cmp_ge_u32 s38, 4
    s_cbranch_scc1 P_B
    s_setprio 3
    v_lshrrev_b32 v147, 5, v0
    v_and_b32 v148, 31, v0
    v_mul_u32_u24 v140, 0x480, v147
    s_mul_i32 s44, s2, 9216
    v_mad_u32_u24 v140, v148, 12, v140
    v_mov_b32 v104, 0
    v_mov_b32 v105, 0
    v_mov_b32 v106, 0
    v_mov_b32 v107, 0
    v_add_u32 v140, s44, v140
    v_add_u32 v145, 161280, v3
    s_mov_b64 exec, 0xff
    ds_write_b128 v145, v[104:107]
    s_mov_b64 exec, -1
    v_and_b32 v147, 1, v147
    v_mul_u32_u24 v141, 0x90, v148
    v_lshl_add_u32 v141, v147, 6, v141
    s_lshl_b32 s45, s38, 4
    s_sub_u32 s45, 147504, s45
    v_add_u32 v141, s45, v141
    v_lshrrev_b32 v142, 3, v1
    v_add_u32 v142, v142, v1
    s_mul_i32 s45, s38, 3456
    s_add_u32 s45, s45, 147456
    v_lshl_add_u32 v142, v142, 4, s45
    v_lshrrev_b32 v143, 2, v1
    v_mul_u32_u24 v143, 16320, v143
    v_add_u32 v143, v143, v3
    s_lshl_b32 s46, s2, 6
    s_sub_u32 s46, 81856, s46
    s_mul_i32 s45, s38, 786432
    s_add_u32 s46, s46, s45
    s_add_u32 s47, s46, 262144
    s_add_u32 s48, s46, 524288
    s_mov_b32 s49, 0x05040100
    s_mov_b32 s50, 0x07060302
    v_mov_b32 v144, s49
    s_mov_b32 exec_lo, 0
    v_mov_b32 v144, s50
    s_mov_b64 exec, -1
    v_mov_b32 v145, 161328
    s_lshl_b32 s45, s38, 2
    v_add_u32 v146, s45, v145
    s_waitcnt lgkmcnt(0)
    global_load_dword v95, v104, s[36:37] offset:0
    global_load_dwordx3 v[60:62], v140, s[4:5] offset:0
    global_load_dwordx3 v[64:66], v140, s[4:5] offset:384
    global_load_dwordx3 v[68:70], v140, s[4:5] offset:768
    s_mov_b32 s40, s36
    s_mov_b32 s41, s37
    s_cmp_ge_u32 s2, 192
    s_cbranch_scc1 P_C
    s_lshr_b32 s65, s38, 2
    s_bitcmp1_b32 s2, 0
    s_addc_u32 s51, s65, 0
    s_cmp_eq_u32 s51, 3
    s_cselect_b32 s51, 0, s51
    s_lshl_b32 s52, s51, 8
    s_add_u32 s52, s52, 138048
    v_and_b32 v114, 0x7f, v0
    v_lshl_add_u32 v114, v114, 1, s52
    s_and_b32 s52, s2, 1
    s_add_u32 s52, s52, s51
    s_lshl_b32 s52, s52, 1
    s_add_u32 s52, s52, 142656
    v_mov_b32 v115, s52
    v_mov_b32 v119, 161292
    v_mov_b32 v29, 0
    v_mov_b32 v30, 0
    v_mov_b32 v31, 0
    v_mov_b32 v32, 0
    v_mov_b32 v33, 0
    v_mov_b32 v34, 0
    v_mov_b32 v35, 0
    v_mov_b32 v160, 0
    v_mov_b32 v161, 0
    v_mov_b32 v162, 0
    v_mov_b32 v163, 0
    v_lshlrev_b32 v16, 4, v0
    v_add_u32 v17, 101184, v16
    ds_write_b128 v17, v[160:163] offset:0
    ds_write_b128 v17, v[160:163] offset:12288
    ds_write_b128 v17, v[160:163] offset:24576
    s_mul_i32 s67, s65, 544
    s_and_b32 s66, s38, 1
    s_lshl_b32 s66, s66, 8
    s_add_u32 s66, s66, s67
    s_mov_b32 m0, s66
    s_mul_i32 s64, s65, 5888
    s_add_u32 s64, s64, 101184
    s_and_b32 s69, s38, 3
    v_and_b32 v5, 15, v0
    v_bfe_u32 v6, v0, 4, 2
    v_and_b32 v17, 48, v0
    v_mul_u32_u24 v110, 1632, v5
    s_mov_b32 s52, 0
    s_movk_i32 s53, 6528
    s_movk_i32 s54, 14688
    s_cmp_eq_u32 s69, 1
    s_cselect_b32 s52, 29376, s52
    s_cselect_b32 s53, 3264, s53
    s_cselect_b32 s54, 9792, s54
    s_cmp_eq_u32 s69, 2
    s_cselect_b32 s52, 48960, s52
    s_cselect_b32 s54, 13056, s54
    s_cmp_eq_u32 s69, 3
    s_cselect_b32 s52, 1632, s52
    s_add_u32 s52, s52, s67
    s_add_u32 s67, s67, 75072
    v_and_b32 v111, 3, v0
    v_mul_u32_u24 v111, 1632, v111
    v_bfe_u32 v18, v0, 2, 1
    v_bfe_u32 v19, v0, 3, 1
    v_xor_b32 v18, v18, v19
    v_mad_u32_u24 v111, v19, s53, v111
    v_mad_u32_u24 v111, v18, s54, v111
    v_add3_u32 v111, v111, v17, s52
    v_add3_u32 v110, v110, v17, s67
    s_barrier
    v_lshl_add_u32 v18, v5, 1, v6
    s_sub_u32 s52, s69, 11
    v_add_u32 v18, s52, v18
    v_add_u32 v19, 1, v18
    v_lshl_add_u32 v20, v6, 1, 2
    v_cmp_le_u32 s[52:53], v18, v20
    v_cmp_le_u32 s[54:55], v19, v20
    v_mov_b32 v18, 0x3f80
    v_cndmask_b32 v112, 0, v18, s[52:53]
    v_cndmask_b32 v19, 0, 1.0, s[54:55]
    v_or_b32 v112, v112, v19
    s_mul_i32 s52, s38, 1600
    s_add_u32 s52, s52, 120016
    v_lshl_add_u32 v113, v1, 2, s52
    s_mul_i32 s67, s65, 6400
    s_add_u32 s67, s67, 118848
    s_min_u32 s63, s65, 1
    s_add_u32 s63, s63, s65
    s_cmp_eq_u32 s69, 3
    s_cselect_b32 s62, s65, s69
    s_cselect_b32 s63, 1, s63
    v_add_u32 v7, 1, v5
    v_and_b32 v8, 3, v7
    v_mul_u32_u24 v8, 1598, v8
    v_lshl_add_u32 v7, v7, 1, v8
    s_mul_i32 s68, s62, 6400
    s_add_u32 s68, s68, 118848
    v_add3_u32 v7, v7, v17, s68
    s_mul_i32 s61, s62, 5888
    s_add_u32 s61, s61, 101184
    v_add_u32 v18, s61, v17
    v_lshl_add_u32 v9, v5, 3, v18
    v_and_b32 v10, 1, v5
    v_mul_u32_u24 v10, 380, v10
    v_lshl_add_u32 v10, v5, 2, v10
    v_add_u32 v10, v18, v10
    v_lshlrev_b32 v8, 5, v5
    v_sub_u32 v8, v18, v8
    v_lshrrev_b32 v11, 2, v5
    v_lshl_add_u32 v2, v5, 2, v6
    v_add_u32 v15, v2, v11
    s_mul_i32 s59, s62, 13824
    v_lshl_add_u32 v4, v15, 3, s59
    s_lshl_b32 s52, s62, 4
    s_add_u32 s52, s52, 161280
    v_mov_b32 v166, s52
    v_mov_b32 v167, 147468
    s_branch P_D
P_C:
    v_mov_b32 v8, 0
    v_mov_b32 v9, 0
    v_mov_b32 v10, 0
    v_mov_b32 v166, 0
    s_barrier
P_D:
    s_waitcnt vmcnt(0)
LN1:
    v_dot2c_f32_bf16 v104, 0x3f803f80, v60
    v_dot2c_f32_bf16 v106, v60, v60
    v_dot2c_f32_bf16 v105, 0x3f803f80, v61
    v_dot2c_f32_bf16 v107, v61, v61
    v_dot2c_f32_bf16 v104, 0x3f803f80, v62
    v_dot2c_f32_bf16 v106, v62, v62
    v_dot2c_f32_bf16 v105, 0x3f803f80, v64
    v_dot2c_f32_bf16 v107, v64, v64
    v_dot2c_f32_bf16 v104, 0x3f803f80, v65
    v_dot2c_f32_bf16 v106, v65, v65
    v_dot2c_f32_bf16 v105, 0x3f803f80, v66
    v_dot2c_f32_bf16 v107, v66, v66
    v_dot2c_f32_bf16 v104, 0x3f803f80, v68
    v_dot2c_f32_bf16 v106, v68, v68
    v_dot2c_f32_bf16 v105, 0x3f803f80, v69
    v_dot2c_f32_bf16 v107, v69, v69
    v_dot2c_f32_bf16 v104, 0x3f803f80, v70
    v_dot2c_f32_bf16 v106, v70, v70
    v_lshlrev_b32 v72, 16, v60
    v_and_b32 v73, 0xffff0000, v60
    v_add_f32 v104, v104, v105
    v_add_f32 v106, v106, v107
    v_lshlrev_b32 v74, 16, v61
    v_and_b32 v75, 0xffff0000, v61
    v_permlane16_swap_b32 v104, v106
    v_add_f32 v104, v104, v106
    v_lshlrev_b32 v76, 16, v62
    v_and_b32 v77, 0xffff0000, v62
    v_add_f32_dpp v104, v104, v104 quad_perm:[1,0,3,2] row_mask:0xf bank_mask:0xf
    v_lshlrev_b32 v78, 16, v64
    v_and_b32 v79, 0xffff0000, v64
    v_add_f32_dpp v104, v104, v104 quad_perm:[2,3,0,1] row_mask:0xf bank_mask:0xf
    v_lshlrev_b32 v80, 16, v65
    v_and_b32 v81, 0xffff0000, v65
    v_add_f32_dpp v104, v104, v104 row_half_mirror row_mask:0xf bank_mask:0xf
    v_lshlrev_b32 v82, 16, v66
    v_and_b32 v83, 0xffff0000, v66
    v_add_f32_dpp v104, v104, v104 row_mirror row_mask:0xf bank_mask:0xf
    v_mul_f32 v104, 0x3ae38e39, v104
    v_mov_b32 v105, v104
    v_lshlrev_b32 v84, 16, v68
    v_and_b32 v85, 0xffff0000, v68
    v_permlane16_swap_b32 v104, v105
    v_fma_f32 v105, -v104, v104, v105
    v_max_f32 v105, 0, v105
    v_cvt_pk_bf16_f32 v105, v104, v105
    v_lshlrev_b32 v104, 16, v105
    v_and_b32 v105, 0xffff0000, v105
    v_lshlrev_b32 v86, 16, v69
    v_and_b32 v87, 0xffff0000, v69
    v_lshlrev_b32 v88, 16, v70
    v_and_b32 v89, 0xffff0000, v70
    v_add_u32 v95, 1, v95
    v_mov_b32 v99, v95
    v_mov_b32 v103, v95
    v_readfirstlane_b32 s39, v95
    v_add_f32 v105, 0x3727c5ac, v105
    v_cvt_pk_bf16_f32 v105, v105, v105
    v_lshlrev_b32 v105, 16, v105
    v_sqrt_f32 v106, v105
    v_pk_add_f32 v[72:73], v[72:73], v[104:105] op_sel_hi:[1,0] neg_lo:[0,1] neg_hi:[0,1]
    v_pk_add_f32 v[74:75], v[74:75], v[104:105] op_sel_hi:[1,0] neg_lo:[0,1] neg_hi:[0,1]
    v_pk_add_f32 v[76:77], v[76:77], v[104:105] op_sel_hi:[1,0] neg_lo:[0,1] neg_hi:[0,1]
    v_cvt_pk_bf16_f32 v106, v106, v106
    v_lshlrev_b32 v106, 16, v106
    v_rcp_f32 v106, v106
    v_pk_add_f32 v[78:79], v[78:79], v[104:105] op_sel_hi:[1,0] neg_lo:[0,1] neg_hi:[0,1]
    v_pk_add_f32 v[80:81], v[80:81], v[104:105] op_sel_hi:[1,0] neg_lo:[0,1] neg_hi:[0,1]
    v_pk_add_f32 v[82:83], v[82:83], v[104:105] op_sel_hi:[1,0] neg_lo:[0,1] neg_hi:[0,1]
    v_pk_add_f32 v[84:85], v[84:85], v[104:105] op_sel_hi:[1,0] neg_lo:[0,1] neg_hi:[0,1]
    v_pk_add_f32 v[86:87], v[86:87], v[104:105] op_sel_hi:[1,0] neg_lo:[0,1] neg_hi:[0,1]
    v_pk_add_f32 v[88:89], v[88:89], v[104:105] op_sel_hi:[1,0] neg_lo:[0,1] neg_hi:[0,1]
    v_cvt_pk_bf16_f32 v73, v72, v73
    v_cvt_pk_bf16_f32 v75, v74, v75
    v_cvt_pk_bf16_f32 v77, v76, v77
    v_cvt_pk_bf16_f32 v79, v78, v79
    v_cvt_pk_bf16_f32 v81, v80, v81
    v_cvt_pk_bf16_f32 v83, v82, v83
    v_cvt_pk_bf16_f32 v85, v84, v85
    v_cvt_pk_bf16_f32 v87, v86, v87
    v_cvt_pk_bf16_f32 v89, v88, v89
    v_lshlrev_b32 v72, 16, v73
    v_and_b32 v73, 0xffff0000, v73
    v_lshlrev_b32 v74, 16, v75
    v_and_b32 v75, 0xffff0000, v75
    v_lshlrev_b32 v76, 16, v77
    v_and_b32 v77, 0xffff0000, v77
    v_pk_mul_f32 v[72:73], v[72:73], v[106:107] op_sel_hi:[1,0]
    v_pk_mul_f32 v[74:75], v[74:75], v[106:107] op_sel_hi:[1,0]
    v_pk_mul_f32 v[76:77], v[76:77], v[106:107] op_sel_hi:[1,0]
    v_cvt_pk_bf16_f32 v60, v72, v73
    v_cvt_pk_bf16_f32 v62, v76, v77
    v_cvt_pk_bf16_f32 v61, v74, v75
    v_cvt_pk_bf16_f32 v63, v74, v75
    v_permlane32_swap_b32 v60, v62
    s_nop 0
    v_permlane32_swap_b32 v61, v63
    v_perm_b32 v92, v60, v62, s49
    v_perm_b32 v93, v60, v62, s50
    v_lshlrev_b32 v78, 16, v79
    v_and_b32 v79, 0xffff0000, v79
    v_lshlrev_b32 v80, 16, v81
    v_and_b32 v81, 0xffff0000, v81
    v_lshlrev_b32 v82, 16, v83
    v_and_b32 v83, 0xffff0000, v83
    v_pk_mul_f32 v[78:79], v[78:79], v[106:107] op_sel_hi:[1,0]
    v_pk_mul_f32 v[80:81], v[80:81], v[106:107] op_sel_hi:[1,0]
    v_pk_mul_f32 v[82:83], v[82:83], v[106:107] op_sel_hi:[1,0]
    v_cvt_pk_bf16_f32 v64, v78, v79
    v_cvt_pk_bf16_f32 v66, v82, v83
    v_cvt_pk_bf16_f32 v65, v80, v81
    v_cvt_pk_bf16_f32 v67, v80, v81
    v_perm_b32 v94, v61, v63, v144
    ds_write_b128 v141, v[92:95] offset:0
    v_permlane32_swap_b32 v64, v66
    v_permlane32_swap_b32 v65, v67
    v_perm_b32 v96, v64, v66, s49
    v_perm_b32 v97, v64, v66, s50
    v_lshlrev_b32 v84, 16, v85
    v_and_b32 v85, 0xffff0000, v85
    v_lshlrev_b32 v86, 16, v87
    v_and_b32 v87, 0xffff0000, v87
    v_lshlrev_b32 v88, 16, v89
    v_and_b32 v89, 0xffff0000, v89
    v_pk_mul_f32 v[84:85], v[84:85], v[106:107] op_sel_hi:[1,0]
    v_pk_mul_f32 v[86:87], v[86:87], v[106:107] op_sel_hi:[1,0]
    v_pk_mul_f32 v[88:89], v[88:89], v[106:107] op_sel_hi:[1,0]
    v_cvt_pk_bf16_f32 v68, v84, v85
    v_cvt_pk_bf16_f32 v70, v88, v89
    v_cvt_pk_bf16_f32 v69, v86, v87
    v_cvt_pk_bf16_f32 v71, v86, v87
    v_perm_b32 v98, v65, v67, v144
    ds_write_b128 v141, v[96:99] offset:4608
    v_permlane32_swap_b32 v68, v70
    v_permlane32_swap_b32 v69, v71
    v_perm_b32 v100, v68, v70, s49
    v_perm_b32 v101, v68, v70, s50
    v_perm_b32 v102, v69, v71, v144
    ds_write_b128 v141, v[100:103] offset:9216
    s_mov_b64 exec, 0x1
    ds_write_b32 v146, v144
    s_mov_b64 exec, -1
    s_movk_i32 s60, 4000
LN1_R:
    ds_read_b128 v[104:107], v145
    ds_read_b128 v[72:75], v142 offset:0
    ds_read_b128 v[76:79], v142 offset:1152
    ds_read_b128 v[80:83], v142 offset:2304
    s_sub_u32 s60, s60, 1
    s_waitcnt lgkmcnt(3)
    v_min3_u32 v104, v104, v105, v106
    v_min_u32 v104, v104, v107
    v_cmp_eq_u32 vcc, 0, v104
    s_cmp_gt_i32 s60, 0
    s_cselect_b64 s[52:53], vcc, 0
    s_cmp_lg_u64 s[52:53], 0
    s_waitcnt lgkmcnt(0)
    s_cbranch_scc1 LN1_R
    buffer_store_dwordx4 v[72:75], v143, s[40:43], s46 offen sc1
    buffer_store_dwordx4 v[76:79], v143, s[40:43], s47 offen sc1
    buffer_store_dwordx4 v[80:83], v143, s[40:43], s48 offen sc1
    s_setprio 0
    s_cmp_ge_u32 s2, 192
    s_cbranch_scc1 FFN_DMA
    s_branch C_KS
P_B:
    s_cmp_ge_u32 s2, 192
    s_cbranch_scc1 FFN_DMA0
    s_cmp_lg_u32 s38, 4
    s_cbranch_scc1 P_B2
    s_mul_i32 s52, s2, 768
    v_add_u32 v16, s52, v3
    s_mul_i32 s52, s2, 6
    s_and_b32 s52, s52, -4
    v_lshl_add_u32 v17, v1, 2, s52
    s_waitcnt lgkmcnt(0)
    s_mov_b32 exec_lo, 0xffffffff
    s_mov_b32 exec_hi, 0xffff
    s_mov_b32 m0, 138048
    s_nop 0
    global_load_lds_dwordx4 v16, s[6:7]
    s_mov_b32 m0, 138816
    s_nop 0
    global_load_lds_dwordx4 v16, s[8:9]
    s_mov_b32 m0, 139584
    s_nop 0
    global_load_lds_dwordx4 v16, s[10:11]
    s_mov_b32 m0, 140352
    s_nop 0
    global_load_lds_dwordx4 v16, s[12:13]
    s_mov_b32 m0, 141120
    s_nop 0
    global_load_lds_dwordx4 v16, s[14:15]
    s_mov_b32 m0, 141888
    s_nop 0
    global_load_lds_dwordx4 v16, s[16:17]
    s_mov_b64 exec, 0x3
    s_mov_b32 m0, 142656
    s_nop 0
    global_load_lds_dword v17, s[18:19]
    s_mov_b32 m0, 142672
    s_nop 0
    global_load_lds_dword v17, s[20:21]
    s_mov_b64 exec, -1
P_B2:
    s_lshr_b32 s65, s38, 2
    s_bitcmp1_b32 s2, 0
    s_addc_u32 s51, s65, 0
    s_cmp_eq_u32 s51, 3
    s_cselect_b32 s51, 0, s51
    s_lshl_b32 s52, s51, 8
    s_add_u32 s52, s52, 138048
    v_and_b32 v114, 0x7f, v0
    v_lshl_add_u32 v114, v114, 1, s52
    s_and_b32 s52, s2, 1
    s_add_u32 s52, s52, s51
    s_lshl_b32 s52, s52, 1
    s_add_u32 s52, s52, 142656
    v_mov_b32 v115, s52
    v_mov_b32 v119, 161292
    v_mov_b32 v29, 0
    v_mov_b32 v30, 0
    v_mov_b32 v31, 0
    v_mov_b32 v32, 0
    v_mov_b32 v33, 0
    v_mov_b32 v34, 0
    v_mov_b32 v35, 0
    v_mov_b32 v160, 0
    v_mov_b32 v161, 0
    v_mov_b32 v162, 0
    v_mov_b32 v163, 0
    v_lshlrev_b32 v16, 4, v0
    v_add_u32 v17, 101184, v16
    ds_write_b128 v17, v[160:163] offset:0
    ds_write_b128 v17, v[160:163] offset:12288
    ds_write_b128 v17, v[160:163] offset:24576
    s_mul_i32 s67, s65, 544
    s_and_b32 s66, s38, 1
    s_lshl_b32 s66, s66, 8
    s_add_u32 s66, s66, s67
    s_mov_b32 m0, s66
    s_mul_i32 s64, s65, 5888
    s_add_u32 s64, s64, 101184
    s_and_b32 s69, s38, 3
    v_and_b32 v5, 15, v0
    v_bfe_u32 v6, v0, 4, 2
    v_and_b32 v17, 48, v0
    v_mul_u32_u24 v110, 1632, v5
    s_mov_b32 s52, 0
    s_movk_i32 s53, 6528
    s_movk_i32 s54, 14688
    s_cmp_eq_u32 s69, 1
    s_cselect_b32 s52, 29376, s52
    s_cselect_b32 s53, 3264, s53
    s_cselect_b32 s54, 9792, s54
    s_cmp_eq_u32 s69, 2
    s_cselect_b32 s52, 48960, s52
    s_cselect_b32 s54, 13056, s54
    s_cmp_eq_u32 s69, 3
    s_cselect_b32 s52, 1632, s52
    s_add_u32 s52, s52, s67
    s_add_u32 s67, s67, 75072
    v_and_b32 v111, 3, v0
    v_mul_u32_u24 v111, 1632, v111
    v_bfe_u32 v18, v0, 2, 1
    v_bfe_u32 v19, v0, 3, 1
    v_xor_b32 v18, v18, v19
    v_mad_u32_u24 v111, v19, s53, v111
    v_mad_u32_u24 v111, v18, s54, v111
    v_add3_u32 v111, v111, v17, s52
    v_add3_u32 v110, v110, v17, s67
    s_barrier
    v_lshl_add_u32 v18, v5, 1, v6
    s_sub_u32 s52, s69, 11
    v_add_u32 v18, s52, v18
    v_add_u32 v19, 1, v18
    v_lshl_add_u32 v20, v6, 1, 2
    v_cmp_le_u32 s[52:53], v18, v20
    v_cmp_le_u32 s[54:55], v19, v20
    v_mov_b32 v18, 0x3f80
    v_cndmask_b32 v112, 0, v18, s[52:53]
    v_cndmask_b32 v19, 0, 1.0, s[54:55]
    v_or_b32 v112, v112, v19
    s_mul_i32 s52, s38, 1600
    s_add_u32 s52, s52, 120016
    v_lshl_add_u32 v113, v1, 2, s52
    s_mul_i32 s67, s65, 6400
    s_add_u32 s67, s67, 118848
    s_min_u32 s63, s65, 1
    s_add_u32 s63, s63, s65
    s_cmp_eq_u32 s69, 3
    s_cselect_b32 s62, s65, s69
    s_cselect_b32 s63, 1, s63
    v_add_u32 v7, 1, v5
    v_and_b32 v8, 3, v7
    v_mul_u32_u24 v8, 1598, v8
    v_lshl_add_u32 v7, v7, 1, v8
    s_mul_i32 s68, s62, 6400
    s_add_u32 s68, s68, 118848
    v_add3_u32 v7, v7, v17, s68
    s_mul_i32 s61, s62, 5888
    s_add_u32 s61, s61, 101184
    v_add_u32 v18, s61, v17
    v_lshl_add_u32 v9, v5, 3, v18
    v_and_b32 v10, 1, v5
    v_mul_u32_u24 v10, 380, v10
    v_lshl_add_u32 v10, v5, 2, v10
    v_add_u32 v10, v18, v10
    v_lshlrev_b32 v8, 5, v5
    v_sub_u32 v8, v18, v8
    v_lshrrev_b32 v11, 2, v5
    v_lshl_add_u32 v2, v5, 2, v6
    v_add_u32 v15, v2, v11
    s_mul_i32 s59, s62, 13824
    v_lshl_add_u32 v4, v15, 3, s59
    s_lshl_b32 s52, s62, 4
    s_add_u32 s52, s52, 161280
    v_mov_b32 v166, s52
    v_mov_b32 v167, 147468
    v_mov_b32 v160, -1
    v_mov_b32 v161, -1
    v_mov_b32 v162, -1
    v_mov_b32 v163, -1
    v_lshlrev_b32 v17, 1, v0
    s_mul_i32 s48, s2, 9216
    s_add_u32 s48, s48, 9498624
    s_cmp_eq_u32 s2, 150
    s_cselect_b32 s48, 28672, s48
    s_cselect_b32 s50, 0, s2
    s_add_u32 s49, s48, 11776
    s_waitcnt vmcnt(0) lgkmcnt(0)
    s_mov_b32 s40, s36
    s_mov_b32 s41, s37
    s_cmp_lg_u32 s38, 4
    s_cbranch_scc1 P_B3
    s_mov_b64 exec, 0x1
    ds_write_b32 v119, v119
    s_mov_b64 exec, -1
P_B3:
    s_cmp_ge_u32 s50, 144
    s_cbranch_scc1 C_KS
    buffer_store_dwordx4 v[160:163], v16, s[40:43], s48 offen sc1
    buffer_store_short v160, v17, s[40:43], s49 offen sc1
C_KS:
    s_movk_i32 s60, 4000
C_KP:
    ds_read_b32 v20, v119
    s_sub_u32 s60, s60, 1
    s_cmp_gt_i32 s60, 0
    s_waitcnt lgkmcnt(0)
    v_readfirstlane_b32 s52, v20
    s_nop 0
    s_cselect_b32 s52, s52, 1
    s_cmp_eq_u32 s52, 0
    s_cbranch_scc1 C_KP
    ds_read_u16_d16_hi v29, v115
    ds_read_u16_d16_hi v30, v114 offset:0
    ds_read_u16_d16_hi v31, v114 offset:768
    ds_read_u16_d16_hi v32, v114 offset:1536
    ds_read_u16_d16_hi v33, v114 offset:2304
    ds_read_u16_d16_hi v34, v114 offset:3072
    ds_read_u16_d16_hi v35, v114 offset:3840
    s_waitcnt lgkmcnt(0)
    v_mul_f32 v20, 0x3fb8aa3b, v29
    v_mov_b32 v21, 0x3fb8aa3b
    v_fma_f32 v21, v29, v21, -v20
    v_fmac_f32 v21, 0x32a57060, v29
    v_exp_f32 v20, v20
    v_mul_f32 v21, 0x3f317218, v21
    v_fma_f32 v20, v20, v21, v20
    v_cvt_pk_bf16_f32 v20, v20, v20
    v_lshlrev_b32 v20, 16, v20
    v_mul_f32 v21, v30, v20
    v_mul_f32 v36, v31, v20
    v_mul_f32 v32, v32, v20
    v_mul_f32 v33, v33, v20
    v_mul_f32 v21, 0x3fb8aa3b, v21
    v_mul_f32 v22, 0x3e22f983, v36
    v_mov_b32 v23, 0x3e22f983
    v_fma_f32 v23, v36, v23, -v22
    v_fmac_f32 v23, 0x31dc9c88, v36
    v_pk_mul_f32 v[24:25], v[34:35], v[32:33] op_sel:[0,0] op_sel_hi:[0,1]
    v_pk_fma_f32 v[24:25], v[34:35], v[32:33], v[24:25] op_sel:[1,1,0] op_sel_hi:[1,0,1] neg_lo:[1,0,0]
    s_bitcmp1_b32 s38, 1
    s_cbranch_scc1 C_ROLE1
    v_mul_f32 v36, 0x43000000, v21
    v_mul_f32 v37, 0x43000000, v22
    v_mul_f32 v38, 0x41000000, v21
    v_mul_f32 v39, 0x41000000, v22
    v_exp_f32 v36, v36
    v_fract_f32 v37, v37
    v_exp_f32 v38, v38
    v_fract_f32 v39, v39
    v_fmac_f32 v37, 0x43000000, v23
    v_fmac_f32 v39, 0x41000000, v23
    v_cos_f32 v26, v37
    v_sin_f32 v27, v37
    v_cos_f32 v28, v39
    v_sin_f32 v29, v39
    v_mul_f32 v26, v26, v36
    v_mul_f32 v27, v27, v36
    v_mul_f32 v28, v28, v38
    v_mul_f32 v29, v29, v38
    v_mov_b32 v44, 1.0
    v_mov_b32 v45, 0
    v_pk_mul_f32 v[56:57], v[24:25], v[28:29] op_sel:[0,0] op_sel_hi:[0,1]
    v_pk_mul_f32 v[50:51], v[28:29], v[28:29] op_sel:[0,0] op_sel_hi:[0,1]
    v_pk_fma_f32 v[56:57], v[24:25], v[28:29], v[56:57] op_sel:[1,1,0] op_sel_hi:[1,0,1] neg_lo:[1,0,0]
    v_pk_fma_f32 v[50:51], v[28:29], v[28:29], v[50:51] op_sel:[1,1,0] op_sel_hi:[1,0,1] neg_lo:[1,0,0]
    v_pk_mul_f32 v[58:59], v[56:57], v[26:27] op_sel:[0,0] op_sel_hi:[0,1]
    v_pk_fma_f32 v[58:59], v[56:57], v[26:27], v[58:59] op_sel:[1,1,0] op_sel_hi:[1,0,1] neg_lo:[1,0,0]
    v_cvt_pk_bf16_f32 v40, v56, v57
    ds_write_addtid_b32 v40 offset:13056
    v_pk_mul_f32 v[56:57], v[58:59], v[26:27] op_sel:[0,0] op_sel_hi:[0,1]
    v_pk_mul_f32 v[54:55], v[50:51], v[28:29] op_sel:[0,0] op_sel_hi:[0,1]
    v_pk_fma_f32 v[56:57], v[58:59], v[26:27], v[56:57] op_sel:[1,1,0] op_sel_hi:[1,0,1] neg_lo:[1,0,0]
    v_pk_fma_f32 v[54:55], v[50:51], v[28:29], v[54:55] op_sel:[1,1,0] op_sel_hi:[1,0,1] neg_lo:[1,0,0]
    v_cvt_pk_bf16_f32 v41, v58, v59
    ds_write_addtid_b32 v41 offset:27744
    v_cvt_pk_bf16_f32 v42, v44, -v45
    s_add_u32 m0, s66, 35904
    s_nop 0
    ds_write_addtid_b32 v42 offset:39168
    v_cvt_pk_bf16_f32 v43, v28, -v29
    ds_write_addtid_b32 v43 offset:40800
    v_cvt_pk_bf16_f32 v40, v50, -v51
    ds_write_addtid_b32 v40 offset:42432
    v_pk_mul_f32 v[58:59], v[56:57], v[26:27] op_sel:[0,0] op_sel_hi:[0,1]
    v_pk_mul_f32 v[50:51], v[54:55], v[28:29] op_sel:[0,0] op_sel_hi:[0,1]
    v_pk_fma_f32 v[58:59], v[56:57], v[26:27], v[58:59] op_sel:[1,1,0] op_sel_hi:[1,0,1] neg_lo:[1,0,0]
    v_pk_fma_f32 v[50:51], v[54:55], v[28:29], v[50:51] op_sel:[1,1,0] op_sel_hi:[1,0,1] neg_lo:[1,0,0]
    v_cvt_pk_bf16_f32 v41, v56, v57
    ds_write_addtid_b32 v41 offset:0
    v_cvt_pk_bf16_f32 v42, v54, -v55
    ds_write_addtid_b32 v42 offset:44064
    v_pk_mul_f32 v[56:57], v[58:59], v[26:27] op_sel:[0,0] op_sel_hi:[0,1]
    v_pk_mul_f32 v[54:55], v[50:51], v[28:29] op_sel:[0,0] op_sel_hi:[0,1]
    v_pk_fma_f32 v[56:57], v[58:59], v[26:27], v[56:57] op_sel:[1,1,0] op_sel_hi:[1,0,1] neg_lo:[1,0,0]
    v_pk_fma_f32 v[54:55], v[50:51], v[28:29], v[54:55] op_sel:[1,1,0] op_sel_hi:[1,0,1] neg_lo:[1,0,0]
    v_cvt_pk_bf16_f32 v43, v58, v59
    ds_write_addtid_b32 v43 offset:9792
    v_cvt_pk_bf16_f32 v40, v50, -v51
    ds_write_addtid_b32 v40 offset:45696
    v_pk_mul_f32 v[58:59], v[56:57], v[26:27] op_sel:[0,0] op_sel_hi:[0,1]
    v_pk_mul_f32 v[50:51], v[54:55], v[28:29] op_sel:[0,0] op_sel_hi:[0,1]
    v_pk_fma_f32 v[58:59], v[56:57], v[26:27], v[58:59] op_sel:[1,1,0] op_sel_hi:[1,0,1] neg_lo:[1,0,0]
    v_pk_fma_f32 v[50:51], v[54:55], v[28:29], v[50:51] op_sel:[1,1,0] op_sel_hi:[1,0,1] neg_lo:[1,0,0]
    v_cvt_pk_bf16_f32 v41, v56, v57
    ds_write_addtid_b32 v41 offset:14688
    v_cvt_pk_bf16_f32 v42, v54, -v55
    ds_write_addtid_b32 v42 offset:47328
    v_pk_mul_f32 v[56:57], v[58:59], v[26:27] op_sel:[0,0] op_sel_hi:[0,1]
    v_pk_mul_f32 v[54:55], v[50:51], v[28:29] op_sel:[0,0] op_sel_hi:[0,1]
    v_pk_fma_f32 v[56:57], v[58:59], v[26:27], v[56:57] op_sel:[1,1,0] op_sel_hi:[1,0,1] neg_lo:[1,0,0]
    v_pk_fma_f32 v[54:55], v[50:51], v[28:29], v[54:55] op_sel:[1,1,0] op_sel_hi:[1,0,1] neg_lo:[1,0,0]
    v_cvt_pk_bf16_f32 v43, v58, v59
    ds_write_addtid_b32 v43 offset:17952
    v_cvt_pk_bf16_f32 v40, v50, -v51
    ds_write_addtid_b32 v40 offset:48960
    v_pk_mul_f32 v[58:59], v[56:57], v[26:27] op_sel:[0,0] op_sel_hi:[0,1]
    v_pk_mul_f32 v[50:51], v[54:55], v[28:29] op_sel:[0,0] op_sel_hi:[0,1]
    v_pk_fma_f32 v[58:59], v[56:57], v[26:27], v[58:59] op_sel:[1,1,0] op_sel_hi:[1,0,1] neg_lo:[1,0,0]
    v_pk_fma_f32 v[50:51], v[54:55], v[28:29], v[50:51] op_sel:[1,1,0] op_sel_hi:[1,0,1] neg_lo:[1,0,0]
    v_cvt_pk_bf16_f32 v41, v56, v57
    ds_write_addtid_b32 v41 offset:27744
    v_cvt_pk_bf16_f32 v42, v54, -v55
    ds_write_addtid_b32 v42 offset:50592
    v_pk_mul_f32 v[56:57], v[58:59], v[26:27] op_sel:[0,0] op_sel_hi:[0,1]
    v_pk_mul_f32 v[54:55], v[50:51], v[28:29] op_sel:[0,0] op_sel_hi:[0,1]
    v_pk_fma_f32 v[56:57], v[58:59], v[26:27], v[56:57] op_sel:[1,1,0] op_sel_hi:[1,0,1] neg_lo:[1,0,0]
    v_pk_fma_f32 v[54:55], v[50:51], v[28:29], v[54:55] op_sel:[1,1,0] op_sel_hi:[1,0,1] neg_lo:[1,0,0]
    v_cvt_pk_bf16_f32 v43, v58, v59
    ds_write_addtid_b32 v43 offset:31008
    v_cvt_pk_bf16_f32 v40, v50, -v51
    ds_write_addtid_b32 v40 offset:52224
    v_pk_mul_f32 v[58:59], v[56:57], v[26:27] op_sel:[0,0] op_sel_hi:[0,1]
    v_pk_mul_f32 v[50:51], v[54:55], v[28:29] op_sel:[0,0] op_sel_hi:[0,1]
    v_pk_fma_f32 v[58:59], v[56:57], v[26:27], v[58:59] op_sel:[1,1,0] op_sel_hi:[1,0,1] neg_lo:[1,0,0]
    v_pk_fma_f32 v[50:51], v[54:55], v[28:29], v[50:51] op_sel:[1,1,0] op_sel_hi:[1,0,1] neg_lo:[1,0,0]
    v_cvt_pk_bf16_f32 v41, v56, v57
    ds_write_addtid_b32 v41 offset:32640
    v_cvt_pk_bf16_f32 v42, v54, -v55
    ds_write_addtid_b32 v42 offset:53856
    v_pk_mul_f32 v[56:57], v[58:59], v[26:27] op_sel:[0,0] op_sel_hi:[0,1]
    v_pk_mul_f32 v[54:55], v[50:51], v[28:29] op_sel:[0,0] op_sel_hi:[0,1]
    v_pk_fma_f32 v[56:57], v[58:59], v[26:27], v[56:57] op_sel:[1,1,0] op_sel_hi:[1,0,1] neg_lo:[1,0,0]
    v_pk_fma_f32 v[54:55], v[50:51], v[28:29], v[54:55] op_sel:[1,1,0] op_sel_hi:[1,0,1] neg_lo:[1,0,0]
    v_cvt_pk_bf16_f32 v43, v58, v59
    ds_write_addtid_b32 v43 offset:34272
    v_cvt_pk_bf16_f32 v40, v50, -v51
    ds_write_addtid_b32 v40 offset:55488
    v_pk_mul_f32 v[58:59], v[56:57], v[26:27] op_sel:[0,0] op_sel_hi:[0,1]
    v_pk_mul_f32 v[50:51], v[54:55], v[28:29] op_sel:[0,0] op_sel_hi:[0,1]
    v_pk_fma_f32 v[58:59], v[56:57], v[26:27], v[58:59] op_sel:[1,1,0] op_sel_hi:[1,0,1] neg_lo:[1,0,0]
    v_pk_fma_f32 v[50:51], v[54:55], v[28:29], v[50:51] op_sel:[1,1,0] op_sel_hi:[1,0,1] neg_lo:[1,0,0]
    v_cvt_pk_bf16_f32 v41, v56, v57
    ds_write_addtid_b32 v41 offset:35904
    v_cvt_pk_bf16_f32 v42, v54, -v55
    ds_write_addtid_b32 v42 offset:57120
    v_pk_mul_f32 v[56:57], v[58:59], v[26:27] op_sel:[0,0] op_sel_hi:[0,1]
    v_pk_mul_f32 v[54:55], v[50:51], v[28:29] op_sel:[0,0] op_sel_hi:[0,1]
    v_pk_fma_f32 v[56:57], v[58:59], v[26:27], v[56:57] op_sel:[1,1,0] op_sel_hi:[1,0,1] neg_lo:[1,0,0]
    v_pk_fma_f32 v[54:55], v[50:51], v[28:29], v[54:55] op_sel:[1,1,0] op_sel_hi:[1,0,1] neg_lo:[1,0,0]
    v_cvt_pk_bf16_f32 v43, v58, v59
    ds_write_addtid_b32 v43 offset:37536
    v_cvt_pk_bf16_f32 v40, v50, -v51
    ds_write_addtid_b32 v40 offset:58752
    v_pk_mul_f32 v[58:59], v[56:57], v[26:27] op_sel:[0,0] op_sel_hi:[0,1]
    v_pk_mul_f32 v[50:51], v[54:55], v[28:29] op_sel:[0,0] op_sel_hi:[0,1]
    v_pk_fma_f32 v[58:59], v[56:57], v[26:27], v[58:59] op_sel:[1,1,0] op_sel_hi:[1,0,1] neg_lo:[1,0,0]
    v_pk_fma_f32 v[50:51], v[54:55], v[28:29], v[50:51] op_sel:[1,1,0] op_sel_hi:[1,0,1] neg_lo:[1,0,0]
    v_cvt_pk_bf16_f32 v41, v56, v57
    ds_write_addtid_b32 v41 offset:19584
    v_cvt_pk_bf16_f32 v42, v54, -v55
    ds_write_addtid_b32 v42 offset:60384
    v_pk_mul_f32 v[56:57], v[58:59], v[26:27] op_sel:[0,0] op_sel_hi:[0,1]
    v_pk_mul_f32 v[54:55], v[50:51], v[28:29] op_sel:[0,0] op_sel_hi:[0,1]
    v_pk_fma_f32 v[56:57], v[58:59], v[26:27], v[56:57] op_sel:[1,1,0] op_sel_hi:[1,0,1] neg_lo:[1,0,0]
    v_pk_fma_f32 v[54:55], v[50:51], v[28:29], v[54:55] op_sel:[1,1,0] op_sel_hi:[1,0,1] neg_lo:[1,0,0]
    v_cvt_pk_bf16_f32 v43, v58, v59
    ds_write_addtid_b32 v43 offset:21216
    v_cvt_pk_bf16_f32 v40, v50, -v51
    ds_write_addtid_b32 v40 offset:62016
    v_pk_mul_f32 v[58:59], v[56:57], v[26:27] op_sel:[0,0] op_sel_hi:[0,1]
    v_pk_fma_f32 v[58:59], v[56:57], v[26:27], v[58:59] op_sel:[1,1,0] op_sel_hi:[1,0,1] neg_lo:[1,0,0]
    v_cvt_pk_bf16_f32 v41, v56, v57
    ds_write_addtid_b32 v41 offset:22848
    v_cvt_pk_bf16_f32 v42, v54, -v55
    ds_write_addtid_b32 v42 offset:63648
    v_cvt_pk_bf16_f32 v43, v58, v59
    ds_write_addtid_b32 v43 offset:24480
    s_branch C_MFMA
C_ROLE1:
    v_mul_f32 v36, 0x43000000, v21
    v_mul_f32 v37, 0x43000000, v22
    v_mul_f32 v38, 0x3f800000, v21
    v_mul_f32 v39, 0x3f800000, v22
    v_exp_f32 v36, v36
    v_fract_f32 v37, v37
    v_exp_f32 v38, v38
    v_fract_f32 v39, v39
    v_fmac_f32 v37, 0x43000000, v23
    v_fmac_f32 v39, 0x3f800000, v23
    v_cos_f32 v26, v37
    v_sin_f32 v27, v37
    v_cos_f32 v28, v39
    v_sin_f32 v29, v39
    v_mul_f32 v26, v26, v36
    v_mul_f32 v27, v27, v36
    v_mul_f32 v28, v28, v38
    v_mul_f32 v29, v29, v38
    v_pk_mul_f32 v[44:45], v[24:25], v[26:27] op_sel:[0,0] op_sel_hi:[0,1]
    v_pk_mul_f32 v[46:47], v[28:29], v[28:29] op_sel:[0,0] op_sel_hi:[0,1]
    v_pk_mul_f32 v[48:49], v[24:25], v[28:29] op_sel:[0,0] op_sel_hi:[0,1]
    v_pk_fma_f32 v[44:45], v[24:25], v[26:27], v[44:45] op_sel:[1,1,0] op_sel_hi:[1,0,1] neg_lo:[1,0,0]
    v_pk_fma_f32 v[46:47], v[28:29], v[28:29], v[46:47] op_sel:[1,1,0] op_sel_hi:[1,0,1] neg_lo:[1,0,0]
    v_pk_fma_f32 v[48:49], v[24:25], v[28:29], v[48:49] op_sel:[1,1,0] op_sel_hi:[1,0,1] neg_lo:[1,0,0]
    v_cvt_pk_bf16_f32 v40, v24, v25
    ds_write_addtid_b32 v40 offset:0
    v_pk_mul_f32 v[50:51], v[44:45], v[26:27] op_sel:[0,0] op_sel_hi:[0,1]
    v_pk_mul_f32 v[52:53], v[44:45], v[28:29] op_sel:[0,0] op_sel_hi:[0,1]
    v_pk_mul_f32 v[54:55], v[48:49], v[28:29] op_sel:[0,0] op_sel_hi:[0,1]
    v_pk_mul_f32 v[62:63], v[46:47], v[46:47] op_sel:[0,0] op_sel_hi:[0,1]
    v_pk_fma_f32 v[50:51], v[44:45], v[26:27], v[50:51] op_sel:[1,1,0] op_sel_hi:[1,0,1] neg_lo:[1,0,0]
    v_pk_fma_f32 v[52:53], v[44:45], v[28:29], v[52:53] op_sel:[1,1,0] op_sel_hi:[1,0,1] neg_lo:[1,0,0]
    v_pk_fma_f32 v[54:55], v[48:49], v[28:29], v[54:55] op_sel:[1,1,0] op_sel_hi:[1,0,1] neg_lo:[1,0,0]
    v_pk_fma_f32 v[62:63], v[46:47], v[46:47], v[62:63] op_sel:[1,1,0] op_sel_hi:[1,0,1] neg_lo:[1,0,0]
    v_cvt_pk_bf16_f32 v41, v44, v45
    ds_write_addtid_b32 v41 offset:14688
    v_cvt_pk_bf16_f32 v42, v48, v49
    ds_write_addtid_b32 v42 offset:1632
    v_pk_mul_f32 v[56:57], v[50:51], v[26:27] op_sel:[0,0] op_sel_hi:[0,1]
    v_pk_mul_f32 v[58:59], v[50:51], v[46:47] op_sel:[0,0] op_sel_hi:[0,1]
    v_pk_mul_f32 v[44:45], v[52:53], v[28:29] op_sel:[0,0] op_sel_hi:[0,1]
    v_pk_mul_f32 v[48:49], v[54:55], v[28:29] op_sel:[0,0] op_sel_hi:[0,1]
    v_pk_fma_f32 v[56:57], v[50:51], v[26:27], v[56:57] op_sel:[1,1,0] op_sel_hi:[1,0,1] neg_lo:[1,0,0]
    v_pk_fma_f32 v[58:59], v[50:51], v[46:47], v[58:59] op_sel:[1,1,0] op_sel_hi:[1,0,1] neg_lo:[1,0,0]
    v_pk_fma_f32 v[44:45], v[52:53], v[28:29], v[44:45] op_sel:[1,1,0] op_sel_hi:[1,0,1] neg_lo:[1,0,0]
    v_pk_fma_f32 v[48:49], v[54:55], v[28:29], v[48:49] op_sel:[1,1,0] op_sel_hi:[1,0,1] neg_lo:[1,0,0]
    v_cvt_pk_bf16_f32 v43, v50, v51
    ds_write_addtid_b32 v43 offset:29376
    v_cvt_pk_bf16_f32 v40, v52, v53
    ds_write_addtid_b32 v40 offset:16320
    v_cvt_pk_bf16_f32 v41, v54, v55
    ds_write_addtid_b32 v41 offset:3264
    v_pk_mul_f32 v[54:55], v[48:49], v[28:29] op_sel:[0,0] op_sel_hi:[0,1]
    v_pk_mul_f32 v[52:53], v[44:45], v[28:29] op_sel:[0,0] op_sel_hi:[0,1]
    v_pk_mul_f32 v[50:51], v[58:59], v[46:47] op_sel:[0,0] op_sel_hi:[0,1]
    v_pk_mul_f32 v[24:25], v[56:57], v[46:47] op_sel:[0,0] op_sel_hi:[0,1]
    v_pk_fma_f32 v[54:55], v[48:49], v[28:29], v[54:55] op_sel:[1,1,0] op_sel_hi:[1,0,1] neg_lo:[1,0,0]
    v_pk_fma_f32 v[52:53], v[44:45], v[28:29], v[52:53] op_sel:[1,1,0] op_sel_hi:[1,0,1] neg_lo:[1,0,0]
    v_pk_fma_f32 v[50:51], v[58:59], v[46:47], v[50:51] op_sel:[1,1,0] op_sel_hi:[1,0,1] neg_lo:[1,0,0]
    v_pk_fma_f32 v[24:25], v[56:57], v[46:47], v[24:25] op_sel:[1,1,0] op_sel_hi:[1,0,1] neg_lo:[1,0,0]
    v_cvt_pk_bf16_f32 v42, v48, v49
    ds_write_addtid_b32 v42 offset:4896
    v_cvt_pk_bf16_f32 v43, v44, v45
    ds_write_addtid_b32 v43 offset:17952
    v_cvt_pk_bf16_f32 v40, v58, v59
    ds_write_addtid_b32 v40 offset:31008
    v_pk_mul_f32 v[48:49], v[54:55], v[28:29] op_sel:[0,0] op_sel_hi:[0,1]
    v_pk_mul_f32 v[44:45], v[52:53], v[28:29] op_sel:[0,0] op_sel_hi:[0,1]
    v_pk_mul_f32 v[58:59], v[50:51], v[46:47] op_sel:[0,0] op_sel_hi:[0,1]
    v_pk_mul_f32 v[56:57], v[24:25], v[46:47] op_sel:[0,0] op_sel_hi:[0,1]
    v_pk_fma_f32 v[48:49], v[54:55], v[28:29], v[48:49] op_sel:[1,1,0] op_sel_hi:[1,0,1] neg_lo:[1,0,0]
    v_pk_fma_f32 v[44:45], v[52:53], v[28:29], v[44:45] op_sel:[1,1,0] op_sel_hi:[1,0,1] neg_lo:[1,0,0]
    v_pk_fma_f32 v[58:59], v[50:51], v[46:47], v[58:59] op_sel:[1,1,0] op_sel_hi:[1,0,1] neg_lo:[1,0,0]
    v_pk_fma_f32 v[56:57], v[24:25], v[46:47], v[56:57] op_sel:[1,1,0] op_sel_hi:[1,0,1] neg_lo:[1,0,0]
    v_cvt_pk_bf16_f32 v41, v54, v55
    ds_write_addtid_b32 v41 offset:6528
    v_cvt_pk_bf16_f32 v42, v52, v53
    ds_write_addtid_b32 v42 offset:19584
    v_cvt_pk_bf16_f32 v43, v50, v51
    ds_write_addtid_b32 v43 offset:32640
    v_cvt_pk_bf16_f32 v40, v24, v25
    ds_write_addtid_b32 v40 offset:40800
    v_pk_mul_f32 v[54:55], v[48:49], v[28:29] op_sel:[0,0] op_sel_hi:[0,1]
    v_pk_mul_f32 v[52:53], v[44:45], v[28:29] op_sel:[0,0] op_sel_hi:[0,1]
    v_pk_mul_f32 v[50:51], v[58:59], v[62:63] op_sel:[0,0] op_sel_hi:[0,1]
    v_pk_mul_f32 v[24:25], v[56:57], v[46:47] op_sel:[0,0] op_sel_hi:[0,1]
    v_pk_mul_f32 v[64:65], v[56:57], v[26:27] op_sel:[0,0] op_sel_hi:[0,1]
    v_pk_fma_f32 v[54:55], v[48:49], v[28:29], v[54:55] op_sel:[1,1,0] op_sel_hi:[1,0,1] neg_lo:[1,0,0]
    v_pk_fma_f32 v[52:53], v[44:45], v[28:29], v[52:53] op_sel:[1,1,0] op_sel_hi:[1,0,1] neg_lo:[1,0,0]
    v_pk_fma_f32 v[50:51], v[58:59], v[62:63], v[50:51] op_sel:[1,1,0] op_sel_hi:[1,0,1] neg_lo:[1,0,0]
    v_pk_fma_f32 v[24:25], v[56:57], v[46:47], v[24:25] op_sel:[1,1,0] op_sel_hi:[1,0,1] neg_lo:[1,0,0]
    v_pk_fma_f32 v[64:65], v[56:57], v[26:27], v[64:65] op_sel:[1,1,0] op_sel_hi:[1,0,1] neg_lo:[1,0,0]
    v_cvt_pk_bf16_f32 v41, v48, v49
    ds_write_addtid_b32 v41 offset:8160
    v_cvt_pk_bf16_f32 v42, v44, v45
    ds_write_addtid_b32 v42 offset:21216
    v_cvt_pk_bf16_f32 v43, v58, v59
    ds_write_addtid_b32 v43 offset:34272
    v_cvt_pk_bf16_f32 v40, v56, v57
    ds_write_addtid_b32 v40 offset:42432
    v_pk_mul_f32 v[48:49], v[54:55], v[28:29] op_sel:[0,0] op_sel_hi:[0,1]
    v_pk_mul_f32 v[44:45], v[52:53], v[28:29] op_sel:[0,0] op_sel_hi:[0,1]
    v_pk_mul_f32 v[56:57], v[24:25], v[62:63] op_sel:[0,0] op_sel_hi:[0,1]
    v_pk_mul_f32 v[66:67], v[64:65], v[26:27] op_sel:[0,0] op_sel_hi:[0,1]
    v_pk_fma_f32 v[48:49], v[54:55], v[28:29], v[48:49] op_sel:[1,1,0] op_sel_hi:[1,0,1] neg_lo:[1,0,0]
    v_pk_fma_f32 v[44:45], v[52:53], v[28:29], v[44:45] op_sel:[1,1,0] op_sel_hi:[1,0,1] neg_lo:[1,0,0]
    v_pk_fma_f32 v[56:57], v[24:25], v[62:63], v[56:57] op_sel:[1,1,0] op_sel_hi:[1,0,1] neg_lo:[1,0,0]
    v_pk_fma_f32 v[66:67], v[64:65], v[26:27], v[66:67] op_sel:[1,1,0] op_sel_hi:[1,0,1] neg_lo:[1,0,0]
    v_cvt_pk_bf16_f32 v41, v54, v55
    ds_write_addtid_b32 v41 offset:9792
    v_cvt_pk_bf16_f32 v42, v52, v53
    ds_write_addtid_b32 v42 offset:22848
    v_cvt_pk_bf16_f32 v43, v50, v51
    ds_write_addtid_b32 v43 offset:37536
    v_cvt_pk_bf16_f32 v40, v24, v25
    ds_write_addtid_b32 v40 offset:44064
    v_cvt_pk_bf16_f32 v41, v64, v65
    ds_write_addtid_b32 v41 offset:48960
    v_pk_mul_f32 v[52:53], v[44:45], v[28:29] op_sel:[0,0] op_sel_hi:[0,1]
    v_pk_mul_f32 v[64:65], v[66:67], v[26:27] op_sel:[0,0] op_sel_hi:[0,1]
    v_pk_fma_f32 v[52:53], v[44:45], v[28:29], v[52:53] op_sel:[1,1,0] op_sel_hi:[1,0,1] neg_lo:[1,0,0]
    v_pk_fma_f32 v[64:65], v[66:67], v[26:27], v[64:65] op_sel:[1,1,0] op_sel_hi:[1,0,1] neg_lo:[1,0,0]
    v_cvt_pk_bf16_f32 v42, v48, v49
    ds_write_addtid_b32 v42 offset:11424
    v_cvt_pk_bf16_f32 v43, v44, v45
    ds_write_addtid_b32 v43 offset:24480
    v_cvt_pk_bf16_f32 v40, v56, v57
    ds_write_addtid_b32 v40 offset:47328
    v_cvt_pk_bf16_f32 v41, v66, v67
    ds_write_addtid_b32 v41 offset:52224
    v_pk_mul_f32 v[66:67], v[64:65], v[26:27] op_sel:[0,0] op_sel_hi:[0,1]
    v_pk_fma_f32 v[66:67], v[64:65], v[26:27], v[66:67] op_sel:[1,1,0] op_sel_hi:[1,0,1] neg_lo:[1,0,0]
    v_cvt_pk_bf16_f32 v42, v52, v53
    ds_write_addtid_b32 v42 offset:26112
    v_cvt_pk_bf16_f32 v43, v64, v65
    ds_write_addtid_b32 v43 offset:62016
    v_cvt_pk_bf16_f32 v40, v66, v67
    ds_write_addtid_b32 v40 offset:65280
C_MFMA:
    s_lshl_b32 s56, s2, 14
    s_lshl_b32 s57, s38, 11
    s_add_u32 s56, s56, s57
    s_add_u32 s56, s56, 57344
    s_sub_u32 s52, s38, 4
    s_lshl_b32 s52, s52, 9
    s_waitcnt lgkmcnt(0)
    s_add_u32 m0, s52, 52032
    s_barrier
    ds_read_b128 v[16:19], v111 offset:0
    ds_read_b128 v[20:23], v110 offset:0
    ds_read_b128 v[24:27], v111 offset:64
    ds_read_b128 v[28:31], v110 offset:64
    ds_read_b128 v[32:35], v111 offset:128
    ds_read_b128 v[36:39], v110 offset:128
    ds_read_b128 v[40:43], v111 offset:192
    ds_read_b128 v[44:47], v110 offset:192
    ds_read_b128 v[48:51], v111 offset:256
    ds_read_b128 v[52:55], v110 offset:256
    ds_read_b128 v[56:59], v111 offset:320
    ds_read_b128 v[60:63], v110 offset:320
    ds_read_b128 v[64:67], v111 offset:384
    ds_read_b128 v[68:71], v110 offset:384
    ds_read_b128 v[72:75], v111 offset:448
    ds_read_b128 v[76:79], v110 offset:448
    ds_read_b32 v167, v167
    ds_write_b32 v113, v112
    s_cmp_eq_u32 s69, 2
    s_cbranch_scc1 C_T2
    v_lshrrev_b32 v89, 1, v6
    v_xor_b32 v88, v89, v6
    v_and_b32 v88, 1, v88
    v_lshlrev_b32 v88, 8, v88
    v_lshl_add_u32 v88, v89, 3, v88
    v_lshl_add_u32 v88, v5, 4, v88
    s_cmp_eq_u32 s69, 1
    s_cbranch_scc1 C_T1
    s_lshr_b32 s52, s69, 1
    s_mul_i32 s53, s52, 1600
    s_add_u32 s53, s53, s67
    v_add_u32 v88, s53, v88
    v_add_u32 v89, 3200, v88
    s_xor_b32 s52, s52, 1
    s_mov_b32 s53, 0
    s_waitcnt lgkmcnt(15)
    v_mfma_f32_16x16x32_bf16 v[80:83], v[16:19], v[20:23], 0
    s_waitcnt lgkmcnt(14)
    v_mfma_f32_16x16x32_bf16 v[84:87], v[24:27], v[28:31], 0
    s_waitcnt lgkmcnt(12)
    v_mfma_f32_16x16x32_bf16 v[80:83], v[32:35], v[36:39], v[80:83]
    s_waitcnt lgkmcnt(10)
    v_mfma_f32_16x16x32_bf16 v[84:87], v[40:43], v[44:47], v[84:87]
    s_waitcnt lgkmcnt(8)
    v_mfma_f32_16x16x32_bf16 v[80:83], v[48:51], v[52:55], v[80:83]
    s_waitcnt lgkmcnt(6)
    v_mfma_f32_16x16x32_bf16 v[84:87], v[56:59], v[60:63], v[84:87]
    s_waitcnt lgkmcnt(4)
    v_mfma_f32_16x16x32_bf16 v[80:83], v[64:67], v[68:71], v[80:83]
    s_waitcnt lgkmcnt(2)
    v_mfma_f32_16x16x32_bf16 v[84:87], v[72:75], v[76:79], v[84:87]
    s_waitcnt lgkmcnt(1)
    v_readfirstlane_b32 s39, v167
    s_nop 5
    v_pk_add_f32 v[80:81], v[80:81], v[84:85]
    v_pk_add_f32 v[82:83], v[82:83], v[86:87]
    v_cvt_pk_bf16_f32 v80, v80, v81
    v_cvt_pk_bf16_f32 v81, v82, v83
    ds_write_b64 v88, v[80:81] offset:32
    ds_write2_b32 v89, v80, v81 offset0:7 offset1:8
    s_mov_b64 exec, s[52:53]
    ds_write_b16 v88, v80 offset:1630
    ds_write_b16 v88, v80 offset:4826
    s_mov_b64 exec, -1
    s_branch C_B3
C_T1:
    s_add_u32 s53, s67, 544
    v_add_u32 v88, s53, v88
    v_add_u32 v89, 1600, v88
    s_waitcnt lgkmcnt(15)
    v_mfma_f32_16x16x32_bf16 v[80:83], v[16:19], v[20:23], 0
    s_waitcnt lgkmcnt(14)
    v_mfma_f32_16x16x32_bf16 v[84:87], v[24:27], v[28:31], 0
    s_waitcnt lgkmcnt(12)
    v_mfma_f32_16x16x32_bf16 v[80:83], v[32:35], v[36:39], v[80:83]
    s_waitcnt lgkmcnt(10)
    v_mfma_f32_16x16x32_bf16 v[84:87], v[40:43], v[44:47], v[84:87]
    s_waitcnt lgkmcnt(8)
    v_mfma_f32_16x16x32_bf16 v[80:83], v[48:51], v[52:55], v[80:83]
    s_waitcnt lgkmcnt(6)
    v_mfma_f32_16x16x32_bf16 v[84:87], v[56:59], v[60:63], v[84:87]
    s_waitcnt lgkmcnt(4)
    v_mfma_f32_16x16x32_bf16 v[80:83], v[64:67], v[68:71], v[80:83]
    s_waitcnt lgkmcnt(2)
    v_mfma_f32_16x16x32_bf16 v[84:87], v[72:75], v[76:79], v[84:87]
    s_waitcnt lgkmcnt(1)
    v_readfirstlane_b32 s39, v167
    s_nop 5
    v_pk_add_f32 v[80:81], v[80:81], v[84:85]
    v_pk_add_f32 v[82:83], v[82:83], v[86:87]
    v_cvt_pk_bf16_f32 v16, v81, v82
    v_cvt_pk_bf16_f32 v17, v82, v82
    v_cvt_pk_bf16_f32 v18, v82, v82
    v_cvt_pk_bf16_f32 v19, v82, v83
    ds_write2_b32 v88, v16, v17 offset0:1 offset1:2
    ds_write_b64 v88, v[16:17] offset:3200
    ds_write2_b32 v89, v18, v19 offset0:1 offset1:2
    ds_write_b64 v88, v[18:19] offset:4800
    v_cvt_pk_bf16_f32 v20, v80, v80
    v_cvt_pk_bf16_f32 v21, v80, v81
    s_mov_b64 exec, 0x1
    ds_write_b32 v88, v20
    ds_write_b32 v88, v20 offset:3196
    ds_write_b32 v88, v21 offset:1600
    ds_write_b32 v88, v21 offset:4796
    s_mov_b32 exec_lo, 0x0
    s_mov_b32 exec_hi, 0x8000
    ds_write_b16 v88, v17 offset:12
    ds_write_b16 v88, v17 offset:1610
    ds_write_b16 v88, v17 offset:3208
    ds_write_b16 v88, v17 offset:4806
    s_mov_b64 exec, -1
    s_branch C_B3
C_T2:
    v_lshlrev_b32 v88, 7, v6
    v_lshl_add_u32 v89, v5, 1, v88
    v_lshl_add_u32 v88, v5, 2, v88
    s_add_u32 s52, s64, 4728
    v_add_u32 v88, s52, v88
    s_add_u32 s52, s64, 4920
    v_add_u32 v89, s52, v89
    v_mov_b32 v90, s67
    s_waitcnt lgkmcnt(15)
    v_mfma_f32_16x16x32_bf16 v[80:83], v[16:19], v[20:23], 0
    s_waitcnt lgkmcnt(14)
    v_mfma_f32_16x16x32_bf16 v[84:87], v[24:27], v[28:31], 0
    s_waitcnt lgkmcnt(12)
    v_mfma_f32_16x16x32_bf16 v[80:83], v[32:35], v[36:39], v[80:83]
    s_waitcnt lgkmcnt(10)
    v_mfma_f32_16x16x32_bf16 v[84:87], v[40:43], v[44:47], v[84:87]
    s_waitcnt lgkmcnt(8)
    v_mfma_f32_16x16x32_bf16 v[80:83], v[48:51], v[52:55], v[80:83]
    s_waitcnt lgkmcnt(6)
    v_mfma_f32_16x16x32_bf16 v[84:87], v[56:59], v[60:63], v[84:87]
    s_waitcnt lgkmcnt(4)
    v_mfma_f32_16x16x32_bf16 v[80:83], v[64:67], v[68:71], v[80:83]
    s_waitcnt lgkmcnt(2)
    v_mfma_f32_16x16x32_bf16 v[84:87], v[72:75], v[76:79], v[84:87]
    s_waitcnt lgkmcnt(1)
    v_readfirstlane_b32 s39, v167
    s_nop 5
    v_pk_add_f32 v[80:81], v[80:81], v[84:85]
    v_pk_add_f32 v[82:83], v[82:83], v[86:87]
    v_cvt_pk_bf16_f32 v80, v80, v81
    v_cvt_pk_bf16_f32 v81, v82, v83
    s_mov_b32 exec_hi, 0
    ds_write2_b32 v88, v80, v81 offset0:0 offset1:16
    s_not_b64 exec, exec
    ds_write_b16 v89, v80 offset:4
    ds_write_b16_d16_hi v89, v80 offset:36
    ds_write_b16 v89, v81 offset:68
    ds_write_b16_d16_hi v89, v81 offset:100
    ds_write_b16 v89, v80 offset:384
    ds_write_b16_d16_hi v89, v80 offset:416
    ds_write_b16 v89, v81 offset:448
    ds_write_b16_d16_hi v89, v81 offset:480
    s_mov_b32 exec_lo, 0x80000000
    s_mov_b32 exec_hi, 0x0
    ds_write_b16_d16_hi v90, v81 offset:1126
    ds_write_b16_d16_hi v90, v81 offset:1128
    ds_write_b16_d16_hi v90, v81 offset:2724
    ds_write_b16_d16_hi v90, v81 offset:2726
    ds_write_b16_d16_hi v90, v81 offset:4322
    ds_write_b16_d16_hi v90, v81 offset:4324
    ds_write_b16_d16_hi v90, v81 offset:5920
    ds_write_b16_d16_hi v90, v81 offset:5922
    s_mov_b64 exec, -1
C_B3:
    s_cmp_lt_u32 s38, 4
    s_cbranch_scc1 C_NOUL
    buffer_load_dwordx4 v[120:123], v3, s[40:43], s56 offen sc1
    buffer_load_dwordx4 v[124:127], v3, s[40:43], s56 offen offset:1024 sc1
C_NOUL:
    s_waitcnt lgkmcnt(0)
    s_barrier
    s_cmp_eq_u32 s63, 1
    s_cbranch_scc1 C_E1
    s_cmp_eq_u32 s63, 2
    s_cbranch_scc1 C_E2
    s_cmp_eq_u32 s63, 3
    s_cbranch_scc1 C_E3
    ds_read_b64 v[112:113], v7 offset:1152
    ds_read_b64 v[114:115], v7 offset:1160
    ds_read_b64 v[116:117], v7 offset:1216
    ds_read_b64 v[118:119], v7 offset:1224
    ds_read_b64 v[128:129], v7 offset:1280
    ds_read_b64 v[130:131], v7 offset:1288
    ds_read_b64 v[132:133], v7 offset:1344
    ds_read_b64 v[134:135], v7 offset:1352
    ds_read_b64 v[48:49], v7 offset:0
    ds_read_b64 v[50:51], v7 offset:8
    ds_read_b64 v[52:53], v7 offset:64
    ds_read_b64 v[54:55], v7 offset:72
    ds_read_b64 v[56:57], v7 offset:128
    ds_read_b64 v[58:59], v7 offset:136
    ds_read_b64 v[60:61], v7 offset:192
    ds_read_b64 v[62:63], v7 offset:200
    ds_read_b64 v[64:65], v7 offset:256
    ds_read_b64 v[66:67], v7 offset:264
    ds_read_b64 v[68:69], v7 offset:320
    ds_read_b64 v[70:71], v7 offset:328
    ds_read_b64 v[72:73], v7 offset:384
    ds_read_b64 v[74:75], v7 offset:392
    ds_read_b64 v[76:77], v7 offset:448
    ds_read_b64 v[78:79], v7 offset:456
    ds_read_b64 v[80:81], v7 offset:512
    ds_read_b64 v[82:83], v7 offset:520
    ds_read_b64 v[84:85], v7 offset:576
    ds_read_b64 v[86:87], v7 offset:584
    ds_read_b64 v[88:89], v7 offset:640
    ds_read_b64 v[90:91], v7 offset:648
    ds_read_b64 v[92:93], v7 offset:704
    ds_read_b64 v[94:95], v7 offset:712
    ds_read_b64 v[96:97], v7 offset:768
    ds_read_b64 v[98:99], v7 offset:776
    ds_read_b64 v[100:101], v7 offset:832
    ds_read_b64 v[102:103], v7 offset:840
    ds_read_b64 v[104:105], v7 offset:896
    ds_read_b64 v[106:107], v7 offset:904
    ds_read_b64 v[108:109], v7 offset:960
    ds_read_b64 v[110:111], v7 offset:968
    s_bitcmp1_b32 s2, 0
    s_addc_u32 s51, s62, 0
    s_cmp_eq_u32 s51, 3
    s_cselect_b32 s51, 0, s51
    s_and_b32 s52, s2, 1
    s_add_u32 s52, s52, s51
    s_lshl_b32 s52, s52, 1
    s_add_u32 s52, s52, 142672
    v_mov_b32 v16, s52
    v_mov_b32 v164, 0
    ds_read_u16_d16_hi v164, v16
    s_add_u32 s52, s61, 3576
    v_and_b32 v165, 1, v5
    v_lshl_add_u32 v165, v6, 1, v165
    s_mul_i32 s53, s62, 384
    s_add_u32 s53, s53, 161920
    v_lshl_add_u32 v165, v165, 4, s53
    v_lshlrev_b32 v2, 3, v2
    v_sub_u32 v2, s52, v2
    s_mul_i32 s68, s62, 4352
    s_add_u32 s68, s68, 41472
    v_lshl_add_u32 v15, v15, 3, s68
    v_mov_b32 v10, 0
    s_lshr_b32 s52, s2, 3
    s_mul_i32 s52, s52, 24
    s_and_b32 s53, s2, 7
    s_add_u32 s53, s53, 64
    s_movk_i32 s54, 9216
    s_lshl_b32 s55, s53, 7
    s_mov_b32 s56, s26
    s_mov_b32 s57, s27
    s_cmp_eq_u32 s38, 1
    s_cselect_b32 s56, s28, s56
    s_cselect_b32 s57, s29, s57
    s_mul_i32 s53, s53, 73728
    s_cmp_eq_u32 s38, 2
    s_cselect_b32 s56, s30, s56
    s_cselect_b32 s57, s31, s57
    s_cselect_b32 s54, 128, s54
    s_cselect_b32 s55, s53, s55
    v_add_u32 v9, s52, v1
    v_mul_lo_u32 v9, v9, s54
    v_add_u32 v9, s55, v9
    s_branch C_EE
C_E1:
    s_bitcmp1_b32 s2, 0
    s_addc_u32 s51, s62, 0
    s_cmp_eq_u32 s51, 3
    s_cselect_b32 s51, 0, s51
    s_and_b32 s52, s2, 1
    s_add_u32 s52, s52, s51
    s_lshl_b32 s52, s52, 1
    s_add_u32 s52, s52, 142672
    v_mov_b32 v16, s52
    v_mov_b32 v164, 0
    ds_read_u16_d16_hi v164, v16
    s_add_u32 s52, s61, 2552
    v_and_b32 v165, 1, v5
    v_lshl_add_u32 v165, v6, 1, v165
    s_mul_i32 s53, s62, 384
    s_add_u32 s53, s53, 161920
    v_lshl_add_u32 v165, v165, 4, s53
    v_lshlrev_b32 v2, 3, v2
    v_sub_u32 v2, s52, v2
    s_mul_i32 s68, s62, 4352
    s_add_u32 s68, s68, 42560
    v_lshl_add_u32 v15, v15, 3, s68
    v_and_b32 v17, 3, v5
    v_lshl_add_u32 v18, v6, 3, v11
    v_and_b32 v16, 1, v11
    v_mul_u32_u24 v16, 3456, v16
    v_add_u32 v16, s59, v16
    v_sub_u32 v17, v17, v18
    v_sub_u32 v18, v17, v18
    v_add_u32 v19, 44, v17
    v_lshrrev_b32 v20, 4, v19
    v_add_u32 v19, v19, v20
    v_lshl_add_u32 v11, v19, 3, v16
    v_add_u32 v19, 40, v17
    v_lshrrev_b32 v20, 4, v19
    v_add_u32 v19, v19, v20
    v_lshl_add_u32 v12, v19, 3, v16
    ds_read_b64 v[128:129], v7 offset:1152
    ds_read_b64 v[130:131], v7 offset:1160
    ds_read_b64 v[132:133], v7 offset:1216
    ds_read_b64 v[134:135], v7 offset:1224
    ds_read_b64 v[136:137], v7 offset:1280
    ds_read_b64 v[138:139], v7 offset:1288
    ds_read_b64 v[140:141], v7 offset:1344
    ds_read_b64 v[142:143], v7 offset:1352
    ds_read_b64 v[48:49], v7 offset:0
    ds_read_b64 v[50:51], v7 offset:8
    ds_read_b64 v[52:53], v7 offset:64
    ds_read_b64 v[54:55], v7 offset:72
    ds_read_b64 v[56:57], v7 offset:128
    ds_read_b64 v[58:59], v7 offset:136
    ds_read_b64 v[60:61], v7 offset:192
    ds_read_b64 v[62:63], v7 offset:200
    ds_read_b64 v[64:65], v7 offset:256
    ds_read_b64 v[66:67], v7 offset:264
    ds_read_b64 v[68:69], v7 offset:320
    ds_read_b64 v[70:71], v7 offset:328
    ds_read_b64 v[72:73], v7 offset:384
    ds_read_b64 v[74:75], v7 offset:392
    ds_read_b64 v[76:77], v7 offset:448
    ds_read_b64 v[78:79], v7 offset:456
    ds_read_b64 v[80:81], v7 offset:512
    ds_read_b64 v[82:83], v7 offset:520
    ds_read_b64 v[84:85], v7 offset:576
    ds_read_b64 v[86:87], v7 offset:584
    ds_read_b64 v[88:89], v7 offset:640
    ds_read_b64 v[90:91], v7 offset:648
    ds_read_b64 v[92:93], v7 offset:704
    ds_read_b64 v[94:95], v7 offset:712
    ds_read_b64 v[96:97], v7 offset:768
    ds_read_b64 v[98:99], v7 offset:776
    ds_read_b64 v[100:101], v7 offset:832
    ds_read_b64 v[102:103], v7 offset:840
    ds_read_b64 v[104:105], v7 offset:896
    ds_read_b64 v[106:107], v7 offset:904
    ds_read_b64 v[108:109], v7 offset:960
    ds_read_b64 v[110:111], v7 offset:968
    ds_read_b64 v[112:113], v7 offset:1024
    ds_read_b64 v[114:115], v7 offset:1032
    s_branch C_EE
C_E2:
    s_bitcmp1_b32 s2, 0
    s_addc_u32 s51, s62, 0
    s_cmp_eq_u32 s51, 3
    s_cselect_b32 s51, 0, s51
    s_and_b32 s52, s2, 1
    s_add_u32 s52, s52, s51
    s_lshl_b32 s52, s52, 1
    s_add_u32 s52, s52, 142672
    v_mov_b32 v16, s52
    v_mov_b32 v164, 0
    ds_read_u16_d16_hi v164, v16
    s_add_u32 s52, s61, 1528
    v_and_b32 v165, 1, v5
    v_lshl_add_u32 v165, v6, 1, v165
    s_mul_i32 s53, s62, 384
    s_add_u32 s53, s53, 161920
    v_lshl_add_u32 v165, v165, 4, s53
    v_lshlrev_b32 v2, 3, v2
    v_sub_u32 v2, s52, v2
    s_mul_i32 s68, s62, 4352
    s_add_u32 s68, s68, 43648
    v_lshl_add_u32 v15, v15, 3, s68
    v_and_b32 v17, 3, v5
    v_lshl_add_u32 v18, v6, 3, v11
    v_and_b32 v16, 1, v11
    v_mul_u32_u24 v16, 3456, v16
    v_add_u32 v16, s59, v16
    v_sub_u32 v17, v17, v18
    v_sub_u32 v18, v17, v18
    v_add_u32 v19, 44, v17
    v_lshrrev_b32 v20, 4, v19
    v_add_u32 v19, v19, v20
    v_lshl_add_u32 v11, v19, 3, v16
    v_add_u32 v19, 75, v18
    v_lshrrev_b32 v20, 4, v19
    v_add_u32 v19, v19, v20
    v_lshl_add_u32 v13, v19, 3, v16
    v_add_u32 v19, 40, v17
    v_lshrrev_b32 v20, 4, v19
    v_add_u32 v19, v19, v20
    v_lshl_add_u32 v12, v19, 3, v16
    v_add_u32 v19, 67, v18
    v_lshrrev_b32 v20, 4, v19
    v_add_u32 v19, v19, v20
    v_lshl_add_u32 v14, v19, 3, v16
    ds_read_b64 v[152:153], v7 offset:1152
    ds_read_b64 v[154:155], v7 offset:1160
    ds_read_b64 v[156:157], v7 offset:1216
    ds_read_b64 v[158:159], v7 offset:1224
    ds_read_b64 v[48:49], v7 offset:0
    ds_read_b64 v[50:51], v7 offset:8
    ds_read_b64 v[52:53], v7 offset:64
    ds_read_b64 v[54:55], v7 offset:72
    ds_read_b64 v[56:57], v7 offset:128
    ds_read_b64 v[58:59], v7 offset:136
    ds_read_b64 v[60:61], v7 offset:192
    ds_read_b64 v[62:63], v7 offset:200
    ds_read_b64 v[64:65], v7 offset:256
    ds_read_b64 v[66:67], v7 offset:264
    ds_read_b64 v[68:69], v7 offset:320
    ds_read_b64 v[70:71], v7 offset:328
    ds_read_b64 v[72:73], v7 offset:384
    ds_read_b64 v[74:75], v7 offset:392
    ds_read_b64 v[76:77], v7 offset:448
    ds_read_b64 v[78:79], v7 offset:456
    ds_read_b64 v[80:81], v7 offset:512
    ds_read_b64 v[82:83], v7 offset:520
    ds_read_b64 v[84:85], v7 offset:576
    ds_read_b64 v[86:87], v7 offset:584
    ds_read_b64 v[88:89], v7 offset:640
    ds_read_b64 v[90:91], v7 offset:648
    ds_read_b64 v[92:93], v7 offset:704
    ds_read_b64 v[94:95], v7 offset:712
    ds_read_b64 v[96:97], v7 offset:768
    ds_read_b64 v[98:99], v7 offset:776
    ds_read_b64 v[100:101], v7 offset:832
    ds_read_b64 v[102:103], v7 offset:840
    ds_read_b64 v[104:105], v7 offset:896
    ds_read_b64 v[106:107], v7 offset:904
    ds_read_b64 v[108:109], v7 offset:960
    ds_read_b64 v[110:111], v7 offset:968
    ds_read_b64 v[112:113], v7 offset:1024
    ds_read_b64 v[114:115], v7 offset:1032
    ds_read_b64 v[128:129], v9 offset:4608
    ds_read_b64 v[130:131], v9 offset:4616
    ds_read_b64 v[132:133], v9 offset:4672
    ds_read_b64 v[134:135], v9 offset:4680
    ds_read_b64 v[136:137], v9 offset:4736
    ds_read_b64 v[138:139], v9 offset:4744
    ds_read_b64 v[140:141], v9 offset:4800
    ds_read_b64 v[142:143], v9 offset:4808
    ds_read_b64 v[144:145], v9 offset:4864
    ds_read_b64 v[146:147], v9 offset:4872
    ds_read_b64 v[148:149], v9 offset:4928
    ds_read_b64 v[150:151], v9 offset:4936
    s_branch C_EE
C_E3:
    s_bitcmp1_b32 s2, 0
    s_addc_u32 s51, s62, 0
    s_cmp_eq_u32 s51, 3
    s_cselect_b32 s51, 0, s51
    s_and_b32 s52, s2, 1
    s_add_u32 s52, s52, s51
    s_lshl_b32 s52, s52, 1
    s_add_u32 s52, s52, 142672
    v_mov_b32 v16, s52
    v_mov_b32 v164, 0
    ds_read_u16_d16_hi v164, v16
    s_add_u32 s52, s61, 504
    v_and_b32 v165, 1, v5
    v_lshl_add_u32 v165, v6, 1, v165
    s_mul_i32 s53, s62, 384
    s_add_u32 s53, s53, 161920
    v_lshl_add_u32 v165, v165, 4, s53
    v_lshlrev_b32 v2, 3, v2
    v_sub_u32 v2, s52, v2
    s_mul_i32 s68, s62, 4352
    s_add_u32 s68, s68, 44736
    v_lshl_add_u32 v15, v15, 3, s68
    v_and_b32 v17, 3, v5
    v_lshl_add_u32 v18, v6, 3, v11
    v_and_b32 v16, 1, v11
    v_mul_u32_u24 v16, 3456, v16
    v_add_u32 v16, s59, v16
    v_sub_u32 v17, v17, v18
    v_sub_u32 v18, v17, v18
    v_add_u32 v19, 44, v17
    v_lshrrev_b32 v20, 4, v19
    v_add_u32 v19, v19, v20
    v_lshl_add_u32 v11, v19, 3, v16
    v_add_u32 v19, 75, v18
    v_lshrrev_b32 v20, 4, v19
    v_add_u32 v19, v19, v20
    v_lshl_add_u32 v13, v19, 3, v16
    v_add_u32 v19, 40, v17
    v_lshrrev_b32 v20, 4, v19
    v_add_u32 v19, v19, v20
    v_lshl_add_u32 v12, v19, 3, v16
    v_add_u32 v19, 67, v18
    v_lshrrev_b32 v20, 4, v19
    v_add_u32 v19, v19, v20
    v_lshl_add_u32 v14, v19, 3, v16
    ds_read_b64 v[48:49], v7 offset:0
    ds_read_b64 v[50:51], v7 offset:8
    ds_read_b64 v[52:53], v7 offset:64
    ds_read_b64 v[54:55], v7 offset:72
    ds_read_b64 v[56:57], v7 offset:128
    ds_read_b64 v[58:59], v7 offset:136
    ds_read_b64 v[60:61], v7 offset:192
    ds_read_b64 v[62:63], v7 offset:200
    ds_read_b64 v[64:65], v7 offset:256
    ds_read_b64 v[66:67], v7 offset:264
    ds_read_b64 v[68:69], v7 offset:320
    ds_read_b64 v[70:71], v7 offset:328
    ds_read_b64 v[72:73], v7 offset:384
    ds_read_b64 v[74:75], v7 offset:392
    ds_read_b64 v[76:77], v7 offset:448
    ds_read_b64 v[78:79], v7 offset:456
    ds_read_b64 v[80:81], v7 offset:512
    ds_read_b64 v[82:83], v7 offset:520
    ds_read_b64 v[84:85], v7 offset:576
    ds_read_b64 v[86:87], v7 offset:584
    ds_read_b64 v[88:89], v7 offset:640
    ds_read_b64 v[90:91], v7 offset:648
    ds_read_b64 v[92:93], v7 offset:704
    ds_read_b64 v[94:95], v7 offset:712
    ds_read_b64 v[96:97], v7 offset:768
    ds_read_b64 v[98:99], v7 offset:776
    ds_read_b64 v[100:101], v7 offset:832
    ds_read_b64 v[102:103], v7 offset:840
    ds_read_b64 v[104:105], v7 offset:896
    ds_read_b64 v[106:107], v7 offset:904
    ds_read_b64 v[108:109], v7 offset:960
    ds_read_b64 v[110:111], v7 offset:968
    ds_read_b64 v[112:113], v7 offset:1024
    ds_read_b64 v[114:115], v7 offset:1032
    ds_read_b64 v[116:117], v7 offset:1088
    ds_read_b64 v[118:119], v7 offset:1096
    ds_read_b64 v[128:129], v9 offset:4608
    ds_read_b64 v[130:131], v9 offset:4616
    ds_read_b64 v[132:133], v9 offset:4672
    ds_read_b64 v[134:135], v9 offset:4680
    ds_read_b64 v[136:137], v9 offset:4736
    ds_read_b64 v[138:139], v9 offset:4744
    ds_read_b64 v[140:141], v9 offset:4800
    ds_read_b64 v[142:143], v9 offset:4808
    ds_read_b64 v[144:145], v9 offset:4864
    ds_read_b64 v[146:147], v9 offset:4872
    ds_read_b64 v[148:149], v9 offset:4928
    ds_read_b64 v[150:151], v9 offset:4936
    ds_read_b64 v[152:153], v10 offset:5120
    ds_read_b64 v[154:155], v10 offset:5128
    ds_read_b64 v[156:157], v10 offset:5184
    ds_read_b64 v[158:159], v10 offset:5192
C_EE:
    s_cmp_ge_u32 s38, 4
    s_cbranch_scc1 C_UPOLL
    s_cmp_ge_u32 s38, 2
    s_cbranch_scc1 C_B5
    v_lshrrev_b32 v18, 3, v0
    v_mul_u32_u24 v18, 3328, v18
    v_lshl_add_u32 v18, v0, 4, v18
    v_lshlrev_b32 v19, 4, v0
    v_add_u32 v19, 159872, v19
    s_movk_i32 s52, 0x60
    v_cmp_gt_u32 s[50:51], s52, v0
    s_nop 1
    v_cndmask_b32 v18, v19, v18, s[50:51]
    s_movk_i32 s52, 0x78
    v_cmp_gt_u32 vcc, s52, v0
    s_nop 0
    s_and_saveexec_b64 s[50:51], vcc
    ds_write_b128 v18, v[160:163]
    s_mov_b64 exec, s[50:51]
    s_branch C_B5
C_UPOLL:
    s_movk_i32 s60, 4000
    s_branch C_UP_W
C_UP:
    buffer_load_dwordx4 v[120:123], v3, s[40:43], s56 offen sc1
    buffer_load_dwordx4 v[124:127], v3, s[40:43], s56 offen offset:1024 sc1
C_UP_W:
    s_waitcnt vmcnt(0)
    v_xor_b32 v16, v167, v123
    v_xor_b32 v17, v167, v127
    v_or_b32 v16, v16, v17
    v_cmp_ne_u32 vcc, 0, v16
    s_nop 0
    s_and_b64 exec, exec, vcc
    s_cbranch_execz C_UP_D
    s_sub_u32 s60, s60, 1
    s_cmp_gt_i32 s60, 0
    s_sleep 1
    s_cbranch_scc1 C_UP
C_UP_D:
    s_mov_b64 exec, -1
    ds_write_addtid_b32 v120 offset:49152
    ds_write_addtid_b32 v121 offset:55040
    ds_write_addtid_b32 v122 offset:60928
    ds_write_addtid_b32 v124 offset:49408
    ds_write_addtid_b32 v125 offset:55296
    ds_write_addtid_b32 v126 offset:61184
C_B5:
    s_waitcnt lgkmcnt(0)
    s_barrier
    s_movk_i32 s60, 4000
    s_cmp_eq_u32 s63, 1
    s_cbranch_scc1 C_P1
    s_cmp_eq_u32 s63, 2
    s_cbranch_scc1 C_P2
    s_cmp_eq_u32 s63, 3
    s_cbranch_scc1 C_P3
    s_setprio 3
    ds_read_b128 v[32:35], v8 offset:3552
    ds_read_b128 v[36:39], v8 offset:4064
    ds_read_b128 v[40:43], v8 offset:3680
    s_waitcnt lgkmcnt(2)
    v_mfma_f32_16x16x32_bf16 v[136:139], v[112:115], v[32:35], 0
    v_mfma_f32_16x16x32_bf16 v[140:143], v[116:119], v[32:35], 0
    v_mfma_f32_16x16x32_bf16 v[144:147], v[128:131], v[32:35], 0
    v_mfma_f32_16x16x32_bf16 v[148:151], v[132:135], v[32:35], 0
    v_mfma_f32_16x16x32_bf16 v[28:31], v[52:55], v[32:35], 0
    v_mfma_f32_16x16x32_bf16 v[20:23], v[48:51], v[32:35], 0
    ds_read_b128 v[44:47], v8 offset:3808
    s_waitcnt lgkmcnt(2)
    v_mfma_f32_16x16x32_bf16 v[152:155], v[112:115], v[36:39], 0
    v_mfma_f32_16x16x32_bf16 v[156:159], v[116:119], v[36:39], 0
    v_mfma_f32_16x16x32_bf16 v[120:123], v[128:131], v[36:39], 0
    v_mfma_f32_16x16x32_bf16 v[124:127], v[132:135], v[36:39], 0
    v_mfma_f32_16x16x32_bf16 v[28:31], v[84:87], v[36:39], v[28:31]
    v_mfma_f32_16x16x32_bf16 v[20:23], v[80:83], v[36:39], v[20:23]
    v_mfma_f32_16x16x32_bf16 v[24:27], v[52:55], v[36:39], 0
    v_mfma_f32_16x16x32_bf16 v[16:19], v[48:51], v[36:39], 0
    v_cvt_pk_bf16_f32 v136, v136, v137
    v_cvt_pk_bf16_f32 v137, v138, v139
    ds_write_b64 v4, v[136:137] offset:680
    v_cvt_pk_bf16_f32 v140, v140, v141
    v_cvt_pk_bf16_f32 v141, v142, v143
    ds_write_b64 v4, v[140:141] offset:4136
    v_cvt_pk_bf16_f32 v144, v144, v145
    v_cvt_pk_bf16_f32 v145, v146, v147
    ds_write_b64 v4, v[144:145] offset:7592
    v_cvt_pk_bf16_f32 v148, v148, v149
    v_cvt_pk_bf16_f32 v149, v150, v151
    ds_write_b64 v4, v[148:149] offset:11048
    ds_read_b128 v[32:35], v8 offset:3936
    s_waitcnt lgkmcnt(6)
    v_mfma_f32_16x16x32_bf16 v[28:31], v[60:63], v[40:43], v[28:31]
    v_mfma_f32_16x16x32_bf16 v[20:23], v[56:59], v[40:43], v[20:23]
    v_cvt_pk_bf16_f32 v152, v152, v153
    v_cvt_pk_bf16_f32 v153, v154, v155
    ds_write_b64 v4, v[152:153] offset:136
    v_cvt_pk_bf16_f32 v156, v156, v157
    v_cvt_pk_bf16_f32 v157, v158, v159
    ds_write_b64 v4, v[156:157] offset:3592
    v_cvt_pk_bf16_f32 v120, v120, v121
    v_cvt_pk_bf16_f32 v121, v122, v123
    ds_write_b64 v4, v[120:121] offset:7048
    v_cvt_pk_bf16_f32 v124, v124, v125
    v_cvt_pk_bf16_f32 v125, v126, v127
    ds_write_b64 v4, v[124:125] offset:10504
    s_mov_b64 exec, 0x1
    ds_write_b32 v166, v166 offset:0
    s_mov_b64 exec, -1
    s_setprio 2
    ds_read_b128 v[84:87], v8 offset:4192
    s_or_b32 s52, s38, s2
    s_cbranch_scc1 C_NOEP
    s_mov_b64 exec, 0x1
    buffer_store_dword v167, v10, s[40:43], 0 offen sc1
C_NOEP:
    s_mov_b64 exec, 0xffffff
    global_load_dword v159, v9, s[56:57]
    s_mov_b64 exec, -1
    ds_read_b64 v[160:161], v2 offset:512
    ds_read_b64 v[162:163], v2
    s_waitcnt lgkmcnt(13)
    v_mfma_f32_16x16x32_bf16 v[28:31], v[68:71], v[44:47], v[28:31]
    v_mfma_f32_16x16x32_bf16 v[20:23], v[64:67], v[44:47], v[20:23]
    ds_read_b128 v[80:83], v8 offset:4320
    s_waitcnt lgkmcnt(9)
    v_mfma_f32_16x16x32_bf16 v[28:31], v[76:79], v[32:35], v[28:31]
    v_mfma_f32_16x16x32_bf16 v[20:23], v[72:75], v[32:35], v[20:23]
    ds_read_b128 v[36:39], v8 offset:4448
    s_waitcnt lgkmcnt(2)
    s_setprio 0
    v_and_b32 v48, 0xffff0000, v161
    v_lshlrev_b32 v49, 16, v161
    v_and_b32 v50, 0xffff0000, v160
    v_lshlrev_b32 v51, 16, v160
    v_mul_f32 v48, v48, v164
    v_mul_f32 v49, v49, v164
    v_mul_f32 v50, v50, v164
    v_mul_f32 v51, v51, v164
    v_cvt_pk_bf16_f32 v49, v48, v49
    v_lshlrev_b32 v48, 16, v49
    v_and_b32 v49, 0xffff0000, v49
    v_cvt_pk_bf16_f32 v51, v50, v51
    v_lshlrev_b32 v50, 16, v51
    v_and_b32 v51, 0xffff0000, v51
    v_and_b32 v52, 0xffff0000, v163
    v_lshlrev_b32 v53, 16, v163
    v_and_b32 v54, 0xffff0000, v162
    v_lshlrev_b32 v55, 16, v162
    v_mul_f32 v52, v52, v164
    v_mul_f32 v53, v53, v164
    v_mul_f32 v54, v54, v164
    v_mul_f32 v55, v55, v164
    v_cvt_pk_bf16_f32 v53, v52, v53
    v_lshlrev_b32 v52, 16, v53
    v_and_b32 v53, 0xffff0000, v53
    v_cvt_pk_bf16_f32 v55, v54, v55
    v_lshlrev_b32 v54, 16, v55
    v_and_b32 v55, 0xffff0000, v55
    s_setprio 2
    v_mfma_f32_16x16x32_bf16 v[28:31], v[92:95], v[84:87], v[28:31]
    v_mfma_f32_16x16x32_bf16 v[20:23], v[88:91], v[84:87], v[20:23]
    v_mfma_f32_16x16x32_bf16 v[24:27], v[60:63], v[84:87], v[24:27]
    v_mfma_f32_16x16x32_bf16 v[16:19], v[56:59], v[84:87], v[16:19]
    s_waitcnt lgkmcnt(1)
    v_mfma_f32_16x16x32_bf16 v[28:31], v[100:103], v[80:83], v[28:31]
    v_mfma_f32_16x16x32_bf16 v[20:23], v[96:99], v[80:83], v[20:23]
    v_mfma_f32_16x16x32_bf16 v[24:27], v[68:71], v[80:83], v[24:27]
    v_mfma_f32_16x16x32_bf16 v[16:19], v[64:67], v[80:83], v[16:19]
    s_waitcnt lgkmcnt(0)
    v_mfma_f32_16x16x32_bf16 v[28:31], v[108:111], v[36:39], v[28:31]
    v_mfma_f32_16x16x32_bf16 v[20:23], v[104:107], v[36:39], v[20:23]
    v_mfma_f32_16x16x32_bf16 v[24:27], v[76:79], v[36:39], v[24:27]
    v_mfma_f32_16x16x32_bf16 v[16:19], v[72:75], v[36:39], v[16:19]
    s_mov_b32 exec_lo, 0xc000c000
    s_mov_b32 exec_hi, 0xc000c000
    s_nop 2
    ds_write_b128 v165, v[28:31] offset:128
    ds_write_b32 v166, v166 offset:64
    s_mov_b64 exec, -1
    s_setprio 0
    s_branch C_EPI
C_P1:
    s_setprio 3
    ds_read_b128 v[32:35], v8 offset:2528
    ds_read_b128 v[36:39], v8 offset:3040
    ds_read_b128 v[40:43], v8 offset:2656
    s_waitcnt lgkmcnt(2)
    v_mfma_f32_16x16x32_bf16 v[144:147], v[128:131], v[32:35], 0
    v_mfma_f32_16x16x32_bf16 v[148:151], v[132:135], v[32:35], 0
    v_mfma_f32_16x16x32_bf16 v[152:155], v[136:139], v[32:35], 0
    v_mfma_f32_16x16x32_bf16 v[156:159], v[140:143], v[32:35], 0
    v_mfma_f32_16x16x32_bf16 v[28:31], v[52:55], v[32:35], 0
    v_mfma_f32_16x16x32_bf16 v[20:23], v[48:51], v[32:35], 0
    ds_read_b128 v[44:47], v8 offset:2784
    s_waitcnt lgkmcnt(2)
    v_mfma_f32_16x16x32_bf16 v[116:119], v[128:131], v[36:39], 0
    v_mfma_f32_16x16x32_bf16 v[160:163], v[132:135], v[36:39], 0
    v_mfma_f32_16x16x32_bf16 v[120:123], v[136:139], v[36:39], 0
    v_mfma_f32_16x16x32_bf16 v[124:127], v[140:143], v[36:39], 0
    v_mfma_f32_16x16x32_bf16 v[28:31], v[84:87], v[36:39], v[28:31]
    v_mfma_f32_16x16x32_bf16 v[20:23], v[80:83], v[36:39], v[20:23]
    v_mfma_f32_16x16x32_bf16 v[24:27], v[52:55], v[36:39], 0
    v_mfma_f32_16x16x32_bf16 v[16:19], v[48:51], v[36:39], 0
    v_cvt_pk_bf16_f32 v144, v144, v145
    v_cvt_pk_bf16_f32 v145, v146, v147
    ds_write_b64 v4, v[144:145] offset:1768
    v_cvt_pk_bf16_f32 v148, v148, v149
    v_cvt_pk_bf16_f32 v149, v150, v151
    ds_write_b64 v4, v[148:149] offset:5224
    v_cvt_pk_bf16_f32 v152, v152, v153
    v_cvt_pk_bf16_f32 v153, v154, v155
    ds_write_b64 v4, v[152:153] offset:8680
    v_cvt_pk_bf16_f32 v156, v156, v157
    v_cvt_pk_bf16_f32 v157, v158, v159
    ds_write_b64 v4, v[156:157] offset:12136
    ds_read_b128 v[32:35], v8 offset:2912
    s_waitcnt lgkmcnt(6)
    v_mfma_f32_16x16x32_bf16 v[28:31], v[60:63], v[40:43], v[28:31]
    v_mfma_f32_16x16x32_bf16 v[20:23], v[56:59], v[40:43], v[20:23]
    v_cvt_pk_bf16_f32 v116, v116, v117
    v_cvt_pk_bf16_f32 v117, v118, v119
    ds_write_b64 v4, v[116:117] offset:1224
    v_cvt_pk_bf16_f32 v160, v160, v161
    v_cvt_pk_bf16_f32 v161, v162, v163
    ds_write_b64 v4, v[160:161] offset:4680
    v_cvt_pk_bf16_f32 v120, v120, v121
    v_cvt_pk_bf16_f32 v121, v122, v123
    ds_write_b64 v4, v[120:121] offset:8136
    v_cvt_pk_bf16_f32 v124, v124, v125
    v_cvt_pk_bf16_f32 v125, v126, v127
    ds_write_b64 v4, v[124:125] offset:11592
    s_mov_b64 exec, 0x1
    ds_write_b32 v166, v166 offset:4
    s_mov_b64 exec, -1
    s_setprio 2
    ds_read_b128 v[36:39], v8 offset:3168
    ds_read_b64 v[144:145], v9 offset:4608
    ds_read_b64 v[146:147], v9 offset:4616
    ds_read_b64 v[148:149], v9 offset:4672
    ds_read_b64 v[150:151], v9 offset:4680
    ds_read_b64 v[152:153], v9 offset:4736
    ds_read_b64 v[154:155], v9 offset:4744
    ds_read_b64 v[156:157], v9 offset:4800
    ds_read_b64 v[158:159], v9 offset:4808
    ds_read_b64 v[160:161], v2 offset:512
    ds_read_b64 v[162:163], v2
    s_waitcnt lgkmcnt(15)
    v_mfma_f32_16x16x32_bf16 v[28:31], v[68:71], v[44:47], v[28:31]
    v_mfma_f32_16x16x32_bf16 v[20:23], v[64:67], v[44:47], v[20:23]
    ds_read_b128 v[40:43], v8 offset:3296
    v_mfma_f32_16x16x32_bf16 v[28:31], v[76:79], v[32:35], v[28:31]
    v_mfma_f32_16x16x32_bf16 v[20:23], v[72:75], v[32:35], v[20:23]
    ds_read_b128 v[128:131], v8 offset:3424
    s_waitcnt lgkmcnt(2)
    s_setprio 0
    v_and_b32 v48, 0xffff0000, v161
    v_lshlrev_b32 v49, 16, v161
    v_and_b32 v50, 0xffff0000, v160
    v_lshlrev_b32 v51, 16, v160
    v_mul_f32 v48, v48, v164
    v_mul_f32 v49, v49, v164
    v_mul_f32 v50, v50, v164
    v_mul_f32 v51, v51, v164
    v_cvt_pk_bf16_f32 v49, v48, v49
    v_lshlrev_b32 v48, 16, v49
    v_and_b32 v49, 0xffff0000, v49
    v_cvt_pk_bf16_f32 v51, v50, v51
    v_lshlrev_b32 v50, 16, v51
    v_and_b32 v51, 0xffff0000, v51
    v_and_b32 v52, 0xffff0000, v163
    v_lshlrev_b32 v53, 16, v163
    v_and_b32 v54, 0xffff0000, v162
    v_lshlrev_b32 v55, 16, v162
    v_mul_f32 v52, v52, v164
    v_mul_f32 v53, v53, v164
    v_mul_f32 v54, v54, v164
    v_mul_f32 v55, v55, v164
    v_cvt_pk_bf16_f32 v53, v52, v53
    v_lshlrev_b32 v52, 16, v53
    v_and_b32 v53, 0xffff0000, v53
    v_cvt_pk_bf16_f32 v55, v54, v55
    v_lshlrev_b32 v54, 16, v55
    v_and_b32 v55, 0xffff0000, v55
    s_setprio 2
    v_mfma_f32_16x16x32_bf16 v[28:31], v[92:95], v[36:39], v[28:31]
    v_mfma_f32_16x16x32_bf16 v[20:23], v[88:91], v[36:39], v[20:23]
    v_mfma_f32_16x16x32_bf16 v[24:27], v[60:63], v[36:39], v[24:27]
    v_mfma_f32_16x16x32_bf16 v[16:19], v[56:59], v[36:39], v[16:19]
    ds_read_b128 v[132:135], v8 offset:3552
    s_waitcnt lgkmcnt(2)
    v_mfma_f32_16x16x32_bf16 v[28:31], v[100:103], v[40:43], v[28:31]
    v_mfma_f32_16x16x32_bf16 v[20:23], v[96:99], v[40:43], v[20:23]
    v_mfma_f32_16x16x32_bf16 v[24:27], v[68:71], v[40:43], v[24:27]
    v_mfma_f32_16x16x32_bf16 v[16:19], v[64:67], v[40:43], v[16:19]
    ds_read_b96 v[60:62], v166
    ds_read_b128 v[136:139], v8 offset:3680
    s_waitcnt lgkmcnt(3)
    v_mfma_f32_16x16x32_bf16 v[28:31], v[108:111], v[128:131], v[28:31]
    v_mfma_f32_16x16x32_bf16 v[20:23], v[104:107], v[128:131], v[20:23]
    v_mfma_f32_16x16x32_bf16 v[24:27], v[76:79], v[128:131], v[24:27]
    v_mfma_f32_16x16x32_bf16 v[16:19], v[72:75], v[128:131], v[16:19]
    s_waitcnt lgkmcnt(1)
C_FL1:
    v_min3_u32 v60, v60, v61, v62
    v_cmp_eq_u32 vcc, 0, v60
    s_nop 4
    s_cbranch_vccz C_FD1
    ds_read_b96 v[60:62], v166
    s_sub_u32 s60, s60, 1
    s_cmp_gt_i32 s60, 0
    s_waitcnt lgkmcnt(0)
    s_cbranch_scc1 C_FL1
C_FD1:
    ds_read_b128 v[140:143], v8 offset:3808
    v_mfma_f32_16x16x32_bf16 v[20:23], v[112:115], v[132:135], v[20:23]
    v_mfma_f32_16x16x32_bf16 v[24:27], v[84:87], v[132:135], v[24:27]
    v_mfma_f32_16x16x32_bf16 v[16:19], v[80:83], v[132:135], v[16:19]
    s_mov_b32 exec_lo, 0xc000c000
    s_mov_b32 exec_hi, 0xc000c000
    ds_write_b128 v165, v[28:31] offset:256
    ds_write_b32 v166, v166 offset:68
    s_mov_b64 exec, -1
    ds_read_b128 v[44:47], v8 offset:3936
    s_waitcnt lgkmcnt(4)
    v_mfma_f32_16x16x32_bf16 v[24:27], v[92:95], v[136:139], v[24:27]
    v_mfma_f32_16x16x32_bf16 v[16:19], v[88:91], v[136:139], v[16:19]
    ds_read_b128 v[32:35], v8 offset:4064
    ds_read_b64_tr_b16 v[36:37], v11 offset:0
    ds_read_b64_tr_b16 v[38:39], v12 offset:0
    ds_read_b64_tr_b16 v[68:69], v11 offset:272
    ds_read_b64_tr_b16 v[70:71], v12 offset:272
    s_waitcnt lgkmcnt(8)
    v_mfma_f32_16x16x32_bf16 v[24:27], v[100:103], v[140:143], v[24:27]
    v_mfma_f32_16x16x32_bf16 v[16:19], v[96:99], v[140:143], v[16:19]
    ds_read_b64_tr_b16 v[64:65], v11 offset:544
    ds_read_b64_tr_b16 v[66:67], v12 offset:544
    s_waitcnt lgkmcnt(7)
    v_mfma_f32_16x16x32_bf16 v[24:27], v[108:111], v[44:47], v[24:27]
    v_mfma_f32_16x16x32_bf16 v[16:19], v[104:107], v[44:47], v[16:19]
    ds_read_b64_tr_b16 v[40:41], v11 offset:816
    ds_read_b64_tr_b16 v[42:43], v12 offset:816
    s_waitcnt lgkmcnt(8)
    v_mfma_f32_16x16x32_bf16 v[16:19], v[112:115], v[32:35], v[16:19]
    s_waitcnt lgkmcnt(6)
    v_mfma_f32_16x16x32_bf16 v[20:23], v[36:39], v[156:159], v[20:23]
    v_mfma_f32_16x16x32_bf16 v[16:19], v[36:39], v[148:151], v[16:19]
    s_waitcnt lgkmcnt(4)
    v_mfma_f32_16x16x32_bf16 v[20:23], v[68:71], v[152:155], v[20:23]
    v_mfma_f32_16x16x32_bf16 v[16:19], v[68:71], v[144:147], v[16:19]
    ds_read_b32 v60, v166 offset:64
    ds_read_b128 v[56:59], v165 offset:128
    s_waitcnt lgkmcnt(4)
    v_mfma_f32_16x16x32_bf16 v[20:23], v[64:67], v[148:151], v[20:23]
    s_waitcnt lgkmcnt(2)
    v_mfma_f32_16x16x32_bf16 v[20:23], v[40:43], v[144:147], v[20:23]
    s_setprio 0
    s_waitcnt lgkmcnt(0)
C_CL1:
    v_cmp_eq_u32 vcc, 0, v60
    s_nop 4
    s_cbranch_vccz C_CD
    ds_read_b32 v60, v166 offset:64
    ds_read_b128 v[56:59], v165 offset:128
    s_sub_u32 s60, s60, 1
    s_cmp_gt_i32 s60, 0
    s_waitcnt lgkmcnt(0)
    s_cbranch_scc1 C_CL1
    s_branch C_CD
C_P2:
    s_setprio 3
    ds_read_b128 v[32:35], v8 offset:1504
    ds_read_b128 v[36:39], v8 offset:2016
    ds_read_b128 v[40:43], v8 offset:1632
    s_waitcnt lgkmcnt(2)
    v_mfma_f32_16x16x32_bf16 v[116:119], v[152:155], v[32:35], 0
    v_mfma_f32_16x16x32_bf16 v[160:163], v[156:159], v[32:35], 0
    v_mfma_f32_16x16x32_bf16 v[28:31], v[52:55], v[32:35], 0
    v_mfma_f32_16x16x32_bf16 v[20:23], v[48:51], v[32:35], 0
    ds_read_b128 v[44:47], v8 offset:1760
    s_waitcnt lgkmcnt(2)
    v_mfma_f32_16x16x32_bf16 v[120:123], v[152:155], v[36:39], 0
    v_mfma_f32_16x16x32_bf16 v[124:127], v[156:159], v[36:39], 0
    v_mfma_f32_16x16x32_bf16 v[28:31], v[84:87], v[36:39], v[28:31]
    v_mfma_f32_16x16x32_bf16 v[20:23], v[80:83], v[36:39], v[20:23]
    v_mfma_f32_16x16x32_bf16 v[24:27], v[52:55], v[36:39], 0
    v_mfma_f32_16x16x32_bf16 v[16:19], v[48:51], v[36:39], 0
    v_cvt_pk_bf16_f32 v116, v116, v117
    v_cvt_pk_bf16_f32 v117, v118, v119
    ds_write_b64 v4, v[116:117] offset:2856
    v_cvt_pk_bf16_f32 v160, v160, v161
    v_cvt_pk_bf16_f32 v161, v162, v163
    ds_write_b64 v4, v[160:161] offset:6312
    ds_read_b128 v[32:35], v8 offset:1888
    s_waitcnt lgkmcnt(4)
    v_mfma_f32_16x16x32_bf16 v[28:31], v[60:63], v[40:43], v[28:31]
    v_mfma_f32_16x16x32_bf16 v[20:23], v[56:59], v[40:43], v[20:23]
    v_cvt_pk_bf16_f32 v120, v120, v121
    v_cvt_pk_bf16_f32 v121, v122, v123
    ds_write_b64 v4, v[120:121] offset:2312
    v_cvt_pk_bf16_f32 v124, v124, v125
    v_cvt_pk_bf16_f32 v125, v126, v127
    ds_write_b64 v4, v[124:125] offset:5768
    s_mov_b64 exec, 0x1
    ds_write_b32 v166, v166 offset:8
    s_mov_b64 exec, -1
    s_setprio 2
    ds_read_b128 v[36:39], v8 offset:2144
    ds_read_b64 v[116:117], v7 offset:1088
    ds_read_b64 v[118:119], v7 offset:1096
    ds_read_b64 v[120:121], v10 offset:5120
    ds_read_b64 v[122:123], v10 offset:5128
    ds_read_b64 v[124:125], v10 offset:5184
    ds_read_b64 v[126:127], v10 offset:5192
    ds_read_b64 v[160:161], v2 offset:512
    ds_read_b64 v[162:163], v2
    s_waitcnt lgkmcnt(15)
    v_mfma_f32_16x16x32_bf16 v[28:31], v[68:71], v[44:47], v[28:31]
    v_mfma_f32_16x16x32_bf16 v[20:23], v[64:67], v[44:47], v[20:23]
    ds_read_b128 v[40:43], v8 offset:2272
    s_waitcnt lgkmcnt(13)
    v_mfma_f32_16x16x32_bf16 v[28:31], v[76:79], v[32:35], v[28:31]
    v_mfma_f32_16x16x32_bf16 v[20:23], v[72:75], v[32:35], v[20:23]
    ds_read_b128 v[152:155], v8 offset:2400
    s_waitcnt lgkmcnt(2)
    s_setprio 0
    v_and_b32 v48, 0xffff0000, v161
    v_lshlrev_b32 v49, 16, v161
    v_and_b32 v50, 0xffff0000, v160
    v_lshlrev_b32 v51, 16, v160
    v_mul_f32 v48, v48, v164
    v_mul_f32 v49, v49, v164
    v_mul_f32 v50, v50, v164
    v_mul_f32 v51, v51, v164
    v_cvt_pk_bf16_f32 v49, v48, v49
    v_lshlrev_b32 v48, 16, v49
    v_and_b32 v49, 0xffff0000, v49
    v_cvt_pk_bf16_f32 v51, v50, v51
    v_lshlrev_b32 v50, 16, v51
    v_and_b32 v51, 0xffff0000, v51
    v_and_b32 v52, 0xffff0000, v163
    v_lshlrev_b32 v53, 16, v163
    v_and_b32 v54, 0xffff0000, v162
    v_lshlrev_b32 v55, 16, v162
    v_mul_f32 v52, v52, v164
    v_mul_f32 v53, v53, v164
    v_mul_f32 v54, v54, v164
    v_mul_f32 v55, v55, v164
    v_cvt_pk_bf16_f32 v53, v52, v53
    v_lshlrev_b32 v52, 16, v53
    v_and_b32 v53, 0xffff0000, v53
    v_cvt_pk_bf16_f32 v55, v54, v55
    v_lshlrev_b32 v54, 16, v55
    v_and_b32 v55, 0xffff0000, v55
    s_setprio 2
    v_mfma_f32_16x16x32_bf16 v[28:31], v[92:95], v[36:39], v[28:31]
    v_mfma_f32_16x16x32_bf16 v[20:23], v[88:91], v[36:39], v[20:23]
    v_mfma_f32_16x16x32_bf16 v[24:27], v[60:63], v[36:39], v[24:27]
    v_mfma_f32_16x16x32_bf16 v[16:19], v[56:59], v[36:39], v[16:19]
    ds_read_b128 v[156:159], v8 offset:2528
    s_waitcnt lgkmcnt(2)
    v_mfma_f32_16x16x32_bf16 v[28:31], v[100:103], v[40:43], v[28:31]
    v_mfma_f32_16x16x32_bf16 v[20:23], v[96:99], v[40:43], v[20:23]
    v_mfma_f32_16x16x32_bf16 v[24:27], v[68:71], v[40:43], v[24:27]
    v_mfma_f32_16x16x32_bf16 v[16:19], v[64:67], v[40:43], v[16:19]
    ds_read_b128 v[44:47], v8 offset:2656
    s_waitcnt lgkmcnt(2)
    v_mfma_f32_16x16x32_bf16 v[28:31], v[108:111], v[152:155], v[28:31]
    v_mfma_f32_16x16x32_bf16 v[20:23], v[104:107], v[152:155], v[20:23]
    v_mfma_f32_16x16x32_bf16 v[24:27], v[76:79], v[152:155], v[24:27]
    v_mfma_f32_16x16x32_bf16 v[16:19], v[72:75], v[152:155], v[16:19]
    ds_read_b128 v[32:35], v8 offset:2784
    s_waitcnt lgkmcnt(2)
    v_mfma_f32_16x16x32_bf16 v[20:23], v[112:115], v[156:159], v[20:23]
    v_mfma_f32_16x16x32_bf16 v[24:27], v[84:87], v[156:159], v[24:27]
    v_mfma_f32_16x16x32_bf16 v[16:19], v[80:83], v[156:159], v[16:19]
    s_mov_b32 exec_lo, 0xc000c000
    s_mov_b32 exec_hi, 0xc000c000
    ds_write_b128 v165, v[28:31] offset:384
    ds_write_b32 v166, v166 offset:72
    s_mov_b64 exec, -1
    ds_read_b96 v[60:62], v166
    ds_read_b128 v[36:39], v8 offset:2912
    s_waitcnt lgkmcnt(5)
    v_mfma_f32_16x16x32_bf16 v[24:27], v[92:95], v[44:47], v[24:27]
    v_mfma_f32_16x16x32_bf16 v[16:19], v[88:91], v[44:47], v[16:19]
    s_waitcnt lgkmcnt(1)
C_FL2:
    v_min3_u32 v60, v60, v61, v62
    v_cmp_eq_u32 vcc, 0, v60
    s_nop 4
    s_cbranch_vccz C_FD2
    ds_read_b96 v[60:62], v166
    s_sub_u32 s60, s60, 1
    s_cmp_gt_i32 s60, 0
    s_waitcnt lgkmcnt(0)
    s_cbranch_scc1 C_FL2
C_FD2:
    ds_read_b128 v[68:71], v8 offset:3040
    v_mfma_f32_16x16x32_bf16 v[24:27], v[100:103], v[32:35], v[24:27]
    v_mfma_f32_16x16x32_bf16 v[16:19], v[96:99], v[32:35], v[16:19]
    ds_read_b128 v[64:67], v8 offset:3552
    s_waitcnt lgkmcnt(2)
    v_mfma_f32_16x16x32_bf16 v[24:27], v[108:111], v[36:39], v[24:27]
    v_mfma_f32_16x16x32_bf16 v[16:19], v[104:107], v[36:39], v[16:19]
    ds_read_b128 v[40:43], v8 offset:4064
    ds_read_b64_tr_b16 v[76:77], v13 offset:6912
    ds_read_b64_tr_b16 v[78:79], v14 offset:6912
    ds_read_b64_tr_b16 v[72:73], v13 offset:7456
    ds_read_b64_tr_b16 v[74:75], v14 offset:7456
    s_waitcnt lgkmcnt(6)
    v_mfma_f32_16x16x32_bf16 v[16:19], v[112:115], v[68:71], v[16:19]
    ds_read_b64_tr_b16 v[152:153], v11 offset:0
    ds_read_b64_tr_b16 v[154:155], v12 offset:0
    s_waitcnt lgkmcnt(7)
    v_mfma_f32_16x16x32_bf16 v[20:23], v[116:119], v[64:67], v[20:23]
    ds_read_b64_tr_b16 v[84:85], v11 offset:272
    ds_read_b64_tr_b16 v[86:87], v12 offset:272
    s_waitcnt lgkmcnt(8)
    v_mfma_f32_16x16x32_bf16 v[16:19], v[116:119], v[40:43], v[16:19]
    ds_read_b64_tr_b16 v[80:81], v11 offset:544
    ds_read_b64_tr_b16 v[82:83], v12 offset:544
    s_waitcnt lgkmcnt(8)
    v_mfma_f32_16x16x32_bf16 v[20:23], v[76:79], v[124:127], v[20:23]
    v_mfma_f32_16x16x32_bf16 v[16:19], v[76:79], v[120:123], v[16:19]
    ds_read_b64_tr_b16 v[156:157], v11 offset:816
    ds_read_b64_tr_b16 v[158:159], v12 offset:816
    s_waitcnt lgkmcnt(8)
    v_mfma_f32_16x16x32_bf16 v[20:23], v[72:75], v[120:123], v[20:23]
    ds_read_b64_tr_b16 v[92:93], v11 offset:1088
    ds_read_b64_tr_b16 v[94:95], v12 offset:1088
    s_waitcnt lgkmcnt(8)
    v_mfma_f32_16x16x32_bf16 v[16:19], v[152:155], v[148:151], v[16:19]
    ds_read_b64_tr_b16 v[88:89], v11 offset:1360
    ds_read_b64_tr_b16 v[90:91], v12 offset:1360
    s_waitcnt lgkmcnt(8)
    v_mfma_f32_16x16x32_bf16 v[16:19], v[84:87], v[144:147], v[16:19]
    ds_read_b64_tr_b16 v[44:45], v11 offset:1632
    ds_read_b64_tr_b16 v[46:47], v12 offset:1632
    s_waitcnt lgkmcnt(8)
    v_mfma_f32_16x16x32_bf16 v[20:23], v[80:83], v[148:151], v[20:23]
    v_mfma_f32_16x16x32_bf16 v[16:19], v[80:83], v[140:143], v[16:19]
    ds_read_b64_tr_b16 v[100:101], v11 offset:1904
    ds_read_b64_tr_b16 v[102:103], v12 offset:1904
    s_waitcnt lgkmcnt(8)
    v_mfma_f32_16x16x32_bf16 v[20:23], v[156:159], v[144:147], v[20:23]
    v_mfma_f32_16x16x32_bf16 v[16:19], v[156:159], v[136:139], v[16:19]
    s_waitcnt lgkmcnt(6)
    v_mfma_f32_16x16x32_bf16 v[20:23], v[92:95], v[140:143], v[20:23]
    v_mfma_f32_16x16x32_bf16 v[16:19], v[92:95], v[132:135], v[16:19]
    s_waitcnt lgkmcnt(4)
    v_mfma_f32_16x16x32_bf16 v[20:23], v[88:91], v[136:139], v[20:23]
    v_mfma_f32_16x16x32_bf16 v[16:19], v[88:91], v[128:131], v[16:19]
    ds_read_b32 v60, v166 offset:68
    ds_read_b128 v[56:59], v165 offset:256
    s_waitcnt lgkmcnt(4)
    v_mfma_f32_16x16x32_bf16 v[20:23], v[44:47], v[132:135], v[20:23]
    s_waitcnt lgkmcnt(2)
    v_mfma_f32_16x16x32_bf16 v[20:23], v[100:103], v[128:131], v[20:23]
    s_setprio 0
    s_waitcnt lgkmcnt(0)
C_CL2:
    v_cmp_eq_u32 vcc, 0, v60
    s_nop 4
    s_cbranch_vccz C_CD
    ds_read_b32 v60, v166 offset:68
    ds_read_b128 v[56:59], v165 offset:256
    s_sub_u32 s60, s60, 1
    s_cmp_gt_i32 s60, 0
    s_waitcnt lgkmcnt(0)
    s_cbranch_scc1 C_CL2
    s_branch C_CD
C_P3:
    s_setprio 2
    ds_read_b128 v[32:35], v8 offset:480
    ds_read_b128 v[36:39], v8 offset:608
    ds_read_b128 v[40:43], v8 offset:736
    ds_read_b64 v[120:121], v10 offset:5248
    ds_read_b64 v[122:123], v10 offset:5256
    ds_read_b64 v[124:125], v10 offset:5312
    ds_read_b64 v[126:127], v10 offset:5320
    ds_read_b64 v[160:161], v2 offset:512
    ds_read_b64 v[162:163], v2
    s_waitcnt lgkmcnt(8)
    v_mfma_f32_16x16x32_bf16 v[28:31], v[52:55], v[32:35], 0
    v_mfma_f32_16x16x32_bf16 v[20:23], v[48:51], v[32:35], 0
    ds_read_b128 v[44:47], v8 offset:864
    s_waitcnt lgkmcnt(8)
    v_mfma_f32_16x16x32_bf16 v[28:31], v[60:63], v[36:39], v[28:31]
    v_mfma_f32_16x16x32_bf16 v[20:23], v[56:59], v[36:39], v[20:23]
    ds_read_b128 v[32:35], v8 offset:992
    s_waitcnt lgkmcnt(8)
    v_mfma_f32_16x16x32_bf16 v[28:31], v[68:71], v[40:43], v[28:31]
    v_mfma_f32_16x16x32_bf16 v[20:23], v[64:67], v[40:43], v[20:23]
    ds_read_b128 v[36:39], v8 offset:1120
    s_waitcnt lgkmcnt(2)
    v_mfma_f32_16x16x32_bf16 v[28:31], v[76:79], v[44:47], v[28:31]
    v_mfma_f32_16x16x32_bf16 v[20:23], v[72:75], v[44:47], v[20:23]
    ds_read_b128 v[40:43], v8 offset:1248
    s_waitcnt lgkmcnt(2)
    v_mfma_f32_16x16x32_bf16 v[28:31], v[84:87], v[32:35], v[28:31]
    v_mfma_f32_16x16x32_bf16 v[20:23], v[80:83], v[32:35], v[20:23]
    v_mfma_f32_16x16x32_bf16 v[24:27], v[52:55], v[32:35], 0
    v_mfma_f32_16x16x32_bf16 v[16:19], v[48:51], v[32:35], 0
    ds_read_b128 v[44:47], v8 offset:1376
    s_waitcnt lgkmcnt(2)
    v_mfma_f32_16x16x32_bf16 v[28:31], v[92:95], v[36:39], v[28:31]
    v_mfma_f32_16x16x32_bf16 v[20:23], v[88:91], v[36:39], v[20:23]
    v_mfma_f32_16x16x32_bf16 v[24:27], v[60:63], v[36:39], v[24:27]
    v_mfma_f32_16x16x32_bf16 v[16:19], v[56:59], v[36:39], v[16:19]
    ds_read_b128 v[32:35], v8 offset:1504
    s_setprio 0
    v_and_b32 v48, 0xffff0000, v161
    v_lshlrev_b32 v49, 16, v161
    v_and_b32 v50, 0xffff0000, v160
    v_lshlrev_b32 v51, 16, v160
    v_mul_f32 v48, v48, v164
    v_mul_f32 v49, v49, v164
    v_mul_f32 v50, v50, v164
    v_mul_f32 v51, v51, v164
    v_cvt_pk_bf16_f32 v49, v48, v49
    v_lshlrev_b32 v48, 16, v49
    v_and_b32 v49, 0xffff0000, v49
    v_cvt_pk_bf16_f32 v51, v50, v51
    v_lshlrev_b32 v50, 16, v51
    v_and_b32 v51, 0xffff0000, v51
    v_and_b32 v52, 0xffff0000, v163
    v_lshlrev_b32 v53, 16, v163
    v_and_b32 v54, 0xffff0000, v162
    v_lshlrev_b32 v55, 16, v162
    v_mul_f32 v52, v52, v164
    v_mul_f32 v53, v53, v164
    v_mul_f32 v54, v54, v164
    v_mul_f32 v55, v55, v164
    v_cvt_pk_bf16_f32 v53, v52, v53
    v_lshlrev_b32 v52, 16, v53
    v_and_b32 v53, 0xffff0000, v53
    v_cvt_pk_bf16_f32 v55, v54, v55
    v_lshlrev_b32 v54, 16, v55
    v_and_b32 v55, 0xffff0000, v55
    s_setprio 2
    s_waitcnt lgkmcnt(2)
    v_mfma_f32_16x16x32_bf16 v[28:31], v[100:103], v[40:43], v[28:31]
    v_mfma_f32_16x16x32_bf16 v[20:23], v[96:99], v[40:43], v[20:23]
    v_mfma_f32_16x16x32_bf16 v[24:27], v[68:71], v[40:43], v[24:27]
    v_mfma_f32_16x16x32_bf16 v[16:19], v[64:67], v[40:43], v[16:19]
    ds_read_b128 v[36:39], v8 offset:1632
    s_waitcnt lgkmcnt(2)
    v_mfma_f32_16x16x32_bf16 v[28:31], v[108:111], v[44:47], v[28:31]
    v_mfma_f32_16x16x32_bf16 v[20:23], v[104:107], v[44:47], v[20:23]
    v_mfma_f32_16x16x32_bf16 v[24:27], v[76:79], v[44:47], v[24:27]
    v_mfma_f32_16x16x32_bf16 v[16:19], v[72:75], v[44:47], v[16:19]
    ds_read_b128 v[68:71], v8 offset:1760
    s_waitcnt lgkmcnt(2)
    v_mfma_f32_16x16x32_bf16 v[20:23], v[112:115], v[32:35], v[20:23]
    v_mfma_f32_16x16x32_bf16 v[24:27], v[84:87], v[32:35], v[24:27]
    v_mfma_f32_16x16x32_bf16 v[16:19], v[80:83], v[32:35], v[16:19]
    ds_read_b96 v[60:62], v166
    ds_read_b128 v[64:67], v8 offset:1888
    s_waitcnt lgkmcnt(3)
    v_mfma_f32_16x16x32_bf16 v[24:27], v[92:95], v[36:39], v[24:27]
    v_mfma_f32_16x16x32_bf16 v[16:19], v[88:91], v[36:39], v[16:19]
    s_waitcnt lgkmcnt(1)
C_FL3:
    v_min3_u32 v60, v60, v61, v62
    v_cmp_eq_u32 vcc, 0, v60
    s_nop 4
    s_cbranch_vccz C_FD3
    ds_read_b96 v[60:62], v166
    s_sub_u32 s60, s60, 1
    s_cmp_gt_i32 s60, 0
    s_waitcnt lgkmcnt(0)
    s_cbranch_scc1 C_FL3
C_FD3:
    ds_read_b128 v[40:43], v8 offset:2016
    v_mfma_f32_16x16x32_bf16 v[24:27], v[100:103], v[68:71], v[24:27]
    v_mfma_f32_16x16x32_bf16 v[16:19], v[96:99], v[68:71], v[16:19]
    ds_read_b128 v[76:79], v8 offset:2528
    s_waitcnt lgkmcnt(2)
    v_mfma_f32_16x16x32_bf16 v[24:27], v[108:111], v[64:67], v[24:27]
    v_mfma_f32_16x16x32_bf16 v[16:19], v[104:107], v[64:67], v[16:19]
    ds_read_b128 v[72:75], v8 offset:3040
    ds_read_b64_tr_b16 v[44:45], v13 offset:6912
    ds_read_b64_tr_b16 v[46:47], v14 offset:6912
    ds_read_b64_tr_b16 v[84:85], v13 offset:7456
    ds_read_b64_tr_b16 v[86:87], v14 offset:7456
    s_waitcnt lgkmcnt(6)
    v_mfma_f32_16x16x32_bf16 v[16:19], v[112:115], v[40:43], v[16:19]
    ds_read_b64_tr_b16 v[80:81], v13 offset:8000
    ds_read_b64_tr_b16 v[82:83], v14 offset:8000
    s_waitcnt lgkmcnt(7)
    v_mfma_f32_16x16x32_bf16 v[20:23], v[116:119], v[76:79], v[20:23]
    ds_read_b64_tr_b16 v[32:33], v13 offset:8544
    ds_read_b64_tr_b16 v[34:35], v14 offset:8544
    s_waitcnt lgkmcnt(8)
    v_mfma_f32_16x16x32_bf16 v[16:19], v[116:119], v[72:75], v[16:19]
    ds_read_b64_tr_b16 v[92:93], v11 offset:1088
    ds_read_b64_tr_b16 v[94:95], v12 offset:1088
    s_waitcnt lgkmcnt(8)
    v_mfma_f32_16x16x32_bf16 v[20:23], v[44:47], v[124:127], v[20:23]
    v_mfma_f32_16x16x32_bf16 v[16:19], v[44:47], v[120:123], v[16:19]
    ds_read_b64_tr_b16 v[88:89], v11 offset:1360
    ds_read_b64_tr_b16 v[90:91], v12 offset:1360
    s_waitcnt lgkmcnt(8)
    v_mfma_f32_16x16x32_bf16 v[20:23], v[84:87], v[120:123], v[20:23]
    v_mfma_f32_16x16x32_bf16 v[16:19], v[84:87], v[156:159], v[16:19]
    ds_read_b64_tr_b16 v[36:37], v11 offset:1632
    ds_read_b64_tr_b16 v[38:39], v12 offset:1632
    s_waitcnt lgkmcnt(8)
    v_mfma_f32_16x16x32_bf16 v[20:23], v[80:83], v[156:159], v[20:23]
    v_mfma_f32_16x16x32_bf16 v[16:19], v[80:83], v[152:155], v[16:19]
    ds_read_b64_tr_b16 v[100:101], v11 offset:1904
    ds_read_b64_tr_b16 v[102:103], v12 offset:1904
    s_waitcnt lgkmcnt(8)
    v_mfma_f32_16x16x32_bf16 v[20:23], v[32:35], v[152:155], v[20:23]
    ds_read_b64_tr_b16 v[96:97], v11 offset:2176
    ds_read_b64_tr_b16 v[98:99], v12 offset:2176
    s_waitcnt lgkmcnt(8)
    v_mfma_f32_16x16x32_bf16 v[16:19], v[92:95], v[148:151], v[16:19]
    ds_read_b64_tr_b16 v[68:69], v11 offset:2448
    ds_read_b64_tr_b16 v[70:71], v12 offset:2448
    s_waitcnt lgkmcnt(8)
    v_mfma_f32_16x16x32_bf16 v[16:19], v[88:91], v[144:147], v[16:19]
    ds_read_b64_tr_b16 v[108:109], v11 offset:2720
    ds_read_b64_tr_b16 v[110:111], v12 offset:2720
    s_waitcnt lgkmcnt(8)
    v_mfma_f32_16x16x32_bf16 v[20:23], v[36:39], v[148:151], v[20:23]
    v_mfma_f32_16x16x32_bf16 v[16:19], v[36:39], v[140:143], v[16:19]
    ds_read_b64_tr_b16 v[104:105], v11 offset:2992
    ds_read_b64_tr_b16 v[106:107], v12 offset:2992
    s_waitcnt lgkmcnt(8)
    v_mfma_f32_16x16x32_bf16 v[20:23], v[100:103], v[144:147], v[20:23]
    v_mfma_f32_16x16x32_bf16 v[16:19], v[100:103], v[136:139], v[16:19]
    s_waitcnt lgkmcnt(6)
    v_mfma_f32_16x16x32_bf16 v[20:23], v[96:99], v[140:143], v[20:23]
    v_mfma_f32_16x16x32_bf16 v[16:19], v[96:99], v[132:135], v[16:19]
    s_waitcnt lgkmcnt(4)
    v_mfma_f32_16x16x32_bf16 v[20:23], v[68:71], v[136:139], v[20:23]
    v_mfma_f32_16x16x32_bf16 v[16:19], v[68:71], v[128:131], v[16:19]
    ds_read_b32 v60, v166 offset:72
    ds_read_b128 v[56:59], v165 offset:384
    s_waitcnt lgkmcnt(4)
    v_mfma_f32_16x16x32_bf16 v[20:23], v[108:111], v[132:135], v[20:23]
    s_waitcnt lgkmcnt(2)
    v_mfma_f32_16x16x32_bf16 v[20:23], v[104:107], v[128:131], v[20:23]
    s_setprio 0
    s_waitcnt lgkmcnt(0)
C_CL3:
    v_cmp_eq_u32 vcc, 0, v60
    s_nop 4
    s_cbranch_vccz C_CD
    ds_read_b32 v60, v166 offset:72
    ds_read_b128 v[56:59], v165 offset:384
    s_sub_u32 s60, s60, 1
    s_cmp_gt_i32 s60, 0
    s_waitcnt lgkmcnt(0)
    s_cbranch_scc1 C_CL3
C_CD:
    s_mov_b32 exec_lo, 0x30003
    s_mov_b32 exec_hi, 0x30003
    s_nop 4
    v_pk_add_f32 v[16:17], v[16:17], v[56:57]
    v_pk_add_f32 v[18:19], v[18:19], v[58:59]
    s_mov_b64 exec, -1
C_EPI:
    s_nop 3
    s_movk_i32 s54, 0x3f80
    s_mov_b32 s55, 1.0
    v_add_f32_dpp v16, v24, v16 row_shr:2 row_mask:0xf bank_mask:0xf
    v_add_f32_dpp v17, v25, v17 row_shr:2 row_mask:0xf bank_mask:0xf
    v_add_f32_dpp v18, v26, v18 row_shr:2 row_mask:0xf bank_mask:0xf
    v_add_f32_dpp v19, v27, v19 row_shr:2 row_mask:0xf bank_mask:0xf
    v_add_f32_dpp v20, v28, v20 row_shr:2 row_mask:0xf bank_mask:0xf
    v_add_f32_dpp v21, v29, v21 row_shr:2 row_mask:0xf bank_mask:0xf
    v_add_f32_dpp v22, v30, v22 row_shr:2 row_mask:0xf bank_mask:0xf
    v_add_f32_dpp v23, v31, v23 row_shr:2 row_mask:0xf bank_mask:0xf
    v_add_f32_dpp v20, v24, v20 row_shl:14 row_mask:0xf bank_mask:0xf
    v_add_f32_dpp v21, v25, v21 row_shl:14 row_mask:0xf bank_mask:0xf
    v_add_f32_dpp v22, v26, v22 row_shl:14 row_mask:0xf bank_mask:0xf
    v_add_f32_dpp v23, v27, v23 row_shl:14 row_mask:0xf bank_mask:0xf
    v_cvt_pk_bf16_f32 v16, v16, v17
    v_cvt_pk_bf16_f32 v17, v18, v19
    v_cvt_pk_bf16_f32 v18, v20, v21
    v_cvt_pk_bf16_f32 v19, v22, v23
    v_dot2c_f32_bf16 v48, s54, v16
    v_dot2c_f32_bf16 v49, s55, v16
    v_dot2c_f32_bf16 v50, s54, v17
    v_dot2c_f32_bf16 v51, s55, v17
    v_dot2c_f32_bf16 v52, s54, v18
    v_dot2c_f32_bf16 v53, s55, v18
    v_dot2c_f32_bf16 v54, s54, v19
    v_dot2c_f32_bf16 v55, s55, v19
    v_cvt_pk_bf16_f32 v48, v48, v49
    v_cvt_pk_bf16_f32 v49, v50, v51
    ds_write_b64 v15, v[48:49] offset:0
    v_cvt_pk_bf16_f32 v52, v52, v53
    v_cvt_pk_bf16_f32 v53, v54, v55
    ds_write_b64 v15, v[52:53] offset:544
    s_cmp_ge_u32 s38, 8
    s_cbranch_scc1 C_NOGA
    v_lshrrev_b32 v7, 5, v0
    v_lshlrev_b32 v7, 3, v7
    v_lshl_add_u32 v7, v0, 2, v7
    v_lshrrev_b32 v8, 3, v0
    v_mul_u32_u24 v8, 0x6000, v8
    v_and_b32 v9, 7, v0
    v_lshl_add_u32 v8, v9, 4, v8
    s_lshr_b32 s52, s2, 4
    s_lshl_b32 s52, s52, 11
    s_and_b32 s53, s2, 1
    s_lshl_b32 s53, s53, 10
    s_add_u32 s52, s52, s53
    s_bfe_u32 s53, s2, 0x30001
    s_lshl_b32 s53, s53, 7
    s_add_u32 s52, s52, s53
    s_add_u32 s52, s52, 3211264
    s_add_u32 s53, s52, 1572864
    v_mov_b32 v27, v167
    v_mov_b32 v31, v167
C_NOGA:
    s_waitcnt lgkmcnt(0)
    s_barrier
    s_cmp_ge_u32 s38, 8
    s_cbranch_scc1 C_NOST
    ds_read_b32 v24, v7 offset:41472
    ds_read_b32 v25, v7 offset:45824
    ds_read_b32 v26, v7 offset:50176
    ds_read_b32 v28, v7 offset:43648
    ds_read_b32 v29, v7 offset:48000
    ds_read_b32 v30, v7 offset:52352
    s_waitcnt lgkmcnt(3)
    buffer_store_dwordx4 v[24:27], v8, s[40:43], s52 offen sc1
    s_waitcnt lgkmcnt(0)
    buffer_store_dwordx4 v[28:31], v8, s[40:43], s53 offen sc1
C_NOST:
    s_cmp_ge_u32 s2, 184
    s_cbranch_scc1 FFN_LATE
    s_cmp_ge_u32 s2, 128
    s_cbranch_scc1 FINAL
    v_and_b32 v7, 7, v1
    v_lshrrev_b32 v8, 3, v1
    s_mul_i32 s44, s2, 18432
    s_mul_i32 s45, s38, 96
    s_add_u32 s46, s44, s45
    v_mul_u32_u24 v9, 0x900, v7
    v_mad_u32_u24 v9, v8, 12, v9
    v_add_u32 v9, s46, v9
    v_xor_b32 v10, 1, v8
    v_mad_u32_u24 v10, v10, 12, s45
    global_load_dwordx3 v[16:18], v9, s[4:5]
    global_load_dwordx3 v[20:22], v9, s[4:5] offset:1152
    global_load_dwordx3 v[24:26], v10, s[24:25]
    s_mul_i32 s47, s2, 24576
    s_lshl_b32 s48, s38, 11
    s_add_u32 s47, s47, s48
    s_add_u32 s47, s47, 3211264
    v_mul_u32_u24 v84, 0x70, v7
    v_bfe_u32 v10, v1, 3, 1
    v_lshl_add_u32 v84, v10, 2, v84
    s_lshl_b32 s49, s38, 3
    s_add_u32 s49, s49, 103168
    v_add_u32 v84, s49, v84
    v_mul_u32_u24 v85, 0x70, v1
    v_add_u32 v85, 97792, v85
    s_mov_b32 exec_lo, 0xf0000f
    s_mov_b32 exec_hi, 0xf0000f00
    v_subrev_u32 v84, 3584, v84
    s_mov_b32 exec_lo, 0xff000000
    s_mov_b32 exec_hi, 0xff0000
    v_subrev_u32 v84, 1792, v84
    s_mov_b32 exec_lo, 0xff00
    s_mov_b32 exec_hi, 0xff
    v_subrev_u32 v84, 5376, v84
    s_mov_b64 exec, -1
    s_add_u32 s48, s48, 54528
    v_and_b32 v10, 6, v7
    v_xor_b32 v10, v10, v8
    v_lshl_add_u32 v10, v7, 3, v10
    v_lshl_add_u32 v86, v10, 4, s48
    v_and_b32 v10, 6, v8
    v_xor_b32 v10, v10, v1
    v_lshl_add_u32 v87, v10, 4, s48
    v_mul_u32_u24 v88, 2944, v8
    v_add_u32 v88, v88, v3
    s_mul_i32 s48, s2, 24576
    s_lshl_b32 s49, s38, 7
    s_add_u32 s48, s48, s49
    s_add_u32 s48, s48, 6356992
    v_mul_u32_u24 v89, 2336, v7
    v_mad_u32_u24 v89, v8, 12, v89
    s_add_u32 s45, s45, 79104
    v_add_u32 v89, s45, v89
    v_add_u32 v10, 4944, v0
    v_add_u32 v11, 0, v0
    v_mul_u32_u24 v11, 911, v11
    v_lshrrev_b32 v11, 16, v11
    v_add_lshl_u32 v90, v10, v11, 4
    v_add_u32 v10, 5712, v0
    v_add_u32 v11, 768, v0
    v_mul_u32_u24 v11, 911, v11
    v_lshrrev_b32 v11, 16, v11
    v_add_lshl_u32 v91, v10, v11, 4
    v_lshl_add_u32 v92, v0, 4, s44
    v_bfe_u32 v10, v1, 3, 1
    v_lshl_add_u32 v10, v7, 1, v10
    s_lshl_b32 s49, s2, 4
    v_add_u32 v93, s49, v10
    v_sub_u32 v12, 0x7ff, v93
    v_lshlrev_b32 v93, 2, v93
    s_mov_b32 s49, 32768
    v_mov_b32 v51, 0
    v_mov_b32 v55, 0
    v_mov_b32 v76, 0
    v_mov_b32 v56, 0
    v_mov_b32 v57, 0
    v_mov_b32 v58, 0
    v_mov_b32 v59, 0
    v_mov_b32 v60, 0
    v_mov_b32 v61, 0
    v_mov_b32 v62, 0
    v_mov_b32 v63, 0
    s_lshl_b32 s50, s2, 6
    s_lshl_b32 s51, s38, 2
    s_add_u32 s50, s50, s51
    s_add_u32 s50, s50, 8192
    s_mov_b32 s56, 0x00100001
    s_mov_b32 s57, 0x10000100
    s_mov_b32 s58, 0xffff0000
    s_waitcnt vmcnt(0)
    buffer_load_dwordx4 v[28:31], v3, s[40:43], s47 offen sc1
    buffer_load_dwordx4 v[32:35], v3, s[40:43], s47 offen offset:1024 sc1
    v_dot2c_f32_bf16 v76, 0x3f803f80, v24
    v_dot2c_f32_bf16 v76, 0x3f803f80, v25
    v_dot2c_f32_bf16 v76, 0x3f803f80, v26
    v_lshlrev_b32 v36, 16, v16
    v_and_b32 v37, 0xffff0000, v16
    v_lshlrev_b32 v42, 16, v20
    v_and_b32 v43, 0xffff0000, v20
    v_lshlrev_b32 v38, 16, v17
    v_and_b32 v39, 0xffff0000, v17
    v_lshlrev_b32 v44, 16, v21
    v_and_b32 v45, 0xffff0000, v21
    v_lshlrev_b32 v40, 16, v18
    v_and_b32 v41, 0xffff0000, v18
    v_lshlrev_b32 v46, 16, v22
    v_and_b32 v47, 0xffff0000, v22
    v_mov_b32 v77, v76
    s_nop 1
    v_permlane16_swap_b32 v76, v77
    v_add_f32 v76, v76, v77
    v_mov_b32 v77, v76
    s_nop 1
    v_permlane32_swap_b32 v76, v77
    v_add_f32 v76, v76, v77
    s_mov_b32 exec_lo, 0xf00f0
    s_mov_b32 exec_hi, 0xf00f000
    ds_write2_b32 v84, v76, v76 offset0:0 offset1:224
    s_mov_b32 exec_lo, 0xf0f0f0f
    s_mov_b32 exec_hi, 0xf0f0f0f
    v_mov_b32 v24, 0x3f803f80
    v_mov_b32 v25, 0x3f803f80
    v_mov_b32 v26, 0x3f803f80
    s_mov_b32 exec_lo, 0x11111111
    s_mov_b32 exec_hi, 0x11111111
    v_mov_b32 v56, v24
    v_mov_b32 v57, v25
    v_mov_b32 v58, v26
    s_mov_b32 exec_lo, 0x22222222
    s_mov_b32 exec_hi, 0x22222222
    v_mov_b32 v60, v24
    v_mov_b32 v61, v25
    v_mov_b32 v62, v26
    s_mov_b64 exec, -1
    s_movk_i32 s60, 4000
    s_branch L_YP_W
L_YP:
    buffer_load_dwordx4 v[28:31], v3, s[40:43], s47 offen sc1
    buffer_load_dwordx4 v[32:35], v3, s[40:43], s47 offen offset:1024 sc1
L_YP_W:
    s_waitcnt vmcnt(0)
    v_xor_b32 v10, v167, v31
    v_xor_b32 v11, v167, v35
    v_or_b32 v10, v10, v11
    v_cmp_ne_u32 vcc, 0, v10
    s_nop 0
    s_and_b64 exec, exec, vcc
    s_cbranch_execz L_YP_D
    s_sub_u32 s60, s60, 1
    s_cmp_gt_i32 s60, 0
    s_sleep 1
    s_cbranch_scc1 L_YP
L_YP_D:
    s_mov_b64 exec, -1
    v_dot2c_f32_bf16 v36, s54, v28
    v_dot2c_f32_bf16 v37, s54, v29
    v_dot2c_f32_bf16 v38, s54, v30
    v_dot2c_f32_bf16 v39, s54, v34
    v_dot2c_f32_bf16 v40, s54, v32
    v_dot2c_f32_bf16 v41, s54, v33
    v_dot2c_f32_bf16 v42, s55, v28
    v_dot2c_f32_bf16 v43, s55, v29
    v_dot2c_f32_bf16 v44, s55, v30
    v_dot2c_f32_bf16 v45, s55, v34
    v_cvt_pk_bf16_f32 v48, v36, v37
    v_dot2c_f32_bf16 v46, s55, v32
    v_cvt_pk_bf16_f32 v49, v38, v39
    v_dot2c_f32_bf16 v47, s55, v33
    v_cvt_pk_bf16_f32 v50, v40, v41
    v_cvt_pk_bf16_f32 v52, v42, v43
    v_cvt_pk_bf16_f32 v53, v44, v45
    v_mfma_f32_16x16x32_bf16 v[68:71], v[48:51], v[48:51], 0
    v_cvt_pk_bf16_f32 v54, v46, v47
    v_mfma_f32_16x16x32_bf16 v[64:67], v[56:59], v[48:51], 0
    s_nop 0
    v_mfma_f32_16x16x32_bf16 v[64:67], v[60:63], v[52:55], v[64:67]
    v_mfma_f32_16x16x32_bf16 v[72:75], v[52:55], v[52:55], 0
    v_lshlrev_b32 v36, 16, v48
    v_and_b32 v37, 0xffff0000, v48
    v_lshlrev_b32 v38, 16, v49
    v_and_b32 v39, 0xffff0000, v49
    v_lshlrev_b32 v40, 16, v50
    v_and_b32 v41, 0xffff0000, v50
    s_mov_b64 exec, s[56:57]
    v_mov_b32 v64, v68
    v_mov_b32 v65, v72
    s_lshl_b64 exec, exec, 1
    v_mov_b32 v64, v69
    v_mov_b32 v65, v73
    s_lshl_b64 exec, exec, 1
    v_mov_b32 v64, v70
    v_mov_b32 v65, v74
    s_lshl_b64 exec, exec, 1
    v_mov_b32 v64, v71
    v_mov_b32 v65, v75
    s_mov_b32 exec_lo, 0xfff0ff0f
    s_mov_b32 exec_hi, 0xf0ff0fff
    ds_write2_b32 v84, v64, v65 offset0:0 offset1:224
    s_mov_b64 exec, -1
    v_lshlrev_b32 v42, 16, v52
    v_and_b32 v43, 0xffff0000, v52
    v_lshlrev_b32 v44, 16, v53
    v_and_b32 v45, 0xffff0000, v53
    v_lshlrev_b32 v46, 16, v54
    v_and_b32 v47, 0xffff0000, v54
    s_cmp_eq_u32 s38, 0
    s_cbranch_scc0 L_NP
    s_setprio 3
L_NP:
    s_waitcnt lgkmcnt(0)
    s_barrier
    ds_read_b128 v[52:55], v85 offset:0
    ds_read_b128 v[56:59], v85 offset:16
    ds_read_b128 v[60:63], v85 offset:32
    ds_read_b128 v[64:67], v85 offset:48
    ds_read_b128 v[68:71], v85 offset:64
    ds_read_b128 v[72:75], v85 offset:80
    s_waitcnt lgkmcnt(4)
    s_waitcnt lgkmcnt(2)
    v_pk_add_f32 v[52:53], v[52:53], v[60:61]
    v_pk_add_f32 v[54:55], v[54:55], v[62:63]
    v_pk_add_f32 v[56:57], v[56:57], v[64:65]
    v_pk_add_f32 v[58:59], v[58:59], v[66:67]
    s_waitcnt lgkmcnt(0)
    v_pk_add_f32 v[52:53], v[52:53], v[68:69]
    v_pk_add_f32 v[54:55], v[54:55], v[70:71]
    v_pk_add_f32 v[56:57], v[56:57], v[72:73]
    v_pk_add_f32 v[58:59], v[58:59], v[74:75]
    v_pk_add_f32 v[52:53], v[52:53], v[54:55]
    v_pk_add_f32 v[56:57], v[56:57], v[58:59]
    v_pk_add_f32 v[52:53], v[52:53], v[56:57]
    v_add_f32 v76, v52, v53
    v_add_f32 v78, v52, v53
    s_nop 1
    v_permlane16_swap_b32 v76, v78
    v_mov_b32 v77, v76
    v_mov_b32 v13, v78
    s_nop 0
    v_permlane32_swap_b32 v76, v77
    v_permlane32_swap_b32 v78, v13
    v_mul_f32 v76, 0x3ae38e39, v76
    v_mul_f32 v78, 0x3ae38e39, v78
    v_fma_f32 v78, -v76, v76, v78
    v_max_f32 v78, 0, v78
    v_cvt_pk_bf16_f32 v78, v76, v78
    v_and_b32 v82, 0xffff0000, v78
    v_lshlrev_b32 v80, 16, v78
    v_add_f32 v82, 0x3727c5ac, v82
    v_lshlrev_b32 v81, 16, v78
    v_cvt_pk_bf16_f32 v82, v82, v82
    v_lshlrev_b32 v82, 16, v82
    v_sqrt_f32 v82, v82
    v_fma_f32 v77, -v80, v13, v77
    v_cvt_pk_bf16_f32 v82, v82, v82
    v_lshlrev_b32 v82, 16, v82
    v_rcp_f32 v83, v82
    v_rcp_f32 v82, v82
    s_cbranch_scc0 L_NK
    v_mul_f32 v77, v77, v83
    v_cvt_pk_bf16_f32 v77, v77, v77
    v_ashrrev_i32 v76, 31, v77
    v_or_b32 v76, 0x80000000, v76
    v_xor_b32 v76, v76, v77
    v_and_or_b32 v76, v76, s58, v12
    s_mov_b64 exec, 0xffff
    buffer_store_dword v76, v93, s[40:43], s49 offen sc1
    s_mov_b64 exec, -1
    s_setprio 0
L_NK:
    v_mov_b32_dpp v80, v80 row_ror:8 row_mask:0xf bank_mask:0xc
    v_mov_b32_dpp v81, v81 row_ror:8 row_mask:0xf bank_mask:0x3
    v_mov_b32_dpp v82, v82 row_ror:8 row_mask:0xf bank_mask:0xc
    v_mov_b32_dpp v83, v83 row_ror:8 row_mask:0xf bank_mask:0x3
    v_pk_add_f32 v[56:57], v[36:37], v[80:81] op_sel_hi:[1,0] neg_lo:[0,1] neg_hi:[0,1]
    v_pk_add_f32 v[58:59], v[38:39], v[80:81] op_sel_hi:[1,0] neg_lo:[0,1] neg_hi:[0,1]
    v_pk_add_f32 v[60:61], v[40:41], v[80:81] op_sel_hi:[1,0] neg_lo:[0,1] neg_hi:[0,1]
    v_pk_add_f32 v[62:63], v[42:43], v[80:81] op_sel:[0,1] neg_lo:[0,1] neg_hi:[0,1]
    v_pk_add_f32 v[64:65], v[44:45], v[80:81] op_sel:[0,1] neg_lo:[0,1] neg_hi:[0,1]
    v_pk_add_f32 v[66:67], v[46:47], v[80:81] op_sel:[0,1] neg_lo:[0,1] neg_hi:[0,1]
    v_cvt_pk_bf16_f32 v57, v56, v57
    v_cvt_pk_bf16_f32 v59, v58, v59
    v_cvt_pk_bf16_f32 v61, v60, v61
    v_cvt_pk_bf16_f32 v63, v62, v63
    v_cvt_pk_bf16_f32 v65, v64, v65
    v_cvt_pk_bf16_f32 v67, v66, v67
    v_lshlrev_b32 v56, 16, v57
    v_and_b32 v57, 0xffff0000, v57
    v_lshlrev_b32 v58, 16, v59
    v_and_b32 v59, 0xffff0000, v59
    v_lshlrev_b32 v60, 16, v61
    v_and_b32 v61, 0xffff0000, v61
    v_lshlrev_b32 v62, 16, v63
    v_and_b32 v63, 0xffff0000, v63
    v_lshlrev_b32 v64, 16, v65
    v_and_b32 v65, 0xffff0000, v65
    v_lshlrev_b32 v66, 16, v67
    v_and_b32 v67, 0xffff0000, v67
    v_pk_mul_f32 v[56:57], v[56:57], v[82:83] op_sel_hi:[1,0]
    v_pk_mul_f32 v[58:59], v[58:59], v[82:83] op_sel_hi:[1,0]
    v_pk_mul_f32 v[60:61], v[60:61], v[82:83] op_sel_hi:[1,0]
    v_pk_mul_f32 v[62:63], v[62:63], v[82:83] op_sel:[0,1]
    v_pk_mul_f32 v[64:65], v[64:65], v[82:83] op_sel:[0,1]
    v_pk_mul_f32 v[66:67], v[66:67], v[82:83] op_sel:[0,1]
    v_cvt_pk_bf16_f32 v28, v56, v57
    v_cvt_pk_bf16_f32 v29, v58, v59
    v_cvt_pk_bf16_f32 v30, v60, v61
    ds_write_b128 v86, v[28:31]
    v_cvt_pk_bf16_f32 v32, v62, v63
    v_cvt_pk_bf16_f32 v33, v64, v65
    v_cvt_pk_bf16_f32 v34, v66, v67
    ds_write_b128 v86, v[32:35] offset:1024
    ds_read_b128 v[56:59], v87
    ds_read_b128 v[60:63], v87 offset:1024
    v_dot2c_f32_bf16 v36, s54, v28
    v_dot2c_f32_bf16 v37, s55, v28
    v_dot2c_f32_bf16 v38, s54, v29
    v_dot2c_f32_bf16 v39, s55, v29
    v_dot2c_f32_bf16 v40, s54, v30
    v_dot2c_f32_bf16 v41, s55, v30
    v_dot2c_f32_bf16 v42, s54, v32
    v_dot2c_f32_bf16 v43, s55, v32
    v_dot2c_f32_bf16 v44, s54, v33
    v_dot2c_f32_bf16 v45, s55, v33
    v_dot2c_f32_bf16 v46, s54, v34
    v_dot2c_f32_bf16 v47, s55, v34
    s_waitcnt lgkmcnt(1)
    buffer_store_dwordx4 v[56:59], v88, s[40:43], s48 offen sc1
    s_waitcnt lgkmcnt(0)
    buffer_store_dwordx4 v[60:63], v88, s[40:43], s48 offen offset:1536 sc1
    v_cvt_pk_bf16_f32 v48, v36, v37
    v_cvt_pk_bf16_f32 v49, v38, v39
    v_cvt_pk_bf16_f32 v50, v40, v41
    v_cvt_pk_bf16_f32 v51, v42, v43
    v_cvt_pk_bf16_f32 v52, v44, v45
    v_cvt_pk_bf16_f32 v53, v46, v47
    v_add_u32 v10, 1168, v89
    ds_write2_b32 v89, v48, v49 offset0:0 offset1:1
    ds_write_b32 v89, v50 offset:8
    ds_write2_b32 v10, v51, v52 offset0:0 offset1:1
    ds_write_b32 v10, v53 offset:8
    v_add_u32 v11, 12288, v92
    s_waitcnt lgkmcnt(0)
    s_barrier
    ds_read_b128 v[16:19], v90
    ds_read_b128 v[20:23], v91
    v_mov_b32 v10, 0
    s_waitcnt lgkmcnt(1)
    global_store_dwordx4 v92, v[16:19], s[32:33] sc1
    s_cmp_ge_u32 s38, 6
    s_cbranch_scc1 L_O1
    s_waitcnt lgkmcnt(0)
    global_store_dwordx4 v11, v[20:23], s[32:33] sc1
L_O1:
    s_cmp_eq_u32 s38, 11
    s_cbranch_scc1 TOP8
    s_waitcnt vmcnt(0)
    s_mov_b64 exec, 0x1
    buffer_store_dword v167, v10, s[40:43], s50 offen sc1
    s_mov_b64 exec, -1
    s_branch END
FFN_DMA0:
    s_sub_u32 s61, s2, 192
    s_bfe_u32 s50, s38, 0x10003
    s_and_b32 s51, s38, 1
    s_bfe_u32 s52, s38, 0x10001
    s_mul_i32 s52, s52, 36
    s_add_u32 s52, s52, s51
    s_mul_i32 s48, s52, 73728
    s_lshl_b32 s53, s61, 7
    s_add_u32 s48, s48, s53
    s_lshl_b32 s49, s52, 10
    s_mul_i32 s53, s50, 73728
    s_add_u32 s49, s49, s53
    s_lshl_b32 s51, s51, 1
    s_lshl_b32 s53, s50, 2
    s_or_b32 s51, s51, s53
    v_bfe_u32 v2, v1, 4, 1
    v_and_b32 v4, 7, v1
    v_xor_b32 v2, v2, v4
    v_xor_b32 v2, s51, v2
    v_lshrrev_b32 v4, 3, v1
    v_mul_u32_u24 v4, 0x2400, v4
    v_lshl_add_u32 v2, v2, 4, v4
    s_mov_b32 s46, 5308416
    s_mov_b32 s47, 0x00020000
    s_waitcnt lgkmcnt(0)
    s_cmp_eq_u32 s50, 0
    s_cselect_b32 s44, s26, s28
    s_cselect_b32 s45, s27, s29
    s_mov_b32 s40, s36
    s_mov_b32 s41, s37
    s_barrier
    s_add_u32 m0, s49, 0
    s_add_u32 s53, s48, 0
    buffer_load_dwordx4 v2, s[44:47], s53 offen lds
    s_add_u32 m0, s49, 2048
    s_add_u32 s53, s48, 147456
    buffer_load_dwordx4 v2, s[44:47], s53 offen lds
    s_add_u32 m0, s49, 4096
    s_add_u32 s53, s48, 294912
    buffer_load_dwordx4 v2, s[44:47], s53 offen lds
    s_add_u32 m0, s49, 6144
    s_add_u32 s53, s48, 442368
    buffer_load_dwordx4 v2, s[44:47], s53 offen lds
F_B:
    s_barrier
    s_add_u32 m0, s49, 8192
    s_add_u32 s53, s48, 589824
    buffer_load_dwordx4 v2, s[44:47], s53 offen lds
    s_add_u32 m0, s49, 10240
    s_add_u32 s53, s48, 737280
    buffer_load_dwordx4 v2, s[44:47], s53 offen lds
    s_add_u32 m0, s49, 12288
    s_add_u32 s53, s48, 884736
    buffer_load_dwordx4 v2, s[44:47], s53 offen lds
    s_add_u32 m0, s49, 14336
    s_add_u32 s53, s48, 1032192
    buffer_load_dwordx4 v2, s[44:47], s53 offen lds
    s_add_u32 m0, s49, 16384
    s_add_u32 s53, s48, 1179648
    buffer_load_dwordx4 v2, s[44:47], s53 offen lds
    s_add_u32 m0, s49, 18432
    s_add_u32 s53, s48, 1327104
    buffer_load_dwordx4 v2, s[44:47], s53 offen lds
    s_add_u32 m0, s49, 20480
    s_add_u32 s53, s48, 1474560
    buffer_load_dwordx4 v2, s[44:47], s53 offen lds
    s_add_u32 m0, s49, 22528
    s_add_u32 s53, s48, 1622016
    buffer_load_dwordx4 v2, s[44:47], s53 offen lds
    s_add_u32 m0, s49, 24576
    s_add_u32 s53, s48, 1769472
    buffer_load_dwordx4 v2, s[44:47], s53 offen lds
    s_add_u32 m0, s49, 26624
    s_add_u32 s53, s48, 1916928
    buffer_load_dwordx4 v2, s[44:47], s53 offen lds
    s_add_u32 m0, s49, 28672
    s_add_u32 s53, s48, 2064384
    buffer_load_dwordx4 v2, s[44:47], s53 offen lds
    s_add_u32 m0, s49, 30720
    s_add_u32 s53, s48, 2211840
    buffer_load_dwordx4 v2, s[44:47], s53 offen lds
    s_add_u32 m0, s49, 32768
    s_add_u32 s53, s48, 2359296
    buffer_load_dwordx4 v2, s[44:47], s53 offen lds
    s_add_u32 m0, s49, 34816
    s_add_u32 s53, s48, 2506752
    buffer_load_dwordx4 v2, s[44:47], s53 offen lds
    s_cmp_ge_u32 s2, 192
    s_cbranch_scc1 F_W
    s_add_u32 m0, s49, 0
    s_add_u32 s53, s48, 0
    buffer_load_dwordx4 v2, s[44:47], s53 offen lds
    s_add_u32 m0, s49, 2048
    s_add_u32 s53, s48, 147456
    buffer_load_dwordx4 v2, s[44:47], s53 offen lds
    s_add_u32 m0, s49, 4096
    s_add_u32 s53, s48, 294912
    buffer_load_dwordx4 v2, s[44:47], s53 offen lds
    s_add_u32 m0, s49, 6144
    s_add_u32 s53, s48, 442368
    buffer_load_dwordx4 v2, s[44:47], s53 offen lds
    s_branch F_W
FFN_LATE:
    s_sub_u32 s61, s2, 120
    s_cmp_lt_u32 s38, 4
    s_cbranch_scc1 F_B0
    s_bfe_u32 s50, s38, 0x10003
    s_and_b32 s51, s38, 1
    s_bfe_u32 s52, s38, 0x10001
    s_mul_i32 s52, s52, 36
    s_add_u32 s52, s52, s51
    s_mul_i32 s48, s52, 73728
    s_lshl_b32 s53, s61, 7
    s_add_u32 s48, s48, s53
    s_lshl_b32 s49, s52, 10
    s_mul_i32 s53, s50, 73728
    s_add_u32 s49, s49, s53
    s_lshl_b32 s51, s51, 1
    s_lshl_b32 s53, s50, 2
    s_or_b32 s51, s51, s53
    v_bfe_u32 v2, v1, 4, 1
    v_and_b32 v4, 7, v1
    v_xor_b32 v2, v2, v4
    v_xor_b32 v2, s51, v2
    v_lshrrev_b32 v4, 3, v1
    v_mul_u32_u24 v4, 0x2400, v4
    v_lshl_add_u32 v2, v2, 4, v4
    s_mov_b32 s46, 5308416
    s_mov_b32 s47, 0x00020000
    s_cmp_eq_u32 s50, 0
    s_cselect_b32 s44, s26, s28
    s_cselect_b32 s45, s27, s29
    s_branch F_B
FFN_DMA:
    s_sub_u32 s61, s2, 192
F_B0:
    s_barrier
F_W:
    v_mov_b32 v167, 156684
    ds_read_b32 v167, v167
    v_and_b32 v7, 7, v1
    v_lshrrev_b32 v8, 3, v1
    v_and_b32 v5, 15, v1
    v_lshrrev_b32 v6, 4, v1
    s_mul_i32 s52, s61, 73728
    s_mul_i32 s53, s38, 96
    s_add_u32 s52, s52, s53
    v_mul_u32_u24 v9, 0x480, v8
    v_mad_u32_u24 v9, v7, 12, v9
    v_add_u32 v9, s52, v9
    global_load_dwordx3 v[16:18], v9, s[30:31]
    v_add_u32 v9, 0x2400, v9
    global_load_dwordx3 v[20:22], v9, s[30:31]
    v_add_u32 v9, 0x2400, v9
    global_load_dwordx3 v[24:26], v9, s[30:31]
    v_add_u32 v9, 0x2400, v9
    global_load_dwordx3 v[28:30], v9, s[30:31]
    v_add_u32 v9, 0x2400, v9
    global_load_dwordx3 v[32:34], v9, s[30:31]
    v_add_u32 v9, 0x2400, v9
    global_load_dwordx3 v[36:38], v9, s[30:31]
    v_add_u32 v9, 0x2400, v9
    global_load_dwordx3 v[40:42], v9, s[30:31]
    v_add_u32 v9, 0x2400, v9
    global_load_dwordx3 v[44:46], v9, s[30:31]
    v_mul_u32_u24 v10, 683, v0
    v_lshrrev_b32 v10, 16, v10
    v_mul_u32_u24 v11, 0x60, v10
    v_sub_u32 v11, v0, v11
    s_mov_b32 s52, 161920
    v_lshl_add_u32 v160, v10, 2, s52
    s_mov_b32 s52, 3144192
    v_lshl_add_u32 v161, v11, 4, s52
    v_mul_u32_u24 v162, 1184, v10
    v_mad_u32_u24 v162, v11, 12, v162
    v_add_u32 v162, 147456, v162
    v_mul_u32_u24 v163, 1184, v7
    v_lshl_add_u32 v163, v6, 4, v163
    v_add_u32 v163, 147456, v163
    s_lshr_b32 s52, s38, 2
    s_lshl_b32 s52, s52, 10
    s_and_b32 s53, s38, 3
    s_lshl_b32 s53, s53, 2
    s_add_u32 s52, s52, s53
    s_add_u32 s52, s52, 156928
    v_add_u32 v164, s52, v3
    v_and_b32 v10, 1, v6
    v_mul_u32_u24 v10, 0x48, v10
    v_and_b32 v11, 1, v8
    v_add3_u32 v166, v10, v11, 2
    v_lshl_add_u32 v10, v11, 2, v10
    v_lshrrev_b32 v11, 1, v6
    v_add_u32 v165, v10, v11
    v_mul_u32_u24 v165, 0x2400, v165
    v_mul_u32_u24 v166, 0x2400, v166
    v_lshl_add_u32 v165, v7, 4, v165
    v_lshl_add_u32 v166, v7, 4, v166
    s_mul_i32 s62, s38, 55296
    s_lshl_b32 s53, s61, 7
    s_add_u32 s62, s62, s53
    s_add_u32 s62, s62, 9502720
    s_mov_b32 s63, 6356992
    s_movk_i32 s64, -1536
    v_and_b32 v10, 1, v1
    v_bfe_u32 v11, v1, 3, 2
    v_lshl_add_u32 v11, v10, 2, v11
    v_xor_b32 v11, s38, v11
    v_mul_u32_u24 v12, 73728, v10
    v_lshl_add_u32 v12, v11, 4, v12
    v_and_b32 v10, 2, v1
    v_lshl_add_u32 v12, v10, 2, v12
    v_bfe_u32 v10, v1, 2, 2
    v_lshl_add_u32 v10, v6, 3, v10
    v_lshl_add_u32 v12, v10, 7, v12
    v_add_u32 v13, 36864, v12
    v_mov_b32 v14, 161308
    v_mov_b32 v15, 1
    s_mov_b32 s52, 0x05040100
    s_mov_b32 s53, 0x07060302
    v_mov_b32 v10, s52
    s_mov_b32 exec_lo, 0xff00ff00
    s_mov_b32 exec_hi, 0xff00ff00
    v_mov_b32 v10, 0x03020706
    s_mov_b64 exec, -1
    s_waitcnt lgkmcnt(0)
    v_readfirstlane_b32 s39, v167
    s_cmp_lt_u32 s38, 4
    s_cbranch_scc1 F_NC
    s_waitcnt vmcnt(8)
    s_mov_b64 exec, 0x1
    ds_add_u32 v14, v15
    s_mov_b64 exec, -1
F_NC:
    s_waitcnt vmcnt(7)
    v_mov_b32 v19, v16
    v_mov_b32_dpp v11, v17 row_ror:8 row_mask:0xf bank_mask:0xf
    v_mov_b32_dpp v16, v18 row_ror:8 row_mask:0xf bank_mask:0xc
    v_mov_b32_dpp v18, v19 row_ror:8 row_mask:0xf bank_mask:0x3
    v_perm_b32 v152, v11, v17, v10
    v_perm_b32 v136, v18, v16, s52
    v_perm_b32 v144, v18, v16, s53
    s_waitcnt vmcnt(6)
    v_mov_b32 v23, v20
    v_mov_b32_dpp v11, v21 row_ror:8 row_mask:0xf bank_mask:0xf
    v_mov_b32_dpp v20, v22 row_ror:8 row_mask:0xf bank_mask:0xc
    v_mov_b32_dpp v22, v23 row_ror:8 row_mask:0xf bank_mask:0x3
    v_perm_b32 v153, v11, v21, v10
    v_perm_b32 v137, v22, v20, s52
    v_perm_b32 v145, v22, v20, s53
    s_waitcnt vmcnt(5)
    v_mov_b32 v27, v24
    v_mov_b32_dpp v11, v25 row_ror:8 row_mask:0xf bank_mask:0xf
    v_mov_b32_dpp v24, v26 row_ror:8 row_mask:0xf bank_mask:0xc
    v_mov_b32_dpp v26, v27 row_ror:8 row_mask:0xf bank_mask:0x3
    v_perm_b32 v154, v11, v25, v10
    v_perm_b32 v138, v26, v24, s52
    v_perm_b32 v146, v26, v24, s53
    s_waitcnt vmcnt(4)
    v_mov_b32 v31, v28
    v_mov_b32_dpp v11, v29 row_ror:8 row_mask:0xf bank_mask:0xf
    v_mov_b32_dpp v28, v30 row_ror:8 row_mask:0xf bank_mask:0xc
    v_mov_b32_dpp v30, v31 row_ror:8 row_mask:0xf bank_mask:0x3
    v_perm_b32 v155, v11, v29, v10
    v_perm_b32 v139, v30, v28, s52
    v_perm_b32 v147, v30, v28, s53
    s_waitcnt vmcnt(3)
    v_mov_b32 v35, v32
    v_mov_b32_dpp v11, v33 row_ror:8 row_mask:0xf bank_mask:0xf
    v_mov_b32_dpp v32, v34 row_ror:8 row_mask:0xf bank_mask:0xc
    v_mov_b32_dpp v34, v35 row_ror:8 row_mask:0xf bank_mask:0x3
    v_perm_b32 v156, v11, v33, v10
    v_perm_b32 v140, v34, v32, s52
    v_perm_b32 v148, v34, v32, s53
    s_waitcnt vmcnt(2)
    v_mov_b32 v39, v36
    v_mov_b32_dpp v11, v37 row_ror:8 row_mask:0xf bank_mask:0xf
    v_mov_b32_dpp v36, v38 row_ror:8 row_mask:0xf bank_mask:0xc
    v_mov_b32_dpp v38, v39 row_ror:8 row_mask:0xf bank_mask:0x3
    v_perm_b32 v157, v11, v37, v10
    v_perm_b32 v141, v38, v36, s52
    v_perm_b32 v149, v38, v36, s53
    s_waitcnt vmcnt(1)
    v_mov_b32 v43, v40
    v_mov_b32_dpp v11, v41 row_ror:8 row_mask:0xf bank_mask:0xf
    v_mov_b32_dpp v40, v42 row_ror:8 row_mask:0xf bank_mask:0xc
    v_mov_b32_dpp v42, v43 row_ror:8 row_mask:0xf bank_mask:0x3
    v_perm_b32 v158, v11, v41, v10
    v_perm_b32 v142, v42, v40, s52
    v_perm_b32 v150, v42, v40, s53
    s_waitcnt vmcnt(0)
    v_mov_b32 v47, v44
    v_mov_b32_dpp v11, v45 row_ror:8 row_mask:0xf bank_mask:0xf
    v_mov_b32_dpp v44, v46 row_ror:8 row_mask:0xf bank_mask:0xc
    v_mov_b32_dpp v46, v47 row_ror:8 row_mask:0xf bank_mask:0x3
    v_perm_b32 v159, v11, v45, v10
    v_perm_b32 v143, v46, v44, s52
    v_perm_b32 v151, v46, v44, s53
    s_cmp_ge_u32 s38, 8
    s_cbranch_scc1 F_NT
    s_movk_i32 s60, 4000
F_CP:
    ds_read_b32 v15, v14
    s_sub_u32 s60, s60, 1
    s_cmp_gt_i32 s60, 0
    s_waitcnt lgkmcnt(0)
    v_readfirstlane_b32 s52, v15
    s_nop 0
    s_cselect_b32 s52, s52, 8
    s_cmp_eq_u32 s52, 8
    s_cbranch_scc1 F_CD
    s_sleep 2
    s_branch F_CP
F_CD:
    ds_read_b64_tr_b16 v[64:65], v12 offset:0
    ds_read_b64_tr_b16 v[66:67], v12 offset:512
    ds_read_b64_tr_b16 v[68:69], v12 offset:4096
    ds_read_b64_tr_b16 v[70:71], v12 offset:4608
    ds_read_b64_tr_b16 v[72:73], v12 offset:8192
    ds_read_b64_tr_b16 v[74:75], v12 offset:8704
    ds_read_b64_tr_b16 v[76:77], v12 offset:12288
    ds_read_b64_tr_b16 v[78:79], v12 offset:12800
    ds_read_b64_tr_b16 v[80:81], v12 offset:16384
    ds_read_b64_tr_b16 v[82:83], v12 offset:16896
    ds_read_b64_tr_b16 v[84:85], v12 offset:20480
    ds_read_b64_tr_b16 v[86:87], v12 offset:20992
    ds_read_b64_tr_b16 v[88:89], v12 offset:24576
    ds_read_b64_tr_b16 v[90:91], v12 offset:25088
    ds_read_b64_tr_b16 v[92:93], v12 offset:28672
    ds_read_b64_tr_b16 v[94:95], v12 offset:29184
    ds_read_b64_tr_b16 v[96:97], v12 offset:32768
    ds_read_b64_tr_b16 v[98:99], v12 offset:33280
    ds_read_b64_tr_b16 v[100:101], v13 offset:0
    ds_read_b64_tr_b16 v[102:103], v13 offset:512
    ds_read_b64_tr_b16 v[104:105], v13 offset:4096
    ds_read_b64_tr_b16 v[106:107], v13 offset:4608
    ds_read_b64_tr_b16 v[108:109], v13 offset:8192
    ds_read_b64_tr_b16 v[110:111], v13 offset:8704
    ds_read_b64_tr_b16 v[112:113], v13 offset:12288
    ds_read_b64_tr_b16 v[114:115], v13 offset:12800
    ds_read_b64_tr_b16 v[116:117], v13 offset:16384
    ds_read_b64_tr_b16 v[118:119], v13 offset:16896
    ds_read_b64_tr_b16 v[120:121], v13 offset:20480
    ds_read_b64_tr_b16 v[122:123], v13 offset:20992
    ds_read_b64_tr_b16 v[124:125], v13 offset:24576
    ds_read_b64_tr_b16 v[126:127], v13 offset:25088
    ds_read_b64_tr_b16 v[128:129], v13 offset:28672
    ds_read_b64_tr_b16 v[130:131], v13 offset:29184
    ds_read_b64_tr_b16 v[132:133], v13 offset:32768
    ds_read_b64_tr_b16 v[134:135], v13 offset:33280
F_NT:
    s_cmp_lg_u32 s38, 11
    s_cbranch_scc1 F_SEL
    s_branch T_EV
FINAL:
    s_cmp_ge_u32 s2, 144
    s_cbranch_scc1 END
    s_cmp_lg_u32 s38, 11
    s_cbranch_scc1 END
T_EV:
TOP8:
    v_bfe_i32 v7, v1, 0, 1
    v_bfe_i32 v8, v1, 1, 1
    v_bfe_i32 v9, v1, 3, 1
    v_bfe_i32 v11, v1, 4, 1
    v_bfe_i32 v13, v1, 5, 1
    v_xor_b32 v48, v7, v8
    v_xor_b32 v49, v8, v9
    v_xor_b32 v50, v7, v9
    v_xor_b32 v11, v11, v13
    v_xor_b32 v51, v9, v11
    v_xor_b32 v52, v8, v11
    v_xor_b32 v53, v7, v11
    v_sub_u32 v54, 148464, v3
    v_and_b32 v7, 4, v1
    v_and_b32 v8, 48, v1
    v_lshlrev_b32 v8, 6, v8
    v_lshl_add_u32 v55, v7, 1, v8
    v_add_u32 v55, 147456, v55
    s_mov_b32 s65, 32768
    s_mov_b32 s66, 36864
    s_and_b32 s67, s2, 127
    s_lshl_b32 s68, s67, 6
    s_add_u32 s68, s68, 32768
    v_mov_b32 v10, 0
    s_cmp_lt_u32 s2, 128
    s_cbranch_scc0 T_E2
    s_waitcnt vmcnt(0)
    s_mov_b64 exec, 0x1
    buffer_store_dword v167, v10, s[40:43], s50 offen sc1
    s_branch T_H
T_E2:
    s_mul_i32 s67, s67, 24576
    s_add_u32 s67, s67, 3230092
    s_mov_b64 exec, 0x1
    s_movk_i32 s60, 4000
T_EP:
    buffer_load_dword v11, v10, s[40:43], s67 offen sc1
T_EP_W:
    s_waitcnt vmcnt(0)
    v_cmp_ne_u32 vcc, s39, v11
    s_nop 0
    s_and_b64 exec, exec, vcc
    s_cbranch_execz T_EP_D
    s_sub_u32 s60, s60, 1
    s_cmp_gt_i32 s60, 0
    s_sleep 2
    s_cbranch_scc1 T_EP
T_EP_D:
T_H:
    s_mov_b64 exec, 0x1
    s_movk_i32 s60, 4000
T_HP:
    buffer_load_dword v11, v10, s[40:43], s68 offen sc1
T_HP_W:
    s_waitcnt vmcnt(0)
    v_cmp_eq_u32 vcc, -1, v11
    s_nop 0
    s_and_b64 exec, exec, vcc
    s_cbranch_execz T_HP_D
    s_sub_u32 s60, s60, 1
    s_cmp_gt_i32 s60, 0
    s_sleep 1
    s_cbranch_scc1 T_HP
T_HP_D:
    s_mov_b64 exec, -1
    s_movk_i32 s60, 4000
T_KP:
    buffer_load_dwordx4 v[16:19], v3, s[40:43], s65 offen offset:0 sc1
    buffer_load_dwordx4 v[20:23], v3, s[40:43], s65 offen offset:1024 sc1
    buffer_load_dwordx4 v[24:27], v3, s[40:43], s65 offen offset:2048 sc1
    buffer_load_dwordx4 v[28:31], v3, s[40:43], s65 offen offset:3072 sc1
    buffer_load_dwordx4 v[32:35], v3, s[40:43], s66 offen offset:0 sc1
    buffer_load_dwordx4 v[36:39], v3, s[40:43], s66 offen offset:1024 sc1
    buffer_load_dwordx4 v[40:43], v3, s[40:43], s66 offen offset:2048 sc1
    buffer_load_dwordx4 v[44:47], v3, s[40:43], s66 offen offset:3072 sc1
T_KP_W:
    s_waitcnt vmcnt(0)
    v_max3_u32 v56, v16, v17, v18
    v_max3_u32 v58, v19, v20, v21
    v_max3_u32 v57, v32, v33, v34
    v_max3_u32 v59, v35, v36, v37
    v_max3_u32 v56, v56, v22, v23
    v_max3_u32 v58, v58, v24, v25
    v_max3_u32 v57, v57, v38, v39
    v_max3_u32 v59, v59, v40, v41
    v_max3_u32 v56, v56, v26, v27
    v_max3_u32 v58, v58, v28, v29
    v_max3_u32 v57, v57, v42, v43
    v_max3_u32 v59, v59, v44, v45
    v_max3_u32 v58, v58, v30, v31
    v_max3_u32 v59, v59, v46, v47
    v_max_u32 v56, v56, v58
    v_max_u32 v57, v57, v59
    v_max_u32 v58, v56, v57
    v_cmp_eq_u32 vcc, -1, v58
    s_nop 0
    s_and_b64 exec, exec, vcc
    s_cbranch_execz T_KP_D
    s_sub_u32 s60, s60, 1
    s_cmp_gt_i32 s60, 0
    s_cbranch_scc1 T_KP
T_KP_D:
    s_mov_b64 exec, -1
    v_mov_b32_dpp v58, v56 quad_perm:[1,0,3,2] row_mask:0xf bank_mask:0xf
    v_mov_b32_dpp v59, v57 quad_perm:[1,0,3,2] row_mask:0xf bank_mask:0xf
    v_med3_u32 v56, v56, v58, v48
    v_med3_u32 v57, v57, v59, v48
    ds_write_b128 v54, v[16:19] offset:7168
    v_mov_b32_dpp v58, v56 quad_perm:[2,3,0,1] row_mask:0xf bank_mask:0xf
    v_mov_b32_dpp v59, v57 quad_perm:[2,3,0,1] row_mask:0xf bank_mask:0xf
    v_med3_u32 v56, v56, v58, v49
    v_med3_u32 v57, v57, v59, v49
    ds_write_b128 v54, v[20:23] offset:6144
    v_mov_b32_dpp v58, v56 quad_perm:[1,0,3,2] row_mask:0xf bank_mask:0xf
    v_mov_b32_dpp v59, v57 quad_perm:[1,0,3,2] row_mask:0xf bank_mask:0xf
    v_med3_u32 v56, v56, v58, v50
    v_med3_u32 v57, v57, v59, v50
    ds_write_b128 v54, v[24:27] offset:5120
    v_mov_b32_dpp v58, v56 row_ror:8 row_mask:0xf bank_mask:0xf
    v_mov_b32_dpp v59, v57 row_ror:8 row_mask:0xf bank_mask:0xf
    v_med3_u32 v56, v56, v58, v51
    v_med3_u32 v57, v57, v59, v51
    ds_write_b128 v54, v[28:31] offset:4096
    v_mov_b32_dpp v58, v56 quad_perm:[2,3,0,1] row_mask:0xf bank_mask:0xf
    v_mov_b32_dpp v59, v57 quad_perm:[2,3,0,1] row_mask:0xf bank_mask:0xf
    v_med3_u32 v56, v56, v58, v52
    v_med3_u32 v57, v57, v59, v52
    ds_write_b128 v54, v[32:35] offset:3072
    v_mov_b32_dpp v58, v56 quad_perm:[1,0,3,2] row_mask:0xf bank_mask:0xf
    v_mov_b32_dpp v59, v57 quad_perm:[1,0,3,2] row_mask:0xf bank_mask:0xf
    v_med3_u32 v56, v56, v58, v53
    v_med3_u32 v57, v57, v59, v53
    ds_write_b128 v54, v[36:39] offset:2048
    s_nop 0
    v_max_u32_dpp v56, v57, v56 row_mirror row_mask:0xf bank_mask:0xf
    ds_write_b128 v54, v[40:43] offset:1024
    s_nop 0
    v_mov_b32_dpp v58, v56 row_ror:8 row_mask:0xf bank_mask:0xf
    v_med3_u32 v56, v56, v58, v51
    ds_write_b128 v54, v[44:47] offset:0
    s_nop 0
    v_mov_b32_dpp v58, v56 quad_perm:[2,3,0,1] row_mask:0xf bank_mask:0xf
    v_med3_u32 v56, v56, v58, v52
    s_nop 1
    v_mov_b32_dpp v58, v56 quad_perm:[1,0,3,2] row_mask:0xf bank_mask:0xf
    v_med3_u32 v56, v56, v58, v53
    s_nop 1
    v_max_u32_dpp v56, v56, v56 row_mirror row_mask:0xf bank_mask:0xf
    s_nop 1
    v_mov_b32_dpp v58, v56 row_ror:8 row_mask:0xf bank_mask:0xf
    v_med3_u32 v56, v56, v58, v51
    s_nop 1
    v_mov_b32_dpp v58, v56 quad_perm:[2,3,0,1] row_mask:0xf bank_mask:0xf
    v_med3_u32 v56, v56, v58, v52
    s_nop 1
    v_mov_b32_dpp v58, v56 quad_perm:[1,0,3,2] row_mask:0xf bank_mask:0xf
    v_med3_u32 v57, v56, v58, v53
    v_med3_u32 v56, v56, v58, v53
    s_nop 1
    v_permlane16_swap_b32 v56, v57
    v_max_u32 v56, v56, v57
    s_nop 1
    v_mov_b32_dpp v58, v56 row_ror:8 row_mask:0xf bank_mask:0xf
    v_med3_u32 v56, v56, v58, v51
    s_nop 1
    v_mov_b32_dpp v58, v56 quad_perm:[2,3,0,1] row_mask:0xf bank_mask:0xf
    v_med3_u32 v56, v56, v58, v52
    s_nop 1
    v_mov_b32_dpp v58, v56 quad_perm:[1,0,3,2] row_mask:0xf bank_mask:0xf
    v_med3_u32 v57, v56, v58, v53
    v_med3_u32 v56, v56, v58, v53
    s_nop 1
    v_permlane32_swap_b32 v56, v57
    v_max_u32 v56, v56, v57
    v_and_b32 v56, 0x4fc, v56
    v_lshl_or_b32 v56, v56, 2, v55
    ds_read_b64 v[56:57], v56
    v_and_b32 v7, 3, v1
    v_and_b32 v8, 8, v1
    v_lshlrev_b32 v7, 2, v7
    v_lshl_add_u32 v7, v8, 1, v7
    v_add_u32 v7, 161920, v7
    s_waitcnt lgkmcnt(0)
    v_mov_b32_dpp v58, v56 quad_perm:[1,0,3,2] row_mask:0xf bank_mask:0xf
    v_mov_b32_dpp v59, v57 quad_perm:[1,0,3,2] row_mask:0xf bank_mask:0xf
    v_med3_u32 v56, v56, v58, v48
    v_med3_u32 v57, v57, v59, v48
    s_nop 0
    v_mov_b32_dpp v58, v56 quad_perm:[2,3,0,1] row_mask:0xf bank_mask:0xf
    v_mov_b32_dpp v59, v57 quad_perm:[2,3,0,1] row_mask:0xf bank_mask:0xf
    v_med3_u32 v56, v56, v58, v49
    v_med3_u32 v57, v57, v59, v49
    s_nop 0
    v_mov_b32_dpp v58, v56 quad_perm:[1,0,3,2] row_mask:0xf bank_mask:0xf
    v_mov_b32_dpp v59, v57 quad_perm:[1,0,3,2] row_mask:0xf bank_mask:0xf
    v_med3_u32 v56, v56, v58, v50
    v_med3_u32 v57, v57, v59, v50
    s_nop 0
    v_mov_b32_dpp v58, v56 row_ror:8 row_mask:0xf bank_mask:0xf
    v_mov_b32_dpp v59, v57 row_ror:8 row_mask:0xf bank_mask:0xf
    v_med3_u32 v56, v56, v58, v51
    v_med3_u32 v57, v57, v59, v51
    s_nop 0
    v_mov_b32_dpp v58, v56 quad_perm:[2,3,0,1] row_mask:0xf bank_mask:0xf
    v_mov_b32_dpp v59, v57 quad_perm:[2,3,0,1] row_mask:0xf bank_mask:0xf
    v_med3_u32 v56, v56, v58, v52
    v_med3_u32 v57, v57, v59, v52
    s_nop 0
    v_mov_b32_dpp v58, v56 quad_perm:[1,0,3,2] row_mask:0xf bank_mask:0xf
    v_mov_b32_dpp v59, v57 quad_perm:[1,0,3,2] row_mask:0xf bank_mask:0xf
    v_med3_u32 v56, v56, v58, v53
    v_med3_u32 v57, v57, v59, v53
    s_nop 1
    v_max_u32_dpp v56, v57, v56 row_mirror row_mask:0xf bank_mask:0xf
    s_nop 1
    v_mov_b32_dpp v58, v56 row_ror:8 row_mask:0xf bank_mask:0xf
    v_med3_u32 v56, v56, v58, v51
    s_nop 1
    v_mov_b32_dpp v58, v56 quad_perm:[2,3,0,1] row_mask:0xf bank_mask:0xf
    v_med3_u32 v56, v56, v58, v52
    s_nop 1
    v_mov_b32_dpp v58, v56 quad_perm:[1,0,3,2] row_mask:0xf bank_mask:0xf
    v_med3_u32 v56, v56, v58, v53
    s_nop 1
    v_max_u32_dpp v56, v56, v56 row_mirror row_mask:0xf bank_mask:0xf
    s_nop 1
    v_mov_b32_dpp v58, v56 row_ror:8 row_mask:0xf bank_mask:0xf
    v_med3_u32 v56, v56, v58, v51
    s_nop 1
    v_mov_b32_dpp v58, v56 quad_perm:[2,3,0,1] row_mask:0xf bank_mask:0xf
    v_med3_u32 v56, v56, v58, v52
    s_nop 1
    v_mov_b32_dpp v58, v56 quad_perm:[1,0,3,2] row_mask:0xf bank_mask:0xf
    v_med3_u32 v57, v56, v58, v53
    v_med3_u32 v56, v56, v58, v53
    s_nop 1
    v_permlane16_swap_b32 v56, v57
    v_max_u32 v56, v56, v57
    s_nop 1
    v_mov_b32_dpp v58, v56 row_ror:8 row_mask:0xf bank_mask:0xf
    v_med3_u32 v56, v56, v58, v51
    s_nop 1
    v_mov_b32_dpp v58, v56 quad_perm:[2,3,0,1] row_mask:0xf bank_mask:0xf
    v_med3_u32 v56, v56, v58, v52
    s_nop 1
    v_mov_b32_dpp v58, v56 quad_perm:[1,0,3,2] row_mask:0xf bank_mask:0xf
    v_med3_u32 v57, v56, v58, v53
    v_med3_u32 v56, v56, v58, v53
    s_nop 1
    v_permlane32_swap_b32 v56, v57
    v_max_u32 v56, v56, v57
    s_cmp_lt_u32 s2, 144
    s_cbranch_scc1 FIN
    s_mov_b64 exec, 0xf0f
    ds_write_b32 v7, v56
    s_mov_b64 exec, -1
F_SEL:
    s_waitcnt lgkmcnt(0)
    s_barrier
    ds_read_b32 v7, v160
    s_waitcnt lgkmcnt(0)
    v_and_b32 v7, 0x7ff, v7
    v_mad_i32_i24 v7, v7, s64, v161
    s_movk_i32 s60, 4000
F_ZP:
    buffer_load_dwordx4 v[8:11], v7, s[40:43], s63 offen sc1
F_ZP_W:
    s_waitcnt vmcnt(0)
    v_cmp_ne_u32 vcc, s39, v11
    s_nop 0
    s_and_b64 exec, exec, vcc
    s_cbranch_execz F_ZP_D
    s_sub_u32 s60, s60, 1
    s_cmp_gt_i32 s60, 0
    s_cbranch_scc1 F_ZP
F_ZP_D:
    s_mov_b64 exec, -1
    ds_write2_b32 v162, v8, v9 offset0:0 offset1:1
    ds_write_b32 v162, v10 offset:8
    v_add_u32 v7, 156928, v3
    s_waitcnt lgkmcnt(0)
    s_barrier
    s_cmp_ge_u32 s38, 8
    s_cbranch_scc1 F_H
    ds_read_b128 v[16:19], v163 offset:0
    ds_read_b128 v[20:23], v163 offset:64
    ds_read_b128 v[24:27], v163 offset:128
    ds_read_b128 v[28:31], v163 offset:192
    ds_read_b128 v[32:35], v163 offset:256
    ds_read_b128 v[36:39], v163 offset:320
    ds_read_b128 v[40:43], v163 offset:384
    ds_read_b128 v[44:47], v163 offset:448
    ds_read_b128 v[48:51], v163 offset:512
    ds_read_b128 v[52:55], v163 offset:576
    ds_read_b128 v[56:59], v163 offset:640
    ds_read_b128 v[60:63], v163 offset:704
    s_waitcnt lgkmcnt(11)
    v_mfma_f32_16x16x32_bf16 v[8:11], v[64:67], v[16:19], 0
    s_waitcnt lgkmcnt(10)
    v_mfma_f32_16x16x32_bf16 v[8:11], v[68:71], v[20:23], v[8:11]
    ds_read_b128 v[16:19], v163 offset:768
    s_waitcnt lgkmcnt(10)
    v_mfma_f32_16x16x32_bf16 v[8:11], v[72:75], v[24:27], v[8:11]
    ds_read_b128 v[20:23], v163 offset:832
    s_waitcnt lgkmcnt(10)
    v_mfma_f32_16x16x32_bf16 v[8:11], v[76:79], v[28:31], v[8:11]
    ds_read_b128 v[24:27], v163 offset:896
    s_waitcnt lgkmcnt(10)
    v_mfma_f32_16x16x32_bf16 v[8:11], v[80:83], v[32:35], v[8:11]
    ds_read_b128 v[28:31], v163 offset:960
    s_waitcnt lgkmcnt(10)
    v_mfma_f32_16x16x32_bf16 v[8:11], v[84:87], v[36:39], v[8:11]
    ds_read_b128 v[32:35], v163 offset:1024
    s_waitcnt lgkmcnt(10)
    v_mfma_f32_16x16x32_bf16 v[8:11], v[88:91], v[40:43], v[8:11]
    ds_read_b128 v[36:39], v163 offset:1088
    s_waitcnt lgkmcnt(10)
    v_mfma_f32_16x16x32_bf16 v[8:11], v[92:95], v[44:47], v[8:11]
    s_waitcnt lgkmcnt(9)
    v_mfma_f32_16x16x32_bf16 v[8:11], v[96:99], v[48:51], v[8:11]
    s_waitcnt lgkmcnt(8)
    v_mfma_f32_16x16x32_bf16 v[8:11], v[100:103], v[52:55], v[8:11]
    s_waitcnt lgkmcnt(7)
    v_mfma_f32_16x16x32_bf16 v[8:11], v[104:107], v[56:59], v[8:11]
    s_waitcnt lgkmcnt(6)
    v_mfma_f32_16x16x32_bf16 v[8:11], v[108:111], v[60:63], v[8:11]
    s_waitcnt lgkmcnt(5)
    v_mfma_f32_16x16x32_bf16 v[8:11], v[112:115], v[16:19], v[8:11]
    s_waitcnt lgkmcnt(4)
    v_mfma_f32_16x16x32_bf16 v[8:11], v[116:119], v[20:23], v[8:11]
    s_waitcnt lgkmcnt(3)
    v_mfma_f32_16x16x32_bf16 v[8:11], v[120:123], v[24:27], v[8:11]
    s_waitcnt lgkmcnt(2)
    v_mfma_f32_16x16x32_bf16 v[8:11], v[124:127], v[28:31], v[8:11]
    s_waitcnt lgkmcnt(1)
    v_mfma_f32_16x16x32_bf16 v[8:11], v[128:131], v[32:35], v[8:11]
    s_waitcnt lgkmcnt(0)
    v_mfma_f32_16x16x32_bf16 v[8:11], v[132:135], v[36:39], v[8:11]
    s_nop 7
    v_permlane16_swap_b32 v8, v10
    v_permlane16_swap_b32 v9, v11
    v_cvt_pk_bf16_f32 v9, v8, v9
    v_cvt_pk_bf16_f32 v11, v10, v11
    v_lshlrev_b32 v8, 16, v9
    v_and_b32 v9, 0xffff0000, v9
    v_mul_f32 v12, 0xbfb8aa3b, v8
    v_mul_f32 v13, 0xbfb8aa3b, v9
    v_exp_f32 v12, v12
    v_exp_f32 v13, v13
    v_lshlrev_b32 v10, 16, v11
    v_and_b32 v11, 0xffff0000, v11
    v_add_f32 v12, 1.0, v12
    v_add_f32 v13, 1.0, v13
    v_rcp_f32 v12, v12
    v_rcp_f32 v13, v13
    v_mul_f32 v8, v8, v12
    v_mul_f32 v9, v9, v13
    v_cvt_pk_bf16_f32 v9, v8, v9
    v_lshlrev_b32 v8, 16, v9
    v_and_b32 v9, 0xffff0000, v9
    v_mul_f32 v8, v8, v10
    v_mul_f32 v9, v9, v11
    v_cvt_pk_bf16_f32 v8, v8, v9
    ds_write_b32 v164, v8
F_H:
    v_mov_b32 v16, 0
    v_mov_b32 v17, 0
    v_mov_b32 v18, 0
    v_mov_b32 v19, 0
    v_mov_b32 v20, 0
    v_mov_b32 v21, 0
    v_mov_b32 v22, 0
    v_mov_b32 v23, 0
    v_mov_b32 v24, 0
    v_mov_b32 v25, 0
    v_mov_b32 v26, 0
    v_mov_b32 v27, 0
    v_mov_b32 v28, 0
    v_mov_b32 v29, 0
    v_mov_b32 v30, 0
    v_mov_b32 v31, 0
    s_waitcnt lgkmcnt(0)
    s_barrier
    s_mov_b32 exec_lo, 0xff00ff
    s_mov_b32 exec_hi, 0xff00ff
    ds_read_b128 v[16:19], v7
    ds_read_b128 v[20:23], v7 offset:1024
    s_not_b64 exec, exec
    ds_read_b128 v[24:27], v7
    ds_read_b128 v[28:31], v7 offset:1024
    s_mov_b64 exec, -1
    s_waitcnt lgkmcnt(3)
    v_mfma_f32_16x16x32_bf16 v[12:15], v[16:19], v[152:155], 0
    v_mfma_f32_16x16x32_bf16 v[8:11], v[16:19], v[136:139], 0
    s_waitcnt lgkmcnt(2)
    v_mfma_f32_16x16x32_bf16 v[12:15], v[20:23], v[156:159], v[12:15]
    v_mfma_f32_16x16x32_bf16 v[8:11], v[20:23], v[140:143], v[8:11]
    s_waitcnt lgkmcnt(1)
    v_mfma_f32_16x16x32_bf16 v[8:11], v[24:27], v[144:147], v[8:11]
    s_waitcnt lgkmcnt(0)
    v_mfma_f32_16x16x32_bf16 v[8:11], v[28:31], v[148:151], v[8:11]
    s_mov_b32 exec_hi, 0
    s_nop 1
    buffer_store_dwordx4 v[12:15], v166, s[40:43], s62 offen sc1
    s_mov_b64 exec, -1
    s_nop 2
    buffer_store_dwordx4 v[8:11], v165, s[40:43], s62 offen sc1
    s_branch END
FIN:
    s_cmp_ge_u32 s2, 72
    s_cselect_b32 s44, 32, 0
    s_cselect_b32 s45, 72, 0
    s_sub_u32 s45, s2, s45
    s_mul_i32 s46, s45, 43
    s_lshr_b32 s46, s46, 8
    s_mul_i32 s47, s46, 6
    s_sub_u32 s47, s45, s47
    v_lshrrev_b32 v6, 4, v1
    v_lshl_add_u32 v7, v6, 2, s44
    ds_bpermute_b32 v7, v7, v56
    v_and_b32 v8, 7, v1
    v_and_b32 v5, 15, v1
    s_lshl_b32 s48, s47, 2
    s_add_u32 s49, s48, 1024 - 16
    s_cmp_eq_u32 s47, 3
    s_cselect_b32 s49, 1024 + 8, s49
    s_cmp_lt_u32 s47, 3
    s_cselect_b32 s48, s48, s49
    s_lshl_b32 s49, s46, 11
    s_add_u32 s48, s48, s49
    s_add_u32 s48, s48, 3211264
    s_lshl_b32 s47, s47, 1
    s_lshl_b32 s49, s46, 7
    s_add_u32 s49, s49, s47
    s_add_u32 s49, s49, 6356992
    s_mul_i32 s46, s46, 96
    s_add_u32 s46, s46, s47
    s_movk_i32 s47, 8192
    s_mul_i32 s52, s2, 9216
    s_add_u32 s52, s52, 9502720
    s_add_u32 s53, s52, 4096
    s_add_u32 s54, s52, 8192
    v_mov_b32 v60, 0
    v_mov_b32 v61, 0
    v_mov_b32 v62, 0
    s_waitcnt lgkmcnt(0)
    v_and_b32 v9, 0x7ff, v7
    v_sub_u32 v9, 0x7ff, v9
    v_lshrrev_b32 v10, 4, v9
    v_lshlrev_b32 v11, 6, v10
    v_lshl_add_u32 v11, v5, 2, v11
    v_mul_u32_u24 v12, 0x480, v9
    v_mad_u32_u24 v12, v8, 12, v12
    v_add_u32 v12, s46, v12
    v_mul_u32_u24 v10, 0x6000, v10
    v_lshl_add_u32 v10, v8, 7, v10
    v_and_b32 v13, 14, v9
    v_lshl_add_u32 v10, v13, 3, v10
    v_and_b32 v13, 1, v9
    v_lshl_add_u32 v10, v13, 1, v10
    v_mul_u32_u24 v9, 0x600, v9
    v_lshl_add_u32 v9, v8, 4, v9
    global_load_short_d16_hi v60, v12, s[4:5]
    buffer_load_short_d16_hi v61, v10, s[40:43], s48 offen sc1
    s_mov_b32 exec_lo, 0xfff0fff
    s_mov_b32 exec_hi, 0xfff0fff
    s_movk_i32 s60, 4000
FN_OF:
    buffer_load_dword v13, v11, s[40:43], s47 offen sc1
FN_OF_W:
    s_waitcnt vmcnt(0)
    v_cmp_ne_u32 vcc, s39, v13
    s_nop 0
    s_and_b64 exec, exec, vcc
    s_cbranch_execz FN_OF_D
    s_sub_u32 s60, s60, 1
    s_cmp_gt_i32 s60, 0
    s_sleep 1
    s_cbranch_scc1 FN_OF
FN_OF_D:
    s_mov_b64 exec, -1
    buffer_load_short_d16_hi v62, v9, s[40:43], s49 offen sc1
    v_ashrrev_i32 v13, 31, v7
    v_not_b32 v13, v13
    v_or_b32 v13, 0x80000000, v13
    v_xor_b32 v7, v7, v13
    v_and_b32 v7, 0xffff0000, v7
    v_mul_f32 v7, 0xbfb8aa3b, v7
    v_exp_f32 v7, v7
    v_add_f32 v60, v60, v61
    v_add_f32 v7, 1.0, v7
    v_rcp_f32 v7, v7
    v_cvt_pk_bf16_f32 v60, v60, v60
    v_lshlrev_b32 v60, 16, v60
    v_cvt_pk_bf16_f32 v7, v7, v7
    v_lshlrev_b32 v7, 16, v7
    s_mov_b64 exec, 0x1
    s_movk_i32 s60, 4000
FN_HP:
    buffer_load_dword v13, v3, s[40:43], s52 offen offset:0 sc1
FN_HP_W:
    s_waitcnt vmcnt(0)
    v_cmp_eq_u32 vcc, -1, v13
    s_nop 0
    s_and_b64 exec, exec, vcc
    s_cbranch_execz FN_HP_D
    s_sub_u32 s60, s60, 1
    s_cmp_gt_i32 s60, 0
    s_sleep 1
    s_cbranch_scc1 FN_HP
FN_HP_D:
    s_mov_b64 exec, -1
    s_movk_i32 s60, 4000
FN_PP:
    buffer_load_dwordx4 v[16:19], v3, s[40:43], s52 offen offset:0 sc1
    buffer_load_dwordx4 v[20:23], v3, s[40:43], s52 offen offset:1024 sc1
    buffer_load_dwordx4 v[24:27], v3, s[40:43], s52 offen offset:2048 sc1
    buffer_load_dwordx4 v[28:31], v3, s[40:43], s52 offen offset:3072 sc1
    buffer_load_dwordx4 v[32:35], v3, s[40:43], s53 offen offset:0 sc1
    buffer_load_dwordx4 v[36:39], v3, s[40:43], s53 offen offset:1024 sc1
    buffer_load_dwordx4 v[40:43], v3, s[40:43], s53 offen offset:2048 sc1
    buffer_load_dwordx4 v[44:47], v3, s[40:43], s53 offen offset:3072 sc1
    buffer_load_dwordx4 v[48:51], v3, s[40:43], s54 offen offset:0 sc1
FN_PP_W:
    s_waitcnt vmcnt(0)
    v_pk_add_f32 v[52:53], v[16:17], v[20:21]
    v_pk_add_f32 v[56:57], v[24:25], v[28:29]
    v_pk_add_f32 v[54:55], v[18:19], v[22:23]
    v_pk_add_f32 v[58:59], v[26:27], v[30:31]
    v_pk_add_f32 v[52:53], v[52:53], v[32:33]
    v_pk_add_f32 v[54:55], v[54:55], v[34:35]
    v_pk_add_f32 v[56:57], v[56:57], v[36:37]
    v_pk_add_f32 v[58:59], v[58:59], v[38:39]
    v_pk_add_f32 v[52:53], v[52:53], v[40:41]
    v_pk_add_f32 v[54:55], v[54:55], v[42:43]
    v_pk_add_f32 v[56:57], v[56:57], v[44:45]
    v_pk_add_f32 v[58:59], v[58:59], v[46:47]
    v_pk_add_f32 v[52:53], v[52:53], v[48:49]
    v_pk_add_f32 v[54:55], v[54:55], v[50:51]
    v_pk_add_f32 v[52:53], v[52:53], v[56:57]
    v_pk_add_f32 v[54:55], v[54:55], v[58:59]
    v_pk_add_f32 v[56:57], v[52:53], v[54:55]
    v_cmp_u_f32 vcc, v56, v57
    s_nop 0
    s_and_b64 exec, exec, vcc
    s_cbranch_execz FN_PP_D
    s_sub_u32 s60, s60, 1
    s_cmp_gt_i32 s60, 0
    s_cbranch_scc1 FN_PP
FN_PP_D:
    s_mov_b64 exec, -1
    v_permlane32_swap_b32 v52, v54
    v_permlane32_swap_b32 v53, v55
    v_add_f32 v52, v52, v54
    v_add_f32 v53, v53, v55
    s_nop 1
    v_permlane16_swap_b32 v52, v53
    v_add_f32 v52, v52, v53
    s_nop 1
    v_add_f32_dpp v52, v52, v52 row_ror:8 row_mask:0xf bank_mask:0xf
    v_cvt_pk_bf16_f32 v52, v52, v52
    v_lshlrev_b32 v52, 16, v52
    v_mul_f32 v52, v52, v7
    v_cvt_pk_bf16_f32 v52, v52, v52
    v_lshlrev_b32 v52, 16, v52
    v_add_f32 v52, v52, v62
    v_cvt_pk_bf16_f32 v52, v52, v52
    v_lshlrev_b32 v52, 16, v52
    v_add_f32 v52, v52, v60
    v_cvt_pk_bf16_f32 v52, v52, v52
    s_mov_b32 exec_lo, 0xff00ff
    s_mov_b32 exec_hi, 0xff00ff
    global_store_short v12, v52, s[32:33]
    s_mov_b64 exec, -1
END:
    s_endpgm
.section .rodata,"a"
.p2align 6
.amdhsa_kernel sequential_preLN__ssm_conv_s4__moe_arch_mod__prompt_kernel
  .amdhsa_next_free_vgpr 168
  .amdhsa_next_free_sgpr 102
  .amdhsa_accum_offset 168
  .amdhsa_group_segment_fixed_size 0
  .amdhsa_kernarg_size 136
  .amdhsa_user_sgpr_count 2
  .amdhsa_user_sgpr_kernarg_segment_ptr 1
  .amdhsa_system_sgpr_workgroup_id_x 1
.end_amdhsa_kernel
```

```asm
; @launch grid=(256,1,1) block=(768,1,1) lds=163840
.amdgcn_target "amdgcn-amd-amdhsa--gfx950"
    .text
    .globl sequential_preLN__ssm_conv_s4__moe_arch_mod__prompt_kernel
    .p2align 8
    .type sequential_preLN__ssm_conv_s4__moe_arch_mod__prompt_kernel,@function
sequential_preLN__ssm_conv_s4__moe_arch_mod__prompt_kernel:
    s_cmp_ge_u32 s2, 256
    s_cbranch_scc1 END
    s_load_dwordx16 s[4:19], s[0:1], 0
    s_load_dwordx2 s[36:37], s[0:1], 128
    s_load_dwordx16 s[20:35], s[0:1], 64
    s_getpc_b64 s[70:71]
    s_lshr_b32 s3, s2, 3
    s_mul_i32 s3, s3, 7
    v_subrev_u32 v2, 320, v0
    v_cmp_gt_u32 vcc, 7, v2
    v_add_lshl_u32 v2, v2, s3, 7
    v_min_u32 v2, CODE_END-sequential_preLN__ssm_conv_s4__moe_arch_mod__prompt_kernel-64, v2
    v_mov_b32 v3, s71
    s_mov_b64 exec, vcc
    v_add_co_u32 v2, vcc, s70, v2
    s_nop 1
    v_addc_co_u32 v3, vcc, 0, v3, vcc
    s_cbranch_execz P_NC
    global_load_dword v159, v[2:3], off
P_NC:
    s_mov_b64 exec, -1
    v_lshrrev_b32 v2, 6, v0
    v_and_b32 v1, 63, v0
    v_readfirstlane_b32 s38, v2
    v_lshlrev_b32 v3, 4, v1
    s_mov_b32 s42, 0x10000000
    s_mov_b32 s43, 0x00020000
    s_cmp_ge_u32 s38, 4
    s_cbranch_scc1 P_B
    s_setprio 3
    v_lshrrev_b32 v147, 5, v0
    v_and_b32 v148, 31, v0
    v_mul_u32_u24 v140, 0x480, v147
    s_mul_i32 s44, s2, 9216
    v_mad_u32_u24 v140, v148, 12, v140
    v_mov_b32 v104, 0
    v_mov_b32 v105, 0
    v_mov_b32 v106, 0
    v_mov_b32 v107, 0
    v_add_u32 v140, s44, v140
    v_add_u32 v145, 161280, v3
    s_mov_b64 exec, 0xff
    ds_write_b128 v145, v[104:107]
    s_mov_b64 exec, -1
    v_and_b32 v147, 1, v147
    v_mul_u32_u24 v141, 0x90, v148
    v_lshl_add_u32 v141, v147, 6, v141
    s_lshl_b32 s45, s38, 4
    s_sub_u32 s45, 147504, s45
    v_add_u32 v141, s45, v141
    v_lshrrev_b32 v142, 3, v1
    v_add_u32 v142, v142, v1
    s_mul_i32 s45, s38, 3456
    s_add_u32 s45, s45, 147456
    v_lshl_add_u32 v142, v142, 4, s45
    v_lshrrev_b32 v143, 2, v1
    v_mul_u32_u24 v143, 16320, v143
    v_add_u32 v143, v143, v3
    s_lshl_b32 s46, s2, 6
    s_sub_u32 s46, 81856, s46
    s_mul_i32 s45, s38, 786432
    s_add_u32 s46, s46, s45
    s_add_u32 s47, s46, 262144
    s_add_u32 s48, s46, 524288
    s_mov_b32 s49, 0x05040100
    s_mov_b32 s50, 0x07060302
    v_mov_b32 v144, s49
    s_mov_b32 exec_lo, 0
    v_mov_b32 v144, s50
    s_mov_b64 exec, -1
    v_mov_b32 v145, 161328
    s_lshl_b32 s45, s38, 2
    v_add_u32 v146, s45, v145
    s_waitcnt lgkmcnt(0)
    global_load_dword v95, v104, s[36:37] offset:0
    global_load_dwordx3 v[60:62], v140, s[4:5] offset:0
    global_load_dwordx3 v[64:66], v140, s[4:5] offset:384
    global_load_dwordx3 v[68:70], v140, s[4:5] offset:768
    s_mov_b32 s40, s36
    s_mov_b32 s41, s37
    s_cmp_ge_u32 s2, 192
    s_cbranch_scc1 P_C
    s_lshr_b32 s65, s38, 2
    s_bitcmp1_b32 s2, 0
    s_addc_u32 s51, s65, 0
    s_cmp_eq_u32 s51, 3
    s_cselect_b32 s51, 0, s51
    s_lshl_b32 s52, s51, 8
    s_add_u32 s52, s52, 138048
    v_and_b32 v114, 0x7f, v0
    v_lshl_add_u32 v114, v114, 1, s52
    s_and_b32 s52, s2, 1
    s_add_u32 s52, s52, s51
    s_lshl_b32 s52, s52, 1
    s_add_u32 s52, s52, 142656
    v_mov_b32 v115, s52
    v_mov_b32 v119, 161292
    v_mov_b32 v29, 0
    v_mov_b32 v30, 0
    v_mov_b32 v31, 0
    v_mov_b32 v32, 0
    v_mov_b32 v33, 0
    v_mov_b32 v34, 0
    v_mov_b32 v35, 0
    v_mov_b32 v160, 0
    v_mov_b32 v161, 0
    v_mov_b32 v162, 0
    v_mov_b32 v163, 0
    v_lshlrev_b32 v16, 4, v0
    v_add_u32 v17, 101184, v16
    ds_write_b128 v17, v[160:163] offset:0
    ds_write_b128 v17, v[160:163] offset:12288
    ds_write_b128 v17, v[160:163] offset:24576
    s_mul_i32 s67, s65, 544
    s_and_b32 s66, s38, 1
    s_lshl_b32 s66, s66, 8
    s_add_u32 s66, s66, s67
    s_mov_b32 m0, s66
    s_mul_i32 s64, s65, 5888
    s_add_u32 s64, s64, 101184
    s_and_b32 s69, s38, 3
    v_and_b32 v5, 15, v0
    v_bfe_u32 v6, v0, 4, 2
    v_and_b32 v17, 48, v0
    v_mul_u32_u24 v110, 1632, v5
    s_mov_b32 s52, 0
    s_movk_i32 s53, 6528
    s_movk_i32 s54, 14688
    s_cmp_eq_u32 s69, 1
    s_cselect_b32 s52, 29376, s52
    s_cselect_b32 s53, 3264, s53
    s_cselect_b32 s54, 9792, s54
    s_cmp_eq_u32 s69, 2
    s_cselect_b32 s52, 48960, s52
    s_cselect_b32 s54, 13056, s54
    s_cmp_eq_u32 s69, 3
    s_cselect_b32 s52, 1632, s52
    s_add_u32 s52, s52, s67
    s_add_u32 s67, s67, 75072
    v_and_b32 v111, 3, v0
    v_mul_u32_u24 v111, 1632, v111
    v_bfe_u32 v18, v0, 2, 1
    v_bfe_u32 v19, v0, 3, 1
    v_xor_b32 v18, v18, v19
    v_mad_u32_u24 v111, v19, s53, v111
    v_mad_u32_u24 v111, v18, s54, v111
    v_add3_u32 v111, v111, v17, s52
    v_add3_u32 v110, v110, v17, s67
    s_barrier
    v_lshl_add_u32 v18, v5, 1, v6
    s_sub_u32 s52, s69, 11
    v_add_u32 v18, s52, v18
    v_add_u32 v19, 1, v18
    v_lshl_add_u32 v20, v6, 1, 2
    v_cmp_le_u32 s[52:53], v18, v20
    v_cmp_le_u32 s[54:55], v19, v20
    v_mov_b32 v18, 0x3f80
    v_cndmask_b32 v112, 0, v18, s[52:53]
    v_cndmask_b32 v19, 0, 1.0, s[54:55]
    v_or_b32 v112, v112, v19
    s_mul_i32 s52, s38, 1600
    s_add_u32 s52, s52, 120016
    v_lshl_add_u32 v113, v1, 2, s52
    s_mul_i32 s67, s65, 6400
    s_add_u32 s67, s67, 118848
    s_min_u32 s63, s65, 1
    s_add_u32 s63, s63, s65
    s_cmp_eq_u32 s69, 3
    s_cselect_b32 s62, s65, s69
    s_cselect_b32 s63, 1, s63
    v_add_u32 v7, 1, v5
    v_and_b32 v8, 3, v7
    v_mul_u32_u24 v8, 1598, v8
    v_lshl_add_u32 v7, v7, 1, v8
    s_mul_i32 s68, s62, 6400
    s_add_u32 s68, s68, 118848
    v_add3_u32 v7, v7, v17, s68
    s_mul_i32 s61, s62, 5888
    s_add_u32 s61, s61, 101184
    v_add_u32 v18, s61, v17
    v_lshl_add_u32 v9, v5, 3, v18
    v_and_b32 v10, 1, v5
    v_mul_u32_u24 v10, 380, v10
    v_lshl_add_u32 v10, v5, 2, v10
    v_add_u32 v10, v18, v10
    v_lshlrev_b32 v8, 5, v5
    v_sub_u32 v8, v18, v8
    v_lshrrev_b32 v11, 2, v5
    v_lshl_add_u32 v2, v5, 2, v6
    v_add_u32 v15, v2, v11
    s_mul_i32 s59, s62, 13824
    v_lshl_add_u32 v4, v15, 3, s59
    s_lshl_b32 s52, s62, 4
    s_add_u32 s52, s52, 161280
    v_mov_b32 v166, s52
    v_mov_b32 v167, 147468
    v_mul_u32_u24 v150, 57, v1
    v_lshrrev_b32 v150, 9, v150
    v_mul_u32_u24 v151, 9, v150
    v_sub_u32 v151, v1, v151
    s_lshr_b32 s52, s2, 3
    s_lshl_b32 s52, s52, 2
    s_add_u32 s52, s52, s38
    s_mul_i32 s52, s52, 6
    v_add_u32 v150, s52, v150
    s_and_b32 s52, s2, 7
    v_lshl_add_u32 v151, v151, 3, s52
    v_min_u32 v150, 0x23f, v150
    v_mul_u32_u24 v152, 0x48, v150
    v_mul_u32_u24 v153, 0x240, v151
    v_add_lshl_u32 v14, v151, v152, 7
    v_add_lshl_u32 v13, v150, v153, 7
    s_branch P_D
P_C:
    v_mov_b32 v8, 0
    v_mov_b32 v9, 0
    v_mov_b32 v10, 0
    v_mov_b32 v13, 0
    v_mov_b32 v14, 0
    v_mov_b32 v166, 0
    s_barrier
P_D:
    s_waitcnt vmcnt(0)
LN1:
    v_dot2c_f32_bf16 v104, 0x3f803f80, v60
    v_dot2c_f32_bf16 v106, v60, v60
    v_dot2c_f32_bf16 v105, 0x3f803f80, v61
    v_dot2c_f32_bf16 v107, v61, v61
    v_dot2c_f32_bf16 v104, 0x3f803f80, v62
    v_dot2c_f32_bf16 v106, v62, v62
    v_dot2c_f32_bf16 v105, 0x3f803f80, v64
    v_dot2c_f32_bf16 v107, v64, v64
    v_dot2c_f32_bf16 v104, 0x3f803f80, v65
    v_dot2c_f32_bf16 v106, v65, v65
    v_dot2c_f32_bf16 v105, 0x3f803f80, v66
    v_dot2c_f32_bf16 v107, v66, v66
    v_dot2c_f32_bf16 v104, 0x3f803f80, v68
    v_dot2c_f32_bf16 v106, v68, v68
    v_dot2c_f32_bf16 v105, 0x3f803f80, v69
    v_dot2c_f32_bf16 v107, v69, v69
    v_dot2c_f32_bf16 v104, 0x3f803f80, v70
    v_dot2c_f32_bf16 v106, v70, v70
    v_lshlrev_b32 v72, 16, v60
    v_and_b32 v73, 0xffff0000, v60
    v_add_f32 v104, v104, v105
    v_add_f32 v106, v106, v107
    v_lshlrev_b32 v74, 16, v61
    v_and_b32 v75, 0xffff0000, v61
    v_permlane16_swap_b32 v104, v106
    v_add_f32 v104, v104, v106
    v_lshlrev_b32 v76, 16, v62
    v_and_b32 v77, 0xffff0000, v62
    v_add_f32_dpp v104, v104, v104 quad_perm:[1,0,3,2] row_mask:0xf bank_mask:0xf
    v_lshlrev_b32 v78, 16, v64
    v_and_b32 v79, 0xffff0000, v64
    v_add_f32_dpp v104, v104, v104 quad_perm:[2,3,0,1] row_mask:0xf bank_mask:0xf
    v_lshlrev_b32 v80, 16, v65
    v_and_b32 v81, 0xffff0000, v65
    v_add_f32_dpp v104, v104, v104 row_half_mirror row_mask:0xf bank_mask:0xf
    v_lshlrev_b32 v82, 16, v66
    v_and_b32 v83, 0xffff0000, v66
    v_add_f32_dpp v104, v104, v104 row_mirror row_mask:0xf bank_mask:0xf
    v_mul_f32 v104, 0x3ae38e39, v104
    v_mov_b32 v105, v104
    v_lshlrev_b32 v84, 16, v68
    v_and_b32 v85, 0xffff0000, v68
    v_permlane16_swap_b32 v104, v105
    v_fma_f32 v105, -v104, v104, v105
    v_max_f32 v105, 0, v105
    v_cvt_pk_bf16_f32 v105, v104, v105
    v_lshlrev_b32 v104, 16, v105
    v_and_b32 v105, 0xffff0000, v105
    v_lshlrev_b32 v86, 16, v69
    v_and_b32 v87, 0xffff0000, v69
    v_lshlrev_b32 v88, 16, v70
    v_and_b32 v89, 0xffff0000, v70
    v_add_u32 v95, 1, v95
    v_mov_b32 v99, v95
    v_mov_b32 v103, v95
    v_readfirstlane_b32 s39, v95
    v_add_f32 v105, 0x3727c5ac, v105
    v_cvt_pk_bf16_f32 v105, v105, v105
    v_lshlrev_b32 v105, 16, v105
    v_sqrt_f32 v106, v105
    v_pk_add_f32 v[72:73], v[72:73], v[104:105] op_sel_hi:[1,0] neg_lo:[0,1] neg_hi:[0,1]
    v_pk_add_f32 v[74:75], v[74:75], v[104:105] op_sel_hi:[1,0] neg_lo:[0,1] neg_hi:[0,1]
    v_pk_add_f32 v[76:77], v[76:77], v[104:105] op_sel_hi:[1,0] neg_lo:[0,1] neg_hi:[0,1]
    v_cvt_pk_bf16_f32 v106, v106, v106
    v_lshlrev_b32 v106, 16, v106
    v_rcp_f32 v106, v106
    v_pk_add_f32 v[78:79], v[78:79], v[104:105] op_sel_hi:[1,0] neg_lo:[0,1] neg_hi:[0,1]
    v_pk_add_f32 v[80:81], v[80:81], v[104:105] op_sel_hi:[1,0] neg_lo:[0,1] neg_hi:[0,1]
    v_pk_add_f32 v[82:83], v[82:83], v[104:105] op_sel_hi:[1,0] neg_lo:[0,1] neg_hi:[0,1]
    v_pk_add_f32 v[84:85], v[84:85], v[104:105] op_sel_hi:[1,0] neg_lo:[0,1] neg_hi:[0,1]
    v_pk_add_f32 v[86:87], v[86:87], v[104:105] op_sel_hi:[1,0] neg_lo:[0,1] neg_hi:[0,1]
    v_pk_add_f32 v[88:89], v[88:89], v[104:105] op_sel_hi:[1,0] neg_lo:[0,1] neg_hi:[0,1]
    v_cvt_pk_bf16_f32 v73, v72, v73
    v_cvt_pk_bf16_f32 v75, v74, v75
    v_cvt_pk_bf16_f32 v77, v76, v77
    v_cvt_pk_bf16_f32 v79, v78, v79
    v_cvt_pk_bf16_f32 v81, v80, v81
    v_cvt_pk_bf16_f32 v83, v82, v83
    v_cvt_pk_bf16_f32 v85, v84, v85
    v_cvt_pk_bf16_f32 v87, v86, v87
    v_cvt_pk_bf16_f32 v89, v88, v89
    v_lshlrev_b32 v72, 16, v73
    v_and_b32 v73, 0xffff0000, v73
    v_lshlrev_b32 v74, 16, v75
    v_and_b32 v75, 0xffff0000, v75
    v_lshlrev_b32 v76, 16, v77
    v_and_b32 v77, 0xffff0000, v77
    v_pk_mul_f32 v[72:73], v[72:73], v[106:107] op_sel_hi:[1,0]
    v_pk_mul_f32 v[74:75], v[74:75], v[106:107] op_sel_hi:[1,0]
    v_pk_mul_f32 v[76:77], v[76:77], v[106:107] op_sel_hi:[1,0]
    v_cvt_pk_bf16_f32 v60, v72, v73
    v_cvt_pk_bf16_f32 v62, v76, v77
    v_cvt_pk_bf16_f32 v61, v74, v75
    v_cvt_pk_bf16_f32 v63, v74, v75
    v_permlane32_swap_b32 v60, v62
    s_nop 0
    v_permlane32_swap_b32 v61, v63
    v_perm_b32 v92, v60, v62, s49
    v_perm_b32 v93, v60, v62, s50
    v_lshlrev_b32 v78, 16, v79
    v_and_b32 v79, 0xffff0000, v79
    v_lshlrev_b32 v80, 16, v81
    v_and_b32 v81, 0xffff0000, v81
    v_lshlrev_b32 v82, 16, v83
    v_and_b32 v83, 0xffff0000, v83
    v_pk_mul_f32 v[78:79], v[78:79], v[106:107] op_sel_hi:[1,0]
    v_pk_mul_f32 v[80:81], v[80:81], v[106:107] op_sel_hi:[1,0]
    v_pk_mul_f32 v[82:83], v[82:83], v[106:107] op_sel_hi:[1,0]
    v_cvt_pk_bf16_f32 v64, v78, v79
    v_cvt_pk_bf16_f32 v66, v82, v83
    v_cvt_pk_bf16_f32 v65, v80, v81
    v_cvt_pk_bf16_f32 v67, v80, v81
    v_perm_b32 v94, v61, v63, v144
    ds_write_b128 v141, v[92:95] offset:0
    v_permlane32_swap_b32 v64, v66
    v_permlane32_swap_b32 v65, v67
    v_perm_b32 v96, v64, v66, s49
    v_perm_b32 v97, v64, v66, s50
    v_lshlrev_b32 v84, 16, v85
    v_and_b32 v85, 0xffff0000, v85
    v_lshlrev_b32 v86, 16, v87
    v_and_b32 v87, 0xffff0000, v87
    v_lshlrev_b32 v88, 16, v89
    v_and_b32 v89, 0xffff0000, v89
    v_pk_mul_f32 v[84:85], v[84:85], v[106:107] op_sel_hi:[1,0]
    v_pk_mul_f32 v[86:87], v[86:87], v[106:107] op_sel_hi:[1,0]
    v_pk_mul_f32 v[88:89], v[88:89], v[106:107] op_sel_hi:[1,0]
    v_cvt_pk_bf16_f32 v68, v84, v85
    v_cvt_pk_bf16_f32 v70, v88, v89
    v_cvt_pk_bf16_f32 v69, v86, v87
    v_cvt_pk_bf16_f32 v71, v86, v87
    v_perm_b32 v98, v65, v67, v144
    ds_write_b128 v141, v[96:99] offset:4608
    v_permlane32_swap_b32 v68, v70
    v_permlane32_swap_b32 v69, v71
    v_perm_b32 v100, v68, v70, s49
    v_perm_b32 v101, v68, v70, s50
    v_perm_b32 v102, v69, v71, v144
    ds_write_b128 v141, v[100:103] offset:9216
    s_mov_b64 exec, 0x1
    ds_write_b32 v146, v144
    s_mov_b64 exec, -1
    s_movk_i32 s60, 4000
LN1_R:
    ds_read_b128 v[104:107], v145
    ds_read_b128 v[72:75], v142 offset:0
    ds_read_b128 v[76:79], v142 offset:1152
    ds_read_b128 v[80:83], v142 offset:2304
    s_sub_u32 s60, s60, 1
    s_waitcnt lgkmcnt(3)
    v_min3_u32 v104, v104, v105, v106
    v_min_u32 v104, v104, v107
    v_cmp_eq_u32 vcc, 0, v104
    s_cmp_gt_i32 s60, 0
    s_cselect_b64 s[52:53], vcc, 0
    s_cmp_lg_u64 s[52:53], 0
    s_waitcnt lgkmcnt(0)
    s_cbranch_scc1 LN1_R
    buffer_store_dwordx4 v[72:75], v143, s[40:43], s46 offen sc1
    buffer_store_dwordx4 v[76:79], v143, s[40:43], s47 offen sc1
    buffer_store_dwordx4 v[80:83], v143, s[40:43], s48 offen sc1
    s_setprio 0
    s_cmp_ge_u32 s2, 192
    s_cbranch_scc1 FFN_DMA
    s_branch C_KS
P_B:
    s_cmp_ge_u32 s2, 192
    s_cbranch_scc1 FFN_DMA0
    s_cmp_lg_u32 s38, 4
    s_cbranch_scc1 P_B2
    s_mul_i32 s52, s2, 768
    v_add_u32 v16, s52, v3
    s_mul_i32 s52, s2, 6
    s_and_b32 s52, s52, -4
    v_lshl_add_u32 v17, v1, 2, s52
    s_waitcnt lgkmcnt(0)
    s_mov_b32 exec_lo, 0xffffffff
    s_mov_b32 exec_hi, 0xffff
    s_mov_b32 m0, 138048
    s_nop 0
    global_load_lds_dwordx4 v16, s[6:7]
    s_mov_b32 m0, 138816
    s_nop 0
    global_load_lds_dwordx4 v16, s[8:9]
    s_mov_b32 m0, 139584
    s_nop 0
    global_load_lds_dwordx4 v16, s[10:11]
    s_mov_b32 m0, 140352
    s_nop 0
    global_load_lds_dwordx4 v16, s[12:13]
    s_mov_b32 m0, 141120
    s_nop 0
    global_load_lds_dwordx4 v16, s[14:15]
    s_mov_b32 m0, 141888
    s_nop 0
    global_load_lds_dwordx4 v16, s[16:17]
    s_mov_b64 exec, 0x3
    s_mov_b32 m0, 142656
    s_nop 0
    global_load_lds_dword v17, s[18:19]
    s_mov_b32 m0, 142672
    s_nop 0
    global_load_lds_dword v17, s[20:21]
    s_mov_b64 exec, -1
P_B2:
    s_lshr_b32 s65, s38, 2
    s_bitcmp1_b32 s2, 0
    s_addc_u32 s51, s65, 0
    s_cmp_eq_u32 s51, 3
    s_cselect_b32 s51, 0, s51
    s_lshl_b32 s52, s51, 8
    s_add_u32 s52, s52, 138048
    v_and_b32 v114, 0x7f, v0
    v_lshl_add_u32 v114, v114, 1, s52
    s_and_b32 s52, s2, 1
    s_add_u32 s52, s52, s51
    s_lshl_b32 s52, s52, 1
    s_add_u32 s52, s52, 142656
    v_mov_b32 v115, s52
    v_mov_b32 v119, 161292
    v_mov_b32 v29, 0
    v_mov_b32 v30, 0
    v_mov_b32 v31, 0
    v_mov_b32 v32, 0
    v_mov_b32 v33, 0
    v_mov_b32 v34, 0
    v_mov_b32 v35, 0
    v_mov_b32 v160, 0
    v_mov_b32 v161, 0
    v_mov_b32 v162, 0
    v_mov_b32 v163, 0
    v_lshlrev_b32 v16, 4, v0
    v_add_u32 v17, 101184, v16
    ds_write_b128 v17, v[160:163] offset:0
    ds_write_b128 v17, v[160:163] offset:12288
    ds_write_b128 v17, v[160:163] offset:24576
    s_mul_i32 s67, s65, 544
    s_and_b32 s66, s38, 1
    s_lshl_b32 s66, s66, 8
    s_add_u32 s66, s66, s67
    s_mov_b32 m0, s66
    s_mul_i32 s64, s65, 5888
    s_add_u32 s64, s64, 101184
    s_and_b32 s69, s38, 3
    v_and_b32 v5, 15, v0
    v_bfe_u32 v6, v0, 4, 2
    v_and_b32 v17, 48, v0
    v_mul_u32_u24 v110, 1632, v5
    s_mov_b32 s52, 0
    s_movk_i32 s53, 6528
    s_movk_i32 s54, 14688
    s_cmp_eq_u32 s69, 1
    s_cselect_b32 s52, 29376, s52
    s_cselect_b32 s53, 3264, s53
    s_cselect_b32 s54, 9792, s54
    s_cmp_eq_u32 s69, 2
    s_cselect_b32 s52, 48960, s52
    s_cselect_b32 s54, 13056, s54
    s_cmp_eq_u32 s69, 3
    s_cselect_b32 s52, 1632, s52
    s_add_u32 s52, s52, s67
    s_add_u32 s67, s67, 75072
    v_and_b32 v111, 3, v0
    v_mul_u32_u24 v111, 1632, v111
    v_bfe_u32 v18, v0, 2, 1
    v_bfe_u32 v19, v0, 3, 1
    v_xor_b32 v18, v18, v19
    v_mad_u32_u24 v111, v19, s53, v111
    v_mad_u32_u24 v111, v18, s54, v111
    v_add3_u32 v111, v111, v17, s52
    v_add3_u32 v110, v110, v17, s67
    s_barrier
    v_lshl_add_u32 v18, v5, 1, v6
    s_sub_u32 s52, s69, 11
    v_add_u32 v18, s52, v18
    v_add_u32 v19, 1, v18
    v_lshl_add_u32 v20, v6, 1, 2
    v_cmp_le_u32 s[52:53], v18, v20
    v_cmp_le_u32 s[54:55], v19, v20
    v_mov_b32 v18, 0x3f80
    v_cndmask_b32 v112, 0, v18, s[52:53]
    v_cndmask_b32 v19, 0, 1.0, s[54:55]
    v_or_b32 v112, v112, v19
    s_mul_i32 s52, s38, 1600
    s_add_u32 s52, s52, 120016
    v_lshl_add_u32 v113, v1, 2, s52
    s_mul_i32 s67, s65, 6400
    s_add_u32 s67, s67, 118848
    s_min_u32 s63, s65, 1
    s_add_u32 s63, s63, s65
    s_cmp_eq_u32 s69, 3
    s_cselect_b32 s62, s65, s69
    s_cselect_b32 s63, 1, s63
    v_add_u32 v7, 1, v5
    v_and_b32 v8, 3, v7
    v_mul_u32_u24 v8, 1598, v8
    v_lshl_add_u32 v7, v7, 1, v8
    s_mul_i32 s68, s62, 6400
    s_add_u32 s68, s68, 118848
    v_add3_u32 v7, v7, v17, s68
    s_mul_i32 s61, s62, 5888
    s_add_u32 s61, s61, 101184
    v_add_u32 v18, s61, v17
    v_lshl_add_u32 v9, v5, 3, v18
    v_and_b32 v10, 1, v5
    v_mul_u32_u24 v10, 380, v10
    v_lshl_add_u32 v10, v5, 2, v10
    v_add_u32 v10, v18, v10
    v_lshlrev_b32 v8, 5, v5
    v_sub_u32 v8, v18, v8
    v_lshrrev_b32 v11, 2, v5
    v_lshl_add_u32 v2, v5, 2, v6
    v_add_u32 v15, v2, v11
    s_mul_i32 s59, s62, 13824
    v_lshl_add_u32 v4, v15, 3, s59
    s_lshl_b32 s52, s62, 4
    s_add_u32 s52, s52, 161280
    v_mov_b32 v166, s52
    v_mov_b32 v167, 147468
    v_mov_b32 v13, 0
    v_mov_b32 v14, 0
    v_mov_b32 v160, -1
    v_mov_b32 v161, -1
    v_mov_b32 v162, -1
    v_mov_b32 v163, -1
    v_lshlrev_b32 v17, 1, v0
    s_mul_i32 s48, s2, 9216
    s_add_u32 s48, s48, 9498624
    s_cmp_eq_u32 s2, 150
    s_cselect_b32 s48, 28672, s48
    s_cselect_b32 s50, 0, s2
    s_add_u32 s49, s48, 11776
    s_waitcnt vmcnt(0) lgkmcnt(0)
    s_mov_b32 s40, s36
    s_mov_b32 s41, s37
    s_cmp_lg_u32 s38, 4
    s_cbranch_scc1 P_B3
    s_mov_b64 exec, 0x1
    ds_write_b32 v119, v119
    s_mov_b64 exec, -1
P_B3:
C_KS:
    s_movk_i32 s60, 4000
C_KP:
    ds_read_b32 v20, v119
    s_sub_u32 s60, s60, 1
    s_cmp_gt_i32 s60, 0
    s_waitcnt lgkmcnt(0)
    v_readfirstlane_b32 s52, v20
    s_nop 0
    s_cselect_b32 s52, s52, 1
    s_cmp_eq_u32 s52, 0
    s_cbranch_scc1 C_KP
    ds_read_u16_d16_hi v29, v115
    ds_read_u16_d16_hi v30, v114 offset:0
    ds_read_u16_d16_hi v31, v114 offset:768
    ds_read_u16_d16_hi v32, v114 offset:1536
    ds_read_u16_d16_hi v33, v114 offset:2304
    ds_read_u16_d16_hi v34, v114 offset:3072
    ds_read_u16_d16_hi v35, v114 offset:3840
    s_waitcnt lgkmcnt(0)
    v_mul_f32 v20, 0x3fb8aa3b, v29
    v_mov_b32 v21, 0x3fb8aa3b
    v_fma_f32 v21, v29, v21, -v20
    v_fmac_f32 v21, 0x32a57060, v29
    v_exp_f32 v20, v20
    v_mul_f32 v21, 0x3f317218, v21
    v_fma_f32 v20, v20, v21, v20
    v_cvt_pk_bf16_f32 v20, v20, v20
    v_lshlrev_b32 v20, 16, v20
    v_mul_f32 v21, v30, v20
    v_mul_f32 v36, v31, v20
    v_mul_f32 v32, v32, v20
    v_mul_f32 v33, v33, v20
    v_mul_f32 v21, 0x3fb8aa3b, v21
    v_mul_f32 v22, 0x3e22f983, v36
    v_mov_b32 v23, 0x3e22f983
    v_fma_f32 v23, v36, v23, -v22
    v_fmac_f32 v23, 0x31dc9c88, v36
    v_pk_mul_f32 v[24:25], v[34:35], v[32:33] op_sel:[0,0] op_sel_hi:[0,1]
    v_pk_fma_f32 v[24:25], v[34:35], v[32:33], v[24:25] op_sel:[1,1,0] op_sel_hi:[1,0,1] neg_lo:[1,0,0]
    s_bitcmp1_b32 s38, 1
    s_cbranch_scc1 C_ROLE1
    v_mul_f32 v36, 0x43000000, v21
    v_mul_f32 v37, 0x43000000, v22
    v_mul_f32 v38, 0x41000000, v21
    v_mul_f32 v39, 0x41000000, v22
    v_exp_f32 v36, v36
    v_fract_f32 v37, v37
    v_exp_f32 v38, v38
    v_fract_f32 v39, v39
    v_fmac_f32 v37, 0x43000000, v23
    v_fmac_f32 v39, 0x41000000, v23
    v_cos_f32 v26, v37
    v_sin_f32 v27, v37
    v_cos_f32 v28, v39
    v_sin_f32 v29, v39
    v_mul_f32 v26, v26, v36
    v_mul_f32 v27, v27, v36
    v_mul_f32 v28, v28, v38
    v_mul_f32 v29, v29, v38
    v_mov_b32 v44, 1.0
    v_mov_b32 v45, 0
    v_pk_mul_f32 v[56:57], v[24:25], v[28:29] op_sel:[0,0] op_sel_hi:[0,1]
    v_pk_mul_f32 v[50:51], v[28:29], v[28:29] op_sel:[0,0] op_sel_hi:[0,1]
    v_pk_fma_f32 v[56:57], v[24:25], v[28:29], v[56:57] op_sel:[1,1,0] op_sel_hi:[1,0,1] neg_lo:[1,0,0]
    v_pk_fma_f32 v[50:51], v[28:29], v[28:29], v[50:51] op_sel:[1,1,0] op_sel_hi:[1,0,1] neg_lo:[1,0,0]
    v_pk_mul_f32 v[58:59], v[56:57], v[26:27] op_sel:[0,0] op_sel_hi:[0,1]
    v_pk_fma_f32 v[58:59], v[56:57], v[26:27], v[58:59] op_sel:[1,1,0] op_sel_hi:[1,0,1] neg_lo:[1,0,0]
    v_cvt_pk_bf16_f32 v40, v56, v57
    ds_write_addtid_b32 v40 offset:13056
    v_pk_mul_f32 v[56:57], v[58:59], v[26:27] op_sel:[0,0] op_sel_hi:[0,1]
    v_pk_mul_f32 v[54:55], v[50:51], v[28:29] op_sel:[0,0] op_sel_hi:[0,1]
    v_pk_fma_f32 v[56:57], v[58:59], v[26:27], v[56:57] op_sel:[1,1,0] op_sel_hi:[1,0,1] neg_lo:[1,0,0]
    v_pk_fma_f32 v[54:55], v[50:51], v[28:29], v[54:55] op_sel:[1,1,0] op_sel_hi:[1,0,1] neg_lo:[1,0,0]
    v_cvt_pk_bf16_f32 v41, v58, v59
    ds_write_addtid_b32 v41 offset:27744
    v_cvt_pk_bf16_f32 v42, v44, -v45
    s_add_u32 m0, s66, 35904
    s_nop 0
    ds_write_addtid_b32 v42 offset:39168
    v_cvt_pk_bf16_f32 v43, v28, -v29
    ds_write_addtid_b32 v43 offset:40800
    v_cvt_pk_bf16_f32 v40, v50, -v51
    ds_write_addtid_b32 v40 offset:42432
    v_pk_mul_f32 v[58:59], v[56:57], v[26:27] op_sel:[0,0] op_sel_hi:[0,1]
    v_pk_mul_f32 v[50:51], v[54:55], v[28:29] op_sel:[0,0] op_sel_hi:[0,1]
    v_pk_fma_f32 v[58:59], v[56:57], v[26:27], v[58:59] op_sel:[1,1,0] op_sel_hi:[1,0,1] neg_lo:[1,0,0]
    v_pk_fma_f32 v[50:51], v[54:55], v[28:29], v[50:51] op_sel:[1,1,0] op_sel_hi:[1,0,1] neg_lo:[1,0,0]
    v_cvt_pk_bf16_f32 v41, v56, v57
    ds_write_addtid_b32 v41 offset:0
    v_cvt_pk_bf16_f32 v42, v54, -v55
    ds_write_addtid_b32 v42 offset:44064
    v_pk_mul_f32 v[56:57], v[58:59], v[26:27] op_sel:[0,0] op_sel_hi:[0,1]
    v_pk_mul_f32 v[54:55], v[50:51], v[28:29] op_sel:[0,0] op_sel_hi:[0,1]
    v_pk_fma_f32 v[56:57], v[58:59], v[26:27], v[56:57] op_sel:[1,1,0] op_sel_hi:[1,0,1] neg_lo:[1,0,0]
    v_pk_fma_f32 v[54:55], v[50:51], v[28:29], v[54:55] op_sel:[1,1,0] op_sel_hi:[1,0,1] neg_lo:[1,0,0]
    v_cvt_pk_bf16_f32 v43, v58, v59
    ds_write_addtid_b32 v43 offset:9792
    v_cvt_pk_bf16_f32 v40, v50, -v51
    ds_write_addtid_b32 v40 offset:45696
    v_pk_mul_f32 v[58:59], v[56:57], v[26:27] op_sel:[0,0] op_sel_hi:[0,1]
    v_pk_mul_f32 v[50:51], v[54:55], v[28:29] op_sel:[0,0] op_sel_hi:[0,1]
    v_pk_fma_f32 v[58:59], v[56:57], v[26:27], v[58:59] op_sel:[1,1,0] op_sel_hi:[1,0,1] neg_lo:[1,0,0]
    v_pk_fma_f32 v[50:51], v[54:55], v[28:29], v[50:51] op_sel:[1,1,0] op_sel_hi:[1,0,1] neg_lo:[1,0,0]
    v_cvt_pk_bf16_f32 v41, v56, v57
    ds_write_addtid_b32 v41 offset:14688
    v_cvt_pk_bf16_f32 v42, v54, -v55
    ds_write_addtid_b32 v42 offset:47328
    v_pk_mul_f32 v[56:57], v[58:59], v[26:27] op_sel:[0,0] op_sel_hi:[0,1]
    v_pk_mul_f32 v[54:55], v[50:51], v[28:29] op_sel:[0,0] op_sel_hi:[0,1]
    v_pk_fma_f32 v[56:57], v[58:59], v[26:27], v[56:57] op_sel:[1,1,0] op_sel_hi:[1,0,1] neg_lo:[1,0,0]
    v_pk_fma_f32 v[54:55], v[50:51], v[28:29], v[54:55] op_sel:[1,1,0] op_sel_hi:[1,0,1] neg_lo:[1,0,0]
    v_cvt_pk_bf16_f32 v43, v58, v59
    ds_write_addtid_b32 v43 offset:17952
    v_cvt_pk_bf16_f32 v40, v50, -v51
    ds_write_addtid_b32 v40 offset:48960
    v_pk_mul_f32 v[58:59], v[56:57], v[26:27] op_sel:[0,0] op_sel_hi:[0,1]
    v_pk_mul_f32 v[50:51], v[54:55], v[28:29] op_sel:[0,0] op_sel_hi:[0,1]
    v_pk_fma_f32 v[58:59], v[56:57], v[26:27], v[58:59] op_sel:[1,1,0] op_sel_hi:[1,0,1] neg_lo:[1,0,0]
    v_pk_fma_f32 v[50:51], v[54:55], v[28:29], v[50:51] op_sel:[1,1,0] op_sel_hi:[1,0,1] neg_lo:[1,0,0]
    v_cvt_pk_bf16_f32 v41, v56, v57
    ds_write_addtid_b32 v41 offset:27744
    v_cvt_pk_bf16_f32 v42, v54, -v55
    ds_write_addtid_b32 v42 offset:50592
    v_pk_mul_f32 v[56:57], v[58:59], v[26:27] op_sel:[0,0] op_sel_hi:[0,1]
    v_pk_mul_f32 v[54:55], v[50:51], v[28:29] op_sel:[0,0] op_sel_hi:[0,1]
    v_pk_fma_f32 v[56:57], v[58:59], v[26:27], v[56:57] op_sel:[1,1,0] op_sel_hi:[1,0,1] neg_lo:[1,0,0]
    v_pk_fma_f32 v[54:55], v[50:51], v[28:29], v[54:55] op_sel:[1,1,0] op_sel_hi:[1,0,1] neg_lo:[1,0,0]
    v_cvt_pk_bf16_f32 v43, v58, v59
    ds_write_addtid_b32 v43 offset:31008
    v_cvt_pk_bf16_f32 v40, v50, -v51
    ds_write_addtid_b32 v40 offset:52224
    v_pk_mul_f32 v[58:59], v[56:57], v[26:27] op_sel:[0,0] op_sel_hi:[0,1]
    v_pk_mul_f32 v[50:51], v[54:55], v[28:29] op_sel:[0,0] op_sel_hi:[0,1]
    v_pk_fma_f32 v[58:59], v[56:57], v[26:27], v[58:59] op_sel:[1,1,0] op_sel_hi:[1,0,1] neg_lo:[1,0,0]
    v_pk_fma_f32 v[50:51], v[54:55], v[28:29], v[50:51] op_sel:[1,1,0] op_sel_hi:[1,0,1] neg_lo:[1,0,0]
    v_cvt_pk_bf16_f32 v41, v56, v57
    ds_write_addtid_b32 v41 offset:32640
    v_cvt_pk_bf16_f32 v42, v54, -v55
    ds_write_addtid_b32 v42 offset:53856
    v_pk_mul_f32 v[56:57], v[58:59], v[26:27] op_sel:[0,0] op_sel_hi:[0,1]
    v_pk_mul_f32 v[54:55], v[50:51], v[28:29] op_sel:[0,0] op_sel_hi:[0,1]
    v_pk_fma_f32 v[56:57], v[58:59], v[26:27], v[56:57] op_sel:[1,1,0] op_sel_hi:[1,0,1] neg_lo:[1,0,0]
    v_pk_fma_f32 v[54:55], v[50:51], v[28:29], v[54:55] op_sel:[1,1,0] op_sel_hi:[1,0,1] neg_lo:[1,0,0]
    v_cvt_pk_bf16_f32 v43, v58, v59
    ds_write_addtid_b32 v43 offset:34272
    v_cvt_pk_bf16_f32 v40, v50, -v51
    ds_write_addtid_b32 v40 offset:55488
    v_pk_mul_f32 v[58:59], v[56:57], v[26:27] op_sel:[0,0] op_sel_hi:[0,1]
    v_pk_mul_f32 v[50:51], v[54:55], v[28:29] op_sel:[0,0] op_sel_hi:[0,1]
    v_pk_fma_f32 v[58:59], v[56:57], v[26:27], v[58:59] op_sel:[1,1,0] op_sel_hi:[1,0,1] neg_lo:[1,0,0]
    v_pk_fma_f32 v[50:51], v[54:55], v[28:29], v[50:51] op_sel:[1,1,0] op_sel_hi:[1,0,1] neg_lo:[1,0,0]
    v_cvt_pk_bf16_f32 v41, v56, v57
    ds_write_addtid_b32 v41 offset:35904
    v_cvt_pk_bf16_f32 v42, v54, -v55
    ds_write_addtid_b32 v42 offset:57120
    v_pk_mul_f32 v[56:57], v[58:59], v[26:27] op_sel:[0,0] op_sel_hi:[0,1]
    v_pk_mul_f32 v[54:55], v[50:51], v[28:29] op_sel:[0,0] op_sel_hi:[0,1]
    v_pk_fma_f32 v[56:57], v[58:59], v[26:27], v[56:57] op_sel:[1,1,0] op_sel_hi:[1,0,1] neg_lo:[1,0,0]
    v_pk_fma_f32 v[54:55], v[50:51], v[28:29], v[54:55] op_sel:[1,1,0] op_sel_hi:[1,0,1] neg_lo:[1,0,0]
    v_cvt_pk_bf16_f32 v43, v58, v59
    ds_write_addtid_b32 v43 offset:37536
    v_cvt_pk_bf16_f32 v40, v50, -v51
    ds_write_addtid_b32 v40 offset:58752
    v_pk_mul_f32 v[58:59], v[56:57], v[26:27] op_sel:[0,0] op_sel_hi:[0,1]
    v_pk_mul_f32 v[50:51], v[54:55], v[28:29] op_sel:[0,0] op_sel_hi:[0,1]
    v_pk_fma_f32 v[58:59], v[56:57], v[26:27], v[58:59] op_sel:[1,1,0] op_sel_hi:[1,0,1] neg_lo:[1,0,0]
    v_pk_fma_f32 v[50:51], v[54:55], v[28:29], v[50:51] op_sel:[1,1,0] op_sel_hi:[1,0,1] neg_lo:[1,0,0]
    v_cvt_pk_bf16_f32 v41, v56, v57
    ds_write_addtid_b32 v41 offset:19584
    v_cvt_pk_bf16_f32 v42, v54, -v55
    ds_write_addtid_b32 v42 offset:60384
    v_pk_mul_f32 v[56:57], v[58:59], v[26:27] op_sel:[0,0] op_sel_hi:[0,1]
    v_pk_mul_f32 v[54:55], v[50:51], v[28:29] op_sel:[0,0] op_sel_hi:[0,1]
    v_pk_fma_f32 v[56:57], v[58:59], v[26:27], v[56:57] op_sel:[1,1,0] op_sel_hi:[1,0,1] neg_lo:[1,0,0]
    v_pk_fma_f32 v[54:55], v[50:51], v[28:29], v[54:55] op_sel:[1,1,0] op_sel_hi:[1,0,1] neg_lo:[1,0,0]
    v_cvt_pk_bf16_f32 v43, v58, v59
    ds_write_addtid_b32 v43 offset:21216
    v_cvt_pk_bf16_f32 v40, v50, -v51
    ds_write_addtid_b32 v40 offset:62016
    v_pk_mul_f32 v[58:59], v[56:57], v[26:27] op_sel:[0,0] op_sel_hi:[0,1]
    v_pk_fma_f32 v[58:59], v[56:57], v[26:27], v[58:59] op_sel:[1,1,0] op_sel_hi:[1,0,1] neg_lo:[1,0,0]
    v_cvt_pk_bf16_f32 v41, v56, v57
    ds_write_addtid_b32 v41 offset:22848
    v_cvt_pk_bf16_f32 v42, v54, -v55
    ds_write_addtid_b32 v42 offset:63648
    v_cvt_pk_bf16_f32 v43, v58, v59
    ds_write_addtid_b32 v43 offset:24480
    s_branch C_MFMA
C_ROLE1:
    v_mul_f32 v36, 0x43000000, v21
    v_mul_f32 v37, 0x43000000, v22
    v_mul_f32 v38, 0x3f800000, v21
    v_mul_f32 v39, 0x3f800000, v22
    v_exp_f32 v36, v36
    v_fract_f32 v37, v37
    v_exp_f32 v38, v38
    v_fract_f32 v39, v39
    v_fmac_f32 v37, 0x43000000, v23
    v_fmac_f32 v39, 0x3f800000, v23
    v_cos_f32 v26, v37
    v_sin_f32 v27, v37
    v_cos_f32 v28, v39
    v_sin_f32 v29, v39
    v_mul_f32 v26, v26, v36
    v_mul_f32 v27, v27, v36
    v_mul_f32 v28, v28, v38
    v_mul_f32 v29, v29, v38
    v_pk_mul_f32 v[44:45], v[24:25], v[26:27] op_sel:[0,0] op_sel_hi:[0,1]
    v_pk_mul_f32 v[46:47], v[28:29], v[28:29] op_sel:[0,0] op_sel_hi:[0,1]
    v_pk_mul_f32 v[48:49], v[24:25], v[28:29] op_sel:[0,0] op_sel_hi:[0,1]
    v_pk_fma_f32 v[44:45], v[24:25], v[26:27], v[44:45] op_sel:[1,1,0] op_sel_hi:[1,0,1] neg_lo:[1,0,0]
    v_pk_fma_f32 v[46:47], v[28:29], v[28:29], v[46:47] op_sel:[1,1,0] op_sel_hi:[1,0,1] neg_lo:[1,0,0]
    v_pk_fma_f32 v[48:49], v[24:25], v[28:29], v[48:49] op_sel:[1,1,0] op_sel_hi:[1,0,1] neg_lo:[1,0,0]
    v_cvt_pk_bf16_f32 v40, v24, v25
    ds_write_addtid_b32 v40 offset:0
    v_pk_mul_f32 v[50:51], v[44:45], v[26:27] op_sel:[0,0] op_sel_hi:[0,1]
    v_pk_mul_f32 v[52:53], v[44:45], v[28:29] op_sel:[0,0] op_sel_hi:[0,1]
    v_pk_mul_f32 v[54:55], v[48:49], v[28:29] op_sel:[0,0] op_sel_hi:[0,1]
    v_pk_mul_f32 v[62:63], v[46:47], v[46:47] op_sel:[0,0] op_sel_hi:[0,1]
    v_pk_fma_f32 v[50:51], v[44:45], v[26:27], v[50:51] op_sel:[1,1,0] op_sel_hi:[1,0,1] neg_lo:[1,0,0]
    v_pk_fma_f32 v[52:53], v[44:45], v[28:29], v[52:53] op_sel:[1,1,0] op_sel_hi:[1,0,1] neg_lo:[1,0,0]
    v_pk_fma_f32 v[54:55], v[48:49], v[28:29], v[54:55] op_sel:[1,1,0] op_sel_hi:[1,0,1] neg_lo:[1,0,0]
    v_pk_fma_f32 v[62:63], v[46:47], v[46:47], v[62:63] op_sel:[1,1,0] op_sel_hi:[1,0,1] neg_lo:[1,0,0]
    v_cvt_pk_bf16_f32 v41, v44, v45
    ds_write_addtid_b32 v41 offset:14688
    v_cvt_pk_bf16_f32 v42, v48, v49
    ds_write_addtid_b32 v42 offset:1632
    v_pk_mul_f32 v[56:57], v[50:51], v[26:27] op_sel:[0,0] op_sel_hi:[0,1]
    v_pk_mul_f32 v[58:59], v[50:51], v[46:47] op_sel:[0,0] op_sel_hi:[0,1]
    v_pk_mul_f32 v[44:45], v[52:53], v[28:29] op_sel:[0,0] op_sel_hi:[0,1]
    v_pk_mul_f32 v[48:49], v[54:55], v[28:29] op_sel:[0,0] op_sel_hi:[0,1]
    v_pk_fma_f32 v[56:57], v[50:51], v[26:27], v[56:57] op_sel:[1,1,0] op_sel_hi:[1,0,1] neg_lo:[1,0,0]
    v_pk_fma_f32 v[58:59], v[50:51], v[46:47], v[58:59] op_sel:[1,1,0] op_sel_hi:[1,0,1] neg_lo:[1,0,0]
    v_pk_fma_f32 v[44:45], v[52:53], v[28:29], v[44:45] op_sel:[1,1,0] op_sel_hi:[1,0,1] neg_lo:[1,0,0]
    v_pk_fma_f32 v[48:49], v[54:55], v[28:29], v[48:49] op_sel:[1,1,0] op_sel_hi:[1,0,1] neg_lo:[1,0,0]
    v_cvt_pk_bf16_f32 v43, v50, v51
    ds_write_addtid_b32 v43 offset:29376
    v_cvt_pk_bf16_f32 v40, v52, v53
    ds_write_addtid_b32 v40 offset:16320
    v_cvt_pk_bf16_f32 v41, v54, v55
    ds_write_addtid_b32 v41 offset:3264
    v_pk_mul_f32 v[54:55], v[48:49], v[28:29] op_sel:[0,0] op_sel_hi:[0,1]
    v_pk_mul_f32 v[52:53], v[44:45], v[28:29] op_sel:[0,0] op_sel_hi:[0,1]
    v_pk_mul_f32 v[50:51], v[58:59], v[46:47] op_sel:[0,0] op_sel_hi:[0,1]
    v_pk_mul_f32 v[24:25], v[56:57], v[46:47] op_sel:[0,0] op_sel_hi:[0,1]
    v_pk_fma_f32 v[54:55], v[48:49], v[28:29], v[54:55] op_sel:[1,1,0] op_sel_hi:[1,0,1] neg_lo:[1,0,0]
    v_pk_fma_f32 v[52:53], v[44:45], v[28:29], v[52:53] op_sel:[1,1,0] op_sel_hi:[1,0,1] neg_lo:[1,0,0]
    v_pk_fma_f32 v[50:51], v[58:59], v[46:47], v[50:51] op_sel:[1,1,0] op_sel_hi:[1,0,1] neg_lo:[1,0,0]
    v_pk_fma_f32 v[24:25], v[56:57], v[46:47], v[24:25] op_sel:[1,1,0] op_sel_hi:[1,0,1] neg_lo:[1,0,0]
    v_cvt_pk_bf16_f32 v42, v48, v49
    ds_write_addtid_b32 v42 offset:4896
    v_cvt_pk_bf16_f32 v43, v44, v45
    ds_write_addtid_b32 v43 offset:17952
    v_cvt_pk_bf16_f32 v40, v58, v59
    ds_write_addtid_b32 v40 offset:31008
    v_pk_mul_f32 v[48:49], v[54:55], v[28:29] op_sel:[0,0] op_sel_hi:[0,1]
    v_pk_mul_f32 v[44:45], v[52:53], v[28:29] op_sel:[0,0] op_sel_hi:[0,1]
    v_pk_mul_f32 v[58:59], v[50:51], v[46:47] op_sel:[0,0] op_sel_hi:[0,1]
    v_pk_mul_f32 v[56:57], v[24:25], v[46:47] op_sel:[0,0] op_sel_hi:[0,1]
    v_pk_fma_f32 v[48:49], v[54:55], v[28:29], v[48:49] op_sel:[1,1,0] op_sel_hi:[1,0,1] neg_lo:[1,0,0]
    v_pk_fma_f32 v[44:45], v[52:53], v[28:29], v[44:45] op_sel:[1,1,0] op_sel_hi:[1,0,1] neg_lo:[1,0,0]
    v_pk_fma_f32 v[58:59], v[50:51], v[46:47], v[58:59] op_sel:[1,1,0] op_sel_hi:[1,0,1] neg_lo:[1,0,0]
    v_pk_fma_f32 v[56:57], v[24:25], v[46:47], v[56:57] op_sel:[1,1,0] op_sel_hi:[1,0,1] neg_lo:[1,0,0]
    v_cvt_pk_bf16_f32 v41, v54, v55
    ds_write_addtid_b32 v41 offset:6528
    v_cvt_pk_bf16_f32 v42, v52, v53
    ds_write_addtid_b32 v42 offset:19584
    v_cvt_pk_bf16_f32 v43, v50, v51
    ds_write_addtid_b32 v43 offset:32640
    v_cvt_pk_bf16_f32 v40, v24, v25
    ds_write_addtid_b32 v40 offset:40800
    v_pk_mul_f32 v[54:55], v[48:49], v[28:29] op_sel:[0,0] op_sel_hi:[0,1]
    v_pk_mul_f32 v[52:53], v[44:45], v[28:29] op_sel:[0,0] op_sel_hi:[0,1]
    v_pk_mul_f32 v[50:51], v[58:59], v[62:63] op_sel:[0,0] op_sel_hi:[0,1]
    v_pk_mul_f32 v[24:25], v[56:57], v[46:47] op_sel:[0,0] op_sel_hi:[0,1]
    v_pk_mul_f32 v[64:65], v[56:57], v[26:27] op_sel:[0,0] op_sel_hi:[0,1]
    v_pk_fma_f32 v[54:55], v[48:49], v[28:29], v[54:55] op_sel:[1,1,0] op_sel_hi:[1,0,1] neg_lo:[1,0,0]
    v_pk_fma_f32 v[52:53], v[44:45], v[28:29], v[52:53] op_sel:[1,1,0] op_sel_hi:[1,0,1] neg_lo:[1,0,0]
    v_pk_fma_f32 v[50:51], v[58:59], v[62:63], v[50:51] op_sel:[1,1,0] op_sel_hi:[1,0,1] neg_lo:[1,0,0]
    v_pk_fma_f32 v[24:25], v[56:57], v[46:47], v[24:25] op_sel:[1,1,0] op_sel_hi:[1,0,1] neg_lo:[1,0,0]
    v_pk_fma_f32 v[64:65], v[56:57], v[26:27], v[64:65] op_sel:[1,1,0] op_sel_hi:[1,0,1] neg_lo:[1,0,0]
    v_cvt_pk_bf16_f32 v41, v48, v49
    ds_write_addtid_b32 v41 offset:8160
    v_cvt_pk_bf16_f32 v42, v44, v45
    ds_write_addtid_b32 v42 offset:21216
    v_cvt_pk_bf16_f32 v43, v58, v59
    ds_write_addtid_b32 v43 offset:34272
    v_cvt_pk_bf16_f32 v40, v56, v57
    ds_write_addtid_b32 v40 offset:42432
    v_pk_mul_f32 v[48:49], v[54:55], v[28:29] op_sel:[0,0] op_sel_hi:[0,1]
    v_pk_mul_f32 v[44:45], v[52:53], v[28:29] op_sel:[0,0] op_sel_hi:[0,1]
    v_pk_mul_f32 v[56:57], v[24:25], v[62:63] op_sel:[0,0] op_sel_hi:[0,1]
    v_pk_mul_f32 v[66:67], v[64:65], v[26:27] op_sel:[0,0] op_sel_hi:[0,1]
    v_pk_fma_f32 v[48:49], v[54:55], v[28:29], v[48:49] op_sel:[1,1,0] op_sel_hi:[1,0,1] neg_lo:[1,0,0]
    v_pk_fma_f32 v[44:45], v[52:53], v[28:29], v[44:45] op_sel:[1,1,0] op_sel_hi:[1,0,1] neg_lo:[1,0,0]
    v_pk_fma_f32 v[56:57], v[24:25], v[62:63], v[56:57] op_sel:[1,1,0] op_sel_hi:[1,0,1] neg_lo:[1,0,0]
    v_pk_fma_f32 v[66:67], v[64:65], v[26:27], v[66:67] op_sel:[1,1,0] op_sel_hi:[1,0,1] neg_lo:[1,0,0]
    v_cvt_pk_bf16_f32 v41, v54, v55
    ds_write_addtid_b32 v41 offset:9792
    v_cvt_pk_bf16_f32 v42, v52, v53
    ds_write_addtid_b32 v42 offset:22848
    v_cvt_pk_bf16_f32 v43, v50, v51
    ds_write_addtid_b32 v43 offset:37536
    v_cvt_pk_bf16_f32 v40, v24, v25
    ds_write_addtid_b32 v40 offset:44064
    v_cvt_pk_bf16_f32 v41, v64, v65
    ds_write_addtid_b32 v41 offset:48960
    v_pk_mul_f32 v[52:53], v[44:45], v[28:29] op_sel:[0,0] op_sel_hi:[0,1]
    v_pk_mul_f32 v[64:65], v[66:67], v[26:27] op_sel:[0,0] op_sel_hi:[0,1]
    v_pk_fma_f32 v[52:53], v[44:45], v[28:29], v[52:53] op_sel:[1,1,0] op_sel_hi:[1,0,1] neg_lo:[1,0,0]
    v_pk_fma_f32 v[64:65], v[66:67], v[26:27], v[64:65] op_sel:[1,1,0] op_sel_hi:[1,0,1] neg_lo:[1,0,0]
    v_cvt_pk_bf16_f32 v42, v48, v49
    ds_write_addtid_b32 v42 offset:11424
    v_cvt_pk_bf16_f32 v43, v44, v45
    ds_write_addtid_b32 v43 offset:24480
    v_cvt_pk_bf16_f32 v40, v56, v57
    ds_write_addtid_b32 v40 offset:47328
    v_cvt_pk_bf16_f32 v41, v66, v67
    ds_write_addtid_b32 v41 offset:52224
    v_pk_mul_f32 v[66:67], v[64:65], v[26:27] op_sel:[0,0] op_sel_hi:[0,1]
    v_pk_fma_f32 v[66:67], v[64:65], v[26:27], v[66:67] op_sel:[1,1,0] op_sel_hi:[1,0,1] neg_lo:[1,0,0]
    v_cvt_pk_bf16_f32 v42, v52, v53
    ds_write_addtid_b32 v42 offset:26112
    v_cvt_pk_bf16_f32 v43, v64, v65
    ds_write_addtid_b32 v43 offset:62016
    v_cvt_pk_bf16_f32 v40, v66, v67
    ds_write_addtid_b32 v40 offset:65280
C_MFMA:
    s_lshl_b32 s56, s2, 14
    s_lshl_b32 s57, s38, 11
    s_add_u32 s56, s56, s57
    s_add_u32 s56, s56, 57344
    s_sub_u32 s52, s38, 4
    s_lshl_b32 s52, s52, 9
    s_waitcnt lgkmcnt(0)
    s_add_u32 m0, s52, 52032
    s_barrier
    ds_read_b128 v[16:19], v111 offset:0
    ds_read_b128 v[20:23], v110 offset:0
    ds_read_b128 v[24:27], v111 offset:64
    ds_read_b128 v[28:31], v110 offset:64
    ds_read_b128 v[32:35], v111 offset:128
    ds_read_b128 v[36:39], v110 offset:128
    ds_read_b128 v[40:43], v111 offset:192
    ds_read_b128 v[44:47], v110 offset:192
    ds_read_b128 v[48:51], v111 offset:256
    ds_read_b128 v[52:55], v110 offset:256
    ds_read_b128 v[56:59], v111 offset:320
    ds_read_b128 v[60:63], v110 offset:320
    ds_read_b128 v[64:67], v111 offset:384
    ds_read_b128 v[68:71], v110 offset:384
    ds_read_b128 v[72:75], v111 offset:448
    ds_read_b128 v[76:79], v110 offset:448
    ds_read_b32 v167, v167
    ds_write_b32 v113, v112
    s_cmp_eq_u32 s69, 2
    s_cbranch_scc1 C_T2
    v_lshrrev_b32 v89, 1, v6
    v_xor_b32 v88, v89, v6
    v_and_b32 v88, 1, v88
    v_lshlrev_b32 v88, 8, v88
    v_lshl_add_u32 v88, v89, 3, v88
    v_lshl_add_u32 v88, v5, 4, v88
    s_cmp_eq_u32 s69, 1
    s_cbranch_scc1 C_T1
    s_lshr_b32 s52, s69, 1
    s_mul_i32 s53, s52, 1600
    s_add_u32 s53, s53, s67
    v_add_u32 v88, s53, v88
    v_add_u32 v89, 3200, v88
    s_xor_b32 s52, s52, 1
    s_mov_b32 s53, 0
    s_waitcnt lgkmcnt(15)
    v_mfma_f32_16x16x32_bf16 v[80:83], v[16:19], v[20:23], 0
    s_waitcnt lgkmcnt(14)
    v_mfma_f32_16x16x32_bf16 v[84:87], v[24:27], v[28:31], 0
    s_waitcnt lgkmcnt(12)
    v_mfma_f32_16x16x32_bf16 v[80:83], v[32:35], v[36:39], v[80:83]
    s_waitcnt lgkmcnt(10)
    v_mfma_f32_16x16x32_bf16 v[84:87], v[40:43], v[44:47], v[84:87]
    s_waitcnt lgkmcnt(8)
    v_mfma_f32_16x16x32_bf16 v[80:83], v[48:51], v[52:55], v[80:83]
    s_waitcnt lgkmcnt(6)
    v_mfma_f32_16x16x32_bf16 v[84:87], v[56:59], v[60:63], v[84:87]
    s_waitcnt lgkmcnt(4)
    v_mfma_f32_16x16x32_bf16 v[80:83], v[64:67], v[68:71], v[80:83]
    s_waitcnt lgkmcnt(2)
    v_mfma_f32_16x16x32_bf16 v[84:87], v[72:75], v[76:79], v[84:87]
    s_waitcnt lgkmcnt(1)
    v_readfirstlane_b32 s39, v167
    s_nop 5
    v_pk_add_f32 v[80:81], v[80:81], v[84:85]
    v_pk_add_f32 v[82:83], v[82:83], v[86:87]
    v_cvt_pk_bf16_f32 v80, v80, v81
    v_cvt_pk_bf16_f32 v81, v82, v83
    ds_write_b64 v88, v[80:81] offset:32
    ds_write2_b32 v89, v80, v81 offset0:7 offset1:8
    s_mov_b64 exec, s[52:53]
    ds_write_b16 v88, v80 offset:1630
    ds_write_b16 v88, v80 offset:4826
    s_mov_b64 exec, -1
    s_branch C_B3
C_T1:
    s_add_u32 s53, s67, 544
    v_add_u32 v88, s53, v88
    v_add_u32 v89, 1600, v88
    s_waitcnt lgkmcnt(15)
    v_mfma_f32_16x16x32_bf16 v[80:83], v[16:19], v[20:23], 0
    s_waitcnt lgkmcnt(14)
    v_mfma_f32_16x16x32_bf16 v[84:87], v[24:27], v[28:31], 0
    s_waitcnt lgkmcnt(12)
    v_mfma_f32_16x16x32_bf16 v[80:83], v[32:35], v[36:39], v[80:83]
    s_waitcnt lgkmcnt(10)
    v_mfma_f32_16x16x32_bf16 v[84:87], v[40:43], v[44:47], v[84:87]
    s_waitcnt lgkmcnt(8)
    v_mfma_f32_16x16x32_bf16 v[80:83], v[48:51], v[52:55], v[80:83]
    s_waitcnt lgkmcnt(6)
    v_mfma_f32_16x16x32_bf16 v[84:87], v[56:59], v[60:63], v[84:87]
    s_waitcnt lgkmcnt(4)
    v_mfma_f32_16x16x32_bf16 v[80:83], v[64:67], v[68:71], v[80:83]
    s_waitcnt lgkmcnt(2)
    v_mfma_f32_16x16x32_bf16 v[84:87], v[72:75], v[76:79], v[84:87]
    s_waitcnt lgkmcnt(1)
    v_readfirstlane_b32 s39, v167
    s_nop 5
    v_pk_add_f32 v[80:81], v[80:81], v[84:85]
    v_pk_add_f32 v[82:83], v[82:83], v[86:87]
    v_cvt_pk_bf16_f32 v16, v81, v82
    v_cvt_pk_bf16_f32 v17, v82, v82
    v_cvt_pk_bf16_f32 v18, v82, v82
    v_cvt_pk_bf16_f32 v19, v82, v83
    ds_write2_b32 v88, v16, v17 offset0:1 offset1:2
    ds_write_b64 v88, v[16:17] offset:3200
    ds_write2_b32 v89, v18, v19 offset0:1 offset1:2
    ds_write_b64 v88, v[18:19] offset:4800
    v_cvt_pk_bf16_f32 v20, v80, v80
    v_cvt_pk_bf16_f32 v21, v80, v81
    s_mov_b64 exec, 0x1
    ds_write_b32 v88, v20
    ds_write_b32 v88, v20 offset:3196
    ds_write_b32 v88, v21 offset:1600
    ds_write_b32 v88, v21 offset:4796
    s_mov_b32 exec_lo, 0x0
    s_mov_b32 exec_hi, 0x8000
    ds_write_b16 v88, v17 offset:12
    ds_write_b16 v88, v17 offset:1610
    ds_write_b16 v88, v17 offset:3208
    ds_write_b16 v88, v17 offset:4806
    s_mov_b64 exec, -1
    s_branch C_B3
C_T2:
    v_lshlrev_b32 v88, 7, v6
    v_lshl_add_u32 v89, v5, 1, v88
    v_lshl_add_u32 v88, v5, 2, v88
    s_add_u32 s52, s64, 4728
    v_add_u32 v88, s52, v88
    s_add_u32 s52, s64, 4920
    v_add_u32 v89, s52, v89
    v_mov_b32 v90, s67
    s_waitcnt lgkmcnt(15)
    v_mfma_f32_16x16x32_bf16 v[80:83], v[16:19], v[20:23], 0
    s_waitcnt lgkmcnt(14)
    v_mfma_f32_16x16x32_bf16 v[84:87], v[24:27], v[28:31], 0
    s_waitcnt lgkmcnt(12)
    v_mfma_f32_16x16x32_bf16 v[80:83], v[32:35], v[36:39], v[80:83]
    s_waitcnt lgkmcnt(10)
    v_mfma_f32_16x16x32_bf16 v[84:87], v[40:43], v[44:47], v[84:87]
    s_waitcnt lgkmcnt(8)
    v_mfma_f32_16x16x32_bf16 v[80:83], v[48:51], v[52:55], v[80:83]
    s_waitcnt lgkmcnt(6)
    v_mfma_f32_16x16x32_bf16 v[84:87], v[56:59], v[60:63], v[84:87]
    s_waitcnt lgkmcnt(4)
    v_mfma_f32_16x16x32_bf16 v[80:83], v[64:67], v[68:71], v[80:83]
    s_waitcnt lgkmcnt(2)
    v_mfma_f32_16x16x32_bf16 v[84:87], v[72:75], v[76:79], v[84:87]
    s_waitcnt lgkmcnt(1)
    v_readfirstlane_b32 s39, v167
    s_nop 5
    v_pk_add_f32 v[80:81], v[80:81], v[84:85]
    v_pk_add_f32 v[82:83], v[82:83], v[86:87]
    v_cvt_pk_bf16_f32 v80, v80, v81
    v_cvt_pk_bf16_f32 v81, v82, v83
    s_mov_b32 exec_hi, 0
    ds_write2_b32 v88, v80, v81 offset0:0 offset1:16
    s_not_b64 exec, exec
    ds_write_b16 v89, v80 offset:4
    ds_write_b16_d16_hi v89, v80 offset:36
    ds_write_b16 v89, v81 offset:68
    ds_write_b16_d16_hi v89, v81 offset:100
    ds_write_b16 v89, v80 offset:384
    ds_write_b16_d16_hi v89, v80 offset:416
    ds_write_b16 v89, v81 offset:448
    ds_write_b16_d16_hi v89, v81 offset:480
    s_mov_b32 exec_lo, 0x80000000
    s_mov_b32 exec_hi, 0x0
    ds_write_b16_d16_hi v90, v81 offset:1126
    ds_write_b16_d16_hi v90, v81 offset:1128
    ds_write_b16_d16_hi v90, v81 offset:2724
    ds_write_b16_d16_hi v90, v81 offset:2726
    ds_write_b16_d16_hi v90, v81 offset:4322
    ds_write_b16_d16_hi v90, v81 offset:4324
    ds_write_b16_d16_hi v90, v81 offset:5920
    ds_write_b16_d16_hi v90, v81 offset:5922
    s_mov_b64 exec, -1
C_B3:
    s_cmp_lt_u32 s38, 4
    s_cbranch_scc1 C_NOUL
    buffer_load_dwordx4 v[120:123], v3, s[40:43], s56 offen sc1
    buffer_load_dwordx4 v[124:127], v3, s[40:43], s56 offen offset:1024 sc1
C_NOUL:
    s_waitcnt lgkmcnt(0)
    s_barrier
    s_cmp_eq_u32 s63, 1
    s_cbranch_scc1 C_E1
    s_cmp_eq_u32 s63, 2
    s_cbranch_scc1 C_E2
    s_cmp_eq_u32 s63, 3
    s_cbranch_scc1 C_E3
    ds_read_b64 v[112:113], v7 offset:1152
    ds_read_b64 v[114:115], v7 offset:1160
    ds_read_b64 v[116:117], v7 offset:1216
    ds_read_b64 v[118:119], v7 offset:1224
    ds_read_b64 v[128:129], v7 offset:1280
    ds_read_b64 v[130:131], v7 offset:1288
    ds_read_b64 v[132:133], v7 offset:1344
    ds_read_b64 v[134:135], v7 offset:1352
    ds_read_b64 v[48:49], v7 offset:0
    ds_read_b64 v[50:51], v7 offset:8
    ds_read_b64 v[52:53], v7 offset:64
    ds_read_b64 v[54:55], v7 offset:72
    ds_read_b64 v[56:57], v7 offset:128
    ds_read_b64 v[58:59], v7 offset:136
    ds_read_b64 v[60:61], v7 offset:192
    ds_read_b64 v[62:63], v7 offset:200
    ds_read_b64 v[64:65], v7 offset:256
    ds_read_b64 v[66:67], v7 offset:264
    ds_read_b64 v[68:69], v7 offset:320
    ds_read_b64 v[70:71], v7 offset:328
    ds_read_b64 v[72:73], v7 offset:384
    ds_read_b64 v[74:75], v7 offset:392
    ds_read_b64 v[76:77], v7 offset:448
    ds_read_b64 v[78:79], v7 offset:456
    ds_read_b64 v[80:81], v7 offset:512
    ds_read_b64 v[82:83], v7 offset:520
    ds_read_b64 v[84:85], v7 offset:576
    ds_read_b64 v[86:87], v7 offset:584
    ds_read_b64 v[88:89], v7 offset:640
    ds_read_b64 v[90:91], v7 offset:648
    ds_read_b64 v[92:93], v7 offset:704
    ds_read_b64 v[94:95], v7 offset:712
    ds_read_b64 v[96:97], v7 offset:768
    ds_read_b64 v[98:99], v7 offset:776
    ds_read_b64 v[100:101], v7 offset:832
    ds_read_b64 v[102:103], v7 offset:840
    ds_read_b64 v[104:105], v7 offset:896
    ds_read_b64 v[106:107], v7 offset:904
    ds_read_b64 v[108:109], v7 offset:960
    ds_read_b64 v[110:111], v7 offset:968
    s_bitcmp1_b32 s2, 0
    s_addc_u32 s51, s62, 0
    s_cmp_eq_u32 s51, 3
    s_cselect_b32 s51, 0, s51
    s_and_b32 s52, s2, 1
    s_add_u32 s52, s52, s51
    s_lshl_b32 s52, s52, 1
    s_add_u32 s52, s52, 142672
    v_mov_b32 v16, s52
    v_mov_b32 v164, 0
    ds_read_u16_d16_hi v164, v16
    s_add_u32 s52, s61, 3576
    v_and_b32 v165, 1, v5
    v_lshl_add_u32 v165, v6, 1, v165
    s_mul_i32 s53, s62, 384
    s_add_u32 s53, s53, 161920
    v_lshl_add_u32 v165, v165, 4, s53
    v_lshlrev_b32 v2, 3, v2
    v_sub_u32 v2, s52, v2
    s_mul_i32 s68, s62, 4352
    s_add_u32 s68, s68, 41472
    v_lshl_add_u32 v15, v15, 3, s68
    v_mov_b32 v10, 0
    s_branch C_EE
C_E1:
    s_bitcmp1_b32 s2, 0
    s_addc_u32 s51, s62, 0
    s_cmp_eq_u32 s51, 3
    s_cselect_b32 s51, 0, s51
    s_and_b32 s52, s2, 1
    s_add_u32 s52, s52, s51
    s_lshl_b32 s52, s52, 1
    s_add_u32 s52, s52, 142672
    v_mov_b32 v16, s52
    v_mov_b32 v164, 0
    ds_read_u16_d16_hi v164, v16
    s_add_u32 s52, s61, 2552
    v_and_b32 v165, 1, v5
    v_lshl_add_u32 v165, v6, 1, v165
    s_mul_i32 s53, s62, 384
    s_add_u32 s53, s53, 161920
    v_lshl_add_u32 v165, v165, 4, s53
    v_lshlrev_b32 v2, 3, v2
    v_sub_u32 v2, s52, v2
    s_mul_i32 s68, s62, 4352
    s_add_u32 s68, s68, 42560
    v_lshl_add_u32 v15, v15, 3, s68
    v_and_b32 v17, 3, v5
    v_lshl_add_u32 v18, v6, 3, v11
    v_and_b32 v16, 1, v11
    v_mul_u32_u24 v16, 3456, v16
    v_add_u32 v16, s59, v16
    v_sub_u32 v17, v17, v18
    v_sub_u32 v18, v17, v18
    v_add_u32 v19, 44, v17
    v_lshrrev_b32 v20, 4, v19
    v_add_u32 v19, v19, v20
    v_lshl_add_u32 v11, v19, 3, v16
    v_add_u32 v19, 40, v17
    v_lshrrev_b32 v20, 4, v19
    v_add_u32 v19, v19, v20
    v_lshl_add_u32 v12, v19, 3, v16
    ds_read_b64 v[128:129], v7 offset:1152
    ds_read_b64 v[130:131], v7 offset:1160
    ds_read_b64 v[132:133], v7 offset:1216
    ds_read_b64 v[134:135], v7 offset:1224
    ds_read_b64 v[136:137], v7 offset:1280
    ds_read_b64 v[138:139], v7 offset:1288
    ds_read_b64 v[140:141], v7 offset:1344
    ds_read_b64 v[142:143], v7 offset:1352
    ds_read_b64 v[48:49], v7 offset:0
    ds_read_b64 v[50:51], v7 offset:8
    ds_read_b64 v[52:53], v7 offset:64
    ds_read_b64 v[54:55], v7 offset:72
    ds_read_b64 v[56:57], v7 offset:128
    ds_read_b64 v[58:59], v7 offset:136
    ds_read_b64 v[60:61], v7 offset:192
    ds_read_b64 v[62:63], v7 offset:200
    ds_read_b64 v[64:65], v7 offset:256
    ds_read_b64 v[66:67], v7 offset:264
    ds_read_b64 v[68:69], v7 offset:320
    ds_read_b64 v[70:71], v7 offset:328
    ds_read_b64 v[72:73], v7 offset:384
    ds_read_b64 v[74:75], v7 offset:392
    ds_read_b64 v[76:77], v7 offset:448
    ds_read_b64 v[78:79], v7 offset:456
    ds_read_b64 v[80:81], v7 offset:512
    ds_read_b64 v[82:83], v7 offset:520
    ds_read_b64 v[84:85], v7 offset:576
    ds_read_b64 v[86:87], v7 offset:584
    ds_read_b64 v[88:89], v7 offset:640
    ds_read_b64 v[90:91], v7 offset:648
    ds_read_b64 v[92:93], v7 offset:704
    ds_read_b64 v[94:95], v7 offset:712
    ds_read_b64 v[96:97], v7 offset:768
    ds_read_b64 v[98:99], v7 offset:776
    ds_read_b64 v[100:101], v7 offset:832
    ds_read_b64 v[102:103], v7 offset:840
    ds_read_b64 v[104:105], v7 offset:896
    ds_read_b64 v[106:107], v7 offset:904
    ds_read_b64 v[108:109], v7 offset:960
    ds_read_b64 v[110:111], v7 offset:968
    ds_read_b64 v[112:113], v7 offset:1024
    ds_read_b64 v[114:115], v7 offset:1032
    s_branch C_EE
C_E2:
    s_bitcmp1_b32 s2, 0
    s_addc_u32 s51, s62, 0
    s_cmp_eq_u32 s51, 3
    s_cselect_b32 s51, 0, s51
    s_and_b32 s52, s2, 1
    s_add_u32 s52, s52, s51
    s_lshl_b32 s52, s52, 1
    s_add_u32 s52, s52, 142672
    v_mov_b32 v16, s52
    v_mov_b32 v164, 0
    ds_read_u16_d16_hi v164, v16
    s_add_u32 s52, s61, 1528
    v_and_b32 v165, 1, v5
    v_lshl_add_u32 v165, v6, 1, v165
    s_mul_i32 s53, s62, 384
    s_add_u32 s53, s53, 161920
    v_lshl_add_u32 v165, v165, 4, s53
    v_lshlrev_b32 v2, 3, v2
    v_sub_u32 v2, s52, v2
    s_mul_i32 s68, s62, 4352
    s_add_u32 s68, s68, 43648
    v_lshl_add_u32 v15, v15, 3, s68
    v_and_b32 v17, 3, v5
    v_lshl_add_u32 v18, v6, 3, v11
    v_and_b32 v16, 1, v11
    v_mul_u32_u24 v16, 3456, v16
    v_add_u32 v16, s59, v16
    v_sub_u32 v17, v17, v18
    v_sub_u32 v18, v17, v18
    v_add_u32 v19, 44, v17
    v_lshrrev_b32 v20, 4, v19
    v_add_u32 v19, v19, v20
    v_lshl_add_u32 v11, v19, 3, v16
    v_add_u32 v19, 75, v18
    v_lshrrev_b32 v20, 4, v19
    v_add_u32 v19, v19, v20
    v_lshl_add_u32 v13, v19, 3, v16
    v_add_u32 v19, 40, v17
    v_lshrrev_b32 v20, 4, v19
    v_add_u32 v19, v19, v20
    v_lshl_add_u32 v12, v19, 3, v16
    v_add_u32 v19, 67, v18
    v_lshrrev_b32 v20, 4, v19
    v_add_u32 v19, v19, v20
    v_lshl_add_u32 v14, v19, 3, v16
    ds_read_b64 v[152:153], v7 offset:1152
    ds_read_b64 v[154:155], v7 offset:1160
    ds_read_b64 v[156:157], v7 offset:1216
    ds_read_b64 v[158:159], v7 offset:1224
    ds_read_b64 v[48:49], v7 offset:0
    ds_read_b64 v[50:51], v7 offset:8
    ds_read_b64 v[52:53], v7 offset:64
    ds_read_b64 v[54:55], v7 offset:72
    ds_read_b64 v[56:57], v7 offset:128
    ds_read_b64 v[58:59], v7 offset:136
    ds_read_b64 v[60:61], v7 offset:192
    ds_read_b64 v[62:63], v7 offset:200
    ds_read_b64 v[64:65], v7 offset:256
    ds_read_b64 v[66:67], v7 offset:264
    ds_read_b64 v[68:69], v7 offset:320
    ds_read_b64 v[70:71], v7 offset:328
    ds_read_b64 v[72:73], v7 offset:384
    ds_read_b64 v[74:75], v7 offset:392
    ds_read_b64 v[76:77], v7 offset:448
    ds_read_b64 v[78:79], v7 offset:456
    ds_read_b64 v[80:81], v7 offset:512
    ds_read_b64 v[82:83], v7 offset:520
    ds_read_b64 v[84:85], v7 offset:576
    ds_read_b64 v[86:87], v7 offset:584
    ds_read_b64 v[88:89], v7 offset:640
    ds_read_b64 v[90:91], v7 offset:648
    ds_read_b64 v[92:93], v7 offset:704
    ds_read_b64 v[94:95], v7 offset:712
    ds_read_b64 v[96:97], v7 offset:768
    ds_read_b64 v[98:99], v7 offset:776
    ds_read_b64 v[100:101], v7 offset:832
    ds_read_b64 v[102:103], v7 offset:840
    ds_read_b64 v[104:105], v7 offset:896
    ds_read_b64 v[106:107], v7 offset:904
    ds_read_b64 v[108:109], v7 offset:960
    ds_read_b64 v[110:111], v7 offset:968
    ds_read_b64 v[112:113], v7 offset:1024
    ds_read_b64 v[114:115], v7 offset:1032
    ds_read_b64 v[128:129], v9 offset:4608
    ds_read_b64 v[130:131], v9 offset:4616
    ds_read_b64 v[132:133], v9 offset:4672
    ds_read_b64 v[134:135], v9 offset:4680
    ds_read_b64 v[136:137], v9 offset:4736
    ds_read_b64 v[138:139], v9 offset:4744
    ds_read_b64 v[140:141], v9 offset:4800
    ds_read_b64 v[142:143], v9 offset:4808
    ds_read_b64 v[144:145], v9 offset:4864
    ds_read_b64 v[146:147], v9 offset:4872
    ds_read_b64 v[148:149], v9 offset:4928
    ds_read_b64 v[150:151], v9 offset:4936
    s_branch C_EE
C_E3:
    s_bitcmp1_b32 s2, 0
    s_addc_u32 s51, s62, 0
    s_cmp_eq_u32 s51, 3
    s_cselect_b32 s51, 0, s51
    s_and_b32 s52, s2, 1
    s_add_u32 s52, s52, s51
    s_lshl_b32 s52, s52, 1
    s_add_u32 s52, s52, 142672
    v_mov_b32 v16, s52
    v_mov_b32 v164, 0
    ds_read_u16_d16_hi v164, v16
    s_add_u32 s52, s61, 504
    v_and_b32 v165, 1, v5
    v_lshl_add_u32 v165, v6, 1, v165
    s_mul_i32 s53, s62, 384
    s_add_u32 s53, s53, 161920
    v_lshl_add_u32 v165, v165, 4, s53
    v_lshlrev_b32 v2, 3, v2
    v_sub_u32 v2, s52, v2
    s_mul_i32 s68, s62, 4352
    s_add_u32 s68, s68, 44736
    v_lshl_add_u32 v15, v15, 3, s68
    v_and_b32 v17, 3, v5
    v_lshl_add_u32 v18, v6, 3, v11
    v_and_b32 v16, 1, v11
    v_mul_u32_u24 v16, 3456, v16
    v_add_u32 v16, s59, v16
    v_sub_u32 v17, v17, v18
    v_sub_u32 v18, v17, v18
    v_add_u32 v19, 44, v17
    v_lshrrev_b32 v20, 4, v19
    v_add_u32 v19, v19, v20
    v_lshl_add_u32 v11, v19, 3, v16
    v_add_u32 v19, 75, v18
    v_lshrrev_b32 v20, 4, v19
    v_add_u32 v19, v19, v20
    v_lshl_add_u32 v13, v19, 3, v16
    v_add_u32 v19, 40, v17
    v_lshrrev_b32 v20, 4, v19
    v_add_u32 v19, v19, v20
    v_lshl_add_u32 v12, v19, 3, v16
    v_add_u32 v19, 67, v18
    v_lshrrev_b32 v20, 4, v19
    v_add_u32 v19, v19, v20
    v_lshl_add_u32 v14, v19, 3, v16
    ds_read_b64 v[48:49], v7 offset:0
    ds_read_b64 v[50:51], v7 offset:8
    ds_read_b64 v[52:53], v7 offset:64
    ds_read_b64 v[54:55], v7 offset:72
    ds_read_b64 v[56:57], v7 offset:128
    ds_read_b64 v[58:59], v7 offset:136
    ds_read_b64 v[60:61], v7 offset:192
    ds_read_b64 v[62:63], v7 offset:200
    ds_read_b64 v[64:65], v7 offset:256
    ds_read_b64 v[66:67], v7 offset:264
    ds_read_b64 v[68:69], v7 offset:320
    ds_read_b64 v[70:71], v7 offset:328
    ds_read_b64 v[72:73], v7 offset:384
    ds_read_b64 v[74:75], v7 offset:392
    ds_read_b64 v[76:77], v7 offset:448
    ds_read_b64 v[78:79], v7 offset:456
    ds_read_b64 v[80:81], v7 offset:512
    ds_read_b64 v[82:83], v7 offset:520
    ds_read_b64 v[84:85], v7 offset:576
    ds_read_b64 v[86:87], v7 offset:584
    ds_read_b64 v[88:89], v7 offset:640
    ds_read_b64 v[90:91], v7 offset:648
    ds_read_b64 v[92:93], v7 offset:704
    ds_read_b64 v[94:95], v7 offset:712
    ds_read_b64 v[96:97], v7 offset:768
    ds_read_b64 v[98:99], v7 offset:776
    ds_read_b64 v[100:101], v7 offset:832
    ds_read_b64 v[102:103], v7 offset:840
    ds_read_b64 v[104:105], v7 offset:896
    ds_read_b64 v[106:107], v7 offset:904
    ds_read_b64 v[108:109], v7 offset:960
    ds_read_b64 v[110:111], v7 offset:968
    ds_read_b64 v[112:113], v7 offset:1024
    ds_read_b64 v[114:115], v7 offset:1032
    ds_read_b64 v[116:117], v7 offset:1088
    ds_read_b64 v[118:119], v7 offset:1096
    ds_read_b64 v[128:129], v9 offset:4608
    ds_read_b64 v[130:131], v9 offset:4616
    ds_read_b64 v[132:133], v9 offset:4672
    ds_read_b64 v[134:135], v9 offset:4680
    ds_read_b64 v[136:137], v9 offset:4736
    ds_read_b64 v[138:139], v9 offset:4744
    ds_read_b64 v[140:141], v9 offset:4800
    ds_read_b64 v[142:143], v9 offset:4808
    ds_read_b64 v[144:145], v9 offset:4864
    ds_read_b64 v[146:147], v9 offset:4872
    ds_read_b64 v[148:149], v9 offset:4928
    ds_read_b64 v[150:151], v9 offset:4936
    ds_read_b64 v[152:153], v10 offset:5120
    ds_read_b64 v[154:155], v10 offset:5128
    ds_read_b64 v[156:157], v10 offset:5184
    ds_read_b64 v[158:159], v10 offset:5192
C_EE:
    s_cmp_ge_u32 s38, 4
    s_cbranch_scc1 C_UPOLL
    s_cmp_ge_u32 s38, 2
    s_cbranch_scc1 C_B5
    v_lshrrev_b32 v18, 3, v0
    v_mul_u32_u24 v18, 3328, v18
    v_lshl_add_u32 v18, v0, 4, v18
    v_lshlrev_b32 v19, 4, v0
    v_add_u32 v19, 159872, v19
    s_movk_i32 s52, 0x60
    v_cmp_gt_u32 s[50:51], s52, v0
    s_nop 1
    v_cndmask_b32 v18, v19, v18, s[50:51]
    s_movk_i32 s52, 0x78
    v_cmp_gt_u32 vcc, s52, v0
    s_nop 0
    s_and_saveexec_b64 s[50:51], vcc
    ds_write_b128 v18, v[160:163]
    s_mov_b64 exec, s[50:51]
    s_branch C_B5
C_UPOLL:
    s_movk_i32 s60, 4000
    s_branch C_UP_W
C_UP:
    buffer_load_dwordx4 v[120:123], v3, s[40:43], s56 offen sc1
    buffer_load_dwordx4 v[124:127], v3, s[40:43], s56 offen offset:1024 sc1
C_UP_W:
    s_waitcnt vmcnt(0)
    v_xor_b32 v16, v167, v123
    v_xor_b32 v17, v167, v127
    v_or_b32 v16, v16, v17
    v_cmp_ne_u32 vcc, 0, v16
    s_nop 0
    s_and_b64 exec, exec, vcc
    s_cbranch_execz C_UP_D
    s_sub_u32 s60, s60, 1
    s_cmp_gt_i32 s60, 0
    s_sleep 1
    s_cbranch_scc1 C_UP
C_UP_D:
    s_mov_b64 exec, -1
    ds_write_addtid_b32 v120 offset:49152
    ds_write_addtid_b32 v121 offset:55040
    ds_write_addtid_b32 v122 offset:60928
    ds_write_addtid_b32 v124 offset:49408
    ds_write_addtid_b32 v125 offset:55296
    ds_write_addtid_b32 v126 offset:61184
    s_cmp_ge_u32 s50, 144
    s_cbranch_scc1 C_B5
    v_mov_b32 v16, -1
    v_mov_b32 v17, -1
    v_mov_b32 v18, -1
    v_mov_b32 v19, -1
    v_lshlrev_b32 v20, 4, v0
    v_lshlrev_b32 v21, 1, v0
    buffer_store_dwordx4 v[16:19], v20, s[40:43], s48 offen sc1
    buffer_store_short v16, v21, s[40:43], s49 offen sc1
C_B5:
    s_waitcnt lgkmcnt(0)
    s_barrier
    s_movk_i32 s60, 4000
    s_cmp_eq_u32 s63, 1
    s_cbranch_scc1 C_P1
    s_cmp_eq_u32 s63, 2
    s_cbranch_scc1 C_P2
    s_cmp_eq_u32 s63, 3
    s_cbranch_scc1 C_P3
    s_setprio 3
    ds_read_b128 v[32:35], v8 offset:3552
    ds_read_b128 v[36:39], v8 offset:4064
    ds_read_b128 v[40:43], v8 offset:3680
    s_waitcnt lgkmcnt(2)
    v_mfma_f32_16x16x32_bf16 v[136:139], v[112:115], v[32:35], 0
    v_mfma_f32_16x16x32_bf16 v[140:143], v[116:119], v[32:35], 0
    v_mfma_f32_16x16x32_bf16 v[144:147], v[128:131], v[32:35], 0
    v_mfma_f32_16x16x32_bf16 v[148:151], v[132:135], v[32:35], 0
    v_mfma_f32_16x16x32_bf16 v[28:31], v[52:55], v[32:35], 0
    v_mfma_f32_16x16x32_bf16 v[20:23], v[48:51], v[32:35], 0
    ds_read_b128 v[44:47], v8 offset:3808
    s_waitcnt lgkmcnt(2)
    v_mfma_f32_16x16x32_bf16 v[152:155], v[112:115], v[36:39], 0
    v_mfma_f32_16x16x32_bf16 v[156:159], v[116:119], v[36:39], 0
    v_mfma_f32_16x16x32_bf16 v[120:123], v[128:131], v[36:39], 0
    v_mfma_f32_16x16x32_bf16 v[124:127], v[132:135], v[36:39], 0
    v_mfma_f32_16x16x32_bf16 v[28:31], v[84:87], v[36:39], v[28:31]
    v_mfma_f32_16x16x32_bf16 v[20:23], v[80:83], v[36:39], v[20:23]
    v_mfma_f32_16x16x32_bf16 v[24:27], v[52:55], v[36:39], 0
    v_mfma_f32_16x16x32_bf16 v[16:19], v[48:51], v[36:39], 0
    v_cvt_pk_bf16_f32 v136, v136, v137
    v_cvt_pk_bf16_f32 v137, v138, v139
    ds_write_b64 v4, v[136:137] offset:680
    v_cvt_pk_bf16_f32 v140, v140, v141
    v_cvt_pk_bf16_f32 v141, v142, v143
    ds_write_b64 v4, v[140:141] offset:4136
    v_cvt_pk_bf16_f32 v144, v144, v145
    v_cvt_pk_bf16_f32 v145, v146, v147
    ds_write_b64 v4, v[144:145] offset:7592
    v_cvt_pk_bf16_f32 v148, v148, v149
    v_cvt_pk_bf16_f32 v149, v150, v151
    ds_write_b64 v4, v[148:149] offset:11048
    ds_read_b128 v[32:35], v8 offset:3936
    s_waitcnt lgkmcnt(6)
    v_mfma_f32_16x16x32_bf16 v[28:31], v[60:63], v[40:43], v[28:31]
    v_mfma_f32_16x16x32_bf16 v[20:23], v[56:59], v[40:43], v[20:23]
    v_cvt_pk_bf16_f32 v152, v152, v153
    v_cvt_pk_bf16_f32 v153, v154, v155
    ds_write_b64 v4, v[152:153] offset:136
    v_cvt_pk_bf16_f32 v156, v156, v157
    v_cvt_pk_bf16_f32 v157, v158, v159
    ds_write_b64 v4, v[156:157] offset:3592
    v_cvt_pk_bf16_f32 v120, v120, v121
    v_cvt_pk_bf16_f32 v121, v122, v123
    ds_write_b64 v4, v[120:121] offset:7048
    v_cvt_pk_bf16_f32 v124, v124, v125
    v_cvt_pk_bf16_f32 v125, v126, v127
    ds_write_b64 v4, v[124:125] offset:10504
    s_mov_b64 exec, 0x1
    ds_write_b32 v166, v166 offset:0
    s_mov_b64 exec, -1
    s_setprio 2
    ds_read_b128 v[84:87], v8 offset:4192
    s_or_b32 s52, s38, s2
    s_cbranch_scc1 C_NOEP
    s_mov_b64 exec, 0x1
    buffer_store_dword v167, v10, s[40:43], 0 offen sc1
    s_mov_b64 exec, -1
C_NOEP:
    s_cmp_ge_u32 s38, 4
    s_cbranch_scc1 C_NPF30
    s_mov_b32 m0, 163328
    s_mov_b32 exec_lo, 0xffffffff
    s_mov_b32 exec_hi, 0x3fffff
    global_load_lds_dword v14, s[28:29]
    s_mov_b32 exec_lo, 0x4020100
    s_mov_b32 exec_hi, 0x201008
    global_load_lds_dword v13, s[30:31]
    s_mov_b32 exec_lo, 0x4020100
    s_mov_b32 exec_hi, 0x201008
    global_load_lds_dword v14, s[26:27]
    s_mov_b64 exec, -1
C_NPF30:
    ds_read_b64 v[160:161], v2 offset:512
    ds_read_b64 v[162:163], v2
    s_waitcnt lgkmcnt(13)
    v_mfma_f32_16x16x32_bf16 v[28:31], v[68:71], v[44:47], v[28:31]
    v_mfma_f32_16x16x32_bf16 v[20:23], v[64:67], v[44:47], v[20:23]
    ds_read_b128 v[80:83], v8 offset:4320
    s_waitcnt lgkmcnt(9)
    v_mfma_f32_16x16x32_bf16 v[28:31], v[76:79], v[32:35], v[28:31]
    v_mfma_f32_16x16x32_bf16 v[20:23], v[72:75], v[32:35], v[20:23]
    ds_read_b128 v[36:39], v8 offset:4448
    s_waitcnt lgkmcnt(2)
    s_setprio 0
    v_and_b32 v48, 0xffff0000, v161
    v_lshlrev_b32 v49, 16, v161
    v_and_b32 v50, 0xffff0000, v160
    v_lshlrev_b32 v51, 16, v160
    v_mul_f32 v48, v48, v164
    v_mul_f32 v49, v49, v164
    v_mul_f32 v50, v50, v164
    v_mul_f32 v51, v51, v164
    v_cvt_pk_bf16_f32 v49, v48, v49
    v_lshlrev_b32 v48, 16, v49
    v_and_b32 v49, 0xffff0000, v49
    v_cvt_pk_bf16_f32 v51, v50, v51
    v_lshlrev_b32 v50, 16, v51
    v_and_b32 v51, 0xffff0000, v51
    v_and_b32 v52, 0xffff0000, v163
    v_lshlrev_b32 v53, 16, v163
    v_and_b32 v54, 0xffff0000, v162
    v_lshlrev_b32 v55, 16, v162
    v_mul_f32 v52, v52, v164
    v_mul_f32 v53, v53, v164
    v_mul_f32 v54, v54, v164
    v_mul_f32 v55, v55, v164
    v_cvt_pk_bf16_f32 v53, v52, v53
    v_lshlrev_b32 v52, 16, v53
    v_and_b32 v53, 0xffff0000, v53
    v_cvt_pk_bf16_f32 v55, v54, v55
    v_lshlrev_b32 v54, 16, v55
    v_and_b32 v55, 0xffff0000, v55
    s_setprio 2
    v_mfma_f32_16x16x32_bf16 v[28:31], v[92:95], v[84:87], v[28:31]
    v_mfma_f32_16x16x32_bf16 v[20:23], v[88:91], v[84:87], v[20:23]
    v_mfma_f32_16x16x32_bf16 v[24:27], v[60:63], v[84:87], v[24:27]
    v_mfma_f32_16x16x32_bf16 v[16:19], v[56:59], v[84:87], v[16:19]
    s_waitcnt lgkmcnt(1)
    v_mfma_f32_16x16x32_bf16 v[28:31], v[100:103], v[80:83], v[28:31]
    v_mfma_f32_16x16x32_bf16 v[20:23], v[96:99], v[80:83], v[20:23]
    v_mfma_f32_16x16x32_bf16 v[24:27], v[68:71], v[80:83], v[24:27]
    v_mfma_f32_16x16x32_bf16 v[16:19], v[64:67], v[80:83], v[16:19]
    s_waitcnt lgkmcnt(0)
    v_mfma_f32_16x16x32_bf16 v[28:31], v[108:111], v[36:39], v[28:31]
    v_mfma_f32_16x16x32_bf16 v[20:23], v[104:107], v[36:39], v[20:23]
    v_mfma_f32_16x16x32_bf16 v[24:27], v[76:79], v[36:39], v[24:27]
    v_mfma_f32_16x16x32_bf16 v[16:19], v[72:75], v[36:39], v[16:19]
    s_mov_b32 exec_lo, 0xc000c000
    s_mov_b32 exec_hi, 0xc000c000
    s_nop 2
    ds_write_b128 v165, v[28:31] offset:128
    ds_write_b32 v166, v166 offset:64
    s_mov_b64 exec, -1
    s_setprio 0
    s_branch C_EPI
C_P1:
    s_setprio 3
    ds_read_b128 v[32:35], v8 offset:2528
    ds_read_b128 v[36:39], v8 offset:3040
    ds_read_b128 v[40:43], v8 offset:2656
    s_waitcnt lgkmcnt(2)
    v_mfma_f32_16x16x32_bf16 v[144:147], v[128:131], v[32:35], 0
    v_mfma_f32_16x16x32_bf16 v[148:151], v[132:135], v[32:35], 0
    v_mfma_f32_16x16x32_bf16 v[152:155], v[136:139], v[32:35], 0
    v_mfma_f32_16x16x32_bf16 v[156:159], v[140:143], v[32:35], 0
    v_mfma_f32_16x16x32_bf16 v[28:31], v[52:55], v[32:35], 0
    v_mfma_f32_16x16x32_bf16 v[20:23], v[48:51], v[32:35], 0
    ds_read_b128 v[44:47], v8 offset:2784
    s_waitcnt lgkmcnt(2)
    v_mfma_f32_16x16x32_bf16 v[116:119], v[128:131], v[36:39], 0
    v_mfma_f32_16x16x32_bf16 v[160:163], v[132:135], v[36:39], 0
    v_mfma_f32_16x16x32_bf16 v[120:123], v[136:139], v[36:39], 0
    v_mfma_f32_16x16x32_bf16 v[124:127], v[140:143], v[36:39], 0
    v_mfma_f32_16x16x32_bf16 v[28:31], v[84:87], v[36:39], v[28:31]
    v_mfma_f32_16x16x32_bf16 v[20:23], v[80:83], v[36:39], v[20:23]
    v_mfma_f32_16x16x32_bf16 v[24:27], v[52:55], v[36:39], 0
    v_mfma_f32_16x16x32_bf16 v[16:19], v[48:51], v[36:39], 0
    v_cvt_pk_bf16_f32 v144, v144, v145
    v_cvt_pk_bf16_f32 v145, v146, v147
    ds_write_b64 v4, v[144:145] offset:1768
    v_cvt_pk_bf16_f32 v148, v148, v149
    v_cvt_pk_bf16_f32 v149, v150, v151
    ds_write_b64 v4, v[148:149] offset:5224
    v_cvt_pk_bf16_f32 v152, v152, v153
    v_cvt_pk_bf16_f32 v153, v154, v155
    ds_write_b64 v4, v[152:153] offset:8680
    v_cvt_pk_bf16_f32 v156, v156, v157
    v_cvt_pk_bf16_f32 v157, v158, v159
    ds_write_b64 v4, v[156:157] offset:12136
    ds_read_b128 v[32:35], v8 offset:2912
    s_waitcnt lgkmcnt(6)
    v_mfma_f32_16x16x32_bf16 v[28:31], v[60:63], v[40:43], v[28:31]
    v_mfma_f32_16x16x32_bf16 v[20:23], v[56:59], v[40:43], v[20:23]
    v_cvt_pk_bf16_f32 v116, v116, v117
    v_cvt_pk_bf16_f32 v117, v118, v119
    ds_write_b64 v4, v[116:117] offset:1224
    v_cvt_pk_bf16_f32 v160, v160, v161
    v_cvt_pk_bf16_f32 v161, v162, v163
    ds_write_b64 v4, v[160:161] offset:4680
    v_cvt_pk_bf16_f32 v120, v120, v121
    v_cvt_pk_bf16_f32 v121, v122, v123
    ds_write_b64 v4, v[120:121] offset:8136
    v_cvt_pk_bf16_f32 v124, v124, v125
    v_cvt_pk_bf16_f32 v125, v126, v127
    ds_write_b64 v4, v[124:125] offset:11592
    s_mov_b64 exec, 0x1
    ds_write_b32 v166, v166 offset:4
    s_mov_b64 exec, -1
    s_setprio 2
    ds_read_b128 v[36:39], v8 offset:3168
    s_cmp_ge_u32 s38, 4
    s_cbranch_scc1 C_NPF31
    s_mov_b32 m0, 163328
    s_mov_b32 exec_lo, 0xffffffff
    s_mov_b32 exec_hi, 0x3fffff
    global_load_lds_dword v14, s[28:29]
    s_mov_b32 exec_lo, 0x4020100
    s_mov_b32 exec_hi, 0x201008
    global_load_lds_dword v13, s[30:31]
    s_mov_b32 exec_lo, 0x4020100
    s_mov_b32 exec_hi, 0x201008
    global_load_lds_dword v14, s[26:27]
    s_mov_b64 exec, -1
C_NPF31:
    ds_read_b64 v[144:145], v9 offset:4608
    ds_read_b64 v[146:147], v9 offset:4616
    ds_read_b64 v[148:149], v9 offset:4672
    ds_read_b64 v[150:151], v9 offset:4680
    ds_read_b64 v[152:153], v9 offset:4736
    ds_read_b64 v[154:155], v9 offset:4744
    ds_read_b64 v[156:157], v9 offset:4800
    ds_read_b64 v[158:159], v9 offset:4808
    ds_read_b64 v[160:161], v2 offset:512
    ds_read_b64 v[162:163], v2
    s_waitcnt lgkmcnt(15)
    v_mfma_f32_16x16x32_bf16 v[28:31], v[68:71], v[44:47], v[28:31]
    v_mfma_f32_16x16x32_bf16 v[20:23], v[64:67], v[44:47], v[20:23]
    ds_read_b128 v[40:43], v8 offset:3296
    v_mfma_f32_16x16x32_bf16 v[28:31], v[76:79], v[32:35], v[28:31]
    v_mfma_f32_16x16x32_bf16 v[20:23], v[72:75], v[32:35], v[20:23]
    ds_read_b128 v[128:131], v8 offset:3424
    s_waitcnt lgkmcnt(2)
    s_setprio 0
    v_and_b32 v48, 0xffff0000, v161
    v_lshlrev_b32 v49, 16, v161
    v_and_b32 v50, 0xffff0000, v160
    v_lshlrev_b32 v51, 16, v160
    v_mul_f32 v48, v48, v164
    v_mul_f32 v49, v49, v164
    v_mul_f32 v50, v50, v164
    v_mul_f32 v51, v51, v164
    v_cvt_pk_bf16_f32 v49, v48, v49
    v_lshlrev_b32 v48, 16, v49
    v_and_b32 v49, 0xffff0000, v49
    v_cvt_pk_bf16_f32 v51, v50, v51
    v_lshlrev_b32 v50, 16, v51
    v_and_b32 v51, 0xffff0000, v51
    v_and_b32 v52, 0xffff0000, v163
    v_lshlrev_b32 v53, 16, v163
    v_and_b32 v54, 0xffff0000, v162
    v_lshlrev_b32 v55, 16, v162
    v_mul_f32 v52, v52, v164
    v_mul_f32 v53, v53, v164
    v_mul_f32 v54, v54, v164
    v_mul_f32 v55, v55, v164
    v_cvt_pk_bf16_f32 v53, v52, v53
    v_lshlrev_b32 v52, 16, v53
    v_and_b32 v53, 0xffff0000, v53
    v_cvt_pk_bf16_f32 v55, v54, v55
    v_lshlrev_b32 v54, 16, v55
    v_and_b32 v55, 0xffff0000, v55
    s_setprio 2
    v_mfma_f32_16x16x32_bf16 v[28:31], v[92:95], v[36:39], v[28:31]
    v_mfma_f32_16x16x32_bf16 v[20:23], v[88:91], v[36:39], v[20:23]
    v_mfma_f32_16x16x32_bf16 v[24:27], v[60:63], v[36:39], v[24:27]
    v_mfma_f32_16x16x32_bf16 v[16:19], v[56:59], v[36:39], v[16:19]
    ds_read_b128 v[132:135], v8 offset:3552
    s_waitcnt lgkmcnt(2)
    v_mfma_f32_16x16x32_bf16 v[28:31], v[100:103], v[40:43], v[28:31]
    v_mfma_f32_16x16x32_bf16 v[20:23], v[96:99], v[40:43], v[20:23]
    v_mfma_f32_16x16x32_bf16 v[24:27], v[68:71], v[40:43], v[24:27]
    v_mfma_f32_16x16x32_bf16 v[16:19], v[64:67], v[40:43], v[16:19]
    ds_read_b96 v[60:62], v166
    ds_read_b128 v[136:139], v8 offset:3680
    s_waitcnt lgkmcnt(3)
    v_mfma_f32_16x16x32_bf16 v[28:31], v[108:111], v[128:131], v[28:31]
    v_mfma_f32_16x16x32_bf16 v[20:23], v[104:107], v[128:131], v[20:23]
    v_mfma_f32_16x16x32_bf16 v[24:27], v[76:79], v[128:131], v[24:27]
    v_mfma_f32_16x16x32_bf16 v[16:19], v[72:75], v[128:131], v[16:19]
    s_waitcnt lgkmcnt(1)
C_FL1:
    v_min3_u32 v60, v60, v61, v62
    v_cmp_eq_u32 vcc, 0, v60
    s_nop 4
    s_cbranch_vccz C_FD1
    ds_read_b96 v[60:62], v166
    s_sub_u32 s60, s60, 1
    s_cmp_gt_i32 s60, 0
    s_waitcnt lgkmcnt(0)
    s_cbranch_scc1 C_FL1
C_FD1:
    ds_read_b128 v[140:143], v8 offset:3808
    v_mfma_f32_16x16x32_bf16 v[20:23], v[112:115], v[132:135], v[20:23]
    v_mfma_f32_16x16x32_bf16 v[24:27], v[84:87], v[132:135], v[24:27]
    v_mfma_f32_16x16x32_bf16 v[16:19], v[80:83], v[132:135], v[16:19]
    s_mov_b32 exec_lo, 0xc000c000
    s_mov_b32 exec_hi, 0xc000c000
    ds_write_b128 v165, v[28:31] offset:256
    ds_write_b32 v166, v166 offset:68
    s_mov_b64 exec, -1
    ds_read_b128 v[44:47], v8 offset:3936
    s_waitcnt lgkmcnt(4)
    v_mfma_f32_16x16x32_bf16 v[24:27], v[92:95], v[136:139], v[24:27]
    v_mfma_f32_16x16x32_bf16 v[16:19], v[88:91], v[136:139], v[16:19]
    ds_read_b128 v[32:35], v8 offset:4064
    ds_read_b64_tr_b16 v[36:37], v11 offset:0
    ds_read_b64_tr_b16 v[38:39], v12 offset:0
    ds_read_b64_tr_b16 v[68:69], v11 offset:272
    ds_read_b64_tr_b16 v[70:71], v12 offset:272
    s_waitcnt lgkmcnt(8)
    v_mfma_f32_16x16x32_bf16 v[24:27], v[100:103], v[140:143], v[24:27]
    v_mfma_f32_16x16x32_bf16 v[16:19], v[96:99], v[140:143], v[16:19]
    ds_read_b64_tr_b16 v[64:65], v11 offset:544
    ds_read_b64_tr_b16 v[66:67], v12 offset:544
    s_waitcnt lgkmcnt(7)
    v_mfma_f32_16x16x32_bf16 v[24:27], v[108:111], v[44:47], v[24:27]
    v_mfma_f32_16x16x32_bf16 v[16:19], v[104:107], v[44:47], v[16:19]
    ds_read_b64_tr_b16 v[40:41], v11 offset:816
    ds_read_b64_tr_b16 v[42:43], v12 offset:816
    s_waitcnt lgkmcnt(8)
    v_mfma_f32_16x16x32_bf16 v[16:19], v[112:115], v[32:35], v[16:19]
    s_waitcnt lgkmcnt(6)
    v_mfma_f32_16x16x32_bf16 v[20:23], v[36:39], v[156:159], v[20:23]
    v_mfma_f32_16x16x32_bf16 v[16:19], v[36:39], v[148:151], v[16:19]
    s_waitcnt lgkmcnt(4)
    v_mfma_f32_16x16x32_bf16 v[20:23], v[68:71], v[152:155], v[20:23]
    v_mfma_f32_16x16x32_bf16 v[16:19], v[68:71], v[144:147], v[16:19]
    ds_read_b32 v60, v166 offset:64
    ds_read_b128 v[56:59], v165 offset:128
    s_waitcnt lgkmcnt(4)
    v_mfma_f32_16x16x32_bf16 v[20:23], v[64:67], v[148:151], v[20:23]
    s_waitcnt lgkmcnt(2)
    v_mfma_f32_16x16x32_bf16 v[20:23], v[40:43], v[144:147], v[20:23]
    s_setprio 0
    s_waitcnt lgkmcnt(0)
C_CL1:
    v_cmp_eq_u32 vcc, 0, v60
    s_nop 4
    s_cbranch_vccz C_CD
    ds_read_b32 v60, v166 offset:64
    ds_read_b128 v[56:59], v165 offset:128
    s_sub_u32 s60, s60, 1
    s_cmp_gt_i32 s60, 0
    s_waitcnt lgkmcnt(0)
    s_cbranch_scc1 C_CL1
    s_branch C_CD
C_P2:
    s_setprio 3
    ds_read_b128 v[32:35], v8 offset:1504
    ds_read_b128 v[36:39], v8 offset:2016
    ds_read_b128 v[40:43], v8 offset:1632
    s_waitcnt lgkmcnt(2)
    v_mfma_f32_16x16x32_bf16 v[116:119], v[152:155], v[32:35], 0
    v_mfma_f32_16x16x32_bf16 v[160:163], v[156:159], v[32:35], 0
    v_mfma_f32_16x16x32_bf16 v[28:31], v[52:55], v[32:35], 0
    v_mfma_f32_16x16x32_bf16 v[20:23], v[48:51], v[32:35], 0
    ds_read_b128 v[44:47], v8 offset:1760
    s_waitcnt lgkmcnt(2)
    v_mfma_f32_16x16x32_bf16 v[120:123], v[152:155], v[36:39], 0
    v_mfma_f32_16x16x32_bf16 v[124:127], v[156:159], v[36:39], 0
    v_mfma_f32_16x16x32_bf16 v[28:31], v[84:87], v[36:39], v[28:31]
    v_mfma_f32_16x16x32_bf16 v[20:23], v[80:83], v[36:39], v[20:23]
    v_mfma_f32_16x16x32_bf16 v[24:27], v[52:55], v[36:39], 0
    v_mfma_f32_16x16x32_bf16 v[16:19], v[48:51], v[36:39], 0
    v_cvt_pk_bf16_f32 v116, v116, v117
    v_cvt_pk_bf16_f32 v117, v118, v119
    ds_write_b64 v4, v[116:117] offset:2856
    v_cvt_pk_bf16_f32 v160, v160, v161
    v_cvt_pk_bf16_f32 v161, v162, v163
    ds_write_b64 v4, v[160:161] offset:6312
    ds_read_b128 v[32:35], v8 offset:1888
    s_waitcnt lgkmcnt(4)
    v_mfma_f32_16x16x32_bf16 v[28:31], v[60:63], v[40:43], v[28:31]
    v_mfma_f32_16x16x32_bf16 v[20:23], v[56:59], v[40:43], v[20:23]
    v_cvt_pk_bf16_f32 v120, v120, v121
    v_cvt_pk_bf16_f32 v121, v122, v123
    ds_write_b64 v4, v[120:121] offset:2312
    v_cvt_pk_bf16_f32 v124, v124, v125
    v_cvt_pk_bf16_f32 v125, v126, v127
    ds_write_b64 v4, v[124:125] offset:5768
    s_mov_b64 exec, 0x1
    ds_write_b32 v166, v166 offset:8
    s_mov_b64 exec, -1
    s_setprio 2
    ds_read_b128 v[36:39], v8 offset:2144
    ds_read_b64 v[116:117], v7 offset:1088
    ds_read_b64 v[118:119], v7 offset:1096
    ds_read_b64 v[120:121], v10 offset:5120
    ds_read_b64 v[122:123], v10 offset:5128
    ds_read_b64 v[124:125], v10 offset:5184
    ds_read_b64 v[126:127], v10 offset:5192
    ds_read_b64 v[160:161], v2 offset:512
    ds_read_b64 v[162:163], v2
    s_waitcnt lgkmcnt(15)
    v_mfma_f32_16x16x32_bf16 v[28:31], v[68:71], v[44:47], v[28:31]
    v_mfma_f32_16x16x32_bf16 v[20:23], v[64:67], v[44:47], v[20:23]
    ds_read_b128 v[40:43], v8 offset:2272
    s_waitcnt lgkmcnt(13)
    v_mfma_f32_16x16x32_bf16 v[28:31], v[76:79], v[32:35], v[28:31]
    v_mfma_f32_16x16x32_bf16 v[20:23], v[72:75], v[32:35], v[20:23]
    ds_read_b128 v[152:155], v8 offset:2400
    s_waitcnt lgkmcnt(2)
    s_setprio 0
    v_and_b32 v48, 0xffff0000, v161
    v_lshlrev_b32 v49, 16, v161
    v_and_b32 v50, 0xffff0000, v160
    v_lshlrev_b32 v51, 16, v160
    v_mul_f32 v48, v48, v164
    v_mul_f32 v49, v49, v164
    v_mul_f32 v50, v50, v164
    v_mul_f32 v51, v51, v164
    v_cvt_pk_bf16_f32 v49, v48, v49
    v_lshlrev_b32 v48, 16, v49
    v_and_b32 v49, 0xffff0000, v49
    v_cvt_pk_bf16_f32 v51, v50, v51
    v_lshlrev_b32 v50, 16, v51
    v_and_b32 v51, 0xffff0000, v51
    v_and_b32 v52, 0xffff0000, v163
    v_lshlrev_b32 v53, 16, v163
    v_and_b32 v54, 0xffff0000, v162
    v_lshlrev_b32 v55, 16, v162
    v_mul_f32 v52, v52, v164
    v_mul_f32 v53, v53, v164
    v_mul_f32 v54, v54, v164
    v_mul_f32 v55, v55, v164
    v_cvt_pk_bf16_f32 v53, v52, v53
    v_lshlrev_b32 v52, 16, v53
    v_and_b32 v53, 0xffff0000, v53
    v_cvt_pk_bf16_f32 v55, v54, v55
    v_lshlrev_b32 v54, 16, v55
    v_and_b32 v55, 0xffff0000, v55
    s_setprio 2
    v_mfma_f32_16x16x32_bf16 v[28:31], v[92:95], v[36:39], v[28:31]
    v_mfma_f32_16x16x32_bf16 v[20:23], v[88:91], v[36:39], v[20:23]
    v_mfma_f32_16x16x32_bf16 v[24:27], v[60:63], v[36:39], v[24:27]
    v_mfma_f32_16x16x32_bf16 v[16:19], v[56:59], v[36:39], v[16:19]
    ds_read_b128 v[156:159], v8 offset:2528
    s_waitcnt lgkmcnt(2)
    v_mfma_f32_16x16x32_bf16 v[28:31], v[100:103], v[40:43], v[28:31]
    v_mfma_f32_16x16x32_bf16 v[20:23], v[96:99], v[40:43], v[20:23]
    v_mfma_f32_16x16x32_bf16 v[24:27], v[68:71], v[40:43], v[24:27]
    v_mfma_f32_16x16x32_bf16 v[16:19], v[64:67], v[40:43], v[16:19]
    ds_read_b128 v[44:47], v8 offset:2656
    s_waitcnt lgkmcnt(2)
    v_mfma_f32_16x16x32_bf16 v[28:31], v[108:111], v[152:155], v[28:31]
    v_mfma_f32_16x16x32_bf16 v[20:23], v[104:107], v[152:155], v[20:23]
    v_mfma_f32_16x16x32_bf16 v[24:27], v[76:79], v[152:155], v[24:27]
    v_mfma_f32_16x16x32_bf16 v[16:19], v[72:75], v[152:155], v[16:19]
    ds_read_b128 v[32:35], v8 offset:2784
    s_waitcnt lgkmcnt(2)
    v_mfma_f32_16x16x32_bf16 v[20:23], v[112:115], v[156:159], v[20:23]
    v_mfma_f32_16x16x32_bf16 v[24:27], v[84:87], v[156:159], v[24:27]
    v_mfma_f32_16x16x32_bf16 v[16:19], v[80:83], v[156:159], v[16:19]
    s_mov_b32 exec_lo, 0xc000c000
    s_mov_b32 exec_hi, 0xc000c000
    ds_write_b128 v165, v[28:31] offset:384
    ds_write_b32 v166, v166 offset:72
    s_mov_b64 exec, -1
    ds_read_b96 v[60:62], v166
    ds_read_b128 v[36:39], v8 offset:2912
    s_waitcnt lgkmcnt(5)
    v_mfma_f32_16x16x32_bf16 v[24:27], v[92:95], v[44:47], v[24:27]
    v_mfma_f32_16x16x32_bf16 v[16:19], v[88:91], v[44:47], v[16:19]
    s_waitcnt lgkmcnt(1)
C_FL2:
    v_min3_u32 v60, v60, v61, v62
    v_cmp_eq_u32 vcc, 0, v60
    s_nop 4
    s_cbranch_vccz C_FD2
    ds_read_b96 v[60:62], v166
    s_sub_u32 s60, s60, 1
    s_cmp_gt_i32 s60, 0
    s_waitcnt lgkmcnt(0)
    s_cbranch_scc1 C_FL2
C_FD2:
    ds_read_b128 v[68:71], v8 offset:3040
    v_mfma_f32_16x16x32_bf16 v[24:27], v[100:103], v[32:35], v[24:27]
    v_mfma_f32_16x16x32_bf16 v[16:19], v[96:99], v[32:35], v[16:19]
    ds_read_b128 v[64:67], v8 offset:3552
    s_waitcnt lgkmcnt(2)
    v_mfma_f32_16x16x32_bf16 v[24:27], v[108:111], v[36:39], v[24:27]
    v_mfma_f32_16x16x32_bf16 v[16:19], v[104:107], v[36:39], v[16:19]
    ds_read_b128 v[40:43], v8 offset:4064
    ds_read_b64_tr_b16 v[76:77], v13 offset:6912
    ds_read_b64_tr_b16 v[78:79], v14 offset:6912
    ds_read_b64_tr_b16 v[72:73], v13 offset:7456
    ds_read_b64_tr_b16 v[74:75], v14 offset:7456
    s_waitcnt lgkmcnt(6)
    v_mfma_f32_16x16x32_bf16 v[16:19], v[112:115], v[68:71], v[16:19]
    ds_read_b64_tr_b16 v[152:153], v11 offset:0
    ds_read_b64_tr_b16 v[154:155], v12 offset:0
    s_waitcnt lgkmcnt(7)
    v_mfma_f32_16x16x32_bf16 v[20:23], v[116:119], v[64:67], v[20:23]
    ds_read_b64_tr_b16 v[84:85], v11 offset:272
    ds_read_b64_tr_b16 v[86:87], v12 offset:272
    s_waitcnt lgkmcnt(8)
    v_mfma_f32_16x16x32_bf16 v[16:19], v[116:119], v[40:43], v[16:19]
    ds_read_b64_tr_b16 v[80:81], v11 offset:544
    ds_read_b64_tr_b16 v[82:83], v12 offset:544
    s_waitcnt lgkmcnt(8)
    v_mfma_f32_16x16x32_bf16 v[20:23], v[76:79], v[124:127], v[20:23]
    v_mfma_f32_16x16x32_bf16 v[16:19], v[76:79], v[120:123], v[16:19]
    ds_read_b64_tr_b16 v[156:157], v11 offset:816
    ds_read_b64_tr_b16 v[158:159], v12 offset:816
    s_waitcnt lgkmcnt(8)
    v_mfma_f32_16x16x32_bf16 v[20:23], v[72:75], v[120:123], v[20:23]
    ds_read_b64_tr_b16 v[92:93], v11 offset:1088
    ds_read_b64_tr_b16 v[94:95], v12 offset:1088
    s_waitcnt lgkmcnt(8)
    v_mfma_f32_16x16x32_bf16 v[16:19], v[152:155], v[148:151], v[16:19]
    ds_read_b64_tr_b16 v[88:89], v11 offset:1360
    ds_read_b64_tr_b16 v[90:91], v12 offset:1360
    s_waitcnt lgkmcnt(8)
    v_mfma_f32_16x16x32_bf16 v[16:19], v[84:87], v[144:147], v[16:19]
    ds_read_b64_tr_b16 v[44:45], v11 offset:1632
    ds_read_b64_tr_b16 v[46:47], v12 offset:1632
    s_waitcnt lgkmcnt(8)
    v_mfma_f32_16x16x32_bf16 v[20:23], v[80:83], v[148:151], v[20:23]
    v_mfma_f32_16x16x32_bf16 v[16:19], v[80:83], v[140:143], v[16:19]
    ds_read_b64_tr_b16 v[100:101], v11 offset:1904
    ds_read_b64_tr_b16 v[102:103], v12 offset:1904
    s_waitcnt lgkmcnt(8)
    v_mfma_f32_16x16x32_bf16 v[20:23], v[156:159], v[144:147], v[20:23]
    v_mfma_f32_16x16x32_bf16 v[16:19], v[156:159], v[136:139], v[16:19]
    s_waitcnt lgkmcnt(6)
    v_mfma_f32_16x16x32_bf16 v[20:23], v[92:95], v[140:143], v[20:23]
    v_mfma_f32_16x16x32_bf16 v[16:19], v[92:95], v[132:135], v[16:19]
    s_waitcnt lgkmcnt(4)
    v_mfma_f32_16x16x32_bf16 v[20:23], v[88:91], v[136:139], v[20:23]
    v_mfma_f32_16x16x32_bf16 v[16:19], v[88:91], v[128:131], v[16:19]
    ds_read_b32 v60, v166 offset:68
    ds_read_b128 v[56:59], v165 offset:256
    s_waitcnt lgkmcnt(4)
    v_mfma_f32_16x16x32_bf16 v[20:23], v[44:47], v[132:135], v[20:23]
    s_waitcnt lgkmcnt(2)
    v_mfma_f32_16x16x32_bf16 v[20:23], v[100:103], v[128:131], v[20:23]
    s_setprio 0
    s_waitcnt lgkmcnt(0)
C_CL2:
    v_cmp_eq_u32 vcc, 0, v60
    s_nop 4
    s_cbranch_vccz C_CD
    ds_read_b32 v60, v166 offset:68
    ds_read_b128 v[56:59], v165 offset:256
    s_sub_u32 s60, s60, 1
    s_cmp_gt_i32 s60, 0
    s_waitcnt lgkmcnt(0)
    s_cbranch_scc1 C_CL2
    s_branch C_CD
C_P3:
    s_setprio 2
    ds_read_b128 v[32:35], v8 offset:480
    ds_read_b128 v[36:39], v8 offset:608
    ds_read_b128 v[40:43], v8 offset:736
    ds_read_b64 v[120:121], v10 offset:5248
    ds_read_b64 v[122:123], v10 offset:5256
    ds_read_b64 v[124:125], v10 offset:5312
    ds_read_b64 v[126:127], v10 offset:5320
    ds_read_b64 v[160:161], v2 offset:512
    ds_read_b64 v[162:163], v2
    s_waitcnt lgkmcnt(8)
    v_mfma_f32_16x16x32_bf16 v[28:31], v[52:55], v[32:35], 0
    v_mfma_f32_16x16x32_bf16 v[20:23], v[48:51], v[32:35], 0
    ds_read_b128 v[44:47], v8 offset:864
    s_waitcnt lgkmcnt(8)
    v_mfma_f32_16x16x32_bf16 v[28:31], v[60:63], v[36:39], v[28:31]
    v_mfma_f32_16x16x32_bf16 v[20:23], v[56:59], v[36:39], v[20:23]
    ds_read_b128 v[32:35], v8 offset:992
    s_waitcnt lgkmcnt(8)
    v_mfma_f32_16x16x32_bf16 v[28:31], v[68:71], v[40:43], v[28:31]
    v_mfma_f32_16x16x32_bf16 v[20:23], v[64:67], v[40:43], v[20:23]
    ds_read_b128 v[36:39], v8 offset:1120
    s_waitcnt lgkmcnt(2)
    v_mfma_f32_16x16x32_bf16 v[28:31], v[76:79], v[44:47], v[28:31]
    v_mfma_f32_16x16x32_bf16 v[20:23], v[72:75], v[44:47], v[20:23]
    ds_read_b128 v[40:43], v8 offset:1248
    s_waitcnt lgkmcnt(2)
    v_mfma_f32_16x16x32_bf16 v[28:31], v[84:87], v[32:35], v[28:31]
    v_mfma_f32_16x16x32_bf16 v[20:23], v[80:83], v[32:35], v[20:23]
    v_mfma_f32_16x16x32_bf16 v[24:27], v[52:55], v[32:35], 0
    v_mfma_f32_16x16x32_bf16 v[16:19], v[48:51], v[32:35], 0
    ds_read_b128 v[44:47], v8 offset:1376
    s_waitcnt lgkmcnt(2)
    v_mfma_f32_16x16x32_bf16 v[28:31], v[92:95], v[36:39], v[28:31]
    v_mfma_f32_16x16x32_bf16 v[20:23], v[88:91], v[36:39], v[20:23]
    v_mfma_f32_16x16x32_bf16 v[24:27], v[60:63], v[36:39], v[24:27]
    v_mfma_f32_16x16x32_bf16 v[16:19], v[56:59], v[36:39], v[16:19]
    ds_read_b128 v[32:35], v8 offset:1504
    s_setprio 0
    v_and_b32 v48, 0xffff0000, v161
    v_lshlrev_b32 v49, 16, v161
    v_and_b32 v50, 0xffff0000, v160
    v_lshlrev_b32 v51, 16, v160
    v_mul_f32 v48, v48, v164
    v_mul_f32 v49, v49, v164
    v_mul_f32 v50, v50, v164
    v_mul_f32 v51, v51, v164
    v_cvt_pk_bf16_f32 v49, v48, v49
    v_lshlrev_b32 v48, 16, v49
    v_and_b32 v49, 0xffff0000, v49
    v_cvt_pk_bf16_f32 v51, v50, v51
    v_lshlrev_b32 v50, 16, v51
    v_and_b32 v51, 0xffff0000, v51
    v_and_b32 v52, 0xffff0000, v163
    v_lshlrev_b32 v53, 16, v163
    v_and_b32 v54, 0xffff0000, v162
    v_lshlrev_b32 v55, 16, v162
    v_mul_f32 v52, v52, v164
    v_mul_f32 v53, v53, v164
    v_mul_f32 v54, v54, v164
    v_mul_f32 v55, v55, v164
    v_cvt_pk_bf16_f32 v53, v52, v53
    v_lshlrev_b32 v52, 16, v53
    v_and_b32 v53, 0xffff0000, v53
    v_cvt_pk_bf16_f32 v55, v54, v55
    v_lshlrev_b32 v54, 16, v55
    v_and_b32 v55, 0xffff0000, v55
    s_setprio 2
    s_waitcnt lgkmcnt(2)
    v_mfma_f32_16x16x32_bf16 v[28:31], v[100:103], v[40:43], v[28:31]
    v_mfma_f32_16x16x32_bf16 v[20:23], v[96:99], v[40:43], v[20:23]
    v_mfma_f32_16x16x32_bf16 v[24:27], v[68:71], v[40:43], v[24:27]
    v_mfma_f32_16x16x32_bf16 v[16:19], v[64:67], v[40:43], v[16:19]
    ds_read_b128 v[36:39], v8 offset:1632
    s_waitcnt lgkmcnt(2)
    v_mfma_f32_16x16x32_bf16 v[28:31], v[108:111], v[44:47], v[28:31]
    v_mfma_f32_16x16x32_bf16 v[20:23], v[104:107], v[44:47], v[20:23]
    v_mfma_f32_16x16x32_bf16 v[24:27], v[76:79], v[44:47], v[24:27]
    v_mfma_f32_16x16x32_bf16 v[16:19], v[72:75], v[44:47], v[16:19]
    ds_read_b128 v[68:71], v8 offset:1760
    s_waitcnt lgkmcnt(2)
    v_mfma_f32_16x16x32_bf16 v[20:23], v[112:115], v[32:35], v[20:23]
    v_mfma_f32_16x16x32_bf16 v[24:27], v[84:87], v[32:35], v[24:27]
    v_mfma_f32_16x16x32_bf16 v[16:19], v[80:83], v[32:35], v[16:19]
    ds_read_b96 v[60:62], v166
    ds_read_b128 v[64:67], v8 offset:1888
    s_waitcnt lgkmcnt(3)
    v_mfma_f32_16x16x32_bf16 v[24:27], v[92:95], v[36:39], v[24:27]
    v_mfma_f32_16x16x32_bf16 v[16:19], v[88:91], v[36:39], v[16:19]
    s_waitcnt lgkmcnt(1)
C_FL3:
    v_min3_u32 v60, v60, v61, v62
    v_cmp_eq_u32 vcc, 0, v60
    s_nop 4
    s_cbranch_vccz C_FD3
    ds_read_b96 v[60:62], v166
    s_sub_u32 s60, s60, 1
    s_cmp_gt_i32 s60, 0
    s_waitcnt lgkmcnt(0)
    s_cbranch_scc1 C_FL3
C_FD3:
    ds_read_b128 v[40:43], v8 offset:2016
    v_mfma_f32_16x16x32_bf16 v[24:27], v[100:103], v[68:71], v[24:27]
    v_mfma_f32_16x16x32_bf16 v[16:19], v[96:99], v[68:71], v[16:19]
    ds_read_b128 v[76:79], v8 offset:2528
    s_waitcnt lgkmcnt(2)
    v_mfma_f32_16x16x32_bf16 v[24:27], v[108:111], v[64:67], v[24:27]
    v_mfma_f32_16x16x32_bf16 v[16:19], v[104:107], v[64:67], v[16:19]
    ds_read_b128 v[72:75], v8 offset:3040
    ds_read_b64_tr_b16 v[44:45], v13 offset:6912
    ds_read_b64_tr_b16 v[46:47], v14 offset:6912
    ds_read_b64_tr_b16 v[84:85], v13 offset:7456
    ds_read_b64_tr_b16 v[86:87], v14 offset:7456
    s_waitcnt lgkmcnt(6)
    v_mfma_f32_16x16x32_bf16 v[16:19], v[112:115], v[40:43], v[16:19]
    ds_read_b64_tr_b16 v[80:81], v13 offset:8000
    ds_read_b64_tr_b16 v[82:83], v14 offset:8000
    s_waitcnt lgkmcnt(7)
    v_mfma_f32_16x16x32_bf16 v[20:23], v[116:119], v[76:79], v[20:23]
    ds_read_b64_tr_b16 v[32:33], v13 offset:8544
    ds_read_b64_tr_b16 v[34:35], v14 offset:8544
    s_waitcnt lgkmcnt(8)
    v_mfma_f32_16x16x32_bf16 v[16:19], v[116:119], v[72:75], v[16:19]
    ds_read_b64_tr_b16 v[92:93], v11 offset:1088
    ds_read_b64_tr_b16 v[94:95], v12 offset:1088
    s_waitcnt lgkmcnt(8)
    v_mfma_f32_16x16x32_bf16 v[20:23], v[44:47], v[124:127], v[20:23]
    v_mfma_f32_16x16x32_bf16 v[16:19], v[44:47], v[120:123], v[16:19]
    ds_read_b64_tr_b16 v[88:89], v11 offset:1360
    ds_read_b64_tr_b16 v[90:91], v12 offset:1360
    s_waitcnt lgkmcnt(8)
    v_mfma_f32_16x16x32_bf16 v[20:23], v[84:87], v[120:123], v[20:23]
    v_mfma_f32_16x16x32_bf16 v[16:19], v[84:87], v[156:159], v[16:19]
    ds_read_b64_tr_b16 v[36:37], v11 offset:1632
    ds_read_b64_tr_b16 v[38:39], v12 offset:1632
    s_waitcnt lgkmcnt(8)
    v_mfma_f32_16x16x32_bf16 v[20:23], v[80:83], v[156:159], v[20:23]
    v_mfma_f32_16x16x32_bf16 v[16:19], v[80:83], v[152:155], v[16:19]
    ds_read_b64_tr_b16 v[100:101], v11 offset:1904
    ds_read_b64_tr_b16 v[102:103], v12 offset:1904
    s_waitcnt lgkmcnt(8)
    v_mfma_f32_16x16x32_bf16 v[20:23], v[32:35], v[152:155], v[20:23]
    ds_read_b64_tr_b16 v[96:97], v11 offset:2176
    ds_read_b64_tr_b16 v[98:99], v12 offset:2176
    s_waitcnt lgkmcnt(8)
    v_mfma_f32_16x16x32_bf16 v[16:19], v[92:95], v[148:151], v[16:19]
    ds_read_b64_tr_b16 v[68:69], v11 offset:2448
    ds_read_b64_tr_b16 v[70:71], v12 offset:2448
    s_waitcnt lgkmcnt(8)
    v_mfma_f32_16x16x32_bf16 v[16:19], v[88:91], v[144:147], v[16:19]
    ds_read_b64_tr_b16 v[108:109], v11 offset:2720
    ds_read_b64_tr_b16 v[110:111], v12 offset:2720
    s_waitcnt lgkmcnt(8)
    v_mfma_f32_16x16x32_bf16 v[20:23], v[36:39], v[148:151], v[20:23]
    v_mfma_f32_16x16x32_bf16 v[16:19], v[36:39], v[140:143], v[16:19]
    ds_read_b64_tr_b16 v[104:105], v11 offset:2992
    ds_read_b64_tr_b16 v[106:107], v12 offset:2992
    s_waitcnt lgkmcnt(8)
    v_mfma_f32_16x16x32_bf16 v[20:23], v[100:103], v[144:147], v[20:23]
    v_mfma_f32_16x16x32_bf16 v[16:19], v[100:103], v[136:139], v[16:19]
    s_waitcnt lgkmcnt(6)
    v_mfma_f32_16x16x32_bf16 v[20:23], v[96:99], v[140:143], v[20:23]
    v_mfma_f32_16x16x32_bf16 v[16:19], v[96:99], v[132:135], v[16:19]
    s_waitcnt lgkmcnt(4)
    v_mfma_f32_16x16x32_bf16 v[20:23], v[68:71], v[136:139], v[20:23]
    v_mfma_f32_16x16x32_bf16 v[16:19], v[68:71], v[128:131], v[16:19]
    ds_read_b32 v60, v166 offset:72
    ds_read_b128 v[56:59], v165 offset:384
    s_waitcnt lgkmcnt(4)
    v_mfma_f32_16x16x32_bf16 v[20:23], v[108:111], v[132:135], v[20:23]
    s_waitcnt lgkmcnt(2)
    v_mfma_f32_16x16x32_bf16 v[20:23], v[104:107], v[128:131], v[20:23]
    s_setprio 0
    s_waitcnt lgkmcnt(0)
C_CL3:
    v_cmp_eq_u32 vcc, 0, v60
    s_nop 4
    s_cbranch_vccz C_CD
    ds_read_b32 v60, v166 offset:72
    ds_read_b128 v[56:59], v165 offset:384
    s_sub_u32 s60, s60, 1
    s_cmp_gt_i32 s60, 0
    s_waitcnt lgkmcnt(0)
    s_cbranch_scc1 C_CL3
C_CD:
    s_cmp_lt_u32 s38, 4
    s_cbranch_scc1 C_CD2
    s_waitcnt vmcnt(0)
C_CD2:
    s_mov_b32 exec_lo, 0x30003
    s_mov_b32 exec_hi, 0x30003
    s_nop 4
    v_pk_add_f32 v[16:17], v[16:17], v[56:57]
    v_pk_add_f32 v[18:19], v[18:19], v[58:59]
    s_mov_b64 exec, -1
C_EPI:
    s_nop 3
    s_movk_i32 s54, 0x3f80
    s_mov_b32 s55, 1.0
    v_add_f32_dpp v16, v24, v16 row_shr:2 row_mask:0xf bank_mask:0xf
    v_add_f32_dpp v17, v25, v17 row_shr:2 row_mask:0xf bank_mask:0xf
    v_add_f32_dpp v18, v26, v18 row_shr:2 row_mask:0xf bank_mask:0xf
    v_add_f32_dpp v19, v27, v19 row_shr:2 row_mask:0xf bank_mask:0xf
    v_add_f32_dpp v20, v28, v20 row_shr:2 row_mask:0xf bank_mask:0xf
    v_add_f32_dpp v21, v29, v21 row_shr:2 row_mask:0xf bank_mask:0xf
    v_add_f32_dpp v22, v30, v22 row_shr:2 row_mask:0xf bank_mask:0xf
    v_add_f32_dpp v23, v31, v23 row_shr:2 row_mask:0xf bank_mask:0xf
    v_add_f32_dpp v20, v24, v20 row_shl:14 row_mask:0xf bank_mask:0xf
    v_add_f32_dpp v21, v25, v21 row_shl:14 row_mask:0xf bank_mask:0xf
    v_add_f32_dpp v22, v26, v22 row_shl:14 row_mask:0xf bank_mask:0xf
    v_add_f32_dpp v23, v27, v23 row_shl:14 row_mask:0xf bank_mask:0xf
    v_cvt_pk_bf16_f32 v16, v16, v17
    v_cvt_pk_bf16_f32 v17, v18, v19
    v_cvt_pk_bf16_f32 v18, v20, v21
    v_cvt_pk_bf16_f32 v19, v22, v23
    v_dot2c_f32_bf16 v48, s54, v16
    v_dot2c_f32_bf16 v49, s55, v16
    v_dot2c_f32_bf16 v50, s54, v17
    v_dot2c_f32_bf16 v51, s55, v17
    v_dot2c_f32_bf16 v52, s54, v18
    v_dot2c_f32_bf16 v53, s55, v18
    v_dot2c_f32_bf16 v54, s54, v19
    v_dot2c_f32_bf16 v55, s55, v19
    v_cvt_pk_bf16_f32 v48, v48, v49
    v_cvt_pk_bf16_f32 v49, v50, v51
    ds_write_b64 v15, v[48:49] offset:0
    v_cvt_pk_bf16_f32 v52, v52, v53
    v_cvt_pk_bf16_f32 v53, v54, v55
    ds_write_b64 v15, v[52:53] offset:544
    s_cmp_ge_u32 s38, 8
    s_cbranch_scc1 C_NOGA
    v_lshrrev_b32 v7, 5, v0
    v_lshlrev_b32 v7, 3, v7
    v_lshl_add_u32 v7, v0, 2, v7
    v_lshrrev_b32 v8, 3, v0
    v_mul_u32_u24 v8, 0x6000, v8
    v_and_b32 v9, 7, v0
    v_lshl_add_u32 v8, v9, 4, v8
    s_lshr_b32 s52, s2, 4
    s_lshl_b32 s52, s52, 11
    s_and_b32 s53, s2, 1
    s_lshl_b32 s53, s53, 10
    s_add_u32 s52, s52, s53
    s_bfe_u32 s53, s2, 0x30001
    s_lshl_b32 s53, s53, 7
    s_add_u32 s52, s52, s53
    s_add_u32 s52, s52, 3211264
    s_add_u32 s53, s52, 1572864
    v_mov_b32 v27, v167
    v_mov_b32 v31, v167
C_NOGA:
    s_waitcnt lgkmcnt(0)
    s_barrier
    s_cmp_ge_u32 s38, 8
    s_cbranch_scc1 C_NOST
    ds_read_b32 v24, v7 offset:41472
    ds_read_b32 v25, v7 offset:45824
    ds_read_b32 v26, v7 offset:50176
    ds_read_b32 v28, v7 offset:43648
    ds_read_b32 v29, v7 offset:48000
    ds_read_b32 v30, v7 offset:52352
    s_waitcnt lgkmcnt(3)
    buffer_store_dwordx4 v[24:27], v8, s[40:43], s52 offen sc1
    s_waitcnt lgkmcnt(0)
    buffer_store_dwordx4 v[28:31], v8, s[40:43], s53 offen sc1
C_NOST:
    s_cmp_ge_u32 s2, 184
    s_cbranch_scc1 FFN_LATE
    s_cmp_ge_u32 s2, 128
    s_cbranch_scc1 FINAL
    v_and_b32 v7, 7, v1
    v_lshrrev_b32 v8, 3, v1
    s_mul_i32 s44, s2, 18432
    s_mul_i32 s45, s38, 96
    s_add_u32 s46, s44, s45
    v_mul_u32_u24 v9, 0x900, v7
    v_mad_u32_u24 v9, v8, 12, v9
    v_add_u32 v9, s46, v9
    v_xor_b32 v10, 1, v8
    v_mad_u32_u24 v10, v10, 12, s45
    global_load_dwordx3 v[16:18], v9, s[4:5]
    global_load_dwordx3 v[20:22], v9, s[4:5] offset:1152
    global_load_dwordx3 v[24:26], v10, s[24:25]
    s_mul_i32 s47, s2, 24576
    s_lshl_b32 s48, s38, 11
    s_add_u32 s47, s47, s48
    s_add_u32 s47, s47, 3211264
    v_mul_u32_u24 v84, 0x70, v7
    v_bfe_u32 v10, v1, 3, 1
    v_lshl_add_u32 v84, v10, 2, v84
    s_lshl_b32 s49, s38, 3
    s_add_u32 s49, s49, 103168
    v_add_u32 v84, s49, v84
    v_mul_u32_u24 v85, 0x70, v1
    v_add_u32 v85, 97792, v85
    s_mov_b32 exec_lo, 0xf0000f
    s_mov_b32 exec_hi, 0xf0000f00
    v_subrev_u32 v84, 3584, v84
    s_mov_b32 exec_lo, 0xff000000
    s_mov_b32 exec_hi, 0xff0000
    v_subrev_u32 v84, 1792, v84
    s_mov_b32 exec_lo, 0xff00
    s_mov_b32 exec_hi, 0xff
    v_subrev_u32 v84, 5376, v84
    s_mov_b64 exec, -1
    s_add_u32 s48, s48, 54528
    v_and_b32 v10, 6, v7
    v_xor_b32 v10, v10, v8
    v_lshl_add_u32 v10, v7, 3, v10
    v_lshl_add_u32 v86, v10, 4, s48
    v_and_b32 v10, 6, v8
    v_xor_b32 v10, v10, v1
    v_lshl_add_u32 v87, v10, 4, s48
    v_mul_u32_u24 v88, 2944, v8
    v_add_u32 v88, v88, v3
    s_mul_i32 s48, s2, 24576
    s_lshl_b32 s49, s38, 7
    s_add_u32 s48, s48, s49
    s_add_u32 s48, s48, 6356992
    v_mul_u32_u24 v89, 2336, v7
    v_mad_u32_u24 v89, v8, 12, v89
    s_add_u32 s45, s45, 79104
    v_add_u32 v89, s45, v89
    v_add_u32 v10, 4944, v0
    v_add_u32 v11, 0, v0
    v_mul_u32_u24 v11, 911, v11
    v_lshrrev_b32 v11, 16, v11
    v_add_lshl_u32 v90, v10, v11, 4
    v_add_u32 v10, 5712, v0
    v_add_u32 v11, 768, v0
    v_mul_u32_u24 v11, 911, v11
    v_lshrrev_b32 v11, 16, v11
    v_add_lshl_u32 v91, v10, v11, 4
    v_lshl_add_u32 v92, v0, 4, s44
    v_bfe_u32 v10, v1, 3, 1
    v_lshl_add_u32 v10, v7, 1, v10
    s_lshl_b32 s49, s2, 4
    v_add_u32 v93, s49, v10
    v_sub_u32 v12, 0x7ff, v93
    v_lshlrev_b32 v93, 2, v93
    s_mov_b32 s49, 32768
    v_mov_b32 v51, 0
    v_mov_b32 v55, 0
    v_mov_b32 v76, 0
    v_mov_b32 v56, 0
    v_mov_b32 v57, 0
    v_mov_b32 v58, 0
    v_mov_b32 v59, 0
    v_mov_b32 v60, 0
    v_mov_b32 v61, 0
    v_mov_b32 v62, 0
    v_mov_b32 v63, 0
    s_lshl_b32 s50, s2, 6
    s_lshl_b32 s51, s38, 2
    s_add_u32 s50, s50, s51
    s_add_u32 s50, s50, 8192
    s_mov_b32 s56, 0x00100001
    s_mov_b32 s57, 0x10000100
    s_mov_b32 s58, 0xffff0000
    s_waitcnt vmcnt(0)
    buffer_load_dwordx4 v[28:31], v3, s[40:43], s47 offen sc1
    buffer_load_dwordx4 v[32:35], v3, s[40:43], s47 offen offset:1024 sc1
    v_dot2c_f32_bf16 v76, 0x3f803f80, v24
    v_dot2c_f32_bf16 v76, 0x3f803f80, v25
    v_dot2c_f32_bf16 v76, 0x3f803f80, v26
    v_lshlrev_b32 v36, 16, v16
    v_and_b32 v37, 0xffff0000, v16
    v_lshlrev_b32 v42, 16, v20
    v_and_b32 v43, 0xffff0000, v20
    v_lshlrev_b32 v38, 16, v17
    v_and_b32 v39, 0xffff0000, v17
    v_lshlrev_b32 v44, 16, v21
    v_and_b32 v45, 0xffff0000, v21
    v_lshlrev_b32 v40, 16, v18
    v_and_b32 v41, 0xffff0000, v18
    v_lshlrev_b32 v46, 16, v22
    v_and_b32 v47, 0xffff0000, v22
    v_mov_b32 v77, v76
    s_nop 1
    v_permlane16_swap_b32 v76, v77
    v_add_f32 v76, v76, v77
    v_mov_b32 v77, v76
    s_nop 1
    v_permlane32_swap_b32 v76, v77
    v_add_f32 v76, v76, v77
    s_mov_b32 exec_lo, 0xf00f0
    s_mov_b32 exec_hi, 0xf00f000
    ds_write2_b32 v84, v76, v76 offset0:0 offset1:224
    s_mov_b32 exec_lo, 0xf0f0f0f
    s_mov_b32 exec_hi, 0xf0f0f0f
    v_mov_b32 v24, 0x3f803f80
    v_mov_b32 v25, 0x3f803f80
    v_mov_b32 v26, 0x3f803f80
    s_mov_b32 exec_lo, 0x11111111
    s_mov_b32 exec_hi, 0x11111111
    v_mov_b32 v56, v24
    v_mov_b32 v57, v25
    v_mov_b32 v58, v26
    s_mov_b32 exec_lo, 0x22222222
    s_mov_b32 exec_hi, 0x22222222
    v_mov_b32 v60, v24
    v_mov_b32 v61, v25
    v_mov_b32 v62, v26
    s_mov_b64 exec, -1
    s_movk_i32 s60, 4000
    s_branch L_YP_W
L_YP:
    buffer_load_dwordx4 v[28:31], v3, s[40:43], s47 offen sc1
    buffer_load_dwordx4 v[32:35], v3, s[40:43], s47 offen offset:1024 sc1
L_YP_W:
    s_waitcnt vmcnt(0)
    v_xor_b32 v10, v167, v31
    v_xor_b32 v11, v167, v35
    v_or_b32 v10, v10, v11
    v_cmp_ne_u32 vcc, 0, v10
    s_nop 0
    s_and_b64 exec, exec, vcc
    s_cbranch_execz L_YP_D
    s_sub_u32 s60, s60, 1
    s_cmp_gt_i32 s60, 0
    s_sleep 1
    s_cbranch_scc1 L_YP
L_YP_D:
    s_mov_b64 exec, -1
    v_dot2c_f32_bf16 v36, s54, v28
    v_dot2c_f32_bf16 v37, s54, v29
    v_dot2c_f32_bf16 v38, s54, v30
    v_dot2c_f32_bf16 v39, s54, v34
    v_dot2c_f32_bf16 v40, s54, v32
    v_dot2c_f32_bf16 v41, s54, v33
    v_dot2c_f32_bf16 v42, s55, v28
    v_dot2c_f32_bf16 v43, s55, v29
    v_dot2c_f32_bf16 v44, s55, v30
    v_dot2c_f32_bf16 v45, s55, v34
    v_cvt_pk_bf16_f32 v48, v36, v37
    v_dot2c_f32_bf16 v46, s55, v32
    v_cvt_pk_bf16_f32 v49, v38, v39
    v_dot2c_f32_bf16 v47, s55, v33
    v_cvt_pk_bf16_f32 v50, v40, v41
    v_cvt_pk_bf16_f32 v52, v42, v43
    v_cvt_pk_bf16_f32 v53, v44, v45
    v_mfma_f32_16x16x32_bf16 v[68:71], v[48:51], v[48:51], 0
    v_cvt_pk_bf16_f32 v54, v46, v47
    v_mfma_f32_16x16x32_bf16 v[64:67], v[56:59], v[48:51], 0
    s_nop 0
    v_mfma_f32_16x16x32_bf16 v[64:67], v[60:63], v[52:55], v[64:67]
    v_mfma_f32_16x16x32_bf16 v[72:75], v[52:55], v[52:55], 0
    v_lshlrev_b32 v36, 16, v48
    v_and_b32 v37, 0xffff0000, v48
    v_lshlrev_b32 v38, 16, v49
    v_and_b32 v39, 0xffff0000, v49
    v_lshlrev_b32 v40, 16, v50
    v_and_b32 v41, 0xffff0000, v50
    s_mov_b64 exec, s[56:57]
    v_mov_b32 v64, v68
    v_mov_b32 v65, v72
    s_lshl_b64 exec, exec, 1
    v_mov_b32 v64, v69
    v_mov_b32 v65, v73
    s_lshl_b64 exec, exec, 1
    v_mov_b32 v64, v70
    v_mov_b32 v65, v74
    s_lshl_b64 exec, exec, 1
    v_mov_b32 v64, v71
    v_mov_b32 v65, v75
    s_mov_b32 exec_lo, 0xfff0ff0f
    s_mov_b32 exec_hi, 0xf0ff0fff
    ds_write2_b32 v84, v64, v65 offset0:0 offset1:224
    s_mov_b64 exec, -1
    v_lshlrev_b32 v42, 16, v52
    v_and_b32 v43, 0xffff0000, v52
    v_lshlrev_b32 v44, 16, v53
    v_and_b32 v45, 0xffff0000, v53
    v_lshlrev_b32 v46, 16, v54
    v_and_b32 v47, 0xffff0000, v54
    s_cmp_eq_u32 s38, 0
    s_cbranch_scc0 L_NP
    s_setprio 3
L_NP:
    s_waitcnt lgkmcnt(0)
    s_barrier
    ds_read_b128 v[52:55], v85 offset:0
    ds_read_b128 v[56:59], v85 offset:16
    ds_read_b128 v[60:63], v85 offset:32
    ds_read_b128 v[64:67], v85 offset:48
    ds_read_b128 v[68:71], v85 offset:64
    ds_read_b128 v[72:75], v85 offset:80
    s_waitcnt lgkmcnt(4)
    s_waitcnt lgkmcnt(2)
    v_pk_add_f32 v[52:53], v[52:53], v[60:61]
    v_pk_add_f32 v[54:55], v[54:55], v[62:63]
    v_pk_add_f32 v[56:57], v[56:57], v[64:65]
    v_pk_add_f32 v[58:59], v[58:59], v[66:67]
    s_waitcnt lgkmcnt(0)
    v_pk_add_f32 v[52:53], v[52:53], v[68:69]
    v_pk_add_f32 v[54:55], v[54:55], v[70:71]
    v_pk_add_f32 v[56:57], v[56:57], v[72:73]
    v_pk_add_f32 v[58:59], v[58:59], v[74:75]
    v_pk_add_f32 v[52:53], v[52:53], v[54:55]
    v_pk_add_f32 v[56:57], v[56:57], v[58:59]
    v_pk_add_f32 v[52:53], v[52:53], v[56:57]
    v_add_f32 v76, v52, v53
    v_add_f32 v78, v52, v53
    s_nop 1
    v_permlane16_swap_b32 v76, v78
    v_mov_b32 v77, v76
    v_mov_b32 v13, v78
    s_nop 0
    v_permlane32_swap_b32 v76, v77
    v_permlane32_swap_b32 v78, v13
    v_mul_f32 v76, 0x3ae38e39, v76
    v_mul_f32 v78, 0x3ae38e39, v78
    v_fma_f32 v78, -v76, v76, v78
    v_max_f32 v78, 0, v78
    v_cvt_pk_bf16_f32 v78, v76, v78
    v_and_b32 v82, 0xffff0000, v78
    v_lshlrev_b32 v80, 16, v78
    v_add_f32 v82, 0x3727c5ac, v82
    v_lshlrev_b32 v81, 16, v78
    v_cvt_pk_bf16_f32 v82, v82, v82
    v_lshlrev_b32 v82, 16, v82
    v_sqrt_f32 v82, v82
    v_fma_f32 v77, -v80, v13, v77
    v_cvt_pk_bf16_f32 v82, v82, v82
    v_lshlrev_b32 v82, 16, v82
    v_rcp_f32 v83, v82
    v_rcp_f32 v82, v82
    s_cbranch_scc0 L_NK
    v_mul_f32 v77, v77, v83
    v_cvt_pk_bf16_f32 v77, v77, v77
    v_ashrrev_i32 v76, 31, v77
    v_or_b32 v76, 0x80000000, v76
    v_xor_b32 v76, v76, v77
    v_and_or_b32 v76, v76, s58, v12
    s_mov_b64 exec, 0xffff
    buffer_store_dword v76, v93, s[40:43], s49 offen sc1
    s_mov_b64 exec, -1
    s_setprio 0
L_NK:
    v_mov_b32_dpp v80, v80 row_ror:8 row_mask:0xf bank_mask:0xc
    v_mov_b32_dpp v81, v81 row_ror:8 row_mask:0xf bank_mask:0x3
    v_mov_b32_dpp v82, v82 row_ror:8 row_mask:0xf bank_mask:0xc
    v_mov_b32_dpp v83, v83 row_ror:8 row_mask:0xf bank_mask:0x3
    v_pk_add_f32 v[56:57], v[36:37], v[80:81] op_sel_hi:[1,0] neg_lo:[0,1] neg_hi:[0,1]
    v_pk_add_f32 v[58:59], v[38:39], v[80:81] op_sel_hi:[1,0] neg_lo:[0,1] neg_hi:[0,1]
    v_pk_add_f32 v[60:61], v[40:41], v[80:81] op_sel_hi:[1,0] neg_lo:[0,1] neg_hi:[0,1]
    v_pk_add_f32 v[62:63], v[42:43], v[80:81] op_sel:[0,1] neg_lo:[0,1] neg_hi:[0,1]
    v_pk_add_f32 v[64:65], v[44:45], v[80:81] op_sel:[0,1] neg_lo:[0,1] neg_hi:[0,1]
    v_pk_add_f32 v[66:67], v[46:47], v[80:81] op_sel:[0,1] neg_lo:[0,1] neg_hi:[0,1]
    v_cvt_pk_bf16_f32 v57, v56, v57
    v_cvt_pk_bf16_f32 v59, v58, v59
    v_cvt_pk_bf16_f32 v61, v60, v61
    v_cvt_pk_bf16_f32 v63, v62, v63
    v_cvt_pk_bf16_f32 v65, v64, v65
    v_cvt_pk_bf16_f32 v67, v66, v67
    v_lshlrev_b32 v56, 16, v57
    v_and_b32 v57, 0xffff0000, v57
    v_lshlrev_b32 v58, 16, v59
    v_and_b32 v59, 0xffff0000, v59
    v_lshlrev_b32 v60, 16, v61
    v_and_b32 v61, 0xffff0000, v61
    v_lshlrev_b32 v62, 16, v63
    v_and_b32 v63, 0xffff0000, v63
    v_lshlrev_b32 v64, 16, v65
    v_and_b32 v65, 0xffff0000, v65
    v_lshlrev_b32 v66, 16, v67
    v_and_b32 v67, 0xffff0000, v67
    v_pk_mul_f32 v[56:57], v[56:57], v[82:83] op_sel_hi:[1,0]
    v_pk_mul_f32 v[58:59], v[58:59], v[82:83] op_sel_hi:[1,0]
    v_pk_mul_f32 v[60:61], v[60:61], v[82:83] op_sel_hi:[1,0]
    v_pk_mul_f32 v[62:63], v[62:63], v[82:83] op_sel:[0,1]
    v_pk_mul_f32 v[64:65], v[64:65], v[82:83] op_sel:[0,1]
    v_pk_mul_f32 v[66:67], v[66:67], v[82:83] op_sel:[0,1]
    v_cvt_pk_bf16_f32 v28, v56, v57
    v_cvt_pk_bf16_f32 v29, v58, v59
    v_cvt_pk_bf16_f32 v30, v60, v61
    ds_write_b128 v86, v[28:31]
    v_cvt_pk_bf16_f32 v32, v62, v63
    v_cvt_pk_bf16_f32 v33, v64, v65
    v_cvt_pk_bf16_f32 v34, v66, v67
    ds_write_b128 v86, v[32:35] offset:1024
    ds_read_b128 v[56:59], v87
    ds_read_b128 v[60:63], v87 offset:1024
    v_dot2c_f32_bf16 v36, s54, v28
    v_dot2c_f32_bf16 v37, s55, v28
    v_dot2c_f32_bf16 v38, s54, v29
    v_dot2c_f32_bf16 v39, s55, v29
    v_dot2c_f32_bf16 v40, s54, v30
    v_dot2c_f32_bf16 v41, s55, v30
    v_dot2c_f32_bf16 v42, s54, v32
    v_dot2c_f32_bf16 v43, s55, v32
    v_dot2c_f32_bf16 v44, s54, v33
    v_dot2c_f32_bf16 v45, s55, v33
    v_dot2c_f32_bf16 v46, s54, v34
    v_dot2c_f32_bf16 v47, s55, v34
    s_waitcnt lgkmcnt(1)
    buffer_store_dwordx4 v[56:59], v88, s[40:43], s48 offen sc1
    s_waitcnt lgkmcnt(0)
    buffer_store_dwordx4 v[60:63], v88, s[40:43], s48 offen offset:1536 sc1
    v_cvt_pk_bf16_f32 v48, v36, v37
    v_cvt_pk_bf16_f32 v49, v38, v39
    v_cvt_pk_bf16_f32 v50, v40, v41
    v_cvt_pk_bf16_f32 v51, v42, v43
    v_cvt_pk_bf16_f32 v52, v44, v45
    v_cvt_pk_bf16_f32 v53, v46, v47
    v_add_u32 v10, 1168, v89
    ds_write2_b32 v89, v48, v49 offset0:0 offset1:1
    ds_write_b32 v89, v50 offset:8
    ds_write2_b32 v10, v51, v52 offset0:0 offset1:1
    ds_write_b32 v10, v53 offset:8
    v_add_u32 v11, 12288, v92
    s_waitcnt lgkmcnt(0)
    s_barrier
    ds_read_b128 v[16:19], v90
    ds_read_b128 v[20:23], v91
    v_mov_b32 v10, 0
    s_waitcnt lgkmcnt(1)
    global_store_dwordx4 v92, v[16:19], s[32:33] sc1
    s_cmp_ge_u32 s38, 6
    s_cbranch_scc1 L_O1
    s_waitcnt lgkmcnt(0)
    global_store_dwordx4 v11, v[20:23], s[32:33] sc1
L_O1:
    s_cmp_eq_u32 s38, 11
    s_cbranch_scc1 TOP8
    s_waitcnt vmcnt(0)
    s_mov_b64 exec, 0x1
    buffer_store_dword v167, v10, s[40:43], s50 offen sc1
    s_mov_b64 exec, -1
    s_branch END
FFN_DMA0:
    s_sub_u32 s61, s2, 192
    s_bfe_u32 s50, s38, 0x10003
    s_and_b32 s51, s38, 1
    s_bfe_u32 s52, s38, 0x10001
    s_mul_i32 s52, s52, 36
    s_add_u32 s52, s52, s51
    s_mul_i32 s48, s52, 73728
    s_lshl_b32 s53, s61, 7
    s_add_u32 s48, s48, s53
    s_lshl_b32 s49, s52, 10
    s_mul_i32 s53, s50, 73728
    s_add_u32 s49, s49, s53
    s_lshl_b32 s51, s51, 1
    s_lshl_b32 s53, s50, 2
    s_or_b32 s51, s51, s53
    v_bfe_u32 v2, v1, 4, 1
    v_and_b32 v4, 7, v1
    v_xor_b32 v2, v2, v4
    v_xor_b32 v2, s51, v2
    v_lshrrev_b32 v4, 3, v1
    v_mul_u32_u24 v4, 0x2400, v4
    v_lshl_add_u32 v2, v2, 4, v4
    s_mov_b32 s46, 5308416
    s_mov_b32 s47, 0x00020000
    s_waitcnt lgkmcnt(0)
    s_cmp_eq_u32 s50, 0
    s_cselect_b32 s44, s26, s28
    s_cselect_b32 s45, s27, s29
    s_mov_b32 s40, s36
    s_mov_b32 s41, s37
    s_barrier
F_B:
    s_barrier
    s_add_u32 m0, s49, 0
    s_add_u32 s53, s48, 0
    buffer_load_dwordx4 v2, s[44:47], s53 offen lds
    s_add_u32 m0, s49, 2048
    s_add_u32 s53, s48, 147456
    buffer_load_dwordx4 v2, s[44:47], s53 offen lds
    s_add_u32 m0, s49, 4096
    s_add_u32 s53, s48, 294912
    buffer_load_dwordx4 v2, s[44:47], s53 offen lds
    s_add_u32 m0, s49, 6144
    s_add_u32 s53, s48, 442368
    buffer_load_dwordx4 v2, s[44:47], s53 offen lds
    s_add_u32 m0, s49, 8192
    s_add_u32 s53, s48, 589824
    buffer_load_dwordx4 v2, s[44:47], s53 offen lds
    s_add_u32 m0, s49, 10240
    s_add_u32 s53, s48, 737280
    buffer_load_dwordx4 v2, s[44:47], s53 offen lds
    s_add_u32 m0, s49, 12288
    s_add_u32 s53, s48, 884736
    buffer_load_dwordx4 v2, s[44:47], s53 offen lds
    s_add_u32 m0, s49, 14336
    s_add_u32 s53, s48, 1032192
    buffer_load_dwordx4 v2, s[44:47], s53 offen lds
    s_add_u32 m0, s49, 16384
    s_add_u32 s53, s48, 1179648
    buffer_load_dwordx4 v2, s[44:47], s53 offen lds
    s_add_u32 m0, s49, 18432
    s_add_u32 s53, s48, 1327104
    buffer_load_dwordx4 v2, s[44:47], s53 offen lds
    s_add_u32 m0, s49, 20480
    s_add_u32 s53, s48, 1474560
    buffer_load_dwordx4 v2, s[44:47], s53 offen lds
    s_add_u32 m0, s49, 22528
    s_add_u32 s53, s48, 1622016
    buffer_load_dwordx4 v2, s[44:47], s53 offen lds
    s_add_u32 m0, s49, 24576
    s_add_u32 s53, s48, 1769472
    buffer_load_dwordx4 v2, s[44:47], s53 offen lds
    s_add_u32 m0, s49, 26624
    s_add_u32 s53, s48, 1916928
    buffer_load_dwordx4 v2, s[44:47], s53 offen lds
    s_add_u32 m0, s49, 28672
    s_add_u32 s53, s48, 2064384
    buffer_load_dwordx4 v2, s[44:47], s53 offen lds
    s_add_u32 m0, s49, 30720
    s_add_u32 s53, s48, 2211840
    buffer_load_dwordx4 v2, s[44:47], s53 offen lds
    s_add_u32 m0, s49, 32768
    s_add_u32 s53, s48, 2359296
    buffer_load_dwordx4 v2, s[44:47], s53 offen lds
    s_add_u32 m0, s49, 34816
    s_add_u32 s53, s48, 2506752
    buffer_load_dwordx4 v2, s[44:47], s53 offen lds
    s_cmp_ge_u32 s2, 192
    s_cbranch_scc1 F_W
    s_branch F_W
FFN_LATE:
    s_sub_u32 s61, s2, 120
    s_cmp_lt_u32 s38, 4
    s_cbranch_scc1 F_B0
    s_bfe_u32 s50, s38, 0x10003
    s_and_b32 s51, s38, 1
    s_bfe_u32 s52, s38, 0x10001
    s_mul_i32 s52, s52, 36
    s_add_u32 s52, s52, s51
    s_mul_i32 s48, s52, 73728
    s_lshl_b32 s53, s61, 7
    s_add_u32 s48, s48, s53
    s_lshl_b32 s49, s52, 10
    s_mul_i32 s53, s50, 73728
    s_add_u32 s49, s49, s53
    s_lshl_b32 s51, s51, 1
    s_lshl_b32 s53, s50, 2
    s_or_b32 s51, s51, s53
    v_bfe_u32 v2, v1, 4, 1
    v_and_b32 v4, 7, v1
    v_xor_b32 v2, v2, v4
    v_xor_b32 v2, s51, v2
    v_lshrrev_b32 v4, 3, v1
    v_mul_u32_u24 v4, 0x2400, v4
    v_lshl_add_u32 v2, v2, 4, v4
    s_mov_b32 s46, 5308416
    s_mov_b32 s47, 0x00020000
    s_cmp_eq_u32 s50, 0
    s_cselect_b32 s44, s26, s28
    s_cselect_b32 s45, s27, s29
    s_branch F_B
FFN_DMA:
    s_sub_u32 s61, s2, 192
    s_waitcnt vmcnt(0)
F_B0:
    s_barrier
F_W:
    v_mov_b32 v167, 156684
    ds_read_b32 v167, v167
    v_and_b32 v7, 7, v1
    v_lshrrev_b32 v8, 3, v1
    v_and_b32 v5, 15, v1
    v_lshrrev_b32 v6, 4, v1
    s_mul_i32 s52, s61, 73728
    s_mul_i32 s53, s38, 96
    s_add_u32 s52, s52, s53
    v_mul_u32_u24 v9, 0x480, v8
    v_mad_u32_u24 v9, v7, 12, v9
    v_add_u32 v9, s52, v9
    global_load_dwordx3 v[16:18], v9, s[30:31]
    v_add_u32 v9, 0x2400, v9
    global_load_dwordx3 v[20:22], v9, s[30:31]
    v_add_u32 v9, 0x2400, v9
    global_load_dwordx3 v[24:26], v9, s[30:31]
    v_add_u32 v9, 0x2400, v9
    global_load_dwordx3 v[28:30], v9, s[30:31]
    v_add_u32 v9, 0x2400, v9
    global_load_dwordx3 v[32:34], v9, s[30:31]
    v_add_u32 v9, 0x2400, v9
    global_load_dwordx3 v[36:38], v9, s[30:31]
    v_add_u32 v9, 0x2400, v9
    global_load_dwordx3 v[40:42], v9, s[30:31]
    v_add_u32 v9, 0x2400, v9
    global_load_dwordx3 v[44:46], v9, s[30:31]
    v_mul_u32_u24 v10, 683, v0
    v_lshrrev_b32 v10, 16, v10
    v_mul_u32_u24 v11, 0x60, v10
    v_sub_u32 v11, v0, v11
    s_mov_b32 s52, 161920
    v_lshl_add_u32 v160, v10, 2, s52
    s_mov_b32 s52, 3144192
    v_lshl_add_u32 v161, v11, 4, s52
    v_mul_u32_u24 v162, 1184, v10
    v_mad_u32_u24 v162, v11, 12, v162
    v_add_u32 v162, 147456, v162
    v_mul_u32_u24 v163, 1184, v7
    v_lshl_add_u32 v163, v6, 4, v163
    v_add_u32 v163, 147456, v163
    s_lshr_b32 s52, s38, 2
    s_lshl_b32 s52, s52, 10
    s_and_b32 s53, s38, 3
    s_lshl_b32 s53, s53, 2
    s_add_u32 s52, s52, s53
    s_add_u32 s52, s52, 156928
    v_add_u32 v164, s52, v3
    v_and_b32 v10, 1, v6
    v_mul_u32_u24 v10, 0x48, v10
    v_and_b32 v11, 1, v8
    v_add3_u32 v166, v10, v11, 2
    v_lshl_add_u32 v10, v11, 2, v10
    v_lshrrev_b32 v11, 1, v6
    v_add_u32 v165, v10, v11
    v_mul_u32_u24 v165, 0x2400, v165
    v_mul_u32_u24 v166, 0x2400, v166
    v_lshl_add_u32 v165, v7, 4, v165
    v_lshl_add_u32 v166, v7, 4, v166
    s_mul_i32 s62, s38, 55296
    s_lshl_b32 s53, s61, 7
    s_add_u32 s62, s62, s53
    s_add_u32 s62, s62, 9502720
    s_mov_b32 s63, 6356992
    s_movk_i32 s64, -1536
    v_and_b32 v10, 1, v1
    v_bfe_u32 v11, v1, 3, 2
    v_lshl_add_u32 v11, v10, 2, v11
    v_xor_b32 v11, s38, v11
    v_mul_u32_u24 v12, 73728, v10
    v_lshl_add_u32 v12, v11, 4, v12
    v_and_b32 v10, 2, v1
    v_lshl_add_u32 v12, v10, 2, v12
    v_bfe_u32 v10, v1, 2, 2
    v_lshl_add_u32 v10, v6, 3, v10
    v_lshl_add_u32 v12, v10, 7, v12
    v_add_u32 v13, 36864, v12
    v_mov_b32 v14, 161308
    v_mov_b32 v15, 1
    s_mov_b32 s52, 0x05040100
    s_mov_b32 s53, 0x07060302
    v_mov_b32 v10, s52
    s_mov_b32 exec_lo, 0xff00ff00
    s_mov_b32 exec_hi, 0xff00ff00
    v_mov_b32 v10, 0x03020706
    s_mov_b64 exec, -1
    s_waitcnt lgkmcnt(0)
    v_readfirstlane_b32 s39, v167
    s_cmp_lt_u32 s38, 4
    s_cbranch_scc1 F_NC
    s_waitcnt vmcnt(8)
    s_mov_b64 exec, 0x1
    ds_add_u32 v14, v15
    s_mov_b64 exec, -1
F_NC:
    s_waitcnt vmcnt(7)
    v_mov_b32 v19, v16
    v_mov_b32_dpp v11, v17 row_ror:8 row_mask:0xf bank_mask:0xf
    v_mov_b32_dpp v16, v18 row_ror:8 row_mask:0xf bank_mask:0xc
    v_mov_b32_dpp v18, v19 row_ror:8 row_mask:0xf bank_mask:0x3
    v_perm_b32 v152, v11, v17, v10
    v_perm_b32 v136, v18, v16, s52
    v_perm_b32 v144, v18, v16, s53
    s_waitcnt vmcnt(6)
    v_mov_b32 v23, v20
    v_mov_b32_dpp v11, v21 row_ror:8 row_mask:0xf bank_mask:0xf
    v_mov_b32_dpp v20, v22 row_ror:8 row_mask:0xf bank_mask:0xc
    v_mov_b32_dpp v22, v23 row_ror:8 row_mask:0xf bank_mask:0x3
    v_perm_b32 v153, v11, v21, v10
    v_perm_b32 v137, v22, v20, s52
    v_perm_b32 v145, v22, v20, s53
    s_waitcnt vmcnt(5)
    v_mov_b32 v27, v24
    v_mov_b32_dpp v11, v25 row_ror:8 row_mask:0xf bank_mask:0xf
    v_mov_b32_dpp v24, v26 row_ror:8 row_mask:0xf bank_mask:0xc
    v_mov_b32_dpp v26, v27 row_ror:8 row_mask:0xf bank_mask:0x3
    v_perm_b32 v154, v11, v25, v10
    v_perm_b32 v138, v26, v24, s52
    v_perm_b32 v146, v26, v24, s53
    s_waitcnt vmcnt(4)
    v_mov_b32 v31, v28
    v_mov_b32_dpp v11, v29 row_ror:8 row_mask:0xf bank_mask:0xf
    v_mov_b32_dpp v28, v30 row_ror:8 row_mask:0xf bank_mask:0xc
    v_mov_b32_dpp v30, v31 row_ror:8 row_mask:0xf bank_mask:0x3
    v_perm_b32 v155, v11, v29, v10
    v_perm_b32 v139, v30, v28, s52
    v_perm_b32 v147, v30, v28, s53
    s_waitcnt vmcnt(3)
    v_mov_b32 v35, v32
    v_mov_b32_dpp v11, v33 row_ror:8 row_mask:0xf bank_mask:0xf
    v_mov_b32_dpp v32, v34 row_ror:8 row_mask:0xf bank_mask:0xc
    v_mov_b32_dpp v34, v35 row_ror:8 row_mask:0xf bank_mask:0x3
    v_perm_b32 v156, v11, v33, v10
    v_perm_b32 v140, v34, v32, s52
    v_perm_b32 v148, v34, v32, s53
    s_waitcnt vmcnt(2)
    v_mov_b32 v39, v36
    v_mov_b32_dpp v11, v37 row_ror:8 row_mask:0xf bank_mask:0xf
    v_mov_b32_dpp v36, v38 row_ror:8 row_mask:0xf bank_mask:0xc
    v_mov_b32_dpp v38, v39 row_ror:8 row_mask:0xf bank_mask:0x3
    v_perm_b32 v157, v11, v37, v10
    v_perm_b32 v141, v38, v36, s52
    v_perm_b32 v149, v38, v36, s53
    s_waitcnt vmcnt(1)
    v_mov_b32 v43, v40
    v_mov_b32_dpp v11, v41 row_ror:8 row_mask:0xf bank_mask:0xf
    v_mov_b32_dpp v40, v42 row_ror:8 row_mask:0xf bank_mask:0xc
    v_mov_b32_dpp v42, v43 row_ror:8 row_mask:0xf bank_mask:0x3
    v_perm_b32 v158, v11, v41, v10
    v_perm_b32 v142, v42, v40, s52
    v_perm_b32 v150, v42, v40, s53
    s_waitcnt vmcnt(0)
    v_mov_b32 v47, v44
    v_mov_b32_dpp v11, v45 row_ror:8 row_mask:0xf bank_mask:0xf
    v_mov_b32_dpp v44, v46 row_ror:8 row_mask:0xf bank_mask:0xc
    v_mov_b32_dpp v46, v47 row_ror:8 row_mask:0xf bank_mask:0x3
    v_perm_b32 v159, v11, v45, v10
    v_perm_b32 v143, v46, v44, s52
    v_perm_b32 v151, v46, v44, s53
    s_cmp_ge_u32 s38, 8
    s_cbranch_scc1 F_NT
    s_movk_i32 s60, 4000
F_CP:
    ds_read_b32 v15, v14
    s_sub_u32 s60, s60, 1
    s_cmp_gt_i32 s60, 0
    s_waitcnt lgkmcnt(0)
    v_readfirstlane_b32 s52, v15
    s_nop 0
    s_cselect_b32 s52, s52, 8
    s_cmp_eq_u32 s52, 8
    s_cbranch_scc1 F_CD
    s_sleep 2
    s_branch F_CP
F_CD:
    ds_read_b64_tr_b16 v[64:65], v12 offset:0
    ds_read_b64_tr_b16 v[66:67], v12 offset:512
    ds_read_b64_tr_b16 v[68:69], v12 offset:4096
    ds_read_b64_tr_b16 v[70:71], v12 offset:4608
    ds_read_b64_tr_b16 v[72:73], v12 offset:8192
    ds_read_b64_tr_b16 v[74:75], v12 offset:8704
    ds_read_b64_tr_b16 v[76:77], v12 offset:12288
    ds_read_b64_tr_b16 v[78:79], v12 offset:12800
    ds_read_b64_tr_b16 v[80:81], v12 offset:16384
    ds_read_b64_tr_b16 v[82:83], v12 offset:16896
    ds_read_b64_tr_b16 v[84:85], v12 offset:20480
    ds_read_b64_tr_b16 v[86:87], v12 offset:20992
    ds_read_b64_tr_b16 v[88:89], v12 offset:24576
    ds_read_b64_tr_b16 v[90:91], v12 offset:25088
    ds_read_b64_tr_b16 v[92:93], v12 offset:28672
    ds_read_b64_tr_b16 v[94:95], v12 offset:29184
    ds_read_b64_tr_b16 v[96:97], v12 offset:32768
    ds_read_b64_tr_b16 v[98:99], v12 offset:33280
    ds_read_b64_tr_b16 v[100:101], v13 offset:0
    ds_read_b64_tr_b16 v[102:103], v13 offset:512
    ds_read_b64_tr_b16 v[104:105], v13 offset:4096
    ds_read_b64_tr_b16 v[106:107], v13 offset:4608
    ds_read_b64_tr_b16 v[108:109], v13 offset:8192
    ds_read_b64_tr_b16 v[110:111], v13 offset:8704
    ds_read_b64_tr_b16 v[112:113], v13 offset:12288
    ds_read_b64_tr_b16 v[114:115], v13 offset:12800
    ds_read_b64_tr_b16 v[116:117], v13 offset:16384
    ds_read_b64_tr_b16 v[118:119], v13 offset:16896
    ds_read_b64_tr_b16 v[120:121], v13 offset:20480
    ds_read_b64_tr_b16 v[122:123], v13 offset:20992
    ds_read_b64_tr_b16 v[124:125], v13 offset:24576
    ds_read_b64_tr_b16 v[126:127], v13 offset:25088
    ds_read_b64_tr_b16 v[128:129], v13 offset:28672
    ds_read_b64_tr_b16 v[130:131], v13 offset:29184
    ds_read_b64_tr_b16 v[132:133], v13 offset:32768
    ds_read_b64_tr_b16 v[134:135], v13 offset:33280
F_NT:
    s_cmp_lg_u32 s38, 11
    s_cbranch_scc1 F_SEL
    s_branch T_EV
FINAL:
    s_cmp_ge_u32 s2, 144
    s_cbranch_scc1 END
    s_cmp_lg_u32 s38, 11
    s_cbranch_scc1 END
T_EV:
TOP8:
    v_bfe_i32 v7, v1, 0, 1
    v_bfe_i32 v8, v1, 1, 1
    v_bfe_i32 v9, v1, 3, 1
    v_bfe_i32 v11, v1, 4, 1
    v_bfe_i32 v13, v1, 5, 1
    v_xor_b32 v48, v7, v8
    v_xor_b32 v49, v8, v9
    v_xor_b32 v50, v7, v9
    v_xor_b32 v11, v11, v13
    v_xor_b32 v51, v9, v11
    v_xor_b32 v52, v8, v11
    v_xor_b32 v53, v7, v11
    v_sub_u32 v54, 148464, v3
    v_and_b32 v7, 4, v1
    v_and_b32 v8, 48, v1
    v_lshlrev_b32 v8, 6, v8
    v_lshl_add_u32 v55, v7, 1, v8
    v_add_u32 v55, 147456, v55
    s_mov_b32 s65, 32768
    s_mov_b32 s66, 36864
    s_and_b32 s67, s2, 127
    s_lshl_b32 s68, s67, 6
    s_add_u32 s68, s68, 32768
    v_mov_b32 v10, 0
    s_cmp_lt_u32 s2, 128
    s_cbranch_scc0 T_E2
    s_waitcnt vmcnt(0)
    s_mov_b64 exec, 0x1
    buffer_store_dword v167, v10, s[40:43], s50 offen sc1
    s_branch T_H
T_E2:
    s_mul_i32 s67, s67, 24576
    s_add_u32 s67, s67, 3230092
    s_mov_b64 exec, 0x1
    s_movk_i32 s60, 4000
T_EP:
    buffer_load_dword v11, v10, s[40:43], s67 offen sc1
T_EP_W:
    s_waitcnt vmcnt(0)
    v_cmp_ne_u32 vcc, s39, v11
    s_nop 0
    s_and_b64 exec, exec, vcc
    s_cbranch_execz T_EP_D
    s_sub_u32 s60, s60, 1
    s_cmp_gt_i32 s60, 0
    s_sleep 2
    s_cbranch_scc1 T_EP
T_EP_D:
T_H:
    s_mov_b64 exec, 0x1
    s_movk_i32 s60, 4000
T_HP:
    buffer_load_dword v11, v10, s[40:43], s68 offen sc1
T_HP_W:
    s_waitcnt vmcnt(0)
    v_cmp_eq_u32 vcc, -1, v11
    s_nop 0
    s_and_b64 exec, exec, vcc
    s_cbranch_execz T_HP_D
    s_sub_u32 s60, s60, 1
    s_cmp_gt_i32 s60, 0
    s_sleep 1
    s_cbranch_scc1 T_HP
T_HP_D:
    s_mov_b64 exec, -1
    s_movk_i32 s60, 4000
T_KP:
    buffer_load_dwordx4 v[16:19], v3, s[40:43], s65 offen offset:0 sc1
    buffer_load_dwordx4 v[20:23], v3, s[40:43], s65 offen offset:1024 sc1
    buffer_load_dwordx4 v[24:27], v3, s[40:43], s65 offen offset:2048 sc1
    buffer_load_dwordx4 v[28:31], v3, s[40:43], s65 offen offset:3072 sc1
    buffer_load_dwordx4 v[32:35], v3, s[40:43], s66 offen offset:0 sc1
    buffer_load_dwordx4 v[36:39], v3, s[40:43], s66 offen offset:1024 sc1
    buffer_load_dwordx4 v[40:43], v3, s[40:43], s66 offen offset:2048 sc1
    buffer_load_dwordx4 v[44:47], v3, s[40:43], s66 offen offset:3072 sc1
T_KP_W:
    s_waitcnt vmcnt(0)
    v_max3_u32 v56, v16, v17, v18
    v_max3_u32 v58, v19, v20, v21
    v_max3_u32 v57, v32, v33, v34
    v_max3_u32 v59, v35, v36, v37
    v_max3_u32 v56, v56, v22, v23
    v_max3_u32 v58, v58, v24, v25
    v_max3_u32 v57, v57, v38, v39
    v_max3_u32 v59, v59, v40, v41
    v_max3_u32 v56, v56, v26, v27
    v_max3_u32 v58, v58, v28, v29
    v_max3_u32 v57, v57, v42, v43
    v_max3_u32 v59, v59, v44, v45
    v_max3_u32 v58, v58, v30, v31
    v_max3_u32 v59, v59, v46, v47
    v_max_u32 v56, v56, v58
    v_max_u32 v57, v57, v59
    v_max_u32 v58, v56, v57
    v_cmp_eq_u32 vcc, -1, v58
    s_nop 0
    s_and_b64 exec, exec, vcc
    s_cbranch_execz T_KP_D
    s_sub_u32 s60, s60, 1
    s_cmp_gt_i32 s60, 0
    s_cbranch_scc1 T_KP
T_KP_D:
    s_mov_b64 exec, -1
    v_mov_b32_dpp v58, v56 quad_perm:[1,0,3,2] row_mask:0xf bank_mask:0xf
    v_mov_b32_dpp v59, v57 quad_perm:[1,0,3,2] row_mask:0xf bank_mask:0xf
    v_med3_u32 v56, v56, v58, v48
    v_med3_u32 v57, v57, v59, v48
    ds_write_b128 v54, v[16:19] offset:7168
    v_mov_b32_dpp v58, v56 quad_perm:[2,3,0,1] row_mask:0xf bank_mask:0xf
    v_mov_b32_dpp v59, v57 quad_perm:[2,3,0,1] row_mask:0xf bank_mask:0xf
    v_med3_u32 v56, v56, v58, v49
    v_med3_u32 v57, v57, v59, v49
    ds_write_b128 v54, v[20:23] offset:6144
    v_mov_b32_dpp v58, v56 quad_perm:[1,0,3,2] row_mask:0xf bank_mask:0xf
    v_mov_b32_dpp v59, v57 quad_perm:[1,0,3,2] row_mask:0xf bank_mask:0xf
    v_med3_u32 v56, v56, v58, v50
    v_med3_u32 v57, v57, v59, v50
    ds_write_b128 v54, v[24:27] offset:5120
    v_mov_b32_dpp v58, v56 row_ror:8 row_mask:0xf bank_mask:0xf
    v_mov_b32_dpp v59, v57 row_ror:8 row_mask:0xf bank_mask:0xf
    v_med3_u32 v56, v56, v58, v51
    v_med3_u32 v57, v57, v59, v51
    ds_write_b128 v54, v[28:31] offset:4096
    v_mov_b32_dpp v58, v56 quad_perm:[2,3,0,1] row_mask:0xf bank_mask:0xf
    v_mov_b32_dpp v59, v57 quad_perm:[2,3,0,1] row_mask:0xf bank_mask:0xf
    v_med3_u32 v56, v56, v58, v52
    v_med3_u32 v57, v57, v59, v52
    ds_write_b128 v54, v[32:35] offset:3072
    v_mov_b32_dpp v58, v56 quad_perm:[1,0,3,2] row_mask:0xf bank_mask:0xf
    v_mov_b32_dpp v59, v57 quad_perm:[1,0,3,2] row_mask:0xf bank_mask:0xf
    v_med3_u32 v56, v56, v58, v53
    v_med3_u32 v57, v57, v59, v53
    ds_write_b128 v54, v[36:39] offset:2048
    s_nop 0
    v_max_u32_dpp v56, v57, v56 row_mirror row_mask:0xf bank_mask:0xf
    ds_write_b128 v54, v[40:43] offset:1024
    s_nop 0
    v_mov_b32_dpp v58, v56 row_ror:8 row_mask:0xf bank_mask:0xf
    v_med3_u32 v56, v56, v58, v51
    ds_write_b128 v54, v[44:47] offset:0
    s_nop 0
    v_mov_b32_dpp v58, v56 quad_perm:[2,3,0,1] row_mask:0xf bank_mask:0xf
    v_med3_u32 v56, v56, v58, v52
    s_nop 1
    v_mov_b32_dpp v58, v56 quad_perm:[1,0,3,2] row_mask:0xf bank_mask:0xf
    v_med3_u32 v56, v56, v58, v53
    s_nop 1
    v_max_u32_dpp v56, v56, v56 row_mirror row_mask:0xf bank_mask:0xf
    s_nop 1
    v_mov_b32_dpp v58, v56 row_ror:8 row_mask:0xf bank_mask:0xf
    v_med3_u32 v56, v56, v58, v51
    s_nop 1
    v_mov_b32_dpp v58, v56 quad_perm:[2,3,0,1] row_mask:0xf bank_mask:0xf
    v_med3_u32 v56, v56, v58, v52
    s_nop 1
    v_mov_b32_dpp v58, v56 quad_perm:[1,0,3,2] row_mask:0xf bank_mask:0xf
    v_med3_u32 v57, v56, v58, v53
    v_med3_u32 v56, v56, v58, v53
    s_nop 1
    v_permlane16_swap_b32 v56, v57
    v_max_u32 v56, v56, v57
    s_nop 1
    v_mov_b32_dpp v58, v56 row_ror:8 row_mask:0xf bank_mask:0xf
    v_med3_u32 v56, v56, v58, v51
    s_nop 1
    v_mov_b32_dpp v58, v56 quad_perm:[2,3,0,1] row_mask:0xf bank_mask:0xf
    v_med3_u32 v56, v56, v58, v52
    s_nop 1
    v_mov_b32_dpp v58, v56 quad_perm:[1,0,3,2] row_mask:0xf bank_mask:0xf
    v_med3_u32 v57, v56, v58, v53
    v_med3_u32 v56, v56, v58, v53
    s_nop 1
    v_permlane32_swap_b32 v56, v57
    v_max_u32 v56, v56, v57
    v_and_b32 v56, 0x4fc, v56
    v_lshl_or_b32 v56, v56, 2, v55
    ds_read_b64 v[56:57], v56
    v_and_b32 v7, 3, v1
    v_and_b32 v8, 8, v1
    v_lshlrev_b32 v7, 2, v7
    v_lshl_add_u32 v7, v8, 1, v7
    v_add_u32 v7, 161920, v7
    s_waitcnt lgkmcnt(0)
    v_mov_b32_dpp v58, v56 quad_perm:[1,0,3,2] row_mask:0xf bank_mask:0xf
    v_mov_b32_dpp v59, v57 quad_perm:[1,0,3,2] row_mask:0xf bank_mask:0xf
    v_med3_u32 v56, v56, v58, v48
    v_med3_u32 v57, v57, v59, v48
    s_nop 0
    v_mov_b32_dpp v58, v56 quad_perm:[2,3,0,1] row_mask:0xf bank_mask:0xf
    v_mov_b32_dpp v59, v57 quad_perm:[2,3,0,1] row_mask:0xf bank_mask:0xf
    v_med3_u32 v56, v56, v58, v49
    v_med3_u32 v57, v57, v59, v49
    s_nop 0
    v_mov_b32_dpp v58, v56 quad_perm:[1,0,3,2] row_mask:0xf bank_mask:0xf
    v_mov_b32_dpp v59, v57 quad_perm:[1,0,3,2] row_mask:0xf bank_mask:0xf
    v_med3_u32 v56, v56, v58, v50
    v_med3_u32 v57, v57, v59, v50
    s_nop 0
    v_mov_b32_dpp v58, v56 row_ror:8 row_mask:0xf bank_mask:0xf
    v_mov_b32_dpp v59, v57 row_ror:8 row_mask:0xf bank_mask:0xf
    v_med3_u32 v56, v56, v58, v51
    v_med3_u32 v57, v57, v59, v51
    s_nop 0
    v_mov_b32_dpp v58, v56 quad_perm:[2,3,0,1] row_mask:0xf bank_mask:0xf
    v_mov_b32_dpp v59, v57 quad_perm:[2,3,0,1] row_mask:0xf bank_mask:0xf
    v_med3_u32 v56, v56, v58, v52
    v_med3_u32 v57, v57, v59, v52
    s_nop 0
    v_mov_b32_dpp v58, v56 quad_perm:[1,0,3,2] row_mask:0xf bank_mask:0xf
    v_mov_b32_dpp v59, v57 quad_perm:[1,0,3,2] row_mask:0xf bank_mask:0xf
    v_med3_u32 v56, v56, v58, v53
    v_med3_u32 v57, v57, v59, v53
    s_nop 1
    v_max_u32_dpp v56, v57, v56 row_mirror row_mask:0xf bank_mask:0xf
    s_nop 1
    v_mov_b32_dpp v58, v56 row_ror:8 row_mask:0xf bank_mask:0xf
    v_med3_u32 v56, v56, v58, v51
    s_nop 1
    v_mov_b32_dpp v58, v56 quad_perm:[2,3,0,1] row_mask:0xf bank_mask:0xf
    v_med3_u32 v56, v56, v58, v52
    s_nop 1
    v_mov_b32_dpp v58, v56 quad_perm:[1,0,3,2] row_mask:0xf bank_mask:0xf
    v_med3_u32 v56, v56, v58, v53
    s_nop 1
    v_max_u32_dpp v56, v56, v56 row_mirror row_mask:0xf bank_mask:0xf
    s_nop 1
    v_mov_b32_dpp v58, v56 row_ror:8 row_mask:0xf bank_mask:0xf
    v_med3_u32 v56, v56, v58, v51
    s_nop 1
    v_mov_b32_dpp v58, v56 quad_perm:[2,3,0,1] row_mask:0xf bank_mask:0xf
    v_med3_u32 v56, v56, v58, v52
    s_nop 1
    v_mov_b32_dpp v58, v56 quad_perm:[1,0,3,2] row_mask:0xf bank_mask:0xf
    v_med3_u32 v57, v56, v58, v53
    v_med3_u32 v56, v56, v58, v53
    s_nop 1
    v_permlane16_swap_b32 v56, v57
    v_max_u32 v56, v56, v57
    s_nop 1
    v_mov_b32_dpp v58, v56 row_ror:8 row_mask:0xf bank_mask:0xf
    v_med3_u32 v56, v56, v58, v51
    s_nop 1
    v_mov_b32_dpp v58, v56 quad_perm:[2,3,0,1] row_mask:0xf bank_mask:0xf
    v_med3_u32 v56, v56, v58, v52
    s_nop 1
    v_mov_b32_dpp v58, v56 quad_perm:[1,0,3,2] row_mask:0xf bank_mask:0xf
    v_med3_u32 v57, v56, v58, v53
    v_med3_u32 v56, v56, v58, v53
    s_nop 1
    v_permlane32_swap_b32 v56, v57
    v_max_u32 v56, v56, v57
    s_cmp_lt_u32 s2, 144
    s_cbranch_scc1 FIN
    s_mov_b64 exec, 0xf0f
    ds_write_b32 v7, v56
    s_mov_b64 exec, -1
F_SEL:
    s_waitcnt lgkmcnt(0)
    s_barrier
    ds_read_b32 v7, v160
    s_waitcnt lgkmcnt(0)
    v_and_b32 v7, 0x7ff, v7
    v_mad_i32_i24 v7, v7, s64, v161
    s_movk_i32 s60, 4000
F_ZP:
    buffer_load_dwordx4 v[8:11], v7, s[40:43], s63 offen sc1
F_ZP_W:
    s_waitcnt vmcnt(0)
    v_cmp_ne_u32 vcc, s39, v11
    s_nop 0
    s_and_b64 exec, exec, vcc
    s_cbranch_execz F_ZP_D
    s_sub_u32 s60, s60, 1
    s_cmp_gt_i32 s60, 0
    s_cbranch_scc1 F_ZP
F_ZP_D:
    s_mov_b64 exec, -1
    ds_write2_b32 v162, v8, v9 offset0:0 offset1:1
    ds_write_b32 v162, v10 offset:8
    v_add_u32 v7, 156928, v3
    s_waitcnt lgkmcnt(0)
    s_barrier
    s_cmp_ge_u32 s38, 8
    s_cbranch_scc1 F_H
    ds_read_b128 v[16:19], v163 offset:0
    ds_read_b128 v[20:23], v163 offset:64
    ds_read_b128 v[24:27], v163 offset:128
    ds_read_b128 v[28:31], v163 offset:192
    ds_read_b128 v[32:35], v163 offset:256
    ds_read_b128 v[36:39], v163 offset:320
    ds_read_b128 v[40:43], v163 offset:384
    ds_read_b128 v[44:47], v163 offset:448
    ds_read_b128 v[48:51], v163 offset:512
    ds_read_b128 v[52:55], v163 offset:576
    ds_read_b128 v[56:59], v163 offset:640
    ds_read_b128 v[60:63], v163 offset:704
    s_waitcnt lgkmcnt(11)
    v_mfma_f32_16x16x32_bf16 v[8:11], v[64:67], v[16:19], 0
    s_waitcnt lgkmcnt(10)
    v_mfma_f32_16x16x32_bf16 v[8:11], v[68:71], v[20:23], v[8:11]
    ds_read_b128 v[16:19], v163 offset:768
    s_waitcnt lgkmcnt(10)
    v_mfma_f32_16x16x32_bf16 v[8:11], v[72:75], v[24:27], v[8:11]
    ds_read_b128 v[20:23], v163 offset:832
    s_waitcnt lgkmcnt(10)
    v_mfma_f32_16x16x32_bf16 v[8:11], v[76:79], v[28:31], v[8:11]
    ds_read_b128 v[24:27], v163 offset:896
    s_waitcnt lgkmcnt(10)
    v_mfma_f32_16x16x32_bf16 v[8:11], v[80:83], v[32:35], v[8:11]
    ds_read_b128 v[28:31], v163 offset:960
    s_waitcnt lgkmcnt(10)
    v_mfma_f32_16x16x32_bf16 v[8:11], v[84:87], v[36:39], v[8:11]
    ds_read_b128 v[32:35], v163 offset:1024
    s_waitcnt lgkmcnt(10)
    v_mfma_f32_16x16x32_bf16 v[8:11], v[88:91], v[40:43], v[8:11]
    ds_read_b128 v[36:39], v163 offset:1088
    s_waitcnt lgkmcnt(10)
    v_mfma_f32_16x16x32_bf16 v[8:11], v[92:95], v[44:47], v[8:11]
    s_waitcnt lgkmcnt(9)
    v_mfma_f32_16x16x32_bf16 v[8:11], v[96:99], v[48:51], v[8:11]
    s_waitcnt lgkmcnt(8)
    v_mfma_f32_16x16x32_bf16 v[8:11], v[100:103], v[52:55], v[8:11]
    s_waitcnt lgkmcnt(7)
    v_mfma_f32_16x16x32_bf16 v[8:11], v[104:107], v[56:59], v[8:11]
    s_waitcnt lgkmcnt(6)
    v_mfma_f32_16x16x32_bf16 v[8:11], v[108:111], v[60:63], v[8:11]
    s_waitcnt lgkmcnt(5)
    v_mfma_f32_16x16x32_bf16 v[8:11], v[112:115], v[16:19], v[8:11]
    s_waitcnt lgkmcnt(4)
    v_mfma_f32_16x16x32_bf16 v[8:11], v[116:119], v[20:23], v[8:11]
    s_waitcnt lgkmcnt(3)
    v_mfma_f32_16x16x32_bf16 v[8:11], v[120:123], v[24:27], v[8:11]
    s_waitcnt lgkmcnt(2)
    v_mfma_f32_16x16x32_bf16 v[8:11], v[124:127], v[28:31], v[8:11]
    s_waitcnt lgkmcnt(1)
    v_mfma_f32_16x16x32_bf16 v[8:11], v[128:131], v[32:35], v[8:11]
    s_waitcnt lgkmcnt(0)
    v_mfma_f32_16x16x32_bf16 v[8:11], v[132:135], v[36:39], v[8:11]
    s_nop 7
    v_permlane16_swap_b32 v8, v10
    v_permlane16_swap_b32 v9, v11
    v_cvt_pk_bf16_f32 v9, v8, v9
    v_cvt_pk_bf16_f32 v11, v10, v11
    v_lshlrev_b32 v8, 16, v9
    v_and_b32 v9, 0xffff0000, v9
    v_mul_f32 v12, 0xbfb8aa3b, v8
    v_mul_f32 v13, 0xbfb8aa3b, v9
    v_exp_f32 v12, v12
    v_exp_f32 v13, v13
    v_lshlrev_b32 v10, 16, v11
    v_and_b32 v11, 0xffff0000, v11
    v_add_f32 v12, 1.0, v12
    v_add_f32 v13, 1.0, v13
    v_rcp_f32 v12, v12
    v_rcp_f32 v13, v13
    v_mul_f32 v8, v8, v12
    v_mul_f32 v9, v9, v13
    v_cvt_pk_bf16_f32 v9, v8, v9
    v_lshlrev_b32 v8, 16, v9
    v_and_b32 v9, 0xffff0000, v9
    v_mul_f32 v8, v8, v10
    v_mul_f32 v9, v9, v11
    v_cvt_pk_bf16_f32 v8, v8, v9
    ds_write_b32 v164, v8
F_H:
    v_mov_b32 v16, 0
    v_mov_b32 v17, 0
    v_mov_b32 v18, 0
    v_mov_b32 v19, 0
    v_mov_b32 v20, 0
    v_mov_b32 v21, 0
    v_mov_b32 v22, 0
    v_mov_b32 v23, 0
    v_mov_b32 v24, 0
    v_mov_b32 v25, 0
    v_mov_b32 v26, 0
    v_mov_b32 v27, 0
    v_mov_b32 v28, 0
    v_mov_b32 v29, 0
    v_mov_b32 v30, 0
    v_mov_b32 v31, 0
    s_waitcnt lgkmcnt(0)
    s_barrier
    s_mov_b32 exec_lo, 0xff00ff
    s_mov_b32 exec_hi, 0xff00ff
    ds_read_b128 v[16:19], v7
    ds_read_b128 v[20:23], v7 offset:1024
    s_not_b64 exec, exec
    ds_read_b128 v[24:27], v7
    ds_read_b128 v[28:31], v7 offset:1024
    s_mov_b64 exec, -1
    s_waitcnt lgkmcnt(3)
    v_mfma_f32_16x16x32_bf16 v[12:15], v[16:19], v[152:155], 0
    v_mfma_f32_16x16x32_bf16 v[8:11], v[16:19], v[136:139], 0
    s_waitcnt lgkmcnt(2)
    v_mfma_f32_16x16x32_bf16 v[12:15], v[20:23], v[156:159], v[12:15]
    v_mfma_f32_16x16x32_bf16 v[8:11], v[20:23], v[140:143], v[8:11]
    s_waitcnt lgkmcnt(1)
    v_mfma_f32_16x16x32_bf16 v[8:11], v[24:27], v[144:147], v[8:11]
    s_waitcnt lgkmcnt(0)
    v_mfma_f32_16x16x32_bf16 v[8:11], v[28:31], v[148:151], v[8:11]
    s_mov_b32 exec_hi, 0
    s_nop 1
    buffer_store_dwordx4 v[12:15], v166, s[40:43], s62 offen sc1
    s_mov_b64 exec, -1
    s_nop 2
    buffer_store_dwordx4 v[8:11], v165, s[40:43], s62 offen sc1
    s_branch END
FIN:
    s_cmp_ge_u32 s2, 72
    s_cselect_b32 s44, 32, 0
    s_cselect_b32 s45, 72, 0
    s_sub_u32 s45, s2, s45
    s_mul_i32 s46, s45, 43
    s_lshr_b32 s46, s46, 8
    s_mul_i32 s47, s46, 6
    s_sub_u32 s47, s45, s47
    v_lshrrev_b32 v6, 4, v1
    v_lshl_add_u32 v7, v6, 2, s44
    ds_bpermute_b32 v7, v7, v56
    v_and_b32 v8, 7, v1
    v_and_b32 v5, 15, v1
    s_lshl_b32 s48, s47, 2
    s_add_u32 s49, s48, 1024 - 16
    s_cmp_eq_u32 s47, 3
    s_cselect_b32 s49, 1024 + 8, s49
    s_cmp_lt_u32 s47, 3
    s_cselect_b32 s48, s48, s49
    s_lshl_b32 s49, s46, 11
    s_add_u32 s48, s48, s49
    s_add_u32 s48, s48, 3211264
    s_lshl_b32 s47, s47, 1
    s_lshl_b32 s49, s46, 7
    s_add_u32 s49, s49, s47
    s_add_u32 s49, s49, 6356992
    s_mul_i32 s46, s46, 96
    s_add_u32 s46, s46, s47
    s_movk_i32 s47, 8192
    s_mul_i32 s52, s2, 9216
    s_add_u32 s52, s52, 9502720
    s_add_u32 s53, s52, 4096
    s_add_u32 s54, s52, 8192
    v_mov_b32 v60, 0
    v_mov_b32 v61, 0
    v_mov_b32 v62, 0
    s_waitcnt lgkmcnt(0)
    v_and_b32 v9, 0x7ff, v7
    v_sub_u32 v9, 0x7ff, v9
    v_lshrrev_b32 v10, 4, v9
    v_lshlrev_b32 v11, 6, v10
    v_lshl_add_u32 v11, v5, 2, v11
    v_mul_u32_u24 v12, 0x480, v9
    v_mad_u32_u24 v12, v8, 12, v12
    v_add_u32 v12, s46, v12
    v_mul_u32_u24 v10, 0x6000, v10
    v_lshl_add_u32 v10, v8, 7, v10
    v_and_b32 v13, 14, v9
    v_lshl_add_u32 v10, v13, 3, v10
    v_and_b32 v13, 1, v9
    v_lshl_add_u32 v10, v13, 1, v10
    v_mul_u32_u24 v9, 0x600, v9
    v_lshl_add_u32 v9, v8, 4, v9
    global_load_short_d16_hi v60, v12, s[4:5]
    buffer_load_short_d16_hi v61, v10, s[40:43], s48 offen sc1
    s_mov_b32 exec_lo, 0xfff0fff
    s_mov_b32 exec_hi, 0xfff0fff
    s_movk_i32 s60, 4000
FN_OF:
    buffer_load_dword v13, v11, s[40:43], s47 offen sc1
FN_OF_W:
    s_waitcnt vmcnt(0)
    v_cmp_ne_u32 vcc, s39, v13
    s_nop 0
    s_and_b64 exec, exec, vcc
    s_cbranch_execz FN_OF_D
    s_sub_u32 s60, s60, 1
    s_cmp_gt_i32 s60, 0
    s_sleep 1
    s_cbranch_scc1 FN_OF
FN_OF_D:
    s_mov_b64 exec, -1
    buffer_load_short_d16_hi v62, v9, s[40:43], s49 offen sc1
    v_ashrrev_i32 v13, 31, v7
    v_not_b32 v13, v13
    v_or_b32 v13, 0x80000000, v13
    v_xor_b32 v7, v7, v13
    v_and_b32 v7, 0xffff0000, v7
    v_mul_f32 v7, 0xbfb8aa3b, v7
    v_exp_f32 v7, v7
    v_add_f32 v60, v60, v61
    v_add_f32 v7, 1.0, v7
    v_rcp_f32 v7, v7
    v_cvt_pk_bf16_f32 v60, v60, v60
    v_lshlrev_b32 v60, 16, v60
    v_cvt_pk_bf16_f32 v7, v7, v7
    v_lshlrev_b32 v7, 16, v7
    s_mov_b64 exec, 0x1
    s_movk_i32 s60, 4000
FN_HP:
    buffer_load_dword v13, v3, s[40:43], s52 offen offset:0 sc1
FN_HP_W:
    s_waitcnt vmcnt(0)
    v_cmp_eq_u32 vcc, -1, v13
    s_nop 0
    s_and_b64 exec, exec, vcc
    s_cbranch_execz FN_HP_D
    s_sub_u32 s60, s60, 1
    s_cmp_gt_i32 s60, 0
    s_sleep 1
    s_cbranch_scc1 FN_HP
FN_HP_D:
    s_mov_b64 exec, -1
    s_movk_i32 s60, 4000
FN_PP:
    buffer_load_dwordx4 v[16:19], v3, s[40:43], s52 offen offset:0 sc1
    buffer_load_dwordx4 v[20:23], v3, s[40:43], s52 offen offset:1024 sc1
    buffer_load_dwordx4 v[24:27], v3, s[40:43], s52 offen offset:2048 sc1
    buffer_load_dwordx4 v[28:31], v3, s[40:43], s52 offen offset:3072 sc1
    buffer_load_dwordx4 v[32:35], v3, s[40:43], s53 offen offset:0 sc1
    buffer_load_dwordx4 v[36:39], v3, s[40:43], s53 offen offset:1024 sc1
    buffer_load_dwordx4 v[40:43], v3, s[40:43], s53 offen offset:2048 sc1
    buffer_load_dwordx4 v[44:47], v3, s[40:43], s53 offen offset:3072 sc1
    buffer_load_dwordx4 v[48:51], v3, s[40:43], s54 offen offset:0 sc1
FN_PP_W:
    s_waitcnt vmcnt(0)
    v_pk_add_f32 v[52:53], v[16:17], v[20:21]
    v_pk_add_f32 v[56:57], v[24:25], v[28:29]
    v_pk_add_f32 v[54:55], v[18:19], v[22:23]
    v_pk_add_f32 v[58:59], v[26:27], v[30:31]
    v_pk_add_f32 v[52:53], v[52:53], v[32:33]
    v_pk_add_f32 v[54:55], v[54:55], v[34:35]
    v_pk_add_f32 v[56:57], v[56:57], v[36:37]
    v_pk_add_f32 v[58:59], v[58:59], v[38:39]
    v_pk_add_f32 v[52:53], v[52:53], v[40:41]
    v_pk_add_f32 v[54:55], v[54:55], v[42:43]
    v_pk_add_f32 v[56:57], v[56:57], v[44:45]
    v_pk_add_f32 v[58:59], v[58:59], v[46:47]
    v_pk_add_f32 v[52:53], v[52:53], v[48:49]
    v_pk_add_f32 v[54:55], v[54:55], v[50:51]
    v_pk_add_f32 v[52:53], v[52:53], v[56:57]
    v_pk_add_f32 v[54:55], v[54:55], v[58:59]
    v_pk_add_f32 v[56:57], v[52:53], v[54:55]
    v_cmp_u_f32 vcc, v56, v57
    s_nop 0
    s_and_b64 exec, exec, vcc
    s_cbranch_execz FN_PP_D
    s_sub_u32 s60, s60, 1
    s_cmp_gt_i32 s60, 0
    s_cbranch_scc1 FN_PP
FN_PP_D:
    s_mov_b64 exec, -1
    v_permlane32_swap_b32 v52, v54
    v_permlane32_swap_b32 v53, v55
    v_add_f32 v52, v52, v54
    v_add_f32 v53, v53, v55
    s_nop 1
    v_permlane16_swap_b32 v52, v53
    v_add_f32 v52, v52, v53
    s_nop 1
    v_add_f32_dpp v52, v52, v52 row_ror:8 row_mask:0xf bank_mask:0xf
    v_cvt_pk_bf16_f32 v52, v52, v52
    v_lshlrev_b32 v52, 16, v52
    v_mul_f32 v52, v52, v7
    v_cvt_pk_bf16_f32 v52, v52, v52
    v_lshlrev_b32 v52, 16, v52
    v_add_f32 v52, v52, v62
    v_cvt_pk_bf16_f32 v52, v52, v52
    v_lshlrev_b32 v52, 16, v52
    v_add_f32 v52, v52, v60
    v_cvt_pk_bf16_f32 v52, v52, v52
    s_mov_b32 exec_lo, 0xff00ff
    s_mov_b32 exec_hi, 0xff00ff
    global_store_short v12, v52, s[32:33]
    s_mov_b64 exec, -1
END:
    s_endpgm
CODE_END:
.section .rodata,"a"
.p2align 6
.amdhsa_kernel sequential_preLN__ssm_conv_s4__moe_arch_mod__prompt_kernel
  .amdhsa_next_free_vgpr 168
  .amdhsa_next_free_sgpr 102
  .amdhsa_accum_offset 168
  .amdhsa_group_segment_fixed_size 0
  .amdhsa_kernarg_size 136
  .amdhsa_user_sgpr_count 2
  .amdhsa_user_sgpr_kernarg_segment_ptr 1
  .amdhsa_system_sgpr_workgroup_id_x 1
.end_amdhsa_kernel
```

```asm
; @launch grid=(256,1,1) block=(768,1,1) lds=163840
.amdgcn_target "amdgcn-amd-amdhsa--gfx950"
    .text
    .globl sequential_preLN__ssm_conv_s4__moe_arch_mod__prompt_kernel
    .p2align 8
    .type sequential_preLN__ssm_conv_s4__moe_arch_mod__prompt_kernel,@function
sequential_preLN__ssm_conv_s4__moe_arch_mod__prompt_kernel:
    s_cmp_ge_u32 s2, 256
    s_cbranch_scc1 END
    s_load_dwordx16 s[4:19], s[0:1], 0
    s_load_dwordx2 s[36:37], s[0:1], 128
    s_load_dwordx16 s[20:35], s[0:1], 64
    s_getpc_b64 s[70:71]
    s_lshr_b32 s3, s2, 3
    s_mul_i32 s3, s3, 7
    v_subrev_u32 v2, 320, v0
    v_cmp_gt_u32 vcc, 7, v2
    v_add_lshl_u32 v2, v2, s3, 7
    v_min_u32 v2, CODE_END-sequential_preLN__ssm_conv_s4__moe_arch_mod__prompt_kernel-64, v2
    v_mov_b32 v3, s71
    s_mov_b64 exec, vcc
    v_add_co_u32 v2, vcc, s70, v2
    s_nop 1
    v_addc_co_u32 v3, vcc, 0, v3, vcc
    s_cbranch_execz P_NC
    global_load_dword v159, v[2:3], off
P_NC:
    s_mov_b64 exec, -1
    v_lshrrev_b32 v2, 6, v0
    v_and_b32 v1, 63, v0
    v_readfirstlane_b32 s38, v2
    v_lshlrev_b32 v3, 4, v1
    s_mov_b32 s42, 0x10000000
    s_mov_b32 s43, 0x00020000
    s_cmp_lt_u32 s2, 192
    s_cselect_b32 s3, 4, -1
    s_cmp_lg_u32 s38, s3
    s_cbranch_scc1 P_NP
    s_mul_i32 s52, s2, 768
    v_add_u32 v16, s52, v3
    s_mul_i32 s52, s2, 6
    s_and_b32 s52, s52, -4
    v_lshl_add_u32 v17, v1, 2, s52
    v_mov_b32 v18, 161536
    v_mov_b32 v19, 0
    ds_write_b32 v18, v19
    v_mov_b32 v20, s70
    v_mov_b32 v21, s71
    s_waitcnt lgkmcnt(0)
    s_mov_b32 exec_lo, 0xffffffff
    s_mov_b32 exec_hi, 0xffff
    s_mov_b32 m0, 138048
    s_nop 0
    global_load_lds_dwordx4 v16, s[6:7]
    s_mov_b32 m0, 138816
    s_nop 0
    global_load_lds_dwordx4 v16, s[8:9]
    s_mov_b32 m0, 139584
    s_nop 0
    global_load_lds_dwordx4 v16, s[10:11]
    s_mov_b32 m0, 140352
    s_nop 0
    global_load_lds_dwordx4 v16, s[12:13]
    s_mov_b32 m0, 141120
    s_nop 0
    global_load_lds_dwordx4 v16, s[14:15]
    s_mov_b32 m0, 141888
    s_nop 0
    global_load_lds_dwordx4 v16, s[16:17]
    s_mov_b64 exec, 0x3
    s_mov_b32 m0, 142656
    s_nop 0
    global_load_lds_dword v17, s[18:19]
    s_mov_b32 m0, 142672
    s_nop 0
    global_load_lds_dword v17, s[20:21]
    s_mov_b64 exec, 0x1
    s_mov_b32 m0, 161536
    s_nop 0
    global_load_lds_dword v[20:21], off
    s_mov_b64 exec, -1
P_NP:
    s_cmp_ge_u32 s38, 4
    s_cbranch_scc1 P_B
    s_setprio 3
    v_lshrrev_b32 v147, 5, v0
    v_and_b32 v148, 31, v0
    v_mul_u32_u24 v140, 0x480, v147
    s_mul_i32 s44, s2, 9216
    v_mad_u32_u24 v140, v148, 12, v140
    v_mov_b32 v104, 0
    v_mov_b32 v105, 0
    v_mov_b32 v106, 0
    v_mov_b32 v107, 0
    v_add_u32 v140, s44, v140
    v_add_u32 v149, 161280, v3
    s_mov_b64 exec, 0xffff
    ds_write_b128 v149, v[104:107]
    s_mov_b64 exec, -1
    v_mov_b32 v94, 1
    v_and_b32 v147, 1, v147
    v_mul_u32_u24 v141, 0x90, v148
    v_lshl_add_u32 v141, v147, 6, v141
    s_lshl_b32 s45, s38, 4
    s_sub_u32 s45, 147504, s45
    v_add_u32 v141, s45, v141
    v_lshrrev_b32 v142, 3, v1
    v_add_u32 v142, v142, v1
    s_mul_i32 s45, s38, 3456
    s_add_u32 s45, s45, 147456
    v_lshl_add_u32 v142, v142, 4, s45
    v_lshrrev_b32 v143, 2, v1
    v_mul_u32_u24 v143, 16320, v143
    v_add_u32 v143, v143, v3
    s_lshl_b32 s46, s2, 6
    s_sub_u32 s46, 81856, s46
    s_mul_i32 s45, s38, 786432
    s_add_u32 s46, s46, s45
    s_add_u32 s47, s46, 262144
    s_add_u32 s48, s46, 524288
    s_mov_b32 s49, 0x05040100
    s_mov_b32 s50, 0x07060302
    v_mov_b32 v144, s49
    s_mov_b32 exec_lo, 0
    v_mov_b32 v144, s50
    s_mov_b64 exec, -1
    v_mov_b32 v145, 161328
    s_lshl_b32 s45, s38, 2
    v_add_u32 v146, s45, v145
    s_waitcnt lgkmcnt(0)
    global_load_dword v95, v104, s[36:37] offset:0
    global_load_dwordx3 v[60:62], v140, s[4:5] offset:0
    global_load_dwordx3 v[64:66], v140, s[4:5] offset:384
    global_load_dwordx3 v[68:70], v140, s[4:5] offset:768
    s_mov_b32 s40, s36
    s_mov_b32 s41, s37
    s_cmp_ge_u32 s2, 192
    s_cbranch_scc1 P_C
    s_lshr_b32 s65, s38, 2
    s_bitcmp1_b32 s2, 0
    s_addc_u32 s51, s65, 0
    s_cmp_eq_u32 s51, 3
    s_cselect_b32 s51, 0, s51
    s_lshl_b32 s52, s51, 8
    s_add_u32 s52, s52, 138048
    v_and_b32 v114, 0x7f, v0
    v_lshl_add_u32 v114, v114, 1, s52
    s_and_b32 s52, s2, 1
    s_add_u32 s52, s52, s51
    s_lshl_b32 s52, s52, 1
    s_add_u32 s52, s52, 142656
    v_mov_b32 v115, s52
    v_mov_b32 v119, 161536
    v_mov_b32 v29, 0
    v_mov_b32 v30, 0
    v_mov_b32 v31, 0
    v_mov_b32 v32, 0
    v_mov_b32 v33, 0
    v_mov_b32 v34, 0
    v_mov_b32 v35, 0
    v_mov_b32 v160, 0
    v_mov_b32 v161, 0
    v_mov_b32 v162, 0
    v_mov_b32 v163, 0
    v_mov_b32 v164, 0
    v_lshlrev_b32 v16, 4, v0
    v_add_u32 v17, 101184, v16
    ds_write_b128 v17, v[160:163] offset:0
    ds_write_b128 v17, v[160:163] offset:12288
    ds_write_b128 v17, v[160:163] offset:24576
    s_mul_i32 s59, s65, 16320
    s_mul_i32 s67, s65, 17408
    s_add_u32 s71, s67, 48960
    s_and_b32 s66, s38, 1
    s_lshl_b32 s66, s66, 8
    s_add_u32 s70, s66, s67
    s_add_u32 s70, s70, 16192
    s_add_u32 s66, s66, s59
    s_mov_b32 m0, s66
    s_mul_i32 s64, s65, 5888
    s_add_u32 s64, s64, 101184
    s_and_b32 s69, s38, 3
    v_and_b32 v5, 15, v0
    v_bfe_u32 v6, v0, 4, 2
    v_and_b32 v17, 48, v0
    v_mul_u32_u24 v110, 544, v5
    s_mov_b32 s52, 0
    s_movk_i32 s53, 2176
    s_movk_i32 s54, 4896
    s_cmp_eq_u32 s69, 1
    s_cselect_b32 s52, 9792, s52
    s_cselect_b32 s53, 1088, s53
    s_cselect_b32 s54, 3264, s54
    s_cmp_eq_u32 s69, 3
    s_cselect_b32 s52, 544, s52
    s_add_u32 s52, s52, s59
    s_cmp_eq_u32 s69, 2
    s_cselect_b32 s52, s71, s52
    s_cselect_b32 s54, 4352, s54
    s_add_u32 s67, s71, 8704
    v_and_b32 v111, 3, v0
    v_mul_u32_u24 v111, 544, v111
    v_bfe_u32 v18, v0, 2, 1
    v_bfe_u32 v19, v0, 3, 1
    v_xor_b32 v18, v18, v19
    v_mad_u32_u24 v111, v19, s53, v111
    v_mad_u32_u24 v111, v18, s54, v111
    v_add3_u32 v111, v111, v17, s52
    v_add3_u32 v110, v110, v17, s67
    s_barrier
    v_lshl_add_u32 v18, v5, 1, v6
    s_sub_u32 s52, s69, 11
    v_add_u32 v18, s52, v18
    v_add_u32 v19, 1, v18
    v_lshl_add_u32 v20, v6, 1, 2
    v_cmp_le_u32 s[52:53], v18, v20
    v_cmp_le_u32 s[54:55], v19, v20
    v_mov_b32 v18, 0x3f80
    v_cndmask_b32 v112, 0, v18, s[52:53]
    v_cndmask_b32 v19, 0, 1.0, s[54:55]
    v_or_b32 v112, v112, v19
    s_mul_i32 s52, s38, 1600
    s_add_u32 s52, s52, 120016
    v_lshl_add_u32 v113, v1, 2, s52
    s_mul_i32 s67, s65, 6400
    s_add_u32 s67, s67, 118848
    s_sub_u32 s63, s69, s65
    s_cselect_b32 s52, 3, 0
    s_add_u32 s63, s63, s52
    s_min_u32 s52, s63, 1
    s_add_u32 s63, s63, s52
    s_cmp_eq_u32 s69, 3
    s_cselect_b32 s63, 1, s63
    v_add_u32 v7, 1, v5
    v_and_b32 v8, 3, v7
    v_mul_u32_u24 v8, 1598, v8
    v_lshl_add_u32 v7, v7, 1, v8
    v_add3_u32 v7, v7, v17, s67
    v_add_u32 v18, s64, v17
    v_lshl_add_u32 v9, v5, 3, v18
    v_and_b32 v10, 1, v5
    v_mul_u32_u24 v10, 380, v10
    v_lshl_add_u32 v10, v5, 2, v10
    v_add_u32 v10, v18, v10
    v_lshlrev_b32 v8, 5, v5
    v_sub_u32 v8, v18, v8
    v_lshrrev_b32 v11, 2, v5
    v_lshl_add_u32 v2, v5, 2, v6
    v_add_u32 v15, v2, v11
    v_lshl_add_u32 v4, v15, 3, s59
    s_lshl_b32 s52, s65, 4
    s_add_u32 s52, s52, 161280
    v_mov_b32 v166, s52
    s_branch P_D
P_C:
    v_mov_b32 v8, 0
    v_mov_b32 v10, 0
    v_mov_b32 v166, 0
    s_barrier
P_D:
    s_waitcnt vmcnt(0)
LN1:
    v_dot2c_f32_bf16 v104, 0x3f803f80, v60
    v_dot2c_f32_bf16 v106, v60, v60
    v_dot2c_f32_bf16 v105, 0x3f803f80, v61
    v_dot2c_f32_bf16 v107, v61, v61
    v_dot2c_f32_bf16 v104, 0x3f803f80, v62
    v_dot2c_f32_bf16 v106, v62, v62
    v_dot2c_f32_bf16 v105, 0x3f803f80, v64
    v_dot2c_f32_bf16 v107, v64, v64
    v_dot2c_f32_bf16 v104, 0x3f803f80, v65
    v_dot2c_f32_bf16 v106, v65, v65
    v_dot2c_f32_bf16 v105, 0x3f803f80, v66
    v_dot2c_f32_bf16 v107, v66, v66
    v_dot2c_f32_bf16 v104, 0x3f803f80, v68
    v_dot2c_f32_bf16 v106, v68, v68
    v_dot2c_f32_bf16 v105, 0x3f803f80, v69
    v_dot2c_f32_bf16 v107, v69, v69
    v_dot2c_f32_bf16 v104, 0x3f803f80, v70
    v_dot2c_f32_bf16 v106, v70, v70
    v_add_u32 v95, 1, v95
    s_mov_b64 exec, 0x7
    ds_write_b64 v149, v[94:95] offset:136
    s_mov_b64 exec, -1
    v_add_f32 v104, v104, v105
    v_add_f32 v106, v106, v107
    v_lshlrev_b32 v72, 16, v60
    v_and_b32 v73, 0xffff0000, v60
    v_permlane16_swap_b32 v104, v106
    v_add_f32 v104, v104, v106
    v_lshlrev_b32 v74, 16, v61
    v_and_b32 v75, 0xffff0000, v61
    v_add_f32_dpp v104, v104, v104 quad_perm:[1,0,3,2] row_mask:0xf bank_mask:0xf
    v_lshlrev_b32 v76, 16, v62
    v_and_b32 v77, 0xffff0000, v62
    v_add_f32_dpp v104, v104, v104 quad_perm:[2,3,0,1] row_mask:0xf bank_mask:0xf
    v_lshlrev_b32 v78, 16, v64
    v_and_b32 v79, 0xffff0000, v64
    v_add_f32_dpp v104, v104, v104 row_half_mirror row_mask:0xf bank_mask:0xf
    v_lshlrev_b32 v80, 16, v65
    v_and_b32 v81, 0xffff0000, v65
    v_add_f32_dpp v104, v104, v104 row_mirror row_mask:0xf bank_mask:0xf
    v_mul_f32 v104, 0x3ae38e39, v104
    v_mov_b32 v105, v104
    v_lshlrev_b32 v82, 16, v66
    v_and_b32 v83, 0xffff0000, v66
    v_permlane16_swap_b32 v104, v105
    v_fma_f32 v105, -v104, v104, v105
    v_max_f32 v105, 0, v105
    v_cvt_pk_bf16_f32 v105, v104, v105
    v_lshlrev_b32 v104, 16, v105
    v_and_b32 v105, 0xffff0000, v105
    v_lshlrev_b32 v84, 16, v68
    v_and_b32 v85, 0xffff0000, v68
    v_lshlrev_b32 v86, 16, v69
    v_and_b32 v87, 0xffff0000, v69
    v_lshlrev_b32 v88, 16, v70
    v_and_b32 v89, 0xffff0000, v70
    v_mov_b32 v99, v95
    v_mov_b32 v103, v95
    v_readfirstlane_b32 s39, v95
    v_add_f32 v105, 0x3727c5ac, v105
    v_cvt_pk_bf16_f32 v105, v105, v105
    v_lshlrev_b32 v105, 16, v105
    v_sqrt_f32 v106, v105
    v_pk_add_f32 v[72:73], v[72:73], v[104:105] op_sel_hi:[1,0] neg_lo:[0,1] neg_hi:[0,1]
    v_pk_add_f32 v[74:75], v[74:75], v[104:105] op_sel_hi:[1,0] neg_lo:[0,1] neg_hi:[0,1]
    v_pk_add_f32 v[76:77], v[76:77], v[104:105] op_sel_hi:[1,0] neg_lo:[0,1] neg_hi:[0,1]
    v_cvt_pk_bf16_f32 v106, v106, v106
    v_lshlrev_b32 v106, 16, v106
    v_rcp_f32 v106, v106
    v_pk_add_f32 v[78:79], v[78:79], v[104:105] op_sel_hi:[1,0] neg_lo:[0,1] neg_hi:[0,1]
    v_pk_add_f32 v[80:81], v[80:81], v[104:105] op_sel_hi:[1,0] neg_lo:[0,1] neg_hi:[0,1]
    v_pk_add_f32 v[82:83], v[82:83], v[104:105] op_sel_hi:[1,0] neg_lo:[0,1] neg_hi:[0,1]
    v_pk_add_f32 v[84:85], v[84:85], v[104:105] op_sel_hi:[1,0] neg_lo:[0,1] neg_hi:[0,1]
    v_pk_add_f32 v[86:87], v[86:87], v[104:105] op_sel_hi:[1,0] neg_lo:[0,1] neg_hi:[0,1]
    v_pk_add_f32 v[88:89], v[88:89], v[104:105] op_sel_hi:[1,0] neg_lo:[0,1] neg_hi:[0,1]
    v_cvt_pk_bf16_f32 v73, v72, v73
    v_cvt_pk_bf16_f32 v75, v74, v75
    v_cvt_pk_bf16_f32 v77, v76, v77
    v_cvt_pk_bf16_f32 v79, v78, v79
    v_cvt_pk_bf16_f32 v81, v80, v81
    v_cvt_pk_bf16_f32 v83, v82, v83
    v_cvt_pk_bf16_f32 v85, v84, v85
    v_cvt_pk_bf16_f32 v87, v86, v87
    v_cvt_pk_bf16_f32 v89, v88, v89
    v_lshlrev_b32 v72, 16, v73
    v_and_b32 v73, 0xffff0000, v73
    v_lshlrev_b32 v74, 16, v75
    v_and_b32 v75, 0xffff0000, v75
    v_lshlrev_b32 v76, 16, v77
    v_and_b32 v77, 0xffff0000, v77
    v_pk_mul_f32 v[72:73], v[72:73], v[106:107] op_sel_hi:[1,0]
    v_pk_mul_f32 v[74:75], v[74:75], v[106:107] op_sel_hi:[1,0]
    v_pk_mul_f32 v[76:77], v[76:77], v[106:107] op_sel_hi:[1,0]
    v_cvt_pk_bf16_f32 v60, v72, v73
    v_cvt_pk_bf16_f32 v62, v76, v77
    v_cvt_pk_bf16_f32 v61, v74, v75
    v_cvt_pk_bf16_f32 v63, v74, v75
    v_permlane32_swap_b32 v60, v62
    s_nop 0
    v_permlane32_swap_b32 v61, v63
    v_perm_b32 v92, v60, v62, s49
    v_perm_b32 v93, v60, v62, s50
    v_lshlrev_b32 v78, 16, v79
    v_and_b32 v79, 0xffff0000, v79
    v_lshlrev_b32 v80, 16, v81
    v_and_b32 v81, 0xffff0000, v81
    v_lshlrev_b32 v82, 16, v83
    v_and_b32 v83, 0xffff0000, v83
    v_pk_mul_f32 v[78:79], v[78:79], v[106:107] op_sel_hi:[1,0]
    v_pk_mul_f32 v[80:81], v[80:81], v[106:107] op_sel_hi:[1,0]
    v_pk_mul_f32 v[82:83], v[82:83], v[106:107] op_sel_hi:[1,0]
    v_cvt_pk_bf16_f32 v64, v78, v79
    v_cvt_pk_bf16_f32 v66, v82, v83
    v_cvt_pk_bf16_f32 v65, v80, v81
    v_cvt_pk_bf16_f32 v67, v80, v81
    v_perm_b32 v94, v61, v63, v144
    ds_write_b128 v141, v[92:95] offset:0
    v_permlane32_swap_b32 v64, v66
    v_permlane32_swap_b32 v65, v67
    v_perm_b32 v96, v64, v66, s49
    v_perm_b32 v97, v64, v66, s50
    v_lshlrev_b32 v84, 16, v85
    v_and_b32 v85, 0xffff0000, v85
    v_lshlrev_b32 v86, 16, v87
    v_and_b32 v87, 0xffff0000, v87
    v_lshlrev_b32 v88, 16, v89
    v_and_b32 v89, 0xffff0000, v89
    v_pk_mul_f32 v[84:85], v[84:85], v[106:107] op_sel_hi:[1,0]
    v_pk_mul_f32 v[86:87], v[86:87], v[106:107] op_sel_hi:[1,0]
    v_pk_mul_f32 v[88:89], v[88:89], v[106:107] op_sel_hi:[1,0]
    v_cvt_pk_bf16_f32 v68, v84, v85
    v_cvt_pk_bf16_f32 v70, v88, v89
    v_cvt_pk_bf16_f32 v69, v86, v87
    v_cvt_pk_bf16_f32 v71, v86, v87
    v_perm_b32 v98, v65, v67, v144
    ds_write_b128 v141, v[96:99] offset:4608
    v_permlane32_swap_b32 v68, v70
    v_permlane32_swap_b32 v69, v71
    v_perm_b32 v100, v68, v70, s49
    v_perm_b32 v101, v68, v70, s50
    v_perm_b32 v102, v69, v71, v144
    ds_write_b128 v141, v[100:103] offset:9216
    s_mov_b64 exec, 0x1
    ds_write_b32 v146, v144
    s_mov_b64 exec, -1
    s_movk_i32 s60, 4000
LN1_R:
    ds_read_b128 v[104:107], v145
    ds_read_b128 v[72:75], v142 offset:0
    ds_read_b128 v[76:79], v142 offset:1152
    ds_read_b128 v[80:83], v142 offset:2304
    s_sub_u32 s60, s60, 1
    s_waitcnt lgkmcnt(3)
    v_min3_u32 v104, v104, v105, v106
    v_min_u32 v104, v104, v107
    v_cmp_eq_u32 vcc, 0, v104
    s_cmp_gt_i32 s60, 0
    s_cselect_b64 s[52:53], vcc, 0
    s_cmp_lg_u64 s[52:53], 0
    s_waitcnt lgkmcnt(0)
    s_cbranch_scc1 LN1_R
    buffer_store_dwordx4 v[72:75], v143, s[40:43], s46 offen sc1
    buffer_store_dwordx4 v[76:79], v143, s[40:43], s47 offen sc1
    buffer_store_dwordx4 v[80:83], v143, s[40:43], s48 offen sc1
    s_cmp_ge_u32 s2, 192
    s_cbranch_scc1 FFN_DMA
    s_branch C_KS
P_B:
    s_cmp_ge_u32 s2, 192
    s_cbranch_scc1 FFN_DMA0
P_B2:
    s_lshr_b32 s65, s38, 2
    s_bitcmp1_b32 s2, 0
    s_addc_u32 s51, s65, 0
    s_cmp_eq_u32 s51, 3
    s_cselect_b32 s51, 0, s51
    s_lshl_b32 s52, s51, 8
    s_add_u32 s52, s52, 138048
    v_and_b32 v114, 0x7f, v0
    v_lshl_add_u32 v114, v114, 1, s52
    s_and_b32 s52, s2, 1
    s_add_u32 s52, s52, s51
    s_lshl_b32 s52, s52, 1
    s_add_u32 s52, s52, 142656
    v_mov_b32 v115, s52
    v_mov_b32 v119, 161536
    v_mov_b32 v29, 0
    v_mov_b32 v30, 0
    v_mov_b32 v31, 0
    v_mov_b32 v32, 0
    v_mov_b32 v33, 0
    v_mov_b32 v34, 0
    v_mov_b32 v35, 0
    v_mov_b32 v160, 0
    v_mov_b32 v161, 0
    v_mov_b32 v162, 0
    v_mov_b32 v163, 0
    v_mov_b32 v164, 0
    v_lshlrev_b32 v16, 4, v0
    v_add_u32 v17, 101184, v16
    ds_write_b128 v17, v[160:163] offset:0
    ds_write_b128 v17, v[160:163] offset:12288
    ds_write_b128 v17, v[160:163] offset:24576
    s_mul_i32 s59, s65, 16320
    s_mul_i32 s67, s65, 17408
    s_add_u32 s71, s67, 48960
    s_and_b32 s66, s38, 1
    s_lshl_b32 s66, s66, 8
    s_add_u32 s70, s66, s67
    s_add_u32 s70, s70, 16192
    s_add_u32 s66, s66, s59
    s_mov_b32 m0, s66
    s_mul_i32 s64, s65, 5888
    s_add_u32 s64, s64, 101184
    s_and_b32 s69, s38, 3
    v_and_b32 v5, 15, v0
    v_bfe_u32 v6, v0, 4, 2
    v_and_b32 v17, 48, v0
    v_mul_u32_u24 v110, 544, v5
    s_mov_b32 s52, 0
    s_movk_i32 s53, 2176
    s_movk_i32 s54, 4896
    s_cmp_eq_u32 s69, 1
    s_cselect_b32 s52, 9792, s52
    s_cselect_b32 s53, 1088, s53
    s_cselect_b32 s54, 3264, s54
    s_cmp_eq_u32 s69, 3
    s_cselect_b32 s52, 544, s52
    s_add_u32 s52, s52, s59
    s_cmp_eq_u32 s69, 2
    s_cselect_b32 s52, s71, s52
    s_cselect_b32 s54, 4352, s54
    s_add_u32 s67, s71, 8704
    v_and_b32 v111, 3, v0
    v_mul_u32_u24 v111, 544, v111
    v_bfe_u32 v18, v0, 2, 1
    v_bfe_u32 v19, v0, 3, 1
    v_xor_b32 v18, v18, v19
    v_mad_u32_u24 v111, v19, s53, v111
    v_mad_u32_u24 v111, v18, s54, v111
    v_add3_u32 v111, v111, v17, s52
    v_add3_u32 v110, v110, v17, s67
    s_barrier
    v_lshl_add_u32 v18, v5, 1, v6
    s_sub_u32 s52, s69, 11
    v_add_u32 v18, s52, v18
    v_add_u32 v19, 1, v18
    v_lshl_add_u32 v20, v6, 1, 2
    v_cmp_le_u32 s[52:53], v18, v20
    v_cmp_le_u32 s[54:55], v19, v20
    v_mov_b32 v18, 0x3f80
    v_cndmask_b32 v112, 0, v18, s[52:53]
    v_cndmask_b32 v19, 0, 1.0, s[54:55]
    v_or_b32 v112, v112, v19
    s_mul_i32 s52, s38, 1600
    s_add_u32 s52, s52, 120016
    v_lshl_add_u32 v113, v1, 2, s52
    s_mul_i32 s67, s65, 6400
    s_add_u32 s67, s67, 118848
    s_sub_u32 s63, s69, s65
    s_cselect_b32 s52, 3, 0
    s_add_u32 s63, s63, s52
    s_min_u32 s52, s63, 1
    s_add_u32 s63, s63, s52
    s_cmp_eq_u32 s69, 3
    s_cselect_b32 s63, 1, s63
    v_add_u32 v7, 1, v5
    v_and_b32 v8, 3, v7
    v_mul_u32_u24 v8, 1598, v8
    v_lshl_add_u32 v7, v7, 1, v8
    v_add3_u32 v7, v7, v17, s67
    v_add_u32 v18, s64, v17
    v_lshl_add_u32 v9, v5, 3, v18
    v_and_b32 v10, 1, v5
    v_mul_u32_u24 v10, 380, v10
    v_lshl_add_u32 v10, v5, 2, v10
    v_add_u32 v10, v18, v10
    v_lshlrev_b32 v8, 5, v5
    v_sub_u32 v8, v18, v8
    v_lshrrev_b32 v11, 2, v5
    v_lshl_add_u32 v2, v5, 2, v6
    v_add_u32 v15, v2, v11
    v_lshl_add_u32 v4, v15, 3, s59
    s_lshl_b32 s52, s65, 4
    s_add_u32 s52, s52, 161280
    v_mov_b32 v166, s52
    s_mul_i32 s48, s2, 9216
    s_add_u32 s48, s48, 9498624
    s_cmp_eq_u32 s2, 150
    s_cselect_b32 s48, 28672, s48
    s_cselect_b32 s50, 0, s2
    s_add_u32 s49, s48, 11776
    s_waitcnt lgkmcnt(0)
    s_mov_b32 s40, s36
    s_mov_b32 s41, s37
C_KS:
    s_movk_i32 s60, 4000
C_KP:
    ds_read_b32 v20, v119
    s_sub_u32 s60, s60, 1
    s_cmp_gt_i32 s60, 0
    s_waitcnt lgkmcnt(0)
    v_readfirstlane_b32 s52, v20
    s_nop 0
    s_cselect_b32 s52, s52, 1
    s_cmp_eq_u32 s52, 0
    s_cbranch_scc1 C_KP
    ds_read_u16_d16_hi v29, v115
    ds_read_u16_d16_hi v30, v114 offset:0
    ds_read_u16_d16_hi v31, v114 offset:768
    ds_read_u16_d16_hi v32, v114 offset:1536
    ds_read_u16_d16_hi v33, v114 offset:2304
    ds_read_u16_d16_hi v34, v114 offset:3072
    ds_read_u16_d16_hi v35, v114 offset:3840
    ds_read_u16_d16_hi v164, v115 offset:16
    s_setprio 2
    s_cmp_lt_u32 s38, 4
    s_cbranch_scc1 PG1
    s_setprio 3
PG1:
    s_waitcnt lgkmcnt(0)
    v_mul_f32 v20, 0x3fb8aa3b, v29
    v_mov_b32 v21, 0x3fb8aa3b
    v_fma_f32 v21, v29, v21, -v20
    v_fmac_f32 v21, 0x32a57060, v29
    v_exp_f32 v20, v20
    v_mul_f32 v21, 0x3f317218, v21
    v_fma_f32 v20, v20, v21, v20
    v_cvt_pk_bf16_f32 v20, v20, v20
    v_lshlrev_b32 v20, 16, v20
    v_mul_f32 v21, v30, v20
    v_mul_f32 v36, v31, v20
    v_mul_f32 v32, v32, v20
    v_mul_f32 v33, v33, v20
    v_mul_f32 v21, 0x3fb8aa3b, v21
    v_mul_f32 v22, 0x3e22f983, v36
    v_mov_b32 v23, 0x3e22f983
    v_fma_f32 v23, v36, v23, -v22
    v_fmac_f32 v23, 0x31dc9c88, v36
    v_pk_mul_f32 v[24:25], v[34:35], v[32:33] op_sel:[0,0] op_sel_hi:[0,1]
    v_pk_fma_f32 v[24:25], v[34:35], v[32:33], v[24:25] op_sel:[1,1,0] op_sel_hi:[1,0,1] neg_lo:[1,0,0]
    s_bitcmp1_b32 s38, 1
    s_cbranch_scc1 C_ROLE1
    v_mul_f32 v36, 0x43000000, v21
    v_mul_f32 v37, 0x43000000, v22
    v_mul_f32 v38, 0x41000000, v21
    v_mul_f32 v39, 0x41000000, v22
    v_exp_f32 v36, v36
    v_fract_f32 v37, v37
    v_exp_f32 v38, v38
    v_fract_f32 v39, v39
    v_fmac_f32 v37, 0x43000000, v23
    v_fmac_f32 v39, 0x41000000, v23
    v_cos_f32 v26, v37
    v_sin_f32 v27, v37
    v_cos_f32 v28, v39
    v_sin_f32 v29, v39
    v_mul_f32 v26, v26, v36
    v_mul_f32 v27, v27, v36
    v_mul_f32 v28, v28, v38
    v_mul_f32 v29, v29, v38
    v_mov_b32 v44, 1.0
    v_mov_b32 v45, 0
    v_pk_mul_f32 v[56:57], v[24:25], v[28:29] op_sel:[0,0] op_sel_hi:[0,1]
    v_pk_mul_f32 v[50:51], v[28:29], v[28:29] op_sel:[0,0] op_sel_hi:[0,1]
    v_pk_fma_f32 v[56:57], v[24:25], v[28:29], v[56:57] op_sel:[1,1,0] op_sel_hi:[1,0,1] neg_lo:[1,0,0]
    v_pk_fma_f32 v[50:51], v[28:29], v[28:29], v[50:51] op_sel:[1,1,0] op_sel_hi:[1,0,1] neg_lo:[1,0,0]
    v_pk_mul_f32 v[58:59], v[56:57], v[26:27] op_sel:[0,0] op_sel_hi:[0,1]
    v_pk_fma_f32 v[58:59], v[56:57], v[26:27], v[58:59] op_sel:[1,1,0] op_sel_hi:[1,0,1] neg_lo:[1,0,0]
    v_cvt_pk_bf16_f32 v40, v56, v57
    ds_write_addtid_b32 v40 offset:4352
    v_pk_mul_f32 v[56:57], v[58:59], v[26:27] op_sel:[0,0] op_sel_hi:[0,1]
    v_pk_mul_f32 v[54:55], v[50:51], v[28:29] op_sel:[0,0] op_sel_hi:[0,1]
    v_pk_fma_f32 v[56:57], v[58:59], v[26:27], v[56:57] op_sel:[1,1,0] op_sel_hi:[1,0,1] neg_lo:[1,0,0]
    v_pk_fma_f32 v[54:55], v[50:51], v[28:29], v[54:55] op_sel:[1,1,0] op_sel_hi:[1,0,1] neg_lo:[1,0,0]
    v_cvt_pk_bf16_f32 v41, v58, v59
    ds_write_addtid_b32 v41 offset:9248
    v_cvt_pk_bf16_f32 v42, v44, -v45
    s_mov_b32 m0, s70
    s_nop 0
    ds_write_addtid_b32 v42 offset:41472
    v_cvt_pk_bf16_f32 v43, v28, -v29
    ds_write_addtid_b32 v43 offset:42016
    v_cvt_pk_bf16_f32 v40, v50, -v51
    ds_write_addtid_b32 v40 offset:42560
    v_pk_mul_f32 v[58:59], v[56:57], v[26:27] op_sel:[0,0] op_sel_hi:[0,1]
    v_pk_mul_f32 v[50:51], v[54:55], v[28:29] op_sel:[0,0] op_sel_hi:[0,1]
    v_pk_fma_f32 v[58:59], v[56:57], v[26:27], v[58:59] op_sel:[1,1,0] op_sel_hi:[1,0,1] neg_lo:[1,0,0]
    v_pk_fma_f32 v[50:51], v[54:55], v[28:29], v[50:51] op_sel:[1,1,0] op_sel_hi:[1,0,1] neg_lo:[1,0,0]
    v_cvt_pk_bf16_f32 v41, v56, v57
    s_mov_b32 m0, s66
    s_nop 0
    ds_write_addtid_b32 v41 offset:11968
    v_cvt_pk_bf16_f32 v42, v54, -v55
    s_mov_b32 m0, s70
    s_nop 0
    ds_write_addtid_b32 v42 offset:43104
    v_pk_mul_f32 v[56:57], v[58:59], v[26:27] op_sel:[0,0] op_sel_hi:[0,1]
    v_pk_mul_f32 v[54:55], v[50:51], v[28:29] op_sel:[0,0] op_sel_hi:[0,1]
    v_pk_fma_f32 v[56:57], v[58:59], v[26:27], v[56:57] op_sel:[1,1,0] op_sel_hi:[1,0,1] neg_lo:[1,0,0]
    v_pk_fma_f32 v[54:55], v[50:51], v[28:29], v[54:55] op_sel:[1,1,0] op_sel_hi:[1,0,1] neg_lo:[1,0,0]
    v_cvt_pk_bf16_f32 v43, v58, v59
    s_mov_b32 m0, s66
    s_nop 0
    ds_write_addtid_b32 v43 offset:15232
    v_cvt_pk_bf16_f32 v40, v50, -v51
    s_mov_b32 m0, s70
    s_nop 0
    ds_write_addtid_b32 v40 offset:43648
    v_pk_mul_f32 v[58:59], v[56:57], v[26:27] op_sel:[0,0] op_sel_hi:[0,1]
    v_pk_mul_f32 v[50:51], v[54:55], v[28:29] op_sel:[0,0] op_sel_hi:[0,1]
    v_pk_fma_f32 v[58:59], v[56:57], v[26:27], v[58:59] op_sel:[1,1,0] op_sel_hi:[1,0,1] neg_lo:[1,0,0]
    v_pk_fma_f32 v[50:51], v[54:55], v[28:29], v[50:51] op_sel:[1,1,0] op_sel_hi:[1,0,1] neg_lo:[1,0,0]
    v_cvt_pk_bf16_f32 v41, v56, v57
    ds_write_addtid_b32 v41 offset:33312
    v_cvt_pk_bf16_f32 v42, v54, -v55
    ds_write_addtid_b32 v42 offset:44192
    v_pk_mul_f32 v[56:57], v[58:59], v[26:27] op_sel:[0,0] op_sel_hi:[0,1]
    v_pk_mul_f32 v[54:55], v[50:51], v[28:29] op_sel:[0,0] op_sel_hi:[0,1]
    v_pk_fma_f32 v[56:57], v[58:59], v[26:27], v[56:57] op_sel:[1,1,0] op_sel_hi:[1,0,1] neg_lo:[1,0,0]
    v_pk_fma_f32 v[54:55], v[50:51], v[28:29], v[54:55] op_sel:[1,1,0] op_sel_hi:[1,0,1] neg_lo:[1,0,0]
    v_cvt_pk_bf16_f32 v43, v58, v59
    ds_write_addtid_b32 v43 offset:34400
    v_cvt_pk_bf16_f32 v40, v50, -v51
    ds_write_addtid_b32 v40 offset:44736
    v_pk_mul_f32 v[58:59], v[56:57], v[26:27] op_sel:[0,0] op_sel_hi:[0,1]
    v_pk_mul_f32 v[50:51], v[54:55], v[28:29] op_sel:[0,0] op_sel_hi:[0,1]
    v_pk_fma_f32 v[58:59], v[56:57], v[26:27], v[58:59] op_sel:[1,1,0] op_sel_hi:[1,0,1] neg_lo:[1,0,0]
    v_pk_fma_f32 v[50:51], v[54:55], v[28:29], v[50:51] op_sel:[1,1,0] op_sel_hi:[1,0,1] neg_lo:[1,0,0]
    v_cvt_pk_bf16_f32 v41, v56, v57
    ds_write_addtid_b32 v41 offset:37664
    v_cvt_pk_bf16_f32 v42, v54, -v55
    ds_write_addtid_b32 v42 offset:45280
    v_pk_mul_f32 v[56:57], v[58:59], v[26:27] op_sel:[0,0] op_sel_hi:[0,1]
    v_pk_mul_f32 v[54:55], v[50:51], v[28:29] op_sel:[0,0] op_sel_hi:[0,1]
    v_pk_fma_f32 v[56:57], v[58:59], v[26:27], v[56:57] op_sel:[1,1,0] op_sel_hi:[1,0,1] neg_lo:[1,0,0]
    v_pk_fma_f32 v[54:55], v[50:51], v[28:29], v[54:55] op_sel:[1,1,0] op_sel_hi:[1,0,1] neg_lo:[1,0,0]
    v_cvt_pk_bf16_f32 v43, v58, v59
    ds_write_addtid_b32 v43 offset:38752
    v_cvt_pk_bf16_f32 v40, v50, -v51
    ds_write_addtid_b32 v40 offset:45824
    v_pk_mul_f32 v[58:59], v[56:57], v[26:27] op_sel:[0,0] op_sel_hi:[0,1]
    v_pk_mul_f32 v[50:51], v[54:55], v[28:29] op_sel:[0,0] op_sel_hi:[0,1]
    v_pk_fma_f32 v[58:59], v[56:57], v[26:27], v[58:59] op_sel:[1,1,0] op_sel_hi:[1,0,1] neg_lo:[1,0,0]
    v_pk_fma_f32 v[50:51], v[54:55], v[28:29], v[50:51] op_sel:[1,1,0] op_sel_hi:[1,0,1] neg_lo:[1,0,0]
    v_cvt_pk_bf16_f32 v41, v56, v57
    ds_write_addtid_b32 v41 offset:39296
    v_cvt_pk_bf16_f32 v42, v54, -v55
    ds_write_addtid_b32 v42 offset:46368
    v_pk_mul_f32 v[56:57], v[58:59], v[26:27] op_sel:[0,0] op_sel_hi:[0,1]
    v_pk_mul_f32 v[54:55], v[50:51], v[28:29] op_sel:[0,0] op_sel_hi:[0,1]
    v_pk_fma_f32 v[56:57], v[58:59], v[26:27], v[56:57] op_sel:[1,1,0] op_sel_hi:[1,0,1] neg_lo:[1,0,0]
    v_pk_fma_f32 v[54:55], v[50:51], v[28:29], v[54:55] op_sel:[1,1,0] op_sel_hi:[1,0,1] neg_lo:[1,0,0]
    v_cvt_pk_bf16_f32 v43, v58, v59
    ds_write_addtid_b32 v43 offset:39840
    v_cvt_pk_bf16_f32 v40, v50, -v51
    ds_write_addtid_b32 v40 offset:46912
    v_pk_mul_f32 v[58:59], v[56:57], v[26:27] op_sel:[0,0] op_sel_hi:[0,1]
    v_pk_mul_f32 v[50:51], v[54:55], v[28:29] op_sel:[0,0] op_sel_hi:[0,1]
    v_pk_fma_f32 v[58:59], v[56:57], v[26:27], v[58:59] op_sel:[1,1,0] op_sel_hi:[1,0,1] neg_lo:[1,0,0]
    v_pk_fma_f32 v[50:51], v[54:55], v[28:29], v[50:51] op_sel:[1,1,0] op_sel_hi:[1,0,1] neg_lo:[1,0,0]
    v_cvt_pk_bf16_f32 v41, v56, v57
    ds_write_addtid_b32 v41 offset:40384
    v_cvt_pk_bf16_f32 v42, v54, -v55
    ds_write_addtid_b32 v42 offset:47456
    v_pk_mul_f32 v[56:57], v[58:59], v[26:27] op_sel:[0,0] op_sel_hi:[0,1]
    v_pk_mul_f32 v[54:55], v[50:51], v[28:29] op_sel:[0,0] op_sel_hi:[0,1]
    v_pk_fma_f32 v[56:57], v[58:59], v[26:27], v[56:57] op_sel:[1,1,0] op_sel_hi:[1,0,1] neg_lo:[1,0,0]
    v_pk_fma_f32 v[54:55], v[50:51], v[28:29], v[54:55] op_sel:[1,1,0] op_sel_hi:[1,0,1] neg_lo:[1,0,0]
    v_cvt_pk_bf16_f32 v43, v58, v59
    ds_write_addtid_b32 v43 offset:40928
    v_cvt_pk_bf16_f32 v40, v50, -v51
    ds_write_addtid_b32 v40 offset:48000
    v_pk_mul_f32 v[58:59], v[56:57], v[26:27] op_sel:[0,0] op_sel_hi:[0,1]
    v_pk_mul_f32 v[50:51], v[54:55], v[28:29] op_sel:[0,0] op_sel_hi:[0,1]
    v_pk_fma_f32 v[58:59], v[56:57], v[26:27], v[58:59] op_sel:[1,1,0] op_sel_hi:[1,0,1] neg_lo:[1,0,0]
    v_pk_fma_f32 v[50:51], v[54:55], v[28:29], v[50:51] op_sel:[1,1,0] op_sel_hi:[1,0,1] neg_lo:[1,0,0]
    v_cvt_pk_bf16_f32 v41, v56, v57
    ds_write_addtid_b32 v41 offset:34944
    v_cvt_pk_bf16_f32 v42, v54, -v55
    ds_write_addtid_b32 v42 offset:48544
    v_pk_mul_f32 v[56:57], v[58:59], v[26:27] op_sel:[0,0] op_sel_hi:[0,1]
    v_pk_mul_f32 v[54:55], v[50:51], v[28:29] op_sel:[0,0] op_sel_hi:[0,1]
    v_pk_fma_f32 v[56:57], v[58:59], v[26:27], v[56:57] op_sel:[1,1,0] op_sel_hi:[1,0,1] neg_lo:[1,0,0]
    v_pk_fma_f32 v[54:55], v[50:51], v[28:29], v[54:55] op_sel:[1,1,0] op_sel_hi:[1,0,1] neg_lo:[1,0,0]
    v_cvt_pk_bf16_f32 v43, v58, v59
    ds_write_addtid_b32 v43 offset:35488
    v_cvt_pk_bf16_f32 v40, v50, -v51
    ds_write_addtid_b32 v40 offset:49088
    v_pk_mul_f32 v[58:59], v[56:57], v[26:27] op_sel:[0,0] op_sel_hi:[0,1]
    v_pk_fma_f32 v[58:59], v[56:57], v[26:27], v[58:59] op_sel:[1,1,0] op_sel_hi:[1,0,1] neg_lo:[1,0,0]
    v_cvt_pk_bf16_f32 v41, v56, v57
    ds_write_addtid_b32 v41 offset:36032
    v_cvt_pk_bf16_f32 v42, v54, -v55
    ds_write_addtid_b32 v42 offset:49632
    v_cvt_pk_bf16_f32 v43, v58, v59
    ds_write_addtid_b32 v43 offset:36576
    s_branch C_MFMA
C_ROLE1:
    v_mul_f32 v36, 0x43000000, v21
    v_mul_f32 v37, 0x43000000, v22
    v_mul_f32 v38, 0x3f800000, v21
    v_mul_f32 v39, 0x3f800000, v22
    v_exp_f32 v36, v36
    v_fract_f32 v37, v37
    v_exp_f32 v38, v38
    v_fract_f32 v39, v39
    v_fmac_f32 v37, 0x43000000, v23
    v_fmac_f32 v39, 0x3f800000, v23
    v_cos_f32 v26, v37
    v_sin_f32 v27, v37
    v_cos_f32 v28, v39
    v_sin_f32 v29, v39
    v_mul_f32 v26, v26, v36
    v_mul_f32 v27, v27, v36
    v_mul_f32 v28, v28, v38
    v_mul_f32 v29, v29, v38
    v_pk_mul_f32 v[44:45], v[24:25], v[26:27] op_sel:[0,0] op_sel_hi:[0,1]
    v_pk_mul_f32 v[46:47], v[28:29], v[28:29] op_sel:[0,0] op_sel_hi:[0,1]
    v_pk_mul_f32 v[48:49], v[24:25], v[28:29] op_sel:[0,0] op_sel_hi:[0,1]
    v_pk_fma_f32 v[44:45], v[24:25], v[26:27], v[44:45] op_sel:[1,1,0] op_sel_hi:[1,0,1] neg_lo:[1,0,0]
    v_pk_fma_f32 v[46:47], v[28:29], v[28:29], v[46:47] op_sel:[1,1,0] op_sel_hi:[1,0,1] neg_lo:[1,0,0]
    v_pk_fma_f32 v[48:49], v[24:25], v[28:29], v[48:49] op_sel:[1,1,0] op_sel_hi:[1,0,1] neg_lo:[1,0,0]
    v_cvt_pk_bf16_f32 v40, v24, v25
    ds_write_addtid_b32 v40 offset:0
    v_pk_mul_f32 v[50:51], v[44:45], v[26:27] op_sel:[0,0] op_sel_hi:[0,1]
    v_pk_mul_f32 v[52:53], v[44:45], v[28:29] op_sel:[0,0] op_sel_hi:[0,1]
    v_pk_mul_f32 v[54:55], v[48:49], v[28:29] op_sel:[0,0] op_sel_hi:[0,1]
    v_pk_mul_f32 v[62:63], v[46:47], v[46:47] op_sel:[0,0] op_sel_hi:[0,1]
    v_pk_fma_f32 v[50:51], v[44:45], v[26:27], v[50:51] op_sel:[1,1,0] op_sel_hi:[1,0,1] neg_lo:[1,0,0]
    v_pk_fma_f32 v[52:53], v[44:45], v[28:29], v[52:53] op_sel:[1,1,0] op_sel_hi:[1,0,1] neg_lo:[1,0,0]
    v_pk_fma_f32 v[54:55], v[48:49], v[28:29], v[54:55] op_sel:[1,1,0] op_sel_hi:[1,0,1] neg_lo:[1,0,0]
    v_pk_fma_f32 v[62:63], v[46:47], v[46:47], v[62:63] op_sel:[1,1,0] op_sel_hi:[1,0,1] neg_lo:[1,0,0]
    v_cvt_pk_bf16_f32 v41, v44, v45
    ds_write_addtid_b32 v41 offset:4896
    v_cvt_pk_bf16_f32 v42, v48, v49
    ds_write_addtid_b32 v42 offset:544
    v_pk_mul_f32 v[56:57], v[50:51], v[26:27] op_sel:[0,0] op_sel_hi:[0,1]
    v_pk_mul_f32 v[58:59], v[50:51], v[46:47] op_sel:[0,0] op_sel_hi:[0,1]
    v_pk_mul_f32 v[44:45], v[52:53], v[28:29] op_sel:[0,0] op_sel_hi:[0,1]
    v_pk_mul_f32 v[48:49], v[54:55], v[28:29] op_sel:[0,0] op_sel_hi:[0,1]
    v_pk_fma_f32 v[56:57], v[50:51], v[26:27], v[56:57] op_sel:[1,1,0] op_sel_hi:[1,0,1] neg_lo:[1,0,0]
    v_pk_fma_f32 v[58:59], v[50:51], v[46:47], v[58:59] op_sel:[1,1,0] op_sel_hi:[1,0,1] neg_lo:[1,0,0]
    v_pk_fma_f32 v[44:45], v[52:53], v[28:29], v[44:45] op_sel:[1,1,0] op_sel_hi:[1,0,1] neg_lo:[1,0,0]
    v_pk_fma_f32 v[48:49], v[54:55], v[28:29], v[48:49] op_sel:[1,1,0] op_sel_hi:[1,0,1] neg_lo:[1,0,0]
    v_cvt_pk_bf16_f32 v43, v50, v51
    ds_write_addtid_b32 v43 offset:9792
    v_cvt_pk_bf16_f32 v40, v52, v53
    ds_write_addtid_b32 v40 offset:5440
    v_cvt_pk_bf16_f32 v41, v54, v55
    ds_write_addtid_b32 v41 offset:1088
    v_pk_mul_f32 v[54:55], v[48:49], v[28:29] op_sel:[0,0] op_sel_hi:[0,1]
    v_pk_mul_f32 v[52:53], v[44:45], v[28:29] op_sel:[0,0] op_sel_hi:[0,1]
    v_pk_mul_f32 v[50:51], v[58:59], v[46:47] op_sel:[0,0] op_sel_hi:[0,1]
    v_pk_mul_f32 v[24:25], v[56:57], v[46:47] op_sel:[0,0] op_sel_hi:[0,1]
    v_pk_fma_f32 v[54:55], v[48:49], v[28:29], v[54:55] op_sel:[1,1,0] op_sel_hi:[1,0,1] neg_lo:[1,0,0]
    v_pk_fma_f32 v[52:53], v[44:45], v[28:29], v[52:53] op_sel:[1,1,0] op_sel_hi:[1,0,1] neg_lo:[1,0,0]
    v_pk_fma_f32 v[50:51], v[58:59], v[46:47], v[50:51] op_sel:[1,1,0] op_sel_hi:[1,0,1] neg_lo:[1,0,0]
    v_pk_fma_f32 v[24:25], v[56:57], v[46:47], v[24:25] op_sel:[1,1,0] op_sel_hi:[1,0,1] neg_lo:[1,0,0]
    v_cvt_pk_bf16_f32 v42, v48, v49
    ds_write_addtid_b32 v42 offset:1632
    v_cvt_pk_bf16_f32 v43, v44, v45
    ds_write_addtid_b32 v43 offset:5984
    v_cvt_pk_bf16_f32 v40, v58, v59
    ds_write_addtid_b32 v40 offset:10336
    v_pk_mul_f32 v[48:49], v[54:55], v[28:29] op_sel:[0,0] op_sel_hi:[0,1]
    v_pk_mul_f32 v[44:45], v[52:53], v[28:29] op_sel:[0,0] op_sel_hi:[0,1]
    v_pk_mul_f32 v[58:59], v[50:51], v[46:47] op_sel:[0,0] op_sel_hi:[0,1]
    v_pk_mul_f32 v[56:57], v[24:25], v[46:47] op_sel:[0,0] op_sel_hi:[0,1]
    v_pk_fma_f32 v[48:49], v[54:55], v[28:29], v[48:49] op_sel:[1,1,0] op_sel_hi:[1,0,1] neg_lo:[1,0,0]
    v_pk_fma_f32 v[44:45], v[52:53], v[28:29], v[44:45] op_sel:[1,1,0] op_sel_hi:[1,0,1] neg_lo:[1,0,0]
    v_pk_fma_f32 v[58:59], v[50:51], v[46:47], v[58:59] op_sel:[1,1,0] op_sel_hi:[1,0,1] neg_lo:[1,0,0]
    v_pk_fma_f32 v[56:57], v[24:25], v[46:47], v[56:57] op_sel:[1,1,0] op_sel_hi:[1,0,1] neg_lo:[1,0,0]
    v_cvt_pk_bf16_f32 v41, v54, v55
    ds_write_addtid_b32 v41 offset:2176
    v_cvt_pk_bf16_f32 v42, v52, v53
    ds_write_addtid_b32 v42 offset:6528
    v_cvt_pk_bf16_f32 v43, v50, v51
    ds_write_addtid_b32 v43 offset:10880
    v_cvt_pk_bf16_f32 v40, v24, v25
    ds_write_addtid_b32 v40 offset:13600
    v_pk_mul_f32 v[54:55], v[48:49], v[28:29] op_sel:[0,0] op_sel_hi:[0,1]
    v_pk_mul_f32 v[52:53], v[44:45], v[28:29] op_sel:[0,0] op_sel_hi:[0,1]
    v_pk_mul_f32 v[50:51], v[58:59], v[62:63] op_sel:[0,0] op_sel_hi:[0,1]
    v_pk_mul_f32 v[24:25], v[56:57], v[46:47] op_sel:[0,0] op_sel_hi:[0,1]
    v_pk_mul_f32 v[64:65], v[56:57], v[26:27] op_sel:[0,0] op_sel_hi:[0,1]
    v_pk_fma_f32 v[54:55], v[48:49], v[28:29], v[54:55] op_sel:[1,1,0] op_sel_hi:[1,0,1] neg_lo:[1,0,0]
    v_pk_fma_f32 v[52:53], v[44:45], v[28:29], v[52:53] op_sel:[1,1,0] op_sel_hi:[1,0,1] neg_lo:[1,0,0]
    v_pk_fma_f32 v[50:51], v[58:59], v[62:63], v[50:51] op_sel:[1,1,0] op_sel_hi:[1,0,1] neg_lo:[1,0,0]
    v_pk_fma_f32 v[24:25], v[56:57], v[46:47], v[24:25] op_sel:[1,1,0] op_sel_hi:[1,0,1] neg_lo:[1,0,0]
    v_pk_fma_f32 v[64:65], v[56:57], v[26:27], v[64:65] op_sel:[1,1,0] op_sel_hi:[1,0,1] neg_lo:[1,0,0]
    v_cvt_pk_bf16_f32 v41, v48, v49
    ds_write_addtid_b32 v41 offset:2720
    v_cvt_pk_bf16_f32 v42, v44, v45
    ds_write_addtid_b32 v42 offset:7072
    v_cvt_pk_bf16_f32 v43, v58, v59
    ds_write_addtid_b32 v43 offset:11424
    v_cvt_pk_bf16_f32 v40, v56, v57
    ds_write_addtid_b32 v40 offset:14144
    v_pk_mul_f32 v[48:49], v[54:55], v[28:29] op_sel:[0,0] op_sel_hi:[0,1]
    v_pk_mul_f32 v[44:45], v[52:53], v[28:29] op_sel:[0,0] op_sel_hi:[0,1]
    v_pk_mul_f32 v[56:57], v[24:25], v[62:63] op_sel:[0,0] op_sel_hi:[0,1]
    v_pk_mul_f32 v[66:67], v[64:65], v[26:27] op_sel:[0,0] op_sel_hi:[0,1]
    v_pk_fma_f32 v[48:49], v[54:55], v[28:29], v[48:49] op_sel:[1,1,0] op_sel_hi:[1,0,1] neg_lo:[1,0,0]
    v_pk_fma_f32 v[44:45], v[52:53], v[28:29], v[44:45] op_sel:[1,1,0] op_sel_hi:[1,0,1] neg_lo:[1,0,0]
    v_pk_fma_f32 v[56:57], v[24:25], v[62:63], v[56:57] op_sel:[1,1,0] op_sel_hi:[1,0,1] neg_lo:[1,0,0]
    v_pk_fma_f32 v[66:67], v[64:65], v[26:27], v[66:67] op_sel:[1,1,0] op_sel_hi:[1,0,1] neg_lo:[1,0,0]
    v_cvt_pk_bf16_f32 v41, v54, v55
    ds_write_addtid_b32 v41 offset:3264
    v_cvt_pk_bf16_f32 v42, v52, v53
    ds_write_addtid_b32 v42 offset:7616
    v_cvt_pk_bf16_f32 v43, v50, v51
    ds_write_addtid_b32 v43 offset:12512
    v_cvt_pk_bf16_f32 v40, v24, v25
    ds_write_addtid_b32 v40 offset:14688
    v_cvt_pk_bf16_f32 v41, v64, v65
    s_mov_b32 m0, s70
    s_nop 0
    ds_write_addtid_b32 v41 offset:32768
    v_pk_mul_f32 v[52:53], v[44:45], v[28:29] op_sel:[0,0] op_sel_hi:[0,1]
    v_pk_mul_f32 v[64:65], v[66:67], v[26:27] op_sel:[0,0] op_sel_hi:[0,1]
    v_pk_fma_f32 v[52:53], v[44:45], v[28:29], v[52:53] op_sel:[1,1,0] op_sel_hi:[1,0,1] neg_lo:[1,0,0]
    v_pk_fma_f32 v[64:65], v[66:67], v[26:27], v[64:65] op_sel:[1,1,0] op_sel_hi:[1,0,1] neg_lo:[1,0,0]
    v_cvt_pk_bf16_f32 v42, v48, v49
    s_mov_b32 m0, s66
    s_nop 0
    ds_write_addtid_b32 v42 offset:3808
    v_cvt_pk_bf16_f32 v43, v44, v45
    ds_write_addtid_b32 v43 offset:8160
    v_cvt_pk_bf16_f32 v40, v56, v57
    ds_write_addtid_b32 v40 offset:15776
    v_cvt_pk_bf16_f32 v41, v66, v67
    s_mov_b32 m0, s70
    s_nop 0
    ds_write_addtid_b32 v41 offset:33856
    v_pk_mul_f32 v[66:67], v[64:65], v[26:27] op_sel:[0,0] op_sel_hi:[0,1]
    v_pk_fma_f32 v[66:67], v[64:65], v[26:27], v[66:67] op_sel:[1,1,0] op_sel_hi:[1,0,1] neg_lo:[1,0,0]
    v_cvt_pk_bf16_f32 v42, v52, v53
    s_mov_b32 m0, s66
    s_nop 0
    ds_write_addtid_b32 v42 offset:8704
    v_cvt_pk_bf16_f32 v43, v64, v65
    s_mov_b32 m0, s70
    s_nop 0
    ds_write_addtid_b32 v43 offset:37120
    v_cvt_pk_bf16_f32 v40, v66, v67
    ds_write_addtid_b32 v40 offset:38208
C_MFMA:
    s_lshl_b32 s56, s2, 14
    s_lshl_b32 s57, s38, 12
    s_add_u32 s56, s56, s57
    s_add_u32 s56, s56, 49152
    s_mov_b64 exec, 0x1
    ds_inc_u32 v166, v166 offset:12
    s_mov_b64 exec, -1
    ds_write_b32 v113, v112
    s_setprio 1
    s_cmp_lt_u32 s38, 4
    s_cbranch_scc1 PG2
    s_setprio 2
PG2:
    s_movk_i32 s60, 4000
C_KG:
    ds_read_b32 v16, v166 offset:12
    s_sub_u32 s60, s60, 1
    s_cmp_gt_i32 s60, 0
    s_waitcnt lgkmcnt(0)
    v_readfirstlane_b32 s52, v16
    s_nop 0
    s_cselect_b32 s52, s52, 4
    s_cmp_lg_u32 s52, 4
    s_cbranch_scc1 C_KG
    ds_read_b128 v[16:19], v111 offset:0
    ds_read_b128 v[20:23], v110 offset:0
    ds_read_b128 v[24:27], v111 offset:64
    ds_read_b128 v[28:31], v110 offset:64
    ds_read_b128 v[32:35], v111 offset:128
    ds_read_b128 v[36:39], v110 offset:128
    ds_read_b128 v[40:43], v111 offset:192
    ds_read_b128 v[44:47], v110 offset:192
    ds_read_b128 v[48:51], v111 offset:256
    ds_read_b128 v[52:55], v110 offset:256
    ds_read_b128 v[56:59], v111 offset:320
    ds_read_b128 v[60:63], v110 offset:320
    ds_read_b128 v[64:67], v111 offset:384
    ds_read_b128 v[68:71], v110 offset:384
    ds_read_b128 v[72:75], v111 offset:448
    ds_read_b128 v[76:79], v110 offset:448
    s_lshl_b32 s53, s63, 10
    s_sub_u32 s52, s64, s53
    s_add_u32 s52, s52, 3576
    v_and_b32 v165, 1, v5
    v_lshl_add_u32 v165, v6, 1, v165
    s_mul_i32 s53, s65, 384
    s_add_u32 s53, s53, 161920
    v_lshl_add_u32 v165, v165, 4, s53
    v_lshlrev_b32 v2, 3, v2
    v_sub_u32 v2, s52, v2
    s_mul_i32 s68, s63, 1088
    s_add_u32 s68, s68, s71
    v_lshl_add_u32 v15, v15, 3, s68
    s_cmp_lg_u32 s63, 0
    s_cbranch_scc1 C_LA1
    s_lshr_b32 s52, s2, 3
    s_mul_i32 s52, s52, 3
    s_add_u32 s52, s52, s65
    s_lshl_b32 s52, s52, 3
    s_and_b32 s53, s2, 7
    v_and_b32 v11, 7, v1
    v_add_u32 v11, s52, v11
    v_and_b32 v12, 56, v1
    v_mul_u32_u24 v13, 0x48, v11
    v_add3_u32 v14, v12, v13, s53
    v_lshlrev_b32 v14, 7, v14
    s_add_u32 s53, s53, 64
    v_add_lshl_u32 v13, v13, s53, 7
    s_mul_i32 s53, s53, 0x240
    v_add_lshl_u32 v12, v11, s53, 7
    v_mov_b32 v10, 0
    v_lshrrev_b32 v9, 3, v1
    v_mul_u32_u24 v9, 3328, v9
    v_add3_u32 v9, v9, v3, s59
    s_branch C_LA2
C_LA1:
    v_and_b32 v93, 3, v5
    v_lshl_add_u32 v94, v6, 3, v11
    v_and_b32 v92, 1, v11
    v_mul_u32_u24 v92, 3456, v92
    v_add_u32 v92, s59, v92
    v_sub_u32 v93, v93, v94
    v_sub_u32 v94, v93, v94
    v_add_u32 v95, 44, v93
    v_lshrrev_b32 v96, 4, v95
    v_add_u32 v95, v95, v96
    v_lshl_add_u32 v11, v95, 3, v92
    v_add_u32 v95, 75, v94
    v_lshrrev_b32 v96, 4, v95
    v_add_u32 v95, v95, v96
    v_lshl_add_u32 v13, v95, 3, v92
    v_add_u32 v95, 40, v93
    v_lshrrev_b32 v96, 4, v95
    v_add_u32 v95, v95, v96
    v_lshl_add_u32 v12, v95, 3, v92
    v_add_u32 v95, 67, v94
    v_lshrrev_b32 v96, 4, v95
    v_add_u32 v95, v95, v96
    v_lshl_add_u32 v14, v95, 3, v92
C_LA2:
    s_cmp_eq_u32 s69, 2
    s_cbranch_scc1 C_T2
    v_lshrrev_b32 v89, 1, v6
    v_xor_b32 v88, v89, v6
    v_and_b32 v88, 1, v88
    v_lshlrev_b32 v88, 8, v88
    v_lshl_add_u32 v88, v89, 3, v88
    v_lshl_add_u32 v88, v5, 4, v88
    s_cmp_eq_u32 s69, 1
    s_cbranch_scc1 C_T1
    s_lshr_b32 s52, s69, 1
    s_mul_i32 s53, s52, 1600
    s_add_u32 s53, s53, s67
    v_add_u32 v88, s53, v88
    v_add_u32 v89, 3200, v88
    s_xor_b32 s52, s52, 1
    s_mov_b32 s53, 0
    s_waitcnt lgkmcnt(14)
    v_mfma_f32_16x16x32_bf16 v[80:83], v[16:19], v[20:23], 0
    s_waitcnt lgkmcnt(12)
    v_mfma_f32_16x16x32_bf16 v[84:87], v[24:27], v[28:31], 0
    s_waitcnt lgkmcnt(10)
    v_mfma_f32_16x16x32_bf16 v[80:83], v[32:35], v[36:39], v[80:83]
    s_waitcnt lgkmcnt(8)
    v_mfma_f32_16x16x32_bf16 v[84:87], v[40:43], v[44:47], v[84:87]
    s_waitcnt lgkmcnt(6)
    v_mfma_f32_16x16x32_bf16 v[80:83], v[48:51], v[52:55], v[80:83]
    s_waitcnt lgkmcnt(4)
    v_mfma_f32_16x16x32_bf16 v[84:87], v[56:59], v[60:63], v[84:87]
    s_waitcnt lgkmcnt(2)
    v_mfma_f32_16x16x32_bf16 v[80:83], v[64:67], v[68:71], v[80:83]
    s_waitcnt lgkmcnt(0)
    v_mfma_f32_16x16x32_bf16 v[84:87], v[72:75], v[76:79], v[84:87]
    s_nop 7
    v_pk_add_f32 v[80:81], v[80:81], v[84:85]
    v_pk_add_f32 v[82:83], v[82:83], v[86:87]
    v_cvt_pk_bf16_f32 v80, v80, v81
    v_cvt_pk_bf16_f32 v81, v82, v83
    ds_write_b64 v88, v[80:81] offset:32
    ds_write2_b32 v89, v80, v81 offset0:7 offset1:8
    s_mov_b64 exec, s[52:53]
    ds_write_b16 v88, v80 offset:1630
    ds_write_b16 v88, v80 offset:4826
    s_mov_b64 exec, -1
    s_branch C_B3
C_T1:
    s_add_u32 s53, s67, 544
    v_add_u32 v88, s53, v88
    v_add_u32 v89, 1600, v88
    s_waitcnt lgkmcnt(14)
    v_mfma_f32_16x16x32_bf16 v[80:83], v[16:19], v[20:23], 0
    s_waitcnt lgkmcnt(12)
    v_mfma_f32_16x16x32_bf16 v[84:87], v[24:27], v[28:31], 0
    s_waitcnt lgkmcnt(10)
    v_mfma_f32_16x16x32_bf16 v[80:83], v[32:35], v[36:39], v[80:83]
    s_waitcnt lgkmcnt(8)
    v_mfma_f32_16x16x32_bf16 v[84:87], v[40:43], v[44:47], v[84:87]
    s_waitcnt lgkmcnt(6)
    v_mfma_f32_16x16x32_bf16 v[80:83], v[48:51], v[52:55], v[80:83]
    s_waitcnt lgkmcnt(4)
    v_mfma_f32_16x16x32_bf16 v[84:87], v[56:59], v[60:63], v[84:87]
    s_waitcnt lgkmcnt(2)
    v_mfma_f32_16x16x32_bf16 v[80:83], v[64:67], v[68:71], v[80:83]
    s_waitcnt lgkmcnt(0)
    v_mfma_f32_16x16x32_bf16 v[84:87], v[72:75], v[76:79], v[84:87]
    s_nop 7
    v_pk_add_f32 v[80:81], v[80:81], v[84:85]
    v_pk_add_f32 v[82:83], v[82:83], v[86:87]
    v_cvt_pk_bf16_f32 v16, v81, v82
    v_cvt_pk_bf16_f32 v17, v82, v82
    v_cvt_pk_bf16_f32 v18, v82, v82
    v_cvt_pk_bf16_f32 v19, v82, v83
    ds_write2_b32 v88, v16, v17 offset0:1 offset1:2
    ds_write_b64 v88, v[16:17] offset:3200
    ds_write2_b32 v89, v18, v19 offset0:1 offset1:2
    ds_write_b64 v88, v[18:19] offset:4800
    v_cvt_pk_bf16_f32 v20, v80, v80
    v_cvt_pk_bf16_f32 v21, v80, v81
    s_mov_b64 exec, 0x1
    ds_write_b32 v88, v20
    ds_write_b32 v88, v20 offset:3196
    ds_write_b32 v88, v21 offset:1600
    ds_write_b32 v88, v21 offset:4796
    s_mov_b32 exec_lo, 0x0
    s_mov_b32 exec_hi, 0x8000
    ds_write_b16 v88, v17 offset:12
    ds_write_b16 v88, v17 offset:1610
    ds_write_b16 v88, v17 offset:3208
    ds_write_b16 v88, v17 offset:4806
    s_mov_b64 exec, -1
    s_branch C_B3
C_T2:
    v_lshlrev_b32 v88, 7, v6
    v_lshl_add_u32 v89, v5, 1, v88
    v_lshl_add_u32 v88, v5, 2, v88
    s_add_u32 s52, s64, 4728
    v_add_u32 v88, s52, v88
    s_add_u32 s52, s64, 4920
    v_add_u32 v89, s52, v89
    v_mov_b32 v90, s67
    s_waitcnt lgkmcnt(14)
    v_mfma_f32_16x16x32_bf16 v[80:83], v[16:19], v[20:23], 0
    s_waitcnt lgkmcnt(12)
    v_mfma_f32_16x16x32_bf16 v[84:87], v[24:27], v[28:31], 0
    s_waitcnt lgkmcnt(10)
    v_mfma_f32_16x16x32_bf16 v[80:83], v[32:35], v[36:39], v[80:83]
    s_waitcnt lgkmcnt(8)
    v_mfma_f32_16x16x32_bf16 v[84:87], v[40:43], v[44:47], v[84:87]
    s_waitcnt lgkmcnt(6)
    v_mfma_f32_16x16x32_bf16 v[80:83], v[48:51], v[52:55], v[80:83]
    s_waitcnt lgkmcnt(4)
    v_mfma_f32_16x16x32_bf16 v[84:87], v[56:59], v[60:63], v[84:87]
    s_waitcnt lgkmcnt(2)
    v_mfma_f32_16x16x32_bf16 v[80:83], v[64:67], v[68:71], v[80:83]
    s_waitcnt lgkmcnt(0)
    v_mfma_f32_16x16x32_bf16 v[84:87], v[72:75], v[76:79], v[84:87]
    s_nop 7
    v_pk_add_f32 v[80:81], v[80:81], v[84:85]
    v_pk_add_f32 v[82:83], v[82:83], v[86:87]
    v_cvt_pk_bf16_f32 v80, v80, v81
    v_cvt_pk_bf16_f32 v81, v82, v83
    s_mov_b32 exec_hi, 0
    ds_write2_b32 v88, v80, v81 offset0:0 offset1:16
    s_not_b64 exec, exec
    ds_write_b16 v89, v80 offset:4
    ds_write_b16_d16_hi v89, v80 offset:36
    ds_write_b16 v89, v81 offset:68
    ds_write_b16_d16_hi v89, v81 offset:100
    ds_write_b16 v89, v80 offset:384
    ds_write_b16_d16_hi v89, v80 offset:416
    ds_write_b16 v89, v81 offset:448
    ds_write_b16_d16_hi v89, v81 offset:480
    s_mov_b32 exec_lo, 0x80000000
    s_mov_b32 exec_hi, 0x0
    ds_write_b16_d16_hi v90, v81 offset:1126
    ds_write_b16_d16_hi v90, v81 offset:1128
    ds_write_b16_d16_hi v90, v81 offset:2724
    ds_write_b16_d16_hi v90, v81 offset:2726
    ds_write_b16_d16_hi v90, v81 offset:4322
    ds_write_b16_d16_hi v90, v81 offset:4324
    ds_write_b16_d16_hi v90, v81 offset:5920
    ds_write_b16_d16_hi v90, v81 offset:5922
    s_mov_b64 exec, -1
C_B3:
    s_mov_b64 exec, 0x1
    ds_inc_u32 v166, v166 offset:128
    s_mov_b64 exec, -1
    s_cmp_lg_u32 s65, 1
    s_cbranch_scc1 C_NOUL
    s_waitcnt vmcnt(0)
    buffer_load_dwordx4 v[24:27], v3, s[40:43], s56 offen offset:0 sc1
    buffer_load_dwordx4 v[28:31], v3, s[40:43], s56 offen offset:1024 sc1
    buffer_load_dwordx4 v[32:35], v3, s[40:43], s56 offen offset:2048 sc1
    buffer_load_dwordx4 v[36:39], v3, s[40:43], s56 offen offset:3072 sc1
C_NOUL:
    s_movk_i32 s60, 4000
C_KM:
    ds_read_b128 v[16:19], v166 offset:128
    s_sub_u32 s60, s60, 1
    s_cmp_gt_i32 s60, 0
    s_waitcnt lgkmcnt(0)
    v_add_u32 v16, v16, v18
    s_nop 0
    v_readfirstlane_b32 s52, v16
    s_nop 0
    s_cselect_b32 s52, s52, 5
    s_cmp_lg_u32 s52, 5
    s_cbranch_scc1 C_KM
    ds_read_b64 v[48:49], v7 offset:0
    ds_read_b64 v[50:51], v7 offset:8
    ds_read_b64 v[52:53], v7 offset:64
    ds_read_b64 v[54:55], v7 offset:72
    ds_read_b64 v[56:57], v7 offset:128
    ds_read_b64 v[58:59], v7 offset:136
    ds_read_b64 v[60:61], v7 offset:192
    ds_read_b64 v[62:63], v7 offset:200
    ds_read_b64 v[64:65], v7 offset:256
    ds_read_b64 v[66:67], v7 offset:264
    ds_read_b64 v[68:69], v7 offset:320
    ds_read_b64 v[70:71], v7 offset:328
    ds_read_b64 v[72:73], v7 offset:384
    ds_read_b64 v[74:75], v7 offset:392
    ds_read_b64 v[76:77], v7 offset:448
    ds_read_b64 v[78:79], v7 offset:456
    ds_read_b64 v[80:81], v7 offset:512
    ds_read_b64 v[82:83], v7 offset:520
    ds_read_b64 v[84:85], v7 offset:576
    ds_read_b64 v[86:87], v7 offset:584
    ds_read_b64 v[88:89], v7 offset:640
    ds_read_b64 v[90:91], v7 offset:648
    ds_read_b64 v[92:93], v7 offset:704
    ds_read_b64 v[94:95], v7 offset:712
    ds_read_b64 v[96:97], v7 offset:768
    ds_read_b64 v[98:99], v7 offset:776
    ds_read_b64 v[100:101], v7 offset:832
    ds_read_b64 v[102:103], v7 offset:840
    ds_read_b64 v[104:105], v7 offset:896
    ds_read_b64 v[106:107], v7 offset:904
    ds_read_b64 v[108:109], v7 offset:960
    ds_read_b64 v[110:111], v7 offset:968
    s_cmp_eq_u32 s63, 1
    s_cbranch_scc1 C_E1
    s_cmp_eq_u32 s63, 2
    s_cbranch_scc1 C_E2
    s_cmp_eq_u32 s63, 3
    s_cbranch_scc1 C_E3
    ds_read_b64 v[112:113], v7 offset:1152
    ds_read_b64 v[114:115], v7 offset:1160
    ds_read_b64 v[116:117], v7 offset:1216
    ds_read_b64 v[118:119], v7 offset:1224
    ds_read_b64 v[128:129], v7 offset:1280
    ds_read_b64 v[130:131], v7 offset:1288
    ds_read_b64 v[132:133], v7 offset:1344
    ds_read_b64 v[134:135], v7 offset:1352
    s_mov_b32 exec_hi, 0
    ds_write_b128 v9, v[160:163]
    s_mov_b64 exec, -1
    s_branch C_EE
C_E1:
    ds_read_b64 v[128:129], v7 offset:1152
    ds_read_b64 v[130:131], v7 offset:1160
    ds_read_b64 v[132:133], v7 offset:1216
    ds_read_b64 v[134:135], v7 offset:1224
    ds_read_b64 v[136:137], v7 offset:1280
    ds_read_b64 v[138:139], v7 offset:1288
    ds_read_b64 v[140:141], v7 offset:1344
    ds_read_b64 v[142:143], v7 offset:1352
    ds_read_b64 v[112:113], v7 offset:1024
    ds_read_b64 v[114:115], v7 offset:1032
    s_branch C_EE
C_E2:
    ds_read_b64 v[152:153], v7 offset:1152
    ds_read_b64 v[154:155], v7 offset:1160
    ds_read_b64 v[156:157], v7 offset:1216
    ds_read_b64 v[158:159], v7 offset:1224
    ds_read_b64 v[112:113], v7 offset:1024
    ds_read_b64 v[114:115], v7 offset:1032
    ds_read_b64 v[128:129], v9 offset:4608
    ds_read_b64 v[130:131], v9 offset:4616
    ds_read_b64 v[132:133], v9 offset:4672
    ds_read_b64 v[134:135], v9 offset:4680
    ds_read_b64 v[136:137], v9 offset:4736
    ds_read_b64 v[138:139], v9 offset:4744
    ds_read_b64 v[140:141], v9 offset:4800
    ds_read_b64 v[142:143], v9 offset:4808
    ds_read_b64 v[144:145], v9 offset:4864
    ds_read_b64 v[146:147], v9 offset:4872
    ds_read_b64 v[148:149], v9 offset:4928
    ds_read_b64 v[150:151], v9 offset:4936
    s_branch C_EE
C_E3:
    ds_read_b64 v[112:113], v7 offset:1024
    ds_read_b64 v[114:115], v7 offset:1032
    ds_read_b64 v[116:117], v7 offset:1088
    ds_read_b64 v[118:119], v7 offset:1096
    ds_read_b64 v[128:129], v9 offset:4608
    ds_read_b64 v[130:131], v9 offset:4616
    ds_read_b64 v[132:133], v9 offset:4672
    ds_read_b64 v[134:135], v9 offset:4680
    ds_read_b64 v[136:137], v9 offset:4736
    ds_read_b64 v[138:139], v9 offset:4744
    ds_read_b64 v[140:141], v9 offset:4800
    ds_read_b64 v[142:143], v9 offset:4808
    ds_read_b64 v[144:145], v9 offset:4864
    ds_read_b64 v[146:147], v9 offset:4872
    ds_read_b64 v[148:149], v9 offset:4928
    ds_read_b64 v[150:151], v9 offset:4936
    ds_read_b64 v[152:153], v10 offset:5120
    ds_read_b64 v[154:155], v10 offset:5128
    ds_read_b64 v[156:157], v10 offset:5184
    ds_read_b64 v[158:159], v10 offset:5192
    ds_read_b64 v[120:121], v10 offset:5248
    ds_read_b64 v[122:123], v10 offset:5256
    ds_read_b64 v[124:125], v10 offset:5312
    ds_read_b64 v[126:127], v10 offset:5320
C_EE:
    v_mov_b32 v167, v19
    v_readfirstlane_b32 s39, v19
    v_mul_u32_u24 v5, 37, v1
    v_lshrrev_b32 v5, 8, v5
    v_mul_u32_u24 v5, 1040, v5
    v_add_u32 v5, v5, v3
    v_add_u32 v6, 0x2400, v5
    s_mul_i32 s44, s2, 18432
    s_mul_i32 s45, s38, 96
    s_add_u32 s44, s44, s45
    s_add_u32 s72, s4, s44
    s_addc_u32 s73, s5, 0
    s_add_u32 s74, s24, s45
    s_addc_u32 s75, s25, 0
    s_mul_i32 s58, s69, 1920
    s_add_u32 s58, s58, s71
    s_add_u32 s58, s58, 4352
    s_cmp_lt_u32 s38, 4
    s_cbranch_scc1 C_B5
    v_mov_b32 v40, -1
    v_mov_b32 v41, -1
    v_mov_b32 v42, -1
    v_mov_b32 v43, -1
    v_lshlrev_b32 v20, 4, v0
    v_lshlrev_b32 v21, 1, v0
    s_cmp_lg_u32 s65, 1
    s_cbranch_scc1 C_PO
    s_lshl_b32 s52, s38, 10
    s_add_u32 m0, s52, 47936
    v_add_u32 v18, 161412, v3
    s_movk_i32 s60, 4000
    s_branch C_UP_W
C_UP:
    buffer_load_dwordx4 v[24:27], v3, s[40:43], s56 offen offset:0 sc1
    buffer_load_dwordx4 v[28:31], v3, s[40:43], s56 offen offset:1024 sc1
    buffer_load_dwordx4 v[32:35], v3, s[40:43], s56 offen offset:2048 sc1
    buffer_load_dwordx4 v[36:39], v3, s[40:43], s56 offen offset:3072 sc1
C_UP_W:
    s_waitcnt vmcnt(0)
    v_xor_b32 v44, v167, v27
    v_xor_b32 v45, v167, v31
    v_xor_b32 v46, v167, v35
    v_xor_b32 v47, v167, v39
    v_or3_b32 v44, v44, v45, v46
    v_or_b32 v44, v44, v47
    v_cmp_ne_u32 vcc, 0, v44
    s_nop 0
    s_and_b64 exec, exec, vcc
    s_cbranch_execz C_UP_D
    s_sub_u32 s60, s60, 1
    s_cmp_gt_i32 s60, 0
    s_sleep 2
    s_cbranch_scc1 C_UP
C_UP_D:
    s_mov_b64 exec, -1
    ds_write_addtid_b32 v25 offset:55040
    ds_write_addtid_b32 v29 offset:55296
    ds_write_addtid_b32 v33 offset:55552
    ds_write_addtid_b32 v37 offset:55808
    s_mov_b64 exec, 0x2
    ds_inc_u32 v18, v18
    s_mov_b64 exec, -1
    ds_write_addtid_b32 v26 offset:60928
    ds_write_addtid_b32 v30 offset:61184
    ds_write_addtid_b32 v34 offset:61440
    ds_write_addtid_b32 v38 offset:61696
    s_mov_b64 exec, 0x4
    ds_inc_u32 v18, v18
    s_mov_b64 exec, -1
    ds_write_addtid_b32 v24 offset:49152
    ds_write_addtid_b32 v28 offset:49408
    ds_write_addtid_b32 v32 offset:49664
    ds_write_addtid_b32 v36 offset:49920
    s_mov_b64 exec, 0x1
    ds_inc_u32 v18, v18
    s_mov_b64 exec, -1
C_PO:
    s_cmp_ge_u32 s50, 144
    s_cbranch_scc1 C_B5
    buffer_store_dwordx4 v[40:43], v20, s[40:43], s48 offen sc1
    buffer_store_short v40, v21, s[40:43], s49 offen sc1
C_B5:
    s_mov_b32 s56, 0xf7efdfbf
    s_mov_b32 s57, 0x7efdfb
    s_movk_i32 s60, 4000
C_UF:
    ds_read_b32 v16, v166 offset:132
    s_sub_u32 s60, s60, 1
    s_cmp_gt_i32 s60, 0
    s_waitcnt lgkmcnt(0)
    v_readfirstlane_b32 s52, v16
    s_nop 0
    s_cselect_b32 s52, s52, 4
    s_cmp_lg_u32 s52, 4
    s_cbranch_scc1 C_UF
    s_movk_i32 s60, 4000
    s_cmp_eq_u32 s63, 1
    s_cbranch_scc1 C_P1
    s_cmp_eq_u32 s63, 2
    s_cbranch_scc1 C_P2
    s_cmp_eq_u32 s63, 3
    s_cbranch_scc1 C_P3
    s_setprio 3
    ds_read_b128 v[32:35], v8 offset:3552
    ds_read_b128 v[36:39], v8 offset:4064
    ds_read_b128 v[40:43], v8 offset:3680
    s_waitcnt lgkmcnt(2)
    v_mfma_f32_16x16x32_bf16 v[136:139], v[112:115], v[32:35], 0
    v_mfma_f32_16x16x32_bf16 v[140:143], v[116:119], v[32:35], 0
    v_mfma_f32_16x16x32_bf16 v[144:147], v[128:131], v[32:35], 0
    v_mfma_f32_16x16x32_bf16 v[148:151], v[132:135], v[32:35], 0
    v_mfma_f32_16x16x32_bf16 v[28:31], v[52:55], v[32:35], 0
    v_mfma_f32_16x16x32_bf16 v[20:23], v[48:51], v[32:35], 0
    ds_read_b128 v[44:47], v8 offset:3808
    s_waitcnt lgkmcnt(2)
    v_mfma_f32_16x16x32_bf16 v[152:155], v[112:115], v[36:39], 0
    v_mfma_f32_16x16x32_bf16 v[156:159], v[116:119], v[36:39], 0
    v_mfma_f32_16x16x32_bf16 v[120:123], v[128:131], v[36:39], 0
    v_mfma_f32_16x16x32_bf16 v[124:127], v[132:135], v[36:39], 0
    v_mfma_f32_16x16x32_bf16 v[28:31], v[84:87], v[36:39], v[28:31]
    v_mfma_f32_16x16x32_bf16 v[20:23], v[80:83], v[36:39], v[20:23]
    v_mfma_f32_16x16x32_bf16 v[24:27], v[52:55], v[36:39], 0
    v_mfma_f32_16x16x32_bf16 v[16:19], v[48:51], v[36:39], 0
    v_cvt_pk_bf16_f32 v136, v136, v137
    v_cvt_pk_bf16_f32 v137, v138, v139
    ds_write_b64 v4, v[136:137] offset:680
    v_cvt_pk_bf16_f32 v140, v140, v141
    v_cvt_pk_bf16_f32 v141, v142, v143
    ds_write_b64 v4, v[140:141] offset:4136
    v_cvt_pk_bf16_f32 v144, v144, v145
    v_cvt_pk_bf16_f32 v145, v146, v147
    ds_write_b64 v4, v[144:145] offset:7592
    v_cvt_pk_bf16_f32 v148, v148, v149
    v_cvt_pk_bf16_f32 v149, v150, v151
    ds_write_b64 v4, v[148:149] offset:11048
    ds_read_b128 v[32:35], v8 offset:3936
    s_waitcnt lgkmcnt(6)
    v_mfma_f32_16x16x32_bf16 v[28:31], v[60:63], v[40:43], v[28:31]
    v_mfma_f32_16x16x32_bf16 v[20:23], v[56:59], v[40:43], v[20:23]
    v_cvt_pk_bf16_f32 v152, v152, v153
    v_cvt_pk_bf16_f32 v153, v154, v155
    ds_write_b64 v4, v[152:153] offset:136
    v_cvt_pk_bf16_f32 v156, v156, v157
    v_cvt_pk_bf16_f32 v157, v158, v159
    ds_write_b64 v4, v[156:157] offset:3592
    v_cvt_pk_bf16_f32 v120, v120, v121
    v_cvt_pk_bf16_f32 v121, v122, v123
    ds_write_b64 v4, v[120:121] offset:7048
    v_cvt_pk_bf16_f32 v124, v124, v125
    v_cvt_pk_bf16_f32 v125, v126, v127
    ds_write_b64 v4, v[124:125] offset:10504
    s_mov_b64 exec, 0x1
    ds_write_b32 v166, v166 offset:0
    s_mov_b64 exec, -1
    s_setprio 2
    ds_read_b128 v[84:87], v8 offset:4192
    ds_read_b64 v[160:161], v2 offset:512
    ds_read_b64 v[162:163], v2
    s_or_b32 s52, s38, s2
    s_cbranch_scc1 C_NOEP
    s_mov_b64 exec, 0x1
    buffer_store_dword v167, v10, s[40:43], 0 offen sc1
    s_mov_b64 exec, -1
C_NOEP:
    s_cmp_ge_u32 s2, 128
    s_cbranch_scc1 C_NX0
    s_mov_b32 m0, s58
    s_mov_b64 exec, s[56:57]
    global_load_lds_dwordx4 v5, s[72:73]
    s_add_u32 m0, s58, 896
    s_nop 0
    global_load_lds_dwordx4 v6, s[72:73]
    s_add_u32 m0, s58, 1792
    s_mov_b64 exec, 0x3f
    global_load_lds_dwordx4 v3, s[74:75]
    s_mov_b64 exec, -1
C_NX0:
    s_mov_b32 m0, 163328
    s_nop 0
    global_load_lds_dword v14, s[28:29]
    s_mov_b64 exec, 0xff
    global_load_lds_dword v13, s[28:29]
    global_load_lds_dword v13, s[26:27]
    global_load_lds_dword v12, s[30:31]
    s_mov_b64 exec, -1
    s_waitcnt lgkmcnt(13)
    v_mfma_f32_16x16x32_bf16 v[28:31], v[68:71], v[44:47], v[28:31]
    v_mfma_f32_16x16x32_bf16 v[20:23], v[64:67], v[44:47], v[20:23]
    ds_read_b128 v[80:83], v8 offset:4320
    s_waitcnt lgkmcnt(9)
    v_mfma_f32_16x16x32_bf16 v[28:31], v[76:79], v[32:35], v[28:31]
    v_mfma_f32_16x16x32_bf16 v[20:23], v[72:75], v[32:35], v[20:23]
    ds_read_b128 v[36:39], v8 offset:4448
    s_waitcnt lgkmcnt(2)
    s_setprio 0
    v_and_b32 v48, 0xffff0000, v161
    v_lshlrev_b32 v49, 16, v161
    v_and_b32 v50, 0xffff0000, v160
    v_lshlrev_b32 v51, 16, v160
    v_mul_f32 v48, v48, v164
    v_mul_f32 v49, v49, v164
    v_mul_f32 v50, v50, v164
    v_mul_f32 v51, v51, v164
    v_cvt_pk_bf16_f32 v49, v48, v49
    v_lshlrev_b32 v48, 16, v49
    v_and_b32 v49, 0xffff0000, v49
    v_cvt_pk_bf16_f32 v51, v50, v51
    v_lshlrev_b32 v50, 16, v51
    v_and_b32 v51, 0xffff0000, v51
    v_and_b32 v52, 0xffff0000, v163
    v_lshlrev_b32 v53, 16, v163
    v_and_b32 v54, 0xffff0000, v162
    v_lshlrev_b32 v55, 16, v162
    v_mul_f32 v52, v52, v164
    v_mul_f32 v53, v53, v164
    v_mul_f32 v54, v54, v164
    v_mul_f32 v55, v55, v164
    v_cvt_pk_bf16_f32 v53, v52, v53
    v_lshlrev_b32 v52, 16, v53
    v_and_b32 v53, 0xffff0000, v53
    v_cvt_pk_bf16_f32 v55, v54, v55
    v_lshlrev_b32 v54, 16, v55
    v_and_b32 v55, 0xffff0000, v55
    s_setprio 2
    v_mfma_f32_16x16x32_bf16 v[28:31], v[92:95], v[84:87], v[28:31]
    v_mfma_f32_16x16x32_bf16 v[20:23], v[88:91], v[84:87], v[20:23]
    v_mfma_f32_16x16x32_bf16 v[24:27], v[60:63], v[84:87], v[24:27]
    v_mfma_f32_16x16x32_bf16 v[16:19], v[56:59], v[84:87], v[16:19]
    s_waitcnt lgkmcnt(1)
    v_mfma_f32_16x16x32_bf16 v[28:31], v[100:103], v[80:83], v[28:31]
    v_mfma_f32_16x16x32_bf16 v[20:23], v[96:99], v[80:83], v[20:23]
    v_mfma_f32_16x16x32_bf16 v[24:27], v[68:71], v[80:83], v[24:27]
    v_mfma_f32_16x16x32_bf16 v[16:19], v[64:67], v[80:83], v[16:19]
    s_waitcnt lgkmcnt(0)
    v_mfma_f32_16x16x32_bf16 v[28:31], v[108:111], v[36:39], v[28:31]
    v_mfma_f32_16x16x32_bf16 v[20:23], v[104:107], v[36:39], v[20:23]
    v_mfma_f32_16x16x32_bf16 v[24:27], v[76:79], v[36:39], v[24:27]
    v_mfma_f32_16x16x32_bf16 v[16:19], v[72:75], v[36:39], v[16:19]
    s_mov_b32 exec_lo, 0xc000c000
    s_mov_b32 exec_hi, 0xc000c000
    s_nop 2
    ds_write_b128 v165, v[28:31] offset:128
    ds_write_b32 v166, v166 offset:64
    s_mov_b64 exec, -1
    s_setprio 0
    s_waitcnt vmcnt(7)
    s_cmp_lt_u32 s2, 128
    s_cbranch_scc1 C_EPI
    s_waitcnt vmcnt(4)
    s_branch C_EPI
C_P1:
    s_setprio 3
    ds_read_b128 v[32:35], v8 offset:2528
    ds_read_b128 v[36:39], v8 offset:3040
    ds_read_b128 v[40:43], v8 offset:2656
    s_waitcnt lgkmcnt(2)
    v_mfma_f32_16x16x32_bf16 v[144:147], v[128:131], v[32:35], 0
    v_mfma_f32_16x16x32_bf16 v[148:151], v[132:135], v[32:35], 0
    v_mfma_f32_16x16x32_bf16 v[152:155], v[136:139], v[32:35], 0
    v_mfma_f32_16x16x32_bf16 v[156:159], v[140:143], v[32:35], 0
    v_mfma_f32_16x16x32_bf16 v[28:31], v[52:55], v[32:35], 0
    v_mfma_f32_16x16x32_bf16 v[20:23], v[48:51], v[32:35], 0
    ds_read_b128 v[44:47], v8 offset:2784
    s_waitcnt lgkmcnt(2)
    v_mfma_f32_16x16x32_bf16 v[116:119], v[128:131], v[36:39], 0
    v_mfma_f32_16x16x32_bf16 v[160:163], v[132:135], v[36:39], 0
    v_mfma_f32_16x16x32_bf16 v[120:123], v[136:139], v[36:39], 0
    v_mfma_f32_16x16x32_bf16 v[124:127], v[140:143], v[36:39], 0
    v_mfma_f32_16x16x32_bf16 v[28:31], v[84:87], v[36:39], v[28:31]
    v_mfma_f32_16x16x32_bf16 v[20:23], v[80:83], v[36:39], v[20:23]
    v_mfma_f32_16x16x32_bf16 v[24:27], v[52:55], v[36:39], 0
    v_mfma_f32_16x16x32_bf16 v[16:19], v[48:51], v[36:39], 0
    v_cvt_pk_bf16_f32 v144, v144, v145
    v_cvt_pk_bf16_f32 v145, v146, v147
    ds_write_b64 v4, v[144:145] offset:1768
    v_cvt_pk_bf16_f32 v148, v148, v149
    v_cvt_pk_bf16_f32 v149, v150, v151
    ds_write_b64 v4, v[148:149] offset:5224
    v_cvt_pk_bf16_f32 v152, v152, v153
    v_cvt_pk_bf16_f32 v153, v154, v155
    ds_write_b64 v4, v[152:153] offset:8680
    v_cvt_pk_bf16_f32 v156, v156, v157
    v_cvt_pk_bf16_f32 v157, v158, v159
    ds_write_b64 v4, v[156:157] offset:12136
    ds_read_b128 v[32:35], v8 offset:2912
    s_waitcnt lgkmcnt(6)
    v_mfma_f32_16x16x32_bf16 v[28:31], v[60:63], v[40:43], v[28:31]
    v_mfma_f32_16x16x32_bf16 v[20:23], v[56:59], v[40:43], v[20:23]
    v_cvt_pk_bf16_f32 v116, v116, v117
    v_cvt_pk_bf16_f32 v117, v118, v119
    ds_write_b64 v4, v[116:117] offset:1224
    v_cvt_pk_bf16_f32 v160, v160, v161
    v_cvt_pk_bf16_f32 v161, v162, v163
    ds_write_b64 v4, v[160:161] offset:4680
    v_cvt_pk_bf16_f32 v120, v120, v121
    v_cvt_pk_bf16_f32 v121, v122, v123
    ds_write_b64 v4, v[120:121] offset:8136
    v_cvt_pk_bf16_f32 v124, v124, v125
    v_cvt_pk_bf16_f32 v125, v126, v127
    ds_write_b64 v4, v[124:125] offset:11592
    s_mov_b64 exec, 0x1
    ds_write_b32 v166, v166 offset:4
    s_mov_b64 exec, -1
    s_setprio 2
    ds_read_b128 v[36:39], v8 offset:3168
    ds_read_b64 v[144:145], v9 offset:4608
    ds_read_b64 v[146:147], v9 offset:4616
    ds_read_b64 v[148:149], v9 offset:4672
    ds_read_b64 v[150:151], v9 offset:4680
    ds_read_b64 v[152:153], v9 offset:4736
    ds_read_b64 v[154:155], v9 offset:4744
    ds_read_b64 v[156:157], v9 offset:4800
    ds_read_b64 v[158:159], v9 offset:4808
    ds_read_b64 v[160:161], v2 offset:512
    ds_read_b64 v[162:163], v2
    s_cmp_ge_u32 s2, 128
    s_cbranch_scc1 C_NX1
    s_mov_b32 m0, s58
    s_mov_b64 exec, s[56:57]
    global_load_lds_dwordx4 v5, s[72:73]
    s_add_u32 m0, s58, 896
    s_nop 0
    global_load_lds_dwordx4 v6, s[72:73]
    s_add_u32 m0, s58, 1792
    s_mov_b64 exec, 0x3f
    global_load_lds_dwordx4 v3, s[74:75]
    s_mov_b64 exec, -1
C_NX1:
    s_waitcnt lgkmcnt(15)
    v_mfma_f32_16x16x32_bf16 v[28:31], v[68:71], v[44:47], v[28:31]
    v_mfma_f32_16x16x32_bf16 v[20:23], v[64:67], v[44:47], v[20:23]
    ds_read_b128 v[40:43], v8 offset:3296
    v_mfma_f32_16x16x32_bf16 v[28:31], v[76:79], v[32:35], v[28:31]
    v_mfma_f32_16x16x32_bf16 v[20:23], v[72:75], v[32:35], v[20:23]
    ds_read_b128 v[128:131], v8 offset:3424
    s_waitcnt lgkmcnt(2)
    s_setprio 0
    v_and_b32 v48, 0xffff0000, v161
    v_lshlrev_b32 v49, 16, v161
    v_and_b32 v50, 0xffff0000, v160
    v_lshlrev_b32 v51, 16, v160
    v_mul_f32 v48, v48, v164
    v_mul_f32 v49, v49, v164
    v_mul_f32 v50, v50, v164
    v_mul_f32 v51, v51, v164
    v_cvt_pk_bf16_f32 v49, v48, v49
    v_lshlrev_b32 v48, 16, v49
    v_and_b32 v49, 0xffff0000, v49
    v_cvt_pk_bf16_f32 v51, v50, v51
    v_lshlrev_b32 v50, 16, v51
    v_and_b32 v51, 0xffff0000, v51
    v_and_b32 v52, 0xffff0000, v163
    v_lshlrev_b32 v53, 16, v163
    v_and_b32 v54, 0xffff0000, v162
    v_lshlrev_b32 v55, 16, v162
    v_mul_f32 v52, v52, v164
    v_mul_f32 v53, v53, v164
    v_mul_f32 v54, v54, v164
    v_mul_f32 v55, v55, v164
    v_cvt_pk_bf16_f32 v53, v52, v53
    v_lshlrev_b32 v52, 16, v53
    v_and_b32 v53, 0xffff0000, v53
    v_cvt_pk_bf16_f32 v55, v54, v55
    v_lshlrev_b32 v54, 16, v55
    v_and_b32 v55, 0xffff0000, v55
    s_setprio 2
    v_mfma_f32_16x16x32_bf16 v[28:31], v[92:95], v[36:39], v[28:31]
    v_mfma_f32_16x16x32_bf16 v[20:23], v[88:91], v[36:39], v[20:23]
    v_mfma_f32_16x16x32_bf16 v[24:27], v[60:63], v[36:39], v[24:27]
    v_mfma_f32_16x16x32_bf16 v[16:19], v[56:59], v[36:39], v[16:19]
    ds_read_b128 v[132:135], v8 offset:3552
    s_waitcnt lgkmcnt(2)
    v_mfma_f32_16x16x32_bf16 v[28:31], v[100:103], v[40:43], v[28:31]
    v_mfma_f32_16x16x32_bf16 v[20:23], v[96:99], v[40:43], v[20:23]
    v_mfma_f32_16x16x32_bf16 v[24:27], v[68:71], v[40:43], v[24:27]
    v_mfma_f32_16x16x32_bf16 v[16:19], v[64:67], v[40:43], v[16:19]
    ds_read_b96 v[60:62], v166
    ds_read_b128 v[136:139], v8 offset:3680
    s_waitcnt lgkmcnt(3)
    v_mfma_f32_16x16x32_bf16 v[28:31], v[108:111], v[128:131], v[28:31]
    v_mfma_f32_16x16x32_bf16 v[20:23], v[104:107], v[128:131], v[20:23]
    v_mfma_f32_16x16x32_bf16 v[24:27], v[76:79], v[128:131], v[24:27]
    v_mfma_f32_16x16x32_bf16 v[16:19], v[72:75], v[128:131], v[16:19]
    s_waitcnt lgkmcnt(1)
C_FL1:
    v_min3_u32 v60, v60, v61, v62
    v_cmp_eq_u32 vcc, 0, v60
    s_nop 4
    s_cbranch_vccz C_FD1
    ds_read_b96 v[60:62], v166
    s_sub_u32 s60, s60, 1
    s_cmp_gt_i32 s60, 0
    s_waitcnt lgkmcnt(0)
    s_cbranch_scc1 C_FL1
C_FD1:
    ds_read_b128 v[140:143], v8 offset:3808
    v_mfma_f32_16x16x32_bf16 v[20:23], v[112:115], v[132:135], v[20:23]
    v_mfma_f32_16x16x32_bf16 v[24:27], v[84:87], v[132:135], v[24:27]
    v_mfma_f32_16x16x32_bf16 v[16:19], v[80:83], v[132:135], v[16:19]
    s_mov_b32 exec_lo, 0xc000c000
    s_mov_b32 exec_hi, 0xc000c000
    ds_write_b128 v165, v[28:31] offset:256
    ds_write_b32 v166, v166 offset:68
    s_mov_b64 exec, -1
    ds_read_b128 v[44:47], v8 offset:3936
    s_waitcnt lgkmcnt(4)
    v_mfma_f32_16x16x32_bf16 v[24:27], v[92:95], v[136:139], v[24:27]
    v_mfma_f32_16x16x32_bf16 v[16:19], v[88:91], v[136:139], v[16:19]
    ds_read_b128 v[32:35], v8 offset:4064
    ds_read_b64_tr_b16 v[36:37], v11 offset:0
    ds_read_b64_tr_b16 v[38:39], v12 offset:0
    ds_read_b64_tr_b16 v[68:69], v11 offset:272
    ds_read_b64_tr_b16 v[70:71], v12 offset:272
    s_waitcnt lgkmcnt(8)
    v_mfma_f32_16x16x32_bf16 v[24:27], v[100:103], v[140:143], v[24:27]
    v_mfma_f32_16x16x32_bf16 v[16:19], v[96:99], v[140:143], v[16:19]
    ds_read_b64_tr_b16 v[64:65], v11 offset:544
    ds_read_b64_tr_b16 v[66:67], v12 offset:544
    s_waitcnt lgkmcnt(7)
    v_mfma_f32_16x16x32_bf16 v[24:27], v[108:111], v[44:47], v[24:27]
    v_mfma_f32_16x16x32_bf16 v[16:19], v[104:107], v[44:47], v[16:19]
    ds_read_b64_tr_b16 v[40:41], v11 offset:816
    ds_read_b64_tr_b16 v[42:43], v12 offset:816
    s_waitcnt lgkmcnt(8)
    v_mfma_f32_16x16x32_bf16 v[16:19], v[112:115], v[32:35], v[16:19]
    s_waitcnt lgkmcnt(6)
    v_mfma_f32_16x16x32_bf16 v[20:23], v[36:39], v[156:159], v[20:23]
    v_mfma_f32_16x16x32_bf16 v[16:19], v[36:39], v[148:151], v[16:19]
    s_waitcnt lgkmcnt(4)
    v_mfma_f32_16x16x32_bf16 v[20:23], v[68:71], v[152:155], v[20:23]
    v_mfma_f32_16x16x32_bf16 v[16:19], v[68:71], v[144:147], v[16:19]
    ds_read_b32 v60, v166 offset:64
    ds_read_b128 v[56:59], v165 offset:128
    s_waitcnt lgkmcnt(4)
    v_mfma_f32_16x16x32_bf16 v[20:23], v[64:67], v[148:151], v[20:23]
    s_waitcnt lgkmcnt(2)
    v_mfma_f32_16x16x32_bf16 v[20:23], v[40:43], v[144:147], v[20:23]
    s_setprio 0
    s_waitcnt lgkmcnt(0)
C_CL1:
    v_cmp_eq_u32 vcc, 0, v60
    s_nop 4
    s_cbranch_vccz C_CD
    ds_read_b32 v60, v166 offset:64
    ds_read_b128 v[56:59], v165 offset:128
    s_sub_u32 s60, s60, 1
    s_cmp_gt_i32 s60, 0
    s_waitcnt lgkmcnt(0)
    s_cbranch_scc1 C_CL1
    s_branch C_CD
C_P2:
    s_setprio 3
    ds_read_b128 v[32:35], v8 offset:1504
    ds_read_b128 v[36:39], v8 offset:2016
    ds_read_b128 v[40:43], v8 offset:1632
    s_waitcnt lgkmcnt(2)
    v_mfma_f32_16x16x32_bf16 v[116:119], v[152:155], v[32:35], 0
    v_mfma_f32_16x16x32_bf16 v[160:163], v[156:159], v[32:35], 0
    v_mfma_f32_16x16x32_bf16 v[28:31], v[52:55], v[32:35], 0
    v_mfma_f32_16x16x32_bf16 v[20:23], v[48:51], v[32:35], 0
    ds_read_b128 v[44:47], v8 offset:1760
    s_waitcnt lgkmcnt(2)
    v_mfma_f32_16x16x32_bf16 v[120:123], v[152:155], v[36:39], 0
    v_mfma_f32_16x16x32_bf16 v[124:127], v[156:159], v[36:39], 0
    v_mfma_f32_16x16x32_bf16 v[28:31], v[84:87], v[36:39], v[28:31]
    v_mfma_f32_16x16x32_bf16 v[20:23], v[80:83], v[36:39], v[20:23]
    v_mfma_f32_16x16x32_bf16 v[24:27], v[52:55], v[36:39], 0
    v_mfma_f32_16x16x32_bf16 v[16:19], v[48:51], v[36:39], 0
    v_cvt_pk_bf16_f32 v116, v116, v117
    v_cvt_pk_bf16_f32 v117, v118, v119
    ds_write_b64 v4, v[116:117] offset:2856
    v_cvt_pk_bf16_f32 v160, v160, v161
    v_cvt_pk_bf16_f32 v161, v162, v163
    ds_write_b64 v4, v[160:161] offset:6312
    ds_read_b128 v[32:35], v8 offset:1888
    s_waitcnt lgkmcnt(4)
    v_mfma_f32_16x16x32_bf16 v[28:31], v[60:63], v[40:43], v[28:31]
    v_mfma_f32_16x16x32_bf16 v[20:23], v[56:59], v[40:43], v[20:23]
    v_cvt_pk_bf16_f32 v120, v120, v121
    v_cvt_pk_bf16_f32 v121, v122, v123
    ds_write_b64 v4, v[120:121] offset:2312
    v_cvt_pk_bf16_f32 v124, v124, v125
    v_cvt_pk_bf16_f32 v125, v126, v127
    ds_write_b64 v4, v[124:125] offset:5768
    s_mov_b64 exec, 0x1
    ds_write_b32 v166, v166 offset:8
    s_mov_b64 exec, -1
    s_setprio 2
    ds_read_b128 v[36:39], v8 offset:2144
    ds_read_b64 v[116:117], v7 offset:1088
    ds_read_b64 v[118:119], v7 offset:1096
    ds_read_b64 v[120:121], v10 offset:5120
    ds_read_b64 v[122:123], v10 offset:5128
    ds_read_b64 v[124:125], v10 offset:5184
    ds_read_b64 v[126:127], v10 offset:5192
    ds_read_b64 v[160:161], v2 offset:512
    ds_read_b64 v[162:163], v2
    s_cmp_ge_u32 s2, 128
    s_cbranch_scc1 C_NX2
    s_mov_b32 m0, s58
    s_mov_b64 exec, s[56:57]
    global_load_lds_dwordx4 v5, s[72:73]
    s_add_u32 m0, s58, 896
    s_nop 0
    global_load_lds_dwordx4 v6, s[72:73]
    s_add_u32 m0, s58, 1792
    s_mov_b64 exec, 0x3f
    global_load_lds_dwordx4 v3, s[74:75]
    s_mov_b64 exec, -1
C_NX2:
    s_waitcnt lgkmcnt(15)
    v_mfma_f32_16x16x32_bf16 v[28:31], v[68:71], v[44:47], v[28:31]
    v_mfma_f32_16x16x32_bf16 v[20:23], v[64:67], v[44:47], v[20:23]
    ds_read_b128 v[40:43], v8 offset:2272
    s_waitcnt lgkmcnt(13)
    v_mfma_f32_16x16x32_bf16 v[28:31], v[76:79], v[32:35], v[28:31]
    v_mfma_f32_16x16x32_bf16 v[20:23], v[72:75], v[32:35], v[20:23]
    ds_read_b128 v[152:155], v8 offset:2400
    s_waitcnt lgkmcnt(2)
    s_setprio 0
    v_and_b32 v48, 0xffff0000, v161
    v_lshlrev_b32 v49, 16, v161
    v_and_b32 v50, 0xffff0000, v160
    v_lshlrev_b32 v51, 16, v160
    v_mul_f32 v48, v48, v164
    v_mul_f32 v49, v49, v164
    v_mul_f32 v50, v50, v164
    v_mul_f32 v51, v51, v164
    v_cvt_pk_bf16_f32 v49, v48, v49
    v_lshlrev_b32 v48, 16, v49
    v_and_b32 v49, 0xffff0000, v49
    v_cvt_pk_bf16_f32 v51, v50, v51
    v_lshlrev_b32 v50, 16, v51
    v_and_b32 v51, 0xffff0000, v51
    v_and_b32 v52, 0xffff0000, v163
    v_lshlrev_b32 v53, 16, v163
    v_and_b32 v54, 0xffff0000, v162
    v_lshlrev_b32 v55, 16, v162
    v_mul_f32 v52, v52, v164
    v_mul_f32 v53, v53, v164
    v_mul_f32 v54, v54, v164
    v_mul_f32 v55, v55, v164
    v_cvt_pk_bf16_f32 v53, v52, v53
    v_lshlrev_b32 v52, 16, v53
    v_and_b32 v53, 0xffff0000, v53
    v_cvt_pk_bf16_f32 v55, v54, v55
    v_lshlrev_b32 v54, 16, v55
    v_and_b32 v55, 0xffff0000, v55
    s_setprio 2
    v_mfma_f32_16x16x32_bf16 v[28:31], v[92:95], v[36:39], v[28:31]
    v_mfma_f32_16x16x32_bf16 v[20:23], v[88:91], v[36:39], v[20:23]
    v_mfma_f32_16x16x32_bf16 v[24:27], v[60:63], v[36:39], v[24:27]
    v_mfma_f32_16x16x32_bf16 v[16:19], v[56:59], v[36:39], v[16:19]
    ds_read_b128 v[156:159], v8 offset:2528
    s_waitcnt lgkmcnt(2)
    v_mfma_f32_16x16x32_bf16 v[28:31], v[100:103], v[40:43], v[28:31]
    v_mfma_f32_16x16x32_bf16 v[20:23], v[96:99], v[40:43], v[20:23]
    v_mfma_f32_16x16x32_bf16 v[24:27], v[68:71], v[40:43], v[24:27]
    v_mfma_f32_16x16x32_bf16 v[16:19], v[64:67], v[40:43], v[16:19]
    ds_read_b128 v[44:47], v8 offset:2656
    s_waitcnt lgkmcnt(2)
    v_mfma_f32_16x16x32_bf16 v[28:31], v[108:111], v[152:155], v[28:31]
    v_mfma_f32_16x16x32_bf16 v[20:23], v[104:107], v[152:155], v[20:23]
    v_mfma_f32_16x16x32_bf16 v[24:27], v[76:79], v[152:155], v[24:27]
    v_mfma_f32_16x16x32_bf16 v[16:19], v[72:75], v[152:155], v[16:19]
    ds_read_b128 v[32:35], v8 offset:2784
    s_waitcnt lgkmcnt(2)
    v_mfma_f32_16x16x32_bf16 v[20:23], v[112:115], v[156:159], v[20:23]
    v_mfma_f32_16x16x32_bf16 v[24:27], v[84:87], v[156:159], v[24:27]
    v_mfma_f32_16x16x32_bf16 v[16:19], v[80:83], v[156:159], v[16:19]
    s_mov_b32 exec_lo, 0xc000c000
    s_mov_b32 exec_hi, 0xc000c000
    ds_write_b128 v165, v[28:31] offset:384
    ds_write_b32 v166, v166 offset:72
    s_mov_b64 exec, -1
    ds_read_b96 v[60:62], v166
    ds_read_b128 v[36:39], v8 offset:2912
    s_waitcnt lgkmcnt(5)
    v_mfma_f32_16x16x32_bf16 v[24:27], v[92:95], v[44:47], v[24:27]
    v_mfma_f32_16x16x32_bf16 v[16:19], v[88:91], v[44:47], v[16:19]
    s_waitcnt lgkmcnt(1)
C_FL2:
    v_min3_u32 v60, v60, v61, v62
    v_cmp_eq_u32 vcc, 0, v60
    s_nop 4
    s_cbranch_vccz C_FD2
    ds_read_b96 v[60:62], v166
    s_sub_u32 s60, s60, 1
    s_cmp_gt_i32 s60, 0
    s_waitcnt lgkmcnt(0)
    s_cbranch_scc1 C_FL2
C_FD2:
    ds_read_b128 v[68:71], v8 offset:3040
    v_mfma_f32_16x16x32_bf16 v[24:27], v[100:103], v[32:35], v[24:27]
    v_mfma_f32_16x16x32_bf16 v[16:19], v[96:99], v[32:35], v[16:19]
    ds_read_b128 v[64:67], v8 offset:3552
    s_waitcnt lgkmcnt(2)
    v_mfma_f32_16x16x32_bf16 v[24:27], v[108:111], v[36:39], v[24:27]
    v_mfma_f32_16x16x32_bf16 v[16:19], v[104:107], v[36:39], v[16:19]
    ds_read_b128 v[40:43], v8 offset:4064
    ds_read_b64_tr_b16 v[76:77], v13 offset:6912
    ds_read_b64_tr_b16 v[78:79], v14 offset:6912
    ds_read_b64_tr_b16 v[72:73], v13 offset:7456
    ds_read_b64_tr_b16 v[74:75], v14 offset:7456
    s_waitcnt lgkmcnt(6)
    v_mfma_f32_16x16x32_bf16 v[16:19], v[112:115], v[68:71], v[16:19]
    ds_read_b64_tr_b16 v[152:153], v11 offset:0
    ds_read_b64_tr_b16 v[154:155], v12 offset:0
    s_waitcnt lgkmcnt(7)
    v_mfma_f32_16x16x32_bf16 v[20:23], v[116:119], v[64:67], v[20:23]
    ds_read_b64_tr_b16 v[84:85], v11 offset:272
    ds_read_b64_tr_b16 v[86:87], v12 offset:272
    s_waitcnt lgkmcnt(8)
    v_mfma_f32_16x16x32_bf16 v[16:19], v[116:119], v[40:43], v[16:19]
    ds_read_b64_tr_b16 v[80:81], v11 offset:544
    ds_read_b64_tr_b16 v[82:83], v12 offset:544
    s_waitcnt lgkmcnt(8)
    v_mfma_f32_16x16x32_bf16 v[20:23], v[76:79], v[124:127], v[20:23]
    v_mfma_f32_16x16x32_bf16 v[16:19], v[76:79], v[120:123], v[16:19]
    ds_read_b64_tr_b16 v[156:157], v11 offset:816
    ds_read_b64_tr_b16 v[158:159], v12 offset:816
    s_waitcnt lgkmcnt(8)
    v_mfma_f32_16x16x32_bf16 v[20:23], v[72:75], v[120:123], v[20:23]
    ds_read_b64_tr_b16 v[92:93], v11 offset:1088
    ds_read_b64_tr_b16 v[94:95], v12 offset:1088
    s_waitcnt lgkmcnt(8)
    v_mfma_f32_16x16x32_bf16 v[16:19], v[152:155], v[148:151], v[16:19]
    ds_read_b64_tr_b16 v[88:89], v11 offset:1360
    ds_read_b64_tr_b16 v[90:91], v12 offset:1360
    s_waitcnt lgkmcnt(8)
    v_mfma_f32_16x16x32_bf16 v[16:19], v[84:87], v[144:147], v[16:19]
    ds_read_b64_tr_b16 v[44:45], v11 offset:1632
    ds_read_b64_tr_b16 v[46:47], v12 offset:1632
    s_waitcnt lgkmcnt(8)
    v_mfma_f32_16x16x32_bf16 v[20:23], v[80:83], v[148:151], v[20:23]
    v_mfma_f32_16x16x32_bf16 v[16:19], v[80:83], v[140:143], v[16:19]
    ds_read_b64_tr_b16 v[100:101], v11 offset:1904
    ds_read_b64_tr_b16 v[102:103], v12 offset:1904
    s_waitcnt lgkmcnt(8)
    v_mfma_f32_16x16x32_bf16 v[20:23], v[156:159], v[144:147], v[20:23]
    v_mfma_f32_16x16x32_bf16 v[16:19], v[156:159], v[136:139], v[16:19]
    s_waitcnt lgkmcnt(6)
    v_mfma_f32_16x16x32_bf16 v[20:23], v[92:95], v[140:143], v[20:23]
    v_mfma_f32_16x16x32_bf16 v[16:19], v[92:95], v[132:135], v[16:19]
    s_waitcnt lgkmcnt(4)
    v_mfma_f32_16x16x32_bf16 v[20:23], v[88:91], v[136:139], v[20:23]
    v_mfma_f32_16x16x32_bf16 v[16:19], v[88:91], v[128:131], v[16:19]
    ds_read_b32 v60, v166 offset:68
    ds_read_b128 v[56:59], v165 offset:256
    s_waitcnt lgkmcnt(4)
    v_mfma_f32_16x16x32_bf16 v[20:23], v[44:47], v[132:135], v[20:23]
    s_waitcnt lgkmcnt(2)
    v_mfma_f32_16x16x32_bf16 v[20:23], v[100:103], v[128:131], v[20:23]
    s_setprio 0
    s_waitcnt lgkmcnt(0)
C_CL2:
    v_cmp_eq_u32 vcc, 0, v60
    s_nop 4
    s_cbranch_vccz C_CD
    ds_read_b32 v60, v166 offset:68
    ds_read_b128 v[56:59], v165 offset:256
    s_sub_u32 s60, s60, 1
    s_cmp_gt_i32 s60, 0
    s_waitcnt lgkmcnt(0)
    s_cbranch_scc1 C_CL2
    s_branch C_CD
C_P3:
    s_setprio 2
    ds_read_b128 v[32:35], v8 offset:480
    ds_read_b128 v[36:39], v8 offset:608
    ds_read_b128 v[40:43], v8 offset:736
    ds_read_b64 v[160:161], v2 offset:512
    ds_read_b64 v[162:163], v2
    s_waitcnt lgkmcnt(4)
    v_mfma_f32_16x16x32_bf16 v[28:31], v[52:55], v[32:35], 0
    v_mfma_f32_16x16x32_bf16 v[20:23], v[48:51], v[32:35], 0
    ds_read_b128 v[44:47], v8 offset:864
    s_waitcnt lgkmcnt(4)
    v_mfma_f32_16x16x32_bf16 v[28:31], v[60:63], v[36:39], v[28:31]
    v_mfma_f32_16x16x32_bf16 v[20:23], v[56:59], v[36:39], v[20:23]
    s_cmp_ge_u32 s2, 128
    s_cbranch_scc1 C_NX3
    s_mov_b32 m0, s58
    s_mov_b64 exec, s[56:57]
    global_load_lds_dwordx4 v5, s[72:73]
    s_add_u32 m0, s58, 896
    s_nop 0
    global_load_lds_dwordx4 v6, s[72:73]
    s_add_u32 m0, s58, 1792
    s_mov_b64 exec, 0x3f
    global_load_lds_dwordx4 v3, s[74:75]
    s_mov_b64 exec, -1
C_NX3:
    ds_read_b128 v[32:35], v8 offset:992
    s_waitcnt lgkmcnt(4)
    v_mfma_f32_16x16x32_bf16 v[28:31], v[68:71], v[40:43], v[28:31]
    v_mfma_f32_16x16x32_bf16 v[20:23], v[64:67], v[40:43], v[20:23]
    ds_read_b128 v[36:39], v8 offset:1120
    s_waitcnt lgkmcnt(2)
    v_mfma_f32_16x16x32_bf16 v[28:31], v[76:79], v[44:47], v[28:31]
    v_mfma_f32_16x16x32_bf16 v[20:23], v[72:75], v[44:47], v[20:23]
    ds_read_b128 v[40:43], v8 offset:1248
    s_waitcnt lgkmcnt(2)
    v_mfma_f32_16x16x32_bf16 v[28:31], v[84:87], v[32:35], v[28:31]
    v_mfma_f32_16x16x32_bf16 v[20:23], v[80:83], v[32:35], v[20:23]
    v_mfma_f32_16x16x32_bf16 v[24:27], v[52:55], v[32:35], 0
    v_mfma_f32_16x16x32_bf16 v[16:19], v[48:51], v[32:35], 0
    ds_read_b128 v[44:47], v8 offset:1376
    s_waitcnt lgkmcnt(2)
    v_mfma_f32_16x16x32_bf16 v[28:31], v[92:95], v[36:39], v[28:31]
    v_mfma_f32_16x16x32_bf16 v[20:23], v[88:91], v[36:39], v[20:23]
    v_mfma_f32_16x16x32_bf16 v[24:27], v[60:63], v[36:39], v[24:27]
    v_mfma_f32_16x16x32_bf16 v[16:19], v[56:59], v[36:39], v[16:19]
    ds_read_b128 v[32:35], v8 offset:1504
    s_setprio 0
    v_and_b32 v48, 0xffff0000, v161
    v_lshlrev_b32 v49, 16, v161
    v_and_b32 v50, 0xffff0000, v160
    v_lshlrev_b32 v51, 16, v160
    v_mul_f32 v48, v48, v164
    v_mul_f32 v49, v49, v164
    v_mul_f32 v50, v50, v164
    v_mul_f32 v51, v51, v164
    v_cvt_pk_bf16_f32 v49, v48, v49
    v_lshlrev_b32 v48, 16, v49
    v_and_b32 v49, 0xffff0000, v49
    v_cvt_pk_bf16_f32 v51, v50, v51
    v_lshlrev_b32 v50, 16, v51
    v_and_b32 v51, 0xffff0000, v51
    v_and_b32 v52, 0xffff0000, v163
    v_lshlrev_b32 v53, 16, v163
    v_and_b32 v54, 0xffff0000, v162
    v_lshlrev_b32 v55, 16, v162
    v_mul_f32 v52, v52, v164
    v_mul_f32 v53, v53, v164
    v_mul_f32 v54, v54, v164
    v_mul_f32 v55, v55, v164
    v_cvt_pk_bf16_f32 v53, v52, v53
    v_lshlrev_b32 v52, 16, v53
    v_and_b32 v53, 0xffff0000, v53
    v_cvt_pk_bf16_f32 v55, v54, v55
    v_lshlrev_b32 v54, 16, v55
    v_and_b32 v55, 0xffff0000, v55
    s_setprio 2
    s_waitcnt lgkmcnt(2)
    v_mfma_f32_16x16x32_bf16 v[28:31], v[100:103], v[40:43], v[28:31]
    v_mfma_f32_16x16x32_bf16 v[20:23], v[96:99], v[40:43], v[20:23]
    v_mfma_f32_16x16x32_bf16 v[24:27], v[68:71], v[40:43], v[24:27]
    v_mfma_f32_16x16x32_bf16 v[16:19], v[64:67], v[40:43], v[16:19]
    ds_read_b128 v[36:39], v8 offset:1632
    s_waitcnt lgkmcnt(2)
    v_mfma_f32_16x16x32_bf16 v[28:31], v[108:111], v[44:47], v[28:31]
    v_mfma_f32_16x16x32_bf16 v[20:23], v[104:107], v[44:47], v[20:23]
    v_mfma_f32_16x16x32_bf16 v[24:27], v[76:79], v[44:47], v[24:27]
    v_mfma_f32_16x16x32_bf16 v[16:19], v[72:75], v[44:47], v[16:19]
    ds_read_b128 v[68:71], v8 offset:1760
    s_waitcnt lgkmcnt(2)
    v_mfma_f32_16x16x32_bf16 v[20:23], v[112:115], v[32:35], v[20:23]
    v_mfma_f32_16x16x32_bf16 v[24:27], v[84:87], v[32:35], v[24:27]
    v_mfma_f32_16x16x32_bf16 v[16:19], v[80:83], v[32:35], v[16:19]
    ds_read_b96 v[60:62], v166
    ds_read_b128 v[64:67], v8 offset:1888
    s_waitcnt lgkmcnt(3)
    v_mfma_f32_16x16x32_bf16 v[24:27], v[92:95], v[36:39], v[24:27]
    v_mfma_f32_16x16x32_bf16 v[16:19], v[88:91], v[36:39], v[16:19]
    s_waitcnt lgkmcnt(1)
C_FL3:
    v_min3_u32 v60, v60, v61, v62
    v_cmp_eq_u32 vcc, 0, v60
    s_nop 4
    s_cbranch_vccz C_FD3
    ds_read_b96 v[60:62], v166
    s_sub_u32 s60, s60, 1
    s_cmp_gt_i32 s60, 0
    s_waitcnt lgkmcnt(0)
    s_cbranch_scc1 C_FL3
C_FD3:
    ds_read_b128 v[40:43], v8 offset:2016
    v_mfma_f32_16x16x32_bf16 v[24:27], v[100:103], v[68:71], v[24:27]
    v_mfma_f32_16x16x32_bf16 v[16:19], v[96:99], v[68:71], v[16:19]
    ds_read_b128 v[76:79], v8 offset:2528
    s_waitcnt lgkmcnt(2)
    v_mfma_f32_16x16x32_bf16 v[24:27], v[108:111], v[64:67], v[24:27]
    v_mfma_f32_16x16x32_bf16 v[16:19], v[104:107], v[64:67], v[16:19]
    ds_read_b128 v[72:75], v8 offset:3040
    ds_read_b64_tr_b16 v[44:45], v13 offset:6912
    ds_read_b64_tr_b16 v[46:47], v14 offset:6912
    ds_read_b64_tr_b16 v[84:85], v13 offset:7456
    ds_read_b64_tr_b16 v[86:87], v14 offset:7456
    s_waitcnt lgkmcnt(6)
    v_mfma_f32_16x16x32_bf16 v[16:19], v[112:115], v[40:43], v[16:19]
    ds_read_b64_tr_b16 v[80:81], v13 offset:8000
    ds_read_b64_tr_b16 v[82:83], v14 offset:8000
    s_waitcnt lgkmcnt(7)
    v_mfma_f32_16x16x32_bf16 v[20:23], v[116:119], v[76:79], v[20:23]
    ds_read_b64_tr_b16 v[32:33], v13 offset:8544
    ds_read_b64_tr_b16 v[34:35], v14 offset:8544
    s_waitcnt lgkmcnt(8)
    v_mfma_f32_16x16x32_bf16 v[16:19], v[116:119], v[72:75], v[16:19]
    ds_read_b64_tr_b16 v[92:93], v11 offset:1088
    ds_read_b64_tr_b16 v[94:95], v12 offset:1088
    s_waitcnt lgkmcnt(8)
    v_mfma_f32_16x16x32_bf16 v[20:23], v[44:47], v[124:127], v[20:23]
    v_mfma_f32_16x16x32_bf16 v[16:19], v[44:47], v[120:123], v[16:19]
    ds_read_b64_tr_b16 v[88:89], v11 offset:1360
    ds_read_b64_tr_b16 v[90:91], v12 offset:1360
    s_waitcnt lgkmcnt(8)
    v_mfma_f32_16x16x32_bf16 v[20:23], v[84:87], v[120:123], v[20:23]
    v_mfma_f32_16x16x32_bf16 v[16:19], v[84:87], v[156:159], v[16:19]
    ds_read_b64_tr_b16 v[36:37], v11 offset:1632
    ds_read_b64_tr_b16 v[38:39], v12 offset:1632
    s_waitcnt lgkmcnt(8)
    v_mfma_f32_16x16x32_bf16 v[20:23], v[80:83], v[156:159], v[20:23]
    v_mfma_f32_16x16x32_bf16 v[16:19], v[80:83], v[152:155], v[16:19]
    ds_read_b64_tr_b16 v[100:101], v11 offset:1904
    ds_read_b64_tr_b16 v[102:103], v12 offset:1904
    s_waitcnt lgkmcnt(8)
    v_mfma_f32_16x16x32_bf16 v[20:23], v[32:35], v[152:155], v[20:23]
    ds_read_b64_tr_b16 v[96:97], v11 offset:2176
    ds_read_b64_tr_b16 v[98:99], v12 offset:2176
    s_waitcnt lgkmcnt(8)
    v_mfma_f32_16x16x32_bf16 v[16:19], v[92:95], v[148:151], v[16:19]
    ds_read_b64_tr_b16 v[68:69], v11 offset:2448
    ds_read_b64_tr_b16 v[70:71], v12 offset:2448
    s_waitcnt lgkmcnt(8)
    v_mfma_f32_16x16x32_bf16 v[16:19], v[88:91], v[144:147], v[16:19]
    ds_read_b64_tr_b16 v[108:109], v11 offset:2720
    ds_read_b64_tr_b16 v[110:111], v12 offset:2720
    s_waitcnt lgkmcnt(8)
    v_mfma_f32_16x16x32_bf16 v[20:23], v[36:39], v[148:151], v[20:23]
    v_mfma_f32_16x16x32_bf16 v[16:19], v[36:39], v[140:143], v[16:19]
    ds_read_b64_tr_b16 v[104:105], v11 offset:2992
    ds_read_b64_tr_b16 v[106:107], v12 offset:2992
    s_waitcnt lgkmcnt(8)
    v_mfma_f32_16x16x32_bf16 v[20:23], v[100:103], v[144:147], v[20:23]
    v_mfma_f32_16x16x32_bf16 v[16:19], v[100:103], v[136:139], v[16:19]
    s_waitcnt lgkmcnt(6)
    v_mfma_f32_16x16x32_bf16 v[20:23], v[96:99], v[140:143], v[20:23]
    v_mfma_f32_16x16x32_bf16 v[16:19], v[96:99], v[132:135], v[16:19]
    s_waitcnt lgkmcnt(4)
    v_mfma_f32_16x16x32_bf16 v[20:23], v[68:71], v[136:139], v[20:23]
    v_mfma_f32_16x16x32_bf16 v[16:19], v[68:71], v[128:131], v[16:19]
    ds_read_b32 v60, v166 offset:72
    ds_read_b128 v[56:59], v165 offset:384
    s_waitcnt lgkmcnt(4)
    v_mfma_f32_16x16x32_bf16 v[20:23], v[108:111], v[132:135], v[20:23]
    s_waitcnt lgkmcnt(2)
    v_mfma_f32_16x16x32_bf16 v[20:23], v[104:107], v[128:131], v[20:23]
    s_setprio 0
    s_waitcnt lgkmcnt(0)
C_CL3:
    v_cmp_eq_u32 vcc, 0, v60
    s_nop 4
    s_cbranch_vccz C_CD
    ds_read_b32 v60, v166 offset:72
    ds_read_b128 v[56:59], v165 offset:384
    s_sub_u32 s60, s60, 1
    s_cmp_gt_i32 s60, 0
    s_waitcnt lgkmcnt(0)
    s_cbranch_scc1 C_CL3
C_CD:
    s_waitcnt vmcnt(3)
    s_cmp_lt_u32 s2, 128
    s_cbranch_scc1 C_CD2
    s_waitcnt vmcnt(0)
C_CD2:
    s_mov_b32 exec_lo, 0x30003
    s_mov_b32 exec_hi, 0x30003
    s_nop 4
    v_pk_add_f32 v[16:17], v[16:17], v[56:57]
    v_pk_add_f32 v[18:19], v[18:19], v[58:59]
    s_mov_b64 exec, -1
C_EPI:
    s_nop 3
    s_movk_i32 s54, 0x3f80
    s_mov_b32 s55, 1.0
    v_add_f32_dpp v16, v24, v16 row_shr:2 row_mask:0xf bank_mask:0xf
    v_add_f32_dpp v17, v25, v17 row_shr:2 row_mask:0xf bank_mask:0xf
    v_add_f32_dpp v18, v26, v18 row_shr:2 row_mask:0xf bank_mask:0xf
    v_add_f32_dpp v19, v27, v19 row_shr:2 row_mask:0xf bank_mask:0xf
    v_add_f32_dpp v20, v28, v20 row_shr:2 row_mask:0xf bank_mask:0xf
    v_add_f32_dpp v21, v29, v21 row_shr:2 row_mask:0xf bank_mask:0xf
    v_add_f32_dpp v22, v30, v22 row_shr:2 row_mask:0xf bank_mask:0xf
    v_add_f32_dpp v23, v31, v23 row_shr:2 row_mask:0xf bank_mask:0xf
    v_add_f32_dpp v20, v24, v20 row_shl:14 row_mask:0xf bank_mask:0xf
    v_add_f32_dpp v21, v25, v21 row_shl:14 row_mask:0xf bank_mask:0xf
    v_add_f32_dpp v22, v26, v22 row_shl:14 row_mask:0xf bank_mask:0xf
    v_add_f32_dpp v23, v27, v23 row_shl:14 row_mask:0xf bank_mask:0xf
    v_cvt_pk_bf16_f32 v16, v16, v17
    v_cvt_pk_bf16_f32 v17, v18, v19
    v_cvt_pk_bf16_f32 v18, v20, v21
    v_cvt_pk_bf16_f32 v19, v22, v23
    v_dot2c_f32_bf16 v48, s54, v16
    v_dot2c_f32_bf16 v49, s55, v16
    v_dot2c_f32_bf16 v50, s54, v17
    v_dot2c_f32_bf16 v51, s55, v17
    v_dot2c_f32_bf16 v52, s54, v18
    v_dot2c_f32_bf16 v53, s55, v18
    v_dot2c_f32_bf16 v54, s54, v19
    v_dot2c_f32_bf16 v55, s55, v19
    v_cvt_pk_bf16_f32 v48, v48, v49
    v_cvt_pk_bf16_f32 v49, v50, v51
    ds_write_b64 v15, v[48:49] offset:0
    v_cvt_pk_bf16_f32 v52, v52, v53
    v_cvt_pk_bf16_f32 v53, v54, v55
    ds_write_b64 v15, v[52:53] offset:544
    s_cmp_ge_u32 s38, 8
    s_cbranch_scc1 C_NOGA
    v_lshrrev_b32 v7, 5, v0
    v_lshlrev_b32 v7, 3, v7
    v_lshl_add_u32 v7, v0, 2, v7
    v_add_u32 v7, 48960, v7
    v_lshrrev_b32 v8, 3, v0
    v_mul_u32_u24 v8, 0x6000, v8
    v_and_b32 v9, 7, v0
    v_lshl_add_u32 v8, v9, 4, v8
    s_lshr_b32 s52, s2, 4
    s_lshl_b32 s52, s52, 11
    s_and_b32 s53, s2, 1
    s_lshl_b32 s53, s53, 10
    s_add_u32 s52, s52, s53
    s_bfe_u32 s53, s2, 0x30001
    s_lshl_b32 s53, s53, 7
    s_add_u32 s52, s52, s53
    s_add_u32 s52, s52, 3211264
    s_add_u32 s53, s52, 1572864
    v_mov_b32 v27, v167
    v_mov_b32 v31, v167
C_NOGA:
    s_waitcnt lgkmcnt(0)
    s_barrier
    s_cmp_ge_u32 s38, 8
    s_cbranch_scc1 C_NOST
    ds_read_b32 v24, v7 offset:0
    ds_read_b32 v25, v7 offset:17408
    ds_read_b32 v26, v7 offset:34816
    ds_read_b32 v28, v7 offset:2176
    ds_read_b32 v29, v7 offset:19584
    ds_read_b32 v30, v7 offset:36992
    s_waitcnt lgkmcnt(3)
    buffer_store_dwordx4 v[24:27], v8, s[40:43], s52 offen sc1
    s_waitcnt lgkmcnt(0)
    buffer_store_dwordx4 v[28:31], v8, s[40:43], s53 offen sc1
C_NOST:
    s_cmp_ge_u32 s2, 184
    s_cbranch_scc1 FFN_LATE
    s_cmp_ge_u32 s2, 128
    s_cbranch_scc1 FINAL
    v_and_b32 v7, 7, v1
    v_lshrrev_b32 v8, 3, v1
    s_mul_i32 s44, s2, 18432
    s_mul_i32 s45, s38, 96
    v_mul_u32_u24 v9, 0xe0, v7
    v_mad_u32_u24 v9, v8, 12, v9
    v_add_u32 v9, s58, v9
    v_xor_b32 v10, 1, v8
    v_mad_u32_u24 v13, v10, 12, s58
    s_mul_i32 s47, s2, 24576
    s_lshl_b32 s48, s38, 11
    s_add_u32 s47, s47, s48
    s_add_u32 s47, s47, 3211264
    v_mul_u32_u24 v84, 48, v7
    v_bfe_u32 v10, v1, 3, 1
    v_lshl_add_u32 v84, v10, 2, v84
    s_lshl_b32 s49, s69, 3
    s_add_u32 s49, s49, s71
    s_add_u32 s49, s49, 14336
    v_add_u32 v84, s49, v84
    v_mul_u32_u24 v85, 48, v1
    v_add_u32 v85, 60992, v85
    s_mov_b32 exec_lo, 0xf0000f
    s_mov_b32 exec_hi, 0xf0000f00
    v_subrev_u32 v84, 1536, v84
    s_mov_b32 exec_lo, 0xff000000
    s_mov_b32 exec_hi, 0xff0000
    v_subrev_u32 v84, 768, v84
    s_mov_b32 exec_lo, 0xff00
    s_mov_b32 exec_hi, 0xff
    v_subrev_u32 v84, 2304, v84
    s_mov_b64 exec, -1
    s_add_u32 s48, s48, 0
    v_and_b32 v10, 6, v7
    v_xor_b32 v10, v10, v8
    v_lshl_add_u32 v10, v7, 3, v10
    v_lshl_add_u32 v86, v10, 4, s48
    v_and_b32 v10, 6, v8
    v_xor_b32 v10, v10, v1
    v_lshl_add_u32 v87, v10, 4, s48
    v_mul_u32_u24 v88, 2944, v8
    v_add_u32 v88, v88, v3
    s_mul_i32 s48, s2, 24576
    s_lshl_b32 s49, s38, 7
    s_add_u32 s48, s48, s49
    s_add_u32 s48, s48, 6356992
    v_mul_u32_u24 v89, 2336, v7
    v_mad_u32_u24 v89, v8, 12, v89
    s_add_u32 s45, s45, 24576
    v_add_u32 v89, s45, v89
    v_add_u32 v10, 1536, v0
    v_add_u32 v11, 0, v0
    v_mul_u32_u24 v11, 911, v11
    v_lshrrev_b32 v11, 16, v11
    v_add_lshl_u32 v90, v10, v11, 4
    v_add_u32 v10, 2304, v0
    v_add_u32 v11, 768, v0
    v_mul_u32_u24 v11, 911, v11
    v_lshrrev_b32 v11, 16, v11
    v_add_lshl_u32 v91, v10, v11, 4
    v_lshl_add_u32 v92, v0, 4, s44
    v_bfe_u32 v10, v1, 3, 1
    v_lshl_add_u32 v10, v7, 1, v10
    s_lshl_b32 s49, s2, 4
    v_add_u32 v93, s49, v10
    v_sub_u32 v12, 0x7ff, v93
    v_lshlrev_b32 v93, 2, v93
    s_mov_b32 s49, 32768
    v_mov_b32 v51, 0
    v_mov_b32 v55, 0
    v_mov_b32 v76, 0
    v_mov_b32 v56, 0
    v_mov_b32 v57, 0
    v_mov_b32 v58, 0
    v_mov_b32 v59, 0
    v_mov_b32 v60, 0
    v_mov_b32 v61, 0
    v_mov_b32 v62, 0
    v_mov_b32 v63, 0
    s_lshl_b32 s50, s2, 6
    s_lshl_b32 s51, s38, 2
    s_add_u32 s50, s50, s51
    s_add_u32 s50, s50, 8192
    s_mov_b32 s56, 0x00100001
    s_mov_b32 s57, 0x10000100
    s_mov_b32 s58, 0xffff0000
    s_waitcnt vmcnt(0)
    buffer_load_dwordx4 v[28:31], v3, s[40:43], s47 offen sc1
    buffer_load_dwordx4 v[32:35], v3, s[40:43], s47 offen offset:1024 sc1
    ds_read_b32 v24, v13 offset:1792
    ds_read_b32 v25, v13 offset:1796
    ds_read_b32 v26, v13 offset:1800
    ds_read2_b32 v[16:17], v9 offset0:0 offset1:1
    ds_read2_b32 v[18:19], v9 offset0:2 offset1:28
    ds_read2_b32 v[20:21], v9 offset0:29 offset1:30
    s_waitcnt lgkmcnt(0)
    v_dot2c_f32_bf16 v76, 0x3f803f80, v24
    v_dot2c_f32_bf16 v76, 0x3f803f80, v25
    v_dot2c_f32_bf16 v76, 0x3f803f80, v26
    v_lshlrev_b32 v36, 16, v16
    v_and_b32 v37, 0xffff0000, v16
    v_lshlrev_b32 v42, 16, v19
    v_and_b32 v43, 0xffff0000, v19
    v_lshlrev_b32 v38, 16, v17
    v_and_b32 v39, 0xffff0000, v17
    v_lshlrev_b32 v44, 16, v20
    v_and_b32 v45, 0xffff0000, v20
    v_lshlrev_b32 v40, 16, v18
    v_and_b32 v41, 0xffff0000, v18
    v_lshlrev_b32 v46, 16, v21
    v_and_b32 v47, 0xffff0000, v21
    v_mov_b32 v77, v76
    s_nop 1
    v_permlane16_swap_b32 v76, v77
    v_add_f32 v76, v76, v77
    v_mov_b32 v77, v76
    s_nop 1
    v_permlane32_swap_b32 v76, v77
    v_add_f32 v76, v76, v77
    s_mov_b32 exec_lo, 0xf00f0
    s_mov_b32 exec_hi, 0xf00f000
    ds_write2_b32 v84, v76, v76 offset0:0 offset1:96
    s_mov_b32 exec_lo, 0xf0f0f0f
    s_mov_b32 exec_hi, 0xf0f0f0f
    v_mov_b32 v24, 0x3f803f80
    v_mov_b32 v25, 0x3f803f80
    v_mov_b32 v26, 0x3f803f80
    s_mov_b32 exec_lo, 0x11111111
    s_mov_b32 exec_hi, 0x11111111
    v_mov_b32 v56, v24
    v_mov_b32 v57, v25
    v_mov_b32 v58, v26
    s_mov_b32 exec_lo, 0x22222222
    s_mov_b32 exec_hi, 0x22222222
    v_mov_b32 v60, v24
    v_mov_b32 v61, v25
    v_mov_b32 v62, v26
    s_mov_b64 exec, -1
    s_movk_i32 s60, 4000
    s_branch L_YP_W
L_YP:
    buffer_load_dwordx4 v[28:31], v3, s[40:43], s47 offen sc1
    buffer_load_dwordx4 v[32:35], v3, s[40:43], s47 offen offset:1024 sc1
L_YP_W:
    s_waitcnt vmcnt(0)
    v_xor_b32 v10, v167, v31
    v_xor_b32 v11, v167, v35
    v_or_b32 v10, v10, v11
    v_cmp_ne_u32 vcc, 0, v10
    s_nop 0
    s_and_b64 exec, exec, vcc
    s_cbranch_execz L_YP_D
    s_sub_u32 s60, s60, 1
    s_cmp_gt_i32 s60, 0
    s_sleep 1
    s_cbranch_scc1 L_YP
L_YP_D:
    s_mov_b64 exec, -1
    v_dot2c_f32_bf16 v36, s54, v28
    v_dot2c_f32_bf16 v37, s54, v29
    v_dot2c_f32_bf16 v38, s54, v30
    v_dot2c_f32_bf16 v39, s54, v34
    v_dot2c_f32_bf16 v40, s54, v32
    v_dot2c_f32_bf16 v41, s54, v33
    v_dot2c_f32_bf16 v42, s55, v28
    v_dot2c_f32_bf16 v43, s55, v29
    v_dot2c_f32_bf16 v44, s55, v30
    v_dot2c_f32_bf16 v45, s55, v34
    v_cvt_pk_bf16_f32 v48, v36, v37
    v_dot2c_f32_bf16 v46, s55, v32
    v_cvt_pk_bf16_f32 v49, v38, v39
    v_dot2c_f32_bf16 v47, s55, v33
    v_cvt_pk_bf16_f32 v50, v40, v41
    v_cvt_pk_bf16_f32 v52, v42, v43
    v_cvt_pk_bf16_f32 v53, v44, v45
    v_mfma_f32_16x16x32_bf16 v[68:71], v[48:51], v[48:51], 0
    v_cvt_pk_bf16_f32 v54, v46, v47
    v_mfma_f32_16x16x32_bf16 v[64:67], v[56:59], v[48:51], 0
    s_nop 0
    v_mfma_f32_16x16x32_bf16 v[64:67], v[60:63], v[52:55], v[64:67]
    v_mfma_f32_16x16x32_bf16 v[72:75], v[52:55], v[52:55], 0
    v_lshlrev_b32 v36, 16, v48
    v_and_b32 v37, 0xffff0000, v48
    v_lshlrev_b32 v38, 16, v49
    v_and_b32 v39, 0xffff0000, v49
    v_lshlrev_b32 v40, 16, v50
    v_and_b32 v41, 0xffff0000, v50
    s_mov_b64 exec, s[56:57]
    v_mov_b32 v64, v68
    v_mov_b32 v65, v72
    s_lshl_b64 exec, exec, 1
    v_mov_b32 v64, v69
    v_mov_b32 v65, v73
    s_lshl_b64 exec, exec, 1
    v_mov_b32 v64, v70
    v_mov_b32 v65, v74
    s_lshl_b64 exec, exec, 1
    v_mov_b32 v64, v71
    v_mov_b32 v65, v75
    s_mov_b32 exec_lo, 0xfff0ff0f
    s_mov_b32 exec_hi, 0xf0ff0fff
    ds_write2_b32 v84, v64, v65 offset0:0 offset1:96
    s_mov_b64 exec, -1
    v_lshlrev_b32 v42, 16, v52
    v_and_b32 v43, 0xffff0000, v52
    v_lshlrev_b32 v44, 16, v53
    v_and_b32 v45, 0xffff0000, v53
    v_lshlrev_b32 v46, 16, v54
    v_and_b32 v47, 0xffff0000, v54
    s_cmp_eq_u32 s38, 0
    s_cbranch_scc0 L_NP
    s_setprio 3
L_NP:
    s_waitcnt lgkmcnt(0)
    s_barrier
    ds_read_b128 v[52:55], v85 offset:0
    ds_read_b128 v[56:59], v85 offset:16
    ds_read_b128 v[60:63], v85 offset:17408
    ds_read_b128 v[64:67], v85 offset:17424
    ds_read_b128 v[68:71], v85 offset:34816
    ds_read_b128 v[72:75], v85 offset:34832
    s_waitcnt lgkmcnt(4)
    s_waitcnt lgkmcnt(2)
    v_pk_add_f32 v[52:53], v[52:53], v[60:61]
    v_pk_add_f32 v[54:55], v[54:55], v[62:63]
    v_pk_add_f32 v[56:57], v[56:57], v[64:65]
    v_pk_add_f32 v[58:59], v[58:59], v[66:67]
    s_waitcnt lgkmcnt(0)
    v_pk_add_f32 v[52:53], v[52:53], v[68:69]
    v_pk_add_f32 v[54:55], v[54:55], v[70:71]
    v_pk_add_f32 v[56:57], v[56:57], v[72:73]
    v_pk_add_f32 v[58:59], v[58:59], v[74:75]
    v_pk_add_f32 v[52:53], v[52:53], v[54:55]
    v_pk_add_f32 v[56:57], v[56:57], v[58:59]
    v_pk_add_f32 v[52:53], v[52:53], v[56:57]
    v_add_f32 v76, v52, v53
    v_add_f32 v78, v52, v53
    s_nop 1
    v_permlane16_swap_b32 v76, v78
    v_mov_b32 v77, v76
    v_mov_b32 v13, v78
    s_nop 0
    v_permlane32_swap_b32 v76, v77
    v_permlane32_swap_b32 v78, v13
    v_mul_f32 v76, 0x3ae38e39, v76
    v_mul_f32 v78, 0x3ae38e39, v78
    v_fma_f32 v78, -v76, v76, v78
    v_max_f32 v78, 0, v78
    v_cvt_pk_bf16_f32 v78, v76, v78
    v_and_b32 v82, 0xffff0000, v78
    v_lshlrev_b32 v80, 16, v78
    v_add_f32 v82, 0x3727c5ac, v82
    v_lshlrev_b32 v81, 16, v78
    v_cvt_pk_bf16_f32 v82, v82, v82
    v_lshlrev_b32 v82, 16, v82
    v_sqrt_f32 v82, v82
    v_fma_f32 v77, -v80, v13, v77
    v_cvt_pk_bf16_f32 v82, v82, v82
    v_lshlrev_b32 v82, 16, v82
    v_rcp_f32 v83, v82
    v_rcp_f32 v82, v82
    s_cbranch_scc0 L_NK
    v_mul_f32 v77, v77, v83
    v_cvt_pk_bf16_f32 v77, v77, v77
    v_ashrrev_i32 v76, 31, v77
    v_or_b32 v76, 0x80000000, v76
    v_xor_b32 v76, v76, v77
    v_and_or_b32 v76, v76, s58, v12
    s_mov_b64 exec, 0xffff
    buffer_store_dword v76, v93, s[40:43], s49 offen sc1
    s_mov_b64 exec, -1
    s_setprio 0
L_NK:
    v_mov_b32_dpp v80, v80 row_ror:8 row_mask:0xf bank_mask:0xc
    v_mov_b32_dpp v81, v81 row_ror:8 row_mask:0xf bank_mask:0x3
    v_mov_b32_dpp v82, v82 row_ror:8 row_mask:0xf bank_mask:0xc
    v_mov_b32_dpp v83, v83 row_ror:8 row_mask:0xf bank_mask:0x3
    v_pk_add_f32 v[56:57], v[36:37], v[80:81] op_sel_hi:[1,0] neg_lo:[0,1] neg_hi:[0,1]
    v_pk_add_f32 v[58:59], v[38:39], v[80:81] op_sel_hi:[1,0] neg_lo:[0,1] neg_hi:[0,1]
    v_pk_add_f32 v[60:61], v[40:41], v[80:81] op_sel_hi:[1,0] neg_lo:[0,1] neg_hi:[0,1]
    v_pk_add_f32 v[62:63], v[42:43], v[80:81] op_sel:[0,1] neg_lo:[0,1] neg_hi:[0,1]
    v_pk_add_f32 v[64:65], v[44:45], v[80:81] op_sel:[0,1] neg_lo:[0,1] neg_hi:[0,1]
    v_pk_add_f32 v[66:67], v[46:47], v[80:81] op_sel:[0,1] neg_lo:[0,1] neg_hi:[0,1]
    v_cvt_pk_bf16_f32 v57, v56, v57
    v_cvt_pk_bf16_f32 v59, v58, v59
    v_cvt_pk_bf16_f32 v61, v60, v61
    v_cvt_pk_bf16_f32 v63, v62, v63
    v_cvt_pk_bf16_f32 v65, v64, v65
    v_cvt_pk_bf16_f32 v67, v66, v67
    v_lshlrev_b32 v56, 16, v57
    v_and_b32 v57, 0xffff0000, v57
    v_lshlrev_b32 v58, 16, v59
    v_and_b32 v59, 0xffff0000, v59
    v_lshlrev_b32 v60, 16, v61
    v_and_b32 v61, 0xffff0000, v61
    v_lshlrev_b32 v62, 16, v63
    v_and_b32 v63, 0xffff0000, v63
    v_lshlrev_b32 v64, 16, v65
    v_and_b32 v65, 0xffff0000, v65
    v_lshlrev_b32 v66, 16, v67
    v_and_b32 v67, 0xffff0000, v67
    v_pk_mul_f32 v[56:57], v[56:57], v[82:83] op_sel_hi:[1,0]
    v_pk_mul_f32 v[58:59], v[58:59], v[82:83] op_sel_hi:[1,0]
    v_pk_mul_f32 v[60:61], v[60:61], v[82:83] op_sel_hi:[1,0]
    v_pk_mul_f32 v[62:63], v[62:63], v[82:83] op_sel:[0,1]
    v_pk_mul_f32 v[64:65], v[64:65], v[82:83] op_sel:[0,1]
    v_pk_mul_f32 v[66:67], v[66:67], v[82:83] op_sel:[0,1]
    v_cvt_pk_bf16_f32 v28, v56, v57
    v_cvt_pk_bf16_f32 v29, v58, v59
    v_cvt_pk_bf16_f32 v30, v60, v61
    ds_write_b128 v86, v[28:31]
    v_cvt_pk_bf16_f32 v32, v62, v63
    v_cvt_pk_bf16_f32 v33, v64, v65
    v_cvt_pk_bf16_f32 v34, v66, v67
    ds_write_b128 v86, v[32:35] offset:1024
    ds_read_b128 v[56:59], v87
    ds_read_b128 v[60:63], v87 offset:1024
    v_dot2c_f32_bf16 v36, s54, v28
    v_dot2c_f32_bf16 v37, s55, v28
    v_dot2c_f32_bf16 v38, s54, v29
    v_dot2c_f32_bf16 v39, s55, v29
    v_dot2c_f32_bf16 v40, s54, v30
    v_dot2c_f32_bf16 v41, s55, v30
    v_dot2c_f32_bf16 v42, s54, v32
    v_dot2c_f32_bf16 v43, s55, v32
    v_dot2c_f32_bf16 v44, s54, v33
    v_dot2c_f32_bf16 v45, s55, v33
    v_dot2c_f32_bf16 v46, s54, v34
    v_dot2c_f32_bf16 v47, s55, v34
    s_waitcnt lgkmcnt(1)
    buffer_store_dwordx4 v[56:59], v88, s[40:43], s48 offen sc1
    s_waitcnt lgkmcnt(0)
    buffer_store_dwordx4 v[60:63], v88, s[40:43], s48 offen offset:1536 sc1
    v_cvt_pk_bf16_f32 v48, v36, v37
    v_cvt_pk_bf16_f32 v49, v38, v39
    v_cvt_pk_bf16_f32 v50, v40, v41
    v_cvt_pk_bf16_f32 v51, v42, v43
    v_cvt_pk_bf16_f32 v52, v44, v45
    v_cvt_pk_bf16_f32 v53, v46, v47
    v_add_u32 v10, 1168, v89
    ds_write2_b32 v89, v48, v49 offset0:0 offset1:1
    ds_write_b32 v89, v50 offset:8
    ds_write2_b32 v10, v51, v52 offset0:0 offset1:1
    ds_write_b32 v10, v53 offset:8
    v_add_u32 v11, 12288, v92
    s_waitcnt lgkmcnt(0)
    s_barrier
    ds_read_b128 v[16:19], v90
    ds_read_b128 v[20:23], v91
    v_mov_b32 v10, 0
    s_waitcnt lgkmcnt(1)
    global_store_dwordx4 v92, v[16:19], s[32:33] sc1
    s_cmp_ge_u32 s38, 6
    s_cbranch_scc1 L_O1
    s_waitcnt lgkmcnt(0)
    global_store_dwordx4 v11, v[20:23], s[32:33] sc1
L_O1:
    s_cmp_eq_u32 s38, 11
    s_cbranch_scc1 TOP8
    s_waitcnt vmcnt(0)
    s_mov_b64 exec, 0x1
    buffer_store_dword v167, v10, s[40:43], s50 offen sc1
    s_mov_b64 exec, -1
    s_branch END
FFN_DMA0:
    s_sub_u32 s58, s2, 192
    s_lshl_b32 s61, s58, 1
    s_mov_b32 s59, 8
    s_add_u32 s56, s38, 1
    s_bfe_u32 s50, s56, 0x10003
    s_and_b32 s51, s56, 1
    s_bfe_u32 s52, s56, 0x10001
    s_mul_i32 s52, s52, 36
    s_add_u32 s52, s52, s51
    s_mul_i32 s48, s52, 73728
    s_lshl_b32 s53, s61, 6
    s_add_u32 s48, s48, s53
    s_lshl_b32 s49, s52, 10
    s_mul_i32 s53, s50, 73728
    s_add_u32 s49, s49, s53
    s_lshl_b32 s51, s51, 1
    s_lshl_b32 s53, s50, 2
    s_or_b32 s51, s51, s53
    v_bfe_u32 v2, v1, 4, 1
    v_and_b32 v4, 7, v1
    v_xor_b32 v2, v2, v4
    v_xor_b32 v2, s51, v2
    v_lshrrev_b32 v4, 3, v1
    v_mul_u32_u24 v4, 0x2400, v4
    v_lshl_add_u32 v2, v2, 4, v4
    s_mov_b32 s46, 5308416
    s_mov_b32 s47, 0x00020000
    s_waitcnt lgkmcnt(0)
    s_cmp_eq_u32 s50, 0
    s_cselect_b32 s44, s26, s28
    s_cselect_b32 s45, s27, s29
    s_mov_b32 s40, s36
    s_mov_b32 s41, s37
    s_barrier
    s_sub_u32 s51, s38, 3
    s_cmp_ge_u32 s51, 8
    s_cbranch_scc1 F_B0
    s_add_u32 m0, s49, 0
    s_add_u32 s53, s48, 0
    buffer_load_dwordx4 v2, s[44:47], s53 offen lds
    s_add_u32 m0, s49, 2048
    s_add_u32 s53, s48, 147456
    buffer_load_dwordx4 v2, s[44:47], s53 offen lds
    s_barrier
    s_branch F_B2
FFN_LATE:
    s_sub_u32 s58, s2, 120
    s_lshl_b32 s61, s58, 1
    s_mov_b32 s59, 8
F_L2:
    s_sub_u32 s51, s38, 3
    s_cmp_ge_u32 s51, 8
    s_cbranch_scc1 F_B0
    s_add_u32 s56, s38, 1
    s_bfe_u32 s50, s56, 0x10003
    s_and_b32 s51, s56, 1
    s_bfe_u32 s52, s56, 0x10001
    s_mul_i32 s52, s52, 36
    s_add_u32 s52, s52, s51
    s_mul_i32 s48, s52, 73728
    s_lshl_b32 s53, s61, 6
    s_add_u32 s48, s48, s53
    s_lshl_b32 s49, s52, 10
    s_mul_i32 s53, s50, 73728
    s_add_u32 s49, s49, s53
    s_lshl_b32 s51, s51, 1
    s_lshl_b32 s53, s50, 2
    s_or_b32 s51, s51, s53
    v_bfe_u32 v2, v1, 4, 1
    v_and_b32 v4, 7, v1
    v_xor_b32 v2, v2, v4
    v_xor_b32 v2, s51, v2
    v_lshrrev_b32 v4, 3, v1
    v_mul_u32_u24 v4, 0x2400, v4
    v_lshl_add_u32 v2, v2, 4, v4
    s_mov_b32 s46, 5308416
    s_mov_b32 s47, 0x00020000
    s_cmp_eq_u32 s50, 0
    s_cselect_b32 s44, s26, s28
    s_cselect_b32 s45, s27, s29
    s_barrier
    s_add_u32 m0, s49, 0
    s_add_u32 s53, s48, 0
    buffer_load_dwordx4 v2, s[44:47], s53 offen lds
    s_add_u32 m0, s49, 2048
    s_add_u32 s53, s48, 147456
    buffer_load_dwordx4 v2, s[44:47], s53 offen lds
F_B2:
    s_add_u32 m0, s49, 4096
    s_add_u32 s53, s48, 294912
    buffer_load_dwordx4 v2, s[44:47], s53 offen lds
    s_add_u32 m0, s49, 6144
    s_add_u32 s53, s48, 442368
    buffer_load_dwordx4 v2, s[44:47], s53 offen lds
    s_add_u32 m0, s49, 8192
    s_add_u32 s53, s48, 589824
    buffer_load_dwordx4 v2, s[44:47], s53 offen lds
    s_add_u32 m0, s49, 10240
    s_add_u32 s53, s48, 737280
    buffer_load_dwordx4 v2, s[44:47], s53 offen lds
    s_add_u32 m0, s49, 12288
    s_add_u32 s53, s48, 884736
    buffer_load_dwordx4 v2, s[44:47], s53 offen lds
    s_add_u32 m0, s49, 14336
    s_add_u32 s53, s48, 1032192
    buffer_load_dwordx4 v2, s[44:47], s53 offen lds
    s_add_u32 m0, s49, 16384
    s_add_u32 s53, s48, 1179648
    buffer_load_dwordx4 v2, s[44:47], s53 offen lds
    s_add_u32 m0, s49, 18432
    s_add_u32 s53, s48, 1327104
    buffer_load_dwordx4 v2, s[44:47], s53 offen lds
    s_add_u32 m0, s49, 20480
    s_add_u32 s53, s48, 1474560
    buffer_load_dwordx4 v2, s[44:47], s53 offen lds
    s_add_u32 m0, s49, 22528
    s_add_u32 s53, s48, 1622016
    buffer_load_dwordx4 v2, s[44:47], s53 offen lds
    s_add_u32 m0, s49, 24576
    s_add_u32 s53, s48, 1769472
    buffer_load_dwordx4 v2, s[44:47], s53 offen lds
    s_add_u32 m0, s49, 26624
    s_add_u32 s53, s48, 1916928
    buffer_load_dwordx4 v2, s[44:47], s53 offen lds
    s_add_u32 m0, s49, 28672
    s_add_u32 s53, s48, 2064384
    buffer_load_dwordx4 v2, s[44:47], s53 offen lds
    s_add_u32 m0, s49, 30720
    s_add_u32 s53, s48, 2211840
    buffer_load_dwordx4 v2, s[44:47], s53 offen lds
    s_add_u32 m0, s49, 32768
    s_add_u32 s53, s48, 2359296
    buffer_load_dwordx4 v2, s[44:47], s53 offen lds
    s_add_u32 m0, s49, 34816
    s_add_u32 s53, s48, 2506752
    buffer_load_dwordx4 v2, s[44:47], s53 offen lds
    s_branch F_W
FFN_DMA:
    s_setprio 0
    s_sub_u32 s58, s2, 192
    s_lshl_b32 s61, s58, 1
    s_mov_b32 s59, 8
    s_waitcnt vmcnt(0)
    s_branch F_L2
F_B0:
    s_setprio 3
    s_barrier
F_W:
    s_mov_b64 exec, -1
    v_mov_b32 v167, 156684
    ds_read_b32 v167, v167
    v_and_b32 v7, 7, v1
    v_lshrrev_b32 v8, 3, v1
    v_and_b32 v5, 15, v1
    v_lshrrev_b32 v6, 4, v1
    s_mul_i32 s52, s61, 36864
    s_mul_i32 s53, s38, 96
    s_add_u32 s52, s52, s53
    v_mul_u32_u24 v9, 0x480, v8
    v_mad_u32_u24 v9, v7, 12, v9
    v_add_u32 v9, s52, v9
    global_load_dwordx3 v[16:18], v9, s[30:31]
    v_add_u32 v9, 0x2400, v9
    global_load_dwordx3 v[20:22], v9, s[30:31]
    v_add_u32 v9, 0x2400, v9
    global_load_dwordx3 v[24:26], v9, s[30:31]
    v_add_u32 v9, 0x2400, v9
    global_load_dwordx3 v[28:30], v9, s[30:31]
    v_add_u32 v9, 0x2400, v9
    global_load_dwordx3 v[32:34], v9, s[30:31]
    v_add_u32 v9, 0x2400, v9
    global_load_dwordx3 v[36:38], v9, s[30:31]
    v_add_u32 v9, 0x2400, v9
    global_load_dwordx3 v[40:42], v9, s[30:31]
    v_add_u32 v9, 0x2400, v9
    global_load_dwordx3 v[44:46], v9, s[30:31]
    s_mov_b64 exec, -1
    v_mul_u32_u24 v10, 683, v0
    v_lshrrev_b32 v10, 16, v10
    v_mul_u32_u24 v11, 0x60, v10
    v_sub_u32 v11, v0, v11
    s_mov_b32 s52, 161920
    v_lshl_add_u32 v160, v10, 2, s52
    s_mov_b32 s52, 3144192
    v_lshl_add_u32 v161, v11, 4, s52
    v_mul_u32_u24 v162, 1184, v10
    v_mad_u32_u24 v162, v11, 12, v162
    v_add_u32 v162, 147456, v162
    v_mul_u32_u24 v163, 1184, v7
    v_lshl_add_u32 v163, v6, 4, v163
    v_add_u32 v163, 147456, v163
    s_lshr_b32 s52, s38, 2
    s_lshl_b32 s52, s52, 10
    s_and_b32 s53, s38, 3
    s_lshl_b32 s53, s53, 2
    s_add_u32 s52, s52, s53
    s_add_u32 s52, s52, 156928
    v_add_u32 v164, s52, v3
    v_and_b32 v10, 1, v6
    v_mul_u32_u24 v10, 0x48, v10
    v_and_b32 v11, 1, v8
    v_add3_u32 v166, v10, v11, 2
    v_lshl_add_u32 v10, v11, 2, v10
    v_lshrrev_b32 v11, 1, v6
    v_add_u32 v165, v10, v11
    v_mul_u32_u24 v165, 9216, v165
    v_mul_u32_u24 v166, 9216, v166
    v_lshl_add_u32 v165, v7, 4, v165
    v_lshl_add_u32 v166, v7, 4, v166
    s_mul_i32 s62, s38, 55296
    s_lshl_b32 s53, s58, 7
    s_add_u32 s62, s62, s53
    s_add_u32 s62, s62, 9502720
    s_mov_b32 s63, 6356992
    s_movk_i32 s64, -1536
    v_and_b32 v10, 1, v1
    v_bfe_u32 v11, v1, 3, 2
    v_lshl_add_u32 v11, v10, 2, v11
    v_xor_b32 v11, s38, v11
    v_mul_u32_u24 v12, 73728, v10
    v_lshl_add_u32 v12, v11, 4, v12
    v_and_b32 v10, 2, v1
    v_lshl_add_u32 v12, v10, 2, v12
    v_bfe_u32 v10, v1, 2, 2
    v_lshl_add_u32 v10, v6, 3, v10
    v_lshl_add_u32 v12, v10, 7, v12
    v_add_u32 v13, 36864, v12
    v_mov_b32 v14, 161488
    v_mov_b32 v15, 1
    s_mov_b32 s52, 0x05040100
    s_mov_b32 s53, 0x07060302
    v_mov_b32 v10, s52
    s_mov_b32 exec_lo, 0xff00ff00
    s_mov_b32 exec_hi, 0xff00ff00
    v_mov_b32 v10, 0x03020706
    s_mov_b64 exec, -1
    s_waitcnt lgkmcnt(0)
    v_readfirstlane_b32 s39, v167
    s_sub_u32 s51, s38, 3
    s_cmp_ge_u32 s51, 8
    s_cbranch_scc1 F_NC
    s_waitcnt vmcnt(8)
    s_mov_b64 exec, 0x1
    ds_add_u32 v14, v15
    s_mov_b64 exec, -1
F_NC:
    s_waitcnt vmcnt(7)
    v_mov_b32 v19, v16
    v_mov_b32_dpp v11, v17 row_ror:8 row_mask:0xf bank_mask:0xf
    v_mov_b32_dpp v16, v18 row_ror:8 row_mask:0xf bank_mask:0xc
    v_mov_b32_dpp v18, v19 row_ror:8 row_mask:0xf bank_mask:0x3
    v_perm_b32 v152, v11, v17, v10
    v_perm_b32 v136, v18, v16, s52
    v_perm_b32 v144, v18, v16, s53
    s_waitcnt vmcnt(6)
    v_mov_b32 v23, v20
    v_mov_b32_dpp v11, v21 row_ror:8 row_mask:0xf bank_mask:0xf
    v_mov_b32_dpp v20, v22 row_ror:8 row_mask:0xf bank_mask:0xc
    v_mov_b32_dpp v22, v23 row_ror:8 row_mask:0xf bank_mask:0x3
    v_perm_b32 v153, v11, v21, v10
    v_perm_b32 v137, v22, v20, s52
    v_perm_b32 v145, v22, v20, s53
    s_waitcnt vmcnt(5)
    v_mov_b32 v27, v24
    v_mov_b32_dpp v11, v25 row_ror:8 row_mask:0xf bank_mask:0xf
    v_mov_b32_dpp v24, v26 row_ror:8 row_mask:0xf bank_mask:0xc
    v_mov_b32_dpp v26, v27 row_ror:8 row_mask:0xf bank_mask:0x3
    v_perm_b32 v154, v11, v25, v10
    v_perm_b32 v138, v26, v24, s52
    v_perm_b32 v146, v26, v24, s53
    s_waitcnt vmcnt(4)
    v_mov_b32 v31, v28
    v_mov_b32_dpp v11, v29 row_ror:8 row_mask:0xf bank_mask:0xf
    v_mov_b32_dpp v28, v30 row_ror:8 row_mask:0xf bank_mask:0xc
    v_mov_b32_dpp v30, v31 row_ror:8 row_mask:0xf bank_mask:0x3
    v_perm_b32 v155, v11, v29, v10
    v_perm_b32 v139, v30, v28, s52
    v_perm_b32 v147, v30, v28, s53
    s_waitcnt vmcnt(3)
    v_mov_b32 v35, v32
    v_mov_b32_dpp v11, v33 row_ror:8 row_mask:0xf bank_mask:0xf
    v_mov_b32_dpp v32, v34 row_ror:8 row_mask:0xf bank_mask:0xc
    v_mov_b32_dpp v34, v35 row_ror:8 row_mask:0xf bank_mask:0x3
    v_perm_b32 v156, v11, v33, v10
    v_perm_b32 v140, v34, v32, s52
    v_perm_b32 v148, v34, v32, s53
    s_waitcnt vmcnt(2)
    v_mov_b32 v39, v36
    v_mov_b32_dpp v11, v37 row_ror:8 row_mask:0xf bank_mask:0xf
    v_mov_b32_dpp v36, v38 row_ror:8 row_mask:0xf bank_mask:0xc
    v_mov_b32_dpp v38, v39 row_ror:8 row_mask:0xf bank_mask:0x3
    v_perm_b32 v157, v11, v37, v10
    v_perm_b32 v141, v38, v36, s52
    v_perm_b32 v149, v38, v36, s53
    s_waitcnt vmcnt(1)
    v_mov_b32 v43, v40
    v_mov_b32_dpp v11, v41 row_ror:8 row_mask:0xf bank_mask:0xf
    v_mov_b32_dpp v40, v42 row_ror:8 row_mask:0xf bank_mask:0xc
    v_mov_b32_dpp v42, v43 row_ror:8 row_mask:0xf bank_mask:0x3
    v_perm_b32 v158, v11, v41, v10
    v_perm_b32 v142, v42, v40, s52
    v_perm_b32 v150, v42, v40, s53
    s_waitcnt vmcnt(0)
    v_mov_b32 v47, v44
    v_mov_b32_dpp v11, v45 row_ror:8 row_mask:0xf bank_mask:0xf
    v_mov_b32_dpp v44, v46 row_ror:8 row_mask:0xf bank_mask:0xc
    v_mov_b32_dpp v46, v47 row_ror:8 row_mask:0xf bank_mask:0x3
    v_perm_b32 v159, v11, v45, v10
    v_perm_b32 v143, v46, v44, s52
    v_perm_b32 v151, v46, v44, s53
    s_cmp_ge_u32 s38, s59
    s_cbranch_scc1 F_NT
    s_movk_i32 s60, 4000
F_CP:
    ds_read_b32 v15, v14
    s_sub_u32 s60, s60, 1
    s_cmp_gt_i32 s60, 0
    s_waitcnt lgkmcnt(0)
    v_readfirstlane_b32 s52, v15
    s_nop 0
    s_cselect_b32 s52, s52, 8
    s_cmp_eq_u32 s52, 8
    s_cbranch_scc1 F_CD
    s_sleep 2
    s_branch F_CP
F_CD:
    ds_read_b64_tr_b16 v[64:65], v12 offset:0
    ds_read_b64_tr_b16 v[66:67], v12 offset:512
    ds_read_b64_tr_b16 v[68:69], v12 offset:4096
    ds_read_b64_tr_b16 v[70:71], v12 offset:4608
    ds_read_b64_tr_b16 v[72:73], v12 offset:8192
    ds_read_b64_tr_b16 v[74:75], v12 offset:8704
    ds_read_b64_tr_b16 v[76:77], v12 offset:12288
    ds_read_b64_tr_b16 v[78:79], v12 offset:12800
    ds_read_b64_tr_b16 v[80:81], v12 offset:16384
    ds_read_b64_tr_b16 v[82:83], v12 offset:16896
    ds_read_b64_tr_b16 v[84:85], v12 offset:20480
    ds_read_b64_tr_b16 v[86:87], v12 offset:20992
    ds_read_b64_tr_b16 v[88:89], v12 offset:24576
    ds_read_b64_tr_b16 v[90:91], v12 offset:25088
    ds_read_b64_tr_b16 v[92:93], v12 offset:28672
    ds_read_b64_tr_b16 v[94:95], v12 offset:29184
    ds_read_b64_tr_b16 v[96:97], v12 offset:32768
    ds_read_b64_tr_b16 v[98:99], v12 offset:33280
    ds_read_b64_tr_b16 v[100:101], v13 offset:0
    ds_read_b64_tr_b16 v[102:103], v13 offset:512
    ds_read_b64_tr_b16 v[104:105], v13 offset:4096
    ds_read_b64_tr_b16 v[106:107], v13 offset:4608
    ds_read_b64_tr_b16 v[108:109], v13 offset:8192
    ds_read_b64_tr_b16 v[110:111], v13 offset:8704
    ds_read_b64_tr_b16 v[112:113], v13 offset:12288
    ds_read_b64_tr_b16 v[114:115], v13 offset:12800
    ds_read_b64_tr_b16 v[116:117], v13 offset:16384
    ds_read_b64_tr_b16 v[118:119], v13 offset:16896
    ds_read_b64_tr_b16 v[120:121], v13 offset:20480
    ds_read_b64_tr_b16 v[122:123], v13 offset:20992
    ds_read_b64_tr_b16 v[124:125], v13 offset:24576
    ds_read_b64_tr_b16 v[126:127], v13 offset:25088
    ds_read_b64_tr_b16 v[128:129], v13 offset:28672
    ds_read_b64_tr_b16 v[130:131], v13 offset:29184
    ds_read_b64_tr_b16 v[132:133], v13 offset:32768
    ds_read_b64_tr_b16 v[134:135], v13 offset:33280
F_NT:
    s_cmp_lg_u32 s38, 11
    s_cbranch_scc1 F_SEL
    s_branch T_EV
FINAL:
    s_cmp_ge_u32 s2, 144
    s_cbranch_scc1 END
    s_cmp_lg_u32 s38, 11
    s_cbranch_scc1 END
T_EV:
TOP8:
    v_bfe_i32 v7, v1, 0, 1
    v_bfe_i32 v8, v1, 1, 1
    v_bfe_i32 v9, v1, 3, 1
    v_bfe_i32 v11, v1, 4, 1
    v_bfe_i32 v13, v1, 5, 1
    v_xor_b32 v48, v7, v8
    v_xor_b32 v49, v8, v9
    v_xor_b32 v50, v7, v9
    v_xor_b32 v11, v11, v13
    v_xor_b32 v51, v9, v11
    v_xor_b32 v52, v8, v11
    v_xor_b32 v53, v7, v11
    v_sub_u32 v54, 148464, v3
    v_and_b32 v7, 4, v1
    v_and_b32 v8, 48, v1
    v_lshlrev_b32 v8, 6, v8
    v_lshl_add_u32 v55, v7, 1, v8
    v_add_u32 v55, 147456, v55
    s_mov_b32 s65, 32768
    s_mov_b32 s66, 36864
    s_and_b32 s67, s2, 127
    s_lshl_b32 s68, s67, 6
    s_add_u32 s68, s68, 32768
    v_mov_b32 v10, 0
    s_cmp_lt_u32 s2, 128
    s_cbranch_scc0 T_E2
    s_waitcnt vmcnt(0)
    s_mov_b64 exec, 0x1
    buffer_store_dword v167, v10, s[40:43], s50 offen sc1
    s_branch T_H
T_E2:
    s_mul_i32 s67, s67, 24576
    s_add_u32 s67, s67, 3230092
    s_mov_b64 exec, 0x1
    s_movk_i32 s60, 4000
T_EP:
    buffer_load_dword v11, v10, s[40:43], s67 offen sc1
T_EP_W:
    s_waitcnt vmcnt(0)
    v_cmp_ne_u32 vcc, s39, v11
    s_nop 0
    s_and_b64 exec, exec, vcc
    s_cbranch_execz T_EP_D
    s_sub_u32 s60, s60, 1
    s_cmp_gt_i32 s60, 0
    s_sleep 2
    s_cbranch_scc1 T_EP
T_EP_D:
T_H:
    s_mov_b64 exec, 0x1
    s_movk_i32 s60, 4000
T_HP:
    buffer_load_dword v11, v10, s[40:43], s68 offen sc1
T_HP_W:
    s_waitcnt vmcnt(0)
    v_cmp_eq_u32 vcc, -1, v11
    s_nop 0
    s_and_b64 exec, exec, vcc
    s_cbranch_execz T_HP_D
    s_sub_u32 s60, s60, 1
    s_cmp_gt_i32 s60, 0
    s_sleep 1
    s_cbranch_scc1 T_HP
T_HP_D:
    s_mov_b64 exec, -1
    s_movk_i32 s60, 4000
T_KP:
    buffer_load_dwordx4 v[16:19], v3, s[40:43], s65 offen offset:0 sc1
    buffer_load_dwordx4 v[20:23], v3, s[40:43], s65 offen offset:1024 sc1
    buffer_load_dwordx4 v[24:27], v3, s[40:43], s65 offen offset:2048 sc1
    buffer_load_dwordx4 v[28:31], v3, s[40:43], s65 offen offset:3072 sc1
    buffer_load_dwordx4 v[32:35], v3, s[40:43], s66 offen offset:0 sc1
    buffer_load_dwordx4 v[36:39], v3, s[40:43], s66 offen offset:1024 sc1
    buffer_load_dwordx4 v[40:43], v3, s[40:43], s66 offen offset:2048 sc1
    buffer_load_dwordx4 v[44:47], v3, s[40:43], s66 offen offset:3072 sc1
T_KP_W:
    s_waitcnt vmcnt(0)
    v_max3_u32 v56, v16, v17, v18
    v_max3_u32 v58, v19, v20, v21
    v_max3_u32 v57, v32, v33, v34
    v_max3_u32 v59, v35, v36, v37
    v_max3_u32 v56, v56, v22, v23
    v_max3_u32 v58, v58, v24, v25
    v_max3_u32 v57, v57, v38, v39
    v_max3_u32 v59, v59, v40, v41
    v_max3_u32 v56, v56, v26, v27
    v_max3_u32 v58, v58, v28, v29
    v_max3_u32 v57, v57, v42, v43
    v_max3_u32 v59, v59, v44, v45
    v_max3_u32 v58, v58, v30, v31
    v_max3_u32 v59, v59, v46, v47
    v_max_u32 v56, v56, v58
    v_max_u32 v57, v57, v59
    v_max_u32 v58, v56, v57
    v_cmp_eq_u32 vcc, -1, v58
    s_nop 0
    s_and_b64 exec, exec, vcc
    s_cbranch_execz T_KP_D
    s_sub_u32 s60, s60, 1
    s_cmp_gt_i32 s60, 0
    s_cbranch_scc1 T_KP
T_KP_D:
    s_mov_b64 exec, -1
    v_mov_b32_dpp v58, v56 quad_perm:[1,0,3,2] row_mask:0xf bank_mask:0xf
    v_mov_b32_dpp v59, v57 quad_perm:[1,0,3,2] row_mask:0xf bank_mask:0xf
    v_med3_u32 v56, v56, v58, v48
    v_med3_u32 v57, v57, v59, v48
    ds_write_b128 v54, v[16:19] offset:7168
    v_mov_b32_dpp v58, v56 quad_perm:[2,3,0,1] row_mask:0xf bank_mask:0xf
    v_mov_b32_dpp v59, v57 quad_perm:[2,3,0,1] row_mask:0xf bank_mask:0xf
    v_med3_u32 v56, v56, v58, v49
    v_med3_u32 v57, v57, v59, v49
    ds_write_b128 v54, v[20:23] offset:6144
    v_mov_b32_dpp v58, v56 quad_perm:[1,0,3,2] row_mask:0xf bank_mask:0xf
    v_mov_b32_dpp v59, v57 quad_perm:[1,0,3,2] row_mask:0xf bank_mask:0xf
    v_med3_u32 v56, v56, v58, v50
    v_med3_u32 v57, v57, v59, v50
    ds_write_b128 v54, v[24:27] offset:5120
    v_mov_b32_dpp v58, v56 row_ror:8 row_mask:0xf bank_mask:0xf
    v_mov_b32_dpp v59, v57 row_ror:8 row_mask:0xf bank_mask:0xf
    v_med3_u32 v56, v56, v58, v51
    v_med3_u32 v57, v57, v59, v51
    ds_write_b128 v54, v[28:31] offset:4096
    v_mov_b32_dpp v58, v56 quad_perm:[2,3,0,1] row_mask:0xf bank_mask:0xf
    v_mov_b32_dpp v59, v57 quad_perm:[2,3,0,1] row_mask:0xf bank_mask:0xf
    v_med3_u32 v56, v56, v58, v52
    v_med3_u32 v57, v57, v59, v52
    ds_write_b128 v54, v[32:35] offset:3072
    v_mov_b32_dpp v58, v56 quad_perm:[1,0,3,2] row_mask:0xf bank_mask:0xf
    v_mov_b32_dpp v59, v57 quad_perm:[1,0,3,2] row_mask:0xf bank_mask:0xf
    v_med3_u32 v56, v56, v58, v53
    v_med3_u32 v57, v57, v59, v53
    ds_write_b128 v54, v[36:39] offset:2048
    s_nop 0
    v_max_u32_dpp v56, v57, v56 row_mirror row_mask:0xf bank_mask:0xf
    ds_write_b128 v54, v[40:43] offset:1024
    s_nop 0
    v_mov_b32_dpp v58, v56 row_ror:8 row_mask:0xf bank_mask:0xf
    v_med3_u32 v56, v56, v58, v51
    ds_write_b128 v54, v[44:47] offset:0
    s_nop 0
    v_mov_b32_dpp v58, v56 quad_perm:[2,3,0,1] row_mask:0xf bank_mask:0xf
    v_med3_u32 v56, v56, v58, v52
    s_nop 1
    v_mov_b32_dpp v58, v56 quad_perm:[1,0,3,2] row_mask:0xf bank_mask:0xf
    v_med3_u32 v56, v56, v58, v53
    s_nop 1
    v_max_u32_dpp v56, v56, v56 row_mirror row_mask:0xf bank_mask:0xf
    s_nop 1
    v_mov_b32_dpp v58, v56 row_ror:8 row_mask:0xf bank_mask:0xf
    v_med3_u32 v56, v56, v58, v51
    s_nop 1
    v_mov_b32_dpp v58, v56 quad_perm:[2,3,0,1] row_mask:0xf bank_mask:0xf
    v_med3_u32 v56, v56, v58, v52
    s_nop 1
    v_mov_b32_dpp v58, v56 quad_perm:[1,0,3,2] row_mask:0xf bank_mask:0xf
    v_med3_u32 v57, v56, v58, v53
    v_med3_u32 v56, v56, v58, v53
    s_nop 1
    v_permlane16_swap_b32 v56, v57
    v_max_u32 v56, v56, v57
    s_nop 1
    v_mov_b32_dpp v58, v56 row_ror:8 row_mask:0xf bank_mask:0xf
    v_med3_u32 v56, v56, v58, v51
    s_nop 1
    v_mov_b32_dpp v58, v56 quad_perm:[2,3,0,1] row_mask:0xf bank_mask:0xf
    v_med3_u32 v56, v56, v58, v52
    s_nop 1
    v_mov_b32_dpp v58, v56 quad_perm:[1,0,3,2] row_mask:0xf bank_mask:0xf
    v_med3_u32 v57, v56, v58, v53
    v_med3_u32 v56, v56, v58, v53
    s_nop 1
    v_permlane32_swap_b32 v56, v57
    v_max_u32 v56, v56, v57
    v_and_b32 v56, 0x4fc, v56
    v_lshl_or_b32 v56, v56, 2, v55
    ds_read_b64 v[56:57], v56
    v_and_b32 v7, 3, v1
    v_and_b32 v8, 8, v1
    v_lshlrev_b32 v7, 2, v7
    v_lshl_add_u32 v7, v8, 1, v7
    v_add_u32 v7, 161920, v7
    s_waitcnt lgkmcnt(0)
    v_mov_b32_dpp v58, v56 quad_perm:[1,0,3,2] row_mask:0xf bank_mask:0xf
    v_mov_b32_dpp v59, v57 quad_perm:[1,0,3,2] row_mask:0xf bank_mask:0xf
    v_med3_u32 v56, v56, v58, v48
    v_med3_u32 v57, v57, v59, v48
    s_nop 0
    v_mov_b32_dpp v58, v56 quad_perm:[2,3,0,1] row_mask:0xf bank_mask:0xf
    v_mov_b32_dpp v59, v57 quad_perm:[2,3,0,1] row_mask:0xf bank_mask:0xf
    v_med3_u32 v56, v56, v58, v49
    v_med3_u32 v57, v57, v59, v49
    s_nop 0
    v_mov_b32_dpp v58, v56 quad_perm:[1,0,3,2] row_mask:0xf bank_mask:0xf
    v_mov_b32_dpp v59, v57 quad_perm:[1,0,3,2] row_mask:0xf bank_mask:0xf
    v_med3_u32 v56, v56, v58, v50
    v_med3_u32 v57, v57, v59, v50
    s_nop 0
    v_mov_b32_dpp v58, v56 row_ror:8 row_mask:0xf bank_mask:0xf
    v_mov_b32_dpp v59, v57 row_ror:8 row_mask:0xf bank_mask:0xf
    v_med3_u32 v56, v56, v58, v51
    v_med3_u32 v57, v57, v59, v51
    s_nop 0
    v_mov_b32_dpp v58, v56 quad_perm:[2,3,0,1] row_mask:0xf bank_mask:0xf
    v_mov_b32_dpp v59, v57 quad_perm:[2,3,0,1] row_mask:0xf bank_mask:0xf
    v_med3_u32 v56, v56, v58, v52
    v_med3_u32 v57, v57, v59, v52
    s_nop 0
    v_mov_b32_dpp v58, v56 quad_perm:[1,0,3,2] row_mask:0xf bank_mask:0xf
    v_mov_b32_dpp v59, v57 quad_perm:[1,0,3,2] row_mask:0xf bank_mask:0xf
    v_med3_u32 v56, v56, v58, v53
    v_med3_u32 v57, v57, v59, v53
    s_nop 1
    v_max_u32_dpp v56, v57, v56 row_mirror row_mask:0xf bank_mask:0xf
    s_nop 1
    v_mov_b32_dpp v58, v56 row_ror:8 row_mask:0xf bank_mask:0xf
    v_med3_u32 v56, v56, v58, v51
    s_nop 1
    v_mov_b32_dpp v58, v56 quad_perm:[2,3,0,1] row_mask:0xf bank_mask:0xf
    v_med3_u32 v56, v56, v58, v52
    s_nop 1
    v_mov_b32_dpp v58, v56 quad_perm:[1,0,3,2] row_mask:0xf bank_mask:0xf
    v_med3_u32 v56, v56, v58, v53
    s_nop 1
    v_max_u32_dpp v56, v56, v56 row_mirror row_mask:0xf bank_mask:0xf
    s_nop 1
    v_mov_b32_dpp v58, v56 row_ror:8 row_mask:0xf bank_mask:0xf
    v_med3_u32 v56, v56, v58, v51
    s_nop 1
    v_mov_b32_dpp v58, v56 quad_perm:[2,3,0,1] row_mask:0xf bank_mask:0xf
    v_med3_u32 v56, v56, v58, v52
    s_nop 1
    v_mov_b32_dpp v58, v56 quad_perm:[1,0,3,2] row_mask:0xf bank_mask:0xf
    v_med3_u32 v57, v56, v58, v53
    v_med3_u32 v56, v56, v58, v53
    s_nop 1
    v_permlane16_swap_b32 v56, v57
    v_max_u32 v56, v56, v57
    s_nop 1
    v_mov_b32_dpp v58, v56 row_ror:8 row_mask:0xf bank_mask:0xf
    v_med3_u32 v56, v56, v58, v51
    s_nop 1
    v_mov_b32_dpp v58, v56 quad_perm:[2,3,0,1] row_mask:0xf bank_mask:0xf
    v_med3_u32 v56, v56, v58, v52
    s_nop 1
    v_mov_b32_dpp v58, v56 quad_perm:[1,0,3,2] row_mask:0xf bank_mask:0xf
    v_med3_u32 v57, v56, v58, v53
    v_med3_u32 v56, v56, v58, v53
    s_nop 1
    v_permlane32_swap_b32 v56, v57
    v_max_u32 v56, v56, v57
    s_cmp_lt_u32 s2, 144
    s_cbranch_scc1 FIN
    s_mov_b64 exec, 0xf0f
    ds_write_b32 v7, v56
    s_mov_b64 exec, -1
F_SEL:
    s_setprio 0
    s_waitcnt lgkmcnt(0)
    s_barrier
    ds_read_b32 v7, v160
    s_waitcnt lgkmcnt(0)
    v_and_b32 v7, 0x7ff, v7
    v_mad_i32_i24 v7, v7, s64, v161
    s_movk_i32 s60, 4000
F_ZP:
    buffer_load_dwordx4 v[8:11], v7, s[40:43], s63 offen sc1
F_ZP_W:
    s_waitcnt vmcnt(0)
    v_cmp_ne_u32 vcc, s39, v11
    s_nop 0
    s_and_b64 exec, exec, vcc
    s_cbranch_execz F_ZP_D
    s_sub_u32 s60, s60, 1
    s_cmp_gt_i32 s60, 0
    s_cbranch_scc1 F_ZP
F_ZP_D:
    s_mov_b64 exec, -1
    ds_write2_b32 v162, v8, v9 offset0:0 offset1:1
    ds_write_b32 v162, v10 offset:8
    v_add_u32 v7, 156928, v3
    s_waitcnt lgkmcnt(0)
    s_barrier
    s_cmp_ge_u32 s38, s59
    s_cbranch_scc1 F_H
    ds_read_b128 v[16:19], v163 offset:0
    ds_read_b128 v[20:23], v163 offset:64
    ds_read_b128 v[24:27], v163 offset:128
    ds_read_b128 v[28:31], v163 offset:192
    ds_read_b128 v[32:35], v163 offset:256
    ds_read_b128 v[36:39], v163 offset:320
    ds_read_b128 v[40:43], v163 offset:384
    ds_read_b128 v[44:47], v163 offset:448
    ds_read_b128 v[48:51], v163 offset:512
    ds_read_b128 v[52:55], v163 offset:576
    ds_read_b128 v[56:59], v163 offset:640
    ds_read_b128 v[60:63], v163 offset:704
    s_waitcnt lgkmcnt(11)
    v_mfma_f32_16x16x32_bf16 v[8:11], v[64:67], v[16:19], 0
    s_waitcnt lgkmcnt(10)
    v_mfma_f32_16x16x32_bf16 v[8:11], v[68:71], v[20:23], v[8:11]
    ds_read_b128 v[16:19], v163 offset:768
    s_waitcnt lgkmcnt(10)
    v_mfma_f32_16x16x32_bf16 v[8:11], v[72:75], v[24:27], v[8:11]
    ds_read_b128 v[20:23], v163 offset:832
    s_waitcnt lgkmcnt(10)
    v_mfma_f32_16x16x32_bf16 v[8:11], v[76:79], v[28:31], v[8:11]
    ds_read_b128 v[24:27], v163 offset:896
    s_waitcnt lgkmcnt(10)
    v_mfma_f32_16x16x32_bf16 v[8:11], v[80:83], v[32:35], v[8:11]
    ds_read_b128 v[28:31], v163 offset:960
    s_waitcnt lgkmcnt(10)
    v_mfma_f32_16x16x32_bf16 v[8:11], v[84:87], v[36:39], v[8:11]
    ds_read_b128 v[32:35], v163 offset:1024
    s_waitcnt lgkmcnt(10)
    v_mfma_f32_16x16x32_bf16 v[8:11], v[88:91], v[40:43], v[8:11]
    ds_read_b128 v[36:39], v163 offset:1088
    s_waitcnt lgkmcnt(10)
    v_mfma_f32_16x16x32_bf16 v[8:11], v[92:95], v[44:47], v[8:11]
    s_waitcnt lgkmcnt(9)
    v_mfma_f32_16x16x32_bf16 v[8:11], v[96:99], v[48:51], v[8:11]
    s_waitcnt lgkmcnt(8)
    v_mfma_f32_16x16x32_bf16 v[8:11], v[100:103], v[52:55], v[8:11]
    s_waitcnt lgkmcnt(7)
    v_mfma_f32_16x16x32_bf16 v[8:11], v[104:107], v[56:59], v[8:11]
    s_waitcnt lgkmcnt(6)
    v_mfma_f32_16x16x32_bf16 v[8:11], v[108:111], v[60:63], v[8:11]
    s_waitcnt lgkmcnt(5)
    v_mfma_f32_16x16x32_bf16 v[8:11], v[112:115], v[16:19], v[8:11]
    s_waitcnt lgkmcnt(4)
    v_mfma_f32_16x16x32_bf16 v[8:11], v[116:119], v[20:23], v[8:11]
    s_waitcnt lgkmcnt(3)
    v_mfma_f32_16x16x32_bf16 v[8:11], v[120:123], v[24:27], v[8:11]
    s_waitcnt lgkmcnt(2)
    v_mfma_f32_16x16x32_bf16 v[8:11], v[124:127], v[28:31], v[8:11]
    s_waitcnt lgkmcnt(1)
    v_mfma_f32_16x16x32_bf16 v[8:11], v[128:131], v[32:35], v[8:11]
    s_waitcnt lgkmcnt(0)
    v_mfma_f32_16x16x32_bf16 v[8:11], v[132:135], v[36:39], v[8:11]
    s_nop 7
    v_permlane16_swap_b32 v8, v10
    v_permlane16_swap_b32 v9, v11
    v_cvt_pk_bf16_f32 v9, v8, v9
    v_cvt_pk_bf16_f32 v11, v10, v11
    v_lshlrev_b32 v8, 16, v9
    v_and_b32 v9, 0xffff0000, v9
    v_mul_f32 v12, 0xbfb8aa3b, v8
    v_mul_f32 v13, 0xbfb8aa3b, v9
    v_exp_f32 v12, v12
    v_exp_f32 v13, v13
    v_lshlrev_b32 v10, 16, v11
    v_and_b32 v11, 0xffff0000, v11
    v_add_f32 v12, 1.0, v12
    v_add_f32 v13, 1.0, v13
    v_rcp_f32 v12, v12
    v_rcp_f32 v13, v13
    v_mul_f32 v8, v8, v12
    v_mul_f32 v9, v9, v13
    v_cvt_pk_bf16_f32 v9, v8, v9
    v_lshlrev_b32 v8, 16, v9
    v_and_b32 v9, 0xffff0000, v9
    v_mul_f32 v8, v8, v10
    v_mul_f32 v9, v9, v11
    v_cvt_pk_bf16_f32 v8, v8, v9
    ds_write_b32 v164, v8
F_H:
    v_mov_b32 v16, 0
    v_mov_b32 v17, 0
    v_mov_b32 v18, 0
    v_mov_b32 v19, 0
    v_mov_b32 v20, 0
    v_mov_b32 v21, 0
    v_mov_b32 v22, 0
    v_mov_b32 v23, 0
    v_mov_b32 v24, 0
    v_mov_b32 v25, 0
    v_mov_b32 v26, 0
    v_mov_b32 v27, 0
    v_mov_b32 v28, 0
    v_mov_b32 v29, 0
    v_mov_b32 v30, 0
    v_mov_b32 v31, 0
    s_waitcnt lgkmcnt(0)
    s_barrier
    s_mov_b32 exec_lo, 0xff00ff
    s_mov_b32 exec_hi, 0xff00ff
    ds_read_b128 v[16:19], v7
    ds_read_b128 v[20:23], v7 offset:1024
    s_not_b64 exec, exec
    ds_read_b128 v[24:27], v7
    ds_read_b128 v[28:31], v7 offset:1024
    s_mov_b64 exec, -1
    s_waitcnt lgkmcnt(3)
    v_mfma_f32_16x16x32_bf16 v[12:15], v[16:19], v[152:155], 0
    v_mfma_f32_16x16x32_bf16 v[8:11], v[16:19], v[136:139], 0
    s_waitcnt lgkmcnt(2)
    v_mfma_f32_16x16x32_bf16 v[12:15], v[20:23], v[156:159], v[12:15]
    v_mfma_f32_16x16x32_bf16 v[8:11], v[20:23], v[140:143], v[8:11]
    s_waitcnt lgkmcnt(1)
    v_mfma_f32_16x16x32_bf16 v[8:11], v[24:27], v[144:147], v[8:11]
    s_waitcnt lgkmcnt(0)
    v_mfma_f32_16x16x32_bf16 v[8:11], v[28:31], v[148:151], v[8:11]
    s_mov_b32 exec_hi, 0
    s_nop 1
    buffer_store_dwordx4 v[12:15], v166, s[40:43], s62 offen sc1
    s_mov_b64 exec, -1
    s_nop 2
    buffer_store_dwordx4 v[8:11], v165, s[40:43], s62 offen sc1
    s_branch END
FIN:
    s_cmp_ge_u32 s2, 72
    s_cselect_b32 s44, 32, 0
    s_cselect_b32 s45, 72, 0
    s_sub_u32 s45, s2, s45
    s_mul_i32 s46, s45, 43
    s_lshr_b32 s46, s46, 8
    s_mul_i32 s47, s46, 6
    s_sub_u32 s47, s45, s47
    v_lshrrev_b32 v6, 4, v1
    v_lshl_add_u32 v7, v6, 2, s44
    ds_bpermute_b32 v7, v7, v56
    v_and_b32 v8, 7, v1
    v_and_b32 v5, 15, v1
    s_lshl_b32 s48, s47, 2
    s_add_u32 s49, s48, 1024 - 16
    s_cmp_eq_u32 s47, 3
    s_cselect_b32 s49, 1024 + 8, s49
    s_cmp_lt_u32 s47, 3
    s_cselect_b32 s48, s48, s49
    s_lshl_b32 s49, s46, 11
    s_add_u32 s48, s48, s49
    s_add_u32 s48, s48, 3211264
    s_lshl_b32 s47, s47, 1
    s_lshl_b32 s49, s46, 7
    s_add_u32 s49, s49, s47
    s_add_u32 s49, s49, 6356992
    s_mul_i32 s46, s46, 96
    s_add_u32 s46, s46, s47
    s_movk_i32 s47, 8192
    s_mul_i32 s52, s2, 9216
    s_add_u32 s52, s52, 9502720
    s_add_u32 s53, s52, 4096
    s_add_u32 s54, s52, 8192
    v_mov_b32 v60, 0
    v_mov_b32 v61, 0
    v_mov_b32 v62, 0
    s_waitcnt lgkmcnt(0)
    v_and_b32 v9, 0x7ff, v7
    v_sub_u32 v9, 0x7ff, v9
    v_lshrrev_b32 v10, 4, v9
    v_lshlrev_b32 v11, 6, v10
    v_lshl_add_u32 v11, v5, 2, v11
    v_mul_u32_u24 v12, 0x480, v9
    v_mad_u32_u24 v12, v8, 12, v12
    v_add_u32 v12, s46, v12
    v_mul_u32_u24 v10, 0x6000, v10
    v_lshl_add_u32 v10, v8, 7, v10
    v_and_b32 v13, 14, v9
    v_lshl_add_u32 v10, v13, 3, v10
    v_and_b32 v13, 1, v9
    v_lshl_add_u32 v10, v13, 1, v10
    v_mul_u32_u24 v9, 0x600, v9
    v_lshl_add_u32 v9, v8, 4, v9
    global_load_short_d16_hi v60, v12, s[4:5]
    buffer_load_short_d16_hi v61, v10, s[40:43], s48 offen sc1
    s_mov_b32 exec_lo, 0xfff0fff
    s_mov_b32 exec_hi, 0xfff0fff
    s_movk_i32 s60, 4000
FN_OF:
    buffer_load_dword v13, v11, s[40:43], s47 offen sc1
FN_OF_W:
    s_waitcnt vmcnt(0)
    v_cmp_ne_u32 vcc, s39, v13
    s_nop 0
    s_and_b64 exec, exec, vcc
    s_cbranch_execz FN_OF_D
    s_sub_u32 s60, s60, 1
    s_cmp_gt_i32 s60, 0
    s_sleep 1
    s_cbranch_scc1 FN_OF
FN_OF_D:
    s_mov_b64 exec, -1
    buffer_load_short_d16_hi v62, v9, s[40:43], s49 offen sc1
    v_ashrrev_i32 v13, 31, v7
    v_not_b32 v13, v13
    v_or_b32 v13, 0x80000000, v13
    v_xor_b32 v7, v7, v13
    v_and_b32 v7, 0xffff0000, v7
    v_mul_f32 v7, 0xbfb8aa3b, v7
    v_exp_f32 v7, v7
    v_add_f32 v60, v60, v61
    v_add_f32 v7, 1.0, v7
    v_rcp_f32 v7, v7
    v_cvt_pk_bf16_f32 v60, v60, v60
    v_lshlrev_b32 v60, 16, v60
    v_cvt_pk_bf16_f32 v7, v7, v7
    v_lshlrev_b32 v7, 16, v7
    s_mov_b64 exec, 0x1
    s_movk_i32 s60, 4000
FN_HP:
    buffer_load_dword v13, v3, s[40:43], s52 offen offset:0 sc1
FN_HP_W:
    s_waitcnt vmcnt(0)
    v_cmp_eq_u32 vcc, -1, v13
    s_nop 0
    s_and_b64 exec, exec, vcc
    s_cbranch_execz FN_HP_D
    s_sub_u32 s60, s60, 1
    s_cmp_gt_i32 s60, 0
    s_sleep 1
    s_cbranch_scc1 FN_HP
FN_HP_D:
    s_mov_b64 exec, -1
    s_movk_i32 s60, 4000
FN_PP:
    buffer_load_dwordx4 v[16:19], v3, s[40:43], s52 offen offset:0 sc1
    buffer_load_dwordx4 v[20:23], v3, s[40:43], s52 offen offset:1024 sc1
    buffer_load_dwordx4 v[24:27], v3, s[40:43], s52 offen offset:2048 sc1
    buffer_load_dwordx4 v[28:31], v3, s[40:43], s52 offen offset:3072 sc1
    buffer_load_dwordx4 v[32:35], v3, s[40:43], s53 offen offset:0 sc1
    buffer_load_dwordx4 v[36:39], v3, s[40:43], s53 offen offset:1024 sc1
    buffer_load_dwordx4 v[40:43], v3, s[40:43], s53 offen offset:2048 sc1
    buffer_load_dwordx4 v[44:47], v3, s[40:43], s53 offen offset:3072 sc1
    buffer_load_dwordx4 v[48:51], v3, s[40:43], s54 offen offset:0 sc1
FN_PP_W:
    s_waitcnt vmcnt(0)
    v_pk_add_f32 v[64:65], v[16:17], v[20:21]
    v_pk_add_f32 v[68:69], v[24:25], v[28:29]
    v_pk_add_f32 v[66:67], v[18:19], v[22:23]
    v_pk_add_f32 v[70:71], v[26:27], v[30:31]
    v_pk_add_f32 v[64:65], v[64:65], v[32:33]
    v_pk_add_f32 v[66:67], v[66:67], v[34:35]
    v_pk_add_f32 v[68:69], v[68:69], v[36:37]
    v_pk_add_f32 v[70:71], v[70:71], v[38:39]
    v_pk_add_f32 v[64:65], v[64:65], v[40:41]
    v_pk_add_f32 v[66:67], v[66:67], v[42:43]
    v_pk_add_f32 v[68:69], v[68:69], v[44:45]
    v_pk_add_f32 v[70:71], v[70:71], v[46:47]
    v_pk_add_f32 v[64:65], v[64:65], v[48:49]
    v_pk_add_f32 v[66:67], v[66:67], v[50:51]
    v_pk_add_f32 v[64:65], v[64:65], v[68:69]
    v_pk_add_f32 v[66:67], v[66:67], v[70:71]
    v_pk_add_f32 v[68:69], v[64:65], v[66:67]
    v_cmp_u_f32 vcc, v68, v69
    s_nop 0
    s_and_b64 exec, exec, vcc
    s_cbranch_execz FN_PP_D
    s_sub_u32 s60, s60, 1
    s_cmp_gt_i32 s60, 0
    s_cbranch_scc1 FN_PP
FN_PP_D:
    s_mov_b64 exec, -1
    v_permlane32_swap_b32 v64, v66
    v_permlane32_swap_b32 v65, v67
    v_add_f32 v64, v64, v66
    v_add_f32 v65, v65, v67
    s_nop 1
    v_permlane16_swap_b32 v64, v65
    v_add_f32 v64, v64, v65
    s_nop 1
    v_add_f32_dpp v64, v64, v64 row_ror:8 row_mask:0xf bank_mask:0xf
    v_cvt_pk_bf16_f32 v64, v64, v64
    v_lshlrev_b32 v64, 16, v64
    v_mul_f32 v64, v64, v7
    v_cvt_pk_bf16_f32 v64, v64, v64
    v_lshlrev_b32 v64, 16, v64
    v_add_f32 v64, v64, v62
    v_cvt_pk_bf16_f32 v64, v64, v64
    v_lshlrev_b32 v64, 16, v64
    v_add_f32 v64, v64, v60
    v_cvt_pk_bf16_f32 v64, v64, v64
    s_mov_b32 exec_lo, 0xff00ff
    s_mov_b32 exec_hi, 0xff00ff
    global_store_short v12, v64, s[32:33]
    s_mov_b64 exec, -1
END:
    s_endpgm
CODE_END:
.section .rodata,"a"
.p2align 6
.amdhsa_kernel sequential_preLN__ssm_conv_s4__moe_arch_mod__prompt_kernel
  .amdhsa_next_free_vgpr 168
  .amdhsa_next_free_sgpr 102
  .amdhsa_accum_offset 168
  .amdhsa_group_segment_fixed_size 0
  .amdhsa_kernarg_size 136
  .amdhsa_user_sgpr_count 2
  .amdhsa_user_sgpr_kernarg_segment_ptr 1
  .amdhsa_system_sgpr_workgroup_id_x 1
.end_amdhsa_kernel
```

```asm
; @launch grid=(256,1,1) block=(768,1,1) lds=163840
.amdgcn_target "amdgcn-amd-amdhsa--gfx950"
    .text
    .globl sequential_preLN__ssm_conv_s4__moe_arch_mod__prompt_kernel
    .p2align 8
    .type sequential_preLN__ssm_conv_s4__moe_arch_mod__prompt_kernel,@function
sequential_preLN__ssm_conv_s4__moe_arch_mod__prompt_kernel:
    s_cmp_ge_u32 s2, 256
    s_cbranch_scc1 END
    s_load_dwordx16 s[4:19], s[0:1], 0
    s_load_dwordx2 s[36:37], s[0:1], 128
    s_load_dwordx16 s[20:35], s[0:1], 64
    s_getpc_b64 s[70:71]
    s_lshr_b32 s3, s2, 3
    s_mul_i32 s3, s3, 7
    v_subrev_u32 v2, 320, v0
    v_cmp_gt_u32 vcc, 7, v2
    v_add_lshl_u32 v2, v2, s3, 7
    v_min_u32 v2, CODE_END-sequential_preLN__ssm_conv_s4__moe_arch_mod__prompt_kernel-64, v2
    v_mov_b32 v3, s71
    s_mov_b64 exec, vcc
    v_add_co_u32 v2, vcc, s70, v2
    s_nop 1
    v_addc_co_u32 v3, vcc, 0, v3, vcc
    s_cbranch_execz P_NC
    global_load_dword v159, v[2:3], off
P_NC:
    s_mov_b64 exec, -1
    v_lshrrev_b32 v2, 6, v0
    v_and_b32 v1, 63, v0
    v_readfirstlane_b32 s38, v2
    v_lshlrev_b32 v3, 4, v1
    s_mov_b32 s42, 0x10000000
    s_mov_b32 s43, 0x00020000
    s_cmp_lt_u32 s2, 192
    s_cselect_b32 s3, 4, -1
    s_cmp_lg_u32 s38, s3
    s_cbranch_scc1 P_NP
    s_mul_i32 s52, s2, 768
    v_add_u32 v16, s52, v3
    s_mul_i32 s52, s2, 6
    s_and_b32 s52, s52, -4
    v_lshl_add_u32 v17, v1, 2, s52
    v_mov_b32 v18, 161536
    v_mov_b32 v19, 0
    ds_write_b32 v18, v19
    v_mov_b32 v20, s70
    v_mov_b32 v21, s71
    s_waitcnt lgkmcnt(0)
    s_mov_b32 exec_lo, 0xffffffff
    s_mov_b32 exec_hi, 0xffff
    s_mov_b32 m0, 138048
    s_nop 0
    global_load_lds_dwordx4 v16, s[6:7]
    s_mov_b32 m0, 138816
    s_nop 0
    global_load_lds_dwordx4 v16, s[8:9]
    s_mov_b32 m0, 139584
    s_nop 0
    global_load_lds_dwordx4 v16, s[10:11]
    s_mov_b32 m0, 140352
    s_nop 0
    global_load_lds_dwordx4 v16, s[12:13]
    s_mov_b32 m0, 141120
    s_nop 0
    global_load_lds_dwordx4 v16, s[14:15]
    s_mov_b32 m0, 141888
    s_nop 0
    global_load_lds_dwordx4 v16, s[16:17]
    s_mov_b64 exec, 0x3
    s_mov_b32 m0, 142656
    s_nop 0
    global_load_lds_dword v17, s[18:19]
    s_mov_b32 m0, 142672
    s_nop 0
    global_load_lds_dword v17, s[20:21]
    s_mov_b64 exec, 0x1
    s_mov_b32 m0, 161536
    s_nop 0
    global_load_lds_dword v[20:21], off
    s_mov_b64 exec, -1
P_NP:
    s_cmp_ge_u32 s38, 4
    s_cbranch_scc1 P_B
    s_setprio 3
    v_lshrrev_b32 v147, 5, v0
    v_and_b32 v148, 31, v0
    v_mul_u32_u24 v140, 0x480, v147
    s_mul_i32 s44, s2, 9216
    v_mad_u32_u24 v140, v148, 12, v140
    v_mov_b32 v104, 0
    v_mov_b32 v105, 0
    v_mov_b32 v106, 0
    v_mov_b32 v107, 0
    v_add_u32 v140, s44, v140
    v_add_u32 v149, 161280, v3
    s_mov_b64 exec, 0xffff
    ds_write_b128 v149, v[104:107]
    s_mov_b64 exec, -1
    v_mov_b32 v94, 1
    v_and_b32 v147, 1, v147
    v_mul_u32_u24 v141, 0x90, v148
    v_lshl_add_u32 v141, v147, 6, v141
    s_lshl_b32 s45, s38, 4
    s_sub_u32 s45, 147504, s45
    v_add_u32 v141, s45, v141
    v_lshrrev_b32 v142, 3, v1
    v_add_u32 v142, v142, v1
    s_mul_i32 s45, s38, 3456
    s_add_u32 s45, s45, 147456
    v_lshl_add_u32 v142, v142, 4, s45
    v_lshrrev_b32 v143, 2, v1
    v_mul_u32_u24 v143, 16320, v143
    v_add_u32 v143, v143, v3
    s_lshl_b32 s46, s2, 6
    s_sub_u32 s46, 81856, s46
    s_mul_i32 s45, s38, 786432
    s_add_u32 s46, s46, s45
    s_add_u32 s47, s46, 262144
    s_add_u32 s48, s46, 524288
    s_mov_b32 s49, 0x05040100
    s_mov_b32 s50, 0x07060302
    v_mov_b32 v144, s49
    s_mov_b32 exec_lo, 0
    v_mov_b32 v144, s50
    s_mov_b64 exec, -1
    v_mov_b32 v145, 161328
    s_lshl_b32 s45, s38, 2
    v_add_u32 v146, s45, v145
    s_waitcnt lgkmcnt(0)
    global_load_dword v95, v104, s[36:37] offset:0
    global_load_dwordx3 v[60:62], v140, s[4:5] offset:0
    global_load_dwordx3 v[64:66], v140, s[4:5] offset:384
    global_load_dwordx3 v[68:70], v140, s[4:5] offset:768
    s_mov_b32 s40, s36
    s_mov_b32 s41, s37
    s_cmp_ge_u32 s2, 192
    s_cbranch_scc1 P_C
    s_lshr_b32 s65, s38, 2
    s_bitcmp1_b32 s2, 0
    s_addc_u32 s51, s65, 0
    s_cmp_eq_u32 s51, 3
    s_cselect_b32 s51, 0, s51
    s_lshl_b32 s52, s51, 8
    s_add_u32 s52, s52, 138048
    v_and_b32 v114, 0x7f, v0
    v_lshl_add_u32 v114, v114, 1, s52
    s_and_b32 s52, s2, 1
    s_add_u32 s52, s52, s51
    s_lshl_b32 s52, s52, 1
    s_add_u32 s52, s52, 142656
    v_mov_b32 v115, s52
    v_mov_b32 v119, 161536
    v_mov_b32 v29, 0
    v_mov_b32 v30, 0
    v_mov_b32 v31, 0
    v_mov_b32 v32, 0
    v_mov_b32 v33, 0
    v_mov_b32 v34, 0
    v_mov_b32 v35, 0
    v_mov_b32 v160, 0
    v_mov_b32 v161, 0
    v_mov_b32 v162, 0
    v_mov_b32 v163, 0
    v_mov_b32 v164, 0
    v_lshlrev_b32 v16, 4, v0
    v_add_u32 v17, 101184, v16
    ds_write_b128 v17, v[160:163] offset:0
    ds_write_b128 v17, v[160:163] offset:12288
    ds_write_b128 v17, v[160:163] offset:24576
    s_mul_i32 s59, s65, 16320
    s_mul_i32 s67, s65, 17408
    s_add_u32 s71, s67, 48960
    s_and_b32 s66, s38, 1
    s_lshl_b32 s66, s66, 8
    s_add_u32 s70, s66, s67
    s_add_u32 s70, s70, 16192
    s_add_u32 s66, s66, s59
    s_mov_b32 m0, s66
    s_mul_i32 s64, s65, 5888
    s_add_u32 s64, s64, 101184
    s_and_b32 s69, s38, 3
    v_and_b32 v5, 15, v0
    v_bfe_u32 v6, v0, 4, 2
    v_and_b32 v17, 48, v0
    v_mul_u32_u24 v110, 544, v5
    s_mov_b32 s52, 0
    s_movk_i32 s53, 2176
    s_movk_i32 s54, 4896
    s_cmp_eq_u32 s69, 1
    s_cselect_b32 s52, 9792, s52
    s_cselect_b32 s53, 1088, s53
    s_cselect_b32 s54, 3264, s54
    s_cmp_eq_u32 s69, 3
    s_cselect_b32 s52, 544, s52
    s_add_u32 s52, s52, s59
    s_cmp_eq_u32 s69, 2
    s_cselect_b32 s52, s71, s52
    s_cselect_b32 s54, 4352, s54
    s_add_u32 s67, s71, 8704
    v_and_b32 v111, 3, v0
    v_mul_u32_u24 v111, 544, v111
    v_bfe_u32 v18, v0, 2, 1
    v_bfe_u32 v19, v0, 3, 1
    v_xor_b32 v18, v18, v19
    v_mad_u32_u24 v111, v19, s53, v111
    v_mad_u32_u24 v111, v18, s54, v111
    v_add3_u32 v111, v111, v17, s52
    v_add3_u32 v110, v110, v17, s67
    s_barrier
    v_lshl_add_u32 v18, v5, 1, v6
    s_sub_u32 s52, s69, 11
    v_add_u32 v18, s52, v18
    v_add_u32 v19, 1, v18
    v_lshl_add_u32 v20, v6, 1, 2
    v_cmp_le_u32 s[52:53], v18, v20
    v_cmp_le_u32 s[54:55], v19, v20
    v_mov_b32 v18, 0x3f80
    v_cndmask_b32 v112, 0, v18, s[52:53]
    v_cndmask_b32 v19, 0, 1.0, s[54:55]
    v_or_b32 v112, v112, v19
    s_mul_i32 s52, s38, 1600
    s_add_u32 s52, s52, 120016
    v_lshl_add_u32 v113, v1, 2, s52
    s_mul_i32 s67, s65, 6400
    s_add_u32 s67, s67, 118848
    s_sub_u32 s63, s69, s65
    s_cselect_b32 s52, 3, 0
    s_add_u32 s63, s63, s52
    s_min_u32 s52, s63, 1
    s_add_u32 s63, s63, s52
    s_cmp_eq_u32 s69, 3
    s_cselect_b32 s63, 1, s63
    v_add_u32 v7, 1, v5
    v_and_b32 v8, 3, v7
    v_mul_u32_u24 v8, 1598, v8
    v_lshl_add_u32 v7, v7, 1, v8
    v_add3_u32 v7, v7, v17, s67
    v_add_u32 v18, s64, v17
    v_lshl_add_u32 v9, v5, 3, v18
    v_and_b32 v10, 1, v5
    v_mul_u32_u24 v10, 380, v10
    v_lshl_add_u32 v10, v5, 2, v10
    v_add_u32 v10, v18, v10
    v_lshlrev_b32 v8, 5, v5
    v_sub_u32 v8, v18, v8
    v_lshrrev_b32 v11, 2, v5
    v_lshl_add_u32 v2, v5, 2, v6
    v_add_u32 v15, v2, v11
    v_lshl_add_u32 v4, v15, 3, s59
    s_lshl_b32 s52, s65, 4
    s_add_u32 s52, s52, 161280
    v_mov_b32 v166, s52
    s_branch P_D
P_C:
    v_mov_b32 v8, 0
    v_mov_b32 v10, 0
    v_mov_b32 v166, 0
    s_barrier
P_D:
    s_waitcnt vmcnt(0)
LN1:
    v_dot2c_f32_bf16 v104, 0x3f803f80, v60
    v_dot2c_f32_bf16 v106, v60, v60
    v_dot2c_f32_bf16 v105, 0x3f803f80, v61
    v_dot2c_f32_bf16 v107, v61, v61
    v_dot2c_f32_bf16 v104, 0x3f803f80, v62
    v_dot2c_f32_bf16 v106, v62, v62
    v_dot2c_f32_bf16 v105, 0x3f803f80, v64
    v_dot2c_f32_bf16 v107, v64, v64
    v_dot2c_f32_bf16 v104, 0x3f803f80, v65
    v_dot2c_f32_bf16 v106, v65, v65
    v_dot2c_f32_bf16 v105, 0x3f803f80, v66
    v_dot2c_f32_bf16 v107, v66, v66
    v_dot2c_f32_bf16 v104, 0x3f803f80, v68
    v_dot2c_f32_bf16 v106, v68, v68
    v_dot2c_f32_bf16 v105, 0x3f803f80, v69
    v_dot2c_f32_bf16 v107, v69, v69
    v_dot2c_f32_bf16 v104, 0x3f803f80, v70
    v_dot2c_f32_bf16 v106, v70, v70
    v_add_u32 v95, 1, v95
    s_mov_b64 exec, 0x7
    ds_write_b64 v149, v[94:95] offset:136
    s_mov_b64 exec, -1
    v_add_f32 v104, v104, v105
    v_add_f32 v106, v106, v107
    v_lshlrev_b32 v72, 16, v60
    v_and_b32 v73, 0xffff0000, v60
    v_permlane16_swap_b32 v104, v106
    v_add_f32 v104, v104, v106
    v_lshlrev_b32 v74, 16, v61
    v_and_b32 v75, 0xffff0000, v61
    v_add_f32_dpp v104, v104, v104 quad_perm:[1,0,3,2] row_mask:0xf bank_mask:0xf
    v_lshlrev_b32 v76, 16, v62
    v_and_b32 v77, 0xffff0000, v62
    v_add_f32_dpp v104, v104, v104 quad_perm:[2,3,0,1] row_mask:0xf bank_mask:0xf
    v_lshlrev_b32 v78, 16, v64
    v_and_b32 v79, 0xffff0000, v64
    v_add_f32_dpp v104, v104, v104 row_half_mirror row_mask:0xf bank_mask:0xf
    v_lshlrev_b32 v80, 16, v65
    v_and_b32 v81, 0xffff0000, v65
    v_add_f32_dpp v104, v104, v104 row_mirror row_mask:0xf bank_mask:0xf
    v_mul_f32 v104, 0x3ae38e39, v104
    v_mov_b32 v105, v104
    v_lshlrev_b32 v82, 16, v66
    v_and_b32 v83, 0xffff0000, v66
    v_permlane16_swap_b32 v104, v105
    v_fma_f32 v105, -v104, v104, v105
    v_max_f32 v105, 0, v105
    v_cvt_pk_bf16_f32 v105, v104, v105
    v_lshlrev_b32 v104, 16, v105
    v_and_b32 v105, 0xffff0000, v105
    v_lshlrev_b32 v84, 16, v68
    v_and_b32 v85, 0xffff0000, v68
    v_lshlrev_b32 v86, 16, v69
    v_and_b32 v87, 0xffff0000, v69
    v_lshlrev_b32 v88, 16, v70
    v_and_b32 v89, 0xffff0000, v70
    v_mov_b32 v99, v95
    v_mov_b32 v103, v95
    v_readfirstlane_b32 s39, v95
    v_add_f32 v105, 0x3727c5ac, v105
    v_cvt_pk_bf16_f32 v105, v105, v105
    v_lshlrev_b32 v105, 16, v105
    v_sqrt_f32 v106, v105
    v_pk_add_f32 v[72:73], v[72:73], v[104:105] op_sel_hi:[1,0] neg_lo:[0,1] neg_hi:[0,1]
    v_pk_add_f32 v[74:75], v[74:75], v[104:105] op_sel_hi:[1,0] neg_lo:[0,1] neg_hi:[0,1]
    v_pk_add_f32 v[76:77], v[76:77], v[104:105] op_sel_hi:[1,0] neg_lo:[0,1] neg_hi:[0,1]
    v_cvt_pk_bf16_f32 v106, v106, v106
    v_lshlrev_b32 v106, 16, v106
    v_rcp_f32 v106, v106
    v_pk_add_f32 v[78:79], v[78:79], v[104:105] op_sel_hi:[1,0] neg_lo:[0,1] neg_hi:[0,1]
    v_pk_add_f32 v[80:81], v[80:81], v[104:105] op_sel_hi:[1,0] neg_lo:[0,1] neg_hi:[0,1]
    v_pk_add_f32 v[82:83], v[82:83], v[104:105] op_sel_hi:[1,0] neg_lo:[0,1] neg_hi:[0,1]
    v_pk_add_f32 v[84:85], v[84:85], v[104:105] op_sel_hi:[1,0] neg_lo:[0,1] neg_hi:[0,1]
    v_pk_add_f32 v[86:87], v[86:87], v[104:105] op_sel_hi:[1,0] neg_lo:[0,1] neg_hi:[0,1]
    v_pk_add_f32 v[88:89], v[88:89], v[104:105] op_sel_hi:[1,0] neg_lo:[0,1] neg_hi:[0,1]
    v_cvt_pk_bf16_f32 v73, v72, v73
    v_cvt_pk_bf16_f32 v75, v74, v75
    v_cvt_pk_bf16_f32 v77, v76, v77
    v_cvt_pk_bf16_f32 v79, v78, v79
    v_cvt_pk_bf16_f32 v81, v80, v81
    v_cvt_pk_bf16_f32 v83, v82, v83
    v_cvt_pk_bf16_f32 v85, v84, v85
    v_cvt_pk_bf16_f32 v87, v86, v87
    v_cvt_pk_bf16_f32 v89, v88, v89
    v_lshlrev_b32 v72, 16, v73
    v_and_b32 v73, 0xffff0000, v73
    v_lshlrev_b32 v74, 16, v75
    v_and_b32 v75, 0xffff0000, v75
    v_lshlrev_b32 v76, 16, v77
    v_and_b32 v77, 0xffff0000, v77
    v_pk_mul_f32 v[72:73], v[72:73], v[106:107] op_sel_hi:[1,0]
    v_pk_mul_f32 v[74:75], v[74:75], v[106:107] op_sel_hi:[1,0]
    v_pk_mul_f32 v[76:77], v[76:77], v[106:107] op_sel_hi:[1,0]
    v_cvt_pk_bf16_f32 v60, v72, v73
    v_cvt_pk_bf16_f32 v62, v76, v77
    v_cvt_pk_bf16_f32 v61, v74, v75
    v_cvt_pk_bf16_f32 v63, v74, v75
    v_permlane32_swap_b32 v60, v62
    s_nop 0
    v_permlane32_swap_b32 v61, v63
    v_perm_b32 v92, v60, v62, s49
    v_perm_b32 v93, v60, v62, s50
    v_lshlrev_b32 v78, 16, v79
    v_and_b32 v79, 0xffff0000, v79
    v_lshlrev_b32 v80, 16, v81
    v_and_b32 v81, 0xffff0000, v81
    v_lshlrev_b32 v82, 16, v83
    v_and_b32 v83, 0xffff0000, v83
    v_pk_mul_f32 v[78:79], v[78:79], v[106:107] op_sel_hi:[1,0]
    v_pk_mul_f32 v[80:81], v[80:81], v[106:107] op_sel_hi:[1,0]
    v_pk_mul_f32 v[82:83], v[82:83], v[106:107] op_sel_hi:[1,0]
    v_cvt_pk_bf16_f32 v64, v78, v79
    v_cvt_pk_bf16_f32 v66, v82, v83
    v_cvt_pk_bf16_f32 v65, v80, v81
    v_cvt_pk_bf16_f32 v67, v80, v81
    v_perm_b32 v94, v61, v63, v144
    ds_write_b128 v141, v[92:95] offset:0
    v_permlane32_swap_b32 v64, v66
    v_permlane32_swap_b32 v65, v67
    v_perm_b32 v96, v64, v66, s49
    v_perm_b32 v97, v64, v66, s50
    v_lshlrev_b32 v84, 16, v85
    v_and_b32 v85, 0xffff0000, v85
    v_lshlrev_b32 v86, 16, v87
    v_and_b32 v87, 0xffff0000, v87
    v_lshlrev_b32 v88, 16, v89
    v_and_b32 v89, 0xffff0000, v89
    v_pk_mul_f32 v[84:85], v[84:85], v[106:107] op_sel_hi:[1,0]
    v_pk_mul_f32 v[86:87], v[86:87], v[106:107] op_sel_hi:[1,0]
    v_pk_mul_f32 v[88:89], v[88:89], v[106:107] op_sel_hi:[1,0]
    v_cvt_pk_bf16_f32 v68, v84, v85
    v_cvt_pk_bf16_f32 v70, v88, v89
    v_cvt_pk_bf16_f32 v69, v86, v87
    v_cvt_pk_bf16_f32 v71, v86, v87
    v_perm_b32 v98, v65, v67, v144
    ds_write_b128 v141, v[96:99] offset:4608
    v_permlane32_swap_b32 v68, v70
    v_permlane32_swap_b32 v69, v71
    v_perm_b32 v100, v68, v70, s49
    v_perm_b32 v101, v68, v70, s50
    v_perm_b32 v102, v69, v71, v144
    ds_write_b128 v141, v[100:103] offset:9216
    s_mov_b64 exec, 0x1
    ds_write_b32 v146, v144
    s_mov_b64 exec, -1
    s_movk_i32 s60, 4000
LN1_R:
    ds_read_b128 v[104:107], v145
    ds_read_b128 v[72:75], v142 offset:0
    ds_read_b128 v[76:79], v142 offset:1152
    ds_read_b128 v[80:83], v142 offset:2304
    s_sub_u32 s60, s60, 1
    s_waitcnt lgkmcnt(3)
    v_min3_u32 v104, v104, v105, v106
    v_min_u32 v104, v104, v107
    v_cmp_eq_u32 vcc, 0, v104
    s_cmp_gt_i32 s60, 0
    s_cselect_b64 s[52:53], vcc, 0
    s_cmp_lg_u64 s[52:53], 0
    s_waitcnt lgkmcnt(0)
    s_cbranch_scc1 LN1_R
    buffer_store_dwordx4 v[72:75], v143, s[40:43], s46 offen sc1
    buffer_store_dwordx4 v[76:79], v143, s[40:43], s47 offen sc1
    buffer_store_dwordx4 v[80:83], v143, s[40:43], s48 offen sc1
    s_cmp_ge_u32 s2, 192
    s_cbranch_scc1 FFN_DMA
    s_branch C_KS
P_B:
    s_cmp_ge_u32 s2, 192
    s_cbranch_scc1 FFN_DMA0
P_B2:
    s_lshr_b32 s65, s38, 2
    s_bitcmp1_b32 s2, 0
    s_addc_u32 s51, s65, 0
    s_cmp_eq_u32 s51, 3
    s_cselect_b32 s51, 0, s51
    s_lshl_b32 s52, s51, 8
    s_add_u32 s52, s52, 138048
    v_and_b32 v114, 0x7f, v0
    v_lshl_add_u32 v114, v114, 1, s52
    s_and_b32 s52, s2, 1
    s_add_u32 s52, s52, s51
    s_lshl_b32 s52, s52, 1
    s_add_u32 s52, s52, 142656
    v_mov_b32 v115, s52
    v_mov_b32 v119, 161536
    v_mov_b32 v29, 0
    v_mov_b32 v30, 0
    v_mov_b32 v31, 0
    v_mov_b32 v32, 0
    v_mov_b32 v33, 0
    v_mov_b32 v34, 0
    v_mov_b32 v35, 0
    v_mov_b32 v160, 0
    v_mov_b32 v161, 0
    v_mov_b32 v162, 0
    v_mov_b32 v163, 0
    v_mov_b32 v164, 0
    v_lshlrev_b32 v16, 4, v0
    v_add_u32 v17, 101184, v16
    ds_write_b128 v17, v[160:163] offset:0
    ds_write_b128 v17, v[160:163] offset:12288
    ds_write_b128 v17, v[160:163] offset:24576
    s_mul_i32 s59, s65, 16320
    s_mul_i32 s67, s65, 17408
    s_add_u32 s71, s67, 48960
    s_and_b32 s66, s38, 1
    s_lshl_b32 s66, s66, 8
    s_add_u32 s70, s66, s67
    s_add_u32 s70, s70, 16192
    s_add_u32 s66, s66, s59
    s_mov_b32 m0, s66
    s_mul_i32 s64, s65, 5888
    s_add_u32 s64, s64, 101184
    s_and_b32 s69, s38, 3
    v_and_b32 v5, 15, v0
    v_bfe_u32 v6, v0, 4, 2
    v_and_b32 v17, 48, v0
    v_mul_u32_u24 v110, 544, v5
    s_mov_b32 s52, 0
    s_movk_i32 s53, 2176
    s_movk_i32 s54, 4896
    s_cmp_eq_u32 s69, 1
    s_cselect_b32 s52, 9792, s52
    s_cselect_b32 s53, 1088, s53
    s_cselect_b32 s54, 3264, s54
    s_cmp_eq_u32 s69, 3
    s_cselect_b32 s52, 544, s52
    s_add_u32 s52, s52, s59
    s_cmp_eq_u32 s69, 2
    s_cselect_b32 s52, s71, s52
    s_cselect_b32 s54, 4352, s54
    s_add_u32 s67, s71, 8704
    v_and_b32 v111, 3, v0
    v_mul_u32_u24 v111, 544, v111
    v_bfe_u32 v18, v0, 2, 1
    v_bfe_u32 v19, v0, 3, 1
    v_xor_b32 v18, v18, v19
    v_mad_u32_u24 v111, v19, s53, v111
    v_mad_u32_u24 v111, v18, s54, v111
    v_add3_u32 v111, v111, v17, s52
    v_add3_u32 v110, v110, v17, s67
    s_barrier
    v_lshl_add_u32 v18, v5, 1, v6
    s_sub_u32 s52, s69, 11
    v_add_u32 v18, s52, v18
    v_add_u32 v19, 1, v18
    v_lshl_add_u32 v20, v6, 1, 2
    v_cmp_le_u32 s[52:53], v18, v20
    v_cmp_le_u32 s[54:55], v19, v20
    v_mov_b32 v18, 0x3f80
    v_cndmask_b32 v112, 0, v18, s[52:53]
    v_cndmask_b32 v19, 0, 1.0, s[54:55]
    v_or_b32 v112, v112, v19
    s_mul_i32 s52, s38, 1600
    s_add_u32 s52, s52, 120016
    v_lshl_add_u32 v113, v1, 2, s52
    s_mul_i32 s67, s65, 6400
    s_add_u32 s67, s67, 118848
    s_sub_u32 s63, s69, s65
    s_cselect_b32 s52, 3, 0
    s_add_u32 s63, s63, s52
    s_min_u32 s52, s63, 1
    s_add_u32 s63, s63, s52
    s_cmp_eq_u32 s69, 3
    s_cselect_b32 s63, 1, s63
    v_add_u32 v7, 1, v5
    v_and_b32 v8, 3, v7
    v_mul_u32_u24 v8, 1598, v8
    v_lshl_add_u32 v7, v7, 1, v8
    v_add3_u32 v7, v7, v17, s67
    v_add_u32 v18, s64, v17
    v_lshl_add_u32 v9, v5, 3, v18
    v_and_b32 v10, 1, v5
    v_mul_u32_u24 v10, 380, v10
    v_lshl_add_u32 v10, v5, 2, v10
    v_add_u32 v10, v18, v10
    v_lshlrev_b32 v8, 5, v5
    v_sub_u32 v8, v18, v8
    v_lshrrev_b32 v11, 2, v5
    v_lshl_add_u32 v2, v5, 2, v6
    v_add_u32 v15, v2, v11
    v_lshl_add_u32 v4, v15, 3, s59
    s_lshl_b32 s52, s65, 4
    s_add_u32 s52, s52, 161280
    v_mov_b32 v166, s52
    s_mul_i32 s48, s2, 10240
    s_add_u32 s48, s48, 9498624
    s_cmp_eq_u32 s2, 150
    s_cselect_b32 s48, 28672, s48
    s_cselect_b32 s50, 0, s2
    s_add_u32 s49, s48, 11264
    s_waitcnt lgkmcnt(0)
    s_mov_b32 s40, s36
    s_mov_b32 s41, s37
C_KS:
    s_movk_i32 s60, 4000
C_KP:
    ds_read_b32 v20, v119
    s_sub_u32 s60, s60, 1
    s_cmp_gt_i32 s60, 0
    s_waitcnt lgkmcnt(0)
    v_readfirstlane_b32 s52, v20
    s_nop 0
    s_cselect_b32 s52, s52, 1
    s_cmp_eq_u32 s52, 0
    s_cbranch_scc1 C_KP
    ds_read_u16_d16_hi v29, v115
    ds_read_u16_d16_hi v30, v114 offset:0
    ds_read_u16_d16_hi v31, v114 offset:768
    ds_read_u16_d16_hi v32, v114 offset:1536
    ds_read_u16_d16_hi v33, v114 offset:2304
    ds_read_u16_d16_hi v34, v114 offset:3072
    ds_read_u16_d16_hi v35, v114 offset:3840
    ds_read_u16_d16_hi v164, v115 offset:16
    s_setprio 2
    s_cmp_lt_u32 s38, 4
    s_cbranch_scc1 PG1
    s_setprio 3
PG1:
    s_waitcnt lgkmcnt(0)
    v_mul_f32 v20, 0x3fb8aa3b, v29
    v_mov_b32 v21, 0x3fb8aa3b
    v_fma_f32 v21, v29, v21, -v20
    v_fmac_f32 v21, 0x32a57060, v29
    v_exp_f32 v20, v20
    v_mul_f32 v21, 0x3f317218, v21
    v_fma_f32 v20, v20, v21, v20
    v_cvt_pk_bf16_f32 v20, v20, v20
    v_lshlrev_b32 v20, 16, v20
    v_mul_f32 v21, v30, v20
    v_mul_f32 v36, v31, v20
    v_mul_f32 v32, v32, v20
    v_mul_f32 v33, v33, v20
    v_mul_f32 v21, 0x3fb8aa3b, v21
    v_mul_f32 v22, 0x3e22f983, v36
    v_mov_b32 v23, 0x3e22f983
    v_fma_f32 v23, v36, v23, -v22
    v_fmac_f32 v23, 0x31dc9c88, v36
    v_pk_mul_f32 v[24:25], v[34:35], v[32:33] op_sel:[0,0] op_sel_hi:[0,1]
    v_pk_fma_f32 v[24:25], v[34:35], v[32:33], v[24:25] op_sel:[1,1,0] op_sel_hi:[1,0,1] neg_lo:[1,0,0]
    s_bitcmp1_b32 s38, 1
    s_cbranch_scc1 C_ROLE1
    v_mul_f32 v36, 0x43000000, v21
    v_mul_f32 v37, 0x43000000, v22
    v_mul_f32 v38, 0x41000000, v21
    v_mul_f32 v39, 0x41000000, v22
    v_exp_f32 v36, v36
    v_fract_f32 v37, v37
    v_exp_f32 v38, v38
    v_fract_f32 v39, v39
    v_fmac_f32 v37, 0x43000000, v23
    v_fmac_f32 v39, 0x41000000, v23
    v_cos_f32 v26, v37
    v_sin_f32 v27, v37
    v_cos_f32 v28, v39
    v_sin_f32 v29, v39
    v_mul_f32 v26, v26, v36
    v_mul_f32 v27, v27, v36
    v_mul_f32 v28, v28, v38
    v_mul_f32 v29, v29, v38
    v_mov_b32 v44, 1.0
    v_mov_b32 v45, 0
    v_pk_mul_f32 v[56:57], v[24:25], v[28:29] op_sel:[0,0] op_sel_hi:[0,1]
    v_pk_mul_f32 v[50:51], v[28:29], v[28:29] op_sel:[0,0] op_sel_hi:[0,1]
    v_pk_fma_f32 v[56:57], v[24:25], v[28:29], v[56:57] op_sel:[1,1,0] op_sel_hi:[1,0,1] neg_lo:[1,0,0]
    v_pk_fma_f32 v[50:51], v[28:29], v[28:29], v[50:51] op_sel:[1,1,0] op_sel_hi:[1,0,1] neg_lo:[1,0,0]
    v_pk_mul_f32 v[58:59], v[56:57], v[26:27] op_sel:[0,0] op_sel_hi:[0,1]
    v_pk_fma_f32 v[58:59], v[56:57], v[26:27], v[58:59] op_sel:[1,1,0] op_sel_hi:[1,0,1] neg_lo:[1,0,0]
    v_cvt_pk_bf16_f32 v40, v56, v57
    ds_write_addtid_b32 v40 offset:4352
    v_pk_mul_f32 v[56:57], v[58:59], v[26:27] op_sel:[0,0] op_sel_hi:[0,1]
    v_pk_mul_f32 v[54:55], v[50:51], v[28:29] op_sel:[0,0] op_sel_hi:[0,1]
    v_pk_fma_f32 v[56:57], v[58:59], v[26:27], v[56:57] op_sel:[1,1,0] op_sel_hi:[1,0,1] neg_lo:[1,0,0]
    v_pk_fma_f32 v[54:55], v[50:51], v[28:29], v[54:55] op_sel:[1,1,0] op_sel_hi:[1,0,1] neg_lo:[1,0,0]
    v_cvt_pk_bf16_f32 v41, v58, v59
    ds_write_addtid_b32 v41 offset:9248
    v_cvt_pk_bf16_f32 v42, v44, -v45
    s_mov_b32 m0, s70
    s_nop 0
    ds_write_addtid_b32 v42 offset:41472
    v_cvt_pk_bf16_f32 v43, v28, -v29
    ds_write_addtid_b32 v43 offset:42016
    v_cvt_pk_bf16_f32 v40, v50, -v51
    ds_write_addtid_b32 v40 offset:42560
    v_pk_mul_f32 v[58:59], v[56:57], v[26:27] op_sel:[0,0] op_sel_hi:[0,1]
    v_pk_mul_f32 v[50:51], v[54:55], v[28:29] op_sel:[0,0] op_sel_hi:[0,1]
    v_pk_fma_f32 v[58:59], v[56:57], v[26:27], v[58:59] op_sel:[1,1,0] op_sel_hi:[1,0,1] neg_lo:[1,0,0]
    v_pk_fma_f32 v[50:51], v[54:55], v[28:29], v[50:51] op_sel:[1,1,0] op_sel_hi:[1,0,1] neg_lo:[1,0,0]
    v_cvt_pk_bf16_f32 v41, v56, v57
    s_mov_b32 m0, s66
    s_nop 0
    ds_write_addtid_b32 v41 offset:11968
    v_cvt_pk_bf16_f32 v42, v54, -v55
    s_mov_b32 m0, s70
    s_nop 0
    ds_write_addtid_b32 v42 offset:43104
    v_pk_mul_f32 v[56:57], v[58:59], v[26:27] op_sel:[0,0] op_sel_hi:[0,1]
    v_pk_mul_f32 v[54:55], v[50:51], v[28:29] op_sel:[0,0] op_sel_hi:[0,1]
    v_pk_fma_f32 v[56:57], v[58:59], v[26:27], v[56:57] op_sel:[1,1,0] op_sel_hi:[1,0,1] neg_lo:[1,0,0]
    v_pk_fma_f32 v[54:55], v[50:51], v[28:29], v[54:55] op_sel:[1,1,0] op_sel_hi:[1,0,1] neg_lo:[1,0,0]
    v_cvt_pk_bf16_f32 v43, v58, v59
    s_mov_b32 m0, s66
    s_nop 0
    ds_write_addtid_b32 v43 offset:15232
    v_cvt_pk_bf16_f32 v40, v50, -v51
    s_mov_b32 m0, s70
    s_nop 0
    ds_write_addtid_b32 v40 offset:43648
    v_pk_mul_f32 v[58:59], v[56:57], v[26:27] op_sel:[0,0] op_sel_hi:[0,1]
    v_pk_mul_f32 v[50:51], v[54:55], v[28:29] op_sel:[0,0] op_sel_hi:[0,1]
    v_pk_fma_f32 v[58:59], v[56:57], v[26:27], v[58:59] op_sel:[1,1,0] op_sel_hi:[1,0,1] neg_lo:[1,0,0]
    v_pk_fma_f32 v[50:51], v[54:55], v[28:29], v[50:51] op_sel:[1,1,0] op_sel_hi:[1,0,1] neg_lo:[1,0,0]
    v_cvt_pk_bf16_f32 v41, v56, v57
    ds_write_addtid_b32 v41 offset:33312
    v_cvt_pk_bf16_f32 v42, v54, -v55
    ds_write_addtid_b32 v42 offset:44192
    v_pk_mul_f32 v[56:57], v[58:59], v[26:27] op_sel:[0,0] op_sel_hi:[0,1]
    v_pk_mul_f32 v[54:55], v[50:51], v[28:29] op_sel:[0,0] op_sel_hi:[0,1]
    v_pk_fma_f32 v[56:57], v[58:59], v[26:27], v[56:57] op_sel:[1,1,0] op_sel_hi:[1,0,1] neg_lo:[1,0,0]
    v_pk_fma_f32 v[54:55], v[50:51], v[28:29], v[54:55] op_sel:[1,1,0] op_sel_hi:[1,0,1] neg_lo:[1,0,0]
    v_cvt_pk_bf16_f32 v43, v58, v59
    ds_write_addtid_b32 v43 offset:34400
    v_cvt_pk_bf16_f32 v40, v50, -v51
    ds_write_addtid_b32 v40 offset:44736
    v_pk_mul_f32 v[58:59], v[56:57], v[26:27] op_sel:[0,0] op_sel_hi:[0,1]
    v_pk_mul_f32 v[50:51], v[54:55], v[28:29] op_sel:[0,0] op_sel_hi:[0,1]
    v_pk_fma_f32 v[58:59], v[56:57], v[26:27], v[58:59] op_sel:[1,1,0] op_sel_hi:[1,0,1] neg_lo:[1,0,0]
    v_pk_fma_f32 v[50:51], v[54:55], v[28:29], v[50:51] op_sel:[1,1,0] op_sel_hi:[1,0,1] neg_lo:[1,0,0]
    v_cvt_pk_bf16_f32 v41, v56, v57
    ds_write_addtid_b32 v41 offset:37664
    v_cvt_pk_bf16_f32 v42, v54, -v55
    ds_write_addtid_b32 v42 offset:45280
    v_pk_mul_f32 v[56:57], v[58:59], v[26:27] op_sel:[0,0] op_sel_hi:[0,1]
    v_pk_mul_f32 v[54:55], v[50:51], v[28:29] op_sel:[0,0] op_sel_hi:[0,1]
    v_pk_fma_f32 v[56:57], v[58:59], v[26:27], v[56:57] op_sel:[1,1,0] op_sel_hi:[1,0,1] neg_lo:[1,0,0]
    v_pk_fma_f32 v[54:55], v[50:51], v[28:29], v[54:55] op_sel:[1,1,0] op_sel_hi:[1,0,1] neg_lo:[1,0,0]
    v_cvt_pk_bf16_f32 v43, v58, v59
    ds_write_addtid_b32 v43 offset:38752
    v_cvt_pk_bf16_f32 v40, v50, -v51
    ds_write_addtid_b32 v40 offset:45824
    v_pk_mul_f32 v[58:59], v[56:57], v[26:27] op_sel:[0,0] op_sel_hi:[0,1]
    v_pk_mul_f32 v[50:51], v[54:55], v[28:29] op_sel:[0,0] op_sel_hi:[0,1]
    v_pk_fma_f32 v[58:59], v[56:57], v[26:27], v[58:59] op_sel:[1,1,0] op_sel_hi:[1,0,1] neg_lo:[1,0,0]
    v_pk_fma_f32 v[50:51], v[54:55], v[28:29], v[50:51] op_sel:[1,1,0] op_sel_hi:[1,0,1] neg_lo:[1,0,0]
    v_cvt_pk_bf16_f32 v41, v56, v57
    ds_write_addtid_b32 v41 offset:39296
    v_cvt_pk_bf16_f32 v42, v54, -v55
    ds_write_addtid_b32 v42 offset:46368
    v_pk_mul_f32 v[56:57], v[58:59], v[26:27] op_sel:[0,0] op_sel_hi:[0,1]
    v_pk_mul_f32 v[54:55], v[50:51], v[28:29] op_sel:[0,0] op_sel_hi:[0,1]
    v_pk_fma_f32 v[56:57], v[58:59], v[26:27], v[56:57] op_sel:[1,1,0] op_sel_hi:[1,0,1] neg_lo:[1,0,0]
    v_pk_fma_f32 v[54:55], v[50:51], v[28:29], v[54:55] op_sel:[1,1,0] op_sel_hi:[1,0,1] neg_lo:[1,0,0]
    v_cvt_pk_bf16_f32 v43, v58, v59
    ds_write_addtid_b32 v43 offset:39840
    v_cvt_pk_bf16_f32 v40, v50, -v51
    ds_write_addtid_b32 v40 offset:46912
    v_pk_mul_f32 v[58:59], v[56:57], v[26:27] op_sel:[0,0] op_sel_hi:[0,1]
    v_pk_mul_f32 v[50:51], v[54:55], v[28:29] op_sel:[0,0] op_sel_hi:[0,1]
    v_pk_fma_f32 v[58:59], v[56:57], v[26:27], v[58:59] op_sel:[1,1,0] op_sel_hi:[1,0,1] neg_lo:[1,0,0]
    v_pk_fma_f32 v[50:51], v[54:55], v[28:29], v[50:51] op_sel:[1,1,0] op_sel_hi:[1,0,1] neg_lo:[1,0,0]
    v_cvt_pk_bf16_f32 v41, v56, v57
    ds_write_addtid_b32 v41 offset:40384
    v_cvt_pk_bf16_f32 v42, v54, -v55
    ds_write_addtid_b32 v42 offset:47456
    v_pk_mul_f32 v[56:57], v[58:59], v[26:27] op_sel:[0,0] op_sel_hi:[0,1]
    v_pk_mul_f32 v[54:55], v[50:51], v[28:29] op_sel:[0,0] op_sel_hi:[0,1]
    v_pk_fma_f32 v[56:57], v[58:59], v[26:27], v[56:57] op_sel:[1,1,0] op_sel_hi:[1,0,1] neg_lo:[1,0,0]
    v_pk_fma_f32 v[54:55], v[50:51], v[28:29], v[54:55] op_sel:[1,1,0] op_sel_hi:[1,0,1] neg_lo:[1,0,0]
    v_cvt_pk_bf16_f32 v43, v58, v59
    ds_write_addtid_b32 v43 offset:40928
    v_cvt_pk_bf16_f32 v40, v50, -v51
    ds_write_addtid_b32 v40 offset:48000
    v_pk_mul_f32 v[58:59], v[56:57], v[26:27] op_sel:[0,0] op_sel_hi:[0,1]
    v_pk_mul_f32 v[50:51], v[54:55], v[28:29] op_sel:[0,0] op_sel_hi:[0,1]
    v_pk_fma_f32 v[58:59], v[56:57], v[26:27], v[58:59] op_sel:[1,1,0] op_sel_hi:[1,0,1] neg_lo:[1,0,0]
    v_pk_fma_f32 v[50:51], v[54:55], v[28:29], v[50:51] op_sel:[1,1,0] op_sel_hi:[1,0,1] neg_lo:[1,0,0]
    v_cvt_pk_bf16_f32 v41, v56, v57
    ds_write_addtid_b32 v41 offset:34944
    v_cvt_pk_bf16_f32 v42, v54, -v55
    ds_write_addtid_b32 v42 offset:48544
    v_pk_mul_f32 v[56:57], v[58:59], v[26:27] op_sel:[0,0] op_sel_hi:[0,1]
    v_pk_mul_f32 v[54:55], v[50:51], v[28:29] op_sel:[0,0] op_sel_hi:[0,1]
    v_pk_fma_f32 v[56:57], v[58:59], v[26:27], v[56:57] op_sel:[1,1,0] op_sel_hi:[1,0,1] neg_lo:[1,0,0]
    v_pk_fma_f32 v[54:55], v[50:51], v[28:29], v[54:55] op_sel:[1,1,0] op_sel_hi:[1,0,1] neg_lo:[1,0,0]
    v_cvt_pk_bf16_f32 v43, v58, v59
    ds_write_addtid_b32 v43 offset:35488
    v_cvt_pk_bf16_f32 v40, v50, -v51
    ds_write_addtid_b32 v40 offset:49088
    v_pk_mul_f32 v[58:59], v[56:57], v[26:27] op_sel:[0,0] op_sel_hi:[0,1]
    v_pk_fma_f32 v[58:59], v[56:57], v[26:27], v[58:59] op_sel:[1,1,0] op_sel_hi:[1,0,1] neg_lo:[1,0,0]
    v_cvt_pk_bf16_f32 v41, v56, v57
    ds_write_addtid_b32 v41 offset:36032
    v_cvt_pk_bf16_f32 v42, v54, -v55
    ds_write_addtid_b32 v42 offset:49632
    v_cvt_pk_bf16_f32 v43, v58, v59
    ds_write_addtid_b32 v43 offset:36576
    s_branch C_MFMA
C_ROLE1:
    v_mul_f32 v36, 0x43000000, v21
    v_mul_f32 v37, 0x43000000, v22
    v_mul_f32 v38, 0x3f800000, v21
    v_mul_f32 v39, 0x3f800000, v22
    v_exp_f32 v36, v36
    v_fract_f32 v37, v37
    v_exp_f32 v38, v38
    v_fract_f32 v39, v39
    v_fmac_f32 v37, 0x43000000, v23
    v_fmac_f32 v39, 0x3f800000, v23
    v_cos_f32 v26, v37
    v_sin_f32 v27, v37
    v_cos_f32 v28, v39
    v_sin_f32 v29, v39
    v_mul_f32 v26, v26, v36
    v_mul_f32 v27, v27, v36
    v_mul_f32 v28, v28, v38
    v_mul_f32 v29, v29, v38
    v_pk_mul_f32 v[44:45], v[24:25], v[26:27] op_sel:[0,0] op_sel_hi:[0,1]
    v_pk_mul_f32 v[46:47], v[28:29], v[28:29] op_sel:[0,0] op_sel_hi:[0,1]
    v_pk_mul_f32 v[48:49], v[24:25], v[28:29] op_sel:[0,0] op_sel_hi:[0,1]
    v_pk_fma_f32 v[44:45], v[24:25], v[26:27], v[44:45] op_sel:[1,1,0] op_sel_hi:[1,0,1] neg_lo:[1,0,0]
    v_pk_fma_f32 v[46:47], v[28:29], v[28:29], v[46:47] op_sel:[1,1,0] op_sel_hi:[1,0,1] neg_lo:[1,0,0]
    v_pk_fma_f32 v[48:49], v[24:25], v[28:29], v[48:49] op_sel:[1,1,0] op_sel_hi:[1,0,1] neg_lo:[1,0,0]
    v_cvt_pk_bf16_f32 v40, v24, v25
    ds_write_addtid_b32 v40 offset:0
    v_pk_mul_f32 v[50:51], v[44:45], v[26:27] op_sel:[0,0] op_sel_hi:[0,1]
    v_pk_mul_f32 v[52:53], v[44:45], v[28:29] op_sel:[0,0] op_sel_hi:[0,1]
    v_pk_mul_f32 v[54:55], v[48:49], v[28:29] op_sel:[0,0] op_sel_hi:[0,1]
    v_pk_mul_f32 v[62:63], v[46:47], v[46:47] op_sel:[0,0] op_sel_hi:[0,1]
    v_pk_fma_f32 v[50:51], v[44:45], v[26:27], v[50:51] op_sel:[1,1,0] op_sel_hi:[1,0,1] neg_lo:[1,0,0]
    v_pk_fma_f32 v[52:53], v[44:45], v[28:29], v[52:53] op_sel:[1,1,0] op_sel_hi:[1,0,1] neg_lo:[1,0,0]
    v_pk_fma_f32 v[54:55], v[48:49], v[28:29], v[54:55] op_sel:[1,1,0] op_sel_hi:[1,0,1] neg_lo:[1,0,0]
    v_pk_fma_f32 v[62:63], v[46:47], v[46:47], v[62:63] op_sel:[1,1,0] op_sel_hi:[1,0,1] neg_lo:[1,0,0]
    v_cvt_pk_bf16_f32 v41, v44, v45
    ds_write_addtid_b32 v41 offset:4896
    v_cvt_pk_bf16_f32 v42, v48, v49
    ds_write_addtid_b32 v42 offset:544
    v_pk_mul_f32 v[56:57], v[50:51], v[26:27] op_sel:[0,0] op_sel_hi:[0,1]
    v_pk_mul_f32 v[58:59], v[50:51], v[46:47] op_sel:[0,0] op_sel_hi:[0,1]
    v_pk_mul_f32 v[44:45], v[52:53], v[28:29] op_sel:[0,0] op_sel_hi:[0,1]
    v_pk_mul_f32 v[48:49], v[54:55], v[28:29] op_sel:[0,0] op_sel_hi:[0,1]
    v_pk_fma_f32 v[56:57], v[50:51], v[26:27], v[56:57] op_sel:[1,1,0] op_sel_hi:[1,0,1] neg_lo:[1,0,0]
    v_pk_fma_f32 v[58:59], v[50:51], v[46:47], v[58:59] op_sel:[1,1,0] op_sel_hi:[1,0,1] neg_lo:[1,0,0]
    v_pk_fma_f32 v[44:45], v[52:53], v[28:29], v[44:45] op_sel:[1,1,0] op_sel_hi:[1,0,1] neg_lo:[1,0,0]
    v_pk_fma_f32 v[48:49], v[54:55], v[28:29], v[48:49] op_sel:[1,1,0] op_sel_hi:[1,0,1] neg_lo:[1,0,0]
    v_cvt_pk_bf16_f32 v43, v50, v51
    ds_write_addtid_b32 v43 offset:9792
    v_cvt_pk_bf16_f32 v40, v52, v53
    ds_write_addtid_b32 v40 offset:5440
    v_cvt_pk_bf16_f32 v41, v54, v55
    ds_write_addtid_b32 v41 offset:1088
    v_pk_mul_f32 v[54:55], v[48:49], v[28:29] op_sel:[0,0] op_sel_hi:[0,1]
    v_pk_mul_f32 v[52:53], v[44:45], v[28:29] op_sel:[0,0] op_sel_hi:[0,1]
    v_pk_mul_f32 v[50:51], v[58:59], v[46:47] op_sel:[0,0] op_sel_hi:[0,1]
    v_pk_mul_f32 v[24:25], v[56:57], v[46:47] op_sel:[0,0] op_sel_hi:[0,1]
    v_pk_fma_f32 v[54:55], v[48:49], v[28:29], v[54:55] op_sel:[1,1,0] op_sel_hi:[1,0,1] neg_lo:[1,0,0]
    v_pk_fma_f32 v[52:53], v[44:45], v[28:29], v[52:53] op_sel:[1,1,0] op_sel_hi:[1,0,1] neg_lo:[1,0,0]
    v_pk_fma_f32 v[50:51], v[58:59], v[46:47], v[50:51] op_sel:[1,1,0] op_sel_hi:[1,0,1] neg_lo:[1,0,0]
    v_pk_fma_f32 v[24:25], v[56:57], v[46:47], v[24:25] op_sel:[1,1,0] op_sel_hi:[1,0,1] neg_lo:[1,0,0]
    v_cvt_pk_bf16_f32 v42, v48, v49
    ds_write_addtid_b32 v42 offset:1632
    v_cvt_pk_bf16_f32 v43, v44, v45
    ds_write_addtid_b32 v43 offset:5984
    v_cvt_pk_bf16_f32 v40, v58, v59
    ds_write_addtid_b32 v40 offset:10336
    v_pk_mul_f32 v[48:49], v[54:55], v[28:29] op_sel:[0,0] op_sel_hi:[0,1]
    v_pk_mul_f32 v[44:45], v[52:53], v[28:29] op_sel:[0,0] op_sel_hi:[0,1]
    v_pk_mul_f32 v[58:59], v[50:51], v[46:47] op_sel:[0,0] op_sel_hi:[0,1]
    v_pk_mul_f32 v[56:57], v[24:25], v[46:47] op_sel:[0,0] op_sel_hi:[0,1]
    v_pk_fma_f32 v[48:49], v[54:55], v[28:29], v[48:49] op_sel:[1,1,0] op_sel_hi:[1,0,1] neg_lo:[1,0,0]
    v_pk_fma_f32 v[44:45], v[52:53], v[28:29], v[44:45] op_sel:[1,1,0] op_sel_hi:[1,0,1] neg_lo:[1,0,0]
    v_pk_fma_f32 v[58:59], v[50:51], v[46:47], v[58:59] op_sel:[1,1,0] op_sel_hi:[1,0,1] neg_lo:[1,0,0]
    v_pk_fma_f32 v[56:57], v[24:25], v[46:47], v[56:57] op_sel:[1,1,0] op_sel_hi:[1,0,1] neg_lo:[1,0,0]
    v_cvt_pk_bf16_f32 v41, v54, v55
    ds_write_addtid_b32 v41 offset:2176
    v_cvt_pk_bf16_f32 v42, v52, v53
    ds_write_addtid_b32 v42 offset:6528
    v_cvt_pk_bf16_f32 v43, v50, v51
    ds_write_addtid_b32 v43 offset:10880
    v_cvt_pk_bf16_f32 v40, v24, v25
    ds_write_addtid_b32 v40 offset:13600
    v_pk_mul_f32 v[54:55], v[48:49], v[28:29] op_sel:[0,0] op_sel_hi:[0,1]
    v_pk_mul_f32 v[52:53], v[44:45], v[28:29] op_sel:[0,0] op_sel_hi:[0,1]
    v_pk_mul_f32 v[50:51], v[58:59], v[62:63] op_sel:[0,0] op_sel_hi:[0,1]
    v_pk_mul_f32 v[24:25], v[56:57], v[46:47] op_sel:[0,0] op_sel_hi:[0,1]
    v_pk_mul_f32 v[64:65], v[56:57], v[26:27] op_sel:[0,0] op_sel_hi:[0,1]
    v_pk_fma_f32 v[54:55], v[48:49], v[28:29], v[54:55] op_sel:[1,1,0] op_sel_hi:[1,0,1] neg_lo:[1,0,0]
    v_pk_fma_f32 v[52:53], v[44:45], v[28:29], v[52:53] op_sel:[1,1,0] op_sel_hi:[1,0,1] neg_lo:[1,0,0]
    v_pk_fma_f32 v[50:51], v[58:59], v[62:63], v[50:51] op_sel:[1,1,0] op_sel_hi:[1,0,1] neg_lo:[1,0,0]
    v_pk_fma_f32 v[24:25], v[56:57], v[46:47], v[24:25] op_sel:[1,1,0] op_sel_hi:[1,0,1] neg_lo:[1,0,0]
    v_pk_fma_f32 v[64:65], v[56:57], v[26:27], v[64:65] op_sel:[1,1,0] op_sel_hi:[1,0,1] neg_lo:[1,0,0]
    v_cvt_pk_bf16_f32 v41, v48, v49
    ds_write_addtid_b32 v41 offset:2720
    v_cvt_pk_bf16_f32 v42, v44, v45
    ds_write_addtid_b32 v42 offset:7072
    v_cvt_pk_bf16_f32 v43, v58, v59
    ds_write_addtid_b32 v43 offset:11424
    v_cvt_pk_bf16_f32 v40, v56, v57
    ds_write_addtid_b32 v40 offset:14144
    v_pk_mul_f32 v[48:49], v[54:55], v[28:29] op_sel:[0,0] op_sel_hi:[0,1]
    v_pk_mul_f32 v[44:45], v[52:53], v[28:29] op_sel:[0,0] op_sel_hi:[0,1]
    v_pk_mul_f32 v[56:57], v[24:25], v[62:63] op_sel:[0,0] op_sel_hi:[0,1]
    v_pk_mul_f32 v[66:67], v[64:65], v[26:27] op_sel:[0,0] op_sel_hi:[0,1]
    v_pk_fma_f32 v[48:49], v[54:55], v[28:29], v[48:49] op_sel:[1,1,0] op_sel_hi:[1,0,1] neg_lo:[1,0,0]
    v_pk_fma_f32 v[44:45], v[52:53], v[28:29], v[44:45] op_sel:[1,1,0] op_sel_hi:[1,0,1] neg_lo:[1,0,0]
    v_pk_fma_f32 v[56:57], v[24:25], v[62:63], v[56:57] op_sel:[1,1,0] op_sel_hi:[1,0,1] neg_lo:[1,0,0]
    v_pk_fma_f32 v[66:67], v[64:65], v[26:27], v[66:67] op_sel:[1,1,0] op_sel_hi:[1,0,1] neg_lo:[1,0,0]
    v_cvt_pk_bf16_f32 v41, v54, v55
    ds_write_addtid_b32 v41 offset:3264
    v_cvt_pk_bf16_f32 v42, v52, v53
    ds_write_addtid_b32 v42 offset:7616
    v_cvt_pk_bf16_f32 v43, v50, v51
    ds_write_addtid_b32 v43 offset:12512
    v_cvt_pk_bf16_f32 v40, v24, v25
    ds_write_addtid_b32 v40 offset:14688
    v_cvt_pk_bf16_f32 v41, v64, v65
    s_mov_b32 m0, s70
    s_nop 0
    ds_write_addtid_b32 v41 offset:32768
    v_pk_mul_f32 v[52:53], v[44:45], v[28:29] op_sel:[0,0] op_sel_hi:[0,1]
    v_pk_mul_f32 v[64:65], v[66:67], v[26:27] op_sel:[0,0] op_sel_hi:[0,1]
    v_pk_fma_f32 v[52:53], v[44:45], v[28:29], v[52:53] op_sel:[1,1,0] op_sel_hi:[1,0,1] neg_lo:[1,0,0]
    v_pk_fma_f32 v[64:65], v[66:67], v[26:27], v[64:65] op_sel:[1,1,0] op_sel_hi:[1,0,1] neg_lo:[1,0,0]
    v_cvt_pk_bf16_f32 v42, v48, v49
    s_mov_b32 m0, s66
    s_nop 0
    ds_write_addtid_b32 v42 offset:3808
    v_cvt_pk_bf16_f32 v43, v44, v45
    ds_write_addtid_b32 v43 offset:8160
    v_cvt_pk_bf16_f32 v40, v56, v57
    ds_write_addtid_b32 v40 offset:15776
    v_cvt_pk_bf16_f32 v41, v66, v67
    s_mov_b32 m0, s70
    s_nop 0
    ds_write_addtid_b32 v41 offset:33856
    v_pk_mul_f32 v[66:67], v[64:65], v[26:27] op_sel:[0,0] op_sel_hi:[0,1]
    v_pk_fma_f32 v[66:67], v[64:65], v[26:27], v[66:67] op_sel:[1,1,0] op_sel_hi:[1,0,1] neg_lo:[1,0,0]
    v_cvt_pk_bf16_f32 v42, v52, v53
    s_mov_b32 m0, s66
    s_nop 0
    ds_write_addtid_b32 v42 offset:8704
    v_cvt_pk_bf16_f32 v43, v64, v65
    s_mov_b32 m0, s70
    s_nop 0
    ds_write_addtid_b32 v43 offset:37120
    v_cvt_pk_bf16_f32 v40, v66, v67
    ds_write_addtid_b32 v40 offset:38208
C_MFMA:
    s_lshl_b32 s56, s2, 14
    s_lshl_b32 s57, s38, 12
    s_add_u32 s56, s56, s57
    s_add_u32 s56, s56, 49152
    s_mov_b64 exec, 0x1
    ds_inc_u32 v166, v166 offset:12
    s_mov_b64 exec, -1
    ds_write_b32 v113, v112
    s_setprio 2
    s_movk_i32 s60, 4000
C_KG:
    ds_read_b32 v16, v166 offset:12
    s_sub_u32 s60, s60, 1
    s_cmp_gt_i32 s60, 0
    s_waitcnt lgkmcnt(0)
    v_readfirstlane_b32 s52, v16
    s_nop 0
    s_cselect_b32 s52, s52, 4
    s_cmp_lg_u32 s52, 4
    s_cbranch_scc1 C_KG
    ds_read_b128 v[16:19], v111 offset:0
    ds_read_b128 v[20:23], v110 offset:0
    ds_read_b128 v[24:27], v111 offset:64
    ds_read_b128 v[28:31], v110 offset:64
    ds_read_b128 v[32:35], v111 offset:128
    ds_read_b128 v[36:39], v110 offset:128
    ds_read_b128 v[40:43], v111 offset:192
    ds_read_b128 v[44:47], v110 offset:192
    ds_read_b128 v[48:51], v111 offset:256
    ds_read_b128 v[52:55], v110 offset:256
    ds_read_b128 v[56:59], v111 offset:320
    ds_read_b128 v[60:63], v110 offset:320
    ds_read_b128 v[64:67], v111 offset:384
    ds_read_b128 v[68:71], v110 offset:384
    ds_read_b128 v[72:75], v111 offset:448
    ds_read_b128 v[76:79], v110 offset:448
    s_lshl_b32 s53, s63, 10
    s_sub_u32 s52, s64, s53
    s_add_u32 s52, s52, 3576
    v_and_b32 v165, 1, v5
    v_lshl_add_u32 v165, v6, 1, v165
    s_mul_i32 s53, s65, 384
    s_add_u32 s53, s53, 161920
    v_lshl_add_u32 v165, v165, 4, s53
    v_lshlrev_b32 v2, 3, v2
    v_sub_u32 v2, s52, v2
    s_mul_i32 s68, s63, 1088
    s_add_u32 s68, s68, s71
    v_lshl_add_u32 v15, v15, 3, s68
    s_cmp_lg_u32 s63, 0
    s_cbranch_scc1 C_LA1
    s_lshr_b32 s52, s2, 3
    s_mul_i32 s52, s52, 3
    s_add_u32 s52, s52, s65
    s_lshl_b32 s52, s52, 3
    s_and_b32 s53, s2, 7
    v_and_b32 v11, 7, v1
    v_add_u32 v11, s52, v11
    v_and_b32 v12, 56, v1
    v_mul_u32_u24 v13, 0x48, v11
    v_add3_u32 v14, v12, v13, s53
    v_lshlrev_b32 v14, 7, v14
    s_add_u32 s53, s53, 64
    v_add_lshl_u32 v13, v13, s53, 7
    s_mul_i32 s53, s53, 0x240
    v_add_lshl_u32 v12, v11, s53, 7
    v_mov_b32 v10, 0
    v_lshrrev_b32 v9, 3, v1
    v_mul_u32_u24 v9, 3328, v9
    v_add3_u32 v9, v9, v3, s59
    s_branch C_LA2
C_LA1:
    v_and_b32 v93, 3, v5
    v_lshl_add_u32 v94, v6, 3, v11
    v_and_b32 v92, 1, v11
    v_mul_u32_u24 v92, 3456, v92
    v_add_u32 v92, s59, v92
    v_sub_u32 v93, v93, v94
    v_sub_u32 v94, v93, v94
    v_add_u32 v95, 44, v93
    v_lshrrev_b32 v96, 4, v95
    v_add_u32 v95, v95, v96
    v_lshl_add_u32 v11, v95, 3, v92
    v_add_u32 v95, 75, v94
    v_lshrrev_b32 v96, 4, v95
    v_add_u32 v95, v95, v96
    v_lshl_add_u32 v13, v95, 3, v92
    v_add_u32 v95, 40, v93
    v_lshrrev_b32 v96, 4, v95
    v_add_u32 v95, v95, v96
    v_lshl_add_u32 v12, v95, 3, v92
    v_add_u32 v95, 67, v94
    v_lshrrev_b32 v96, 4, v95
    v_add_u32 v95, v95, v96
    v_lshl_add_u32 v14, v95, 3, v92
C_LA2:
    s_cmp_eq_u32 s69, 2
    s_cbranch_scc1 C_T2
    v_lshrrev_b32 v89, 1, v6
    v_xor_b32 v88, v89, v6
    v_and_b32 v88, 1, v88
    v_lshlrev_b32 v88, 8, v88
    v_lshl_add_u32 v88, v89, 3, v88
    v_lshl_add_u32 v88, v5, 4, v88
    s_cmp_eq_u32 s69, 1
    s_cbranch_scc1 C_T1
    s_lshr_b32 s52, s69, 1
    s_mul_i32 s53, s52, 1600
    s_add_u32 s53, s53, s67
    v_add_u32 v88, s53, v88
    v_add_u32 v89, 3200, v88
    s_xor_b32 s52, s52, 1
    s_mov_b32 s53, 0
    s_waitcnt lgkmcnt(14)
    v_mfma_f32_16x16x32_bf16 v[80:83], v[16:19], v[20:23], 0
    s_waitcnt lgkmcnt(12)
    v_mfma_f32_16x16x32_bf16 v[84:87], v[24:27], v[28:31], 0
    s_waitcnt lgkmcnt(10)
    v_mfma_f32_16x16x32_bf16 v[80:83], v[32:35], v[36:39], v[80:83]
    s_waitcnt lgkmcnt(8)
    v_mfma_f32_16x16x32_bf16 v[84:87], v[40:43], v[44:47], v[84:87]
    s_waitcnt lgkmcnt(6)
    v_mfma_f32_16x16x32_bf16 v[80:83], v[48:51], v[52:55], v[80:83]
    s_waitcnt lgkmcnt(4)
    v_mfma_f32_16x16x32_bf16 v[84:87], v[56:59], v[60:63], v[84:87]
    s_waitcnt lgkmcnt(2)
    v_mfma_f32_16x16x32_bf16 v[80:83], v[64:67], v[68:71], v[80:83]
    s_waitcnt lgkmcnt(0)
    v_mfma_f32_16x16x32_bf16 v[84:87], v[72:75], v[76:79], v[84:87]
    s_nop 7
    v_pk_add_f32 v[80:81], v[80:81], v[84:85]
    v_pk_add_f32 v[82:83], v[82:83], v[86:87]
    v_cvt_pk_bf16_f32 v80, v80, v81
    v_cvt_pk_bf16_f32 v81, v82, v83
    ds_write_b64 v88, v[80:81] offset:32
    ds_write2_b32 v89, v80, v81 offset0:7 offset1:8
    s_mov_b64 exec, s[52:53]
    ds_write_b16 v88, v80 offset:1630
    ds_write_b16 v88, v80 offset:4826
    s_mov_b64 exec, -1
    s_branch C_B3
C_T1:
    s_add_u32 s53, s67, 544
    v_add_u32 v88, s53, v88
    v_add_u32 v89, 1600, v88
    s_waitcnt lgkmcnt(14)
    v_mfma_f32_16x16x32_bf16 v[80:83], v[16:19], v[20:23], 0
    s_waitcnt lgkmcnt(12)
    v_mfma_f32_16x16x32_bf16 v[84:87], v[24:27], v[28:31], 0
    s_waitcnt lgkmcnt(10)
    v_mfma_f32_16x16x32_bf16 v[80:83], v[32:35], v[36:39], v[80:83]
    s_waitcnt lgkmcnt(8)
    v_mfma_f32_16x16x32_bf16 v[84:87], v[40:43], v[44:47], v[84:87]
    s_waitcnt lgkmcnt(6)
    v_mfma_f32_16x16x32_bf16 v[80:83], v[48:51], v[52:55], v[80:83]
    s_waitcnt lgkmcnt(4)
    v_mfma_f32_16x16x32_bf16 v[84:87], v[56:59], v[60:63], v[84:87]
    s_waitcnt lgkmcnt(2)
    v_mfma_f32_16x16x32_bf16 v[80:83], v[64:67], v[68:71], v[80:83]
    s_waitcnt lgkmcnt(0)
    v_mfma_f32_16x16x32_bf16 v[84:87], v[72:75], v[76:79], v[84:87]
    s_nop 7
    v_pk_add_f32 v[80:81], v[80:81], v[84:85]
    v_pk_add_f32 v[82:83], v[82:83], v[86:87]
    v_cvt_pk_bf16_f32 v16, v81, v82
    v_cvt_pk_bf16_f32 v17, v82, v82
    v_cvt_pk_bf16_f32 v18, v82, v82
    v_cvt_pk_bf16_f32 v19, v82, v83
    ds_write2_b32 v88, v16, v17 offset0:1 offset1:2
    ds_write_b64 v88, v[16:17] offset:3200
    ds_write2_b32 v89, v18, v19 offset0:1 offset1:2
    ds_write_b64 v88, v[18:19] offset:4800
    v_cvt_pk_bf16_f32 v20, v80, v80
    v_cvt_pk_bf16_f32 v21, v80, v81
    s_mov_b64 exec, 0x1
    ds_write_b32 v88, v20
    ds_write_b32 v88, v20 offset:3196
    ds_write_b32 v88, v21 offset:1600
    ds_write_b32 v88, v21 offset:4796
    s_mov_b32 exec_lo, 0x0
    s_mov_b32 exec_hi, 0x8000
    ds_write_b16 v88, v17 offset:12
    ds_write_b16 v88, v17 offset:1610
    ds_write_b16 v88, v17 offset:3208
    ds_write_b16 v88, v17 offset:4806
    s_mov_b64 exec, -1
    s_branch C_B3
C_T2:
    v_lshlrev_b32 v88, 7, v6
    v_lshl_add_u32 v89, v5, 1, v88
    v_lshl_add_u32 v88, v5, 2, v88
    s_add_u32 s52, s64, 4728
    v_add_u32 v88, s52, v88
    s_add_u32 s52, s64, 4920
    v_add_u32 v89, s52, v89
    v_mov_b32 v90, s67
    s_waitcnt lgkmcnt(14)
    v_mfma_f32_16x16x32_bf16 v[80:83], v[16:19], v[20:23], 0
    s_waitcnt lgkmcnt(12)
    v_mfma_f32_16x16x32_bf16 v[84:87], v[24:27], v[28:31], 0
    s_waitcnt lgkmcnt(10)
    v_mfma_f32_16x16x32_bf16 v[80:83], v[32:35], v[36:39], v[80:83]
    s_waitcnt lgkmcnt(8)
    v_mfma_f32_16x16x32_bf16 v[84:87], v[40:43], v[44:47], v[84:87]
    s_waitcnt lgkmcnt(6)
    v_mfma_f32_16x16x32_bf16 v[80:83], v[48:51], v[52:55], v[80:83]
    s_waitcnt lgkmcnt(4)
    v_mfma_f32_16x16x32_bf16 v[84:87], v[56:59], v[60:63], v[84:87]
    s_waitcnt lgkmcnt(2)
    v_mfma_f32_16x16x32_bf16 v[80:83], v[64:67], v[68:71], v[80:83]
    s_waitcnt lgkmcnt(0)
    v_mfma_f32_16x16x32_bf16 v[84:87], v[72:75], v[76:79], v[84:87]
    s_nop 7
    v_pk_add_f32 v[80:81], v[80:81], v[84:85]
    v_pk_add_f32 v[82:83], v[82:83], v[86:87]
    v_cvt_pk_bf16_f32 v80, v80, v81
    v_cvt_pk_bf16_f32 v81, v82, v83
    s_mov_b32 exec_hi, 0
    ds_write2_b32 v88, v80, v81 offset0:0 offset1:16
    s_not_b64 exec, exec
    ds_write_b16 v89, v80 offset:4
    ds_write_b16_d16_hi v89, v80 offset:36
    ds_write_b16 v89, v81 offset:68
    ds_write_b16_d16_hi v89, v81 offset:100
    ds_write_b16 v89, v80 offset:384
    ds_write_b16_d16_hi v89, v80 offset:416
    ds_write_b16 v89, v81 offset:448
    ds_write_b16_d16_hi v89, v81 offset:480
    s_mov_b32 exec_lo, 0x80000000
    s_mov_b32 exec_hi, 0x0
    ds_write_b16_d16_hi v90, v81 offset:1126
    ds_write_b16_d16_hi v90, v81 offset:1128
    ds_write_b16_d16_hi v90, v81 offset:2724
    ds_write_b16_d16_hi v90, v81 offset:2726
    ds_write_b16_d16_hi v90, v81 offset:4322
    ds_write_b16_d16_hi v90, v81 offset:4324
    ds_write_b16_d16_hi v90, v81 offset:5920
    ds_write_b16_d16_hi v90, v81 offset:5922
    s_mov_b64 exec, -1
C_B3:
    s_mov_b64 exec, 0x1
    ds_inc_u32 v166, v166 offset:128
    s_mov_b64 exec, -1
    s_cmp_lg_u32 s65, 1
    s_cbranch_scc1 C_NOUL
    s_waitcnt vmcnt(0)
    buffer_load_dwordx4 v[24:27], v3, s[40:43], s56 offen offset:0 sc1
    buffer_load_dwordx4 v[28:31], v3, s[40:43], s56 offen offset:1024 sc1
    buffer_load_dwordx4 v[32:35], v3, s[40:43], s56 offen offset:2048 sc1
    buffer_load_dwordx4 v[36:39], v3, s[40:43], s56 offen offset:3072 sc1
C_NOUL:
    s_movk_i32 s60, 4000
C_KM:
    ds_read_b128 v[16:19], v166 offset:128
    s_sub_u32 s60, s60, 1
    s_cmp_gt_i32 s60, 0
    s_waitcnt lgkmcnt(0)
    v_add_u32 v16, v16, v18
    s_nop 0
    v_readfirstlane_b32 s52, v16
    s_nop 0
    s_cselect_b32 s52, s52, 5
    s_cmp_lg_u32 s52, 5
    s_cbranch_scc1 C_KM
    s_setprio 3
    ds_read_b64 v[48:49], v7 offset:0
    ds_read_b64 v[50:51], v7 offset:8
    ds_read_b64 v[52:53], v7 offset:64
    ds_read_b64 v[54:55], v7 offset:72
    ds_read_b64 v[56:57], v7 offset:128
    ds_read_b64 v[58:59], v7 offset:136
    ds_read_b64 v[60:61], v7 offset:192
    ds_read_b64 v[62:63], v7 offset:200
    ds_read_b64 v[64:65], v7 offset:256
    ds_read_b64 v[66:67], v7 offset:264
    ds_read_b64 v[68:69], v7 offset:320
    ds_read_b64 v[70:71], v7 offset:328
    ds_read_b64 v[72:73], v7 offset:384
    ds_read_b64 v[74:75], v7 offset:392
    ds_read_b64 v[76:77], v7 offset:448
    ds_read_b64 v[78:79], v7 offset:456
    ds_read_b64 v[80:81], v7 offset:512
    ds_read_b64 v[82:83], v7 offset:520
    ds_read_b64 v[84:85], v7 offset:576
    ds_read_b64 v[86:87], v7 offset:584
    ds_read_b64 v[88:89], v7 offset:640
    ds_read_b64 v[90:91], v7 offset:648
    ds_read_b64 v[92:93], v7 offset:704
    ds_read_b64 v[94:95], v7 offset:712
    ds_read_b64 v[96:97], v7 offset:768
    ds_read_b64 v[98:99], v7 offset:776
    ds_read_b64 v[100:101], v7 offset:832
    ds_read_b64 v[102:103], v7 offset:840
    ds_read_b64 v[104:105], v7 offset:896
    ds_read_b64 v[106:107], v7 offset:904
    ds_read_b64 v[108:109], v7 offset:960
    ds_read_b64 v[110:111], v7 offset:968
    s_cmp_eq_u32 s63, 1
    s_cbranch_scc1 C_E1
    s_cmp_eq_u32 s63, 2
    s_cbranch_scc1 C_E2
    s_cmp_eq_u32 s63, 3
    s_cbranch_scc1 C_E3
    ds_read_b64 v[112:113], v7 offset:1152
    ds_read_b64 v[114:115], v7 offset:1160
    ds_read_b64 v[116:117], v7 offset:1216
    ds_read_b64 v[118:119], v7 offset:1224
    ds_read_b64 v[128:129], v7 offset:1280
    ds_read_b64 v[130:131], v7 offset:1288
    ds_read_b64 v[132:133], v7 offset:1344
    ds_read_b64 v[134:135], v7 offset:1352
    s_mov_b32 exec_hi, 0
    ds_write_b128 v9, v[160:163]
    s_mov_b64 exec, -1
    s_branch C_EE
C_E1:
    ds_read_b64 v[128:129], v7 offset:1152
    ds_read_b64 v[130:131], v7 offset:1160
    ds_read_b64 v[132:133], v7 offset:1216
    ds_read_b64 v[134:135], v7 offset:1224
    ds_read_b64 v[136:137], v7 offset:1280
    ds_read_b64 v[138:139], v7 offset:1288
    ds_read_b64 v[140:141], v7 offset:1344
    ds_read_b64 v[142:143], v7 offset:1352
    ds_read_b64 v[112:113], v7 offset:1024
    ds_read_b64 v[114:115], v7 offset:1032
    s_branch C_EE
C_E2:
    ds_read_b64 v[152:153], v7 offset:1152
    ds_read_b64 v[154:155], v7 offset:1160
    ds_read_b64 v[156:157], v7 offset:1216
    ds_read_b64 v[158:159], v7 offset:1224
    ds_read_b64 v[112:113], v7 offset:1024
    ds_read_b64 v[114:115], v7 offset:1032
    ds_read_b64 v[128:129], v9 offset:4608
    ds_read_b64 v[130:131], v9 offset:4616
    ds_read_b64 v[132:133], v9 offset:4672
    ds_read_b64 v[134:135], v9 offset:4680
    ds_read_b64 v[136:137], v9 offset:4736
    ds_read_b64 v[138:139], v9 offset:4744
    ds_read_b64 v[140:141], v9 offset:4800
    ds_read_b64 v[142:143], v9 offset:4808
    ds_read_b64 v[144:145], v9 offset:4864
    ds_read_b64 v[146:147], v9 offset:4872
    ds_read_b64 v[148:149], v9 offset:4928
    ds_read_b64 v[150:151], v9 offset:4936
    s_branch C_EE
C_E3:
    ds_read_b64 v[112:113], v7 offset:1024
    ds_read_b64 v[114:115], v7 offset:1032
    ds_read_b64 v[116:117], v7 offset:1088
    ds_read_b64 v[118:119], v7 offset:1096
    ds_read_b64 v[128:129], v9 offset:4608
    ds_read_b64 v[130:131], v9 offset:4616
    ds_read_b64 v[132:133], v9 offset:4672
    ds_read_b64 v[134:135], v9 offset:4680
    ds_read_b64 v[136:137], v9 offset:4736
    ds_read_b64 v[138:139], v9 offset:4744
    ds_read_b64 v[140:141], v9 offset:4800
    ds_read_b64 v[142:143], v9 offset:4808
    ds_read_b64 v[144:145], v9 offset:4864
    ds_read_b64 v[146:147], v9 offset:4872
    ds_read_b64 v[148:149], v9 offset:4928
    ds_read_b64 v[150:151], v9 offset:4936
    ds_read_b64 v[152:153], v10 offset:5120
    ds_read_b64 v[154:155], v10 offset:5128
    ds_read_b64 v[156:157], v10 offset:5184
    ds_read_b64 v[158:159], v10 offset:5192
    ds_read_b64 v[120:121], v10 offset:5248
    ds_read_b64 v[122:123], v10 offset:5256
    ds_read_b64 v[124:125], v10 offset:5312
    ds_read_b64 v[126:127], v10 offset:5320
C_EE:
    v_mov_b32 v167, v19
    v_readfirstlane_b32 s39, v19
    v_mul_u32_u24 v5, 37, v1
    v_lshrrev_b32 v5, 8, v5
    v_mul_u32_u24 v5, 1040, v5
    v_add_u32 v5, v5, v3
    v_add_u32 v6, 0x2400, v5
    s_mul_i32 s44, s2, 18432
    s_mul_i32 s45, s38, 96
    s_add_u32 s44, s44, s45
    s_add_u32 s72, s4, s44
    s_addc_u32 s73, s5, 0
    s_add_u32 s74, s24, s45
    s_addc_u32 s75, s25, 0
    s_mul_i32 s58, s69, 1920
    s_add_u32 s58, s58, s71
    s_add_u32 s58, s58, 4352
    s_cmp_lt_u32 s38, 4
    s_cbranch_scc1 C_B5
    v_mov_b32 v40, -1
    v_mov_b32 v41, -1
    v_mov_b32 v42, -1
    v_mov_b32 v43, -1
    v_lshlrev_b32 v20, 4, v0
    v_lshlrev_b32 v21, 2, v0
    s_cmp_lg_u32 s65, 1
    s_cbranch_scc1 C_PO
    s_lshl_b32 s52, s38, 10
    s_add_u32 m0, s52, 47936
    v_add_u32 v18, 161412, v3
    s_movk_i32 s60, 4000
    s_branch C_UP_W
C_UP:
    buffer_load_dwordx4 v[24:27], v3, s[40:43], s56 offen offset:0 sc1
    buffer_load_dwordx4 v[28:31], v3, s[40:43], s56 offen offset:1024 sc1
    buffer_load_dwordx4 v[32:35], v3, s[40:43], s56 offen offset:2048 sc1
    buffer_load_dwordx4 v[36:39], v3, s[40:43], s56 offen offset:3072 sc1
C_UP_W:
    s_waitcnt vmcnt(0)
C_UP_C:
    v_xor_b32 v44, v167, v27
    v_xor_b32 v45, v167, v31
    v_xor_b32 v46, v167, v35
    v_xor_b32 v47, v167, v39
    v_or3_b32 v44, v44, v45, v46
    v_or_b32 v44, v44, v47
    v_cmp_ne_u32 vcc, 0, v44
    s_nop 0
    s_and_b64 exec, exec, vcc
    s_cbranch_execz C_UP_D
    s_sub_u32 s60, s60, 1
    s_cmp_gt_i32 s60, 0
    s_sleep 2
    s_cbranch_scc1 C_UP
C_UP_D:
    s_mov_b64 exec, -1
    ds_write_addtid_b32 v25 offset:55040
    ds_write_addtid_b32 v29 offset:55296
    ds_write_addtid_b32 v33 offset:55552
    ds_write_addtid_b32 v37 offset:55808
    s_mov_b64 exec, 0x2
    ds_inc_u32 v18, v18
    s_mov_b64 exec, -1
    ds_write_addtid_b32 v26 offset:60928
    ds_write_addtid_b32 v30 offset:61184
    ds_write_addtid_b32 v34 offset:61440
    ds_write_addtid_b32 v38 offset:61696
    s_mov_b64 exec, 0x4
    ds_inc_u32 v18, v18
    s_mov_b64 exec, -1
    ds_write_addtid_b32 v24 offset:49152
    ds_write_addtid_b32 v28 offset:49408
    ds_write_addtid_b32 v32 offset:49664
    ds_write_addtid_b32 v36 offset:49920
    s_mov_b64 exec, 0x1
    ds_inc_u32 v18, v18
    s_mov_b64 exec, -1
C_PO:
    s_cmp_ge_u32 s50, 144
    s_cbranch_scc1 C_B5
    buffer_store_dwordx4 v[40:43], v20, s[40:43], s48 offen sc1
    buffer_store_dword v40, v21, s[40:43], s49 offen sc1
C_B5:
    s_mov_b32 s56, 0xf7efdfbf
    s_mov_b32 s57, 0x7efdfb
    s_movk_i32 s60, 4000
C_UF:
    ds_read_b32 v16, v166 offset:132
    s_sub_u32 s60, s60, 1
    s_cmp_gt_i32 s60, 0
    s_waitcnt lgkmcnt(0)
    v_readfirstlane_b32 s52, v16
    s_nop 0
    s_cselect_b32 s52, s52, 4
    s_cmp_lg_u32 s52, 4
    s_cbranch_scc1 C_UF
    s_movk_i32 s60, 4000
    s_cmp_eq_u32 s63, 1
    s_cbranch_scc1 C_P1
    s_cmp_eq_u32 s63, 2
    s_cbranch_scc1 C_P2
    s_cmp_eq_u32 s63, 3
    s_cbranch_scc1 C_P3
    s_setprio 2
    ds_read_b128 v[32:35], v8 offset:3552
    ds_read_b128 v[36:39], v8 offset:4064
    ds_read_b128 v[40:43], v8 offset:3680
    s_waitcnt lgkmcnt(2)
    v_mfma_f32_16x16x32_bf16 v[136:139], v[112:115], v[32:35], 0
    v_mfma_f32_16x16x32_bf16 v[140:143], v[116:119], v[32:35], 0
    v_mfma_f32_16x16x32_bf16 v[144:147], v[128:131], v[32:35], 0
    v_mfma_f32_16x16x32_bf16 v[148:151], v[132:135], v[32:35], 0
    v_mfma_f32_16x16x32_bf16 v[28:31], v[52:55], v[32:35], 0
    v_mfma_f32_16x16x32_bf16 v[20:23], v[48:51], v[32:35], 0
    ds_read_b128 v[44:47], v8 offset:3808
    s_waitcnt lgkmcnt(2)
    v_mfma_f32_16x16x32_bf16 v[152:155], v[112:115], v[36:39], 0
    v_mfma_f32_16x16x32_bf16 v[156:159], v[116:119], v[36:39], 0
    v_mfma_f32_16x16x32_bf16 v[120:123], v[128:131], v[36:39], 0
    v_mfma_f32_16x16x32_bf16 v[124:127], v[132:135], v[36:39], 0
    v_mfma_f32_16x16x32_bf16 v[28:31], v[84:87], v[36:39], v[28:31]
    v_mfma_f32_16x16x32_bf16 v[20:23], v[80:83], v[36:39], v[20:23]
    v_mfma_f32_16x16x32_bf16 v[24:27], v[52:55], v[36:39], 0
    v_mfma_f32_16x16x32_bf16 v[16:19], v[48:51], v[36:39], 0
    v_cvt_pk_bf16_f32 v136, v136, v137
    v_cvt_pk_bf16_f32 v137, v138, v139
    ds_write_b64 v4, v[136:137] offset:680
    v_cvt_pk_bf16_f32 v140, v140, v141
    v_cvt_pk_bf16_f32 v141, v142, v143
    ds_write_b64 v4, v[140:141] offset:4136
    v_cvt_pk_bf16_f32 v144, v144, v145
    v_cvt_pk_bf16_f32 v145, v146, v147
    ds_write_b64 v4, v[144:145] offset:7592
    v_cvt_pk_bf16_f32 v148, v148, v149
    v_cvt_pk_bf16_f32 v149, v150, v151
    ds_write_b64 v4, v[148:149] offset:11048
    ds_read_b128 v[32:35], v8 offset:3936
    s_waitcnt lgkmcnt(6)
    v_mfma_f32_16x16x32_bf16 v[28:31], v[60:63], v[40:43], v[28:31]
    v_mfma_f32_16x16x32_bf16 v[20:23], v[56:59], v[40:43], v[20:23]
    v_cvt_pk_bf16_f32 v152, v152, v153
    v_cvt_pk_bf16_f32 v153, v154, v155
    ds_write_b64 v4, v[152:153] offset:136
    v_cvt_pk_bf16_f32 v156, v156, v157
    v_cvt_pk_bf16_f32 v157, v158, v159
    ds_write_b64 v4, v[156:157] offset:3592
    v_cvt_pk_bf16_f32 v120, v120, v121
    v_cvt_pk_bf16_f32 v121, v122, v123
    ds_write_b64 v4, v[120:121] offset:7048
    v_cvt_pk_bf16_f32 v124, v124, v125
    v_cvt_pk_bf16_f32 v125, v126, v127
    ds_write_b64 v4, v[124:125] offset:10504
    s_mov_b64 exec, 0x1
    ds_write_b32 v166, v166 offset:0
    s_mov_b64 exec, -1
    s_setprio 0
    ds_read_b128 v[84:87], v8 offset:4192
    ds_read_b64 v[160:161], v2 offset:512
    ds_read_b64 v[162:163], v2
    s_or_b32 s52, s38, s2
    s_cbranch_scc1 C_NOEP
    s_mov_b64 exec, 0x1
    buffer_store_dword v167, v10, s[40:43], 0 offen sc1
    s_mov_b64 exec, -1
C_NOEP:
    s_cmp_ge_u32 s2, 128
    s_cbranch_scc1 C_NX0
    s_mov_b32 m0, s58
    s_mov_b64 exec, s[56:57]
    global_load_lds_dwordx4 v5, s[72:73]
    s_add_u32 m0, s58, 896
    s_nop 0
    global_load_lds_dwordx4 v6, s[72:73]
    s_add_u32 m0, s58, 1792
    s_mov_b64 exec, 0x3f
    global_load_lds_dwordx4 v3, s[74:75]
    s_mov_b64 exec, -1
C_NX0:
    s_mov_b32 m0, 163328
    s_nop 0
    global_load_lds_dword v14, s[28:29]
    s_mov_b64 exec, 0xff
    global_load_lds_dword v13, s[28:29]
    global_load_lds_dword v13, s[26:27]
    global_load_lds_dword v12, s[30:31]
    s_mov_b64 exec, -1
    s_waitcnt lgkmcnt(13)
    v_mfma_f32_16x16x32_bf16 v[28:31], v[68:71], v[44:47], v[28:31]
    v_mfma_f32_16x16x32_bf16 v[20:23], v[64:67], v[44:47], v[20:23]
    ds_read_b128 v[80:83], v8 offset:4320
    s_waitcnt lgkmcnt(9)
    v_mfma_f32_16x16x32_bf16 v[28:31], v[76:79], v[32:35], v[28:31]
    v_mfma_f32_16x16x32_bf16 v[20:23], v[72:75], v[32:35], v[20:23]
    ds_read_b128 v[36:39], v8 offset:4448
    s_waitcnt lgkmcnt(2)
    v_and_b32 v48, 0xffff0000, v161
    v_lshlrev_b32 v49, 16, v161
    v_and_b32 v50, 0xffff0000, v160
    v_lshlrev_b32 v51, 16, v160
    v_mul_f32 v48, v48, v164
    v_mul_f32 v49, v49, v164
    v_mul_f32 v50, v50, v164
    v_mul_f32 v51, v51, v164
    v_cvt_pk_bf16_f32 v49, v48, v49
    v_lshlrev_b32 v48, 16, v49
    v_and_b32 v49, 0xffff0000, v49
    v_cvt_pk_bf16_f32 v51, v50, v51
    v_lshlrev_b32 v50, 16, v51
    v_and_b32 v51, 0xffff0000, v51
    v_and_b32 v52, 0xffff0000, v163
    v_lshlrev_b32 v53, 16, v163
    v_and_b32 v54, 0xffff0000, v162
    v_lshlrev_b32 v55, 16, v162
    v_mul_f32 v52, v52, v164
    v_mul_f32 v53, v53, v164
    v_mul_f32 v54, v54, v164
    v_mul_f32 v55, v55, v164
    v_cvt_pk_bf16_f32 v53, v52, v53
    v_lshlrev_b32 v52, 16, v53
    v_and_b32 v53, 0xffff0000, v53
    v_cvt_pk_bf16_f32 v55, v54, v55
    v_lshlrev_b32 v54, 16, v55
    v_and_b32 v55, 0xffff0000, v55
    v_mfma_f32_16x16x32_bf16 v[28:31], v[92:95], v[84:87], v[28:31]
    v_mfma_f32_16x16x32_bf16 v[20:23], v[88:91], v[84:87], v[20:23]
    v_mfma_f32_16x16x32_bf16 v[24:27], v[60:63], v[84:87], v[24:27]
    v_mfma_f32_16x16x32_bf16 v[16:19], v[56:59], v[84:87], v[16:19]
    s_waitcnt lgkmcnt(1)
    v_mfma_f32_16x16x32_bf16 v[28:31], v[100:103], v[80:83], v[28:31]
    v_mfma_f32_16x16x32_bf16 v[20:23], v[96:99], v[80:83], v[20:23]
    v_mfma_f32_16x16x32_bf16 v[24:27], v[68:71], v[80:83], v[24:27]
    v_mfma_f32_16x16x32_bf16 v[16:19], v[64:67], v[80:83], v[16:19]
    s_waitcnt lgkmcnt(0)
    v_mfma_f32_16x16x32_bf16 v[28:31], v[108:111], v[36:39], v[28:31]
    v_mfma_f32_16x16x32_bf16 v[20:23], v[104:107], v[36:39], v[20:23]
    v_mfma_f32_16x16x32_bf16 v[24:27], v[76:79], v[36:39], v[24:27]
    v_mfma_f32_16x16x32_bf16 v[16:19], v[72:75], v[36:39], v[16:19]
    s_mov_b32 exec_lo, 0xc000c000
    s_mov_b32 exec_hi, 0xc000c000
    s_nop 2
    ds_write_b128 v165, v[28:31] offset:128
    ds_write_b32 v166, v166 offset:64
    s_mov_b64 exec, -1
    s_setprio 0
    s_waitcnt vmcnt(7)
    s_cmp_lt_u32 s2, 128
    s_cbranch_scc1 C_EPI
    s_waitcnt vmcnt(4)
    s_branch C_EPI
C_P1:
    s_setprio 2
    ds_read_b128 v[32:35], v8 offset:2528
    ds_read_b128 v[36:39], v8 offset:3040
    ds_read_b128 v[40:43], v8 offset:2656
    s_waitcnt lgkmcnt(2)
    v_mfma_f32_16x16x32_bf16 v[144:147], v[128:131], v[32:35], 0
    v_mfma_f32_16x16x32_bf16 v[148:151], v[132:135], v[32:35], 0
    v_mfma_f32_16x16x32_bf16 v[152:155], v[136:139], v[32:35], 0
    v_mfma_f32_16x16x32_bf16 v[156:159], v[140:143], v[32:35], 0
    v_mfma_f32_16x16x32_bf16 v[28:31], v[52:55], v[32:35], 0
    v_mfma_f32_16x16x32_bf16 v[20:23], v[48:51], v[32:35], 0
    ds_read_b128 v[44:47], v8 offset:2784
    s_waitcnt lgkmcnt(2)
    v_mfma_f32_16x16x32_bf16 v[116:119], v[128:131], v[36:39], 0
    v_mfma_f32_16x16x32_bf16 v[160:163], v[132:135], v[36:39], 0
    v_mfma_f32_16x16x32_bf16 v[120:123], v[136:139], v[36:39], 0
    v_mfma_f32_16x16x32_bf16 v[124:127], v[140:143], v[36:39], 0
    v_mfma_f32_16x16x32_bf16 v[28:31], v[84:87], v[36:39], v[28:31]
    v_mfma_f32_16x16x32_bf16 v[20:23], v[80:83], v[36:39], v[20:23]
    v_mfma_f32_16x16x32_bf16 v[24:27], v[52:55], v[36:39], 0
    v_mfma_f32_16x16x32_bf16 v[16:19], v[48:51], v[36:39], 0
    v_cvt_pk_bf16_f32 v144, v144, v145
    v_cvt_pk_bf16_f32 v145, v146, v147
    ds_write_b64 v4, v[144:145] offset:1768
    v_cvt_pk_bf16_f32 v148, v148, v149
    v_cvt_pk_bf16_f32 v149, v150, v151
    ds_write_b64 v4, v[148:149] offset:5224
    v_cvt_pk_bf16_f32 v152, v152, v153
    v_cvt_pk_bf16_f32 v153, v154, v155
    ds_write_b64 v4, v[152:153] offset:8680
    v_cvt_pk_bf16_f32 v156, v156, v157
    v_cvt_pk_bf16_f32 v157, v158, v159
    ds_write_b64 v4, v[156:157] offset:12136
    ds_read_b128 v[32:35], v8 offset:2912
    s_waitcnt lgkmcnt(6)
    v_mfma_f32_16x16x32_bf16 v[28:31], v[60:63], v[40:43], v[28:31]
    v_mfma_f32_16x16x32_bf16 v[20:23], v[56:59], v[40:43], v[20:23]
    v_cvt_pk_bf16_f32 v116, v116, v117
    v_cvt_pk_bf16_f32 v117, v118, v119
    ds_write_b64 v4, v[116:117] offset:1224
    v_cvt_pk_bf16_f32 v160, v160, v161
    v_cvt_pk_bf16_f32 v161, v162, v163
    ds_write_b64 v4, v[160:161] offset:4680
    v_cvt_pk_bf16_f32 v120, v120, v121
    v_cvt_pk_bf16_f32 v121, v122, v123
    ds_write_b64 v4, v[120:121] offset:8136
    v_cvt_pk_bf16_f32 v124, v124, v125
    v_cvt_pk_bf16_f32 v125, v126, v127
    ds_write_b64 v4, v[124:125] offset:11592
    s_mov_b64 exec, 0x1
    ds_write_b32 v166, v166 offset:4
    s_mov_b64 exec, -1
    s_setprio 1
    ds_read_b128 v[36:39], v8 offset:3168
    ds_read_b64 v[144:145], v9 offset:4608
    ds_read_b64 v[146:147], v9 offset:4616
    ds_read_b64 v[148:149], v9 offset:4672
    ds_read_b64 v[150:151], v9 offset:4680
    ds_read_b64 v[152:153], v9 offset:4736
    ds_read_b64 v[154:155], v9 offset:4744
    ds_read_b64 v[156:157], v9 offset:4800
    ds_read_b64 v[158:159], v9 offset:4808
    ds_read_b64 v[160:161], v2 offset:512
    ds_read_b64 v[162:163], v2
    s_cmp_ge_u32 s2, 128
    s_cbranch_scc1 C_NX1
    s_mov_b32 m0, s58
    s_mov_b64 exec, s[56:57]
    global_load_lds_dwordx4 v5, s[72:73]
    s_add_u32 m0, s58, 896
    s_nop 0
    global_load_lds_dwordx4 v6, s[72:73]
    s_add_u32 m0, s58, 1792
    s_mov_b64 exec, 0x3f
    global_load_lds_dwordx4 v3, s[74:75]
    s_mov_b64 exec, -1
C_NX1:
    s_waitcnt lgkmcnt(15)
    v_mfma_f32_16x16x32_bf16 v[28:31], v[68:71], v[44:47], v[28:31]
    v_mfma_f32_16x16x32_bf16 v[20:23], v[64:67], v[44:47], v[20:23]
    ds_read_b128 v[40:43], v8 offset:3296
    v_mfma_f32_16x16x32_bf16 v[28:31], v[76:79], v[32:35], v[28:31]
    v_mfma_f32_16x16x32_bf16 v[20:23], v[72:75], v[32:35], v[20:23]
    ds_read_b128 v[128:131], v8 offset:3424
    s_waitcnt lgkmcnt(2)
    v_and_b32 v48, 0xffff0000, v161
    v_lshlrev_b32 v49, 16, v161
    v_and_b32 v50, 0xffff0000, v160
    v_lshlrev_b32 v51, 16, v160
    v_mul_f32 v48, v48, v164
    v_mul_f32 v49, v49, v164
    v_mul_f32 v50, v50, v164
    v_mul_f32 v51, v51, v164
    v_cvt_pk_bf16_f32 v49, v48, v49
    v_lshlrev_b32 v48, 16, v49
    v_and_b32 v49, 0xffff0000, v49
    v_cvt_pk_bf16_f32 v51, v50, v51
    v_lshlrev_b32 v50, 16, v51
    v_and_b32 v51, 0xffff0000, v51
    v_and_b32 v52, 0xffff0000, v163
    v_lshlrev_b32 v53, 16, v163
    v_and_b32 v54, 0xffff0000, v162
    v_lshlrev_b32 v55, 16, v162
    v_mul_f32 v52, v52, v164
    v_mul_f32 v53, v53, v164
    v_mul_f32 v54, v54, v164
    v_mul_f32 v55, v55, v164
    v_cvt_pk_bf16_f32 v53, v52, v53
    v_lshlrev_b32 v52, 16, v53
    v_and_b32 v53, 0xffff0000, v53
    v_cvt_pk_bf16_f32 v55, v54, v55
    v_lshlrev_b32 v54, 16, v55
    v_and_b32 v55, 0xffff0000, v55
    v_mfma_f32_16x16x32_bf16 v[28:31], v[92:95], v[36:39], v[28:31]
    v_mfma_f32_16x16x32_bf16 v[20:23], v[88:91], v[36:39], v[20:23]
    v_mfma_f32_16x16x32_bf16 v[24:27], v[60:63], v[36:39], v[24:27]
    v_mfma_f32_16x16x32_bf16 v[16:19], v[56:59], v[36:39], v[16:19]
    ds_read_b128 v[132:135], v8 offset:3552
    s_waitcnt lgkmcnt(2)
    v_mfma_f32_16x16x32_bf16 v[28:31], v[100:103], v[40:43], v[28:31]
    v_mfma_f32_16x16x32_bf16 v[20:23], v[96:99], v[40:43], v[20:23]
    v_mfma_f32_16x16x32_bf16 v[24:27], v[68:71], v[40:43], v[24:27]
    v_mfma_f32_16x16x32_bf16 v[16:19], v[64:67], v[40:43], v[16:19]
    ds_read_b96 v[60:62], v166
    ds_read_b128 v[136:139], v8 offset:3680
    s_waitcnt lgkmcnt(3)
    v_mfma_f32_16x16x32_bf16 v[28:31], v[108:111], v[128:131], v[28:31]
    v_mfma_f32_16x16x32_bf16 v[20:23], v[104:107], v[128:131], v[20:23]
    v_mfma_f32_16x16x32_bf16 v[24:27], v[76:79], v[128:131], v[24:27]
    v_mfma_f32_16x16x32_bf16 v[16:19], v[72:75], v[128:131], v[16:19]
    s_waitcnt lgkmcnt(1)
C_FL1:
    v_min3_u32 v60, v60, v61, v62
    v_cmp_eq_u32 vcc, 0, v60
    s_nop 4
    s_cbranch_vccz C_FD1
    ds_read_b96 v[60:62], v166
    s_sub_u32 s60, s60, 1
    s_cmp_gt_i32 s60, 0
    s_waitcnt lgkmcnt(0)
    s_cbranch_scc1 C_FL1
C_FD1:
    ds_read_b128 v[140:143], v8 offset:3808
    v_mfma_f32_16x16x32_bf16 v[20:23], v[112:115], v[132:135], v[20:23]
    v_mfma_f32_16x16x32_bf16 v[24:27], v[84:87], v[132:135], v[24:27]
    v_mfma_f32_16x16x32_bf16 v[16:19], v[80:83], v[132:135], v[16:19]
    s_mov_b32 exec_lo, 0xc000c000
    s_mov_b32 exec_hi, 0xc000c000
    ds_write_b128 v165, v[28:31] offset:256
    ds_write_b32 v166, v166 offset:68
    s_mov_b64 exec, -1
    ds_read_b128 v[44:47], v8 offset:3936
    s_waitcnt lgkmcnt(4)
    v_mfma_f32_16x16x32_bf16 v[24:27], v[92:95], v[136:139], v[24:27]
    v_mfma_f32_16x16x32_bf16 v[16:19], v[88:91], v[136:139], v[16:19]
    ds_read_b128 v[32:35], v8 offset:4064
    ds_read_b64_tr_b16 v[36:37], v11 offset:0
    ds_read_b64_tr_b16 v[38:39], v12 offset:0
    ds_read_b64_tr_b16 v[68:69], v11 offset:272
    ds_read_b64_tr_b16 v[70:71], v12 offset:272
    s_waitcnt lgkmcnt(8)
    v_mfma_f32_16x16x32_bf16 v[24:27], v[100:103], v[140:143], v[24:27]
    v_mfma_f32_16x16x32_bf16 v[16:19], v[96:99], v[140:143], v[16:19]
    ds_read_b64_tr_b16 v[64:65], v11 offset:544
    ds_read_b64_tr_b16 v[66:67], v12 offset:544
    s_waitcnt lgkmcnt(7)
    v_mfma_f32_16x16x32_bf16 v[24:27], v[108:111], v[44:47], v[24:27]
    v_mfma_f32_16x16x32_bf16 v[16:19], v[104:107], v[44:47], v[16:19]
    ds_read_b64_tr_b16 v[40:41], v11 offset:816
    ds_read_b64_tr_b16 v[42:43], v12 offset:816
    s_waitcnt lgkmcnt(8)
    v_mfma_f32_16x16x32_bf16 v[16:19], v[112:115], v[32:35], v[16:19]
    s_waitcnt lgkmcnt(6)
    v_mfma_f32_16x16x32_bf16 v[20:23], v[36:39], v[156:159], v[20:23]
    v_mfma_f32_16x16x32_bf16 v[16:19], v[36:39], v[148:151], v[16:19]
    s_waitcnt lgkmcnt(4)
    v_mfma_f32_16x16x32_bf16 v[20:23], v[68:71], v[152:155], v[20:23]
    v_mfma_f32_16x16x32_bf16 v[16:19], v[68:71], v[144:147], v[16:19]
    ds_read_b32 v60, v166 offset:64
    ds_read_b128 v[56:59], v165 offset:128
    s_waitcnt lgkmcnt(4)
    v_mfma_f32_16x16x32_bf16 v[20:23], v[64:67], v[148:151], v[20:23]
    s_waitcnt lgkmcnt(2)
    v_mfma_f32_16x16x32_bf16 v[20:23], v[40:43], v[144:147], v[20:23]
    s_setprio 0
    s_waitcnt lgkmcnt(0)
C_CL1:
    v_cmp_eq_u32 vcc, 0, v60
    s_nop 4
    s_cbranch_vccz C_CD
    ds_read_b32 v60, v166 offset:64
    ds_read_b128 v[56:59], v165 offset:128
    s_sub_u32 s60, s60, 1
    s_cmp_gt_i32 s60, 0
    s_waitcnt lgkmcnt(0)
    s_cbranch_scc1 C_CL1
    s_branch C_CD
C_P2:
    s_setprio 2
    ds_read_b128 v[32:35], v8 offset:1504
    ds_read_b128 v[36:39], v8 offset:2016
    ds_read_b128 v[40:43], v8 offset:1632
    s_waitcnt lgkmcnt(2)
    v_mfma_f32_16x16x32_bf16 v[116:119], v[152:155], v[32:35], 0
    v_mfma_f32_16x16x32_bf16 v[160:163], v[156:159], v[32:35], 0
    v_mfma_f32_16x16x32_bf16 v[28:31], v[52:55], v[32:35], 0
    v_mfma_f32_16x16x32_bf16 v[20:23], v[48:51], v[32:35], 0
    ds_read_b128 v[44:47], v8 offset:1760
    s_waitcnt lgkmcnt(2)
    v_mfma_f32_16x16x32_bf16 v[120:123], v[152:155], v[36:39], 0
    v_mfma_f32_16x16x32_bf16 v[124:127], v[156:159], v[36:39], 0
    v_mfma_f32_16x16x32_bf16 v[28:31], v[84:87], v[36:39], v[28:31]
    v_mfma_f32_16x16x32_bf16 v[20:23], v[80:83], v[36:39], v[20:23]
    v_mfma_f32_16x16x32_bf16 v[24:27], v[52:55], v[36:39], 0
    v_mfma_f32_16x16x32_bf16 v[16:19], v[48:51], v[36:39], 0
    v_cvt_pk_bf16_f32 v116, v116, v117
    v_cvt_pk_bf16_f32 v117, v118, v119
    ds_write_b64 v4, v[116:117] offset:2856
    v_cvt_pk_bf16_f32 v160, v160, v161
    v_cvt_pk_bf16_f32 v161, v162, v163
    ds_write_b64 v4, v[160:161] offset:6312
    ds_read_b128 v[32:35], v8 offset:1888
    s_waitcnt lgkmcnt(4)
    v_mfma_f32_16x16x32_bf16 v[28:31], v[60:63], v[40:43], v[28:31]
    v_mfma_f32_16x16x32_bf16 v[20:23], v[56:59], v[40:43], v[20:23]
    v_cvt_pk_bf16_f32 v120, v120, v121
    v_cvt_pk_bf16_f32 v121, v122, v123
    ds_write_b64 v4, v[120:121] offset:2312
    v_cvt_pk_bf16_f32 v124, v124, v125
    v_cvt_pk_bf16_f32 v125, v126, v127
    ds_write_b64 v4, v[124:125] offset:5768
    s_mov_b64 exec, 0x1
    ds_write_b32 v166, v166 offset:8
    s_mov_b64 exec, -1
    s_setprio 1
    ds_read_b128 v[36:39], v8 offset:2144
    ds_read_b64 v[116:117], v7 offset:1088
    ds_read_b64 v[118:119], v7 offset:1096
    ds_read_b64 v[120:121], v10 offset:5120
    ds_read_b64 v[122:123], v10 offset:5128
    ds_read_b64 v[124:125], v10 offset:5184
    ds_read_b64 v[126:127], v10 offset:5192
    ds_read_b64 v[160:161], v2 offset:512
    ds_read_b64 v[162:163], v2
    s_cmp_ge_u32 s2, 128
    s_cbranch_scc1 C_NX2
    s_mov_b32 m0, s58
    s_mov_b64 exec, s[56:57]
    global_load_lds_dwordx4 v5, s[72:73]
    s_add_u32 m0, s58, 896
    s_nop 0
    global_load_lds_dwordx4 v6, s[72:73]
    s_add_u32 m0, s58, 1792
    s_mov_b64 exec, 0x3f
    global_load_lds_dwordx4 v3, s[74:75]
    s_mov_b64 exec, -1
C_NX2:
    s_waitcnt lgkmcnt(15)
    v_mfma_f32_16x16x32_bf16 v[28:31], v[68:71], v[44:47], v[28:31]
    v_mfma_f32_16x16x32_bf16 v[20:23], v[64:67], v[44:47], v[20:23]
    ds_read_b128 v[40:43], v8 offset:2272
    s_waitcnt lgkmcnt(13)
    v_mfma_f32_16x16x32_bf16 v[28:31], v[76:79], v[32:35], v[28:31]
    v_mfma_f32_16x16x32_bf16 v[20:23], v[72:75], v[32:35], v[20:23]
    ds_read_b128 v[152:155], v8 offset:2400
    s_waitcnt lgkmcnt(2)
    v_and_b32 v48, 0xffff0000, v161
    v_lshlrev_b32 v49, 16, v161
    v_and_b32 v50, 0xffff0000, v160
    v_lshlrev_b32 v51, 16, v160
    v_mul_f32 v48, v48, v164
    v_mul_f32 v49, v49, v164
    v_mul_f32 v50, v50, v164
    v_mul_f32 v51, v51, v164
    v_cvt_pk_bf16_f32 v49, v48, v49
    v_lshlrev_b32 v48, 16, v49
    v_and_b32 v49, 0xffff0000, v49
    v_cvt_pk_bf16_f32 v51, v50, v51
    v_lshlrev_b32 v50, 16, v51
    v_and_b32 v51, 0xffff0000, v51
    v_and_b32 v52, 0xffff0000, v163
    v_lshlrev_b32 v53, 16, v163
    v_and_b32 v54, 0xffff0000, v162
    v_lshlrev_b32 v55, 16, v162
    v_mul_f32 v52, v52, v164
    v_mul_f32 v53, v53, v164
    v_mul_f32 v54, v54, v164
    v_mul_f32 v55, v55, v164
    v_cvt_pk_bf16_f32 v53, v52, v53
    v_lshlrev_b32 v52, 16, v53
    v_and_b32 v53, 0xffff0000, v53
    v_cvt_pk_bf16_f32 v55, v54, v55
    v_lshlrev_b32 v54, 16, v55
    v_and_b32 v55, 0xffff0000, v55
    v_mfma_f32_16x16x32_bf16 v[28:31], v[92:95], v[36:39], v[28:31]
    v_mfma_f32_16x16x32_bf16 v[20:23], v[88:91], v[36:39], v[20:23]
    v_mfma_f32_16x16x32_bf16 v[24:27], v[60:63], v[36:39], v[24:27]
    v_mfma_f32_16x16x32_bf16 v[16:19], v[56:59], v[36:39], v[16:19]
    ds_read_b128 v[156:159], v8 offset:2528
    s_waitcnt lgkmcnt(2)
    v_mfma_f32_16x16x32_bf16 v[28:31], v[100:103], v[40:43], v[28:31]
    v_mfma_f32_16x16x32_bf16 v[20:23], v[96:99], v[40:43], v[20:23]
    v_mfma_f32_16x16x32_bf16 v[24:27], v[68:71], v[40:43], v[24:27]
    v_mfma_f32_16x16x32_bf16 v[16:19], v[64:67], v[40:43], v[16:19]
    ds_read_b128 v[44:47], v8 offset:2656
    s_waitcnt lgkmcnt(2)
    v_mfma_f32_16x16x32_bf16 v[28:31], v[108:111], v[152:155], v[28:31]
    v_mfma_f32_16x16x32_bf16 v[20:23], v[104:107], v[152:155], v[20:23]
    v_mfma_f32_16x16x32_bf16 v[24:27], v[76:79], v[152:155], v[24:27]
    v_mfma_f32_16x16x32_bf16 v[16:19], v[72:75], v[152:155], v[16:19]
    ds_read_b128 v[32:35], v8 offset:2784
    s_waitcnt lgkmcnt(2)
    v_mfma_f32_16x16x32_bf16 v[20:23], v[112:115], v[156:159], v[20:23]
    v_mfma_f32_16x16x32_bf16 v[24:27], v[84:87], v[156:159], v[24:27]
    v_mfma_f32_16x16x32_bf16 v[16:19], v[80:83], v[156:159], v[16:19]
    s_mov_b32 exec_lo, 0xc000c000
    s_mov_b32 exec_hi, 0xc000c000
    ds_write_b128 v165, v[28:31] offset:384
    ds_write_b32 v166, v166 offset:72
    s_mov_b64 exec, -1
    ds_read_b96 v[60:62], v166
    ds_read_b128 v[36:39], v8 offset:2912
    s_waitcnt lgkmcnt(5)
    v_mfma_f32_16x16x32_bf16 v[24:27], v[92:95], v[44:47], v[24:27]
    v_mfma_f32_16x16x32_bf16 v[16:19], v[88:91], v[44:47], v[16:19]
    s_waitcnt lgkmcnt(1)
C_FL2:
    v_min3_u32 v60, v60, v61, v62
    v_cmp_eq_u32 vcc, 0, v60
    s_nop 4
    s_cbranch_vccz C_FD2
    ds_read_b96 v[60:62], v166
    s_sub_u32 s60, s60, 1
    s_cmp_gt_i32 s60, 0
    s_waitcnt lgkmcnt(0)
    s_cbranch_scc1 C_FL2
C_FD2:
    ds_read_b128 v[68:71], v8 offset:3040
    v_mfma_f32_16x16x32_bf16 v[24:27], v[100:103], v[32:35], v[24:27]
    v_mfma_f32_16x16x32_bf16 v[16:19], v[96:99], v[32:35], v[16:19]
    ds_read_b128 v[64:67], v8 offset:3552
    s_waitcnt lgkmcnt(2)
    v_mfma_f32_16x16x32_bf16 v[24:27], v[108:111], v[36:39], v[24:27]
    v_mfma_f32_16x16x32_bf16 v[16:19], v[104:107], v[36:39], v[16:19]
    ds_read_b128 v[40:43], v8 offset:4064
    ds_read_b64_tr_b16 v[76:77], v13 offset:6912
    ds_read_b64_tr_b16 v[78:79], v14 offset:6912
    ds_read_b64_tr_b16 v[72:73], v13 offset:7456
    ds_read_b64_tr_b16 v[74:75], v14 offset:7456
    s_waitcnt lgkmcnt(6)
    v_mfma_f32_16x16x32_bf16 v[16:19], v[112:115], v[68:71], v[16:19]
    ds_read_b64_tr_b16 v[152:153], v11 offset:0
    ds_read_b64_tr_b16 v[154:155], v12 offset:0
    s_waitcnt lgkmcnt(7)
    v_mfma_f32_16x16x32_bf16 v[20:23], v[116:119], v[64:67], v[20:23]
    ds_read_b64_tr_b16 v[84:85], v11 offset:272
    ds_read_b64_tr_b16 v[86:87], v12 offset:272
    s_waitcnt lgkmcnt(8)
    v_mfma_f32_16x16x32_bf16 v[16:19], v[116:119], v[40:43], v[16:19]
    ds_read_b64_tr_b16 v[80:81], v11 offset:544
    ds_read_b64_tr_b16 v[82:83], v12 offset:544
    s_waitcnt lgkmcnt(8)
    v_mfma_f32_16x16x32_bf16 v[20:23], v[76:79], v[124:127], v[20:23]
    v_mfma_f32_16x16x32_bf16 v[16:19], v[76:79], v[120:123], v[16:19]
    ds_read_b64_tr_b16 v[156:157], v11 offset:816
    ds_read_b64_tr_b16 v[158:159], v12 offset:816
    s_waitcnt lgkmcnt(8)
    v_mfma_f32_16x16x32_bf16 v[20:23], v[72:75], v[120:123], v[20:23]
    ds_read_b64_tr_b16 v[92:93], v11 offset:1088
    ds_read_b64_tr_b16 v[94:95], v12 offset:1088
    s_waitcnt lgkmcnt(8)
    v_mfma_f32_16x16x32_bf16 v[16:19], v[152:155], v[148:151], v[16:19]
    ds_read_b64_tr_b16 v[88:89], v11 offset:1360
    ds_read_b64_tr_b16 v[90:91], v12 offset:1360
    s_waitcnt lgkmcnt(8)
    v_mfma_f32_16x16x32_bf16 v[16:19], v[84:87], v[144:147], v[16:19]
    ds_read_b64_tr_b16 v[44:45], v11 offset:1632
    ds_read_b64_tr_b16 v[46:47], v12 offset:1632
    s_waitcnt lgkmcnt(8)
    v_mfma_f32_16x16x32_bf16 v[20:23], v[80:83], v[148:151], v[20:23]
    v_mfma_f32_16x16x32_bf16 v[16:19], v[80:83], v[140:143], v[16:19]
    ds_read_b64_tr_b16 v[100:101], v11 offset:1904
    ds_read_b64_tr_b16 v[102:103], v12 offset:1904
    s_waitcnt lgkmcnt(8)
    v_mfma_f32_16x16x32_bf16 v[20:23], v[156:159], v[144:147], v[20:23]
    v_mfma_f32_16x16x32_bf16 v[16:19], v[156:159], v[136:139], v[16:19]
    s_waitcnt lgkmcnt(6)
    v_mfma_f32_16x16x32_bf16 v[20:23], v[92:95], v[140:143], v[20:23]
    v_mfma_f32_16x16x32_bf16 v[16:19], v[92:95], v[132:135], v[16:19]
    s_waitcnt lgkmcnt(4)
    v_mfma_f32_16x16x32_bf16 v[20:23], v[88:91], v[136:139], v[20:23]
    v_mfma_f32_16x16x32_bf16 v[16:19], v[88:91], v[128:131], v[16:19]
    ds_read_b32 v60, v166 offset:68
    ds_read_b128 v[56:59], v165 offset:256
    s_waitcnt lgkmcnt(4)
    v_mfma_f32_16x16x32_bf16 v[20:23], v[44:47], v[132:135], v[20:23]
    s_waitcnt lgkmcnt(2)
    v_mfma_f32_16x16x32_bf16 v[20:23], v[100:103], v[128:131], v[20:23]
    s_setprio 0
    s_waitcnt lgkmcnt(0)
C_CL2:
    v_cmp_eq_u32 vcc, 0, v60
    s_nop 4
    s_cbranch_vccz C_CD
    ds_read_b32 v60, v166 offset:68
    ds_read_b128 v[56:59], v165 offset:256
    s_sub_u32 s60, s60, 1
    s_cmp_gt_i32 s60, 0
    s_waitcnt lgkmcnt(0)
    s_cbranch_scc1 C_CL2
    s_branch C_CD
C_P3:
    s_setprio 1
    ds_read_b128 v[32:35], v8 offset:480
    ds_read_b128 v[36:39], v8 offset:608
    ds_read_b128 v[40:43], v8 offset:736
    ds_read_b64 v[160:161], v2 offset:512
    ds_read_b64 v[162:163], v2
    s_waitcnt lgkmcnt(4)
    v_mfma_f32_16x16x32_bf16 v[28:31], v[52:55], v[32:35], 0
    v_mfma_f32_16x16x32_bf16 v[20:23], v[48:51], v[32:35], 0
    ds_read_b128 v[44:47], v8 offset:864
    s_waitcnt lgkmcnt(4)
    v_mfma_f32_16x16x32_bf16 v[28:31], v[60:63], v[36:39], v[28:31]
    v_mfma_f32_16x16x32_bf16 v[20:23], v[56:59], v[36:39], v[20:23]
    s_cmp_ge_u32 s2, 128
    s_cbranch_scc1 C_NX3
    s_mov_b32 m0, s58
    s_mov_b64 exec, s[56:57]
    global_load_lds_dwordx4 v5, s[72:73]
    s_add_u32 m0, s58, 896
    s_nop 0
    global_load_lds_dwordx4 v6, s[72:73]
    s_add_u32 m0, s58, 1792
    s_mov_b64 exec, 0x3f
    global_load_lds_dwordx4 v3, s[74:75]
    s_mov_b64 exec, -1
C_NX3:
    ds_read_b128 v[32:35], v8 offset:992
    s_waitcnt lgkmcnt(4)
    v_mfma_f32_16x16x32_bf16 v[28:31], v[68:71], v[40:43], v[28:31]
    v_mfma_f32_16x16x32_bf16 v[20:23], v[64:67], v[40:43], v[20:23]
    ds_read_b128 v[36:39], v8 offset:1120
    s_waitcnt lgkmcnt(2)
    v_mfma_f32_16x16x32_bf16 v[28:31], v[76:79], v[44:47], v[28:31]
    v_mfma_f32_16x16x32_bf16 v[20:23], v[72:75], v[44:47], v[20:23]
    ds_read_b128 v[40:43], v8 offset:1248
    s_waitcnt lgkmcnt(2)
    v_mfma_f32_16x16x32_bf16 v[28:31], v[84:87], v[32:35], v[28:31]
    v_mfma_f32_16x16x32_bf16 v[20:23], v[80:83], v[32:35], v[20:23]
    v_mfma_f32_16x16x32_bf16 v[24:27], v[52:55], v[32:35], 0
    v_mfma_f32_16x16x32_bf16 v[16:19], v[48:51], v[32:35], 0
    ds_read_b128 v[44:47], v8 offset:1376
    s_waitcnt lgkmcnt(2)
    v_mfma_f32_16x16x32_bf16 v[28:31], v[92:95], v[36:39], v[28:31]
    v_mfma_f32_16x16x32_bf16 v[20:23], v[88:91], v[36:39], v[20:23]
    v_mfma_f32_16x16x32_bf16 v[24:27], v[60:63], v[36:39], v[24:27]
    v_mfma_f32_16x16x32_bf16 v[16:19], v[56:59], v[36:39], v[16:19]
    ds_read_b128 v[32:35], v8 offset:1504
    v_and_b32 v48, 0xffff0000, v161
    v_lshlrev_b32 v49, 16, v161
    v_and_b32 v50, 0xffff0000, v160
    v_lshlrev_b32 v51, 16, v160
    v_mul_f32 v48, v48, v164
    v_mul_f32 v49, v49, v164
    v_mul_f32 v50, v50, v164
    v_mul_f32 v51, v51, v164
    v_cvt_pk_bf16_f32 v49, v48, v49
    v_lshlrev_b32 v48, 16, v49
    v_and_b32 v49, 0xffff0000, v49
    v_cvt_pk_bf16_f32 v51, v50, v51
    v_lshlrev_b32 v50, 16, v51
    v_and_b32 v51, 0xffff0000, v51
    v_and_b32 v52, 0xffff0000, v163
    v_lshlrev_b32 v53, 16, v163
    v_and_b32 v54, 0xffff0000, v162
    v_lshlrev_b32 v55, 16, v162
    v_mul_f32 v52, v52, v164
    v_mul_f32 v53, v53, v164
    v_mul_f32 v54, v54, v164
    v_mul_f32 v55, v55, v164
    v_cvt_pk_bf16_f32 v53, v52, v53
    v_lshlrev_b32 v52, 16, v53
    v_and_b32 v53, 0xffff0000, v53
    v_cvt_pk_bf16_f32 v55, v54, v55
    v_lshlrev_b32 v54, 16, v55
    v_and_b32 v55, 0xffff0000, v55
    s_waitcnt lgkmcnt(2)
    v_mfma_f32_16x16x32_bf16 v[28:31], v[100:103], v[40:43], v[28:31]
    v_mfma_f32_16x16x32_bf16 v[20:23], v[96:99], v[40:43], v[20:23]
    v_mfma_f32_16x16x32_bf16 v[24:27], v[68:71], v[40:43], v[24:27]
    v_mfma_f32_16x16x32_bf16 v[16:19], v[64:67], v[40:43], v[16:19]
    ds_read_b128 v[36:39], v8 offset:1632
    s_waitcnt lgkmcnt(2)
    v_mfma_f32_16x16x32_bf16 v[28:31], v[108:111], v[44:47], v[28:31]
    v_mfma_f32_16x16x32_bf16 v[20:23], v[104:107], v[44:47], v[20:23]
    v_mfma_f32_16x16x32_bf16 v[24:27], v[76:79], v[44:47], v[24:27]
    v_mfma_f32_16x16x32_bf16 v[16:19], v[72:75], v[44:47], v[16:19]
    ds_read_b128 v[68:71], v8 offset:1760
    s_waitcnt lgkmcnt(2)
    v_mfma_f32_16x16x32_bf16 v[20:23], v[112:115], v[32:35], v[20:23]
    v_mfma_f32_16x16x32_bf16 v[24:27], v[84:87], v[32:35], v[24:27]
    v_mfma_f32_16x16x32_bf16 v[16:19], v[80:83], v[32:35], v[16:19]
    ds_read_b96 v[60:62], v166
    ds_read_b128 v[64:67], v8 offset:1888
    s_waitcnt lgkmcnt(3)
    v_mfma_f32_16x16x32_bf16 v[24:27], v[92:95], v[36:39], v[24:27]
    v_mfma_f32_16x16x32_bf16 v[16:19], v[88:91], v[36:39], v[16:19]
    s_waitcnt lgkmcnt(1)
C_FL3:
    v_min3_u32 v60, v60, v61, v62
    v_cmp_eq_u32 vcc, 0, v60
    s_nop 4
    s_cbranch_vccz C_FD3
    ds_read_b96 v[60:62], v166
    s_sub_u32 s60, s60, 1
    s_cmp_gt_i32 s60, 0
    s_waitcnt lgkmcnt(0)
    s_cbranch_scc1 C_FL3
C_FD3:
    ds_read_b128 v[40:43], v8 offset:2016
    v_mfma_f32_16x16x32_bf16 v[24:27], v[100:103], v[68:71], v[24:27]
    v_mfma_f32_16x16x32_bf16 v[16:19], v[96:99], v[68:71], v[16:19]
    ds_read_b128 v[76:79], v8 offset:2528
    s_waitcnt lgkmcnt(2)
    v_mfma_f32_16x16x32_bf16 v[24:27], v[108:111], v[64:67], v[24:27]
    v_mfma_f32_16x16x32_bf16 v[16:19], v[104:107], v[64:67], v[16:19]
    ds_read_b128 v[72:75], v8 offset:3040
    ds_read_b64_tr_b16 v[44:45], v13 offset:6912
    ds_read_b64_tr_b16 v[46:47], v14 offset:6912
    ds_read_b64_tr_b16 v[84:85], v13 offset:7456
    ds_read_b64_tr_b16 v[86:87], v14 offset:7456
    s_waitcnt lgkmcnt(6)
    v_mfma_f32_16x16x32_bf16 v[16:19], v[112:115], v[40:43], v[16:19]
    ds_read_b64_tr_b16 v[80:81], v13 offset:8000
    ds_read_b64_tr_b16 v[82:83], v14 offset:8000
    s_waitcnt lgkmcnt(7)
    v_mfma_f32_16x16x32_bf16 v[20:23], v[116:119], v[76:79], v[20:23]
    ds_read_b64_tr_b16 v[32:33], v13 offset:8544
    ds_read_b64_tr_b16 v[34:35], v14 offset:8544
    s_waitcnt lgkmcnt(8)
    v_mfma_f32_16x16x32_bf16 v[16:19], v[116:119], v[72:75], v[16:19]
    ds_read_b64_tr_b16 v[92:93], v11 offset:1088
    ds_read_b64_tr_b16 v[94:95], v12 offset:1088
    s_waitcnt lgkmcnt(8)
    v_mfma_f32_16x16x32_bf16 v[20:23], v[44:47], v[124:127], v[20:23]
    v_mfma_f32_16x16x32_bf16 v[16:19], v[44:47], v[120:123], v[16:19]
    ds_read_b64_tr_b16 v[88:89], v11 offset:1360
    ds_read_b64_tr_b16 v[90:91], v12 offset:1360
    s_waitcnt lgkmcnt(8)
    v_mfma_f32_16x16x32_bf16 v[20:23], v[84:87], v[120:123], v[20:23]
    v_mfma_f32_16x16x32_bf16 v[16:19], v[84:87], v[156:159], v[16:19]
    ds_read_b64_tr_b16 v[36:37], v11 offset:1632
    ds_read_b64_tr_b16 v[38:39], v12 offset:1632
    s_waitcnt lgkmcnt(8)
    v_mfma_f32_16x16x32_bf16 v[20:23], v[80:83], v[156:159], v[20:23]
    v_mfma_f32_16x16x32_bf16 v[16:19], v[80:83], v[152:155], v[16:19]
    ds_read_b64_tr_b16 v[100:101], v11 offset:1904
    ds_read_b64_tr_b16 v[102:103], v12 offset:1904
    s_waitcnt lgkmcnt(8)
    v_mfma_f32_16x16x32_bf16 v[20:23], v[32:35], v[152:155], v[20:23]
    ds_read_b64_tr_b16 v[96:97], v11 offset:2176
    ds_read_b64_tr_b16 v[98:99], v12 offset:2176
    s_waitcnt lgkmcnt(8)
    v_mfma_f32_16x16x32_bf16 v[16:19], v[92:95], v[148:151], v[16:19]
    ds_read_b64_tr_b16 v[68:69], v11 offset:2448
    ds_read_b64_tr_b16 v[70:71], v12 offset:2448
    s_waitcnt lgkmcnt(8)
    v_mfma_f32_16x16x32_bf16 v[16:19], v[88:91], v[144:147], v[16:19]
    ds_read_b64_tr_b16 v[108:109], v11 offset:2720
    ds_read_b64_tr_b16 v[110:111], v12 offset:2720
    s_waitcnt lgkmcnt(8)
    v_mfma_f32_16x16x32_bf16 v[20:23], v[36:39], v[148:151], v[20:23]
    v_mfma_f32_16x16x32_bf16 v[16:19], v[36:39], v[140:143], v[16:19]
    ds_read_b64_tr_b16 v[104:105], v11 offset:2992
    ds_read_b64_tr_b16 v[106:107], v12 offset:2992
    s_waitcnt lgkmcnt(8)
    v_mfma_f32_16x16x32_bf16 v[20:23], v[100:103], v[144:147], v[20:23]
    v_mfma_f32_16x16x32_bf16 v[16:19], v[100:103], v[136:139], v[16:19]
    s_waitcnt lgkmcnt(6)
    v_mfma_f32_16x16x32_bf16 v[20:23], v[96:99], v[140:143], v[20:23]
    v_mfma_f32_16x16x32_bf16 v[16:19], v[96:99], v[132:135], v[16:19]
    s_waitcnt lgkmcnt(4)
    v_mfma_f32_16x16x32_bf16 v[20:23], v[68:71], v[136:139], v[20:23]
    v_mfma_f32_16x16x32_bf16 v[16:19], v[68:71], v[128:131], v[16:19]
    ds_read_b32 v60, v166 offset:72
    ds_read_b128 v[56:59], v165 offset:384
    s_waitcnt lgkmcnt(4)
    v_mfma_f32_16x16x32_bf16 v[20:23], v[108:111], v[132:135], v[20:23]
    s_waitcnt lgkmcnt(2)
    v_mfma_f32_16x16x32_bf16 v[20:23], v[104:107], v[128:131], v[20:23]
    s_setprio 0
    s_waitcnt lgkmcnt(0)
C_CL3:
    v_cmp_eq_u32 vcc, 0, v60
    s_nop 4
    s_cbranch_vccz C_CD
    ds_read_b32 v60, v166 offset:72
    ds_read_b128 v[56:59], v165 offset:384
    s_sub_u32 s60, s60, 1
    s_cmp_gt_i32 s60, 0
    s_waitcnt lgkmcnt(0)
    s_cbranch_scc1 C_CL3
C_CD:
    s_waitcnt vmcnt(3)
    s_cmp_lt_u32 s2, 128
    s_cbranch_scc1 C_CD2
    s_waitcnt vmcnt(0)
C_CD2:
    s_mov_b32 exec_lo, 0x30003
    s_mov_b32 exec_hi, 0x30003
    s_nop 4
    v_pk_add_f32 v[16:17], v[16:17], v[56:57]
    v_pk_add_f32 v[18:19], v[18:19], v[58:59]
    s_mov_b64 exec, -1
C_EPI:
    s_nop 3
    s_movk_i32 s54, 0x3f80
    s_mov_b32 s55, 1.0
    v_add_f32_dpp v16, v24, v16 row_shr:2 row_mask:0xf bank_mask:0xf
    v_add_f32_dpp v17, v25, v17 row_shr:2 row_mask:0xf bank_mask:0xf
    v_add_f32_dpp v18, v26, v18 row_shr:2 row_mask:0xf bank_mask:0xf
    v_add_f32_dpp v19, v27, v19 row_shr:2 row_mask:0xf bank_mask:0xf
    v_add_f32_dpp v20, v28, v20 row_shr:2 row_mask:0xf bank_mask:0xf
    v_add_f32_dpp v21, v29, v21 row_shr:2 row_mask:0xf bank_mask:0xf
    v_add_f32_dpp v22, v30, v22 row_shr:2 row_mask:0xf bank_mask:0xf
    v_add_f32_dpp v23, v31, v23 row_shr:2 row_mask:0xf bank_mask:0xf
    v_add_f32_dpp v20, v24, v20 row_shl:14 row_mask:0xf bank_mask:0xf
    v_add_f32_dpp v21, v25, v21 row_shl:14 row_mask:0xf bank_mask:0xf
    v_add_f32_dpp v22, v26, v22 row_shl:14 row_mask:0xf bank_mask:0xf
    v_add_f32_dpp v23, v27, v23 row_shl:14 row_mask:0xf bank_mask:0xf
    v_cvt_pk_bf16_f32 v16, v16, v17
    v_cvt_pk_bf16_f32 v17, v18, v19
    v_cvt_pk_bf16_f32 v18, v20, v21
    v_cvt_pk_bf16_f32 v19, v22, v23
    v_dot2c_f32_bf16 v48, s54, v16
    v_dot2c_f32_bf16 v49, s55, v16
    v_dot2c_f32_bf16 v50, s54, v17
    v_dot2c_f32_bf16 v51, s55, v17
    v_dot2c_f32_bf16 v52, s54, v18
    v_dot2c_f32_bf16 v53, s55, v18
    v_dot2c_f32_bf16 v54, s54, v19
    v_dot2c_f32_bf16 v55, s55, v19
    v_cvt_pk_bf16_f32 v48, v48, v49
    v_cvt_pk_bf16_f32 v49, v50, v51
    ds_write_b64 v15, v[48:49] offset:0
    v_cvt_pk_bf16_f32 v52, v52, v53
    v_cvt_pk_bf16_f32 v53, v54, v55
    ds_write_b64 v15, v[52:53] offset:544
    s_cmp_ge_u32 s38, 8
    s_cbranch_scc1 C_NOGA
    v_lshrrev_b32 v7, 5, v0
    v_lshlrev_b32 v7, 3, v7
    v_lshl_add_u32 v7, v0, 2, v7
    v_add_u32 v7, 48960, v7
    v_lshrrev_b32 v8, 3, v0
    v_mul_u32_u24 v8, 0x6000, v8
    v_and_b32 v9, 7, v0
    v_lshl_add_u32 v8, v9, 4, v8
    s_lshr_b32 s52, s2, 4
    s_lshl_b32 s52, s52, 11
    s_and_b32 s53, s2, 1
    s_lshl_b32 s53, s53, 10
    s_add_u32 s52, s52, s53
    s_bfe_u32 s53, s2, 0x30001
    s_lshl_b32 s53, s53, 7
    s_add_u32 s52, s52, s53
    s_add_u32 s52, s52, 3211264
    s_add_u32 s53, s52, 1572864
    v_mov_b32 v27, v167
    v_mov_b32 v31, v167
C_NOGA:
    s_waitcnt lgkmcnt(0)
    s_barrier
    s_cmp_ge_u32 s38, 8
    s_cbranch_scc1 C_NOST
    ds_read_b32 v24, v7 offset:0
    ds_read_b32 v25, v7 offset:17408
    ds_read_b32 v26, v7 offset:34816
    ds_read_b32 v28, v7 offset:2176
    ds_read_b32 v29, v7 offset:19584
    ds_read_b32 v30, v7 offset:36992
    s_waitcnt lgkmcnt(3)
    buffer_store_dwordx4 v[24:27], v8, s[40:43], s52 offen sc1
    s_waitcnt lgkmcnt(0)
    buffer_store_dwordx4 v[28:31], v8, s[40:43], s53 offen sc1
C_NOST:
    s_cmp_ge_u32 s2, 176
    s_cbranch_scc1 FFN_LATE
    s_cmp_ge_u32 s2, 128
    s_cbranch_scc1 FINAL
    v_and_b32 v7, 7, v1
    v_lshrrev_b32 v8, 3, v1
    s_mul_i32 s44, s2, 18432
    s_mul_i32 s45, s38, 96
    v_mul_u32_u24 v9, 0xe0, v7
    v_mad_u32_u24 v9, v8, 12, v9
    v_add_u32 v9, s58, v9
    v_xor_b32 v10, 1, v8
    v_mad_u32_u24 v13, v10, 12, s58
    s_mul_i32 s47, s2, 24576
    s_lshl_b32 s48, s38, 11
    s_add_u32 s47, s47, s48
    s_add_u32 s47, s47, 3211264
    v_mul_u32_u24 v84, 48, v7
    v_bfe_u32 v10, v1, 3, 1
    v_lshl_add_u32 v84, v10, 2, v84
    s_lshl_b32 s49, s69, 3
    s_add_u32 s49, s49, s71
    s_add_u32 s49, s49, 14336
    v_add_u32 v84, s49, v84
    v_mul_u32_u24 v85, 48, v1
    v_add_u32 v85, 60992, v85
    s_mov_b32 exec_lo, 0xf0000f
    s_mov_b32 exec_hi, 0xf0000f00
    v_subrev_u32 v84, 1536, v84
    s_mov_b32 exec_lo, 0xff000000
    s_mov_b32 exec_hi, 0xff0000
    v_subrev_u32 v84, 768, v84
    s_mov_b32 exec_lo, 0xff00
    s_mov_b32 exec_hi, 0xff
    v_subrev_u32 v84, 2304, v84
    s_mov_b64 exec, -1
    s_add_u32 s48, s48, 0
    v_and_b32 v10, 6, v7
    v_xor_b32 v10, v10, v8
    v_lshl_add_u32 v10, v7, 3, v10
    v_lshl_add_u32 v86, v10, 4, s48
    v_and_b32 v10, 6, v8
    v_xor_b32 v10, v10, v1
    v_lshl_add_u32 v87, v10, 4, s48
    v_mul_u32_u24 v88, 2944, v8
    v_add_u32 v88, v88, v3
    s_mul_i32 s48, s2, 24576
    s_lshl_b32 s49, s38, 7
    s_add_u32 s48, s48, s49
    s_add_u32 s48, s48, 6356992
    v_mul_u32_u24 v89, 2336, v7
    v_mad_u32_u24 v89, v8, 12, v89
    s_add_u32 s45, s45, 24576
    v_add_u32 v89, s45, v89
    v_add_u32 v10, 1536, v0
    v_add_u32 v11, 0, v0
    v_mul_u32_u24 v11, 911, v11
    v_lshrrev_b32 v11, 16, v11
    v_add_lshl_u32 v90, v10, v11, 4
    v_add_u32 v10, 2304, v0
    v_add_u32 v11, 768, v0
    v_mul_u32_u24 v11, 911, v11
    v_lshrrev_b32 v11, 16, v11
    v_add_lshl_u32 v91, v10, v11, 4
    v_lshl_add_u32 v92, v0, 4, s44
    v_bfe_u32 v10, v1, 3, 1
    v_lshl_add_u32 v10, v7, 1, v10
    s_lshl_b32 s49, s2, 4
    v_add_u32 v93, s49, v10
    v_sub_u32 v12, 0x7ff, v93
    v_lshlrev_b32 v93, 2, v93
    s_mov_b32 s49, 32768
    v_mov_b32 v51, 0
    v_mov_b32 v55, 0
    v_mov_b32 v76, 0
    v_mov_b32 v56, 0
    v_mov_b32 v57, 0
    v_mov_b32 v58, 0
    v_mov_b32 v59, 0
    v_mov_b32 v60, 0
    v_mov_b32 v61, 0
    v_mov_b32 v62, 0
    v_mov_b32 v63, 0
    s_lshl_b32 s50, s2, 6
    s_lshl_b32 s51, s38, 2
    s_add_u32 s50, s50, s51
    s_add_u32 s50, s50, 8192
    s_mov_b32 s56, 0x00100001
    s_mov_b32 s57, 0x10000100
    s_mov_b32 s58, 0xffff0000
    s_waitcnt vmcnt(0)
    buffer_load_dwordx4 v[28:31], v3, s[40:43], s47 offen sc1
    buffer_load_dwordx4 v[32:35], v3, s[40:43], s47 offen offset:1024 sc1
    ds_read_b32 v24, v13 offset:1792
    ds_read_b32 v25, v13 offset:1796
    ds_read_b32 v26, v13 offset:1800
    ds_read2_b32 v[16:17], v9 offset0:0 offset1:1
    ds_read2_b32 v[18:19], v9 offset0:2 offset1:28
    ds_read2_b32 v[20:21], v9 offset0:29 offset1:30
    s_waitcnt lgkmcnt(0)
    v_dot2c_f32_bf16 v76, 0x3f803f80, v24
    v_dot2c_f32_bf16 v76, 0x3f803f80, v25
    v_dot2c_f32_bf16 v76, 0x3f803f80, v26
    v_lshlrev_b32 v36, 16, v16
    v_and_b32 v37, 0xffff0000, v16
    v_lshlrev_b32 v42, 16, v19
    v_and_b32 v43, 0xffff0000, v19
    v_lshlrev_b32 v38, 16, v17
    v_and_b32 v39, 0xffff0000, v17
    v_lshlrev_b32 v44, 16, v20
    v_and_b32 v45, 0xffff0000, v20
    v_lshlrev_b32 v40, 16, v18
    v_and_b32 v41, 0xffff0000, v18
    v_lshlrev_b32 v46, 16, v21
    v_and_b32 v47, 0xffff0000, v21
    v_mov_b32 v77, v76
    s_nop 1
    v_permlane16_swap_b32 v76, v77
    v_add_f32 v76, v76, v77
    v_mov_b32 v77, v76
    s_nop 1
    v_permlane32_swap_b32 v76, v77
    v_add_f32 v76, v76, v77
    s_mov_b32 exec_lo, 0xf00f0
    s_mov_b32 exec_hi, 0xf00f000
    ds_write2_b32 v84, v76, v76 offset0:0 offset1:96
    s_mov_b32 exec_lo, 0xf0f0f0f
    s_mov_b32 exec_hi, 0xf0f0f0f
    v_mov_b32 v24, 0x3f803f80
    v_mov_b32 v25, 0x3f803f80
    v_mov_b32 v26, 0x3f803f80
    s_mov_b32 exec_lo, 0x11111111
    s_mov_b32 exec_hi, 0x11111111
    v_mov_b32 v56, v24
    v_mov_b32 v57, v25
    v_mov_b32 v58, v26
    s_mov_b32 exec_lo, 0x22222222
    s_mov_b32 exec_hi, 0x22222222
    v_mov_b32 v60, v24
    v_mov_b32 v61, v25
    v_mov_b32 v62, v26
    s_mov_b64 exec, -1
    s_movk_i32 s60, 4000
    s_branch L_YP_W
L_YP:
    buffer_load_dwordx4 v[28:31], v3, s[40:43], s47 offen sc1
    buffer_load_dwordx4 v[32:35], v3, s[40:43], s47 offen offset:1024 sc1
L_YP_W:
    s_waitcnt vmcnt(0)
L_YP_C:
    v_xor_b32 v10, v167, v31
    v_xor_b32 v11, v167, v35
    v_or_b32 v10, v10, v11
    v_cmp_ne_u32 vcc, 0, v10
    s_nop 0
    s_and_b64 exec, exec, vcc
    s_cbranch_execz L_YP_D
    s_sub_u32 s60, s60, 1
    s_cmp_gt_i32 s60, 0
    s_sleep 1
    s_cbranch_scc1 L_YP
L_YP_D:
    s_mov_b64 exec, -1
    v_dot2c_f32_bf16 v36, s54, v28
    v_dot2c_f32_bf16 v37, s54, v29
    v_dot2c_f32_bf16 v38, s54, v30
    v_dot2c_f32_bf16 v39, s54, v34
    v_dot2c_f32_bf16 v40, s54, v32
    v_dot2c_f32_bf16 v41, s54, v33
    v_dot2c_f32_bf16 v42, s55, v28
    v_dot2c_f32_bf16 v43, s55, v29
    v_dot2c_f32_bf16 v44, s55, v30
    v_dot2c_f32_bf16 v45, s55, v34
    v_cvt_pk_bf16_f32 v48, v36, v37
    v_dot2c_f32_bf16 v46, s55, v32
    v_cvt_pk_bf16_f32 v49, v38, v39
    v_dot2c_f32_bf16 v47, s55, v33
    v_cvt_pk_bf16_f32 v50, v40, v41
    v_cvt_pk_bf16_f32 v52, v42, v43
    v_cvt_pk_bf16_f32 v53, v44, v45
    v_mfma_f32_16x16x32_bf16 v[68:71], v[48:51], v[48:51], 0
    v_cvt_pk_bf16_f32 v54, v46, v47
    v_mfma_f32_16x16x32_bf16 v[64:67], v[56:59], v[48:51], 0
    s_nop 0
    v_mfma_f32_16x16x32_bf16 v[64:67], v[60:63], v[52:55], v[64:67]
    v_mfma_f32_16x16x32_bf16 v[72:75], v[52:55], v[52:55], 0
    v_lshlrev_b32 v36, 16, v48
    v_and_b32 v37, 0xffff0000, v48
    v_lshlrev_b32 v38, 16, v49
    v_and_b32 v39, 0xffff0000, v49
    v_lshlrev_b32 v40, 16, v50
    v_and_b32 v41, 0xffff0000, v50
    s_mov_b64 exec, s[56:57]
    v_mov_b32 v64, v68
    v_mov_b32 v65, v72
    s_lshl_b64 exec, exec, 1
    v_mov_b32 v64, v69
    v_mov_b32 v65, v73
    s_lshl_b64 exec, exec, 1
    v_mov_b32 v64, v70
    v_mov_b32 v65, v74
    s_lshl_b64 exec, exec, 1
    v_mov_b32 v64, v71
    v_mov_b32 v65, v75
    s_mov_b32 exec_lo, 0xfff0ff0f
    s_mov_b32 exec_hi, 0xf0ff0fff
    ds_write2_b32 v84, v64, v65 offset0:0 offset1:96
    s_mov_b64 exec, -1
    v_lshlrev_b32 v42, 16, v52
    v_and_b32 v43, 0xffff0000, v52
    v_lshlrev_b32 v44, 16, v53
    v_and_b32 v45, 0xffff0000, v53
    v_lshlrev_b32 v46, 16, v54
    v_and_b32 v47, 0xffff0000, v54
    s_cmp_eq_u32 s38, 0
    s_cbranch_scc0 L_NP
    s_setprio 3
L_NP:
    s_waitcnt lgkmcnt(0)
    s_barrier
    ds_read_b128 v[52:55], v85 offset:0
    ds_read_b128 v[56:59], v85 offset:16
    ds_read_b128 v[60:63], v85 offset:17408
    ds_read_b128 v[64:67], v85 offset:17424
    ds_read_b128 v[68:71], v85 offset:34816
    ds_read_b128 v[72:75], v85 offset:34832
    s_waitcnt lgkmcnt(4)
    s_waitcnt lgkmcnt(2)
    v_pk_add_f32 v[52:53], v[52:53], v[60:61]
    v_pk_add_f32 v[54:55], v[54:55], v[62:63]
    v_pk_add_f32 v[56:57], v[56:57], v[64:65]
    v_pk_add_f32 v[58:59], v[58:59], v[66:67]
    s_waitcnt lgkmcnt(0)
    v_pk_add_f32 v[52:53], v[52:53], v[68:69]
    v_pk_add_f32 v[54:55], v[54:55], v[70:71]
    v_pk_add_f32 v[56:57], v[56:57], v[72:73]
    v_pk_add_f32 v[58:59], v[58:59], v[74:75]
    v_pk_add_f32 v[52:53], v[52:53], v[54:55]
    v_pk_add_f32 v[56:57], v[56:57], v[58:59]
    v_pk_add_f32 v[52:53], v[52:53], v[56:57]
    v_add_f32 v76, v52, v53
    v_add_f32 v78, v52, v53
    s_nop 1
    v_permlane16_swap_b32 v76, v78
    v_mov_b32 v77, v76
    v_mov_b32 v13, v78
    s_nop 0
    v_permlane32_swap_b32 v76, v77
    v_permlane32_swap_b32 v78, v13
    v_mul_f32 v76, 0x3ae38e39, v76
    v_mul_f32 v78, 0x3ae38e39, v78
    v_fma_f32 v78, -v76, v76, v78
    v_max_f32 v78, 0, v78
    v_cvt_pk_bf16_f32 v78, v76, v78
    v_and_b32 v82, 0xffff0000, v78
    v_lshlrev_b32 v80, 16, v78
    v_add_f32 v82, 0x3727c5ac, v82
    v_lshlrev_b32 v81, 16, v78
    v_cvt_pk_bf16_f32 v82, v82, v82
    v_lshlrev_b32 v82, 16, v82
    v_sqrt_f32 v82, v82
    v_fma_f32 v77, -v80, v13, v77
    v_cvt_pk_bf16_f32 v82, v82, v82
    v_lshlrev_b32 v82, 16, v82
    v_rcp_f32 v83, v82
    v_rcp_f32 v82, v82
    s_cbranch_scc0 L_NK
    v_mul_f32 v77, v77, v83
    v_cvt_pk_bf16_f32 v77, v77, v77
    v_ashrrev_i32 v76, 31, v77
    v_or_b32 v76, 0x80000000, v76
    v_xor_b32 v76, v76, v77
    v_and_or_b32 v76, v76, s58, v12
    s_mov_b64 exec, 0xffff
    buffer_store_dword v76, v93, s[40:43], s49 offen sc1
    s_mov_b64 exec, -1
    s_setprio 0
L_NK:
    v_mov_b32_dpp v80, v80 row_ror:8 row_mask:0xf bank_mask:0xc
    v_mov_b32_dpp v81, v81 row_ror:8 row_mask:0xf bank_mask:0x3
    v_mov_b32_dpp v82, v82 row_ror:8 row_mask:0xf bank_mask:0xc
    v_mov_b32_dpp v83, v83 row_ror:8 row_mask:0xf bank_mask:0x3
    v_pk_add_f32 v[56:57], v[36:37], v[80:81] op_sel_hi:[1,0] neg_lo:[0,1] neg_hi:[0,1]
    v_pk_add_f32 v[58:59], v[38:39], v[80:81] op_sel_hi:[1,0] neg_lo:[0,1] neg_hi:[0,1]
    v_pk_add_f32 v[60:61], v[40:41], v[80:81] op_sel_hi:[1,0] neg_lo:[0,1] neg_hi:[0,1]
    v_pk_add_f32 v[62:63], v[42:43], v[80:81] op_sel:[0,1] neg_lo:[0,1] neg_hi:[0,1]
    v_pk_add_f32 v[64:65], v[44:45], v[80:81] op_sel:[0,1] neg_lo:[0,1] neg_hi:[0,1]
    v_pk_add_f32 v[66:67], v[46:47], v[80:81] op_sel:[0,1] neg_lo:[0,1] neg_hi:[0,1]
    v_cvt_pk_bf16_f32 v57, v56, v57
    v_cvt_pk_bf16_f32 v59, v58, v59
    v_cvt_pk_bf16_f32 v61, v60, v61
    v_cvt_pk_bf16_f32 v63, v62, v63
    v_cvt_pk_bf16_f32 v65, v64, v65
    v_cvt_pk_bf16_f32 v67, v66, v67
    v_lshlrev_b32 v56, 16, v57
    v_and_b32 v57, 0xffff0000, v57
    v_lshlrev_b32 v58, 16, v59
    v_and_b32 v59, 0xffff0000, v59
    v_lshlrev_b32 v60, 16, v61
    v_and_b32 v61, 0xffff0000, v61
    v_lshlrev_b32 v62, 16, v63
    v_and_b32 v63, 0xffff0000, v63
    v_lshlrev_b32 v64, 16, v65
    v_and_b32 v65, 0xffff0000, v65
    v_lshlrev_b32 v66, 16, v67
    v_and_b32 v67, 0xffff0000, v67
    v_pk_mul_f32 v[56:57], v[56:57], v[82:83] op_sel_hi:[1,0]
    v_pk_mul_f32 v[58:59], v[58:59], v[82:83] op_sel_hi:[1,0]
    v_pk_mul_f32 v[60:61], v[60:61], v[82:83] op_sel_hi:[1,0]
    v_pk_mul_f32 v[62:63], v[62:63], v[82:83] op_sel:[0,1]
    v_pk_mul_f32 v[64:65], v[64:65], v[82:83] op_sel:[0,1]
    v_pk_mul_f32 v[66:67], v[66:67], v[82:83] op_sel:[0,1]
    v_cvt_pk_bf16_f32 v28, v56, v57
    v_cvt_pk_bf16_f32 v29, v58, v59
    v_cvt_pk_bf16_f32 v30, v60, v61
    ds_write_b128 v86, v[28:31]
    v_cvt_pk_bf16_f32 v32, v62, v63
    v_cvt_pk_bf16_f32 v33, v64, v65
    v_cvt_pk_bf16_f32 v34, v66, v67
    ds_write_b128 v86, v[32:35] offset:1024
    ds_read_b128 v[56:59], v87
    ds_read_b128 v[60:63], v87 offset:1024
    v_dot2c_f32_bf16 v36, s54, v28
    v_dot2c_f32_bf16 v37, s55, v28
    v_dot2c_f32_bf16 v38, s54, v29
    v_dot2c_f32_bf16 v39, s55, v29
    v_dot2c_f32_bf16 v40, s54, v30
    v_dot2c_f32_bf16 v41, s55, v30
    v_dot2c_f32_bf16 v42, s54, v32
    v_dot2c_f32_bf16 v43, s55, v32
    v_dot2c_f32_bf16 v44, s54, v33
    v_dot2c_f32_bf16 v45, s55, v33
    v_dot2c_f32_bf16 v46, s54, v34
    v_dot2c_f32_bf16 v47, s55, v34
    s_waitcnt lgkmcnt(1)
    buffer_store_dwordx4 v[56:59], v88, s[40:43], s48 offen sc1
    s_waitcnt lgkmcnt(0)
    buffer_store_dwordx4 v[60:63], v88, s[40:43], s48 offen offset:1536 sc1
    v_cvt_pk_bf16_f32 v48, v36, v37
    v_cvt_pk_bf16_f32 v49, v38, v39
    v_cvt_pk_bf16_f32 v50, v40, v41
    v_cvt_pk_bf16_f32 v51, v42, v43
    v_cvt_pk_bf16_f32 v52, v44, v45
    v_cvt_pk_bf16_f32 v53, v46, v47
    v_add_u32 v10, 1168, v89
    ds_write2_b32 v89, v48, v49 offset0:0 offset1:1
    ds_write_b32 v89, v50 offset:8
    ds_write2_b32 v10, v51, v52 offset0:0 offset1:1
    ds_write_b32 v10, v53 offset:8
    v_add_u32 v11, 12288, v92
    s_waitcnt lgkmcnt(0)
    s_barrier
    ds_read_b128 v[16:19], v90
    ds_read_b128 v[20:23], v91
    v_mov_b32 v10, 0
    s_waitcnt lgkmcnt(1)
    global_store_dwordx4 v92, v[16:19], s[32:33] sc1
    s_cmp_ge_u32 s38, 6
    s_cbranch_scc1 L_O1
    s_waitcnt lgkmcnt(0)
    global_store_dwordx4 v11, v[20:23], s[32:33] sc1
L_O1:
    s_cmp_eq_u32 s38, 11
    s_cbranch_scc1 TOP8
    s_waitcnt vmcnt(0)
    s_mov_b64 exec, 0x1
    buffer_store_dword v167, v10, s[40:43], s50 offen sc1
    s_mov_b64 exec, -1
    s_branch END
FFN_DMA0:
    s_sub_u32 s58, s2, 192
    s_lshl_b32 s61, s58, 1
    s_mov_b32 s59, 8
    s_mov_b32 s57, 73728
    s_add_u32 s56, s38, 1
    s_bfe_u32 s50, s56, 0x10003
    s_and_b32 s51, s56, 1
    s_bfe_u32 s52, s56, 0x10001
    s_mul_i32 s52, s52, 36
    s_add_u32 s52, s52, s51
    s_mul_i32 s48, s52, 73728
    s_lshl_b32 s53, s61, 6
    s_add_u32 s48, s48, s53
    s_lshl_b32 s49, s52, 10
    s_mul_i32 s53, s50, 73728
    s_add_u32 s49, s49, s53
    s_lshl_b32 s51, s51, 1
    s_lshl_b32 s53, s50, 2
    s_or_b32 s51, s51, s53
    v_bfe_u32 v2, v1, 4, 1
    v_and_b32 v4, 7, v1
    v_xor_b32 v2, v2, v4
    v_xor_b32 v2, s51, v2
    v_lshrrev_b32 v4, 3, v1
    v_mul_u32_u24 v4, 0x2400, v4
    v_lshl_add_u32 v2, v2, 4, v4
    s_mov_b32 s46, 5308416
    s_mov_b32 s47, 0x00020000
    s_waitcnt lgkmcnt(0)
    s_cmp_eq_u32 s50, 0
    s_cselect_b32 s44, s26, s28
    s_cselect_b32 s45, s27, s29
    s_mov_b32 s40, s36
    s_mov_b32 s41, s37
    s_barrier
    s_sub_u32 s51, s38, 3
    s_cmp_ge_u32 s51, 8
    s_cbranch_scc1 F_B0
    s_add_u32 m0, s49, 0
    s_add_u32 s53, s48, 0
    buffer_load_dwordx4 v2, s[44:47], s53 offen lds
    s_add_u32 m0, s49, 2048
    s_add_u32 s53, s48, 147456
    buffer_load_dwordx4 v2, s[44:47], s53 offen lds
    s_barrier
    s_branch F_B2
FFN_LATE:
    s_and_b32 s61, s2, 7
    s_lshl_b32 s61, s61, 1
    s_bitcmp0_b32 s2, 3
    s_addc_u32 s61, s61, 128
    s_sub_u32 s58, s2, 112
    s_mov_b32 s59, 4
    s_mov_b32 s57, 0
    v_mov_b32 v32, 0
    v_mov_b32 v33, 0
    v_mov_b32 v34, 0
    v_mov_b32 v35, 0
    v_mov_b32 v36, 0
    v_mov_b32 v37, 0
    v_mov_b32 v38, 0
    v_mov_b32 v39, 0
    v_mov_b32 v40, 0
    v_mov_b32 v41, 0
    v_mov_b32 v42, 0
    v_mov_b32 v43, 0
    v_mov_b32 v44, 0
    v_mov_b32 v45, 0
    v_mov_b32 v46, 0
    v_mov_b32 v47, 0
    s_sub_u32 s51, s38, 3
    s_cmp_ge_u32 s51, 8
    s_cbranch_scc1 F_B0
    s_add_u32 s56, s38, 1
    s_bfe_u32 s50, s56, 0x10003
    s_and_b32 s51, s56, 1
    s_bfe_u32 s52, s56, 0x10001
    s_lshl1_add_u32 s52, s50, s52
    s_mul_i32 s52, s52, 18
    s_add_u32 s52, s52, s51
    s_mul_i32 s48, s52, 73728
    s_lshl_b32 s53, s61, 6
    s_add_u32 s48, s48, s53
    s_lshl_b32 m0, s52, 10
    s_lshl_b32 s51, s51, 1
    s_add_u32 s44, s26, s48
    s_addc_u32 s45, s27, 0
    s_add_u32 s46, s28, s48
    s_addc_u32 s47, s29, 0
    v_bfe_u32 v2, v1, 4, 1
    v_xor_b32 v2, v2, v1
    v_xor_b32 v2, s51, v2
    v_and_b32 v2, 3, v2
    v_lshrrev_b32 v4, 3, v1
    v_mul_u32_u24 v4, 0x2400, v4
    v_lshl_add_u32 v2, v2, 4, v4
    v_mov_b32 v4, s44
    v_mov_b32 v5, s45
    s_mov_b32 exec_lo, 0xf0f0f0f0
    s_mov_b32 exec_hi, 0xf0f0f0f0
    v_mov_b32 v4, s46
    v_mov_b32 v5, s47
    s_mov_b64 exec, -1
    v_add_co_u32 v4, vcc, v4, v2
    s_nop 1
    v_addc_co_u32 v5, vcc, 0, v5, vcc
    s_barrier
    global_load_lds_dwordx4 v[4:5], off
    v_add_co_u32 v4, vcc, 147456, v4
    s_add_u32 m0, m0, 2048
    s_nop 0
    v_addc_co_u32 v5, vcc, 0, v5, vcc
    global_load_lds_dwordx4 v[4:5], off
    v_add_co_u32 v4, vcc, 147456, v4
    s_add_u32 m0, m0, 2048
    s_nop 0
    v_addc_co_u32 v5, vcc, 0, v5, vcc
    global_load_lds_dwordx4 v[4:5], off
    v_add_co_u32 v4, vcc, 147456, v4
    s_add_u32 m0, m0, 2048
    s_nop 0
    v_addc_co_u32 v5, vcc, 0, v5, vcc
    global_load_lds_dwordx4 v[4:5], off
    v_add_co_u32 v4, vcc, 147456, v4
    s_add_u32 m0, m0, 2048
    s_nop 0
    v_addc_co_u32 v5, vcc, 0, v5, vcc
    global_load_lds_dwordx4 v[4:5], off
    v_add_co_u32 v4, vcc, 147456, v4
    s_add_u32 m0, m0, 2048
    s_nop 0
    v_addc_co_u32 v5, vcc, 0, v5, vcc
    global_load_lds_dwordx4 v[4:5], off
    v_add_co_u32 v4, vcc, 147456, v4
    s_add_u32 m0, m0, 2048
    s_nop 0
    v_addc_co_u32 v5, vcc, 0, v5, vcc
    global_load_lds_dwordx4 v[4:5], off
    v_add_co_u32 v4, vcc, 147456, v4
    s_add_u32 m0, m0, 2048
    s_nop 0
    v_addc_co_u32 v5, vcc, 0, v5, vcc
    global_load_lds_dwordx4 v[4:5], off
    v_add_co_u32 v4, vcc, 147456, v4
    s_add_u32 m0, m0, 2048
    s_nop 0
    v_addc_co_u32 v5, vcc, 0, v5, vcc
    global_load_lds_dwordx4 v[4:5], off
    s_branch F_W
F_L2:
    s_sub_u32 s51, s38, 3
    s_cmp_ge_u32 s51, 8
    s_cbranch_scc1 F_B0
    s_add_u32 s56, s38, 1
    s_bfe_u32 s50, s56, 0x10003
    s_and_b32 s51, s56, 1
    s_bfe_u32 s52, s56, 0x10001
    s_mul_i32 s52, s52, 36
    s_add_u32 s52, s52, s51
    s_mul_i32 s48, s52, 73728
    s_lshl_b32 s53, s61, 6
    s_add_u32 s48, s48, s53
    s_lshl_b32 s49, s52, 10
    s_mul_i32 s53, s50, 73728
    s_add_u32 s49, s49, s53
    s_lshl_b32 s51, s51, 1
    s_lshl_b32 s53, s50, 2
    s_or_b32 s51, s51, s53
    v_bfe_u32 v2, v1, 4, 1
    v_and_b32 v4, 7, v1
    v_xor_b32 v2, v2, v4
    v_xor_b32 v2, s51, v2
    v_lshrrev_b32 v4, 3, v1
    v_mul_u32_u24 v4, 0x2400, v4
    v_lshl_add_u32 v2, v2, 4, v4
    s_mov_b32 s46, 5308416
    s_mov_b32 s47, 0x00020000
    s_cmp_eq_u32 s50, 0
    s_cselect_b32 s44, s26, s28
    s_cselect_b32 s45, s27, s29
    s_barrier
    s_add_u32 m0, s49, 0
    s_add_u32 s53, s48, 0
    buffer_load_dwordx4 v2, s[44:47], s53 offen lds
    s_add_u32 m0, s49, 2048
    s_add_u32 s53, s48, 147456
    buffer_load_dwordx4 v2, s[44:47], s53 offen lds
F_B2:
    s_add_u32 m0, s49, 4096
    s_add_u32 s53, s48, 294912
    buffer_load_dwordx4 v2, s[44:47], s53 offen lds
    s_add_u32 m0, s49, 6144
    s_add_u32 s53, s48, 442368
    buffer_load_dwordx4 v2, s[44:47], s53 offen lds
    s_add_u32 m0, s49, 8192
    s_add_u32 s53, s48, 589824
    buffer_load_dwordx4 v2, s[44:47], s53 offen lds
    s_add_u32 m0, s49, 10240
    s_add_u32 s53, s48, 737280
    buffer_load_dwordx4 v2, s[44:47], s53 offen lds
    s_add_u32 m0, s49, 12288
    s_add_u32 s53, s48, 884736
    buffer_load_dwordx4 v2, s[44:47], s53 offen lds
    s_add_u32 m0, s49, 14336
    s_add_u32 s53, s48, 1032192
    buffer_load_dwordx4 v2, s[44:47], s53 offen lds
    s_add_u32 m0, s49, 16384
    s_add_u32 s53, s48, 1179648
    buffer_load_dwordx4 v2, s[44:47], s53 offen lds
    s_add_u32 m0, s49, 18432
    s_add_u32 s53, s48, 1327104
    buffer_load_dwordx4 v2, s[44:47], s53 offen lds
    s_add_u32 m0, s49, 20480
    s_add_u32 s53, s48, 1474560
    buffer_load_dwordx4 v2, s[44:47], s53 offen lds
    s_add_u32 m0, s49, 22528
    s_add_u32 s53, s48, 1622016
    buffer_load_dwordx4 v2, s[44:47], s53 offen lds
    s_add_u32 m0, s49, 24576
    s_add_u32 s53, s48, 1769472
    buffer_load_dwordx4 v2, s[44:47], s53 offen lds
    s_add_u32 m0, s49, 26624
    s_add_u32 s53, s48, 1916928
    buffer_load_dwordx4 v2, s[44:47], s53 offen lds
    s_add_u32 m0, s49, 28672
    s_add_u32 s53, s48, 2064384
    buffer_load_dwordx4 v2, s[44:47], s53 offen lds
    s_add_u32 m0, s49, 30720
    s_add_u32 s53, s48, 2211840
    buffer_load_dwordx4 v2, s[44:47], s53 offen lds
    s_add_u32 m0, s49, 32768
    s_add_u32 s53, s48, 2359296
    buffer_load_dwordx4 v2, s[44:47], s53 offen lds
    s_add_u32 m0, s49, 34816
    s_add_u32 s53, s48, 2506752
    buffer_load_dwordx4 v2, s[44:47], s53 offen lds
    s_branch F_W
FFN_DMA:
    s_setprio 0
    s_sub_u32 s58, s2, 192
    s_lshl_b32 s61, s58, 1
    s_mov_b32 s59, 8
    s_mov_b32 s57, 73728
    s_waitcnt vmcnt(0)
    s_branch F_L2
F_B0:
    s_setprio 3
    s_barrier
F_W:
    s_mov_b64 exec, -1
    v_mov_b32 v167, 156684
    ds_read_b32 v167, v167
    v_and_b32 v7, 7, v1
    v_lshrrev_b32 v8, 3, v1
    v_and_b32 v5, 15, v1
    v_lshrrev_b32 v6, 4, v1
    s_mul_i32 s52, s61, 36864
    s_mul_i32 s53, s38, 96
    s_add_u32 s52, s52, s53
    v_mul_u32_u24 v9, 0x480, v8
    v_mad_u32_u24 v9, v7, 12, v9
    v_add_u32 v9, s52, v9
    global_load_dwordx3 v[16:18], v9, s[30:31]
    v_add_u32 v9, 0x2400, v9
    global_load_dwordx3 v[20:22], v9, s[30:31]
    v_add_u32 v9, 0x2400, v9
    global_load_dwordx3 v[24:26], v9, s[30:31]
    v_add_u32 v9, 0x2400, v9
    global_load_dwordx3 v[28:30], v9, s[30:31]
    v_add_u32 v9, 0x2400, v9
    s_cmp_eq_u32 s59, 4
    s_cbranch_scc1 F_W4
    global_load_dwordx3 v[32:34], v9, s[30:31]
    v_add_u32 v9, 0x2400, v9
    global_load_dwordx3 v[36:38], v9, s[30:31]
    v_add_u32 v9, 0x2400, v9
    global_load_dwordx3 v[40:42], v9, s[30:31]
    v_add_u32 v9, 0x2400, v9
    global_load_dwordx3 v[44:46], v9, s[30:31]
F_W4:
    v_mul_u32_u24 v10, 683, v0
    v_lshrrev_b32 v10, 16, v10
    v_mul_u32_u24 v11, 0x60, v10
    v_sub_u32 v11, v0, v11
    s_mov_b32 s52, 161920
    v_lshl_add_u32 v160, v10, 2, s52
    v_and_b32 v63, 4, v10
    v_lshl_add_u32 v160, v63, 2, v160
    v_mov_b32 v63, 161492
    s_mov_b32 s52, 3144192
    v_lshl_add_u32 v161, v11, 4, s52
    v_mul_u32_u24 v162, 608, v10
    v_mad_u32_u24 v162, v11, 6, v162
    v_and_b32 v11, 1, v11
    v_mul_u32_u24 v11, 4862, v11
    v_sub_u32 v2, v162, v11
    v_add_u32 v2, 152320, v2
    v_add_u32 v162, 147456, v162
    v_add_u32 v162, v11, v162
    v_mul_u32_u24 v163, 608, v5
    v_lshl_add_u32 v163, v6, 4, v163
    v_add_u32 v163, 147456, v163
    s_lshr_b32 s52, s38, 2
    s_lshl_b32 s52, s52, 10
    s_and_b32 s53, s38, 3
    s_lshl_b32 s53, s53, 2
    s_add_u32 s52, s52, s53
    s_add_u32 s52, s52, 157184
    v_add_u32 v164, s52, v3
    v_mov_b32 v10, 0
    ds_write_b32 v164, v10
    v_add_u32 v60, 157184, v3
    v_xor_b32 v61, 0x80, v60
    v_and_b32 v10, 6, v1
    v_and_b32 v11, 9, v1
    v_lshl_add_u32 v164, v10, 7, s52
    v_lshl_add_u32 v164, v11, 1, v164
    v_and_b32 v10, 16, v1
    v_and_b32 v11, 32, v1
    v_lshl_add_u32 v164, v10, 2, v164
    v_add_u32 v164, v11, v164
    v_and_b32 v10, 1, v6
    v_mul_u32_u24 v10, 0x48, v10
    v_and_b32 v11, 1, v8
    v_add3_u32 v166, v10, v11, 2
    v_lshl_add_u32 v10, v11, 2, v10
    v_lshrrev_b32 v11, 1, v6
    v_add_u32 v165, v10, v11
    v_mul_u32_u24 v165, 10240, v165
    v_mul_u32_u24 v166, 10240, v166
    v_lshl_add_u32 v165, v7, 4, v165
    v_lshl_add_u32 v166, v7, 4, v166
    s_mul_i32 s62, s38, 61440
    s_lshl_b32 s53, s58, 7
    s_add_u32 s62, s62, s53
    s_add_u32 s62, s62, 9502720
    s_mov_b32 s63, 6356992
    s_add_u32 s69, s53, 16384
    s_cmp_eq_u32 s38, 0
    s_cselect_b32 s70, 1, 0
    s_mov_b32 s71, 0
    s_movk_i32 s64, -1536
    v_bfe_u32 v10, v1, 1, 1
    v_bfe_u32 v11, v1, 3, 2
    v_lshl_add_u32 v11, v10, 2, v11
    v_xor_b32 v11, s38, v11
    v_mul_u32_u24 v12, s57, v10
    v_lshl_add_u32 v12, v11, 4, v12
    v_and_b32 v10, 1, v1
    v_lshl_add_u32 v12, v10, 3, v12
    v_bfe_u32 v10, v1, 2, 2
    v_lshl_add_u32 v10, v6, 3, v10
    v_lshl_add_u32 v12, v10, 7, v12
    v_add_u32 v13, 36864, v12
    v_mov_b32 v14, 161488
    v_mov_b32 v15, 1
    s_mov_b32 s52, 0x05040100
    s_mov_b32 s53, 0x07060302
    v_mov_b32 v10, s52
    v_mov_b32 v4, 0x05040c0c
    v_mov_b32 v5, 0x01000c0c
    v_mov_b32 v6, 0x44444444
    s_mov_b32 exec_lo, 0xff00ff00
    s_mov_b32 exec_hi, 0xff00ff00
    v_mov_b32 v10, 0x03020706
    v_mov_b32 v4, 0x03020c0c
    v_mov_b32 v5, 0x07060c0c
    v_mov_b32 v6, 0xeeeeeeee
    s_mov_b64 exec, -1
    s_waitcnt lgkmcnt(0)
    v_readfirstlane_b32 s39, v167
    s_cmp_eq_u32 s59, 4
    s_cbranch_scc0 F_W8
    s_waitcnt vmcnt(0)
F_W8:
    s_sub_u32 s51, s38, 3
    s_cmp_ge_u32 s51, 8
    s_cbranch_scc1 F_NC
    s_waitcnt vmcnt(8)
    s_mov_b64 exec, 0x1
    ds_add_u32 v14, v15
    s_mov_b64 exec, -1
F_NC:
    s_waitcnt vmcnt(7)
    v_mov_b32 v19, v16
    v_mov_b32_dpp v11, v17 row_ror:8 row_mask:0xf bank_mask:0xf
    v_mov_b32_dpp v16, v18 row_ror:8 row_mask:0xf bank_mask:0xc
    v_mov_b32_dpp v18, v19 row_ror:8 row_mask:0xf bank_mask:0x3
    v_perm_b32 v152, v11, v17, v10
    v_perm_b32 v136, v18, v16, s52
    v_perm_b32 v144, v18, v16, s53
    s_waitcnt vmcnt(6)
    v_mov_b32 v23, v20
    v_mov_b32_dpp v11, v21 row_ror:8 row_mask:0xf bank_mask:0xf
    v_mov_b32_dpp v20, v22 row_ror:8 row_mask:0xf bank_mask:0xc
    v_mov_b32_dpp v22, v23 row_ror:8 row_mask:0xf bank_mask:0x3
    v_perm_b32 v153, v11, v21, v10
    v_perm_b32 v137, v22, v20, s52
    v_perm_b32 v145, v22, v20, s53
    s_waitcnt vmcnt(5)
    v_mov_b32 v27, v24
    v_mov_b32_dpp v11, v25 row_ror:8 row_mask:0xf bank_mask:0xf
    v_mov_b32_dpp v24, v26 row_ror:8 row_mask:0xf bank_mask:0xc
    v_mov_b32_dpp v26, v27 row_ror:8 row_mask:0xf bank_mask:0x3
    v_perm_b32 v154, v11, v25, v10
    v_perm_b32 v138, v26, v24, s52
    v_perm_b32 v146, v26, v24, s53
    s_waitcnt vmcnt(4)
    v_mov_b32 v31, v28
    v_mov_b32_dpp v11, v29 row_ror:8 row_mask:0xf bank_mask:0xf
    v_mov_b32_dpp v28, v30 row_ror:8 row_mask:0xf bank_mask:0xc
    v_mov_b32_dpp v30, v31 row_ror:8 row_mask:0xf bank_mask:0x3
    v_perm_b32 v155, v11, v29, v10
    v_perm_b32 v139, v30, v28, s52
    v_perm_b32 v147, v30, v28, s53
    s_waitcnt vmcnt(3)
    v_mov_b32 v35, v32
    v_mov_b32_dpp v11, v33 row_ror:8 row_mask:0xf bank_mask:0xf
    v_mov_b32_dpp v32, v34 row_ror:8 row_mask:0xf bank_mask:0xc
    v_mov_b32_dpp v34, v35 row_ror:8 row_mask:0xf bank_mask:0x3
    v_perm_b32 v156, v11, v33, v10
    v_perm_b32 v140, v34, v32, s52
    v_perm_b32 v148, v34, v32, s53
    s_waitcnt vmcnt(2)
    v_mov_b32 v39, v36
    v_mov_b32_dpp v11, v37 row_ror:8 row_mask:0xf bank_mask:0xf
    v_mov_b32_dpp v36, v38 row_ror:8 row_mask:0xf bank_mask:0xc
    v_mov_b32_dpp v38, v39 row_ror:8 row_mask:0xf bank_mask:0x3
    v_perm_b32 v157, v11, v37, v10
    v_perm_b32 v141, v38, v36, s52
    v_perm_b32 v149, v38, v36, s53
    s_waitcnt vmcnt(1)
    v_mov_b32 v43, v40
    v_mov_b32_dpp v11, v41 row_ror:8 row_mask:0xf bank_mask:0xf
    v_mov_b32_dpp v40, v42 row_ror:8 row_mask:0xf bank_mask:0xc
    v_mov_b32_dpp v42, v43 row_ror:8 row_mask:0xf bank_mask:0x3
    v_perm_b32 v158, v11, v41, v10
    v_perm_b32 v142, v42, v40, s52
    v_perm_b32 v150, v42, v40, s53
    s_waitcnt vmcnt(0)
    v_mov_b32 v47, v44
    v_mov_b32_dpp v11, v45 row_ror:8 row_mask:0xf bank_mask:0xf
    v_mov_b32_dpp v44, v46 row_ror:8 row_mask:0xf bank_mask:0xc
    v_mov_b32_dpp v46, v47 row_ror:8 row_mask:0xf bank_mask:0x3
    v_perm_b32 v159, v11, v45, v10
    v_perm_b32 v143, v46, v44, s52
    v_perm_b32 v151, v46, v44, s53
    s_cmp_ge_u32 s38, s59
    s_cbranch_scc1 F_NT
    s_movk_i32 s60, 4000
F_CP:
    ds_read_b32 v15, v14
    s_sub_u32 s60, s60, 1
    s_cmp_gt_i32 s60, 0
    s_waitcnt lgkmcnt(0)
    v_readfirstlane_b32 s52, v15
    s_nop 0
    s_cselect_b32 s52, s52, 8
    s_cmp_eq_u32 s52, 8
    s_cbranch_scc1 F_CD
    s_sleep 2
    s_branch F_CP
F_CD:
    ds_read_b64_tr_b16 v[64:65], v12 offset:0
    ds_read_b64_tr_b16 v[66:67], v12 offset:512
    ds_read_b64_tr_b16 v[68:69], v12 offset:4096
    ds_read_b64_tr_b16 v[70:71], v12 offset:4608
    ds_read_b64_tr_b16 v[72:73], v12 offset:8192
    ds_read_b64_tr_b16 v[74:75], v12 offset:8704
    ds_read_b64_tr_b16 v[76:77], v12 offset:12288
    ds_read_b64_tr_b16 v[78:79], v12 offset:12800
    ds_read_b64_tr_b16 v[80:81], v12 offset:16384
    ds_read_b64_tr_b16 v[82:83], v12 offset:16896
    ds_read_b64_tr_b16 v[84:85], v12 offset:20480
    ds_read_b64_tr_b16 v[86:87], v12 offset:20992
    ds_read_b64_tr_b16 v[88:89], v12 offset:24576
    ds_read_b64_tr_b16 v[90:91], v12 offset:25088
    ds_read_b64_tr_b16 v[92:93], v12 offset:28672
    ds_read_b64_tr_b16 v[94:95], v12 offset:29184
    ds_read_b64_tr_b16 v[96:97], v12 offset:32768
    ds_read_b64_tr_b16 v[98:99], v12 offset:33280
    ds_read_b64_tr_b16 v[100:101], v13 offset:0
    ds_read_b64_tr_b16 v[102:103], v13 offset:512
    ds_read_b64_tr_b16 v[104:105], v13 offset:4096
    ds_read_b64_tr_b16 v[106:107], v13 offset:4608
    ds_read_b64_tr_b16 v[108:109], v13 offset:8192
    ds_read_b64_tr_b16 v[110:111], v13 offset:8704
    ds_read_b64_tr_b16 v[112:113], v13 offset:12288
    ds_read_b64_tr_b16 v[114:115], v13 offset:12800
    ds_read_b64_tr_b16 v[116:117], v13 offset:16384
    ds_read_b64_tr_b16 v[118:119], v13 offset:16896
    ds_read_b64_tr_b16 v[120:121], v13 offset:20480
    ds_read_b64_tr_b16 v[122:123], v13 offset:20992
    ds_read_b64_tr_b16 v[124:125], v13 offset:24576
    ds_read_b64_tr_b16 v[126:127], v13 offset:25088
    ds_read_b64_tr_b16 v[128:129], v13 offset:28672
    ds_read_b64_tr_b16 v[130:131], v13 offset:29184
    ds_read_b64_tr_b16 v[132:133], v13 offset:32768
    ds_read_b64_tr_b16 v[134:135], v13 offset:33280
    s_waitcnt lgkmcnt(0)
    v_mov_b32 v12, 0
    v_mov_b32 v13, 0
    v_mov_b32 v14, 0
    v_mov_b32 v15, 0
F_NT:
    s_cmp_lg_u32 s38, 11
    s_cbranch_scc1 F_SEL
    s_branch T_EV
FINAL:
    s_cmp_ge_u32 s2, 144
    s_cbranch_scc1 END
    s_cmp_lg_u32 s38, 11
    s_cbranch_scc1 END
T_EV:
TOP8:
    v_bfe_i32 v7, v1, 0, 1
    v_bfe_i32 v8, v1, 1, 1
    v_bfe_i32 v9, v1, 3, 1
    v_bfe_i32 v11, v1, 4, 1
    v_bfe_i32 v13, v1, 5, 1
    v_xor_b32 v48, v7, v8
    v_xor_b32 v49, v8, v9
    v_xor_b32 v50, v7, v9
    v_xor_b32 v11, v11, v13
    v_xor_b32 v51, v9, v11
    v_xor_b32 v52, v8, v11
    v_xor_b32 v53, v7, v11
    v_mov_b32 v63, 161492
    v_lshl_add_u32 v13, v1, 2, v63
    v_add_u32 v13, 428, v13
    v_sub_u32 v54, 148464, v3
    v_and_b32 v7, 4, v1
    v_and_b32 v8, 48, v1
    v_lshlrev_b32 v8, 6, v8
    v_lshl_add_u32 v55, v7, 1, v8
    v_add_u32 v55, 147456, v55
    s_mov_b32 s65, 32768
    s_mov_b32 s66, 36864
    s_and_b32 s67, s2, 127
    s_lshl_b32 s68, s67, 6
    s_add_u32 s68, s68, 32768
    v_mov_b32 v10, 0
    s_cmp_lt_u32 s2, 128
    s_cbranch_scc0 T_E2
    s_mov_b64 exec, 0x1
    buffer_load_dword v11, v10, s[40:43], s68 offen sc1
    s_movk_i32 s60, 4000
    s_waitcnt vmcnt(0)
    buffer_store_dword v167, v10, s[40:43], s50 offen sc1
    s_branch T_HP_C
T_E2:
    v_mov_b32 v16, -1
    v_mov_b32 v17, -1
    v_mov_b32 v18, -1
    v_mov_b32 v19, -1
    v_mov_b32 v20, -1
    v_mov_b32 v21, -1
    v_mov_b32 v22, -1
    v_mov_b32 v23, -1
    v_mov_b32 v24, -1
    v_mov_b32 v25, -1
    v_mov_b32 v26, -1
    v_mov_b32 v27, -1
    v_mov_b32 v28, -1
    v_mov_b32 v29, -1
    v_mov_b32 v30, -1
    v_mov_b32 v31, -1
    v_mov_b32 v32, -1
    v_mov_b32 v33, -1
    v_mov_b32 v34, -1
    v_mov_b32 v35, -1
    v_mov_b32 v36, -1
    v_mov_b32 v37, -1
    v_mov_b32 v38, -1
    v_mov_b32 v39, -1
    v_mov_b32 v40, -1
    v_mov_b32 v41, -1
    v_mov_b32 v42, -1
    v_mov_b32 v43, -1
    v_mov_b32 v44, -1
    v_mov_b32 v45, -1
    v_mov_b32 v46, -1
    v_mov_b32 v47, -1
    s_mul_i32 s67, s67, 24576
    s_add_u32 s67, s67, 3230092
    s_mov_b64 exec, 0x1
    s_movk_i32 s60, 4000
T_EP:
    buffer_load_dword v11, v10, s[40:43], s67 offen sc1
T_EP_W:
    s_waitcnt vmcnt(0)
T_EP_C:
    v_cmp_ne_u32 vcc, s39, v11
    s_nop 0
    s_and_b64 exec, exec, vcc
    s_cbranch_execz T_EP_D
    s_sub_u32 s60, s60, 1
    s_cmp_gt_i32 s60, 0
    s_sleep 2
    s_cbranch_scc1 T_EP
T_EP_D:
T_H:
    s_mov_b64 exec, 0x1
    s_movk_i32 s60, 4000
T_HP:
    buffer_load_dword v11, v10, s[40:43], s68 offen sc1
T_HP_W:
    s_waitcnt vmcnt(0)
T_HP_C:
    v_cmp_eq_u32 vcc, -1, v11
    s_nop 0
    s_and_b64 exec, exec, vcc
    s_cbranch_execz T_HP_D
    s_sub_u32 s60, s60, 1
    s_cmp_gt_i32 s60, 0
    s_sleep 1
    s_cbranch_scc1 T_HP
T_HP_D:
    s_mov_b64 exec, -1
    s_cmp_ge_u32 s2, 144
    s_cbranch_scc0 T_KQ
    s_movk_i32 s60, 4000
T_KN:
    buffer_load_dwordx4 v[16:19], v3, s[40:43], s65 offen offset:0 sc1
    buffer_load_dwordx4 v[20:23], v3, s[40:43], s65 offen offset:1024 sc1
    buffer_load_dwordx4 v[24:27], v3, s[40:43], s65 offen offset:2048 sc1
    buffer_load_dwordx4 v[28:31], v3, s[40:43], s65 offen offset:3072 sc1
    buffer_load_dwordx4 v[32:35], v3, s[40:43], s66 offen offset:0 sc1
    buffer_load_dwordx4 v[36:39], v3, s[40:43], s66 offen offset:1024 sc1
    buffer_load_dwordx4 v[40:43], v3, s[40:43], s66 offen offset:2048 sc1
    buffer_load_dwordx4 v[44:47], v3, s[40:43], s66 offen offset:3072 sc1
    s_waitcnt vmcnt(16)
    s_sub_u32 s60, s60, 1
    v_max3_u32 v56, v16, v17, v18
    v_max3_u32 v58, v19, v20, v21
    v_max3_u32 v57, v32, v33, v34
    v_max3_u32 v59, v35, v36, v37
    v_max3_u32 v56, v56, v22, v23
    v_max3_u32 v58, v58, v24, v25
    v_max3_u32 v57, v57, v38, v39
    v_max3_u32 v59, v59, v40, v41
    v_max3_u32 v56, v56, v26, v27
    v_max3_u32 v58, v58, v28, v29
    v_max3_u32 v57, v57, v42, v43
    v_max3_u32 v59, v59, v44, v45
    v_max3_u32 v58, v58, v30, v31
    v_max3_u32 v59, v59, v46, v47
    v_max_u32 v56, v56, v58
    v_max_u32 v57, v57, v59
    v_max_u32 v58, v56, v57
    v_cmp_eq_u32 vcc, -1, v58
    s_nop 0
    s_and_b64 exec, exec, vcc
    s_cselect_b32 s60, s60, 0
    s_cmp_gt_i32 s60, 0
    s_cbranch_scc1 T_KN
    s_branch T_KP_D
T_KQ:
    s_movk_i32 s60, 4000
T_KP:
    buffer_load_dwordx4 v[16:19], v3, s[40:43], s65 offen offset:0 sc1
    buffer_load_dwordx4 v[20:23], v3, s[40:43], s65 offen offset:1024 sc1
    buffer_load_dwordx4 v[24:27], v3, s[40:43], s65 offen offset:2048 sc1
    buffer_load_dwordx4 v[28:31], v3, s[40:43], s65 offen offset:3072 sc1
    buffer_load_dwordx4 v[32:35], v3, s[40:43], s66 offen offset:0 sc1
    buffer_load_dwordx4 v[36:39], v3, s[40:43], s66 offen offset:1024 sc1
    buffer_load_dwordx4 v[40:43], v3, s[40:43], s66 offen offset:2048 sc1
    buffer_load_dwordx4 v[44:47], v3, s[40:43], s66 offen offset:3072 sc1
T_KP_W:
    s_waitcnt vmcnt(0)
T_KP_C:
    v_max3_u32 v56, v16, v17, v18
    v_max3_u32 v58, v19, v20, v21
    v_max3_u32 v57, v32, v33, v34
    v_max3_u32 v59, v35, v36, v37
    v_max3_u32 v56, v56, v22, v23
    v_max3_u32 v58, v58, v24, v25
    v_max3_u32 v57, v57, v38, v39
    v_max3_u32 v59, v59, v40, v41
    v_max3_u32 v56, v56, v26, v27
    v_max3_u32 v58, v58, v28, v29
    v_max3_u32 v57, v57, v42, v43
    v_max3_u32 v59, v59, v44, v45
    v_max3_u32 v58, v58, v30, v31
    v_max3_u32 v59, v59, v46, v47
    v_max_u32 v56, v56, v58
    v_max_u32 v57, v57, v59
    v_max_u32 v58, v56, v57
    v_cmp_eq_u32 vcc, -1, v58
    s_nop 0
    s_and_b64 exec, exec, vcc
    s_cbranch_execz T_KP_D
    s_sub_u32 s60, s60, 1
    s_cmp_gt_i32 s60, 0
    s_cbranch_scc1 T_KP
T_KP_D:
    s_mov_b64 exec, -1
    v_mov_b32_dpp v58, v56 quad_perm:[1,0,3,2] row_mask:0xf bank_mask:0xf
    v_mov_b32_dpp v59, v57 quad_perm:[1,0,3,2] row_mask:0xf bank_mask:0xf
    v_med3_u32 v56, v56, v58, v48
    v_med3_u32 v57, v57, v59, v48
    ds_write_b128 v54, v[16:19] offset:7168
    v_mov_b32_dpp v58, v56 quad_perm:[2,3,0,1] row_mask:0xf bank_mask:0xf
    v_mov_b32_dpp v59, v57 quad_perm:[2,3,0,1] row_mask:0xf bank_mask:0xf
    v_med3_u32 v56, v56, v58, v49
    v_med3_u32 v57, v57, v59, v49
    ds_write_b128 v54, v[20:23] offset:6144
    v_mov_b32_dpp v58, v56 quad_perm:[1,0,3,2] row_mask:0xf bank_mask:0xf
    v_mov_b32_dpp v59, v57 quad_perm:[1,0,3,2] row_mask:0xf bank_mask:0xf
    v_med3_u32 v56, v56, v58, v50
    v_med3_u32 v57, v57, v59, v50
    ds_write_b128 v54, v[24:27] offset:5120
    v_mov_b32_dpp v58, v56 row_ror:8 row_mask:0xf bank_mask:0xf
    v_mov_b32_dpp v59, v57 row_ror:8 row_mask:0xf bank_mask:0xf
    v_med3_u32 v56, v56, v58, v51
    v_med3_u32 v57, v57, v59, v51
    ds_write_b128 v54, v[28:31] offset:4096
    v_mov_b32_dpp v58, v56 quad_perm:[2,3,0,1] row_mask:0xf bank_mask:0xf
    v_mov_b32_dpp v59, v57 quad_perm:[2,3,0,1] row_mask:0xf bank_mask:0xf
    v_med3_u32 v56, v56, v58, v52
    v_med3_u32 v57, v57, v59, v52
    ds_write_b128 v54, v[32:35] offset:3072
    v_mov_b32_dpp v58, v56 quad_perm:[1,0,3,2] row_mask:0xf bank_mask:0xf
    v_mov_b32_dpp v59, v57 quad_perm:[1,0,3,2] row_mask:0xf bank_mask:0xf
    v_med3_u32 v56, v56, v58, v53
    v_med3_u32 v57, v57, v59, v53
    ds_write_b128 v54, v[36:39] offset:2048
    s_nop 0
    v_max_u32_dpp v56, v57, v56 row_mirror row_mask:0xf bank_mask:0xf
    ds_write_b128 v54, v[40:43] offset:1024
    s_nop 0
    v_mov_b32_dpp v58, v56 row_ror:8 row_mask:0xf bank_mask:0xf
    v_med3_u32 v56, v56, v58, v51
    ds_write_b128 v54, v[44:47] offset:0
    s_nop 0
    v_mov_b32_dpp v58, v56 quad_perm:[2,3,0,1] row_mask:0xf bank_mask:0xf
    v_med3_u32 v56, v56, v58, v52
    s_nop 1
    v_mov_b32_dpp v58, v56 quad_perm:[1,0,3,2] row_mask:0xf bank_mask:0xf
    v_med3_u32 v56, v56, v58, v53
    s_nop 1
    v_max_u32_dpp v56, v56, v56 row_mirror row_mask:0xf bank_mask:0xf
    s_nop 1
    v_mov_b32_dpp v58, v56 row_ror:8 row_mask:0xf bank_mask:0xf
    v_med3_u32 v56, v56, v58, v51
    s_nop 1
    v_mov_b32_dpp v58, v56 quad_perm:[2,3,0,1] row_mask:0xf bank_mask:0xf
    v_med3_u32 v56, v56, v58, v52
    s_nop 1
    v_mov_b32_dpp v58, v56 quad_perm:[1,0,3,2] row_mask:0xf bank_mask:0xf
    v_med3_u32 v57, v56, v58, v53
    v_med3_u32 v56, v56, v58, v53
    s_nop 1
    v_permlane16_swap_b32 v56, v57
    v_max_u32 v56, v56, v57
    s_nop 1
    v_mov_b32_dpp v58, v56 row_ror:8 row_mask:0xf bank_mask:0xf
    v_med3_u32 v56, v56, v58, v51
    s_nop 1
    v_mov_b32_dpp v58, v56 quad_perm:[2,3,0,1] row_mask:0xf bank_mask:0xf
    v_med3_u32 v56, v56, v58, v52
    s_nop 1
    v_mov_b32_dpp v58, v56 quad_perm:[1,0,3,2] row_mask:0xf bank_mask:0xf
    v_med3_u32 v57, v56, v58, v53
    v_med3_u32 v56, v56, v58, v53
    s_nop 1
    v_permlane32_swap_b32 v56, v57
    v_max_u32 v56, v56, v57
    ds_write_b32 v13, v56
    s_cmp_lt_u32 s2, 144
    v_and_b32 v58, 0x4fc, v56
    v_lshl_or_b32 v58, v58, 2, v55
    v_mov_b32 v62, v56
    ds_read_b64 v[56:57], v58
    s_cbranch_scc1 T_V
    s_waitcnt lgkmcnt(0)
    s_barrier
    ds_read_b32 v7, v160
    s_waitcnt lgkmcnt(0)
    v_and_b32 v7, 0x7ff, v7
    v_mad_i32_i24 v7, v7, s64, v161
    buffer_load_dwordx4 v[8:11], v7, s[40:43], s63 offen sc1
T_V:
    v_min_u32_dpp v58, v62, v62 quad_perm:[1,0,3,2] row_mask:0xf bank_mask:0xf
    s_nop 1
    v_min_u32_dpp v58, v58, v58 quad_perm:[2,3,0,1] row_mask:0xf bank_mask:0xf
    s_nop 1
    v_min_u32_dpp v58, v58, v58 row_ror:8 row_mask:0xf bank_mask:0xf
    s_waitcnt lgkmcnt(0)
    v_cmp_ge_u32 vcc, v56, v58
    v_cmp_ge_u32 s[52:53], v57, v58
    s_bcnt1_i32_b64 s54, vcc
    s_bcnt1_i32_b64 s52, s[52:53]
    s_add_u32 s52, s52, s54
    s_cmp_eq_u32 s52, 8
    s_cbranch_scc0 T_M
T_OK:
    s_movk_i32 s60, 4000
    s_cmp_lt_u32 s2, 144
    s_cbranch_scc1 FIN
    s_setprio 0
    s_branch F_ZP_W
T_M:
    v_cmp_ne_u32 s[56:57], v62, v56
    v_cmp_ne_u32 s[74:75], v62, v57
    s_nop 0
    v_cndmask_b32 v56, 0, v56, s[56:57]
    v_cndmask_b32 v57, 0, v57, s[74:75]
    s_mov_b64 s[72:73], -1
T_L:
    v_max_u32 v59, v56, v57
    v_cmp_gt_u32 vcc, v59, v58
    s_nop 4
    s_cbranch_vccz T_X
    s_ff1_i32_b64 s52, vcc
    v_cmp_eq_u32 vcc, v62, v58
    v_readlane_b32 s53, v59, s52
    s_ff1_i32_b64 s54, vcc
    s_cmp_lt_u32 s2, 144
    s_cbranch_scc1 T_L2
    s_and_b32 s55, s53, 0x7ff
    s_mul_i32 s55, s55, s64
    s_add_u32 s55, s55, 9501184
    buffer_load_dwordx4 v[64:67], v3, s[40:43], s55 offen sc1
    buffer_load_dwordx4 v[68:71], v3, s[40:43], s55 offen offset:1024 sc1
T_L2:
    v_mov_b32 v59, s53
    v_cndmask_b32 v62, v62, v59, vcc
    v_cmp_ne_u32 s[56:57], s53, v56
    v_cmp_ne_u32 s[74:75], s53, v57
    s_nop 0
    v_cndmask_b32 v56, 0, v56, s[56:57]
    v_cndmask_b32 v57, 0, v57, s[74:75]
    v_min_u32_dpp v58, v62, v62 quad_perm:[1,0,3,2] row_mask:0xf bank_mask:0xf
    s_nop 1
    v_min_u32_dpp v58, v58, v58 quad_perm:[2,3,0,1] row_mask:0xf bank_mask:0xf
    s_nop 1
    v_min_u32_dpp v58, v58, v58 row_ror:8 row_mask:0xf bank_mask:0xf
    s_cmp_lt_u32 s2, 144
    s_cbranch_scc1 T_L
    s_lshr_b32 s52, s54, 1
    s_and_b32 s52, s52, 4
    s_and_b32 s54, s54, 3
    s_add_u32 s54, s54, s52
    s_mul_i32 s54, s54, 608
    s_add_u32 s54, s54, 147456
    v_and_b32 v72, 1, v1
    v_mul_u32_u24 v72, 4862, v72
    v_mul_u32_u24 v73, 6, v1
    v_sub_u32 v74, v73, v72
    v_add_u32 v73, v73, v72
    v_add_u32 v75, s54, v73
    v_add_u32 v76, s54, v74
    s_mov_b64 exec, s[72:73]
    s_movk_i32 s60, 4000
    s_branch T_Z_W
T_Z:
    buffer_load_dwordx4 v[8:11], v7, s[40:43], s63 offen sc1
T_Z_W:
    s_waitcnt vmcnt(0)
T_Z_C:
    v_cmp_ne_u32 vcc, s39, v11
    s_nop 0
    s_and_b64 exec, exec, vcc
    s_cbranch_execz T_Z_D
    s_sub_u32 s60, s60, 1
    s_cmp_gt_i32 s60, 0
    s_cbranch_scc1 T_Z
T_Z_D:
    s_mov_b64 exec, s[72:73]
    ds_write2_b32 v162, v8, v10 offset0:0 offset1:1
    ds_write_b32 v2, v9
    s_mov_b64 s[72:73], 0
    s_mov_b64 exec, -1
    s_movk_i32 s60, 4000
    s_branch T_F_W
T_F:
    buffer_load_dwordx4 v[64:67], v3, s[40:43], s55 offen sc1
    buffer_load_dwordx4 v[68:71], v3, s[40:43], s55 offen offset:1024 sc1
T_F_W:
    s_waitcnt vmcnt(0)
T_F_C:
    v_cmp_ne_u32 vcc, s39, v67
    v_cmp_ne_u32 s[56:57], s39, v71
    s_nop 0
    s_or_b32 vcc_lo, vcc_lo, s56
    s_and_b64 exec, exec, vcc
    s_cbranch_execz T_F_D
    s_sub_u32 s60, s60, 1
    s_cmp_gt_i32 s60, 0
    s_cbranch_scc1 T_F
T_F_D:
    s_mov_b64 exec, -1
    s_movk_i32 s60, 4000
T_C:
    ds_read_b32 v72, v63 offset:0
    s_sub_u32 s60, s60, 1
    s_cmp_gt_i32 s60, 0
    s_waitcnt lgkmcnt(0)
    v_readfirstlane_b32 s52, v72
    s_nop 0
    s_cselect_b32 s52, s52, 11
    s_cmp_lg_u32 s52, 11
    s_cbranch_scc1 T_C
    ds_write2_b32 v75, v64, v66 offset0:0 offset1:1
    ds_write_b32 v76, v65 offset:4864
    s_mov_b32 exec_hi, 0
    ds_write2_b32 v75, v68, v70 offset0:96 offset1:97
    ds_write_b32 v76, v69 offset:5248
    s_mov_b64 exec, -1
    s_branch T_L
T_X:
    s_movk_i32 s60, 4000
    s_cmp_lt_u32 s2, 144
    s_cbranch_scc1 FIN
    s_setprio 0
    s_branch F_BQ
F_SEL:
    s_setprio 0
    s_waitcnt lgkmcnt(0)
    s_barrier
    ds_read_b32 v7, v160
    s_waitcnt lgkmcnt(0)
    v_and_b32 v7, 0x7ff, v7
    v_mad_i32_i24 v7, v7, s64, v161
    s_movk_i32 s60, 4000
F_ZP:
    buffer_load_dwordx4 v[8:11], v7, s[40:43], s63 offen sc1
F_ZP_W:
    s_waitcnt vmcnt(0)
F_ZP_C:
    v_cmp_ne_u32 vcc, s39, v11
    s_nop 0
    s_and_b64 exec, exec, vcc
    s_cbranch_execz F_ZP_D
    s_sub_u32 s60, s60, 1
    s_cmp_gt_i32 s60, 0
    s_cbranch_scc1 F_ZP
F_ZP_D:
    s_mov_b64 exec, -1
    ds_write2_b32 v162, v8, v10 offset0:0 offset1:1
    ds_write_b32 v2, v9
    s_mov_b64 exec, 0x1
    ds_inc_u32 v63, v63 offset:0
    s_mov_b64 exec, -1
F_BQ:
    s_cmp_ge_u32 s38, s59
    s_waitcnt lgkmcnt(0)
    s_barrier
    s_cbranch_scc1 F_H
    ds_read_b128 v[16:19], v163 offset:0
    ds_read_b128 v[20:23], v163 offset:64
    ds_read_b128 v[24:27], v163 offset:128
    ds_read_b128 v[28:31], v163 offset:192
    ds_read_b128 v[32:35], v163 offset:256
    ds_read_b128 v[36:39], v163 offset:320
    ds_read_b128 v[40:43], v163 offset:384
    ds_read_b128 v[44:47], v163 offset:448
    ds_read_b128 v[48:51], v163 offset:512
    s_waitcnt lgkmcnt(8)
    v_smfmac_f32_16x16x64_bf16 v[12:15], v[16:19], v[64:71], v6
    s_waitcnt lgkmcnt(7)
    v_smfmac_f32_16x16x64_bf16 v[12:15], v[20:23], v[72:79], v6
    s_waitcnt lgkmcnt(6)
    v_smfmac_f32_16x16x64_bf16 v[12:15], v[24:27], v[80:87], v6
    s_waitcnt lgkmcnt(5)
    v_smfmac_f32_16x16x64_bf16 v[12:15], v[28:31], v[88:95], v6
    s_waitcnt lgkmcnt(4)
    v_smfmac_f32_16x16x64_bf16 v[12:15], v[32:35], v[96:103], v6
    s_waitcnt lgkmcnt(3)
    v_smfmac_f32_16x16x64_bf16 v[12:15], v[36:39], v[104:111], v6
    s_waitcnt lgkmcnt(2)
    v_smfmac_f32_16x16x64_bf16 v[12:15], v[40:43], v[112:119], v6
    s_waitcnt lgkmcnt(1)
    v_smfmac_f32_16x16x64_bf16 v[12:15], v[44:47], v[120:127], v6
    s_waitcnt lgkmcnt(0)
    v_smfmac_f32_16x16x64_bf16 v[12:15], v[48:51], v[128:135], v6
    s_nop 7
    v_permlane32_swap_b32 v12, v14
    v_permlane32_swap_b32 v13, v15
    v_add_f32 v12, v12, v14
    v_add_f32 v13, v13, v15
    v_cvt_pk_bf16_f32 v12, v12, v13
    s_nop 1
    v_mov_b32_dpp v13, v12 row_ror:8 row_mask:0xf bank_mask:0xf
    v_perm_b32 v8, v12, v13, v4
    v_mul_f32 v10, 0xbfb8aa3b, v8
    v_exp_f32 v10, v10
    v_perm_b32 v9, v12, v13, v5
    v_add_f32 v10, 1.0, v10
    v_rcp_f32 v10, v10
    s_nop 0
    v_mul_f32 v8, v8, v10
    v_cvt_pk_bf16_f32 v8, v8, v8
    v_lshlrev_b32 v8, 16, v8
    v_mul_f32 v8, v8, v9
    v_cvt_pk_bf16_f32 v8, v8, v8
    ds_write_b16 v164, v8
F_H:
    s_waitcnt lgkmcnt(0)
    s_barrier
    ds_read_b128 v[16:19], v60
    ds_read_b128 v[20:23], v60 offset:1024
    ds_read_b128 v[24:27], v61
    ds_read_b128 v[28:31], v61 offset:1024
    s_waitcnt lgkmcnt(3)
    v_mfma_f32_16x16x32_bf16 v[12:15], v[16:19], v[152:155], 0
    v_mfma_f32_16x16x32_bf16 v[8:11], v[16:19], v[136:139], 0
    s_waitcnt lgkmcnt(2)
    v_mfma_f32_16x16x32_bf16 v[12:15], v[20:23], v[156:159], v[12:15]
    v_mfma_f32_16x16x32_bf16 v[8:11], v[20:23], v[140:143], v[8:11]
    s_waitcnt lgkmcnt(1)
    v_mfma_f32_16x16x32_bf16 v[8:11], v[24:27], v[144:147], v[8:11]
    s_waitcnt lgkmcnt(0)
    v_mfma_f32_16x16x32_bf16 v[8:11], v[28:31], v[148:151], v[8:11]
    s_mov_b32 exec_hi, 0
    s_nop 1
    buffer_store_dwordx4 v[12:15], v166, s[40:43], s62 offen sc1
    s_mov_b64 exec, -1
    s_nop 2
    buffer_store_dwordx4 v[8:11], v165, s[40:43], s62 offen sc1
    s_branch END
FIN:
    s_cmp_ge_u32 s2, 72
    s_cselect_b32 s44, 32, 0
    s_cselect_b32 s45, 72, 0
    s_sub_u32 s45, s2, s45
    s_mul_i32 s46, s45, 43
    s_lshr_b32 s46, s46, 8
    s_mul_i32 s47, s46, 6
    s_sub_u32 s47, s45, s47
    v_lshrrev_b32 v6, 4, v1
    v_lshl_add_u32 v7, v6, 2, s44
    ds_bpermute_b32 v7, v7, v62
    v_and_b32 v8, 7, v1
    v_and_b32 v5, 15, v1
    s_lshl_b32 s48, s47, 2
    s_add_u32 s49, s48, 1024 - 16
    s_cmp_eq_u32 s47, 3
    s_cselect_b32 s49, 1024 + 8, s49
    s_cmp_lt_u32 s47, 3
    s_cselect_b32 s48, s48, s49
    s_lshl_b32 s49, s46, 11
    s_add_u32 s48, s48, s49
    s_add_u32 s48, s48, 3211264
    s_lshl_b32 s47, s47, 1
    s_lshl_b32 s49, s46, 7
    s_add_u32 s49, s49, s47
    s_add_u32 s49, s49, 6356992
    s_mul_i32 s46, s46, 96
    s_add_u32 s46, s46, s47
    s_movk_i32 s47, 8192
    s_mul_i32 s52, s2, 10240
    s_add_u32 s52, s52, 9502720
    s_add_u32 s53, s52, 4096
    s_add_u32 s54, s52, 8192
    v_mov_b32 v60, 0
    v_mov_b32 v61, 0
    v_mov_b32 v62, 0
    s_waitcnt lgkmcnt(0)
    v_and_b32 v9, 0x7ff, v7
    v_sub_u32 v9, 0x7ff, v9
    v_lshrrev_b32 v10, 4, v9
    v_lshlrev_b32 v11, 6, v10
    v_min_u32 v5, 11, v5
    v_lshl_add_u32 v11, v5, 2, v11
    v_mul_u32_u24 v12, 0x480, v9
    v_mad_u32_u24 v12, v8, 12, v12
    v_add_u32 v12, s46, v12
    v_mul_u32_u24 v10, 0x6000, v10
    v_lshl_add_u32 v10, v8, 7, v10
    v_and_b32 v13, 14, v9
    v_lshl_add_u32 v10, v13, 3, v10
    v_and_b32 v13, 1, v9
    v_lshl_add_u32 v10, v13, 1, v10
    v_mul_u32_u24 v9, 0x600, v9
    v_lshl_add_u32 v9, v8, 4, v9
    global_load_short_d16_hi v60, v12, s[4:5]
    buffer_load_short_d16_hi v61, v10, s[40:43], s48 offen sc1
    v_ashrrev_i32 v13, 31, v7
    v_not_b32 v13, v13
    v_or_b32 v13, 0x80000000, v13
    v_xor_b32 v7, v7, v13
    v_and_b32 v7, 0xffff0000, v7
    v_mul_f32 v7, 0xbfb8aa3b, v7
    v_exp_f32 v7, v7
    s_waitcnt vmcnt(0)
    v_add_f32 v60, v60, v61
    v_add_f32 v7, 1.0, v7
    v_rcp_f32 v7, v7
    v_cvt_pk_bf16_f32 v60, v60, v60
    v_lshlrev_b32 v60, 16, v60
    v_cvt_pk_bf16_f32 v7, v7, v7
    v_lshlrev_b32 v7, 16, v7
    s_mov_b64 exec, 0x1
    s_movk_i32 s60, 4000
FN_HP:
    buffer_load_dword v13, v3, s[40:43], s52 offen offset:0 sc1
FN_HP_W:
    s_waitcnt vmcnt(0)
FN_HP_C:
    v_cmp_eq_u32 vcc, -1, v13
    s_nop 0
    s_and_b64 exec, exec, vcc
    s_cbranch_execz FN_HP_D
    s_sub_u32 s60, s60, 1
    s_cmp_gt_i32 s60, 0
    s_sleep 1
    s_cbranch_scc1 FN_HP
FN_HP_D:
    s_mov_b64 exec, -1
    s_movk_i32 s60, 4000
FN_PP:
    buffer_load_dword v13, v11, s[40:43], s47 offen sc1
    buffer_load_short_d16_hi v62, v9, s[40:43], s49 offen sc1
    buffer_load_dwordx4 v[16:19], v3, s[40:43], s52 offen offset:0 sc1
    buffer_load_dwordx4 v[20:23], v3, s[40:43], s52 offen offset:1024 sc1
    buffer_load_dwordx4 v[24:27], v3, s[40:43], s52 offen offset:2048 sc1
    buffer_load_dwordx4 v[28:31], v3, s[40:43], s52 offen offset:3072 sc1
    buffer_load_dwordx4 v[32:35], v3, s[40:43], s53 offen offset:0 sc1
    buffer_load_dwordx4 v[36:39], v3, s[40:43], s53 offen offset:1024 sc1
    buffer_load_dwordx4 v[40:43], v3, s[40:43], s53 offen offset:2048 sc1
    buffer_load_dwordx4 v[44:47], v3, s[40:43], s53 offen offset:3072 sc1
    buffer_load_dwordx4 v[48:51], v3, s[40:43], s54 offen offset:0 sc1
    buffer_load_dwordx4 v[52:55], v3, s[40:43], s54 offen offset:1024 sc1
FN_PP_W:
    s_waitcnt vmcnt(0)
FN_PP_C:
    v_cmp_ne_u32 s[56:57], s39, v13
    v_pk_add_f32 v[64:65], v[16:17], v[20:21]
    v_pk_add_f32 v[68:69], v[24:25], v[28:29]
    v_pk_add_f32 v[66:67], v[18:19], v[22:23]
    v_pk_add_f32 v[70:71], v[26:27], v[30:31]
    v_pk_add_f32 v[64:65], v[64:65], v[32:33]
    v_pk_add_f32 v[66:67], v[66:67], v[34:35]
    v_pk_add_f32 v[68:69], v[68:69], v[36:37]
    v_pk_add_f32 v[70:71], v[70:71], v[38:39]
    v_pk_add_f32 v[64:65], v[64:65], v[40:41]
    v_pk_add_f32 v[66:67], v[66:67], v[42:43]
    v_pk_add_f32 v[68:69], v[68:69], v[44:45]
    v_pk_add_f32 v[70:71], v[70:71], v[46:47]
    v_pk_add_f32 v[64:65], v[64:65], v[48:49]
    v_pk_add_f32 v[66:67], v[66:67], v[50:51]
    v_pk_add_f32 v[68:69], v[68:69], v[52:53]
    v_pk_add_f32 v[70:71], v[70:71], v[54:55]
    v_pk_add_f32 v[64:65], v[64:65], v[68:69]
    v_pk_add_f32 v[66:67], v[66:67], v[70:71]
    v_pk_add_f32 v[68:69], v[64:65], v[66:67]
    v_cmp_u_f32 vcc, v68, v69
    s_nop 0
    s_or_b64 vcc, vcc, s[56:57]
    s_and_b64 exec, exec, vcc
    s_cbranch_execz FN_PP_D
    s_sub_u32 s60, s60, 1
    s_cmp_gt_i32 s60, 0
    s_cbranch_scc1 FN_PP
FN_PP_D:
    s_mov_b64 exec, -1
    v_permlane32_swap_b32 v64, v66
    v_permlane32_swap_b32 v65, v67
    v_add_f32 v64, v64, v66
    v_add_f32 v65, v65, v67
    s_nop 1
    v_permlane16_swap_b32 v64, v65
    v_add_f32 v64, v64, v65
    s_nop 1
    v_add_f32_dpp v64, v64, v64 row_ror:8 row_mask:0xf bank_mask:0xf
    v_cvt_pk_bf16_f32 v64, v64, v64
    v_lshlrev_b32 v64, 16, v64
    v_mul_f32 v64, v64, v7
    v_cvt_pk_bf16_f32 v64, v64, v64
    v_lshlrev_b32 v64, 16, v64
    v_add_f32 v64, v64, v62
    v_cvt_pk_bf16_f32 v64, v64, v64
    v_lshlrev_b32 v64, 16, v64
    v_add_f32 v64, v64, v60
    v_cvt_pk_bf16_f32 v64, v64, v64
    s_mov_b32 exec_lo, 0xff00ff
    s_mov_b32 exec_hi, 0xff00ff
    global_store_short v12, v64, s[32:33]
    s_mov_b64 exec, -1
END:
    s_endpgm
CODE_END:
.section .rodata,"a"
.p2align 6
.amdhsa_kernel sequential_preLN__ssm_conv_s4__moe_arch_mod__prompt_kernel
  .amdhsa_next_free_vgpr 168
  .amdhsa_next_free_sgpr 102
  .amdhsa_accum_offset 168
  .amdhsa_group_segment_fixed_size 0
  .amdhsa_kernarg_size 136
  .amdhsa_user_sgpr_count 2
  .amdhsa_user_sgpr_kernarg_segment_ptr 1
  .amdhsa_system_sgpr_workgroup_id_x 1
.end_amdhsa_kernel
```

```asm
; @launch grid=(256,1,1) block=(768,1,1) lds=163840
.amdgcn_target "amdgcn-amd-amdhsa--gfx950"
    .text
    .globl sequential_preLN__ssm_conv_s4__moe_arch_mod__prompt_kernel
    .p2align 8
    .type sequential_preLN__ssm_conv_s4__moe_arch_mod__prompt_kernel,@function
sequential_preLN__ssm_conv_s4__moe_arch_mod__prompt_kernel:
    s_cmp_ge_u32 s2, 256
    s_cbranch_scc1 END
    s_load_dwordx16 s[4:19], s[0:1], 0
    s_load_dwordx2 s[36:37], s[0:1], 128
    s_load_dwordx16 s[20:35], s[0:1], 64
    s_getpc_b64 s[70:71]
    s_lshr_b32 s3, s2, 3
    s_mul_i32 s3, s3, 7
    v_subrev_u32 v2, 320, v0
    v_cmp_gt_u32 vcc, 7, v2
    v_add_lshl_u32 v2, v2, s3, 7
    v_min_u32 v2, CODE_END-sequential_preLN__ssm_conv_s4__moe_arch_mod__prompt_kernel-64, v2
    v_mov_b32 v3, s71
    s_mov_b64 exec, vcc
    v_add_co_u32 v2, vcc, s70, v2
    s_nop 1
    v_addc_co_u32 v3, vcc, 0, v3, vcc
    s_cbranch_execz P_NC
    global_load_dword v159, v[2:3], off
P_NC:
    s_mov_b64 exec, -1
    v_lshrrev_b32 v2, 6, v0
    v_and_b32 v1, 63, v0
    v_readfirstlane_b32 s38, v2
    v_lshlrev_b32 v3, 4, v1
    s_mov_b32 s42, 0x10000000
    s_mov_b32 s43, 0x00020000
    s_cmp_lt_u32 s2, 192
    s_cselect_b32 s3, 4, -1
    s_cmp_lg_u32 s38, s3
    s_cbranch_scc1 P_NP
    s_mul_i32 s52, s2, 768
    v_add_u32 v16, s52, v3
    s_mul_i32 s52, s2, 6
    s_and_b32 s52, s52, -4
    v_lshl_add_u32 v17, v1, 2, s52
    v_mov_b32 v18, 161536
    v_mov_b32 v19, 0
    ds_write_b32 v18, v19
    v_mov_b32 v20, s70
    v_mov_b32 v21, s71
    s_waitcnt lgkmcnt(0)
    s_mov_b32 exec_lo, 0xffffffff
    s_mov_b32 exec_hi, 0xffff
    s_mov_b32 m0, 138048
    s_nop 0
    global_load_lds_dwordx4 v16, s[6:7]
    s_mov_b32 m0, 138816
    s_nop 0
    global_load_lds_dwordx4 v16, s[8:9]
    s_mov_b32 m0, 139584
    s_nop 0
    global_load_lds_dwordx4 v16, s[10:11]
    s_mov_b32 m0, 140352
    s_nop 0
    global_load_lds_dwordx4 v16, s[12:13]
    s_mov_b32 m0, 141120
    s_nop 0
    global_load_lds_dwordx4 v16, s[14:15]
    s_mov_b32 m0, 141888
    s_nop 0
    global_load_lds_dwordx4 v16, s[16:17]
    s_mov_b64 exec, 0x3
    s_mov_b32 m0, 142656
    s_nop 0
    global_load_lds_dword v17, s[18:19]
    s_mov_b32 m0, 142672
    s_nop 0
    global_load_lds_dword v17, s[20:21]
    s_mov_b64 exec, 0x1
    s_mov_b32 m0, 161536
    s_nop 0
    global_load_lds_dword v[20:21], off
    s_mov_b64 exec, -1
P_NP:
    s_cmp_ge_u32 s38, 4
    s_cbranch_scc1 P_B
    s_setprio 3
    v_lshrrev_b32 v147, 5, v0
    v_and_b32 v148, 31, v0
    v_mul_u32_u24 v140, 0x480, v147
    s_mul_i32 s44, s2, 9216
    v_mad_u32_u24 v140, v148, 12, v140
    v_mov_b32 v104, 0
    v_mov_b32 v105, 0
    v_mov_b32 v106, 0
    v_mov_b32 v107, 0
    v_add_u32 v140, s44, v140
    v_add_u32 v149, 161280, v3
    s_mov_b64 exec, 0xffff
    ds_write_b128 v149, v[104:107]
    s_mov_b64 exec, -1
    v_mov_b32 v94, 1
    v_and_b32 v147, 1, v147
    v_mul_u32_u24 v141, 0x90, v148
    v_lshl_add_u32 v141, v147, 6, v141
    s_lshl_b32 s45, s38, 4
    s_sub_u32 s45, 147504, s45
    v_add_u32 v141, s45, v141
    v_lshrrev_b32 v142, 3, v1
    v_add_u32 v142, v142, v1
    s_mul_i32 s45, s38, 3456
    s_add_u32 s45, s45, 147456
    v_lshl_add_u32 v142, v142, 4, s45
    v_lshrrev_b32 v143, 2, v1
    v_mul_u32_u24 v143, 16320, v143
    v_add_u32 v143, v143, v3
    s_lshl_b32 s46, s2, 6
    s_sub_u32 s46, 81856, s46
    s_mul_i32 s45, s38, 786432
    s_add_u32 s46, s46, s45
    s_add_u32 s47, s46, 262144
    s_add_u32 s48, s46, 524288
    s_mov_b32 s49, 0x05040100
    s_mov_b32 s50, 0x07060302
    v_mov_b32 v144, s49
    s_mov_b32 exec_lo, 0
    v_mov_b32 v144, s50
    s_mov_b64 exec, -1
    v_mov_b32 v145, 161328
    s_lshl_b32 s45, s38, 2
    v_add_u32 v146, s45, v145
    s_waitcnt lgkmcnt(0)
    global_load_dword v95, v104, s[36:37] offset:0
    global_load_dwordx3 v[60:62], v140, s[4:5] offset:0
    global_load_dwordx3 v[64:66], v140, s[4:5] offset:384
    global_load_dwordx3 v[68:70], v140, s[4:5] offset:768
    s_mov_b32 s40, s36
    s_mov_b32 s41, s37
    s_cmp_ge_u32 s2, 192
    s_cbranch_scc1 P_C
    s_lshr_b32 s65, s38, 2
    s_bitcmp1_b32 s2, 0
    s_addc_u32 s51, s65, 0
    s_cmp_eq_u32 s51, 3
    s_cselect_b32 s51, 0, s51
    s_lshl_b32 s52, s51, 8
    s_add_u32 s52, s52, 138048
    v_and_b32 v114, 0x7f, v0
    v_lshl_add_u32 v114, v114, 1, s52
    s_and_b32 s52, s2, 1
    s_add_u32 s52, s52, s51
    s_lshl_b32 s52, s52, 1
    s_add_u32 s52, s52, 142656
    v_mov_b32 v115, s52
    v_mov_b32 v119, 161536
    v_mov_b32 v29, 0
    v_mov_b32 v30, 0
    v_mov_b32 v31, 0
    v_mov_b32 v32, 0
    v_mov_b32 v33, 0
    v_mov_b32 v34, 0
    v_mov_b32 v35, 0
    v_mov_b32 v160, 0
    v_mov_b32 v161, 0
    v_mov_b32 v162, 0
    v_mov_b32 v163, 0
    v_mov_b32 v164, 0
    v_lshlrev_b32 v16, 4, v0
    v_add_u32 v17, 101184, v16
    ds_write_b128 v17, v[160:163] offset:0
    ds_write_b128 v17, v[160:163] offset:12288
    ds_write_b128 v17, v[160:163] offset:24576
    s_mul_i32 s59, s65, 16320
    s_mul_i32 s67, s65, 17408
    s_add_u32 s71, s67, 48960
    s_and_b32 s66, s38, 1
    s_lshl_b32 s66, s66, 8
    s_add_u32 s70, s66, s67
    s_add_u32 s70, s70, 16192
    s_add_u32 s66, s66, s59
    s_mov_b32 m0, s66
    s_mul_i32 s64, s65, 5888
    s_add_u32 s64, s64, 101184
    s_and_b32 s69, s38, 3
    v_and_b32 v5, 15, v0
    v_bfe_u32 v6, v0, 4, 2
    v_and_b32 v17, 48, v0
    v_mul_u32_u24 v110, 544, v5
    s_mov_b32 s52, 0
    s_movk_i32 s53, 2176
    s_movk_i32 s54, 4896
    s_cmp_eq_u32 s69, 1
    s_cselect_b32 s52, 9792, s52
    s_cselect_b32 s53, 1088, s53
    s_cselect_b32 s54, 3264, s54
    s_cmp_eq_u32 s69, 3
    s_cselect_b32 s52, 544, s52
    s_add_u32 s52, s52, s59
    s_cmp_eq_u32 s69, 2
    s_cselect_b32 s52, s71, s52
    s_cselect_b32 s54, 4352, s54
    s_add_u32 s67, s71, 8704
    v_and_b32 v111, 3, v0
    v_mul_u32_u24 v111, 544, v111
    v_bfe_u32 v18, v0, 2, 1
    v_bfe_u32 v19, v0, 3, 1
    v_xor_b32 v18, v18, v19
    v_mad_u32_u24 v111, v19, s53, v111
    v_mad_u32_u24 v111, v18, s54, v111
    v_add3_u32 v111, v111, v17, s52
    v_add3_u32 v110, v110, v17, s67
    s_barrier
    v_lshl_add_u32 v18, v5, 1, v6
    s_sub_u32 s52, s69, 11
    v_add_u32 v18, s52, v18
    v_add_u32 v19, 1, v18
    v_lshl_add_u32 v20, v6, 1, 2
    v_cmp_le_u32 s[52:53], v18, v20
    v_cmp_le_u32 s[54:55], v19, v20
    v_mov_b32 v18, 0x3f80
    v_cndmask_b32 v112, 0, v18, s[52:53]
    v_cndmask_b32 v19, 0, 1.0, s[54:55]
    v_or_b32 v112, v112, v19
    s_mul_i32 s52, s38, 1600
    s_add_u32 s52, s52, 120016
    v_lshl_add_u32 v113, v1, 2, s52
    s_mul_i32 s67, s65, 6400
    s_add_u32 s67, s67, 118848
    s_sub_u32 s63, s69, s65
    s_cselect_b32 s52, 3, 0
    s_add_u32 s63, s63, s52
    s_min_u32 s52, s63, 1
    s_add_u32 s63, s63, s52
    s_cmp_eq_u32 s69, 3
    s_cselect_b32 s63, 1, s63
    v_add_u32 v7, 1, v5
    v_and_b32 v8, 3, v7
    v_mul_u32_u24 v8, 1598, v8
    v_lshl_add_u32 v7, v7, 1, v8
    v_add3_u32 v7, v7, v17, s67
    v_add_u32 v18, s64, v17
    v_lshl_add_u32 v9, v5, 3, v18
    v_and_b32 v10, 1, v5
    v_mul_u32_u24 v10, 380, v10
    v_lshl_add_u32 v10, v5, 2, v10
    v_add_u32 v10, v18, v10
    v_lshlrev_b32 v8, 5, v5
    v_sub_u32 v8, v18, v8
    v_lshrrev_b32 v11, 2, v5
    v_lshl_add_u32 v2, v5, 2, v6
    v_add_u32 v15, v2, v11
    v_lshl_add_u32 v4, v15, 3, s59
    s_lshl_b32 s52, s65, 4
    s_add_u32 s52, s52, 161280
    v_mov_b32 v166, s52
    s_branch P_D
P_C:
    v_mov_b32 v8, 0
    v_mov_b32 v10, 0
    v_mov_b32 v166, 0
    s_barrier
P_D:
    s_waitcnt vmcnt(0)
LN1:
    v_dot2c_f32_bf16 v104, 0x3f803f80, v60
    v_dot2c_f32_bf16 v106, v60, v60
    v_dot2c_f32_bf16 v105, 0x3f803f80, v61
    v_dot2c_f32_bf16 v107, v61, v61
    v_dot2c_f32_bf16 v104, 0x3f803f80, v62
    v_dot2c_f32_bf16 v106, v62, v62
    v_dot2c_f32_bf16 v105, 0x3f803f80, v64
    v_dot2c_f32_bf16 v107, v64, v64
    v_dot2c_f32_bf16 v104, 0x3f803f80, v65
    v_dot2c_f32_bf16 v106, v65, v65
    v_dot2c_f32_bf16 v105, 0x3f803f80, v66
    v_dot2c_f32_bf16 v107, v66, v66
    v_dot2c_f32_bf16 v104, 0x3f803f80, v68
    v_dot2c_f32_bf16 v106, v68, v68
    v_dot2c_f32_bf16 v105, 0x3f803f80, v69
    v_dot2c_f32_bf16 v107, v69, v69
    v_dot2c_f32_bf16 v104, 0x3f803f80, v70
    v_dot2c_f32_bf16 v106, v70, v70
    v_add_u32 v95, 1, v95
    s_mov_b64 exec, 0x7
    ds_write_b64 v149, v[94:95] offset:136
    s_mov_b64 exec, -1
    v_add_f32 v104, v104, v105
    v_add_f32 v106, v106, v107
    v_lshlrev_b32 v72, 16, v60
    v_and_b32 v73, 0xffff0000, v60
    v_permlane16_swap_b32 v104, v106
    v_add_f32 v104, v104, v106
    v_lshlrev_b32 v74, 16, v61
    v_and_b32 v75, 0xffff0000, v61
    v_add_f32_dpp v104, v104, v104 quad_perm:[1,0,3,2] row_mask:0xf bank_mask:0xf
    v_lshlrev_b32 v76, 16, v62
    v_and_b32 v77, 0xffff0000, v62
    v_add_f32_dpp v104, v104, v104 quad_perm:[2,3,0,1] row_mask:0xf bank_mask:0xf
    v_lshlrev_b32 v78, 16, v64
    v_and_b32 v79, 0xffff0000, v64
    v_add_f32_dpp v104, v104, v104 row_half_mirror row_mask:0xf bank_mask:0xf
    v_lshlrev_b32 v80, 16, v65
    v_and_b32 v81, 0xffff0000, v65
    v_add_f32_dpp v104, v104, v104 row_mirror row_mask:0xf bank_mask:0xf
    v_mul_f32 v104, 0x3ae38e39, v104
    v_mov_b32 v105, v104
    v_lshlrev_b32 v82, 16, v66
    v_and_b32 v83, 0xffff0000, v66
    v_permlane16_swap_b32 v104, v105
    v_fma_f32 v105, -v104, v104, v105
    v_max_f32 v105, 0, v105
    v_cvt_pk_bf16_f32 v105, v104, v105
    v_lshlrev_b32 v104, 16, v105
    v_and_b32 v105, 0xffff0000, v105
    v_lshlrev_b32 v84, 16, v68
    v_and_b32 v85, 0xffff0000, v68
    v_lshlrev_b32 v86, 16, v69
    v_and_b32 v87, 0xffff0000, v69
    v_lshlrev_b32 v88, 16, v70
    v_and_b32 v89, 0xffff0000, v70
    v_mov_b32 v99, v95
    v_mov_b32 v103, v95
    v_readfirstlane_b32 s39, v95
    v_add_f32 v105, 0x3727c5ac, v105
    v_cvt_pk_bf16_f32 v105, v105, v105
    v_lshlrev_b32 v105, 16, v105
    v_sqrt_f32 v106, v105
    v_pk_add_f32 v[72:73], v[72:73], v[104:105] op_sel_hi:[1,0] neg_lo:[0,1] neg_hi:[0,1]
    v_pk_add_f32 v[74:75], v[74:75], v[104:105] op_sel_hi:[1,0] neg_lo:[0,1] neg_hi:[0,1]
    v_pk_add_f32 v[76:77], v[76:77], v[104:105] op_sel_hi:[1,0] neg_lo:[0,1] neg_hi:[0,1]
    v_cvt_pk_bf16_f32 v106, v106, v106
    v_lshlrev_b32 v106, 16, v106
    v_rcp_f32 v106, v106
    v_pk_add_f32 v[78:79], v[78:79], v[104:105] op_sel_hi:[1,0] neg_lo:[0,1] neg_hi:[0,1]
    v_pk_add_f32 v[80:81], v[80:81], v[104:105] op_sel_hi:[1,0] neg_lo:[0,1] neg_hi:[0,1]
    v_pk_add_f32 v[82:83], v[82:83], v[104:105] op_sel_hi:[1,0] neg_lo:[0,1] neg_hi:[0,1]
    v_pk_add_f32 v[84:85], v[84:85], v[104:105] op_sel_hi:[1,0] neg_lo:[0,1] neg_hi:[0,1]
    v_pk_add_f32 v[86:87], v[86:87], v[104:105] op_sel_hi:[1,0] neg_lo:[0,1] neg_hi:[0,1]
    v_pk_add_f32 v[88:89], v[88:89], v[104:105] op_sel_hi:[1,0] neg_lo:[0,1] neg_hi:[0,1]
    v_cvt_pk_bf16_f32 v73, v72, v73
    v_cvt_pk_bf16_f32 v75, v74, v75
    v_cvt_pk_bf16_f32 v77, v76, v77
    v_cvt_pk_bf16_f32 v79, v78, v79
    v_cvt_pk_bf16_f32 v81, v80, v81
    v_cvt_pk_bf16_f32 v83, v82, v83
    v_cvt_pk_bf16_f32 v85, v84, v85
    v_cvt_pk_bf16_f32 v87, v86, v87
    v_cvt_pk_bf16_f32 v89, v88, v89
    v_lshlrev_b32 v72, 16, v73
    v_and_b32 v73, 0xffff0000, v73
    v_lshlrev_b32 v74, 16, v75
    v_and_b32 v75, 0xffff0000, v75
    v_lshlrev_b32 v76, 16, v77
    v_and_b32 v77, 0xffff0000, v77
    v_pk_mul_f32 v[72:73], v[72:73], v[106:107] op_sel_hi:[1,0]
    v_pk_mul_f32 v[74:75], v[74:75], v[106:107] op_sel_hi:[1,0]
    v_pk_mul_f32 v[76:77], v[76:77], v[106:107] op_sel_hi:[1,0]
    v_cvt_pk_bf16_f32 v60, v72, v73
    v_cvt_pk_bf16_f32 v62, v76, v77
    v_cvt_pk_bf16_f32 v61, v74, v75
    v_cvt_pk_bf16_f32 v63, v74, v75
    v_permlane32_swap_b32 v60, v62
    s_nop 0
    v_permlane32_swap_b32 v61, v63
    v_perm_b32 v92, v60, v62, s49
    v_perm_b32 v93, v60, v62, s50
    v_lshlrev_b32 v78, 16, v79
    v_and_b32 v79, 0xffff0000, v79
    v_lshlrev_b32 v80, 16, v81
    v_and_b32 v81, 0xffff0000, v81
    v_lshlrev_b32 v82, 16, v83
    v_and_b32 v83, 0xffff0000, v83
    v_pk_mul_f32 v[78:79], v[78:79], v[106:107] op_sel_hi:[1,0]
    v_pk_mul_f32 v[80:81], v[80:81], v[106:107] op_sel_hi:[1,0]
    v_pk_mul_f32 v[82:83], v[82:83], v[106:107] op_sel_hi:[1,0]
    v_cvt_pk_bf16_f32 v64, v78, v79
    v_cvt_pk_bf16_f32 v66, v82, v83
    v_cvt_pk_bf16_f32 v65, v80, v81
    v_cvt_pk_bf16_f32 v67, v80, v81
    v_perm_b32 v94, v61, v63, v144
    ds_write_b128 v141, v[92:95] offset:0
    v_permlane32_swap_b32 v64, v66
    v_permlane32_swap_b32 v65, v67
    v_perm_b32 v96, v64, v66, s49
    v_perm_b32 v97, v64, v66, s50
    v_lshlrev_b32 v84, 16, v85
    v_and_b32 v85, 0xffff0000, v85
    v_lshlrev_b32 v86, 16, v87
    v_and_b32 v87, 0xffff0000, v87
    v_lshlrev_b32 v88, 16, v89
    v_and_b32 v89, 0xffff0000, v89
    v_pk_mul_f32 v[84:85], v[84:85], v[106:107] op_sel_hi:[1,0]
    v_pk_mul_f32 v[86:87], v[86:87], v[106:107] op_sel_hi:[1,0]
    v_pk_mul_f32 v[88:89], v[88:89], v[106:107] op_sel_hi:[1,0]
    v_cvt_pk_bf16_f32 v68, v84, v85
    v_cvt_pk_bf16_f32 v70, v88, v89
    v_cvt_pk_bf16_f32 v69, v86, v87
    v_cvt_pk_bf16_f32 v71, v86, v87
    v_perm_b32 v98, v65, v67, v144
    ds_write_b128 v141, v[96:99] offset:4608
    v_permlane32_swap_b32 v68, v70
    v_permlane32_swap_b32 v69, v71
    v_perm_b32 v100, v68, v70, s49
    v_perm_b32 v101, v68, v70, s50
    v_perm_b32 v102, v69, v71, v144
    ds_write_b128 v141, v[100:103] offset:9216
    s_mov_b64 exec, 0x1
    ds_write_b32 v146, v144
    s_mov_b64 exec, -1
LN1_U:
    s_movk_i32 s60, 4000
LN1_R:
    ds_read_b128 v[104:107], v145
    ds_read_b128 v[72:75], v142 offset:0
    ds_read_b128 v[76:79], v142 offset:1152
    ds_read_b128 v[80:83], v142 offset:2304
    s_sub_u32 s60, s60, 1
    s_waitcnt lgkmcnt(3)
    v_min3_u32 v104, v104, v105, v106
    v_min_u32 v104, v104, v107
    v_cmp_eq_u32 vcc, 0, v104
    s_cmp_gt_i32 s60, 0
    s_cselect_b64 s[52:53], vcc, 0
    s_cmp_lg_u64 s[52:53], 0
    s_waitcnt lgkmcnt(0)
    s_cbranch_scc1 LN1_R
    buffer_store_dwordx4 v[72:75], v143, s[40:43], s46 offen sc1
    buffer_store_dwordx4 v[76:79], v143, s[40:43], s47 offen sc1
    buffer_store_dwordx4 v[80:83], v143, s[40:43], s48 offen sc1
    s_cmp_ge_u32 s2, 192
    s_cbranch_scc1 FFN_DMA
    s_branch C_KS
P_B:
    s_cmp_ge_u32 s2, 192
    s_cbranch_scc1 FFN_DMA0
P_B2:
    s_lshr_b32 s65, s38, 2
    s_bitcmp1_b32 s2, 0
    s_addc_u32 s51, s65, 0
    s_cmp_eq_u32 s51, 3
    s_cselect_b32 s51, 0, s51
    s_lshl_b32 s52, s51, 8
    s_add_u32 s52, s52, 138048
    v_and_b32 v114, 0x7f, v0
    v_lshl_add_u32 v114, v114, 1, s52
    s_and_b32 s52, s2, 1
    s_add_u32 s52, s52, s51
    s_lshl_b32 s52, s52, 1
    s_add_u32 s52, s52, 142656
    v_mov_b32 v115, s52
    v_mov_b32 v119, 161536
    v_mov_b32 v29, 0
    v_mov_b32 v30, 0
    v_mov_b32 v31, 0
    v_mov_b32 v32, 0
    v_mov_b32 v33, 0
    v_mov_b32 v34, 0
    v_mov_b32 v35, 0
    v_mov_b32 v160, 0
    v_mov_b32 v161, 0
    v_mov_b32 v162, 0
    v_mov_b32 v163, 0
    v_mov_b32 v164, 0
    v_lshlrev_b32 v16, 4, v0
    v_add_u32 v17, 101184, v16
    ds_write_b128 v17, v[160:163] offset:0
    ds_write_b128 v17, v[160:163] offset:12288
    ds_write_b128 v17, v[160:163] offset:24576
    s_mul_i32 s59, s65, 16320
    s_mul_i32 s67, s65, 17408
    s_add_u32 s71, s67, 48960
    s_and_b32 s66, s38, 1
    s_lshl_b32 s66, s66, 8
    s_add_u32 s70, s66, s67
    s_add_u32 s70, s70, 16192
    s_add_u32 s66, s66, s59
    s_mov_b32 m0, s66
    s_mul_i32 s64, s65, 5888
    s_add_u32 s64, s64, 101184
    s_and_b32 s69, s38, 3
    v_and_b32 v5, 15, v0
    v_bfe_u32 v6, v0, 4, 2
    v_and_b32 v17, 48, v0
    v_mul_u32_u24 v110, 544, v5
    s_mov_b32 s52, 0
    s_movk_i32 s53, 2176
    s_movk_i32 s54, 4896
    s_cmp_eq_u32 s69, 1
    s_cselect_b32 s52, 9792, s52
    s_cselect_b32 s53, 1088, s53
    s_cselect_b32 s54, 3264, s54
    s_cmp_eq_u32 s69, 3
    s_cselect_b32 s52, 544, s52
    s_add_u32 s52, s52, s59
    s_cmp_eq_u32 s69, 2
    s_cselect_b32 s52, s71, s52
    s_cselect_b32 s54, 4352, s54
    s_add_u32 s67, s71, 8704
    v_and_b32 v111, 3, v0
    v_mul_u32_u24 v111, 544, v111
    v_bfe_u32 v18, v0, 2, 1
    v_bfe_u32 v19, v0, 3, 1
    v_xor_b32 v18, v18, v19
    v_mad_u32_u24 v111, v19, s53, v111
    v_mad_u32_u24 v111, v18, s54, v111
    v_add3_u32 v111, v111, v17, s52
    v_add3_u32 v110, v110, v17, s67
    s_barrier
    v_lshl_add_u32 v18, v5, 1, v6
    s_sub_u32 s52, s69, 11
    v_add_u32 v18, s52, v18
    v_add_u32 v19, 1, v18
    v_lshl_add_u32 v20, v6, 1, 2
    v_cmp_le_u32 s[52:53], v18, v20
    v_cmp_le_u32 s[54:55], v19, v20
    v_mov_b32 v18, 0x3f80
    v_cndmask_b32 v112, 0, v18, s[52:53]
    v_cndmask_b32 v19, 0, 1.0, s[54:55]
    v_or_b32 v112, v112, v19
    s_mul_i32 s52, s38, 1600
    s_add_u32 s52, s52, 120016
    v_lshl_add_u32 v113, v1, 2, s52
    s_mul_i32 s67, s65, 6400
    s_add_u32 s67, s67, 118848
    s_sub_u32 s63, s69, s65
    s_cselect_b32 s52, 3, 0
    s_add_u32 s63, s63, s52
    s_min_u32 s52, s63, 1
    s_add_u32 s63, s63, s52
    s_cmp_eq_u32 s69, 3
    s_cselect_b32 s63, 1, s63
    v_add_u32 v7, 1, v5
    v_and_b32 v8, 3, v7
    v_mul_u32_u24 v8, 1598, v8
    v_lshl_add_u32 v7, v7, 1, v8
    v_add3_u32 v7, v7, v17, s67
    v_add_u32 v18, s64, v17
    v_lshl_add_u32 v9, v5, 3, v18
    v_and_b32 v10, 1, v5
    v_mul_u32_u24 v10, 380, v10
    v_lshl_add_u32 v10, v5, 2, v10
    v_add_u32 v10, v18, v10
    v_lshlrev_b32 v8, 5, v5
    v_sub_u32 v8, v18, v8
    v_lshrrev_b32 v11, 2, v5
    v_lshl_add_u32 v2, v5, 2, v6
    v_add_u32 v15, v2, v11
    v_lshl_add_u32 v4, v15, 3, s59
    s_lshl_b32 s52, s65, 4
    s_add_u32 s52, s52, 161280
    v_mov_b32 v166, s52
    s_mul_i32 s48, s2, 10240
    s_add_u32 s48, s48, 9498624
    s_cmp_eq_u32 s2, 150
    s_cselect_b32 s48, 28672, s48
    s_cselect_b32 s50, 0, s2
    s_add_u32 s49, s48, 11264
    s_waitcnt lgkmcnt(0)
    s_mov_b32 s40, s36
    s_mov_b32 s41, s37
C_KS:
    s_movk_i32 s60, 4000
C_KP:
    ds_read_b32 v20, v119
    s_sub_u32 s60, s60, 1
    s_cmp_gt_i32 s60, 0
    s_waitcnt lgkmcnt(0)
    v_readfirstlane_b32 s52, v20
    s_nop 0
    s_cselect_b32 s52, s52, 1
    s_cmp_eq_u32 s52, 0
    s_cbranch_scc1 C_KP
    ds_read_u16_d16_hi v29, v115
    ds_read_u16_d16_hi v30, v114 offset:0
    ds_read_u16_d16_hi v31, v114 offset:768
    ds_read_u16_d16_hi v32, v114 offset:1536
    ds_read_u16_d16_hi v33, v114 offset:2304
    ds_read_u16_d16_hi v34, v114 offset:3072
    ds_read_u16_d16_hi v35, v114 offset:3840
    ds_read_u16_d16_hi v164, v115 offset:16
    s_setprio 2
    s_cmp_lt_u32 s38, 4
    s_cbranch_scc1 PG1
    s_setprio 3
PG1:
    s_waitcnt lgkmcnt(0)
    v_mul_f32 v20, 0x3fb8aa3b, v29
    v_mov_b32 v21, 0x3fb8aa3b
    v_fma_f32 v21, v29, v21, -v20
    v_fmac_f32 v21, 0x32a57060, v29
    v_exp_f32 v20, v20
    v_mul_f32 v21, 0x3f317218, v21
    v_fma_f32 v20, v20, v21, v20
    v_cvt_pk_bf16_f32 v20, v20, v20
    v_lshlrev_b32 v20, 16, v20
    v_mul_f32 v21, v30, v20
    v_mul_f32 v36, v31, v20
    v_mul_f32 v32, v32, v20
    v_mul_f32 v33, v33, v20
    v_mul_f32 v21, 0x3fb8aa3b, v21
    v_mul_f32 v22, 0x3e22f983, v36
    v_mov_b32 v23, 0x3e22f983
    v_fma_f32 v23, v36, v23, -v22
    v_fmac_f32 v23, 0x31dc9c88, v36
    v_pk_mul_f32 v[24:25], v[34:35], v[32:33] op_sel:[0,0] op_sel_hi:[0,1]
    v_pk_fma_f32 v[24:25], v[34:35], v[32:33], v[24:25] op_sel:[1,1,0] op_sel_hi:[1,0,1] neg_lo:[1,0,0]
    s_bitcmp1_b32 s38, 1
    s_cbranch_scc1 C_ROLE1
    v_mul_f32 v36, 0x43000000, v21
    v_mul_f32 v37, 0x43000000, v22
    v_mul_f32 v38, 0x41000000, v21
    v_mul_f32 v39, 0x41000000, v22
    v_exp_f32 v36, v36
    v_fract_f32 v37, v37
    v_exp_f32 v38, v38
    v_fract_f32 v39, v39
    v_fmac_f32 v37, 0x43000000, v23
    v_fmac_f32 v39, 0x41000000, v23
    v_cos_f32 v26, v37
    v_sin_f32 v27, v37
    v_cos_f32 v28, v39
    v_sin_f32 v29, v39
    v_mul_f32 v26, v26, v36
    v_mul_f32 v27, v27, v36
    v_mul_f32 v28, v28, v38
    v_mul_f32 v29, v29, v38
    v_mov_b32 v44, 1.0
    v_mov_b32 v45, 0
    v_pk_mul_f32 v[56:57], v[24:25], v[28:29] op_sel:[0,0] op_sel_hi:[0,1]
    v_pk_mul_f32 v[50:51], v[28:29], v[28:29] op_sel:[0,0] op_sel_hi:[0,1]
    v_pk_fma_f32 v[56:57], v[24:25], v[28:29], v[56:57] op_sel:[1,1,0] op_sel_hi:[1,0,1] neg_lo:[1,0,0]
    v_pk_fma_f32 v[50:51], v[28:29], v[28:29], v[50:51] op_sel:[1,1,0] op_sel_hi:[1,0,1] neg_lo:[1,0,0]
    v_pk_mul_f32 v[58:59], v[56:57], v[26:27] op_sel:[0,0] op_sel_hi:[0,1]
    v_pk_fma_f32 v[58:59], v[56:57], v[26:27], v[58:59] op_sel:[1,1,0] op_sel_hi:[1,0,1] neg_lo:[1,0,0]
    v_cvt_pk_bf16_f32 v40, v56, v57
    ds_write_addtid_b32 v40 offset:4352
    v_pk_mul_f32 v[56:57], v[58:59], v[26:27] op_sel:[0,0] op_sel_hi:[0,1]
    v_pk_mul_f32 v[54:55], v[50:51], v[28:29] op_sel:[0,0] op_sel_hi:[0,1]
    v_pk_fma_f32 v[56:57], v[58:59], v[26:27], v[56:57] op_sel:[1,1,0] op_sel_hi:[1,0,1] neg_lo:[1,0,0]
    v_pk_fma_f32 v[54:55], v[50:51], v[28:29], v[54:55] op_sel:[1,1,0] op_sel_hi:[1,0,1] neg_lo:[1,0,0]
    v_cvt_pk_bf16_f32 v41, v58, v59
    ds_write_addtid_b32 v41 offset:9248
    v_cvt_pk_bf16_f32 v42, v44, -v45
    s_mov_b32 m0, s70
    s_nop 0
    ds_write_addtid_b32 v42 offset:41472
    v_cvt_pk_bf16_f32 v43, v28, -v29
    ds_write_addtid_b32 v43 offset:42016
    v_cvt_pk_bf16_f32 v40, v50, -v51
    ds_write_addtid_b32 v40 offset:42560
    v_pk_mul_f32 v[58:59], v[56:57], v[26:27] op_sel:[0,0] op_sel_hi:[0,1]
    v_pk_mul_f32 v[50:51], v[54:55], v[28:29] op_sel:[0,0] op_sel_hi:[0,1]
    v_pk_fma_f32 v[58:59], v[56:57], v[26:27], v[58:59] op_sel:[1,1,0] op_sel_hi:[1,0,1] neg_lo:[1,0,0]
    v_pk_fma_f32 v[50:51], v[54:55], v[28:29], v[50:51] op_sel:[1,1,0] op_sel_hi:[1,0,1] neg_lo:[1,0,0]
    v_cvt_pk_bf16_f32 v41, v56, v57
    s_mov_b32 m0, s66
    s_nop 0
    ds_write_addtid_b32 v41 offset:11968
    v_cvt_pk_bf16_f32 v42, v54, -v55
    s_mov_b32 m0, s70
    s_nop 0
    ds_write_addtid_b32 v42 offset:43104
    v_pk_mul_f32 v[56:57], v[58:59], v[26:27] op_sel:[0,0] op_sel_hi:[0,1]
    v_pk_mul_f32 v[54:55], v[50:51], v[28:29] op_sel:[0,0] op_sel_hi:[0,1]
    v_pk_fma_f32 v[56:57], v[58:59], v[26:27], v[56:57] op_sel:[1,1,0] op_sel_hi:[1,0,1] neg_lo:[1,0,0]
    v_pk_fma_f32 v[54:55], v[50:51], v[28:29], v[54:55] op_sel:[1,1,0] op_sel_hi:[1,0,1] neg_lo:[1,0,0]
    v_cvt_pk_bf16_f32 v43, v58, v59
    s_mov_b32 m0, s66
    s_nop 0
    ds_write_addtid_b32 v43 offset:15232
    v_cvt_pk_bf16_f32 v40, v50, -v51
    s_mov_b32 m0, s70
    s_nop 0
    ds_write_addtid_b32 v40 offset:43648
    v_pk_mul_f32 v[58:59], v[56:57], v[26:27] op_sel:[0,0] op_sel_hi:[0,1]
    v_pk_mul_f32 v[50:51], v[54:55], v[28:29] op_sel:[0,0] op_sel_hi:[0,1]
    v_pk_fma_f32 v[58:59], v[56:57], v[26:27], v[58:59] op_sel:[1,1,0] op_sel_hi:[1,0,1] neg_lo:[1,0,0]
    v_pk_fma_f32 v[50:51], v[54:55], v[28:29], v[50:51] op_sel:[1,1,0] op_sel_hi:[1,0,1] neg_lo:[1,0,0]
    v_cvt_pk_bf16_f32 v41, v56, v57
    ds_write_addtid_b32 v41 offset:33312
    v_cvt_pk_bf16_f32 v42, v54, -v55
    ds_write_addtid_b32 v42 offset:44192
    v_pk_mul_f32 v[56:57], v[58:59], v[26:27] op_sel:[0,0] op_sel_hi:[0,1]
    v_pk_mul_f32 v[54:55], v[50:51], v[28:29] op_sel:[0,0] op_sel_hi:[0,1]
    v_pk_fma_f32 v[56:57], v[58:59], v[26:27], v[56:57] op_sel:[1,1,0] op_sel_hi:[1,0,1] neg_lo:[1,0,0]
    v_pk_fma_f32 v[54:55], v[50:51], v[28:29], v[54:55] op_sel:[1,1,0] op_sel_hi:[1,0,1] neg_lo:[1,0,0]
    v_cvt_pk_bf16_f32 v43, v58, v59
    ds_write_addtid_b32 v43 offset:34400
    v_cvt_pk_bf16_f32 v40, v50, -v51
    ds_write_addtid_b32 v40 offset:44736
    v_pk_mul_f32 v[58:59], v[56:57], v[26:27] op_sel:[0,0] op_sel_hi:[0,1]
    v_pk_mul_f32 v[50:51], v[54:55], v[28:29] op_sel:[0,0] op_sel_hi:[0,1]
    v_pk_fma_f32 v[58:59], v[56:57], v[26:27], v[58:59] op_sel:[1,1,0] op_sel_hi:[1,0,1] neg_lo:[1,0,0]
    v_pk_fma_f32 v[50:51], v[54:55], v[28:29], v[50:51] op_sel:[1,1,0] op_sel_hi:[1,0,1] neg_lo:[1,0,0]
    v_cvt_pk_bf16_f32 v41, v56, v57
    ds_write_addtid_b32 v41 offset:37664
    v_cvt_pk_bf16_f32 v42, v54, -v55
    ds_write_addtid_b32 v42 offset:45280
    v_pk_mul_f32 v[56:57], v[58:59], v[26:27] op_sel:[0,0] op_sel_hi:[0,1]
    v_pk_mul_f32 v[54:55], v[50:51], v[28:29] op_sel:[0,0] op_sel_hi:[0,1]
    v_pk_fma_f32 v[56:57], v[58:59], v[26:27], v[56:57] op_sel:[1,1,0] op_sel_hi:[1,0,1] neg_lo:[1,0,0]
    v_pk_fma_f32 v[54:55], v[50:51], v[28:29], v[54:55] op_sel:[1,1,0] op_sel_hi:[1,0,1] neg_lo:[1,0,0]
    v_cvt_pk_bf16_f32 v43, v58, v59
    ds_write_addtid_b32 v43 offset:38752
    v_cvt_pk_bf16_f32 v40, v50, -v51
    ds_write_addtid_b32 v40 offset:45824
    v_pk_mul_f32 v[58:59], v[56:57], v[26:27] op_sel:[0,0] op_sel_hi:[0,1]
    v_pk_mul_f32 v[50:51], v[54:55], v[28:29] op_sel:[0,0] op_sel_hi:[0,1]
    v_pk_fma_f32 v[58:59], v[56:57], v[26:27], v[58:59] op_sel:[1,1,0] op_sel_hi:[1,0,1] neg_lo:[1,0,0]
    v_pk_fma_f32 v[50:51], v[54:55], v[28:29], v[50:51] op_sel:[1,1,0] op_sel_hi:[1,0,1] neg_lo:[1,0,0]
    v_cvt_pk_bf16_f32 v41, v56, v57
    ds_write_addtid_b32 v41 offset:39296
    v_cvt_pk_bf16_f32 v42, v54, -v55
    ds_write_addtid_b32 v42 offset:46368
    v_pk_mul_f32 v[56:57], v[58:59], v[26:27] op_sel:[0,0] op_sel_hi:[0,1]
    v_pk_mul_f32 v[54:55], v[50:51], v[28:29] op_sel:[0,0] op_sel_hi:[0,1]
    v_pk_fma_f32 v[56:57], v[58:59], v[26:27], v[56:57] op_sel:[1,1,0] op_sel_hi:[1,0,1] neg_lo:[1,0,0]
    v_pk_fma_f32 v[54:55], v[50:51], v[28:29], v[54:55] op_sel:[1,1,0] op_sel_hi:[1,0,1] neg_lo:[1,0,0]
    v_cvt_pk_bf16_f32 v43, v58, v59
    ds_write_addtid_b32 v43 offset:39840
    v_cvt_pk_bf16_f32 v40, v50, -v51
    ds_write_addtid_b32 v40 offset:46912
    v_pk_mul_f32 v[58:59], v[56:57], v[26:27] op_sel:[0,0] op_sel_hi:[0,1]
    v_pk_mul_f32 v[50:51], v[54:55], v[28:29] op_sel:[0,0] op_sel_hi:[0,1]
    v_pk_fma_f32 v[58:59], v[56:57], v[26:27], v[58:59] op_sel:[1,1,0] op_sel_hi:[1,0,1] neg_lo:[1,0,0]
    v_pk_fma_f32 v[50:51], v[54:55], v[28:29], v[50:51] op_sel:[1,1,0] op_sel_hi:[1,0,1] neg_lo:[1,0,0]
    v_cvt_pk_bf16_f32 v41, v56, v57
    ds_write_addtid_b32 v41 offset:40384
    v_cvt_pk_bf16_f32 v42, v54, -v55
    ds_write_addtid_b32 v42 offset:47456
    v_pk_mul_f32 v[56:57], v[58:59], v[26:27] op_sel:[0,0] op_sel_hi:[0,1]
    v_pk_mul_f32 v[54:55], v[50:51], v[28:29] op_sel:[0,0] op_sel_hi:[0,1]
    v_pk_fma_f32 v[56:57], v[58:59], v[26:27], v[56:57] op_sel:[1,1,0] op_sel_hi:[1,0,1] neg_lo:[1,0,0]
    v_pk_fma_f32 v[54:55], v[50:51], v[28:29], v[54:55] op_sel:[1,1,0] op_sel_hi:[1,0,1] neg_lo:[1,0,0]
    v_cvt_pk_bf16_f32 v43, v58, v59
    ds_write_addtid_b32 v43 offset:40928
    v_cvt_pk_bf16_f32 v40, v50, -v51
    ds_write_addtid_b32 v40 offset:48000
    v_pk_mul_f32 v[58:59], v[56:57], v[26:27] op_sel:[0,0] op_sel_hi:[0,1]
    v_pk_mul_f32 v[50:51], v[54:55], v[28:29] op_sel:[0,0] op_sel_hi:[0,1]
    v_pk_fma_f32 v[58:59], v[56:57], v[26:27], v[58:59] op_sel:[1,1,0] op_sel_hi:[1,0,1] neg_lo:[1,0,0]
    v_pk_fma_f32 v[50:51], v[54:55], v[28:29], v[50:51] op_sel:[1,1,0] op_sel_hi:[1,0,1] neg_lo:[1,0,0]
    v_cvt_pk_bf16_f32 v41, v56, v57
    ds_write_addtid_b32 v41 offset:34944
    v_cvt_pk_bf16_f32 v42, v54, -v55
    ds_write_addtid_b32 v42 offset:48544
    v_pk_mul_f32 v[56:57], v[58:59], v[26:27] op_sel:[0,0] op_sel_hi:[0,1]
    v_pk_mul_f32 v[54:55], v[50:51], v[28:29] op_sel:[0,0] op_sel_hi:[0,1]
    v_pk_fma_f32 v[56:57], v[58:59], v[26:27], v[56:57] op_sel:[1,1,0] op_sel_hi:[1,0,1] neg_lo:[1,0,0]
    v_pk_fma_f32 v[54:55], v[50:51], v[28:29], v[54:55] op_sel:[1,1,0] op_sel_hi:[1,0,1] neg_lo:[1,0,0]
    v_cvt_pk_bf16_f32 v43, v58, v59
    ds_write_addtid_b32 v43 offset:35488
    v_cvt_pk_bf16_f32 v40, v50, -v51
    ds_write_addtid_b32 v40 offset:49088
    v_pk_mul_f32 v[58:59], v[56:57], v[26:27] op_sel:[0,0] op_sel_hi:[0,1]
    v_pk_fma_f32 v[58:59], v[56:57], v[26:27], v[58:59] op_sel:[1,1,0] op_sel_hi:[1,0,1] neg_lo:[1,0,0]
    v_cvt_pk_bf16_f32 v41, v56, v57
    ds_write_addtid_b32 v41 offset:36032
    v_cvt_pk_bf16_f32 v42, v54, -v55
    ds_write_addtid_b32 v42 offset:49632
    v_cvt_pk_bf16_f32 v43, v58, v59
    ds_write_addtid_b32 v43 offset:36576
    s_branch C_MFMA
C_ROLE1:
    v_mul_f32 v36, 0x43000000, v21
    v_mul_f32 v37, 0x43000000, v22
    v_mul_f32 v38, 0x3f800000, v21
    v_mul_f32 v39, 0x3f800000, v22
    v_exp_f32 v36, v36
    v_fract_f32 v37, v37
    v_exp_f32 v38, v38
    v_fract_f32 v39, v39
    v_fmac_f32 v37, 0x43000000, v23
    v_fmac_f32 v39, 0x3f800000, v23
    v_cos_f32 v26, v37
    v_sin_f32 v27, v37
    v_cos_f32 v28, v39
    v_sin_f32 v29, v39
    v_mul_f32 v26, v26, v36
    v_mul_f32 v27, v27, v36
    v_mul_f32 v28, v28, v38
    v_mul_f32 v29, v29, v38
    v_pk_mul_f32 v[44:45], v[24:25], v[26:27] op_sel:[0,0] op_sel_hi:[0,1]
    v_pk_mul_f32 v[46:47], v[28:29], v[28:29] op_sel:[0,0] op_sel_hi:[0,1]
    v_pk_mul_f32 v[48:49], v[24:25], v[28:29] op_sel:[0,0] op_sel_hi:[0,1]
    v_pk_fma_f32 v[44:45], v[24:25], v[26:27], v[44:45] op_sel:[1,1,0] op_sel_hi:[1,0,1] neg_lo:[1,0,0]
    v_pk_fma_f32 v[46:47], v[28:29], v[28:29], v[46:47] op_sel:[1,1,0] op_sel_hi:[1,0,1] neg_lo:[1,0,0]
    v_pk_fma_f32 v[48:49], v[24:25], v[28:29], v[48:49] op_sel:[1,1,0] op_sel_hi:[1,0,1] neg_lo:[1,0,0]
    v_cvt_pk_bf16_f32 v40, v24, v25
    ds_write_addtid_b32 v40 offset:0
    v_pk_mul_f32 v[50:51], v[44:45], v[26:27] op_sel:[0,0] op_sel_hi:[0,1]
    v_pk_mul_f32 v[52:53], v[44:45], v[28:29] op_sel:[0,0] op_sel_hi:[0,1]
    v_pk_mul_f32 v[54:55], v[48:49], v[28:29] op_sel:[0,0] op_sel_hi:[0,1]
    v_pk_mul_f32 v[62:63], v[46:47], v[46:47] op_sel:[0,0] op_sel_hi:[0,1]
    v_pk_fma_f32 v[50:51], v[44:45], v[26:27], v[50:51] op_sel:[1,1,0] op_sel_hi:[1,0,1] neg_lo:[1,0,0]
    v_pk_fma_f32 v[52:53], v[44:45], v[28:29], v[52:53] op_sel:[1,1,0] op_sel_hi:[1,0,1] neg_lo:[1,0,0]
    v_pk_fma_f32 v[54:55], v[48:49], v[28:29], v[54:55] op_sel:[1,1,0] op_sel_hi:[1,0,1] neg_lo:[1,0,0]
    v_pk_fma_f32 v[62:63], v[46:47], v[46:47], v[62:63] op_sel:[1,1,0] op_sel_hi:[1,0,1] neg_lo:[1,0,0]
    v_cvt_pk_bf16_f32 v41, v44, v45
    ds_write_addtid_b32 v41 offset:4896
    v_cvt_pk_bf16_f32 v42, v48, v49
    ds_write_addtid_b32 v42 offset:544
    v_pk_mul_f32 v[56:57], v[50:51], v[26:27] op_sel:[0,0] op_sel_hi:[0,1]
    v_pk_mul_f32 v[58:59], v[50:51], v[46:47] op_sel:[0,0] op_sel_hi:[0,1]
    v_pk_mul_f32 v[44:45], v[52:53], v[28:29] op_sel:[0,0] op_sel_hi:[0,1]
    v_pk_mul_f32 v[48:49], v[54:55], v[28:29] op_sel:[0,0] op_sel_hi:[0,1]
    v_pk_fma_f32 v[56:57], v[50:51], v[26:27], v[56:57] op_sel:[1,1,0] op_sel_hi:[1,0,1] neg_lo:[1,0,0]
    v_pk_fma_f32 v[58:59], v[50:51], v[46:47], v[58:59] op_sel:[1,1,0] op_sel_hi:[1,0,1] neg_lo:[1,0,0]
    v_pk_fma_f32 v[44:45], v[52:53], v[28:29], v[44:45] op_sel:[1,1,0] op_sel_hi:[1,0,1] neg_lo:[1,0,0]
    v_pk_fma_f32 v[48:49], v[54:55], v[28:29], v[48:49] op_sel:[1,1,0] op_sel_hi:[1,0,1] neg_lo:[1,0,0]
    v_cvt_pk_bf16_f32 v43, v50, v51
    ds_write_addtid_b32 v43 offset:9792
    v_cvt_pk_bf16_f32 v40, v52, v53
    ds_write_addtid_b32 v40 offset:5440
    v_cvt_pk_bf16_f32 v41, v54, v55
    ds_write_addtid_b32 v41 offset:1088
    v_pk_mul_f32 v[54:55], v[48:49], v[28:29] op_sel:[0,0] op_sel_hi:[0,1]
    v_pk_mul_f32 v[52:53], v[44:45], v[28:29] op_sel:[0,0] op_sel_hi:[0,1]
    v_pk_mul_f32 v[50:51], v[58:59], v[46:47] op_sel:[0,0] op_sel_hi:[0,1]
    v_pk_mul_f32 v[24:25], v[56:57], v[46:47] op_sel:[0,0] op_sel_hi:[0,1]
    v_pk_fma_f32 v[54:55], v[48:49], v[28:29], v[54:55] op_sel:[1,1,0] op_sel_hi:[1,0,1] neg_lo:[1,0,0]
    v_pk_fma_f32 v[52:53], v[44:45], v[28:29], v[52:53] op_sel:[1,1,0] op_sel_hi:[1,0,1] neg_lo:[1,0,0]
    v_pk_fma_f32 v[50:51], v[58:59], v[46:47], v[50:51] op_sel:[1,1,0] op_sel_hi:[1,0,1] neg_lo:[1,0,0]
    v_pk_fma_f32 v[24:25], v[56:57], v[46:47], v[24:25] op_sel:[1,1,0] op_sel_hi:[1,0,1] neg_lo:[1,0,0]
    v_cvt_pk_bf16_f32 v42, v48, v49
    ds_write_addtid_b32 v42 offset:1632
    v_cvt_pk_bf16_f32 v43, v44, v45
    ds_write_addtid_b32 v43 offset:5984
    v_cvt_pk_bf16_f32 v40, v58, v59
    ds_write_addtid_b32 v40 offset:10336
    v_pk_mul_f32 v[48:49], v[54:55], v[28:29] op_sel:[0,0] op_sel_hi:[0,1]
    v_pk_mul_f32 v[44:45], v[52:53], v[28:29] op_sel:[0,0] op_sel_hi:[0,1]
    v_pk_mul_f32 v[58:59], v[50:51], v[46:47] op_sel:[0,0] op_sel_hi:[0,1]
    v_pk_mul_f32 v[56:57], v[24:25], v[46:47] op_sel:[0,0] op_sel_hi:[0,1]
    v_pk_fma_f32 v[48:49], v[54:55], v[28:29], v[48:49] op_sel:[1,1,0] op_sel_hi:[1,0,1] neg_lo:[1,0,0]
    v_pk_fma_f32 v[44:45], v[52:53], v[28:29], v[44:45] op_sel:[1,1,0] op_sel_hi:[1,0,1] neg_lo:[1,0,0]
    v_pk_fma_f32 v[58:59], v[50:51], v[46:47], v[58:59] op_sel:[1,1,0] op_sel_hi:[1,0,1] neg_lo:[1,0,0]
    v_pk_fma_f32 v[56:57], v[24:25], v[46:47], v[56:57] op_sel:[1,1,0] op_sel_hi:[1,0,1] neg_lo:[1,0,0]
    v_cvt_pk_bf16_f32 v41, v54, v55
    ds_write_addtid_b32 v41 offset:2176
    v_cvt_pk_bf16_f32 v42, v52, v53
    ds_write_addtid_b32 v42 offset:6528
    v_cvt_pk_bf16_f32 v43, v50, v51
    ds_write_addtid_b32 v43 offset:10880
    v_cvt_pk_bf16_f32 v40, v24, v25
    ds_write_addtid_b32 v40 offset:13600
    v_pk_mul_f32 v[54:55], v[48:49], v[28:29] op_sel:[0,0] op_sel_hi:[0,1]
    v_pk_mul_f32 v[52:53], v[44:45], v[28:29] op_sel:[0,0] op_sel_hi:[0,1]
    v_pk_mul_f32 v[50:51], v[58:59], v[62:63] op_sel:[0,0] op_sel_hi:[0,1]
    v_pk_mul_f32 v[24:25], v[56:57], v[46:47] op_sel:[0,0] op_sel_hi:[0,1]
    v_pk_mul_f32 v[64:65], v[56:57], v[26:27] op_sel:[0,0] op_sel_hi:[0,1]
    v_pk_fma_f32 v[54:55], v[48:49], v[28:29], v[54:55] op_sel:[1,1,0] op_sel_hi:[1,0,1] neg_lo:[1,0,0]
    v_pk_fma_f32 v[52:53], v[44:45], v[28:29], v[52:53] op_sel:[1,1,0] op_sel_hi:[1,0,1] neg_lo:[1,0,0]
    v_pk_fma_f32 v[50:51], v[58:59], v[62:63], v[50:51] op_sel:[1,1,0] op_sel_hi:[1,0,1] neg_lo:[1,0,0]
    v_pk_fma_f32 v[24:25], v[56:57], v[46:47], v[24:25] op_sel:[1,1,0] op_sel_hi:[1,0,1] neg_lo:[1,0,0]
    v_pk_fma_f32 v[64:65], v[56:57], v[26:27], v[64:65] op_sel:[1,1,0] op_sel_hi:[1,0,1] neg_lo:[1,0,0]
    v_cvt_pk_bf16_f32 v41, v48, v49
    ds_write_addtid_b32 v41 offset:2720
    v_cvt_pk_bf16_f32 v42, v44, v45
    ds_write_addtid_b32 v42 offset:7072
    v_cvt_pk_bf16_f32 v43, v58, v59
    ds_write_addtid_b32 v43 offset:11424
    v_cvt_pk_bf16_f32 v40, v56, v57
    ds_write_addtid_b32 v40 offset:14144
    v_pk_mul_f32 v[48:49], v[54:55], v[28:29] op_sel:[0,0] op_sel_hi:[0,1]
    v_pk_mul_f32 v[44:45], v[52:53], v[28:29] op_sel:[0,0] op_sel_hi:[0,1]
    v_pk_mul_f32 v[56:57], v[24:25], v[62:63] op_sel:[0,0] op_sel_hi:[0,1]
    v_pk_mul_f32 v[66:67], v[64:65], v[26:27] op_sel:[0,0] op_sel_hi:[0,1]
    v_pk_fma_f32 v[48:49], v[54:55], v[28:29], v[48:49] op_sel:[1,1,0] op_sel_hi:[1,0,1] neg_lo:[1,0,0]
    v_pk_fma_f32 v[44:45], v[52:53], v[28:29], v[44:45] op_sel:[1,1,0] op_sel_hi:[1,0,1] neg_lo:[1,0,0]
    v_pk_fma_f32 v[56:57], v[24:25], v[62:63], v[56:57] op_sel:[1,1,0] op_sel_hi:[1,0,1] neg_lo:[1,0,0]
    v_pk_fma_f32 v[66:67], v[64:65], v[26:27], v[66:67] op_sel:[1,1,0] op_sel_hi:[1,0,1] neg_lo:[1,0,0]
    v_cvt_pk_bf16_f32 v41, v54, v55
    ds_write_addtid_b32 v41 offset:3264
    v_cvt_pk_bf16_f32 v42, v52, v53
    ds_write_addtid_b32 v42 offset:7616
    v_cvt_pk_bf16_f32 v43, v50, v51
    ds_write_addtid_b32 v43 offset:12512
    v_cvt_pk_bf16_f32 v40, v24, v25
    ds_write_addtid_b32 v40 offset:14688
    v_cvt_pk_bf16_f32 v41, v64, v65
    s_mov_b32 m0, s70
    s_nop 0
    ds_write_addtid_b32 v41 offset:32768
    v_pk_mul_f32 v[52:53], v[44:45], v[28:29] op_sel:[0,0] op_sel_hi:[0,1]
    v_pk_mul_f32 v[64:65], v[66:67], v[26:27] op_sel:[0,0] op_sel_hi:[0,1]
    v_pk_fma_f32 v[52:53], v[44:45], v[28:29], v[52:53] op_sel:[1,1,0] op_sel_hi:[1,0,1] neg_lo:[1,0,0]
    v_pk_fma_f32 v[64:65], v[66:67], v[26:27], v[64:65] op_sel:[1,1,0] op_sel_hi:[1,0,1] neg_lo:[1,0,0]
    v_cvt_pk_bf16_f32 v42, v48, v49
    s_mov_b32 m0, s66
    s_nop 0
    ds_write_addtid_b32 v42 offset:3808
    v_cvt_pk_bf16_f32 v43, v44, v45
    ds_write_addtid_b32 v43 offset:8160
    v_cvt_pk_bf16_f32 v40, v56, v57
    ds_write_addtid_b32 v40 offset:15776
    v_cvt_pk_bf16_f32 v41, v66, v67
    s_mov_b32 m0, s70
    s_nop 0
    ds_write_addtid_b32 v41 offset:33856
    v_pk_mul_f32 v[66:67], v[64:65], v[26:27] op_sel:[0,0] op_sel_hi:[0,1]
    v_pk_fma_f32 v[66:67], v[64:65], v[26:27], v[66:67] op_sel:[1,1,0] op_sel_hi:[1,0,1] neg_lo:[1,0,0]
    v_cvt_pk_bf16_f32 v42, v52, v53
    s_mov_b32 m0, s66
    s_nop 0
    ds_write_addtid_b32 v42 offset:8704
    v_cvt_pk_bf16_f32 v43, v64, v65
    s_mov_b32 m0, s70
    s_nop 0
    ds_write_addtid_b32 v43 offset:37120
    v_cvt_pk_bf16_f32 v40, v66, v67
    ds_write_addtid_b32 v40 offset:38208
C_MFMA:
    s_lshl_b32 s56, s2, 14
    s_lshl_b32 s57, s38, 12
    s_add_u32 s56, s56, s57
    s_add_u32 s56, s56, 49152
    s_mov_b64 exec, 0x1
    ds_inc_u32 v166, v166 offset:12
    s_mov_b64 exec, -1
    ds_write_b32 v113, v112
    s_setprio 2
    s_movk_i32 s60, 4000
C_KG:
    ds_read_b32 v16, v166 offset:12
    s_sub_u32 s60, s60, 1
    s_cmp_gt_i32 s60, 0
    s_waitcnt lgkmcnt(0)
    v_readfirstlane_b32 s52, v16
    s_nop 0
    s_cselect_b32 s52, s52, 4
    s_cmp_lg_u32 s52, 4
    s_cbranch_scc1 C_KG
    ds_read_b128 v[16:19], v111 offset:0
    ds_read_b128 v[20:23], v110 offset:0
    ds_read_b128 v[24:27], v111 offset:64
    ds_read_b128 v[28:31], v110 offset:64
    ds_read_b128 v[32:35], v111 offset:128
    ds_read_b128 v[36:39], v110 offset:128
    ds_read_b128 v[40:43], v111 offset:192
    ds_read_b128 v[44:47], v110 offset:192
    ds_read_b128 v[48:51], v111 offset:256
    ds_read_b128 v[52:55], v110 offset:256
    ds_read_b128 v[56:59], v111 offset:320
    ds_read_b128 v[60:63], v110 offset:320
    ds_read_b128 v[64:67], v111 offset:384
    ds_read_b128 v[68:71], v110 offset:384
    ds_read_b128 v[72:75], v111 offset:448
    ds_read_b128 v[76:79], v110 offset:448
    s_lshl_b32 s53, s63, 10
    s_sub_u32 s52, s64, s53
    s_add_u32 s52, s52, 3576
    v_and_b32 v165, 1, v5
    v_lshl_add_u32 v165, v6, 1, v165
    s_mul_i32 s53, s65, 384
    s_add_u32 s53, s53, 161920
    v_lshl_add_u32 v165, v165, 4, s53
    v_lshlrev_b32 v2, 3, v2
    v_sub_u32 v2, s52, v2
    s_mul_i32 s68, s63, 1088
    s_add_u32 s68, s68, s71
    v_lshl_add_u32 v15, v15, 3, s68
    s_cmp_lg_u32 s63, 0
    s_cbranch_scc1 C_LA1
    s_lshr_b32 s52, s2, 3
    s_mul_i32 s52, s52, 3
    s_add_u32 s52, s52, s65
    s_lshl_b32 s52, s52, 3
    s_and_b32 s53, s2, 7
    v_and_b32 v11, 7, v1
    v_add_u32 v11, s52, v11
    v_and_b32 v12, 56, v1
    v_mul_u32_u24 v13, 0x48, v11
    v_add3_u32 v14, v12, v13, s53
    v_lshlrev_b32 v14, 7, v14
    s_add_u32 s53, s53, 64
    v_add_lshl_u32 v13, v13, s53, 7
    s_mul_i32 s53, s53, 0x240
    v_add_lshl_u32 v12, v11, s53, 7
    v_mov_b32 v10, 0
    v_lshrrev_b32 v9, 3, v1
    v_mul_u32_u24 v9, 3328, v9
    v_add3_u32 v9, v9, v3, s59
    s_branch C_LA2
C_LA1:
    v_and_b32 v93, 3, v5
    v_lshl_add_u32 v94, v6, 3, v11
    v_and_b32 v92, 1, v11
    v_mul_u32_u24 v92, 3456, v92
    v_add_u32 v92, s59, v92
    v_sub_u32 v93, v93, v94
    v_sub_u32 v94, v93, v94
    v_add_u32 v95, 44, v93
    v_lshrrev_b32 v96, 4, v95
    v_add_u32 v95, v95, v96
    v_lshl_add_u32 v11, v95, 3, v92
    v_add_u32 v95, 75, v94
    v_lshrrev_b32 v96, 4, v95
    v_add_u32 v95, v95, v96
    v_lshl_add_u32 v13, v95, 3, v92
    v_add_u32 v95, 40, v93
    v_lshrrev_b32 v96, 4, v95
    v_add_u32 v95, v95, v96
    v_lshl_add_u32 v12, v95, 3, v92
    v_add_u32 v95, 67, v94
    v_lshrrev_b32 v96, 4, v95
    v_add_u32 v95, v95, v96
    v_lshl_add_u32 v14, v95, 3, v92
C_LA2:
    s_cmp_eq_u32 s69, 2
    s_cbranch_scc1 C_T2
    v_lshrrev_b32 v89, 1, v6
    v_xor_b32 v88, v89, v6
    v_and_b32 v88, 1, v88
    v_lshlrev_b32 v88, 8, v88
    v_lshl_add_u32 v88, v89, 3, v88
    v_lshl_add_u32 v88, v5, 4, v88
    s_cmp_eq_u32 s69, 1
    s_cbranch_scc1 C_T1
    s_lshr_b32 s52, s69, 1
    s_mul_i32 s53, s52, 1600
    s_add_u32 s53, s53, s67
    v_add_u32 v88, s53, v88
    v_add_u32 v89, 3200, v88
    s_xor_b32 s52, s52, 1
    s_mov_b32 s53, 0
    s_waitcnt lgkmcnt(14)
    v_mfma_f32_16x16x32_bf16 v[80:83], v[16:19], v[20:23], 0
    s_waitcnt lgkmcnt(12)
    v_mfma_f32_16x16x32_bf16 v[84:87], v[24:27], v[28:31], 0
    s_waitcnt lgkmcnt(10)
    v_mfma_f32_16x16x32_bf16 v[80:83], v[32:35], v[36:39], v[80:83]
    s_waitcnt lgkmcnt(8)
    v_mfma_f32_16x16x32_bf16 v[84:87], v[40:43], v[44:47], v[84:87]
    s_waitcnt lgkmcnt(6)
    v_mfma_f32_16x16x32_bf16 v[80:83], v[48:51], v[52:55], v[80:83]
    s_waitcnt lgkmcnt(4)
    v_mfma_f32_16x16x32_bf16 v[84:87], v[56:59], v[60:63], v[84:87]
    s_waitcnt lgkmcnt(2)
    v_mfma_f32_16x16x32_bf16 v[80:83], v[64:67], v[68:71], v[80:83]
    s_waitcnt lgkmcnt(0)
    v_mfma_f32_16x16x32_bf16 v[84:87], v[72:75], v[76:79], v[84:87]
    s_nop 7
    v_pk_add_f32 v[80:81], v[80:81], v[84:85]
    v_pk_add_f32 v[82:83], v[82:83], v[86:87]
    v_cvt_pk_bf16_f32 v80, v80, v81
    v_cvt_pk_bf16_f32 v81, v82, v83
    ds_write_b64 v88, v[80:81] offset:32
    ds_write2_b32 v89, v80, v81 offset0:7 offset1:8
    s_mov_b64 exec, s[52:53]
    ds_write_b16 v88, v80 offset:1630
    ds_write_b16 v88, v80 offset:4826
    s_mov_b64 exec, -1
    s_branch C_B3
C_T1:
    s_add_u32 s53, s67, 544
    v_add_u32 v88, s53, v88
    v_add_u32 v89, 1600, v88
    s_waitcnt lgkmcnt(14)
    v_mfma_f32_16x16x32_bf16 v[80:83], v[16:19], v[20:23], 0
    s_waitcnt lgkmcnt(12)
    v_mfma_f32_16x16x32_bf16 v[84:87], v[24:27], v[28:31], 0
    s_waitcnt lgkmcnt(10)
    v_mfma_f32_16x16x32_bf16 v[80:83], v[32:35], v[36:39], v[80:83]
    s_waitcnt lgkmcnt(8)
    v_mfma_f32_16x16x32_bf16 v[84:87], v[40:43], v[44:47], v[84:87]
    s_waitcnt lgkmcnt(6)
    v_mfma_f32_16x16x32_bf16 v[80:83], v[48:51], v[52:55], v[80:83]
    s_waitcnt lgkmcnt(4)
    v_mfma_f32_16x16x32_bf16 v[84:87], v[56:59], v[60:63], v[84:87]
    s_waitcnt lgkmcnt(2)
    v_mfma_f32_16x16x32_bf16 v[80:83], v[64:67], v[68:71], v[80:83]
    s_waitcnt lgkmcnt(0)
    v_mfma_f32_16x16x32_bf16 v[84:87], v[72:75], v[76:79], v[84:87]
    s_nop 7
    v_pk_add_f32 v[80:81], v[80:81], v[84:85]
    v_pk_add_f32 v[82:83], v[82:83], v[86:87]
    v_cvt_pk_bf16_f32 v16, v81, v82
    v_cvt_pk_bf16_f32 v17, v82, v82
    v_cvt_pk_bf16_f32 v18, v82, v82
    v_cvt_pk_bf16_f32 v19, v82, v83
    ds_write2_b32 v88, v16, v17 offset0:1 offset1:2
    ds_write_b64 v88, v[16:17] offset:3200
    ds_write2_b32 v89, v18, v19 offset0:1 offset1:2
    ds_write_b64 v88, v[18:19] offset:4800
    v_cvt_pk_bf16_f32 v20, v80, v80
    v_cvt_pk_bf16_f32 v21, v80, v81
    s_mov_b64 exec, 0x1
    ds_write_b32 v88, v20
    ds_write_b32 v88, v20 offset:3196
    ds_write_b32 v88, v21 offset:1600
    ds_write_b32 v88, v21 offset:4796
    s_mov_b32 exec_lo, 0x0
    s_mov_b32 exec_hi, 0x8000
    ds_write_b16 v88, v17 offset:12
    ds_write_b16 v88, v17 offset:1610
    ds_write_b16 v88, v17 offset:3208
    ds_write_b16 v88, v17 offset:4806
    s_mov_b64 exec, -1
    s_branch C_B3
C_T2:
    v_lshlrev_b32 v88, 7, v6
    v_lshl_add_u32 v89, v5, 1, v88
    v_lshl_add_u32 v88, v5, 2, v88
    s_add_u32 s52, s64, 4728
    v_add_u32 v88, s52, v88
    s_add_u32 s52, s64, 4920
    v_add_u32 v89, s52, v89
    v_mov_b32 v90, s67
    s_waitcnt lgkmcnt(14)
    v_mfma_f32_16x16x32_bf16 v[80:83], v[16:19], v[20:23], 0
    s_waitcnt lgkmcnt(12)
    v_mfma_f32_16x16x32_bf16 v[84:87], v[24:27], v[28:31], 0
    s_waitcnt lgkmcnt(10)
    v_mfma_f32_16x16x32_bf16 v[80:83], v[32:35], v[36:39], v[80:83]
    s_waitcnt lgkmcnt(8)
    v_mfma_f32_16x16x32_bf16 v[84:87], v[40:43], v[44:47], v[84:87]
    s_waitcnt lgkmcnt(6)
    v_mfma_f32_16x16x32_bf16 v[80:83], v[48:51], v[52:55], v[80:83]
    s_waitcnt lgkmcnt(4)
    v_mfma_f32_16x16x32_bf16 v[84:87], v[56:59], v[60:63], v[84:87]
    s_waitcnt lgkmcnt(2)
    v_mfma_f32_16x16x32_bf16 v[80:83], v[64:67], v[68:71], v[80:83]
    s_waitcnt lgkmcnt(0)
    v_mfma_f32_16x16x32_bf16 v[84:87], v[72:75], v[76:79], v[84:87]
    s_nop 7
    v_pk_add_f32 v[80:81], v[80:81], v[84:85]
    v_pk_add_f32 v[82:83], v[82:83], v[86:87]
    v_cvt_pk_bf16_f32 v80, v80, v81
    v_cvt_pk_bf16_f32 v81, v82, v83
    s_mov_b32 exec_hi, 0
    ds_write2_b32 v88, v80, v81 offset0:0 offset1:16
    s_not_b64 exec, exec
    ds_write_b16 v89, v80 offset:4
    ds_write_b16_d16_hi v89, v80 offset:36
    ds_write_b16 v89, v81 offset:68
    ds_write_b16_d16_hi v89, v81 offset:100
    ds_write_b16 v89, v80 offset:384
    ds_write_b16_d16_hi v89, v80 offset:416
    ds_write_b16 v89, v81 offset:448
    ds_write_b16_d16_hi v89, v81 offset:480
    s_mov_b32 exec_lo, 0x80000000
    s_mov_b32 exec_hi, 0x0
    ds_write_b16_d16_hi v90, v81 offset:1126
    ds_write_b16_d16_hi v90, v81 offset:1128
    ds_write_b16_d16_hi v90, v81 offset:2724
    ds_write_b16_d16_hi v90, v81 offset:2726
    ds_write_b16_d16_hi v90, v81 offset:4322
    ds_write_b16_d16_hi v90, v81 offset:4324
    ds_write_b16_d16_hi v90, v81 offset:5920
    ds_write_b16_d16_hi v90, v81 offset:5922
    s_mov_b64 exec, -1
C_B3:
    s_mov_b64 exec, 0x1
    ds_inc_u32 v166, v166 offset:128
    s_mov_b64 exec, -1
    s_cmp_lg_u32 s65, 1
    s_cbranch_scc1 C_NOUL
    s_waitcnt vmcnt(0)
    buffer_load_dwordx4 v[24:27], v3, s[40:43], s56 offen offset:0 sc1
    buffer_load_dwordx4 v[28:31], v3, s[40:43], s56 offen offset:1024 sc1
    buffer_load_dwordx4 v[32:35], v3, s[40:43], s56 offen offset:2048 sc1
    buffer_load_dwordx4 v[36:39], v3, s[40:43], s56 offen offset:3072 sc1
C_NOUL:
    s_movk_i32 s60, 4000
C_KM:
    ds_read_b128 v[16:19], v166 offset:128
    s_sub_u32 s60, s60, 1
    s_cmp_gt_i32 s60, 0
    s_waitcnt lgkmcnt(0)
    v_add_u32 v16, v16, v18
    s_nop 0
    v_readfirstlane_b32 s52, v16
    s_nop 0
    s_cselect_b32 s52, s52, 5
    s_cmp_lg_u32 s52, 5
    s_cbranch_scc1 C_KM
    s_setprio 3
    ds_read_b64 v[48:49], v7 offset:0
    ds_read_b64 v[50:51], v7 offset:8
    ds_read_b64 v[52:53], v7 offset:64
    ds_read_b64 v[54:55], v7 offset:72
    ds_read_b64 v[56:57], v7 offset:128
    ds_read_b64 v[58:59], v7 offset:136
    ds_read_b64 v[60:61], v7 offset:192
    ds_read_b64 v[62:63], v7 offset:200
    ds_read_b64 v[64:65], v7 offset:256
    ds_read_b64 v[66:67], v7 offset:264
    ds_read_b64 v[68:69], v7 offset:320
    ds_read_b64 v[70:71], v7 offset:328
    ds_read_b64 v[72:73], v7 offset:384
    ds_read_b64 v[74:75], v7 offset:392
    ds_read_b64 v[76:77], v7 offset:448
    ds_read_b64 v[78:79], v7 offset:456
    ds_read_b64 v[80:81], v7 offset:512
    ds_read_b64 v[82:83], v7 offset:520
    ds_read_b64 v[84:85], v7 offset:576
    ds_read_b64 v[86:87], v7 offset:584
    ds_read_b64 v[88:89], v7 offset:640
    ds_read_b64 v[90:91], v7 offset:648
    ds_read_b64 v[92:93], v7 offset:704
    ds_read_b64 v[94:95], v7 offset:712
    ds_read_b64 v[96:97], v7 offset:768
    ds_read_b64 v[98:99], v7 offset:776
    ds_read_b64 v[100:101], v7 offset:832
    ds_read_b64 v[102:103], v7 offset:840
    ds_read_b64 v[104:105], v7 offset:896
    ds_read_b64 v[106:107], v7 offset:904
    ds_read_b64 v[108:109], v7 offset:960
    ds_read_b64 v[110:111], v7 offset:968
    s_cmp_eq_u32 s63, 1
    s_cbranch_scc1 C_E1
    s_cmp_eq_u32 s63, 2
    s_cbranch_scc1 C_E2
    s_cmp_eq_u32 s63, 3
    s_cbranch_scc1 C_E3
    ds_read_b64 v[112:113], v7 offset:1152
    ds_read_b64 v[114:115], v7 offset:1160
    ds_read_b64 v[116:117], v7 offset:1216
    ds_read_b64 v[118:119], v7 offset:1224
    ds_read_b64 v[128:129], v7 offset:1280
    ds_read_b64 v[130:131], v7 offset:1288
    ds_read_b64 v[132:133], v7 offset:1344
    ds_read_b64 v[134:135], v7 offset:1352
    s_mov_b32 exec_hi, 0
    ds_write_b128 v9, v[160:163]
    s_mov_b64 exec, -1
    s_branch C_EE
C_E1:
    ds_read_b64 v[128:129], v7 offset:1152
    ds_read_b64 v[130:131], v7 offset:1160
    ds_read_b64 v[132:133], v7 offset:1216
    ds_read_b64 v[134:135], v7 offset:1224
    ds_read_b64 v[136:137], v7 offset:1280
    ds_read_b64 v[138:139], v7 offset:1288
    ds_read_b64 v[140:141], v7 offset:1344
    ds_read_b64 v[142:143], v7 offset:1352
    ds_read_b64 v[112:113], v7 offset:1024
    ds_read_b64 v[114:115], v7 offset:1032
    s_branch C_EE
C_E2:
    ds_read_b64 v[152:153], v7 offset:1152
    ds_read_b64 v[154:155], v7 offset:1160
    ds_read_b64 v[156:157], v7 offset:1216
    ds_read_b64 v[158:159], v7 offset:1224
    ds_read_b64 v[112:113], v7 offset:1024
    ds_read_b64 v[114:115], v7 offset:1032
    ds_read_b64 v[128:129], v9 offset:4608
    ds_read_b64 v[130:131], v9 offset:4616
    ds_read_b64 v[132:133], v9 offset:4672
    ds_read_b64 v[134:135], v9 offset:4680
    ds_read_b64 v[136:137], v9 offset:4736
    ds_read_b64 v[138:139], v9 offset:4744
    ds_read_b64 v[140:141], v9 offset:4800
    ds_read_b64 v[142:143], v9 offset:4808
    ds_read_b64 v[144:145], v9 offset:4864
    ds_read_b64 v[146:147], v9 offset:4872
    ds_read_b64 v[148:149], v9 offset:4928
    ds_read_b64 v[150:151], v9 offset:4936
    s_branch C_EE
C_E3:
    ds_read_b64 v[112:113], v7 offset:1024
    ds_read_b64 v[114:115], v7 offset:1032
    ds_read_b64 v[116:117], v7 offset:1088
    ds_read_b64 v[118:119], v7 offset:1096
    ds_read_b64 v[128:129], v9 offset:4608
    ds_read_b64 v[130:131], v9 offset:4616
    ds_read_b64 v[132:133], v9 offset:4672
    ds_read_b64 v[134:135], v9 offset:4680
    ds_read_b64 v[136:137], v9 offset:4736
    ds_read_b64 v[138:139], v9 offset:4744
    ds_read_b64 v[140:141], v9 offset:4800
    ds_read_b64 v[142:143], v9 offset:4808
    ds_read_b64 v[144:145], v9 offset:4864
    ds_read_b64 v[146:147], v9 offset:4872
    ds_read_b64 v[148:149], v9 offset:4928
    ds_read_b64 v[150:151], v9 offset:4936
    ds_read_b64 v[152:153], v10 offset:5120
    ds_read_b64 v[154:155], v10 offset:5128
    ds_read_b64 v[156:157], v10 offset:5184
    ds_read_b64 v[158:159], v10 offset:5192
    ds_read_b64 v[120:121], v10 offset:5248
    ds_read_b64 v[122:123], v10 offset:5256
    ds_read_b64 v[124:125], v10 offset:5312
    ds_read_b64 v[126:127], v10 offset:5320
C_EE:
    v_mov_b32 v167, v19
    v_readfirstlane_b32 s39, v19
    v_mul_u32_u24 v5, 37, v1
    v_lshrrev_b32 v5, 8, v5
    v_mul_u32_u24 v5, 1040, v5
    v_add_u32 v5, v5, v3
    v_add_u32 v6, 0x2400, v5
    s_mul_i32 s44, s2, 18432
    s_mul_i32 s45, s38, 96
    s_add_u32 s44, s44, s45
    s_add_u32 s72, s4, s44
    s_addc_u32 s73, s5, 0
    s_add_u32 s74, s24, s45
    s_addc_u32 s75, s25, 0
    s_mul_i32 s58, s69, 1920
    s_add_u32 s58, s58, s71
    s_add_u32 s58, s58, 4352
    s_cmp_lt_u32 s38, 4
    s_cbranch_scc1 C_B5
    v_mov_b32 v40, -1
    v_mov_b32 v41, -1
    v_mov_b32 v42, -1
    v_mov_b32 v43, -1
    v_lshlrev_b32 v20, 4, v0
    v_lshlrev_b32 v21, 2, v0
    s_cmp_lg_u32 s65, 1
    s_cbranch_scc1 C_PO
    s_lshl_b32 s52, s38, 10
    s_add_u32 m0, s52, 47936
    v_add_u32 v18, 161412, v3
    s_movk_i32 s60, 4000
    s_branch C_UP_W
C_UP:
    buffer_load_dwordx4 v[24:27], v3, s[40:43], s56 offen offset:0 sc1
    buffer_load_dwordx4 v[28:31], v3, s[40:43], s56 offen offset:1024 sc1
    buffer_load_dwordx4 v[32:35], v3, s[40:43], s56 offen offset:2048 sc1
    buffer_load_dwordx4 v[36:39], v3, s[40:43], s56 offen offset:3072 sc1
C_UP_W:
    s_waitcnt vmcnt(0)
C_UP_C:
    v_xor_b32 v44, v167, v27
    v_xor_b32 v45, v167, v31
    v_xor_b32 v46, v167, v35
    v_xor_b32 v47, v167, v39
    v_or3_b32 v44, v44, v45, v46
    v_or_b32 v44, v44, v47
    v_cmp_ne_u32 vcc, 0, v44
    s_nop 0
    s_and_b64 exec, exec, vcc
    s_cbranch_execz C_UP_D
    s_wqm_b64 exec, exec
    s_sub_u32 s60, s60, 1
    s_cmp_gt_i32 s60, 0
    s_sleep 2
    s_cbranch_scc1 C_UP
C_UP_D:
    s_mov_b64 exec, -1
    ds_write_addtid_b32 v25 offset:55040
    ds_write_addtid_b32 v29 offset:55296
    ds_write_addtid_b32 v33 offset:55552
    ds_write_addtid_b32 v37 offset:55808
    s_mov_b64 exec, 0x2
    ds_inc_u32 v18, v18
    s_mov_b64 exec, -1
    ds_write_addtid_b32 v26 offset:60928
    ds_write_addtid_b32 v30 offset:61184
    ds_write_addtid_b32 v34 offset:61440
    ds_write_addtid_b32 v38 offset:61696
    s_mov_b64 exec, 0x4
    ds_inc_u32 v18, v18
    s_mov_b64 exec, -1
    ds_write_addtid_b32 v24 offset:49152
    ds_write_addtid_b32 v28 offset:49408
    ds_write_addtid_b32 v32 offset:49664
    ds_write_addtid_b32 v36 offset:49920
    s_mov_b64 exec, 0x1
    ds_inc_u32 v18, v18
    s_mov_b64 exec, -1
C_PO:
    s_cmp_ge_u32 s50, 144
    s_cbranch_scc1 C_B5
    buffer_store_dwordx4 v[40:43], v20, s[40:43], s48 offen sc1
    buffer_store_dword v40, v21, s[40:43], s49 offen sc1
C_B5:
    s_mov_b32 s56, 0xf7efdfbf
    s_mov_b32 s57, 0x7efdfb
    s_movk_i32 s60, 4000
C_UF:
    ds_read_b32 v16, v166 offset:132
    s_sub_u32 s60, s60, 1
    s_cmp_gt_i32 s60, 0
    s_waitcnt lgkmcnt(0)
    v_readfirstlane_b32 s52, v16
    s_nop 0
    s_cselect_b32 s52, s52, 4
    s_cmp_lg_u32 s52, 4
    s_cbranch_scc1 C_UF
    s_movk_i32 s60, 4000
    s_cmp_eq_u32 s63, 1
    s_cbranch_scc1 C_P1
    s_cmp_eq_u32 s63, 2
    s_cbranch_scc1 C_P2
    s_cmp_eq_u32 s63, 3
    s_cbranch_scc1 C_P3
    s_setprio 2
    ds_read_b128 v[32:35], v8 offset:3552
    ds_read_b128 v[36:39], v8 offset:4064
    ds_read_b128 v[40:43], v8 offset:3680
    s_waitcnt lgkmcnt(2)
    v_mfma_f32_16x16x32_bf16 v[136:139], v[112:115], v[32:35], 0
    v_mfma_f32_16x16x32_bf16 v[140:143], v[116:119], v[32:35], 0
    v_mfma_f32_16x16x32_bf16 v[144:147], v[128:131], v[32:35], 0
    v_mfma_f32_16x16x32_bf16 v[148:151], v[132:135], v[32:35], 0
    v_mfma_f32_16x16x32_bf16 v[28:31], v[52:55], v[32:35], 0
    v_mfma_f32_16x16x32_bf16 v[20:23], v[48:51], v[32:35], 0
    ds_read_b128 v[44:47], v8 offset:3808
    s_waitcnt lgkmcnt(2)
    v_mfma_f32_16x16x32_bf16 v[152:155], v[112:115], v[36:39], 0
    v_mfma_f32_16x16x32_bf16 v[156:159], v[116:119], v[36:39], 0
    v_mfma_f32_16x16x32_bf16 v[120:123], v[128:131], v[36:39], 0
    v_mfma_f32_16x16x32_bf16 v[124:127], v[132:135], v[36:39], 0
    v_mfma_f32_16x16x32_bf16 v[28:31], v[84:87], v[36:39], v[28:31]
    v_mfma_f32_16x16x32_bf16 v[20:23], v[80:83], v[36:39], v[20:23]
    v_mfma_f32_16x16x32_bf16 v[24:27], v[52:55], v[36:39], 0
    v_mfma_f32_16x16x32_bf16 v[16:19], v[48:51], v[36:39], 0
    v_cvt_pk_bf16_f32 v136, v136, v137
    v_cvt_pk_bf16_f32 v137, v138, v139
    ds_write_b64 v4, v[136:137] offset:680
    v_cvt_pk_bf16_f32 v140, v140, v141
    v_cvt_pk_bf16_f32 v141, v142, v143
    ds_write_b64 v4, v[140:141] offset:4136
    v_cvt_pk_bf16_f32 v144, v144, v145
    v_cvt_pk_bf16_f32 v145, v146, v147
    ds_write_b64 v4, v[144:145] offset:7592
    v_cvt_pk_bf16_f32 v148, v148, v149
    v_cvt_pk_bf16_f32 v149, v150, v151
    ds_write_b64 v4, v[148:149] offset:11048
    ds_read_b128 v[32:35], v8 offset:3936
    s_waitcnt lgkmcnt(6)
    v_mfma_f32_16x16x32_bf16 v[28:31], v[60:63], v[40:43], v[28:31]
    v_mfma_f32_16x16x32_bf16 v[20:23], v[56:59], v[40:43], v[20:23]
    v_cvt_pk_bf16_f32 v152, v152, v153
    v_cvt_pk_bf16_f32 v153, v154, v155
    ds_write_b64 v4, v[152:153] offset:136
    v_cvt_pk_bf16_f32 v156, v156, v157
    v_cvt_pk_bf16_f32 v157, v158, v159
    ds_write_b64 v4, v[156:157] offset:3592
    v_cvt_pk_bf16_f32 v120, v120, v121
    v_cvt_pk_bf16_f32 v121, v122, v123
    ds_write_b64 v4, v[120:121] offset:7048
    v_cvt_pk_bf16_f32 v124, v124, v125
    v_cvt_pk_bf16_f32 v125, v126, v127
    ds_write_b64 v4, v[124:125] offset:10504
    s_mov_b64 exec, 0x1
    ds_write_b32 v166, v166 offset:0
    s_mov_b64 exec, -1
    s_setprio 0
    ds_read_b128 v[84:87], v8 offset:4192
    ds_read_b64 v[160:161], v2 offset:512
    ds_read_b64 v[162:163], v2
    s_or_b32 s52, s38, s2
    s_cbranch_scc1 C_NOEP
    s_mov_b64 exec, 0x1
    buffer_store_dword v167, v10, s[40:43], 0 offen sc1
    s_mov_b64 exec, -1
C_NOEP:
    s_cmp_ge_u32 s2, 128
    s_cbranch_scc1 C_NX0
    s_mov_b32 m0, s58
    s_mov_b64 exec, s[56:57]
    global_load_lds_dwordx4 v5, s[72:73]
    s_add_u32 m0, s58, 896
    s_nop 0
    global_load_lds_dwordx4 v6, s[72:73]
    s_add_u32 m0, s58, 1792
    s_mov_b64 exec, 0x3f
    global_load_lds_dwordx4 v3, s[74:75]
    s_mov_b64 exec, -1
C_NX0:
    s_mov_b32 m0, 163328
    s_nop 0
    global_load_lds_dword v14, s[28:29]
    s_mov_b64 exec, 0xff
    global_load_lds_dword v13, s[28:29]
    global_load_lds_dword v13, s[26:27]
    global_load_lds_dword v12, s[30:31]
    s_mov_b64 exec, -1
    s_waitcnt lgkmcnt(13)
    v_mfma_f32_16x16x32_bf16 v[28:31], v[68:71], v[44:47], v[28:31]
    v_mfma_f32_16x16x32_bf16 v[20:23], v[64:67], v[44:47], v[20:23]
    ds_read_b128 v[80:83], v8 offset:4320
    s_waitcnt lgkmcnt(9)
    v_mfma_f32_16x16x32_bf16 v[28:31], v[76:79], v[32:35], v[28:31]
    v_mfma_f32_16x16x32_bf16 v[20:23], v[72:75], v[32:35], v[20:23]
    ds_read_b128 v[36:39], v8 offset:4448
    s_waitcnt lgkmcnt(2)
    v_and_b32 v48, 0xffff0000, v161
    v_lshlrev_b32 v49, 16, v161
    v_and_b32 v50, 0xffff0000, v160
    v_lshlrev_b32 v51, 16, v160
    v_mul_f32 v48, v48, v164
    v_mul_f32 v49, v49, v164
    v_mul_f32 v50, v50, v164
    v_mul_f32 v51, v51, v164
    v_cvt_pk_bf16_f32 v49, v48, v49
    v_lshlrev_b32 v48, 16, v49
    v_and_b32 v49, 0xffff0000, v49
    v_cvt_pk_bf16_f32 v51, v50, v51
    v_lshlrev_b32 v50, 16, v51
    v_and_b32 v51, 0xffff0000, v51
    v_and_b32 v52, 0xffff0000, v163
    v_lshlrev_b32 v53, 16, v163
    v_and_b32 v54, 0xffff0000, v162
    v_lshlrev_b32 v55, 16, v162
    v_mul_f32 v52, v52, v164
    v_mul_f32 v53, v53, v164
    v_mul_f32 v54, v54, v164
    v_mul_f32 v55, v55, v164
    v_cvt_pk_bf16_f32 v53, v52, v53
    v_lshlrev_b32 v52, 16, v53
    v_and_b32 v53, 0xffff0000, v53
    v_cvt_pk_bf16_f32 v55, v54, v55
    v_lshlrev_b32 v54, 16, v55
    v_and_b32 v55, 0xffff0000, v55
    v_mfma_f32_16x16x32_bf16 v[28:31], v[92:95], v[84:87], v[28:31]
    v_mfma_f32_16x16x32_bf16 v[20:23], v[88:91], v[84:87], v[20:23]
    v_mfma_f32_16x16x32_bf16 v[24:27], v[60:63], v[84:87], v[24:27]
    v_mfma_f32_16x16x32_bf16 v[16:19], v[56:59], v[84:87], v[16:19]
    s_waitcnt lgkmcnt(1)
    v_mfma_f32_16x16x32_bf16 v[28:31], v[100:103], v[80:83], v[28:31]
    v_mfma_f32_16x16x32_bf16 v[20:23], v[96:99], v[80:83], v[20:23]
    v_mfma_f32_16x16x32_bf16 v[24:27], v[68:71], v[80:83], v[24:27]
    v_mfma_f32_16x16x32_bf16 v[16:19], v[64:67], v[80:83], v[16:19]
    s_waitcnt lgkmcnt(0)
    v_mfma_f32_16x16x32_bf16 v[28:31], v[108:111], v[36:39], v[28:31]
    v_mfma_f32_16x16x32_bf16 v[20:23], v[104:107], v[36:39], v[20:23]
    v_mfma_f32_16x16x32_bf16 v[24:27], v[76:79], v[36:39], v[24:27]
    v_mfma_f32_16x16x32_bf16 v[16:19], v[72:75], v[36:39], v[16:19]
    s_mov_b32 exec_lo, 0xc000c000
    s_mov_b32 exec_hi, 0xc000c000
    s_nop 2
    ds_write_b128 v165, v[28:31] offset:128
    ds_write_b32 v166, v166 offset:64
    s_mov_b64 exec, -1
    s_setprio 0
    s_waitcnt vmcnt(7)
    s_cmp_lt_u32 s2, 128
    s_cbranch_scc1 C_EPI
    s_waitcnt vmcnt(4)
    s_branch C_EPI
C_P1:
    s_setprio 2
    ds_read_b128 v[32:35], v8 offset:2528
    ds_read_b128 v[36:39], v8 offset:3040
    ds_read_b128 v[40:43], v8 offset:2656
    s_waitcnt lgkmcnt(2)
    v_mfma_f32_16x16x32_bf16 v[144:147], v[128:131], v[32:35], 0
    v_mfma_f32_16x16x32_bf16 v[148:151], v[132:135], v[32:35], 0
    v_mfma_f32_16x16x32_bf16 v[152:155], v[136:139], v[32:35], 0
    v_mfma_f32_16x16x32_bf16 v[156:159], v[140:143], v[32:35], 0
    v_mfma_f32_16x16x32_bf16 v[28:31], v[52:55], v[32:35], 0
    v_mfma_f32_16x16x32_bf16 v[20:23], v[48:51], v[32:35], 0
    ds_read_b128 v[44:47], v8 offset:2784
    s_waitcnt lgkmcnt(2)
    v_mfma_f32_16x16x32_bf16 v[116:119], v[128:131], v[36:39], 0
    v_mfma_f32_16x16x32_bf16 v[160:163], v[132:135], v[36:39], 0
    v_mfma_f32_16x16x32_bf16 v[120:123], v[136:139], v[36:39], 0
    v_mfma_f32_16x16x32_bf16 v[124:127], v[140:143], v[36:39], 0
    v_mfma_f32_16x16x32_bf16 v[28:31], v[84:87], v[36:39], v[28:31]
    v_mfma_f32_16x16x32_bf16 v[20:23], v[80:83], v[36:39], v[20:23]
    v_mfma_f32_16x16x32_bf16 v[24:27], v[52:55], v[36:39], 0
    v_mfma_f32_16x16x32_bf16 v[16:19], v[48:51], v[36:39], 0
    v_cvt_pk_bf16_f32 v144, v144, v145
    v_cvt_pk_bf16_f32 v145, v146, v147
    ds_write_b64 v4, v[144:145] offset:1768
    v_cvt_pk_bf16_f32 v148, v148, v149
    v_cvt_pk_bf16_f32 v149, v150, v151
    ds_write_b64 v4, v[148:149] offset:5224
    v_cvt_pk_bf16_f32 v152, v152, v153
    v_cvt_pk_bf16_f32 v153, v154, v155
    ds_write_b64 v4, v[152:153] offset:8680
    v_cvt_pk_bf16_f32 v156, v156, v157
    v_cvt_pk_bf16_f32 v157, v158, v159
    ds_write_b64 v4, v[156:157] offset:12136
    ds_read_b128 v[32:35], v8 offset:2912
    s_waitcnt lgkmcnt(6)
    v_mfma_f32_16x16x32_bf16 v[28:31], v[60:63], v[40:43], v[28:31]
    v_mfma_f32_16x16x32_bf16 v[20:23], v[56:59], v[40:43], v[20:23]
    v_cvt_pk_bf16_f32 v116, v116, v117
    v_cvt_pk_bf16_f32 v117, v118, v119
    ds_write_b64 v4, v[116:117] offset:1224
    v_cvt_pk_bf16_f32 v160, v160, v161
    v_cvt_pk_bf16_f32 v161, v162, v163
    ds_write_b64 v4, v[160:161] offset:4680
    v_cvt_pk_bf16_f32 v120, v120, v121
    v_cvt_pk_bf16_f32 v121, v122, v123
    ds_write_b64 v4, v[120:121] offset:8136
    v_cvt_pk_bf16_f32 v124, v124, v125
    v_cvt_pk_bf16_f32 v125, v126, v127
    ds_write_b64 v4, v[124:125] offset:11592
    s_mov_b64 exec, 0x1
    ds_write_b32 v166, v166 offset:4
    s_mov_b64 exec, -1
    s_setprio 1
    ds_read_b128 v[36:39], v8 offset:3168
    ds_read_b64 v[144:145], v9 offset:4608
    ds_read_b64 v[146:147], v9 offset:4616
    ds_read_b64 v[148:149], v9 offset:4672
    ds_read_b64 v[150:151], v9 offset:4680
    ds_read_b64 v[152:153], v9 offset:4736
    ds_read_b64 v[154:155], v9 offset:4744
    ds_read_b64 v[156:157], v9 offset:4800
    ds_read_b64 v[158:159], v9 offset:4808
    ds_read_b64 v[160:161], v2 offset:512
    ds_read_b64 v[162:163], v2
    s_cmp_ge_u32 s2, 128
    s_cbranch_scc1 C_NX1
    s_mov_b32 m0, s58
    s_mov_b64 exec, s[56:57]
    global_load_lds_dwordx4 v5, s[72:73]
    s_add_u32 m0, s58, 896
    s_nop 0
    global_load_lds_dwordx4 v6, s[72:73]
    s_add_u32 m0, s58, 1792
    s_mov_b64 exec, 0x3f
    global_load_lds_dwordx4 v3, s[74:75]
    s_mov_b64 exec, -1
C_NX1:
    s_waitcnt lgkmcnt(15)
    v_mfma_f32_16x16x32_bf16 v[28:31], v[68:71], v[44:47], v[28:31]
    v_mfma_f32_16x16x32_bf16 v[20:23], v[64:67], v[44:47], v[20:23]
    ds_read_b128 v[40:43], v8 offset:3296
    v_mfma_f32_16x16x32_bf16 v[28:31], v[76:79], v[32:35], v[28:31]
    v_mfma_f32_16x16x32_bf16 v[20:23], v[72:75], v[32:35], v[20:23]
    ds_read_b128 v[128:131], v8 offset:3424
    s_waitcnt lgkmcnt(2)
    v_and_b32 v48, 0xffff0000, v161
    v_lshlrev_b32 v49, 16, v161
    v_and_b32 v50, 0xffff0000, v160
    v_lshlrev_b32 v51, 16, v160
    v_mul_f32 v48, v48, v164
    v_mul_f32 v49, v49, v164
    v_mul_f32 v50, v50, v164
    v_mul_f32 v51, v51, v164
    v_cvt_pk_bf16_f32 v49, v48, v49
    v_lshlrev_b32 v48, 16, v49
    v_and_b32 v49, 0xffff0000, v49
    v_cvt_pk_bf16_f32 v51, v50, v51
    v_lshlrev_b32 v50, 16, v51
    v_and_b32 v51, 0xffff0000, v51
    v_and_b32 v52, 0xffff0000, v163
    v_lshlrev_b32 v53, 16, v163
    v_and_b32 v54, 0xffff0000, v162
    v_lshlrev_b32 v55, 16, v162
    v_mul_f32 v52, v52, v164
    v_mul_f32 v53, v53, v164
    v_mul_f32 v54, v54, v164
    v_mul_f32 v55, v55, v164
    v_cvt_pk_bf16_f32 v53, v52, v53
    v_lshlrev_b32 v52, 16, v53
    v_and_b32 v53, 0xffff0000, v53
    v_cvt_pk_bf16_f32 v55, v54, v55
    v_lshlrev_b32 v54, 16, v55
    v_and_b32 v55, 0xffff0000, v55
    v_mfma_f32_16x16x32_bf16 v[28:31], v[92:95], v[36:39], v[28:31]
    v_mfma_f32_16x16x32_bf16 v[20:23], v[88:91], v[36:39], v[20:23]
    v_mfma_f32_16x16x32_bf16 v[24:27], v[60:63], v[36:39], v[24:27]
    v_mfma_f32_16x16x32_bf16 v[16:19], v[56:59], v[36:39], v[16:19]
    ds_read_b128 v[132:135], v8 offset:3552
    s_waitcnt lgkmcnt(2)
    v_mfma_f32_16x16x32_bf16 v[28:31], v[100:103], v[40:43], v[28:31]
    v_mfma_f32_16x16x32_bf16 v[20:23], v[96:99], v[40:43], v[20:23]
    v_mfma_f32_16x16x32_bf16 v[24:27], v[68:71], v[40:43], v[24:27]
    v_mfma_f32_16x16x32_bf16 v[16:19], v[64:67], v[40:43], v[16:19]
    ds_read_b96 v[60:62], v166
    ds_read_b128 v[136:139], v8 offset:3680
    s_waitcnt lgkmcnt(3)
    v_mfma_f32_16x16x32_bf16 v[28:31], v[108:111], v[128:131], v[28:31]
    v_mfma_f32_16x16x32_bf16 v[20:23], v[104:107], v[128:131], v[20:23]
    v_mfma_f32_16x16x32_bf16 v[24:27], v[76:79], v[128:131], v[24:27]
    v_mfma_f32_16x16x32_bf16 v[16:19], v[72:75], v[128:131], v[16:19]
    s_waitcnt lgkmcnt(1)
C_FL1:
    v_min3_u32 v60, v60, v61, v62
    v_cmp_eq_u32 vcc, 0, v60
    s_nop 4
    s_cbranch_vccz C_FD1
    ds_read_b96 v[60:62], v166
    s_sub_u32 s60, s60, 1
    s_cmp_gt_i32 s60, 0
    s_waitcnt lgkmcnt(0)
    s_cbranch_scc1 C_FL1
C_FD1:
    ds_read_b128 v[140:143], v8 offset:3808
    v_mfma_f32_16x16x32_bf16 v[20:23], v[112:115], v[132:135], v[20:23]
    v_mfma_f32_16x16x32_bf16 v[24:27], v[84:87], v[132:135], v[24:27]
    v_mfma_f32_16x16x32_bf16 v[16:19], v[80:83], v[132:135], v[16:19]
    s_mov_b32 exec_lo, 0xc000c000
    s_mov_b32 exec_hi, 0xc000c000
    ds_write_b128 v165, v[28:31] offset:256
    ds_write_b32 v166, v166 offset:68
    s_mov_b64 exec, -1
    ds_read_b128 v[44:47], v8 offset:3936
    s_waitcnt lgkmcnt(4)
    v_mfma_f32_16x16x32_bf16 v[24:27], v[92:95], v[136:139], v[24:27]
    v_mfma_f32_16x16x32_bf16 v[16:19], v[88:91], v[136:139], v[16:19]
    ds_read_b128 v[32:35], v8 offset:4064
    ds_read_b64_tr_b16 v[36:37], v11 offset:0
    ds_read_b64_tr_b16 v[38:39], v12 offset:0
    ds_read_b64_tr_b16 v[68:69], v11 offset:272
    ds_read_b64_tr_b16 v[70:71], v12 offset:272
    s_waitcnt lgkmcnt(8)
    v_mfma_f32_16x16x32_bf16 v[24:27], v[100:103], v[140:143], v[24:27]
    v_mfma_f32_16x16x32_bf16 v[16:19], v[96:99], v[140:143], v[16:19]
    ds_read_b64_tr_b16 v[64:65], v11 offset:544
    ds_read_b64_tr_b16 v[66:67], v12 offset:544
    s_waitcnt lgkmcnt(7)
    v_mfma_f32_16x16x32_bf16 v[24:27], v[108:111], v[44:47], v[24:27]
    v_mfma_f32_16x16x32_bf16 v[16:19], v[104:107], v[44:47], v[16:19]
    ds_read_b64_tr_b16 v[40:41], v11 offset:816
    ds_read_b64_tr_b16 v[42:43], v12 offset:816
    s_waitcnt lgkmcnt(8)
    v_mfma_f32_16x16x32_bf16 v[16:19], v[112:115], v[32:35], v[16:19]
    s_waitcnt lgkmcnt(6)
    v_mfma_f32_16x16x32_bf16 v[20:23], v[36:39], v[156:159], v[20:23]
    v_mfma_f32_16x16x32_bf16 v[16:19], v[36:39], v[148:151], v[16:19]
    s_waitcnt lgkmcnt(4)
    v_mfma_f32_16x16x32_bf16 v[20:23], v[68:71], v[152:155], v[20:23]
    v_mfma_f32_16x16x32_bf16 v[16:19], v[68:71], v[144:147], v[16:19]
    ds_read_b32 v60, v166 offset:64
    ds_read_b128 v[56:59], v165 offset:128
    s_waitcnt lgkmcnt(4)
    v_mfma_f32_16x16x32_bf16 v[20:23], v[64:67], v[148:151], v[20:23]
    s_waitcnt lgkmcnt(2)
    v_mfma_f32_16x16x32_bf16 v[20:23], v[40:43], v[144:147], v[20:23]
    s_setprio 0
    s_waitcnt lgkmcnt(0)
C_CL1:
    v_cmp_eq_u32 vcc, 0, v60
    s_nop 4
    s_cbranch_vccz C_CD
    ds_read_b32 v60, v166 offset:64
    ds_read_b128 v[56:59], v165 offset:128
    s_sub_u32 s60, s60, 1
    s_cmp_gt_i32 s60, 0
    s_waitcnt lgkmcnt(0)
    s_cbranch_scc1 C_CL1
    s_branch C_CD
C_P2:
    s_setprio 2
    ds_read_b128 v[32:35], v8 offset:1504
    ds_read_b128 v[36:39], v8 offset:2016
    ds_read_b128 v[40:43], v8 offset:1632
    s_waitcnt lgkmcnt(2)
    v_mfma_f32_16x16x32_bf16 v[116:119], v[152:155], v[32:35], 0
    v_mfma_f32_16x16x32_bf16 v[160:163], v[156:159], v[32:35], 0
    v_mfma_f32_16x16x32_bf16 v[28:31], v[52:55], v[32:35], 0
    v_mfma_f32_16x16x32_bf16 v[20:23], v[48:51], v[32:35], 0
    ds_read_b128 v[44:47], v8 offset:1760
    s_waitcnt lgkmcnt(2)
    v_mfma_f32_16x16x32_bf16 v[120:123], v[152:155], v[36:39], 0
    v_mfma_f32_16x16x32_bf16 v[124:127], v[156:159], v[36:39], 0
    v_mfma_f32_16x16x32_bf16 v[28:31], v[84:87], v[36:39], v[28:31]
    v_mfma_f32_16x16x32_bf16 v[20:23], v[80:83], v[36:39], v[20:23]
    v_mfma_f32_16x16x32_bf16 v[24:27], v[52:55], v[36:39], 0
    v_mfma_f32_16x16x32_bf16 v[16:19], v[48:51], v[36:39], 0
    v_cvt_pk_bf16_f32 v116, v116, v117
    v_cvt_pk_bf16_f32 v117, v118, v119
    ds_write_b64 v4, v[116:117] offset:2856
    v_cvt_pk_bf16_f32 v160, v160, v161
    v_cvt_pk_bf16_f32 v161, v162, v163
    ds_write_b64 v4, v[160:161] offset:6312
    ds_read_b128 v[32:35], v8 offset:1888
    s_waitcnt lgkmcnt(4)
    v_mfma_f32_16x16x32_bf16 v[28:31], v[60:63], v[40:43], v[28:31]
    v_mfma_f32_16x16x32_bf16 v[20:23], v[56:59], v[40:43], v[20:23]
    v_cvt_pk_bf16_f32 v120, v120, v121
    v_cvt_pk_bf16_f32 v121, v122, v123
    ds_write_b64 v4, v[120:121] offset:2312
    v_cvt_pk_bf16_f32 v124, v124, v125
    v_cvt_pk_bf16_f32 v125, v126, v127
    ds_write_b64 v4, v[124:125] offset:5768
    s_mov_b64 exec, 0x1
    ds_write_b32 v166, v166 offset:8
    s_mov_b64 exec, -1
    s_setprio 1
    ds_read_b128 v[36:39], v8 offset:2144
    ds_read_b64 v[116:117], v7 offset:1088
    ds_read_b64 v[118:119], v7 offset:1096
    ds_read_b64 v[120:121], v10 offset:5120
    ds_read_b64 v[122:123], v10 offset:5128
    ds_read_b64 v[124:125], v10 offset:5184
    ds_read_b64 v[126:127], v10 offset:5192
    ds_read_b64 v[160:161], v2 offset:512
    ds_read_b64 v[162:163], v2
    s_cmp_ge_u32 s2, 128
    s_cbranch_scc1 C_NX2
    s_mov_b32 m0, s58
    s_mov_b64 exec, s[56:57]
    global_load_lds_dwordx4 v5, s[72:73]
    s_add_u32 m0, s58, 896
    s_nop 0
    global_load_lds_dwordx4 v6, s[72:73]
    s_add_u32 m0, s58, 1792
    s_mov_b64 exec, 0x3f
    global_load_lds_dwordx4 v3, s[74:75]
    s_mov_b64 exec, -1
C_NX2:
    s_waitcnt lgkmcnt(15)
    v_mfma_f32_16x16x32_bf16 v[28:31], v[68:71], v[44:47], v[28:31]
    v_mfma_f32_16x16x32_bf16 v[20:23], v[64:67], v[44:47], v[20:23]
    ds_read_b128 v[40:43], v8 offset:2272
    s_waitcnt lgkmcnt(13)
    v_mfma_f32_16x16x32_bf16 v[28:31], v[76:79], v[32:35], v[28:31]
    v_mfma_f32_16x16x32_bf16 v[20:23], v[72:75], v[32:35], v[20:23]
    ds_read_b128 v[152:155], v8 offset:2400
    s_waitcnt lgkmcnt(2)
    v_and_b32 v48, 0xffff0000, v161
    v_lshlrev_b32 v49, 16, v161
    v_and_b32 v50, 0xffff0000, v160
    v_lshlrev_b32 v51, 16, v160
    v_mul_f32 v48, v48, v164
    v_mul_f32 v49, v49, v164
    v_mul_f32 v50, v50, v164
    v_mul_f32 v51, v51, v164
    v_cvt_pk_bf16_f32 v49, v48, v49
    v_lshlrev_b32 v48, 16, v49
    v_and_b32 v49, 0xffff0000, v49
    v_cvt_pk_bf16_f32 v51, v50, v51
    v_lshlrev_b32 v50, 16, v51
    v_and_b32 v51, 0xffff0000, v51
    v_and_b32 v52, 0xffff0000, v163
    v_lshlrev_b32 v53, 16, v163
    v_and_b32 v54, 0xffff0000, v162
    v_lshlrev_b32 v55, 16, v162
    v_mul_f32 v52, v52, v164
    v_mul_f32 v53, v53, v164
    v_mul_f32 v54, v54, v164
    v_mul_f32 v55, v55, v164
    v_cvt_pk_bf16_f32 v53, v52, v53
    v_lshlrev_b32 v52, 16, v53
    v_and_b32 v53, 0xffff0000, v53
    v_cvt_pk_bf16_f32 v55, v54, v55
    v_lshlrev_b32 v54, 16, v55
    v_and_b32 v55, 0xffff0000, v55
    v_mfma_f32_16x16x32_bf16 v[28:31], v[92:95], v[36:39], v[28:31]
    v_mfma_f32_16x16x32_bf16 v[20:23], v[88:91], v[36:39], v[20:23]
    v_mfma_f32_16x16x32_bf16 v[24:27], v[60:63], v[36:39], v[24:27]
    v_mfma_f32_16x16x32_bf16 v[16:19], v[56:59], v[36:39], v[16:19]
    ds_read_b128 v[156:159], v8 offset:2528
    s_waitcnt lgkmcnt(2)
    v_mfma_f32_16x16x32_bf16 v[28:31], v[100:103], v[40:43], v[28:31]
    v_mfma_f32_16x16x32_bf16 v[20:23], v[96:99], v[40:43], v[20:23]
    v_mfma_f32_16x16x32_bf16 v[24:27], v[68:71], v[40:43], v[24:27]
    v_mfma_f32_16x16x32_bf16 v[16:19], v[64:67], v[40:43], v[16:19]
    ds_read_b128 v[44:47], v8 offset:2656
    s_waitcnt lgkmcnt(2)
    v_mfma_f32_16x16x32_bf16 v[28:31], v[108:111], v[152:155], v[28:31]
    v_mfma_f32_16x16x32_bf16 v[20:23], v[104:107], v[152:155], v[20:23]
    v_mfma_f32_16x16x32_bf16 v[24:27], v[76:79], v[152:155], v[24:27]
    v_mfma_f32_16x16x32_bf16 v[16:19], v[72:75], v[152:155], v[16:19]
    ds_read_b128 v[32:35], v8 offset:2784
    s_waitcnt lgkmcnt(2)
    v_mfma_f32_16x16x32_bf16 v[20:23], v[112:115], v[156:159], v[20:23]
    v_mfma_f32_16x16x32_bf16 v[24:27], v[84:87], v[156:159], v[24:27]
    v_mfma_f32_16x16x32_bf16 v[16:19], v[80:83], v[156:159], v[16:19]
    s_mov_b32 exec_lo, 0xc000c000
    s_mov_b32 exec_hi, 0xc000c000
    ds_write_b128 v165, v[28:31] offset:384
    ds_write_b32 v166, v166 offset:72
    s_mov_b64 exec, -1
    ds_read_b96 v[60:62], v166
    ds_read_b128 v[36:39], v8 offset:2912
    s_waitcnt lgkmcnt(5)
    v_mfma_f32_16x16x32_bf16 v[24:27], v[92:95], v[44:47], v[24:27]
    v_mfma_f32_16x16x32_bf16 v[16:19], v[88:91], v[44:47], v[16:19]
    s_waitcnt lgkmcnt(1)
C_FL2:
    v_min3_u32 v60, v60, v61, v62
    v_cmp_eq_u32 vcc, 0, v60
    s_nop 4
    s_cbranch_vccz C_FD2
    ds_read_b96 v[60:62], v166
    s_sub_u32 s60, s60, 1
    s_cmp_gt_i32 s60, 0
    s_waitcnt lgkmcnt(0)
    s_cbranch_scc1 C_FL2
C_FD2:
    ds_read_b128 v[68:71], v8 offset:3040
    v_mfma_f32_16x16x32_bf16 v[24:27], v[100:103], v[32:35], v[24:27]
    v_mfma_f32_16x16x32_bf16 v[16:19], v[96:99], v[32:35], v[16:19]
    ds_read_b128 v[64:67], v8 offset:3552
    s_waitcnt lgkmcnt(2)
    v_mfma_f32_16x16x32_bf16 v[24:27], v[108:111], v[36:39], v[24:27]
    v_mfma_f32_16x16x32_bf16 v[16:19], v[104:107], v[36:39], v[16:19]
    ds_read_b128 v[40:43], v8 offset:4064
    ds_read_b64_tr_b16 v[76:77], v13 offset:6912
    ds_read_b64_tr_b16 v[78:79], v14 offset:6912
    ds_read_b64_tr_b16 v[72:73], v13 offset:7456
    ds_read_b64_tr_b16 v[74:75], v14 offset:7456
    s_waitcnt lgkmcnt(6)
    v_mfma_f32_16x16x32_bf16 v[16:19], v[112:115], v[68:71], v[16:19]
    ds_read_b64_tr_b16 v[152:153], v11 offset:0
    ds_read_b64_tr_b16 v[154:155], v12 offset:0
    s_waitcnt lgkmcnt(7)
    v_mfma_f32_16x16x32_bf16 v[20:23], v[116:119], v[64:67], v[20:23]
    ds_read_b64_tr_b16 v[84:85], v11 offset:272
    ds_read_b64_tr_b16 v[86:87], v12 offset:272
    s_waitcnt lgkmcnt(8)
    v_mfma_f32_16x16x32_bf16 v[16:19], v[116:119], v[40:43], v[16:19]
    ds_read_b64_tr_b16 v[80:81], v11 offset:544
    ds_read_b64_tr_b16 v[82:83], v12 offset:544
    s_waitcnt lgkmcnt(8)
    v_mfma_f32_16x16x32_bf16 v[20:23], v[76:79], v[124:127], v[20:23]
    v_mfma_f32_16x16x32_bf16 v[16:19], v[76:79], v[120:123], v[16:19]
    ds_read_b64_tr_b16 v[156:157], v11 offset:816
    ds_read_b64_tr_b16 v[158:159], v12 offset:816
    s_waitcnt lgkmcnt(8)
    v_mfma_f32_16x16x32_bf16 v[20:23], v[72:75], v[120:123], v[20:23]
    ds_read_b64_tr_b16 v[92:93], v11 offset:1088
    ds_read_b64_tr_b16 v[94:95], v12 offset:1088
    s_waitcnt lgkmcnt(8)
    v_mfma_f32_16x16x32_bf16 v[16:19], v[152:155], v[148:151], v[16:19]
    ds_read_b64_tr_b16 v[88:89], v11 offset:1360
    ds_read_b64_tr_b16 v[90:91], v12 offset:1360
    s_waitcnt lgkmcnt(8)
    v_mfma_f32_16x16x32_bf16 v[16:19], v[84:87], v[144:147], v[16:19]
    ds_read_b64_tr_b16 v[44:45], v11 offset:1632
    ds_read_b64_tr_b16 v[46:47], v12 offset:1632
    s_waitcnt lgkmcnt(8)
    v_mfma_f32_16x16x32_bf16 v[20:23], v[80:83], v[148:151], v[20:23]
    v_mfma_f32_16x16x32_bf16 v[16:19], v[80:83], v[140:143], v[16:19]
    ds_read_b64_tr_b16 v[100:101], v11 offset:1904
    ds_read_b64_tr_b16 v[102:103], v12 offset:1904
    s_waitcnt lgkmcnt(8)
    v_mfma_f32_16x16x32_bf16 v[20:23], v[156:159], v[144:147], v[20:23]
    v_mfma_f32_16x16x32_bf16 v[16:19], v[156:159], v[136:139], v[16:19]
    s_waitcnt lgkmcnt(6)
    v_mfma_f32_16x16x32_bf16 v[20:23], v[92:95], v[140:143], v[20:23]
    v_mfma_f32_16x16x32_bf16 v[16:19], v[92:95], v[132:135], v[16:19]
    s_waitcnt lgkmcnt(4)
    v_mfma_f32_16x16x32_bf16 v[20:23], v[88:91], v[136:139], v[20:23]
    v_mfma_f32_16x16x32_bf16 v[16:19], v[88:91], v[128:131], v[16:19]
    ds_read_b32 v60, v166 offset:68
    ds_read_b128 v[56:59], v165 offset:256
    s_waitcnt lgkmcnt(4)
    v_mfma_f32_16x16x32_bf16 v[20:23], v[44:47], v[132:135], v[20:23]
    s_waitcnt lgkmcnt(2)
    v_mfma_f32_16x16x32_bf16 v[20:23], v[100:103], v[128:131], v[20:23]
    s_setprio 0
    s_waitcnt lgkmcnt(0)
C_CL2:
    v_cmp_eq_u32 vcc, 0, v60
    s_nop 4
    s_cbranch_vccz C_CD
    ds_read_b32 v60, v166 offset:68
    ds_read_b128 v[56:59], v165 offset:256
    s_sub_u32 s60, s60, 1
    s_cmp_gt_i32 s60, 0
    s_waitcnt lgkmcnt(0)
    s_cbranch_scc1 C_CL2
    s_branch C_CD
C_P3:
    s_setprio 1
    ds_read_b128 v[32:35], v8 offset:480
    ds_read_b128 v[36:39], v8 offset:608
    ds_read_b128 v[40:43], v8 offset:736
    ds_read_b64 v[160:161], v2 offset:512
    ds_read_b64 v[162:163], v2
    s_waitcnt lgkmcnt(4)
    v_mfma_f32_16x16x32_bf16 v[28:31], v[52:55], v[32:35], 0
    v_mfma_f32_16x16x32_bf16 v[20:23], v[48:51], v[32:35], 0
    ds_read_b128 v[44:47], v8 offset:864
    s_waitcnt lgkmcnt(4)
    v_mfma_f32_16x16x32_bf16 v[28:31], v[60:63], v[36:39], v[28:31]
    v_mfma_f32_16x16x32_bf16 v[20:23], v[56:59], v[36:39], v[20:23]
    s_cmp_ge_u32 s2, 128
    s_cbranch_scc1 C_NX3
    s_mov_b32 m0, s58
    s_mov_b64 exec, s[56:57]
    global_load_lds_dwordx4 v5, s[72:73]
    s_add_u32 m0, s58, 896
    s_nop 0
    global_load_lds_dwordx4 v6, s[72:73]
    s_add_u32 m0, s58, 1792
    s_mov_b64 exec, 0x3f
    global_load_lds_dwordx4 v3, s[74:75]
    s_mov_b64 exec, -1
C_NX3:
    ds_read_b128 v[32:35], v8 offset:992
    s_waitcnt lgkmcnt(4)
    v_mfma_f32_16x16x32_bf16 v[28:31], v[68:71], v[40:43], v[28:31]
    v_mfma_f32_16x16x32_bf16 v[20:23], v[64:67], v[40:43], v[20:23]
    ds_read_b128 v[36:39], v8 offset:1120
    s_waitcnt lgkmcnt(2)
    v_mfma_f32_16x16x32_bf16 v[28:31], v[76:79], v[44:47], v[28:31]
    v_mfma_f32_16x16x32_bf16 v[20:23], v[72:75], v[44:47], v[20:23]
    ds_read_b128 v[40:43], v8 offset:1248
    s_waitcnt lgkmcnt(2)
    v_mfma_f32_16x16x32_bf16 v[28:31], v[84:87], v[32:35], v[28:31]
    v_mfma_f32_16x16x32_bf16 v[20:23], v[80:83], v[32:35], v[20:23]
    v_mfma_f32_16x16x32_bf16 v[24:27], v[52:55], v[32:35], 0
    v_mfma_f32_16x16x32_bf16 v[16:19], v[48:51], v[32:35], 0
    ds_read_b128 v[44:47], v8 offset:1376
    s_waitcnt lgkmcnt(2)
    v_mfma_f32_16x16x32_bf16 v[28:31], v[92:95], v[36:39], v[28:31]
    v_mfma_f32_16x16x32_bf16 v[20:23], v[88:91], v[36:39], v[20:23]
    v_mfma_f32_16x16x32_bf16 v[24:27], v[60:63], v[36:39], v[24:27]
    v_mfma_f32_16x16x32_bf16 v[16:19], v[56:59], v[36:39], v[16:19]
    ds_read_b128 v[32:35], v8 offset:1504
    v_and_b32 v48, 0xffff0000, v161
    v_lshlrev_b32 v49, 16, v161
    v_and_b32 v50, 0xffff0000, v160
    v_lshlrev_b32 v51, 16, v160
    v_mul_f32 v48, v48, v164
    v_mul_f32 v49, v49, v164
    v_mul_f32 v50, v50, v164
    v_mul_f32 v51, v51, v164
    v_cvt_pk_bf16_f32 v49, v48, v49
    v_lshlrev_b32 v48, 16, v49
    v_and_b32 v49, 0xffff0000, v49
    v_cvt_pk_bf16_f32 v51, v50, v51
    v_lshlrev_b32 v50, 16, v51
    v_and_b32 v51, 0xffff0000, v51
    v_and_b32 v52, 0xffff0000, v163
    v_lshlrev_b32 v53, 16, v163
    v_and_b32 v54, 0xffff0000, v162
    v_lshlrev_b32 v55, 16, v162
    v_mul_f32 v52, v52, v164
    v_mul_f32 v53, v53, v164
    v_mul_f32 v54, v54, v164
    v_mul_f32 v55, v55, v164
    v_cvt_pk_bf16_f32 v53, v52, v53
    v_lshlrev_b32 v52, 16, v53
    v_and_b32 v53, 0xffff0000, v53
    v_cvt_pk_bf16_f32 v55, v54, v55
    v_lshlrev_b32 v54, 16, v55
    v_and_b32 v55, 0xffff0000, v55
    s_waitcnt lgkmcnt(2)
    v_mfma_f32_16x16x32_bf16 v[28:31], v[100:103], v[40:43], v[28:31]
    v_mfma_f32_16x16x32_bf16 v[20:23], v[96:99], v[40:43], v[20:23]
    v_mfma_f32_16x16x32_bf16 v[24:27], v[68:71], v[40:43], v[24:27]
    v_mfma_f32_16x16x32_bf16 v[16:19], v[64:67], v[40:43], v[16:19]
    ds_read_b128 v[36:39], v8 offset:1632
    s_waitcnt lgkmcnt(2)
    v_mfma_f32_16x16x32_bf16 v[28:31], v[108:111], v[44:47], v[28:31]
    v_mfma_f32_16x16x32_bf16 v[20:23], v[104:107], v[44:47], v[20:23]
    v_mfma_f32_16x16x32_bf16 v[24:27], v[76:79], v[44:47], v[24:27]
    v_mfma_f32_16x16x32_bf16 v[16:19], v[72:75], v[44:47], v[16:19]
    ds_read_b128 v[68:71], v8 offset:1760
    s_waitcnt lgkmcnt(2)
    v_mfma_f32_16x16x32_bf16 v[20:23], v[112:115], v[32:35], v[20:23]
    v_mfma_f32_16x16x32_bf16 v[24:27], v[84:87], v[32:35], v[24:27]
    v_mfma_f32_16x16x32_bf16 v[16:19], v[80:83], v[32:35], v[16:19]
    ds_read_b96 v[60:62], v166
    ds_read_b128 v[64:67], v8 offset:1888
    s_waitcnt lgkmcnt(3)
    v_mfma_f32_16x16x32_bf16 v[24:27], v[92:95], v[36:39], v[24:27]
    v_mfma_f32_16x16x32_bf16 v[16:19], v[88:91], v[36:39], v[16:19]
    s_waitcnt lgkmcnt(1)
C_FL3:
    v_min3_u32 v60, v60, v61, v62
    v_cmp_eq_u32 vcc, 0, v60
    s_nop 4
    s_cbranch_vccz C_FD3
    ds_read_b96 v[60:62], v166
    s_sub_u32 s60, s60, 1
    s_cmp_gt_i32 s60, 0
    s_waitcnt lgkmcnt(0)
    s_cbranch_scc1 C_FL3
C_FD3:
    ds_read_b128 v[40:43], v8 offset:2016
    v_mfma_f32_16x16x32_bf16 v[24:27], v[100:103], v[68:71], v[24:27]
    v_mfma_f32_16x16x32_bf16 v[16:19], v[96:99], v[68:71], v[16:19]
    ds_read_b128 v[76:79], v8 offset:2528
    s_waitcnt lgkmcnt(2)
    v_mfma_f32_16x16x32_bf16 v[24:27], v[108:111], v[64:67], v[24:27]
    v_mfma_f32_16x16x32_bf16 v[16:19], v[104:107], v[64:67], v[16:19]
    ds_read_b128 v[72:75], v8 offset:3040
    ds_read_b64_tr_b16 v[44:45], v13 offset:6912
    ds_read_b64_tr_b16 v[46:47], v14 offset:6912
    ds_read_b64_tr_b16 v[84:85], v13 offset:7456
    ds_read_b64_tr_b16 v[86:87], v14 offset:7456
    s_waitcnt lgkmcnt(6)
    v_mfma_f32_16x16x32_bf16 v[16:19], v[112:115], v[40:43], v[16:19]
    ds_read_b64_tr_b16 v[80:81], v13 offset:8000
    ds_read_b64_tr_b16 v[82:83], v14 offset:8000
    s_waitcnt lgkmcnt(7)
    v_mfma_f32_16x16x32_bf16 v[20:23], v[116:119], v[76:79], v[20:23]
    ds_read_b64_tr_b16 v[32:33], v13 offset:8544
    ds_read_b64_tr_b16 v[34:35], v14 offset:8544
    s_waitcnt lgkmcnt(8)
    v_mfma_f32_16x16x32_bf16 v[16:19], v[116:119], v[72:75], v[16:19]
    ds_read_b64_tr_b16 v[92:93], v11 offset:1088
    ds_read_b64_tr_b16 v[94:95], v12 offset:1088
    s_waitcnt lgkmcnt(8)
    v_mfma_f32_16x16x32_bf16 v[20:23], v[44:47], v[124:127], v[20:23]
    v_mfma_f32_16x16x32_bf16 v[16:19], v[44:47], v[120:123], v[16:19]
    ds_read_b64_tr_b16 v[88:89], v11 offset:1360
    ds_read_b64_tr_b16 v[90:91], v12 offset:1360
    s_waitcnt lgkmcnt(8)
    v_mfma_f32_16x16x32_bf16 v[20:23], v[84:87], v[120:123], v[20:23]
    v_mfma_f32_16x16x32_bf16 v[16:19], v[84:87], v[156:159], v[16:19]
    ds_read_b64_tr_b16 v[36:37], v11 offset:1632
    ds_read_b64_tr_b16 v[38:39], v12 offset:1632
    s_waitcnt lgkmcnt(8)
    v_mfma_f32_16x16x32_bf16 v[20:23], v[80:83], v[156:159], v[20:23]
    v_mfma_f32_16x16x32_bf16 v[16:19], v[80:83], v[152:155], v[16:19]
    ds_read_b64_tr_b16 v[100:101], v11 offset:1904
    ds_read_b64_tr_b16 v[102:103], v12 offset:1904
    s_waitcnt lgkmcnt(8)
    v_mfma_f32_16x16x32_bf16 v[20:23], v[32:35], v[152:155], v[20:23]
    ds_read_b64_tr_b16 v[96:97], v11 offset:2176
    ds_read_b64_tr_b16 v[98:99], v12 offset:2176
    s_waitcnt lgkmcnt(8)
    v_mfma_f32_16x16x32_bf16 v[16:19], v[92:95], v[148:151], v[16:19]
    ds_read_b64_tr_b16 v[68:69], v11 offset:2448
    ds_read_b64_tr_b16 v[70:71], v12 offset:2448
    s_waitcnt lgkmcnt(8)
    v_mfma_f32_16x16x32_bf16 v[16:19], v[88:91], v[144:147], v[16:19]
    ds_read_b64_tr_b16 v[108:109], v11 offset:2720
    ds_read_b64_tr_b16 v[110:111], v12 offset:2720
    s_waitcnt lgkmcnt(8)
    v_mfma_f32_16x16x32_bf16 v[20:23], v[36:39], v[148:151], v[20:23]
    v_mfma_f32_16x16x32_bf16 v[16:19], v[36:39], v[140:143], v[16:19]
    ds_read_b64_tr_b16 v[104:105], v11 offset:2992
    ds_read_b64_tr_b16 v[106:107], v12 offset:2992
    s_waitcnt lgkmcnt(8)
    v_mfma_f32_16x16x32_bf16 v[20:23], v[100:103], v[144:147], v[20:23]
    v_mfma_f32_16x16x32_bf16 v[16:19], v[100:103], v[136:139], v[16:19]
    s_waitcnt lgkmcnt(6)
    v_mfma_f32_16x16x32_bf16 v[20:23], v[96:99], v[140:143], v[20:23]
    v_mfma_f32_16x16x32_bf16 v[16:19], v[96:99], v[132:135], v[16:19]
    s_waitcnt lgkmcnt(4)
    v_mfma_f32_16x16x32_bf16 v[20:23], v[68:71], v[136:139], v[20:23]
    v_mfma_f32_16x16x32_bf16 v[16:19], v[68:71], v[128:131], v[16:19]
    ds_read_b32 v60, v166 offset:72
    ds_read_b128 v[56:59], v165 offset:384
    s_waitcnt lgkmcnt(4)
    v_mfma_f32_16x16x32_bf16 v[20:23], v[108:111], v[132:135], v[20:23]
    s_waitcnt lgkmcnt(2)
    v_mfma_f32_16x16x32_bf16 v[20:23], v[104:107], v[128:131], v[20:23]
    s_setprio 0
    s_waitcnt lgkmcnt(0)
C_CL3:
    v_cmp_eq_u32 vcc, 0, v60
    s_nop 4
    s_cbranch_vccz C_CD
    ds_read_b32 v60, v166 offset:72
    ds_read_b128 v[56:59], v165 offset:384
    s_sub_u32 s60, s60, 1
    s_cmp_gt_i32 s60, 0
    s_waitcnt lgkmcnt(0)
    s_cbranch_scc1 C_CL3
C_CD:
    s_waitcnt vmcnt(3)
    s_cmp_lt_u32 s2, 128
    s_cbranch_scc1 C_CD2
    s_waitcnt vmcnt(0)
C_CD2:
    s_mov_b32 exec_lo, 0x30003
    s_mov_b32 exec_hi, 0x30003
    s_nop 4
    v_pk_add_f32 v[16:17], v[16:17], v[56:57]
    v_pk_add_f32 v[18:19], v[18:19], v[58:59]
    s_mov_b64 exec, -1
C_EPI:
    s_nop 3
    s_movk_i32 s54, 0x3f80
    s_mov_b32 s55, 1.0
    v_add_f32_dpp v16, v24, v16 row_shr:2 row_mask:0xf bank_mask:0xf
    v_add_f32_dpp v17, v25, v17 row_shr:2 row_mask:0xf bank_mask:0xf
    v_add_f32_dpp v18, v26, v18 row_shr:2 row_mask:0xf bank_mask:0xf
    v_add_f32_dpp v19, v27, v19 row_shr:2 row_mask:0xf bank_mask:0xf
    v_add_f32_dpp v20, v28, v20 row_shr:2 row_mask:0xf bank_mask:0xf
    v_add_f32_dpp v21, v29, v21 row_shr:2 row_mask:0xf bank_mask:0xf
    v_add_f32_dpp v22, v30, v22 row_shr:2 row_mask:0xf bank_mask:0xf
    v_add_f32_dpp v23, v31, v23 row_shr:2 row_mask:0xf bank_mask:0xf
    v_add_f32_dpp v20, v24, v20 row_shl:14 row_mask:0xf bank_mask:0xf
    v_add_f32_dpp v21, v25, v21 row_shl:14 row_mask:0xf bank_mask:0xf
    v_add_f32_dpp v22, v26, v22 row_shl:14 row_mask:0xf bank_mask:0xf
    v_add_f32_dpp v23, v27, v23 row_shl:14 row_mask:0xf bank_mask:0xf
    v_cvt_pk_bf16_f32 v16, v16, v17
    v_cvt_pk_bf16_f32 v17, v18, v19
    v_cvt_pk_bf16_f32 v18, v20, v21
    v_cvt_pk_bf16_f32 v19, v22, v23
    v_dot2c_f32_bf16 v48, s54, v16
    v_dot2c_f32_bf16 v49, s55, v16
    v_dot2c_f32_bf16 v50, s54, v17
    v_dot2c_f32_bf16 v51, s55, v17
    v_dot2c_f32_bf16 v52, s54, v18
    v_dot2c_f32_bf16 v53, s55, v18
    v_dot2c_f32_bf16 v54, s54, v19
    v_dot2c_f32_bf16 v55, s55, v19
    v_cvt_pk_bf16_f32 v48, v48, v49
    v_cvt_pk_bf16_f32 v49, v50, v51
    ds_write_b64 v15, v[48:49] offset:0
    v_cvt_pk_bf16_f32 v52, v52, v53
    v_cvt_pk_bf16_f32 v53, v54, v55
    ds_write_b64 v15, v[52:53] offset:544
    s_cmp_ge_u32 s38, 8
    s_cbranch_scc1 C_NOGA
    v_lshrrev_b32 v7, 5, v0
    v_lshlrev_b32 v7, 3, v7
    v_lshl_add_u32 v7, v0, 2, v7
    v_add_u32 v7, 48960, v7
    v_lshrrev_b32 v8, 3, v0
    v_mul_u32_u24 v8, 0x6000, v8
    v_and_b32 v9, 7, v0
    v_lshl_add_u32 v8, v9, 4, v8
    s_lshr_b32 s52, s2, 4
    s_lshl_b32 s52, s52, 11
    s_and_b32 s53, s2, 1
    s_lshl_b32 s53, s53, 10
    s_add_u32 s52, s52, s53
    s_bfe_u32 s53, s2, 0x30001
    s_lshl_b32 s53, s53, 7
    s_add_u32 s52, s52, s53
    s_add_u32 s52, s52, 3211264
    s_add_u32 s53, s52, 1572864
    v_mov_b32 v27, v167
    v_mov_b32 v31, v167
C_NOGA:
    s_waitcnt lgkmcnt(0)
    s_barrier
    s_cmp_ge_u32 s38, 8
    s_cbranch_scc1 C_NOST
    ds_read_b32 v24, v7 offset:0
    ds_read_b32 v25, v7 offset:17408
    ds_read_b32 v26, v7 offset:34816
    ds_read_b32 v28, v7 offset:2176
    ds_read_b32 v29, v7 offset:19584
    ds_read_b32 v30, v7 offset:36992
    s_waitcnt lgkmcnt(3)
    buffer_store_dwordx4 v[24:27], v8, s[40:43], s52 offen sc1
    s_waitcnt lgkmcnt(0)
    buffer_store_dwordx4 v[28:31], v8, s[40:43], s53 offen sc1
C_NOST:
    s_cmp_ge_u32 s2, 176
    s_cbranch_scc1 FFN_LATE
    s_cmp_ge_u32 s2, 128
    s_cbranch_scc1 FINAL
    v_and_b32 v7, 7, v1
    v_lshrrev_b32 v8, 3, v1
    s_mul_i32 s44, s2, 18432
    s_mul_i32 s45, s38, 96
    v_mul_u32_u24 v9, 0xe0, v7
    v_mad_u32_u24 v9, v8, 12, v9
    v_add_u32 v9, s58, v9
    v_xor_b32 v10, 1, v8
    v_mad_u32_u24 v13, v10, 12, s58
    s_mul_i32 s47, s2, 24576
    s_lshl_b32 s48, s38, 11
    s_add_u32 s47, s47, s48
    s_add_u32 s47, s47, 3211264
    v_mul_u32_u24 v84, 48, v7
    v_bfe_u32 v10, v1, 3, 1
    v_lshl_add_u32 v84, v10, 2, v84
    s_lshl_b32 s49, s69, 3
    s_add_u32 s49, s49, s71
    s_add_u32 s49, s49, 14336
    v_add_u32 v84, s49, v84
    v_mul_u32_u24 v85, 48, v1
    v_add_u32 v85, 60992, v85
    s_mov_b32 exec_lo, 0xf0000f
    s_mov_b32 exec_hi, 0xf0000f00
    v_subrev_u32 v84, 1536, v84
    s_mov_b32 exec_lo, 0xff000000
    s_mov_b32 exec_hi, 0xff0000
    v_subrev_u32 v84, 768, v84
    s_mov_b32 exec_lo, 0xff00
    s_mov_b32 exec_hi, 0xff
    v_subrev_u32 v84, 2304, v84
    s_mov_b64 exec, -1
    s_add_u32 s48, s48, 0
    v_and_b32 v10, 6, v7
    v_xor_b32 v10, v10, v8
    v_lshl_add_u32 v10, v7, 3, v10
    v_lshl_add_u32 v86, v10, 4, s48
    v_and_b32 v10, 6, v8
    v_xor_b32 v10, v10, v1
    v_lshl_add_u32 v87, v10, 4, s48
    v_mul_u32_u24 v88, 2944, v8
    v_add_u32 v88, v88, v3
    s_mul_i32 s48, s2, 24576
    s_lshl_b32 s49, s38, 7
    s_add_u32 s48, s48, s49
    s_add_u32 s48, s48, 6356992
    v_mul_u32_u24 v89, 2336, v7
    v_mad_u32_u24 v89, v8, 12, v89
    s_add_u32 s45, s45, 24576
    v_add_u32 v89, s45, v89
    v_add_u32 v10, 1536, v0
    v_add_u32 v11, 0, v0
    v_mul_u32_u24 v11, 911, v11
    v_lshrrev_b32 v11, 16, v11
    v_add_lshl_u32 v90, v10, v11, 4
    v_add_u32 v10, 2304, v0
    v_add_u32 v11, 768, v0
    v_mul_u32_u24 v11, 911, v11
    v_lshrrev_b32 v11, 16, v11
    v_add_lshl_u32 v91, v10, v11, 4
    v_lshl_add_u32 v92, v0, 4, s44
    v_bfe_u32 v10, v1, 3, 1
    v_lshl_add_u32 v10, v7, 1, v10
    s_lshl_b32 s49, s2, 4
    v_add_u32 v93, s49, v10
    v_sub_u32 v12, 0x7ff, v93
    v_lshlrev_b32 v93, 2, v93
    s_mov_b32 s49, 32768
    v_mov_b32 v51, 0
    v_mov_b32 v55, 0
    v_mov_b32 v76, 0
    v_mov_b32 v56, 0
    v_mov_b32 v57, 0
    v_mov_b32 v58, 0
    v_mov_b32 v59, 0
    v_mov_b32 v60, 0
    v_mov_b32 v61, 0
    v_mov_b32 v62, 0
    v_mov_b32 v63, 0
    s_lshl_b32 s50, s2, 6
    s_lshl_b32 s51, s38, 2
    s_add_u32 s50, s50, s51
    s_add_u32 s50, s50, 8192
    s_mov_b32 s56, 0x00100001
    s_mov_b32 s57, 0x10000100
    s_mov_b32 s58, 0xffff0000
    s_waitcnt vmcnt(0)
    buffer_load_dwordx4 v[28:31], v3, s[40:43], s47 offen sc1
    buffer_load_dwordx4 v[32:35], v3, s[40:43], s47 offen offset:1024 sc1
    ds_read_b32 v24, v13 offset:1792
    ds_read_b32 v25, v13 offset:1796
    ds_read_b32 v26, v13 offset:1800
    ds_read2_b32 v[16:17], v9 offset0:0 offset1:1
    ds_read2_b32 v[18:19], v9 offset0:2 offset1:28
    ds_read2_b32 v[20:21], v9 offset0:29 offset1:30
    s_waitcnt lgkmcnt(0)
    v_dot2c_f32_bf16 v76, 0x3f803f80, v24
    v_dot2c_f32_bf16 v76, 0x3f803f80, v25
    v_dot2c_f32_bf16 v76, 0x3f803f80, v26
    v_lshlrev_b32 v36, 16, v16
    v_and_b32 v37, 0xffff0000, v16
    v_lshlrev_b32 v42, 16, v19
    v_and_b32 v43, 0xffff0000, v19
    v_lshlrev_b32 v38, 16, v17
    v_and_b32 v39, 0xffff0000, v17
    v_lshlrev_b32 v44, 16, v20
    v_and_b32 v45, 0xffff0000, v20
    v_lshlrev_b32 v40, 16, v18
    v_and_b32 v41, 0xffff0000, v18
    v_lshlrev_b32 v46, 16, v21
    v_and_b32 v47, 0xffff0000, v21
    v_mov_b32 v77, v76
    s_nop 1
    v_permlane16_swap_b32 v76, v77
    v_add_f32 v76, v76, v77
    v_mov_b32 v77, v76
    s_nop 1
    v_permlane32_swap_b32 v76, v77
    v_add_f32 v76, v76, v77
    s_mov_b32 exec_lo, 0xf00f0
    s_mov_b32 exec_hi, 0xf00f000
    ds_write2_b32 v84, v76, v76 offset0:0 offset1:96
    s_mov_b32 exec_lo, 0xf0f0f0f
    s_mov_b32 exec_hi, 0xf0f0f0f
    v_mov_b32 v24, 0x3f803f80
    v_mov_b32 v25, 0x3f803f80
    v_mov_b32 v26, 0x3f803f80
    s_mov_b32 exec_lo, 0x11111111
    s_mov_b32 exec_hi, 0x11111111
    v_mov_b32 v56, v24
    v_mov_b32 v57, v25
    v_mov_b32 v58, v26
    s_mov_b32 exec_lo, 0x22222222
    s_mov_b32 exec_hi, 0x22222222
    v_mov_b32 v60, v24
    v_mov_b32 v61, v25
    v_mov_b32 v62, v26
    s_mov_b64 exec, -1
    s_movk_i32 s60, 4000
    s_branch L_YP_W
L_YP:
    buffer_load_dwordx4 v[28:31], v3, s[40:43], s47 offen sc1
    buffer_load_dwordx4 v[32:35], v3, s[40:43], s47 offen offset:1024 sc1
L_YP_W:
    s_waitcnt vmcnt(0)
L_YP_C:
    v_xor_b32 v10, v167, v31
    v_xor_b32 v11, v167, v35
    v_or_b32 v10, v10, v11
    v_cmp_ne_u32 vcc, 0, v10
    s_nop 0
    s_and_b64 exec, exec, vcc
    s_cbranch_execz L_YP_D
    s_wqm_b64 exec, exec
    s_sub_u32 s60, s60, 1
    s_cmp_gt_i32 s60, 0
    s_sleep 1
    s_cbranch_scc1 L_YP
L_YP_D:
    s_mov_b64 exec, -1
    v_dot2c_f32_bf16 v36, s54, v28
    v_dot2c_f32_bf16 v37, s54, v29
    v_dot2c_f32_bf16 v38, s54, v30
    v_dot2c_f32_bf16 v39, s54, v34
    v_dot2c_f32_bf16 v40, s54, v32
    v_dot2c_f32_bf16 v41, s54, v33
    v_dot2c_f32_bf16 v42, s55, v28
    v_dot2c_f32_bf16 v43, s55, v29
    v_dot2c_f32_bf16 v44, s55, v30
    v_dot2c_f32_bf16 v45, s55, v34
    v_cvt_pk_bf16_f32 v48, v36, v37
    v_dot2c_f32_bf16 v46, s55, v32
    v_cvt_pk_bf16_f32 v49, v38, v39
    v_dot2c_f32_bf16 v47, s55, v33
    v_cvt_pk_bf16_f32 v50, v40, v41
    v_cvt_pk_bf16_f32 v52, v42, v43
    v_cvt_pk_bf16_f32 v53, v44, v45
    v_mfma_f32_16x16x32_bf16 v[68:71], v[48:51], v[48:51], 0
    v_cvt_pk_bf16_f32 v54, v46, v47
    v_mfma_f32_16x16x32_bf16 v[64:67], v[56:59], v[48:51], 0
    s_nop 0
    v_mfma_f32_16x16x32_bf16 v[64:67], v[60:63], v[52:55], v[64:67]
    v_mfma_f32_16x16x32_bf16 v[72:75], v[52:55], v[52:55], 0
    v_lshlrev_b32 v36, 16, v48
    v_and_b32 v37, 0xffff0000, v48
    v_lshlrev_b32 v38, 16, v49
    v_and_b32 v39, 0xffff0000, v49
    v_lshlrev_b32 v40, 16, v50
    v_and_b32 v41, 0xffff0000, v50
    s_mov_b64 exec, s[56:57]
    v_mov_b32 v64, v68
    v_mov_b32 v65, v72
    s_lshl_b64 exec, exec, 1
    v_mov_b32 v64, v69
    v_mov_b32 v65, v73
    s_lshl_b64 exec, exec, 1
    v_mov_b32 v64, v70
    v_mov_b32 v65, v74
    s_lshl_b64 exec, exec, 1
    v_mov_b32 v64, v71
    v_mov_b32 v65, v75
    s_mov_b32 exec_lo, 0xfff0ff0f
    s_mov_b32 exec_hi, 0xf0ff0fff
    ds_write2_b32 v84, v64, v65 offset0:0 offset1:96
    s_mov_b64 exec, -1
    v_lshlrev_b32 v42, 16, v52
    v_and_b32 v43, 0xffff0000, v52
    v_lshlrev_b32 v44, 16, v53
    v_and_b32 v45, 0xffff0000, v53
    v_lshlrev_b32 v46, 16, v54
    v_and_b32 v47, 0xffff0000, v54
    s_cmp_eq_u32 s38, 0
    s_cbranch_scc0 L_NP
    s_setprio 3
L_NP:
    s_waitcnt lgkmcnt(0)
    s_barrier
    ds_read_b128 v[52:55], v85 offset:0
    ds_read_b128 v[56:59], v85 offset:16
    ds_read_b128 v[60:63], v85 offset:17408
    ds_read_b128 v[64:67], v85 offset:17424
    ds_read_b128 v[68:71], v85 offset:34816
    ds_read_b128 v[72:75], v85 offset:34832
    s_waitcnt lgkmcnt(4)
    s_waitcnt lgkmcnt(2)
    v_pk_add_f32 v[52:53], v[52:53], v[60:61]
    v_pk_add_f32 v[54:55], v[54:55], v[62:63]
    v_pk_add_f32 v[56:57], v[56:57], v[64:65]
    v_pk_add_f32 v[58:59], v[58:59], v[66:67]
    s_waitcnt lgkmcnt(0)
    v_pk_add_f32 v[52:53], v[52:53], v[68:69]
    v_pk_add_f32 v[54:55], v[54:55], v[70:71]
    v_pk_add_f32 v[56:57], v[56:57], v[72:73]
    v_pk_add_f32 v[58:59], v[58:59], v[74:75]
    v_pk_add_f32 v[52:53], v[52:53], v[54:55]
    v_pk_add_f32 v[56:57], v[56:57], v[58:59]
    v_pk_add_f32 v[52:53], v[52:53], v[56:57]
    v_add_f32 v76, v52, v53
    v_add_f32 v78, v52, v53
    s_nop 1
    v_permlane16_swap_b32 v76, v78
    v_mov_b32 v77, v76
    v_mov_b32 v13, v78
    s_nop 0
    v_permlane32_swap_b32 v76, v77
    v_permlane32_swap_b32 v78, v13
    v_mul_f32 v76, 0x3ae38e39, v76
    v_mul_f32 v78, 0x3ae38e39, v78
    v_fma_f32 v78, -v76, v76, v78
    v_max_f32 v78, 0, v78
    v_cvt_pk_bf16_f32 v78, v76, v78
    v_and_b32 v82, 0xffff0000, v78
    v_lshlrev_b32 v80, 16, v78
    v_add_f32 v82, 0x3727c5ac, v82
    v_lshlrev_b32 v81, 16, v78
    v_cvt_pk_bf16_f32 v82, v82, v82
    v_lshlrev_b32 v82, 16, v82
    v_sqrt_f32 v82, v82
    v_fma_f32 v77, -v80, v13, v77
    v_cvt_pk_bf16_f32 v82, v82, v82
    v_lshlrev_b32 v82, 16, v82
    v_rcp_f32 v83, v82
    v_rcp_f32 v82, v82
    s_cbranch_scc0 L_NK
    v_mul_f32 v77, v77, v83
    v_cvt_pk_bf16_f32 v77, v77, v77
    v_ashrrev_i32 v76, 31, v77
    v_or_b32 v76, 0x80000000, v76
    v_xor_b32 v76, v76, v77
    v_and_or_b32 v76, v76, s58, v12
    s_mov_b64 exec, 0xffff
    buffer_store_dword v76, v93, s[40:43], s49 offen sc1
    s_mov_b64 exec, -1
    s_setprio 0
L_NK:
    v_mov_b32_dpp v80, v80 row_ror:8 row_mask:0xf bank_mask:0xc
    v_mov_b32_dpp v81, v81 row_ror:8 row_mask:0xf bank_mask:0x3
    v_mov_b32_dpp v82, v82 row_ror:8 row_mask:0xf bank_mask:0xc
    v_mov_b32_dpp v83, v83 row_ror:8 row_mask:0xf bank_mask:0x3
    v_pk_add_f32 v[56:57], v[36:37], v[80:81] op_sel_hi:[1,0] neg_lo:[0,1] neg_hi:[0,1]
    v_pk_add_f32 v[58:59], v[38:39], v[80:81] op_sel_hi:[1,0] neg_lo:[0,1] neg_hi:[0,1]
    v_pk_add_f32 v[60:61], v[40:41], v[80:81] op_sel_hi:[1,0] neg_lo:[0,1] neg_hi:[0,1]
    v_pk_add_f32 v[62:63], v[42:43], v[80:81] op_sel:[0,1] neg_lo:[0,1] neg_hi:[0,1]
    v_pk_add_f32 v[64:65], v[44:45], v[80:81] op_sel:[0,1] neg_lo:[0,1] neg_hi:[0,1]
    v_pk_add_f32 v[66:67], v[46:47], v[80:81] op_sel:[0,1] neg_lo:[0,1] neg_hi:[0,1]
    v_cvt_pk_bf16_f32 v57, v56, v57
    v_cvt_pk_bf16_f32 v59, v58, v59
    v_cvt_pk_bf16_f32 v61, v60, v61
    v_cvt_pk_bf16_f32 v63, v62, v63
    v_cvt_pk_bf16_f32 v65, v64, v65
    v_cvt_pk_bf16_f32 v67, v66, v67
    v_lshlrev_b32 v56, 16, v57
    v_and_b32 v57, 0xffff0000, v57
    v_lshlrev_b32 v58, 16, v59
    v_and_b32 v59, 0xffff0000, v59
    v_lshlrev_b32 v60, 16, v61
    v_and_b32 v61, 0xffff0000, v61
    v_lshlrev_b32 v62, 16, v63
    v_and_b32 v63, 0xffff0000, v63
    v_lshlrev_b32 v64, 16, v65
    v_and_b32 v65, 0xffff0000, v65
    v_lshlrev_b32 v66, 16, v67
    v_and_b32 v67, 0xffff0000, v67
    v_pk_mul_f32 v[56:57], v[56:57], v[82:83] op_sel_hi:[1,0]
    v_pk_mul_f32 v[58:59], v[58:59], v[82:83] op_sel_hi:[1,0]
    v_pk_mul_f32 v[60:61], v[60:61], v[82:83] op_sel_hi:[1,0]
    v_pk_mul_f32 v[62:63], v[62:63], v[82:83] op_sel:[0,1]
    v_pk_mul_f32 v[64:65], v[64:65], v[82:83] op_sel:[0,1]
    v_pk_mul_f32 v[66:67], v[66:67], v[82:83] op_sel:[0,1]
    v_cvt_pk_bf16_f32 v28, v56, v57
    v_cvt_pk_bf16_f32 v29, v58, v59
    v_cvt_pk_bf16_f32 v30, v60, v61
    ds_write_b128 v86, v[28:31]
    v_cvt_pk_bf16_f32 v32, v62, v63
    v_cvt_pk_bf16_f32 v33, v64, v65
    v_cvt_pk_bf16_f32 v34, v66, v67
    ds_write_b128 v86, v[32:35] offset:1024
    ds_read_b128 v[56:59], v87
    ds_read_b128 v[60:63], v87 offset:1024
    v_dot2c_f32_bf16 v36, s54, v28
    v_dot2c_f32_bf16 v37, s55, v28
    v_dot2c_f32_bf16 v38, s54, v29
    v_dot2c_f32_bf16 v39, s55, v29
    v_dot2c_f32_bf16 v40, s54, v30
    v_dot2c_f32_bf16 v41, s55, v30
    v_dot2c_f32_bf16 v42, s54, v32
    v_dot2c_f32_bf16 v43, s55, v32
    v_dot2c_f32_bf16 v44, s54, v33
    v_dot2c_f32_bf16 v45, s55, v33
    v_dot2c_f32_bf16 v46, s54, v34
    v_dot2c_f32_bf16 v47, s55, v34
    s_waitcnt lgkmcnt(1)
    buffer_store_dwordx4 v[56:59], v88, s[40:43], s48 offen sc1
    s_waitcnt lgkmcnt(0)
    buffer_store_dwordx4 v[60:63], v88, s[40:43], s48 offen offset:1536 sc1
    v_cvt_pk_bf16_f32 v48, v36, v37
    v_cvt_pk_bf16_f32 v49, v38, v39
    v_cvt_pk_bf16_f32 v50, v40, v41
    v_cvt_pk_bf16_f32 v51, v42, v43
    v_cvt_pk_bf16_f32 v52, v44, v45
    v_cvt_pk_bf16_f32 v53, v46, v47
    v_add_u32 v10, 1168, v89
    ds_write2_b32 v89, v48, v49 offset0:0 offset1:1
    ds_write_b32 v89, v50 offset:8
    ds_write2_b32 v10, v51, v52 offset0:0 offset1:1
    ds_write_b32 v10, v53 offset:8
    v_add_u32 v11, 12288, v92
    s_waitcnt lgkmcnt(0)
    s_barrier
    ds_read_b128 v[16:19], v90
    ds_read_b128 v[20:23], v91
    v_mov_b32 v10, 0
    s_waitcnt lgkmcnt(1)
    global_store_dwordx4 v92, v[16:19], s[32:33] sc1
    s_cmp_ge_u32 s38, 6
    s_cbranch_scc1 L_O1
    s_waitcnt lgkmcnt(0)
    global_store_dwordx4 v11, v[20:23], s[32:33] sc1
L_O1:
    s_cmp_eq_u32 s38, 11
    s_cbranch_scc1 TOP8
    s_waitcnt vmcnt(0)
    s_mov_b64 exec, 0x1
    buffer_store_dword v167, v10, s[40:43], s50 offen sc1
    s_mov_b64 exec, -1
    s_branch END
FFN_DMA0:
    s_sub_u32 s58, s2, 192
    s_lshl_b32 s61, s58, 1
    s_mov_b32 s59, 8
    s_mov_b32 s57, 73728
    s_add_u32 s56, s38, 1
    s_bfe_u32 s50, s56, 0x10003
    s_and_b32 s51, s56, 1
    s_bfe_u32 s52, s56, 0x10001
    s_mul_i32 s52, s52, 36
    s_add_u32 s52, s52, s51
    s_mul_i32 s48, s52, 73728
    s_lshl_b32 s53, s61, 6
    s_add_u32 s48, s48, s53
    s_lshl_b32 s49, s52, 10
    s_mul_i32 s53, s50, 73728
    s_add_u32 s49, s49, s53
    s_lshl_b32 s51, s51, 1
    s_lshl_b32 s53, s50, 2
    s_or_b32 s51, s51, s53
    v_bfe_u32 v2, v1, 4, 1
    v_and_b32 v4, 7, v1
    v_xor_b32 v2, v2, v4
    v_xor_b32 v2, s51, v2
    v_lshrrev_b32 v4, 3, v1
    v_mul_u32_u24 v4, 0x2400, v4
    v_lshl_add_u32 v2, v2, 4, v4
    s_mov_b32 s46, 5308416
    s_mov_b32 s47, 0x00020000
    s_waitcnt lgkmcnt(0)
    s_cmp_eq_u32 s50, 0
    s_cselect_b32 s44, s26, s28
    s_cselect_b32 s45, s27, s29
    s_mov_b32 s40, s36
    s_mov_b32 s41, s37
    s_barrier
    s_sub_u32 s51, s38, 3
    s_cmp_ge_u32 s51, 8
    s_cbranch_scc1 F_B0
    s_add_u32 m0, s49, 0
    s_add_u32 s53, s48, 0
    buffer_load_dwordx4 v2, s[44:47], s53 offen lds
    s_add_u32 m0, s49, 2048
    s_add_u32 s53, s48, 147456
    buffer_load_dwordx4 v2, s[44:47], s53 offen lds
    s_barrier
    s_branch F_B2
FFN_LATE:
    s_and_b32 s61, s2, 7
    s_lshl_b32 s61, s61, 1
    s_bitcmp0_b32 s2, 3
    s_addc_u32 s61, s61, 128
    s_sub_u32 s58, s2, 112
    s_mov_b32 s59, 4
    s_mov_b32 s57, 0
    v_mov_b32 v32, 0
    v_mov_b32 v33, 0
    v_mov_b32 v34, 0
    v_mov_b32 v35, 0
    v_mov_b32 v36, 0
    v_mov_b32 v37, 0
    v_mov_b32 v38, 0
    v_mov_b32 v39, 0
    v_mov_b32 v40, 0
    v_mov_b32 v41, 0
    v_mov_b32 v42, 0
    v_mov_b32 v43, 0
    v_mov_b32 v44, 0
    v_mov_b32 v45, 0
    v_mov_b32 v46, 0
    v_mov_b32 v47, 0
    s_sub_u32 s51, s38, 3
    s_cmp_ge_u32 s51, 8
    s_cbranch_scc1 F_B0
    s_add_u32 s56, s38, 1
    s_bfe_u32 s50, s56, 0x10003
    s_and_b32 s51, s56, 1
    s_bfe_u32 s52, s56, 0x10001
    s_lshl1_add_u32 s52, s50, s52
    s_mul_i32 s52, s52, 18
    s_add_u32 s52, s52, s51
    s_mul_i32 s48, s52, 73728
    s_lshl_b32 s53, s61, 6
    s_add_u32 s48, s48, s53
    s_lshl_b32 m0, s52, 10
    s_lshl_b32 s51, s51, 1
    s_add_u32 s44, s26, s48
    s_addc_u32 s45, s27, 0
    s_add_u32 s46, s28, s48
    s_addc_u32 s47, s29, 0
    v_bfe_u32 v2, v1, 4, 1
    v_xor_b32 v2, v2, v1
    v_xor_b32 v2, s51, v2
    v_and_b32 v2, 3, v2
    v_lshrrev_b32 v4, 3, v1
    v_mul_u32_u24 v4, 0x2400, v4
    v_lshl_add_u32 v2, v2, 4, v4
    v_mov_b32 v4, s44
    v_mov_b32 v5, s45
    s_mov_b32 exec_lo, 0xf0f0f0f0
    s_mov_b32 exec_hi, 0xf0f0f0f0
    v_mov_b32 v4, s46
    v_mov_b32 v5, s47
    s_mov_b64 exec, -1
    v_add_co_u32 v4, vcc, v4, v2
    s_nop 1
    v_addc_co_u32 v5, vcc, 0, v5, vcc
    s_barrier
    global_load_lds_dwordx4 v[4:5], off
    v_add_co_u32 v4, vcc, 147456, v4
    s_add_u32 m0, m0, 2048
    s_nop 0
    v_addc_co_u32 v5, vcc, 0, v5, vcc
    global_load_lds_dwordx4 v[4:5], off
    v_add_co_u32 v4, vcc, 147456, v4
    s_add_u32 m0, m0, 2048
    s_nop 0
    v_addc_co_u32 v5, vcc, 0, v5, vcc
    global_load_lds_dwordx4 v[4:5], off
    v_add_co_u32 v4, vcc, 147456, v4
    s_add_u32 m0, m0, 2048
    s_nop 0
    v_addc_co_u32 v5, vcc, 0, v5, vcc
    global_load_lds_dwordx4 v[4:5], off
    v_add_co_u32 v4, vcc, 147456, v4
    s_add_u32 m0, m0, 2048
    s_nop 0
    v_addc_co_u32 v5, vcc, 0, v5, vcc
    global_load_lds_dwordx4 v[4:5], off
    v_add_co_u32 v4, vcc, 147456, v4
    s_add_u32 m0, m0, 2048
    s_nop 0
    v_addc_co_u32 v5, vcc, 0, v5, vcc
    global_load_lds_dwordx4 v[4:5], off
    v_add_co_u32 v4, vcc, 147456, v4
    s_add_u32 m0, m0, 2048
    s_nop 0
    v_addc_co_u32 v5, vcc, 0, v5, vcc
    global_load_lds_dwordx4 v[4:5], off
    v_add_co_u32 v4, vcc, 147456, v4
    s_add_u32 m0, m0, 2048
    s_nop 0
    v_addc_co_u32 v5, vcc, 0, v5, vcc
    global_load_lds_dwordx4 v[4:5], off
    v_add_co_u32 v4, vcc, 147456, v4
    s_add_u32 m0, m0, 2048
    s_nop 0
    v_addc_co_u32 v5, vcc, 0, v5, vcc
    global_load_lds_dwordx4 v[4:5], off
    s_branch F_W
F_L2:
    s_sub_u32 s51, s38, 3
    s_cmp_ge_u32 s51, 8
    s_cbranch_scc1 F_B0
    s_add_u32 s56, s38, 1
    s_bfe_u32 s50, s56, 0x10003
    s_and_b32 s51, s56, 1
    s_bfe_u32 s52, s56, 0x10001
    s_mul_i32 s52, s52, 36
    s_add_u32 s52, s52, s51
    s_mul_i32 s48, s52, 73728
    s_lshl_b32 s53, s61, 6
    s_add_u32 s48, s48, s53
    s_lshl_b32 s49, s52, 10
    s_mul_i32 s53, s50, 73728
    s_add_u32 s49, s49, s53
    s_lshl_b32 s51, s51, 1
    s_lshl_b32 s53, s50, 2
    s_or_b32 s51, s51, s53
    v_bfe_u32 v2, v1, 4, 1
    v_and_b32 v4, 7, v1
    v_xor_b32 v2, v2, v4
    v_xor_b32 v2, s51, v2
    v_lshrrev_b32 v4, 3, v1
    v_mul_u32_u24 v4, 0x2400, v4
    v_lshl_add_u32 v2, v2, 4, v4
    s_mov_b32 s46, 5308416
    s_mov_b32 s47, 0x00020000
    s_cmp_eq_u32 s50, 0
    s_cselect_b32 s44, s26, s28
    s_cselect_b32 s45, s27, s29
    s_barrier
    s_add_u32 m0, s49, 0
    s_add_u32 s53, s48, 0
    buffer_load_dwordx4 v2, s[44:47], s53 offen lds
    s_add_u32 m0, s49, 2048
    s_add_u32 s53, s48, 147456
    buffer_load_dwordx4 v2, s[44:47], s53 offen lds
F_B2:
    s_add_u32 m0, s49, 4096
    s_add_u32 s53, s48, 294912
    buffer_load_dwordx4 v2, s[44:47], s53 offen lds
    s_add_u32 m0, s49, 6144
    s_add_u32 s53, s48, 442368
    buffer_load_dwordx4 v2, s[44:47], s53 offen lds
    s_add_u32 m0, s49, 8192
    s_add_u32 s53, s48, 589824
    buffer_load_dwordx4 v2, s[44:47], s53 offen lds
    s_add_u32 m0, s49, 10240
    s_add_u32 s53, s48, 737280
    buffer_load_dwordx4 v2, s[44:47], s53 offen lds
    s_add_u32 m0, s49, 12288
    s_add_u32 s53, s48, 884736
    buffer_load_dwordx4 v2, s[44:47], s53 offen lds
    s_add_u32 m0, s49, 14336
    s_add_u32 s53, s48, 1032192
    buffer_load_dwordx4 v2, s[44:47], s53 offen lds
    s_add_u32 m0, s49, 16384
    s_add_u32 s53, s48, 1179648
    buffer_load_dwordx4 v2, s[44:47], s53 offen lds
    s_add_u32 m0, s49, 18432
    s_add_u32 s53, s48, 1327104
    buffer_load_dwordx4 v2, s[44:47], s53 offen lds
    s_add_u32 m0, s49, 20480
    s_add_u32 s53, s48, 1474560
    buffer_load_dwordx4 v2, s[44:47], s53 offen lds
    s_add_u32 m0, s49, 22528
    s_add_u32 s53, s48, 1622016
    buffer_load_dwordx4 v2, s[44:47], s53 offen lds
    s_add_u32 m0, s49, 24576
    s_add_u32 s53, s48, 1769472
    buffer_load_dwordx4 v2, s[44:47], s53 offen lds
    s_add_u32 m0, s49, 26624
    s_add_u32 s53, s48, 1916928
    buffer_load_dwordx4 v2, s[44:47], s53 offen lds
    s_add_u32 m0, s49, 28672
    s_add_u32 s53, s48, 2064384
    buffer_load_dwordx4 v2, s[44:47], s53 offen lds
    s_add_u32 m0, s49, 30720
    s_add_u32 s53, s48, 2211840
    buffer_load_dwordx4 v2, s[44:47], s53 offen lds
    s_add_u32 m0, s49, 32768
    s_add_u32 s53, s48, 2359296
    buffer_load_dwordx4 v2, s[44:47], s53 offen lds
    s_add_u32 m0, s49, 34816
    s_add_u32 s53, s48, 2506752
    buffer_load_dwordx4 v2, s[44:47], s53 offen lds
    s_branch F_W
FFN_DMA:
    s_setprio 0
    s_sub_u32 s58, s2, 192
    s_lshl_b32 s61, s58, 1
    s_mov_b32 s59, 8
    s_mov_b32 s57, 73728
    s_waitcnt vmcnt(0)
    s_branch F_L2
F_B0:
    s_setprio 3
    s_barrier
F_W:
    s_mov_b64 exec, -1
    v_mov_b32 v167, 156684
    ds_read_b32 v167, v167
    v_and_b32 v7, 7, v1
    v_lshrrev_b32 v8, 3, v1
    v_and_b32 v5, 15, v1
    v_lshrrev_b32 v6, 4, v1
    s_mul_i32 s52, s61, 36864
    s_mul_i32 s53, s38, 96
    s_add_u32 s52, s52, s53
    v_mul_u32_u24 v9, 0x480, v8
    v_mad_u32_u24 v9, v7, 12, v9
    v_add_u32 v9, s52, v9
    global_load_dwordx3 v[16:18], v9, s[30:31]
    v_add_u32 v9, 0x2400, v9
    global_load_dwordx3 v[20:22], v9, s[30:31]
    v_add_u32 v9, 0x2400, v9
    global_load_dwordx3 v[24:26], v9, s[30:31]
    v_add_u32 v9, 0x2400, v9
    global_load_dwordx3 v[28:30], v9, s[30:31]
    v_add_u32 v9, 0x2400, v9
    s_cmp_eq_u32 s59, 4
    s_cbranch_scc1 F_W4
    global_load_dwordx3 v[32:34], v9, s[30:31]
    v_add_u32 v9, 0x2400, v9
    global_load_dwordx3 v[36:38], v9, s[30:31]
    v_add_u32 v9, 0x2400, v9
    global_load_dwordx3 v[40:42], v9, s[30:31]
    v_add_u32 v9, 0x2400, v9
    global_load_dwordx3 v[44:46], v9, s[30:31]
F_W4:
    v_mul_u32_u24 v10, 683, v0
    v_lshrrev_b32 v10, 16, v10
    v_mul_u32_u24 v11, 0x60, v10
    v_sub_u32 v11, v0, v11
    s_mov_b32 s52, 161920
    v_lshl_add_u32 v160, v10, 2, s52
    v_and_b32 v63, 4, v10
    v_lshl_add_u32 v160, v63, 2, v160
    v_mov_b32 v63, 161492
    s_mov_b32 s52, 3144192
    v_lshl_add_u32 v161, v11, 4, s52
    v_mul_u32_u24 v162, 608, v10
    v_mad_u32_u24 v162, v11, 6, v162
    v_and_b32 v11, 1, v11
    v_mul_u32_u24 v11, 4862, v11
    v_sub_u32 v2, v162, v11
    v_add_u32 v2, 152320, v2
    v_add_u32 v162, 147456, v162
    v_add_u32 v162, v11, v162
    v_mul_u32_u24 v163, 608, v5
    v_lshl_add_u32 v163, v6, 4, v163
    v_add_u32 v163, 147456, v163
    s_lshr_b32 s52, s38, 2
    s_lshl_b32 s52, s52, 10
    s_and_b32 s53, s38, 3
    s_lshl_b32 s53, s53, 2
    s_add_u32 s52, s52, s53
    s_add_u32 s52, s52, 157184
    v_add_u32 v164, s52, v3
    v_mov_b32 v10, 0
    ds_write_b32 v164, v10
    v_add_u32 v60, 157184, v3
    v_xor_b32 v61, 0x80, v60
    v_and_b32 v10, 6, v1
    v_and_b32 v11, 9, v1
    v_lshl_add_u32 v164, v10, 7, s52
    v_lshl_add_u32 v164, v11, 1, v164
    v_and_b32 v10, 16, v1
    v_and_b32 v11, 32, v1
    v_lshl_add_u32 v164, v10, 2, v164
    v_add_u32 v164, v11, v164
    v_and_b32 v10, 1, v6
    v_mul_u32_u24 v10, 0x48, v10
    v_and_b32 v11, 1, v8
    v_add3_u32 v166, v10, v11, 2
    v_lshl_add_u32 v10, v11, 2, v10
    v_lshrrev_b32 v11, 1, v6
    v_add_u32 v165, v10, v11
    v_mul_u32_u24 v165, 10240, v165
    v_mul_u32_u24 v166, 10240, v166
    v_lshl_add_u32 v165, v7, 4, v165
    v_lshl_add_u32 v166, v7, 4, v166
    s_mul_i32 s62, s38, 61440
    s_lshl_b32 s53, s58, 7
    s_add_u32 s62, s62, s53
    s_add_u32 s62, s62, 9502720
    s_mov_b32 s63, 6356992
    s_add_u32 s69, s53, 16384
    s_cmp_eq_u32 s38, 0
    s_cselect_b32 s70, 1, 0
    s_mov_b32 s71, 0
    s_movk_i32 s64, -1536
    v_bfe_u32 v10, v1, 1, 1
    v_bfe_u32 v11, v1, 3, 2
    v_lshl_add_u32 v11, v10, 2, v11
    v_xor_b32 v11, s38, v11
    v_mul_u32_u24 v12, s57, v10
    v_lshl_add_u32 v12, v11, 4, v12
    v_and_b32 v10, 1, v1
    v_lshl_add_u32 v12, v10, 3, v12
    v_bfe_u32 v10, v1, 2, 2
    v_lshl_add_u32 v10, v6, 3, v10
    v_lshl_add_u32 v12, v10, 7, v12
    v_add_u32 v13, 36864, v12
    v_mov_b32 v14, 161488
    v_mov_b32 v15, 1
    s_mov_b32 s52, 0x05040100
    s_mov_b32 s53, 0x07060302
    v_mov_b32 v10, s52
    v_mov_b32 v4, 0x05040c0c
    v_mov_b32 v5, 0x01000c0c
    v_mov_b32 v6, 0x44444444
    s_mov_b32 exec_lo, 0xff00ff00
    s_mov_b32 exec_hi, 0xff00ff00
    v_mov_b32 v10, 0x03020706
    v_mov_b32 v4, 0x03020c0c
    v_mov_b32 v5, 0x07060c0c
    v_mov_b32 v6, 0xeeeeeeee
    s_mov_b64 exec, -1
    s_waitcnt lgkmcnt(0)
    v_readfirstlane_b32 s39, v167
    s_cmp_eq_u32 s59, 4
    s_cbranch_scc0 F_W8
    s_waitcnt vmcnt(0)
F_W8:
    s_sub_u32 s51, s38, 3
    s_cmp_ge_u32 s51, 8
    s_cbranch_scc1 F_NC
    s_waitcnt vmcnt(8)
    s_mov_b64 exec, 0x1
    ds_add_u32 v14, v15
    s_mov_b64 exec, -1
F_NC:
    s_waitcnt vmcnt(7)
    v_mov_b32 v19, v16
    v_mov_b32_dpp v11, v17 row_ror:8 row_mask:0xf bank_mask:0xf
    v_mov_b32_dpp v16, v18 row_ror:8 row_mask:0xf bank_mask:0xc
    v_mov_b32_dpp v18, v19 row_ror:8 row_mask:0xf bank_mask:0x3
    v_perm_b32 v152, v11, v17, v10
    v_perm_b32 v136, v18, v16, s52
    v_perm_b32 v144, v18, v16, s53
    s_waitcnt vmcnt(6)
    v_mov_b32 v23, v20
    v_mov_b32_dpp v11, v21 row_ror:8 row_mask:0xf bank_mask:0xf
    v_mov_b32_dpp v20, v22 row_ror:8 row_mask:0xf bank_mask:0xc
    v_mov_b32_dpp v22, v23 row_ror:8 row_mask:0xf bank_mask:0x3
    v_perm_b32 v153, v11, v21, v10
    v_perm_b32 v137, v22, v20, s52
    v_perm_b32 v145, v22, v20, s53
    s_waitcnt vmcnt(5)
    v_mov_b32 v27, v24
    v_mov_b32_dpp v11, v25 row_ror:8 row_mask:0xf bank_mask:0xf
    v_mov_b32_dpp v24, v26 row_ror:8 row_mask:0xf bank_mask:0xc
    v_mov_b32_dpp v26, v27 row_ror:8 row_mask:0xf bank_mask:0x3
    v_perm_b32 v154, v11, v25, v10
    v_perm_b32 v138, v26, v24, s52
    v_perm_b32 v146, v26, v24, s53
    s_waitcnt vmcnt(4)
    v_mov_b32 v31, v28
    v_mov_b32_dpp v11, v29 row_ror:8 row_mask:0xf bank_mask:0xf
    v_mov_b32_dpp v28, v30 row_ror:8 row_mask:0xf bank_mask:0xc
    v_mov_b32_dpp v30, v31 row_ror:8 row_mask:0xf bank_mask:0x3
    v_perm_b32 v155, v11, v29, v10
    v_perm_b32 v139, v30, v28, s52
    v_perm_b32 v147, v30, v28, s53
    s_waitcnt vmcnt(3)
    v_mov_b32 v35, v32
    v_mov_b32_dpp v11, v33 row_ror:8 row_mask:0xf bank_mask:0xf
    v_mov_b32_dpp v32, v34 row_ror:8 row_mask:0xf bank_mask:0xc
    v_mov_b32_dpp v34, v35 row_ror:8 row_mask:0xf bank_mask:0x3
    v_perm_b32 v156, v11, v33, v10
    v_perm_b32 v140, v34, v32, s52
    v_perm_b32 v148, v34, v32, s53
    s_waitcnt vmcnt(2)
    v_mov_b32 v39, v36
    v_mov_b32_dpp v11, v37 row_ror:8 row_mask:0xf bank_mask:0xf
    v_mov_b32_dpp v36, v38 row_ror:8 row_mask:0xf bank_mask:0xc
    v_mov_b32_dpp v38, v39 row_ror:8 row_mask:0xf bank_mask:0x3
    v_perm_b32 v157, v11, v37, v10
    v_perm_b32 v141, v38, v36, s52
    v_perm_b32 v149, v38, v36, s53
    s_waitcnt vmcnt(1)
    v_mov_b32 v43, v40
    v_mov_b32_dpp v11, v41 row_ror:8 row_mask:0xf bank_mask:0xf
    v_mov_b32_dpp v40, v42 row_ror:8 row_mask:0xf bank_mask:0xc
    v_mov_b32_dpp v42, v43 row_ror:8 row_mask:0xf bank_mask:0x3
    v_perm_b32 v158, v11, v41, v10
    v_perm_b32 v142, v42, v40, s52
    v_perm_b32 v150, v42, v40, s53
    s_waitcnt vmcnt(0)
    v_mov_b32 v47, v44
    v_mov_b32_dpp v11, v45 row_ror:8 row_mask:0xf bank_mask:0xf
    v_mov_b32_dpp v44, v46 row_ror:8 row_mask:0xf bank_mask:0xc
    v_mov_b32_dpp v46, v47 row_ror:8 row_mask:0xf bank_mask:0x3
    v_perm_b32 v159, v11, v45, v10
    v_perm_b32 v143, v46, v44, s52
    v_perm_b32 v151, v46, v44, s53
    s_cmp_ge_u32 s38, s59
    s_cbranch_scc1 F_NT
    s_movk_i32 s60, 4000
F_CP:
    ds_read_b32 v15, v14
    s_sub_u32 s60, s60, 1
    s_cmp_gt_i32 s60, 0
    s_waitcnt lgkmcnt(0)
    v_readfirstlane_b32 s52, v15
    s_nop 0
    s_cselect_b32 s52, s52, 8
    s_cmp_eq_u32 s52, 8
    s_cbranch_scc1 F_CD
    s_sleep 2
    s_branch F_CP
F_CD:
    ds_read_b64_tr_b16 v[64:65], v12 offset:0
    ds_read_b64_tr_b16 v[66:67], v12 offset:512
    ds_read_b64_tr_b16 v[68:69], v12 offset:4096
    ds_read_b64_tr_b16 v[70:71], v12 offset:4608
    ds_read_b64_tr_b16 v[72:73], v12 offset:8192
    ds_read_b64_tr_b16 v[74:75], v12 offset:8704
    ds_read_b64_tr_b16 v[76:77], v12 offset:12288
    ds_read_b64_tr_b16 v[78:79], v12 offset:12800
    ds_read_b64_tr_b16 v[80:81], v12 offset:16384
    ds_read_b64_tr_b16 v[82:83], v12 offset:16896
    ds_read_b64_tr_b16 v[84:85], v12 offset:20480
    ds_read_b64_tr_b16 v[86:87], v12 offset:20992
    ds_read_b64_tr_b16 v[88:89], v12 offset:24576
    ds_read_b64_tr_b16 v[90:91], v12 offset:25088
    ds_read_b64_tr_b16 v[92:93], v12 offset:28672
    ds_read_b64_tr_b16 v[94:95], v12 offset:29184
    ds_read_b64_tr_b16 v[96:97], v12 offset:32768
    ds_read_b64_tr_b16 v[98:99], v12 offset:33280
    ds_read_b64_tr_b16 v[100:101], v13 offset:0
    ds_read_b64_tr_b16 v[102:103], v13 offset:512
    ds_read_b64_tr_b16 v[104:105], v13 offset:4096
    ds_read_b64_tr_b16 v[106:107], v13 offset:4608
    ds_read_b64_tr_b16 v[108:109], v13 offset:8192
    ds_read_b64_tr_b16 v[110:111], v13 offset:8704
    ds_read_b64_tr_b16 v[112:113], v13 offset:12288
    ds_read_b64_tr_b16 v[114:115], v13 offset:12800
    ds_read_b64_tr_b16 v[116:117], v13 offset:16384
    ds_read_b64_tr_b16 v[118:119], v13 offset:16896
    ds_read_b64_tr_b16 v[120:121], v13 offset:20480
    ds_read_b64_tr_b16 v[122:123], v13 offset:20992
    ds_read_b64_tr_b16 v[124:125], v13 offset:24576
    ds_read_b64_tr_b16 v[126:127], v13 offset:25088
    ds_read_b64_tr_b16 v[128:129], v13 offset:28672
    ds_read_b64_tr_b16 v[130:131], v13 offset:29184
    ds_read_b64_tr_b16 v[132:133], v13 offset:32768
    ds_read_b64_tr_b16 v[134:135], v13 offset:33280
    s_waitcnt lgkmcnt(0)
    v_mov_b32 v12, 0
    v_mov_b32 v13, 0
    v_mov_b32 v14, 0
    v_mov_b32 v15, 0
F_NT:
    s_cmp_lg_u32 s38, 11
    s_cbranch_scc1 F_SEL
    s_branch T_EV
FINAL:
    s_cmp_ge_u32 s2, 144
    s_cbranch_scc1 END
    s_cmp_lg_u32 s38, 11
    s_cbranch_scc1 END
T_EV:
TOP8:
    v_bfe_i32 v7, v1, 0, 1
    v_bfe_i32 v8, v1, 1, 1
    v_bfe_i32 v9, v1, 3, 1
    v_bfe_i32 v11, v1, 4, 1
    v_bfe_i32 v13, v1, 5, 1
    v_xor_b32 v48, v7, v8
    v_xor_b32 v49, v8, v9
    v_xor_b32 v50, v7, v9
    v_xor_b32 v11, v11, v13
    v_xor_b32 v51, v9, v11
    v_xor_b32 v52, v8, v11
    v_xor_b32 v53, v7, v11
    v_mov_b32 v63, 161492
    v_lshl_add_u32 v13, v1, 2, v63
    v_add_u32 v13, 428, v13
    v_sub_u32 v54, 148464, v3
    v_and_b32 v7, 4, v1
    v_and_b32 v8, 48, v1
    v_lshlrev_b32 v8, 6, v8
    v_lshl_add_u32 v55, v7, 1, v8
    v_add_u32 v55, 147456, v55
    s_mov_b32 s65, 32768
    s_mov_b32 s66, 36864
    s_and_b32 s67, s2, 127
    s_lshl_b32 s68, s67, 6
    s_add_u32 s68, s68, 32768
    v_mov_b32 v10, 0
    s_cmp_lt_u32 s2, 128
    s_cbranch_scc0 T_E2
    s_mov_b64 exec, 0x1
    buffer_load_dword v11, v10, s[40:43], s68 offen sc1
    s_movk_i32 s60, 4000
    s_waitcnt vmcnt(0)
    buffer_store_dword v167, v10, s[40:43], s50 offen sc1
    s_branch T_HP_C
T_E2:
    v_mov_b32 v16, -1
    v_mov_b32 v17, -1
    v_mov_b32 v18, -1
    v_mov_b32 v19, -1
    v_mov_b32 v20, -1
    v_mov_b32 v21, -1
    v_mov_b32 v22, -1
    v_mov_b32 v23, -1
    v_mov_b32 v24, -1
    v_mov_b32 v25, -1
    v_mov_b32 v26, -1
    v_mov_b32 v27, -1
    v_mov_b32 v28, -1
    v_mov_b32 v29, -1
    v_mov_b32 v30, -1
    v_mov_b32 v31, -1
    v_mov_b32 v32, -1
    v_mov_b32 v33, -1
    v_mov_b32 v34, -1
    v_mov_b32 v35, -1
    v_mov_b32 v36, -1
    v_mov_b32 v37, -1
    v_mov_b32 v38, -1
    v_mov_b32 v39, -1
    v_mov_b32 v40, -1
    v_mov_b32 v41, -1
    v_mov_b32 v42, -1
    v_mov_b32 v43, -1
    v_mov_b32 v44, -1
    v_mov_b32 v45, -1
    v_mov_b32 v46, -1
    v_mov_b32 v47, -1
    s_mul_i32 s67, s67, 24576
    s_add_u32 s67, s67, 3230092
    s_mov_b64 exec, 0xf
    s_movk_i32 s60, 4000
T_EP:
    buffer_load_dword v11, v3, s[40:43], s67 offen sc1
T_EP_W:
    s_waitcnt vmcnt(0)
T_EP_C:
    v_cmp_ne_u32 vcc, s39, v11
    s_nop 0
    s_and_b64 exec, exec, vcc
    s_cbranch_execz T_EP_D
    s_sub_u32 s60, s60, 1
    s_cmp_gt_i32 s60, 0
    s_sleep 2
    s_cbranch_scc1 T_EP
T_EP_D:
T_H:
    s_mov_b64 exec, 0x1
    s_movk_i32 s60, 4000
T_HP:
    buffer_load_dword v11, v10, s[40:43], s68 offen sc1
T_HP_W:
    s_waitcnt vmcnt(0)
T_HP_C:
    v_cmp_eq_u32 vcc, -1, v11
    s_nop 0
    s_and_b64 exec, exec, vcc
    s_cbranch_execz T_HP_D
    s_sub_u32 s60, s60, 1
    s_cmp_gt_i32 s60, 0
    s_sleep 1
    s_cbranch_scc1 T_HP
T_HP_D:
    s_mov_b64 exec, -1
    s_cmp_ge_u32 s2, 144
    s_cbranch_scc0 T_KQ
    s_movk_i32 s60, 4000
T_KN:
    buffer_load_dwordx4 v[16:19], v3, s[40:43], s65 offen offset:0 sc1
    buffer_load_dwordx4 v[20:23], v3, s[40:43], s65 offen offset:1024 sc1
    buffer_load_dwordx4 v[24:27], v3, s[40:43], s65 offen offset:2048 sc1
    buffer_load_dwordx4 v[28:31], v3, s[40:43], s65 offen offset:3072 sc1
    buffer_load_dwordx4 v[32:35], v3, s[40:43], s66 offen offset:0 sc1
    buffer_load_dwordx4 v[36:39], v3, s[40:43], s66 offen offset:1024 sc1
    buffer_load_dwordx4 v[40:43], v3, s[40:43], s66 offen offset:2048 sc1
    buffer_load_dwordx4 v[44:47], v3, s[40:43], s66 offen offset:3072 sc1
    s_waitcnt vmcnt(16)
    s_sub_u32 s60, s60, 1
    v_max3_u32 v56, v16, v17, v18
    v_max3_u32 v58, v19, v20, v21
    v_max3_u32 v57, v32, v33, v34
    v_max3_u32 v59, v35, v36, v37
    v_max3_u32 v56, v56, v22, v23
    v_max3_u32 v58, v58, v24, v25
    v_max3_u32 v57, v57, v38, v39
    v_max3_u32 v59, v59, v40, v41
    v_max3_u32 v56, v56, v26, v27
    v_max3_u32 v58, v58, v28, v29
    v_max3_u32 v57, v57, v42, v43
    v_max3_u32 v59, v59, v44, v45
    v_max3_u32 v58, v58, v30, v31
    v_max3_u32 v59, v59, v46, v47
    v_max_u32 v56, v56, v58
    v_max_u32 v57, v57, v59
    v_max_u32 v58, v56, v57
    v_cmp_eq_u32 vcc, -1, v58
    s_nop 0
    s_and_b64 exec, exec, vcc
    s_cselect_b32 s60, s60, 0
    s_cmp_gt_i32 s60, 0
    s_cbranch_scc1 T_KN
    s_branch T_KP_D
T_KQ:
    s_movk_i32 s60, 4000
T_KP:
    buffer_load_dwordx4 v[16:19], v3, s[40:43], s65 offen offset:0 sc1
    buffer_load_dwordx4 v[20:23], v3, s[40:43], s65 offen offset:1024 sc1
    buffer_load_dwordx4 v[24:27], v3, s[40:43], s65 offen offset:2048 sc1
    buffer_load_dwordx4 v[28:31], v3, s[40:43], s65 offen offset:3072 sc1
    buffer_load_dwordx4 v[32:35], v3, s[40:43], s66 offen offset:0 sc1
    buffer_load_dwordx4 v[36:39], v3, s[40:43], s66 offen offset:1024 sc1
    buffer_load_dwordx4 v[40:43], v3, s[40:43], s66 offen offset:2048 sc1
    buffer_load_dwordx4 v[44:47], v3, s[40:43], s66 offen offset:3072 sc1
T_KP_W:
    s_waitcnt vmcnt(0)
T_KP_C:
    v_max3_u32 v56, v16, v17, v18
    v_max3_u32 v58, v19, v20, v21
    v_max3_u32 v57, v32, v33, v34
    v_max3_u32 v59, v35, v36, v37
    v_max3_u32 v56, v56, v22, v23
    v_max3_u32 v58, v58, v24, v25
    v_max3_u32 v57, v57, v38, v39
    v_max3_u32 v59, v59, v40, v41
    v_max3_u32 v56, v56, v26, v27
    v_max3_u32 v58, v58, v28, v29
    v_max3_u32 v57, v57, v42, v43
    v_max3_u32 v59, v59, v44, v45
    v_max3_u32 v58, v58, v30, v31
    v_max3_u32 v59, v59, v46, v47
    v_max_u32 v56, v56, v58
    v_max_u32 v57, v57, v59
    v_max_u32 v58, v56, v57
    v_cmp_eq_u32 vcc, -1, v58
    s_nop 0
    s_and_b64 exec, exec, vcc
    s_cbranch_execz T_KP_D
    s_sub_u32 s60, s60, 1
    s_cmp_gt_i32 s60, 0
    s_cbranch_scc1 T_KP
T_KP_D:
    s_mov_b64 exec, -1
    v_mov_b32_dpp v58, v56 quad_perm:[1,0,3,2] row_mask:0xf bank_mask:0xf
    v_mov_b32_dpp v59, v57 quad_perm:[1,0,3,2] row_mask:0xf bank_mask:0xf
    v_med3_u32 v56, v56, v58, v48
    v_med3_u32 v57, v57, v59, v48
    ds_write_b128 v54, v[16:19] offset:7168
    v_mov_b32_dpp v58, v56 quad_perm:[2,3,0,1] row_mask:0xf bank_mask:0xf
    v_mov_b32_dpp v59, v57 quad_perm:[2,3,0,1] row_mask:0xf bank_mask:0xf
    v_med3_u32 v56, v56, v58, v49
    v_med3_u32 v57, v57, v59, v49
    ds_write_b128 v54, v[20:23] offset:6144
    v_mov_b32_dpp v58, v56 quad_perm:[1,0,3,2] row_mask:0xf bank_mask:0xf
    v_mov_b32_dpp v59, v57 quad_perm:[1,0,3,2] row_mask:0xf bank_mask:0xf
    v_med3_u32 v56, v56, v58, v50
    v_med3_u32 v57, v57, v59, v50
    ds_write_b128 v54, v[24:27] offset:5120
    v_mov_b32_dpp v58, v56 row_ror:8 row_mask:0xf bank_mask:0xf
    v_mov_b32_dpp v59, v57 row_ror:8 row_mask:0xf bank_mask:0xf
    v_med3_u32 v56, v56, v58, v51
    v_med3_u32 v57, v57, v59, v51
    ds_write_b128 v54, v[28:31] offset:4096
    v_mov_b32_dpp v58, v56 quad_perm:[2,3,0,1] row_mask:0xf bank_mask:0xf
    v_mov_b32_dpp v59, v57 quad_perm:[2,3,0,1] row_mask:0xf bank_mask:0xf
    v_med3_u32 v56, v56, v58, v52
    v_med3_u32 v57, v57, v59, v52
    ds_write_b128 v54, v[32:35] offset:3072
    v_mov_b32_dpp v58, v56 quad_perm:[1,0,3,2] row_mask:0xf bank_mask:0xf
    v_mov_b32_dpp v59, v57 quad_perm:[1,0,3,2] row_mask:0xf bank_mask:0xf
    v_med3_u32 v56, v56, v58, v53
    v_med3_u32 v57, v57, v59, v53
    ds_write_b128 v54, v[36:39] offset:2048
    s_nop 0
    v_max_u32_dpp v56, v57, v56 row_mirror row_mask:0xf bank_mask:0xf
    ds_write_b128 v54, v[40:43] offset:1024
    s_nop 0
    v_mov_b32_dpp v58, v56 row_ror:8 row_mask:0xf bank_mask:0xf
    v_med3_u32 v56, v56, v58, v51
    ds_write_b128 v54, v[44:47] offset:0
    s_nop 0
    v_mov_b32_dpp v58, v56 quad_perm:[2,3,0,1] row_mask:0xf bank_mask:0xf
    v_med3_u32 v56, v56, v58, v52
    s_nop 1
    v_mov_b32_dpp v58, v56 quad_perm:[1,0,3,2] row_mask:0xf bank_mask:0xf
    v_med3_u32 v56, v56, v58, v53
    s_nop 1
    v_max_u32_dpp v56, v56, v56 row_mirror row_mask:0xf bank_mask:0xf
    s_nop 1
    v_mov_b32_dpp v58, v56 row_ror:8 row_mask:0xf bank_mask:0xf
    v_med3_u32 v56, v56, v58, v51
    s_nop 1
    v_mov_b32_dpp v58, v56 quad_perm:[2,3,0,1] row_mask:0xf bank_mask:0xf
    v_med3_u32 v56, v56, v58, v52
    s_nop 1
    v_mov_b32_dpp v58, v56 quad_perm:[1,0,3,2] row_mask:0xf bank_mask:0xf
    v_med3_u32 v57, v56, v58, v53
    v_med3_u32 v56, v56, v58, v53
    s_nop 1
    v_permlane16_swap_b32 v56, v57
    v_max_u32 v56, v56, v57
    s_nop 1
    v_mov_b32_dpp v58, v56 row_ror:8 row_mask:0xf bank_mask:0xf
    v_med3_u32 v56, v56, v58, v51
    s_nop 1
    v_mov_b32_dpp v58, v56 quad_perm:[2,3,0,1] row_mask:0xf bank_mask:0xf
    v_med3_u32 v56, v56, v58, v52
    s_nop 1
    v_mov_b32_dpp v58, v56 quad_perm:[1,0,3,2] row_mask:0xf bank_mask:0xf
    v_med3_u32 v57, v56, v58, v53
    v_med3_u32 v56, v56, v58, v53
    s_nop 1
    v_permlane32_swap_b32 v56, v57
    v_max_u32 v56, v56, v57
    ds_write_b32 v13, v56
    s_cmp_lt_u32 s2, 144
    v_and_b32 v58, 0x4fc, v56
    v_lshl_or_b32 v58, v58, 2, v55
    v_mov_b32 v62, v56
    ds_read_b64 v[56:57], v58
    s_cbranch_scc1 T_V
    s_waitcnt lgkmcnt(0)
    s_barrier
    ds_read_b32 v7, v160
    s_waitcnt lgkmcnt(0)
    v_and_b32 v7, 0x7ff, v7
    v_mad_i32_i24 v7, v7, s64, v161
    buffer_load_dwordx4 v[8:11], v7, s[40:43], s63 offen sc1
T_V:
    v_min_u32_dpp v58, v62, v62 quad_perm:[1,0,3,2] row_mask:0xf bank_mask:0xf
    s_nop 1
    v_min_u32_dpp v58, v58, v58 quad_perm:[2,3,0,1] row_mask:0xf bank_mask:0xf
    s_nop 1
    v_min_u32_dpp v58, v58, v58 row_ror:8 row_mask:0xf bank_mask:0xf
    s_waitcnt lgkmcnt(0)
    v_cmp_ge_u32 vcc, v56, v58
    v_cmp_ge_u32 s[52:53], v57, v58
    s_bcnt1_i32_b64 s54, vcc
    s_bcnt1_i32_b64 s52, s[52:53]
    s_add_u32 s52, s52, s54
    s_cmp_eq_u32 s52, 8
    s_cbranch_scc0 T_M
T_OK:
    s_movk_i32 s60, 4000
    s_cmp_lt_u32 s2, 144
    s_cbranch_scc1 FIN
    s_setprio 0
    s_branch F_ZP_W
T_M:
    v_cmp_ne_u32 s[56:57], v62, v56
    v_cmp_ne_u32 s[74:75], v62, v57
    s_nop 0
    v_cndmask_b32 v56, 0, v56, s[56:57]
    v_cndmask_b32 v57, 0, v57, s[74:75]
    s_mov_b64 s[72:73], -1
T_L:
    v_max_u32 v59, v56, v57
    v_cmp_gt_u32 vcc, v59, v58
    s_nop 4
    s_cbranch_vccz T_X
    s_ff1_i32_b64 s52, vcc
    v_cmp_eq_u32 vcc, v62, v58
    v_readlane_b32 s53, v59, s52
    s_ff1_i32_b64 s54, vcc
    s_cmp_lt_u32 s2, 144
    s_cbranch_scc1 T_L2
    s_and_b32 s55, s53, 0x7ff
    s_mul_i32 s55, s55, s64
    s_add_u32 s55, s55, 9501184
    buffer_load_dwordx4 v[64:67], v3, s[40:43], s55 offen sc1
    buffer_load_dwordx4 v[68:71], v3, s[40:43], s55 offen offset:1024 sc1
T_L2:
    v_mov_b32 v59, s53
    v_cndmask_b32 v62, v62, v59, vcc
    v_cmp_ne_u32 s[56:57], s53, v56
    v_cmp_ne_u32 s[74:75], s53, v57
    s_nop 0
    v_cndmask_b32 v56, 0, v56, s[56:57]
    v_cndmask_b32 v57, 0, v57, s[74:75]
    v_min_u32_dpp v58, v62, v62 quad_perm:[1,0,3,2] row_mask:0xf bank_mask:0xf
    s_nop 1
    v_min_u32_dpp v58, v58, v58 quad_perm:[2,3,0,1] row_mask:0xf bank_mask:0xf
    s_nop 1
    v_min_u32_dpp v58, v58, v58 row_ror:8 row_mask:0xf bank_mask:0xf
    s_cmp_lt_u32 s2, 144
    s_cbranch_scc1 T_L
    s_lshr_b32 s52, s54, 1
    s_and_b32 s52, s52, 4
    s_and_b32 s54, s54, 3
    s_add_u32 s54, s54, s52
    s_mul_i32 s54, s54, 608
    s_add_u32 s54, s54, 147456
    v_and_b32 v72, 1, v1
    v_mul_u32_u24 v72, 4862, v72
    v_mul_u32_u24 v73, 6, v1
    v_sub_u32 v74, v73, v72
    v_add_u32 v73, v73, v72
    v_add_u32 v75, s54, v73
    v_add_u32 v76, s54, v74
    s_mov_b64 exec, s[72:73]
    s_movk_i32 s60, 4000
    s_branch T_Z_W
T_Z:
    buffer_load_dwordx4 v[8:11], v7, s[40:43], s63 offen sc1
T_Z_W:
    s_waitcnt vmcnt(0)
T_Z_C:
    v_cmp_ne_u32 vcc, s39, v11
    s_nop 0
    s_and_b64 exec, exec, vcc
    s_cbranch_execz T_Z_D
    s_wqm_b64 exec, exec
    s_sub_u32 s60, s60, 1
    s_cmp_gt_i32 s60, 0
    s_cbranch_scc1 T_Z
T_Z_D:
    s_mov_b64 exec, s[72:73]
    ds_write2_b32 v162, v8, v10 offset0:0 offset1:1
    ds_write_b32 v2, v9
    s_mov_b64 s[72:73], 0
    s_mov_b64 exec, -1
    s_movk_i32 s60, 4000
    s_branch T_F_W
T_F:
    buffer_load_dwordx4 v[64:67], v3, s[40:43], s55 offen sc1
    buffer_load_dwordx4 v[68:71], v3, s[40:43], s55 offen offset:1024 sc1
T_F_W:
    s_waitcnt vmcnt(0)
T_F_C:
    v_cmp_ne_u32 vcc, s39, v67
    v_cmp_ne_u32 s[56:57], s39, v71
    s_nop 0
    s_or_b32 vcc_lo, vcc_lo, s56
    s_and_b64 exec, exec, vcc
    s_cbranch_execz T_F_D
    s_wqm_b64 exec, exec
    s_sub_u32 s60, s60, 1
    s_cmp_gt_i32 s60, 0
    s_cbranch_scc1 T_F
T_F_D:
    s_mov_b64 exec, -1
    s_movk_i32 s60, 4000
T_C:
    ds_read_b32 v72, v63 offset:0
    s_sub_u32 s60, s60, 1
    s_cmp_gt_i32 s60, 0
    s_waitcnt lgkmcnt(0)
    v_readfirstlane_b32 s52, v72
    s_nop 0
    s_cselect_b32 s52, s52, 11
    s_cmp_lg_u32 s52, 11
    s_cbranch_scc1 T_C
    ds_write2_b32 v75, v64, v66 offset0:0 offset1:1
    ds_write_b32 v76, v65 offset:4864
    s_mov_b32 exec_hi, 0
    ds_write2_b32 v75, v68, v70 offset0:96 offset1:97
    ds_write_b32 v76, v69 offset:5248
    s_mov_b64 exec, -1
    s_branch T_L
T_X:
    s_movk_i32 s60, 4000
    s_cmp_lt_u32 s2, 144
    s_cbranch_scc1 FIN
    s_setprio 0
    s_branch F_BQ
F_SEL:
    s_setprio 0
    s_waitcnt lgkmcnt(0)
    s_barrier
    ds_read_b32 v7, v160
    s_waitcnt lgkmcnt(0)
    v_and_b32 v7, 0x7ff, v7
    v_mad_i32_i24 v7, v7, s64, v161
    s_movk_i32 s60, 4000
F_ZP:
    buffer_load_dwordx4 v[8:11], v7, s[40:43], s63 offen sc1
F_ZP_W:
    s_waitcnt vmcnt(0)
F_ZP_C:
    v_cmp_ne_u32 vcc, s39, v11
    s_nop 0
    s_and_b64 exec, exec, vcc
    s_cbranch_execz F_ZP_D
    s_wqm_b64 exec, exec
    s_sub_u32 s60, s60, 1
    s_cmp_gt_i32 s60, 0
    s_cbranch_scc1 F_ZP
F_ZP_D:
    s_mov_b64 exec, -1
    ds_write2_b32 v162, v8, v10 offset0:0 offset1:1
    ds_write_b32 v2, v9
    s_mov_b64 exec, 0x1
    ds_inc_u32 v63, v63 offset:0
    s_mov_b64 exec, -1
F_BQ:
    s_cmp_ge_u32 s38, s59
    s_waitcnt lgkmcnt(0)
    s_barrier
    s_cbranch_scc1 F_H
    ds_read_b128 v[16:19], v163 offset:0
    ds_read_b128 v[20:23], v163 offset:64
    ds_read_b128 v[24:27], v163 offset:128
    ds_read_b128 v[28:31], v163 offset:192
    ds_read_b128 v[32:35], v163 offset:256
    ds_read_b128 v[36:39], v163 offset:320
    ds_read_b128 v[40:43], v163 offset:384
    ds_read_b128 v[44:47], v163 offset:448
    ds_read_b128 v[48:51], v163 offset:512
    s_waitcnt lgkmcnt(8)
    v_smfmac_f32_16x16x64_bf16 v[12:15], v[16:19], v[64:71], v6
    s_waitcnt lgkmcnt(7)
    v_smfmac_f32_16x16x64_bf16 v[12:15], v[20:23], v[72:79], v6
    s_waitcnt lgkmcnt(6)
    v_smfmac_f32_16x16x64_bf16 v[12:15], v[24:27], v[80:87], v6
    s_waitcnt lgkmcnt(5)
    v_smfmac_f32_16x16x64_bf16 v[12:15], v[28:31], v[88:95], v6
    s_waitcnt lgkmcnt(4)
    v_smfmac_f32_16x16x64_bf16 v[12:15], v[32:35], v[96:103], v6
    s_waitcnt lgkmcnt(3)
    v_smfmac_f32_16x16x64_bf16 v[12:15], v[36:39], v[104:111], v6
    s_waitcnt lgkmcnt(2)
    v_smfmac_f32_16x16x64_bf16 v[12:15], v[40:43], v[112:119], v6
    s_waitcnt lgkmcnt(1)
    v_smfmac_f32_16x16x64_bf16 v[12:15], v[44:47], v[120:127], v6
    s_waitcnt lgkmcnt(0)
    v_smfmac_f32_16x16x64_bf16 v[12:15], v[48:51], v[128:135], v6
    s_nop 7
    v_permlane32_swap_b32 v12, v14
    v_permlane32_swap_b32 v13, v15
    v_add_f32 v12, v12, v14
    v_add_f32 v13, v13, v15
    v_cvt_pk_bf16_f32 v12, v12, v13
    s_nop 1
    v_mov_b32_dpp v13, v12 row_ror:8 row_mask:0xf bank_mask:0xf
    v_perm_b32 v8, v12, v13, v4
    v_mul_f32 v10, 0xbfb8aa3b, v8
    v_exp_f32 v10, v10
    v_perm_b32 v9, v12, v13, v5
    v_add_f32 v10, 1.0, v10
    v_rcp_f32 v10, v10
    s_nop 0
    v_mul_f32 v8, v8, v10
    v_cvt_pk_bf16_f32 v8, v8, v8
    v_lshlrev_b32 v8, 16, v8
    v_mul_f32 v8, v8, v9
    v_cvt_pk_bf16_f32 v8, v8, v8
    ds_write_b16 v164, v8
F_H:
    s_waitcnt lgkmcnt(0)
    s_barrier
    ds_read_b128 v[16:19], v60
    ds_read_b128 v[20:23], v60 offset:1024
    ds_read_b128 v[24:27], v61
    ds_read_b128 v[28:31], v61 offset:1024
    s_waitcnt lgkmcnt(3)
    v_mfma_f32_16x16x32_bf16 v[12:15], v[16:19], v[152:155], 0
    v_mfma_f32_16x16x32_bf16 v[8:11], v[16:19], v[136:139], 0
    s_waitcnt lgkmcnt(2)
    v_mfma_f32_16x16x32_bf16 v[12:15], v[20:23], v[156:159], v[12:15]
    v_mfma_f32_16x16x32_bf16 v[8:11], v[20:23], v[140:143], v[8:11]
    s_waitcnt lgkmcnt(1)
    v_mfma_f32_16x16x32_bf16 v[8:11], v[24:27], v[144:147], v[8:11]
    s_waitcnt lgkmcnt(0)
    v_mfma_f32_16x16x32_bf16 v[8:11], v[28:31], v[148:151], v[8:11]
    s_mov_b32 exec_hi, 0
    s_nop 1
    buffer_store_dwordx4 v[12:15], v166, s[40:43], s62 offen sc1
    s_mov_b64 exec, -1
    s_nop 2
    buffer_store_dwordx4 v[8:11], v165, s[40:43], s62 offen sc1
    s_branch END
FIN:
    s_cmp_ge_u32 s2, 72
    s_cselect_b32 s44, 32, 0
    s_cselect_b32 s45, 72, 0
    s_sub_u32 s45, s2, s45
    s_mul_i32 s46, s45, 43
    s_lshr_b32 s46, s46, 8
    s_mul_i32 s47, s46, 6
    s_sub_u32 s47, s45, s47
    v_lshrrev_b32 v6, 4, v1
    v_lshl_add_u32 v7, v6, 2, s44
    ds_bpermute_b32 v7, v7, v62
    v_and_b32 v8, 7, v1
    v_and_b32 v5, 15, v1
    s_lshl_b32 s48, s47, 2
    s_add_u32 s49, s48, 1024 - 16
    s_cmp_eq_u32 s47, 3
    s_cselect_b32 s49, 1024 + 8, s49
    s_cmp_lt_u32 s47, 3
    s_cselect_b32 s48, s48, s49
    s_lshl_b32 s49, s46, 11
    s_add_u32 s48, s48, s49
    s_add_u32 s48, s48, 3211264
    s_lshl_b32 s47, s47, 1
    s_lshl_b32 s49, s46, 7
    s_add_u32 s49, s49, s47
    s_add_u32 s49, s49, 6356992
    s_mul_i32 s46, s46, 96
    s_add_u32 s46, s46, s47
    s_movk_i32 s47, 8192
    s_mul_i32 s52, s2, 10240
    s_add_u32 s52, s52, 9502720
    s_add_u32 s53, s52, 4096
    s_add_u32 s54, s52, 8192
    v_mov_b32 v60, 0
    v_mov_b32 v61, 0
    v_mov_b32 v62, 0
    s_waitcnt lgkmcnt(0)
    v_and_b32 v9, 0x7ff, v7
    v_sub_u32 v9, 0x7ff, v9
    v_lshrrev_b32 v10, 4, v9
    v_lshlrev_b32 v11, 6, v10
    v_min_u32 v5, 11, v5
    v_lshl_add_u32 v11, v5, 2, v11
    v_mul_u32_u24 v12, 0x480, v9
    v_mad_u32_u24 v12, v8, 12, v12
    v_add_u32 v12, s46, v12
    v_mul_u32_u24 v10, 0x6000, v10
    v_lshl_add_u32 v10, v8, 7, v10
    v_and_b32 v13, 14, v9
    v_lshl_add_u32 v10, v13, 3, v10
    v_and_b32 v13, 1, v9
    v_lshl_add_u32 v10, v13, 1, v10
    v_mul_u32_u24 v9, 0x600, v9
    v_lshl_add_u32 v9, v8, 4, v9
    global_load_short_d16_hi v60, v12, s[4:5]
    buffer_load_short_d16_hi v61, v10, s[40:43], s48 offen sc1
    v_ashrrev_i32 v13, 31, v7
    v_not_b32 v13, v13
    v_or_b32 v13, 0x80000000, v13
    v_xor_b32 v7, v7, v13
    v_and_b32 v7, 0xffff0000, v7
    v_mul_f32 v7, 0xbfb8aa3b, v7
    v_exp_f32 v7, v7
    s_waitcnt vmcnt(0)
    v_add_f32 v60, v60, v61
    v_add_f32 v7, 1.0, v7
    v_rcp_f32 v7, v7
    v_cvt_pk_bf16_f32 v60, v60, v60
    v_lshlrev_b32 v60, 16, v60
    v_cvt_pk_bf16_f32 v7, v7, v7
    v_lshlrev_b32 v7, 16, v7
    s_mov_b64 exec, 0x1
    s_movk_i32 s60, 4000
FN_HP:
    buffer_load_dword v13, v3, s[40:43], s52 offen offset:0 sc1
FN_HP_W:
    s_waitcnt vmcnt(0)
FN_HP_C:
    v_cmp_eq_u32 vcc, -1, v13
    s_nop 0
    s_and_b64 exec, exec, vcc
    s_cbranch_execz FN_HP_D
    s_sub_u32 s60, s60, 1
    s_cmp_gt_i32 s60, 0
    s_sleep 1
    s_cbranch_scc1 FN_HP
FN_HP_D:
    s_mov_b64 exec, -1
    s_movk_i32 s60, 4000
FN_PP:
    buffer_load_dword v13, v11, s[40:43], s47 offen sc1
    buffer_load_short_d16_hi v62, v9, s[40:43], s49 offen sc1
    buffer_load_dwordx4 v[16:19], v3, s[40:43], s52 offen offset:0 sc1
    buffer_load_dwordx4 v[20:23], v3, s[40:43], s52 offen offset:1024 sc1
    buffer_load_dwordx4 v[24:27], v3, s[40:43], s52 offen offset:2048 sc1
    buffer_load_dwordx4 v[28:31], v3, s[40:43], s52 offen offset:3072 sc1
    buffer_load_dwordx4 v[32:35], v3, s[40:43], s53 offen offset:0 sc1
    buffer_load_dwordx4 v[36:39], v3, s[40:43], s53 offen offset:1024 sc1
    buffer_load_dwordx4 v[40:43], v3, s[40:43], s53 offen offset:2048 sc1
    buffer_load_dwordx4 v[44:47], v3, s[40:43], s53 offen offset:3072 sc1
    buffer_load_dwordx4 v[48:51], v3, s[40:43], s54 offen offset:0 sc1
    buffer_load_dwordx4 v[52:55], v3, s[40:43], s54 offen offset:1024 sc1
FN_PP_W:
    s_waitcnt vmcnt(0)
FN_PP_C:
    v_cmp_ne_u32 s[56:57], s39, v13
    v_pk_add_f32 v[64:65], v[16:17], v[20:21]
    v_pk_add_f32 v[68:69], v[24:25], v[28:29]
    v_pk_add_f32 v[66:67], v[18:19], v[22:23]
    v_pk_add_f32 v[70:71], v[26:27], v[30:31]
    v_pk_add_f32 v[64:65], v[64:65], v[32:33]
    v_pk_add_f32 v[66:67], v[66:67], v[34:35]
    v_pk_add_f32 v[68:69], v[68:69], v[36:37]
    v_pk_add_f32 v[70:71], v[70:71], v[38:39]
    v_pk_add_f32 v[64:65], v[64:65], v[40:41]
    v_pk_add_f32 v[66:67], v[66:67], v[42:43]
    v_pk_add_f32 v[68:69], v[68:69], v[44:45]
    v_pk_add_f32 v[70:71], v[70:71], v[46:47]
    v_pk_add_f32 v[64:65], v[64:65], v[48:49]
    v_pk_add_f32 v[66:67], v[66:67], v[50:51]
    v_pk_add_f32 v[68:69], v[68:69], v[52:53]
    v_pk_add_f32 v[70:71], v[70:71], v[54:55]
    v_pk_add_f32 v[64:65], v[64:65], v[68:69]
    v_pk_add_f32 v[66:67], v[66:67], v[70:71]
    v_pk_add_f32 v[68:69], v[64:65], v[66:67]
    v_cmp_u_f32 vcc, v68, v69
    s_nop 0
    s_or_b64 vcc, vcc, s[56:57]
    s_and_b64 exec, exec, vcc
    s_cbranch_execz FN_PP_D
    s_sub_u32 s60, s60, 1
    s_cmp_gt_i32 s60, 0
    s_cbranch_scc1 FN_PP
FN_PP_D:
    s_mov_b64 exec, -1
    v_permlane32_swap_b32 v64, v66
    v_permlane32_swap_b32 v65, v67
    v_add_f32 v64, v64, v66
    v_add_f32 v65, v65, v67
    s_nop 1
    v_permlane16_swap_b32 v64, v65
    v_add_f32 v64, v64, v65
    s_nop 1
    v_add_f32_dpp v64, v64, v64 row_ror:8 row_mask:0xf bank_mask:0xf
    v_cvt_pk_bf16_f32 v64, v64, v64
    v_lshlrev_b32 v64, 16, v64
    v_mul_f32 v64, v64, v7
    v_cvt_pk_bf16_f32 v64, v64, v64
    v_lshlrev_b32 v64, 16, v64
    v_add_f32 v64, v64, v62
    v_cvt_pk_bf16_f32 v64, v64, v64
    v_lshlrev_b32 v64, 16, v64
    v_add_f32 v64, v64, v60
    v_cvt_pk_bf16_f32 v64, v64, v64
    s_mov_b32 exec_lo, 0xff00ff
    s_mov_b32 exec_hi, 0xff00ff
    global_store_short v12, v64, s[32:33]
    s_mov_b64 exec, -1
END:
    s_endpgm
CODE_END:
.section .rodata,"a"
.p2align 6
.amdhsa_kernel sequential_preLN__ssm_conv_s4__moe_arch_mod__prompt_kernel
  .amdhsa_next_free_vgpr 168
  .amdhsa_next_free_sgpr 102
  .amdhsa_accum_offset 168
  .amdhsa_group_segment_fixed_size 0
  .amdhsa_kernarg_size 136
  .amdhsa_user_sgpr_count 2
  .amdhsa_user_sgpr_kernarg_segment_ptr 1
  .amdhsa_system_sgpr_workgroup_id_x 1
.end_amdhsa_kernel
```

```asm
; @launch grid=(256,1,1) block=(768,1,1) lds=163840
.amdgcn_target "amdgcn-amd-amdhsa--gfx950"
    .text
    .globl sequential_preLN__ssm_conv_s4__moe_arch_mod__prompt_kernel
    .p2align 8
    .type sequential_preLN__ssm_conv_s4__moe_arch_mod__prompt_kernel,@function
sequential_preLN__ssm_conv_s4__moe_arch_mod__prompt_kernel:
    s_cmp_ge_u32 s2, 256
    s_cbranch_scc1 END
    s_load_dwordx16 s[4:19], s[0:1], 0
    s_load_dwordx2 s[36:37], s[0:1], 128
    s_load_dwordx16 s[20:35], s[0:1], 64
    s_getpc_b64 s[70:71]
    s_lshr_b32 s3, s2, 3
    s_mul_i32 s3, s3, 7
    v_subrev_u32 v2, 320, v0
    v_cmp_gt_u32 vcc, 7, v2
    v_add_lshl_u32 v2, v2, s3, 7
    v_min_u32 v2, CODE_END-sequential_preLN__ssm_conv_s4__moe_arch_mod__prompt_kernel-64, v2
    v_mov_b32 v3, s71
    s_mov_b64 exec, vcc
    v_add_co_u32 v2, vcc, s70, v2
    s_nop 1
    v_addc_co_u32 v3, vcc, 0, v3, vcc
    s_cbranch_execz P_NC
    global_load_dword v159, v[2:3], off
P_NC:
    s_mov_b64 exec, -1
    v_lshrrev_b32 v2, 6, v0
    v_and_b32 v1, 63, v0
    v_readfirstlane_b32 s38, v2
    v_lshlrev_b32 v3, 4, v1
    s_mov_b32 s42, 0x10000000
    s_mov_b32 s43, 0x00020000
    s_cmp_lt_u32 s2, 192
    s_cselect_b32 s3, 4, -1
    s_cmp_lg_u32 s38, s3
    s_cbranch_scc1 P_NP
    s_mul_i32 s52, s2, 768
    v_add_u32 v16, s52, v3
    s_mul_i32 s52, s2, 6
    s_and_b32 s52, s52, -4
    v_lshl_add_u32 v17, v1, 2, s52
    v_mov_b32 v18, 161536
    v_mov_b32 v19, 0
    ds_write_b32 v18, v19
    v_mov_b32 v20, s70
    v_mov_b32 v21, s71
    s_waitcnt lgkmcnt(0)
    s_mov_b32 exec_lo, 0xffffffff
    s_mov_b32 exec_hi, 0xffff
    s_mov_b32 m0, 138048
    s_nop 0
    global_load_lds_dwordx4 v16, s[6:7]
    s_mov_b32 m0, 138816
    s_nop 0
    global_load_lds_dwordx4 v16, s[8:9]
    s_mov_b32 m0, 139584
    s_nop 0
    global_load_lds_dwordx4 v16, s[10:11]
    s_mov_b32 m0, 140352
    s_nop 0
    global_load_lds_dwordx4 v16, s[12:13]
    s_mov_b32 m0, 141120
    s_nop 0
    global_load_lds_dwordx4 v16, s[14:15]
    s_mov_b32 m0, 141888
    s_nop 0
    global_load_lds_dwordx4 v16, s[16:17]
    s_mov_b64 exec, 0x3
    s_mov_b32 m0, 142656
    s_nop 0
    global_load_lds_dword v17, s[18:19]
    s_mov_b32 m0, 142672
    s_nop 0
    global_load_lds_dword v17, s[20:21]
    s_mov_b64 exec, 0x1
    s_mov_b32 m0, 161536
    s_nop 0
    global_load_lds_dword v[20:21], off
    s_mov_b64 exec, -1
P_NP:
    s_cmp_ge_u32 s38, 4
    s_cbranch_scc1 P_B
    s_setprio 3
    v_lshrrev_b32 v147, 5, v0
    v_and_b32 v148, 31, v0
    v_mul_u32_u24 v140, 0x480, v147
    s_mul_i32 s44, s2, 9216
    v_mad_u32_u24 v140, v148, 12, v140
    v_mov_b32 v104, 0
    v_mov_b32 v105, 0
    v_mov_b32 v106, 0
    v_mov_b32 v107, 0
    v_add_u32 v140, s44, v140
    v_add_u32 v149, 161280, v3
    s_mov_b64 exec, 0xffff
    ds_write_b128 v149, v[104:107]
    s_mov_b64 exec, -1
    v_mov_b32 v94, 1
    v_and_b32 v147, 1, v147
    v_mul_u32_u24 v141, 0x90, v148
    v_lshl_add_u32 v141, v147, 6, v141
    s_lshl_b32 s45, s38, 4
    s_sub_u32 s45, 147504, s45
    v_add_u32 v141, s45, v141
    v_lshrrev_b32 v142, 3, v1
    v_add_u32 v142, v142, v1
    s_mul_i32 s45, s38, 3456
    s_add_u32 s45, s45, 147456
    v_lshl_add_u32 v142, v142, 4, s45
    v_lshrrev_b32 v143, 2, v1
    v_mul_u32_u24 v143, 16320, v143
    v_add_u32 v143, v143, v3
    s_lshl_b32 s46, s2, 6
    s_sub_u32 s46, 81856, s46
    s_mul_i32 s45, s38, 786432
    s_add_u32 s46, s46, s45
    s_add_u32 s47, s46, 262144
    s_add_u32 s48, s46, 524288
    s_mov_b32 s49, 0x05040100
    s_mov_b32 s50, 0x07060302
    v_mov_b32 v144, s49
    s_mov_b32 exec_lo, 0
    v_mov_b32 v144, s50
    s_mov_b64 exec, -1
    v_mov_b32 v145, 161328
    s_lshl_b32 s45, s38, 2
    v_add_u32 v146, s45, v145
    s_waitcnt lgkmcnt(0)
    global_load_dword v95, v104, s[36:37] offset:0
    global_load_dwordx3 v[60:62], v140, s[4:5] offset:0
    global_load_dwordx3 v[64:66], v140, s[4:5] offset:384
    global_load_dwordx3 v[68:70], v140, s[4:5] offset:768
    s_mov_b32 s40, s36
    s_mov_b32 s41, s37
    s_cmp_ge_u32 s2, 192
    s_cbranch_scc1 P_C
    s_lshr_b32 s65, s38, 2
    s_bitcmp1_b32 s2, 0
    s_addc_u32 s51, s65, 0
    s_cmp_eq_u32 s51, 3
    s_cselect_b32 s51, 0, s51
    s_lshl_b32 s52, s51, 8
    s_add_u32 s52, s52, 138048
    v_and_b32 v114, 0x7f, v0
    v_lshl_add_u32 v114, v114, 1, s52
    s_and_b32 s52, s2, 1
    s_add_u32 s52, s52, s51
    s_lshl_b32 s52, s52, 1
    s_add_u32 s52, s52, 142656
    v_mov_b32 v115, s52
    v_mov_b32 v119, 161536
    v_mov_b32 v29, 0
    v_mov_b32 v30, 0
    v_mov_b32 v31, 0
    v_mov_b32 v32, 0
    v_mov_b32 v33, 0
    v_mov_b32 v34, 0
    v_mov_b32 v35, 0
    v_mov_b32 v160, 0
    v_mov_b32 v161, 0
    v_mov_b32 v162, 0
    v_mov_b32 v163, 0
    v_mov_b32 v164, 0
    v_lshlrev_b32 v16, 4, v0
    v_add_u32 v17, 101184, v16
    ds_write_b128 v17, v[160:163] offset:0
    ds_write_b128 v17, v[160:163] offset:12288
    ds_write_b128 v17, v[160:163] offset:24576
    s_mul_i32 s59, s65, 16320
    s_mul_i32 s67, s65, 17408
    s_add_u32 s71, s67, 48960
    s_and_b32 s66, s38, 1
    s_lshl_b32 s66, s66, 8
    s_add_u32 s70, s66, s67
    s_add_u32 s70, s70, 16192
    s_add_u32 s66, s66, s59
    s_mov_b32 m0, s66
    s_mul_i32 s64, s65, 5888
    s_add_u32 s64, s64, 101184
    s_and_b32 s69, s38, 3
    v_and_b32 v5, 15, v0
    v_bfe_u32 v6, v0, 4, 2
    v_and_b32 v17, 48, v0
    v_mul_u32_u24 v110, 544, v5
    s_mov_b32 s52, 0
    s_movk_i32 s53, 2176
    s_movk_i32 s54, 4896
    s_cmp_eq_u32 s69, 1
    s_cselect_b32 s52, 9792, s52
    s_cselect_b32 s53, 1088, s53
    s_cselect_b32 s54, 3264, s54
    s_cmp_eq_u32 s69, 3
    s_cselect_b32 s52, 544, s52
    s_add_u32 s52, s52, s59
    s_cmp_eq_u32 s69, 2
    s_cselect_b32 s52, s71, s52
    s_cselect_b32 s54, 4352, s54
    s_add_u32 s67, s71, 8704
    v_and_b32 v111, 3, v0
    v_mul_u32_u24 v111, 544, v111
    v_bfe_u32 v18, v0, 2, 1
    v_bfe_u32 v19, v0, 3, 1
    v_xor_b32 v18, v18, v19
    v_mad_u32_u24 v111, v19, s53, v111
    v_mad_u32_u24 v111, v18, s54, v111
    v_add3_u32 v111, v111, v17, s52
    v_add3_u32 v110, v110, v17, s67
    s_barrier
    v_lshl_add_u32 v18, v5, 1, v6
    s_sub_u32 s52, s69, 11
    v_add_u32 v18, s52, v18
    v_add_u32 v19, 1, v18
    v_lshl_add_u32 v20, v6, 1, 2
    v_cmp_le_u32 s[52:53], v18, v20
    v_cmp_le_u32 s[54:55], v19, v20
    v_mov_b32 v18, 0x3f80
    v_cndmask_b32 v112, 0, v18, s[52:53]
    v_cndmask_b32 v19, 0, 1.0, s[54:55]
    v_or_b32 v112, v112, v19
    s_mul_i32 s52, s38, 1600
    s_add_u32 s52, s52, 120016
    v_lshl_add_u32 v113, v1, 2, s52
    s_mul_i32 s67, s65, 6400
    s_add_u32 s67, s67, 118848
    s_sub_u32 s63, s69, s65
    s_cselect_b32 s52, 3, 0
    s_add_u32 s63, s63, s52
    s_min_u32 s52, s63, 1
    s_add_u32 s63, s63, s52
    s_cmp_eq_u32 s69, 3
    s_cselect_b32 s63, 1, s63
    v_add_u32 v7, 1, v5
    v_and_b32 v8, 3, v7
    v_mul_u32_u24 v8, 1598, v8
    v_lshl_add_u32 v7, v7, 1, v8
    v_add3_u32 v7, v7, v17, s67
    v_add_u32 v18, s64, v17
    v_lshl_add_u32 v9, v5, 3, v18
    v_and_b32 v10, 1, v5
    v_mul_u32_u24 v10, 380, v10
    v_lshl_add_u32 v10, v5, 2, v10
    v_add_u32 v10, v18, v10
    v_lshlrev_b32 v8, 5, v5
    v_sub_u32 v8, v18, v8
    v_lshrrev_b32 v11, 2, v5
    v_lshl_add_u32 v2, v5, 2, v6
    v_add_u32 v15, v2, v11
    v_lshl_add_u32 v4, v15, 3, s59
    s_lshl_b32 s52, s65, 4
    s_add_u32 s52, s52, 161280
    v_mov_b32 v166, s52
    s_branch P_D
P_C:
    v_mov_b32 v8, 0
    v_mov_b32 v10, 0
    v_mov_b32 v166, 0
    s_barrier
P_D:
    s_waitcnt vmcnt(0)
LN1:
    v_dot2c_f32_bf16 v104, 0x3f803f80, v60
    v_dot2c_f32_bf16 v106, v60, v60
    v_dot2c_f32_bf16 v105, 0x3f803f80, v61
    v_dot2c_f32_bf16 v107, v61, v61
    v_dot2c_f32_bf16 v104, 0x3f803f80, v62
    v_dot2c_f32_bf16 v106, v62, v62
    v_dot2c_f32_bf16 v105, 0x3f803f80, v64
    v_dot2c_f32_bf16 v107, v64, v64
    v_dot2c_f32_bf16 v104, 0x3f803f80, v65
    v_dot2c_f32_bf16 v106, v65, v65
    v_dot2c_f32_bf16 v105, 0x3f803f80, v66
    v_dot2c_f32_bf16 v107, v66, v66
    v_dot2c_f32_bf16 v104, 0x3f803f80, v68
    v_dot2c_f32_bf16 v106, v68, v68
    v_dot2c_f32_bf16 v105, 0x3f803f80, v69
    v_dot2c_f32_bf16 v107, v69, v69
    v_dot2c_f32_bf16 v104, 0x3f803f80, v70
    v_dot2c_f32_bf16 v106, v70, v70
    v_add_u32 v95, 1, v95
    s_mov_b64 exec, 0x7
    ds_write_b64 v149, v[94:95] offset:136
    s_mov_b64 exec, -1
    v_add_f32 v104, v104, v105
    v_add_f32 v106, v106, v107
    v_lshlrev_b32 v72, 16, v60
    v_and_b32 v73, 0xffff0000, v60
    v_permlane16_swap_b32 v104, v106
    v_add_f32 v104, v104, v106
    v_lshlrev_b32 v74, 16, v61
    v_and_b32 v75, 0xffff0000, v61
    v_add_f32_dpp v104, v104, v104 quad_perm:[1,0,3,2] row_mask:0xf bank_mask:0xf
    v_lshlrev_b32 v76, 16, v62
    v_and_b32 v77, 0xffff0000, v62
    v_add_f32_dpp v104, v104, v104 quad_perm:[2,3,0,1] row_mask:0xf bank_mask:0xf
    v_lshlrev_b32 v78, 16, v64
    v_and_b32 v79, 0xffff0000, v64
    v_add_f32_dpp v104, v104, v104 row_half_mirror row_mask:0xf bank_mask:0xf
    v_lshlrev_b32 v80, 16, v65
    v_and_b32 v81, 0xffff0000, v65
    v_add_f32_dpp v104, v104, v104 row_mirror row_mask:0xf bank_mask:0xf
    v_mul_f32 v104, 0x3ae38e39, v104
    v_mov_b32 v105, v104
    v_lshlrev_b32 v82, 16, v66
    v_and_b32 v83, 0xffff0000, v66
    v_permlane16_swap_b32 v104, v105
    v_fma_f32 v105, -v104, v104, v105
    v_max_f32 v105, 0, v105
    v_cvt_pk_bf16_f32 v105, v104, v105
    v_lshlrev_b32 v104, 16, v105
    v_and_b32 v105, 0xffff0000, v105
    v_lshlrev_b32 v84, 16, v68
    v_and_b32 v85, 0xffff0000, v68
    v_lshlrev_b32 v86, 16, v69
    v_and_b32 v87, 0xffff0000, v69
    v_lshlrev_b32 v88, 16, v70
    v_and_b32 v89, 0xffff0000, v70
    v_mov_b32 v99, v95
    v_mov_b32 v103, v95
    v_readfirstlane_b32 s39, v95
    v_add_f32 v105, 0x3727c5ac, v105
    v_cvt_pk_bf16_f32 v105, v105, v105
    v_lshlrev_b32 v105, 16, v105
    v_sqrt_f32 v106, v105
    v_pk_add_f32 v[72:73], v[72:73], v[104:105] op_sel_hi:[1,0] neg_lo:[0,1] neg_hi:[0,1]
    v_pk_add_f32 v[74:75], v[74:75], v[104:105] op_sel_hi:[1,0] neg_lo:[0,1] neg_hi:[0,1]
    v_pk_add_f32 v[76:77], v[76:77], v[104:105] op_sel_hi:[1,0] neg_lo:[0,1] neg_hi:[0,1]
    v_cvt_pk_bf16_f32 v106, v106, v106
    v_lshlrev_b32 v106, 16, v106
    v_rcp_f32 v106, v106
    v_pk_add_f32 v[78:79], v[78:79], v[104:105] op_sel_hi:[1,0] neg_lo:[0,1] neg_hi:[0,1]
    v_pk_add_f32 v[80:81], v[80:81], v[104:105] op_sel_hi:[1,0] neg_lo:[0,1] neg_hi:[0,1]
    v_pk_add_f32 v[82:83], v[82:83], v[104:105] op_sel_hi:[1,0] neg_lo:[0,1] neg_hi:[0,1]
    v_pk_add_f32 v[84:85], v[84:85], v[104:105] op_sel_hi:[1,0] neg_lo:[0,1] neg_hi:[0,1]
    v_pk_add_f32 v[86:87], v[86:87], v[104:105] op_sel_hi:[1,0] neg_lo:[0,1] neg_hi:[0,1]
    v_pk_add_f32 v[88:89], v[88:89], v[104:105] op_sel_hi:[1,0] neg_lo:[0,1] neg_hi:[0,1]
    v_cvt_pk_bf16_f32 v73, v72, v73
    v_cvt_pk_bf16_f32 v75, v74, v75
    v_cvt_pk_bf16_f32 v77, v76, v77
    v_cvt_pk_bf16_f32 v79, v78, v79
    v_cvt_pk_bf16_f32 v81, v80, v81
    v_cvt_pk_bf16_f32 v83, v82, v83
    v_cvt_pk_bf16_f32 v85, v84, v85
    v_cvt_pk_bf16_f32 v87, v86, v87
    v_cvt_pk_bf16_f32 v89, v88, v89
    v_lshlrev_b32 v72, 16, v73
    v_and_b32 v73, 0xffff0000, v73
    v_lshlrev_b32 v74, 16, v75
    v_and_b32 v75, 0xffff0000, v75
    v_lshlrev_b32 v76, 16, v77
    v_and_b32 v77, 0xffff0000, v77
    v_pk_mul_f32 v[72:73], v[72:73], v[106:107] op_sel_hi:[1,0]
    v_pk_mul_f32 v[74:75], v[74:75], v[106:107] op_sel_hi:[1,0]
    v_pk_mul_f32 v[76:77], v[76:77], v[106:107] op_sel_hi:[1,0]
    v_cvt_pk_bf16_f32 v60, v72, v73
    v_cvt_pk_bf16_f32 v62, v76, v77
    v_cvt_pk_bf16_f32 v61, v74, v75
    v_cvt_pk_bf16_f32 v63, v74, v75
    v_permlane32_swap_b32 v60, v62
    s_nop 0
    v_permlane32_swap_b32 v61, v63
    v_perm_b32 v92, v60, v62, s49
    v_perm_b32 v93, v60, v62, s50
    v_lshlrev_b32 v78, 16, v79
    v_and_b32 v79, 0xffff0000, v79
    v_lshlrev_b32 v80, 16, v81
    v_and_b32 v81, 0xffff0000, v81
    v_lshlrev_b32 v82, 16, v83
    v_and_b32 v83, 0xffff0000, v83
    v_pk_mul_f32 v[78:79], v[78:79], v[106:107] op_sel_hi:[1,0]
    v_pk_mul_f32 v[80:81], v[80:81], v[106:107] op_sel_hi:[1,0]
    v_pk_mul_f32 v[82:83], v[82:83], v[106:107] op_sel_hi:[1,0]
    v_cvt_pk_bf16_f32 v64, v78, v79
    v_cvt_pk_bf16_f32 v66, v82, v83
    v_cvt_pk_bf16_f32 v65, v80, v81
    v_cvt_pk_bf16_f32 v67, v80, v81
    v_perm_b32 v94, v61, v63, v144
    ds_write_b128 v141, v[92:95] offset:0
    v_permlane32_swap_b32 v64, v66
    v_permlane32_swap_b32 v65, v67
    v_perm_b32 v96, v64, v66, s49
    v_perm_b32 v97, v64, v66, s50
    v_lshlrev_b32 v84, 16, v85
    v_and_b32 v85, 0xffff0000, v85
    v_lshlrev_b32 v86, 16, v87
    v_and_b32 v87, 0xffff0000, v87
    v_lshlrev_b32 v88, 16, v89
    v_and_b32 v89, 0xffff0000, v89
    v_pk_mul_f32 v[84:85], v[84:85], v[106:107] op_sel_hi:[1,0]
    v_pk_mul_f32 v[86:87], v[86:87], v[106:107] op_sel_hi:[1,0]
    v_pk_mul_f32 v[88:89], v[88:89], v[106:107] op_sel_hi:[1,0]
    v_cvt_pk_bf16_f32 v68, v84, v85
    v_cvt_pk_bf16_f32 v70, v88, v89
    v_cvt_pk_bf16_f32 v69, v86, v87
    v_cvt_pk_bf16_f32 v71, v86, v87
    v_perm_b32 v98, v65, v67, v144
    ds_write_b128 v141, v[96:99] offset:4608
    v_permlane32_swap_b32 v68, v70
    v_permlane32_swap_b32 v69, v71
    v_perm_b32 v100, v68, v70, s49
    v_perm_b32 v101, v68, v70, s50
    v_perm_b32 v102, v69, v71, v144
    ds_write_b128 v141, v[100:103] offset:9216
    s_mov_b64 exec, 0x1
    ds_write_b32 v146, v144
    s_mov_b64 exec, -1
LN1_U:
    s_movk_i32 s60, 4000
LN1_R:
    ds_read_b128 v[104:107], v145
    ds_read_b128 v[72:75], v142 offset:0
    ds_read_b128 v[76:79], v142 offset:1152
    ds_read_b128 v[80:83], v142 offset:2304
    s_sub_u32 s60, s60, 1
    s_waitcnt lgkmcnt(3)
    v_min3_u32 v104, v104, v105, v106
    v_min_u32 v104, v104, v107
    v_cmp_eq_u32 vcc, 0, v104
    s_cmp_gt_i32 s60, 0
    s_cselect_b64 s[52:53], vcc, 0
    s_cmp_lg_u64 s[52:53], 0
    s_waitcnt lgkmcnt(0)
    s_cbranch_scc1 LN1_R
    buffer_store_dwordx4 v[72:75], v143, s[40:43], s46 offen sc1
    buffer_store_dwordx4 v[76:79], v143, s[40:43], s47 offen sc1
    buffer_store_dwordx4 v[80:83], v143, s[40:43], s48 offen sc1
    s_cmp_ge_u32 s2, 192
    s_cbranch_scc1 FFN_DMA
    s_branch C_KS
P_B:
    s_cmp_ge_u32 s2, 192
    s_cbranch_scc1 FFN_DMA0
P_B2:
    s_lshr_b32 s65, s38, 2
    s_bitcmp1_b32 s2, 0
    s_addc_u32 s51, s65, 0
    s_cmp_eq_u32 s51, 3
    s_cselect_b32 s51, 0, s51
    s_lshl_b32 s52, s51, 8
    s_add_u32 s52, s52, 138048
    v_and_b32 v114, 0x7f, v0
    v_lshl_add_u32 v114, v114, 1, s52
    s_and_b32 s52, s2, 1
    s_add_u32 s52, s52, s51
    s_lshl_b32 s52, s52, 1
    s_add_u32 s52, s52, 142656
    v_mov_b32 v115, s52
    v_mov_b32 v119, 161536
    v_mov_b32 v29, 0
    v_mov_b32 v30, 0
    v_mov_b32 v31, 0
    v_mov_b32 v32, 0
    v_mov_b32 v33, 0
    v_mov_b32 v34, 0
    v_mov_b32 v35, 0
    v_mov_b32 v160, 0
    v_mov_b32 v161, 0
    v_mov_b32 v162, 0
    v_mov_b32 v163, 0
    v_mov_b32 v164, 0
    v_lshlrev_b32 v16, 4, v0
    v_add_u32 v17, 101184, v16
    ds_write_b128 v17, v[160:163] offset:0
    ds_write_b128 v17, v[160:163] offset:12288
    ds_write_b128 v17, v[160:163] offset:24576
    s_mul_i32 s59, s65, 16320
    s_mul_i32 s67, s65, 17408
    s_add_u32 s71, s67, 48960
    s_and_b32 s66, s38, 1
    s_lshl_b32 s66, s66, 8
    s_add_u32 s70, s66, s67
    s_add_u32 s70, s70, 16192
    s_add_u32 s66, s66, s59
    s_mov_b32 m0, s66
    s_mul_i32 s64, s65, 5888
    s_add_u32 s64, s64, 101184
    s_and_b32 s69, s38, 3
    v_and_b32 v5, 15, v0
    v_bfe_u32 v6, v0, 4, 2
    v_and_b32 v17, 48, v0
    v_mul_u32_u24 v110, 544, v5
    s_mov_b32 s52, 0
    s_movk_i32 s53, 2176
    s_movk_i32 s54, 4896
    s_cmp_eq_u32 s69, 1
    s_cselect_b32 s52, 9792, s52
    s_cselect_b32 s53, 1088, s53
    s_cselect_b32 s54, 3264, s54
    s_cmp_eq_u32 s69, 3
    s_cselect_b32 s52, 544, s52
    s_add_u32 s52, s52, s59
    s_cmp_eq_u32 s69, 2
    s_cselect_b32 s52, s71, s52
    s_cselect_b32 s54, 4352, s54
    s_add_u32 s67, s71, 8704
    v_and_b32 v111, 3, v0
    v_mul_u32_u24 v111, 544, v111
    v_bfe_u32 v18, v0, 2, 1
    v_bfe_u32 v19, v0, 3, 1
    v_xor_b32 v18, v18, v19
    v_mad_u32_u24 v111, v19, s53, v111
    v_mad_u32_u24 v111, v18, s54, v111
    v_add3_u32 v111, v111, v17, s52
    v_add3_u32 v110, v110, v17, s67
    s_barrier
    v_lshl_add_u32 v18, v5, 1, v6
    s_sub_u32 s52, s69, 11
    v_add_u32 v18, s52, v18
    v_add_u32 v19, 1, v18
    v_lshl_add_u32 v20, v6, 1, 2
    v_cmp_le_u32 s[52:53], v18, v20
    v_cmp_le_u32 s[54:55], v19, v20
    v_mov_b32 v18, 0x3f80
    v_cndmask_b32 v112, 0, v18, s[52:53]
    v_cndmask_b32 v19, 0, 1.0, s[54:55]
    v_or_b32 v112, v112, v19
    s_mul_i32 s52, s38, 1600
    s_add_u32 s52, s52, 120016
    v_lshl_add_u32 v113, v1, 2, s52
    s_mul_i32 s67, s65, 6400
    s_add_u32 s67, s67, 118848
    s_sub_u32 s63, s69, s65
    s_cselect_b32 s52, 3, 0
    s_add_u32 s63, s63, s52
    s_min_u32 s52, s63, 1
    s_add_u32 s63, s63, s52
    s_cmp_eq_u32 s69, 3
    s_cselect_b32 s63, 1, s63
    v_add_u32 v7, 1, v5
    v_and_b32 v8, 3, v7
    v_mul_u32_u24 v8, 1598, v8
    v_lshl_add_u32 v7, v7, 1, v8
    v_add3_u32 v7, v7, v17, s67
    v_add_u32 v18, s64, v17
    v_lshl_add_u32 v9, v5, 3, v18
    v_and_b32 v10, 1, v5
    v_mul_u32_u24 v10, 380, v10
    v_lshl_add_u32 v10, v5, 2, v10
    v_add_u32 v10, v18, v10
    v_lshlrev_b32 v8, 5, v5
    v_sub_u32 v8, v18, v8
    v_lshrrev_b32 v11, 2, v5
    v_lshl_add_u32 v2, v5, 2, v6
    v_add_u32 v15, v2, v11
    v_lshl_add_u32 v4, v15, 3, s59
    s_lshl_b32 s52, s65, 4
    s_add_u32 s52, s52, 161280
    v_mov_b32 v166, s52
    s_mul_i32 s48, s2, 10240
    s_add_u32 s48, s48, 9695232
    s_cmp_eq_u32 s2, 150
    s_cselect_b32 s48, 28672, s48
    s_cselect_b32 s50, 0, s2
    s_add_u32 s49, s48, 11264
    s_waitcnt lgkmcnt(0)
    s_mov_b32 s40, s36
    s_mov_b32 s41, s37
C_KS:
    s_movk_i32 s60, 4000
C_KP:
    ds_read_b32 v20, v119
    s_sub_u32 s60, s60, 1
    s_cmp_gt_i32 s60, 0
    s_waitcnt lgkmcnt(0)
    v_readfirstlane_b32 s52, v20
    s_nop 0
    s_cselect_b32 s52, s52, 1
    s_cmp_eq_u32 s52, 0
    s_cbranch_scc1 C_KP
    ds_read_u16_d16_hi v29, v115
    ds_read_u16_d16_hi v30, v114 offset:0
    ds_read_u16_d16_hi v31, v114 offset:768
    ds_read_u16_d16_hi v32, v114 offset:1536
    ds_read_u16_d16_hi v33, v114 offset:2304
    ds_read_u16_d16_hi v34, v114 offset:3072
    ds_read_u16_d16_hi v35, v114 offset:3840
    ds_read_u16_d16_hi v164, v115 offset:16
    s_setprio 2
    s_cmp_lt_u32 s38, 4
    s_cbranch_scc1 PG1
    s_setprio 3
PG1:
    s_waitcnt lgkmcnt(0)
    v_mul_f32 v20, 0x3fb8aa3b, v29
    v_mov_b32 v21, 0x3fb8aa3b
    v_fma_f32 v21, v29, v21, -v20
    v_fmac_f32 v21, 0x32a57060, v29
    v_exp_f32 v20, v20
    v_mul_f32 v21, 0x3f317218, v21
    v_fma_f32 v20, v20, v21, v20
    v_cvt_pk_bf16_f32 v20, v20, v20
    v_lshlrev_b32 v20, 16, v20
    v_mul_f32 v21, v30, v20
    v_mul_f32 v36, v31, v20
    v_mul_f32 v32, v32, v20
    v_mul_f32 v33, v33, v20
    v_mul_f32 v21, 0x3fb8aa3b, v21
    v_mul_f32 v22, 0x3e22f983, v36
    v_mov_b32 v23, 0x3e22f983
    v_fma_f32 v23, v36, v23, -v22
    v_fmac_f32 v23, 0x31dc9c88, v36
    v_pk_mul_f32 v[24:25], v[34:35], v[32:33] op_sel:[0,0] op_sel_hi:[0,1]
    v_pk_fma_f32 v[24:25], v[34:35], v[32:33], v[24:25] op_sel:[1,1,0] op_sel_hi:[1,0,1] neg_lo:[1,0,0]
    s_bitcmp1_b32 s38, 1
    s_cbranch_scc1 C_ROLE1
    v_mul_f32 v36, 0x43000000, v21
    v_mul_f32 v37, 0x43000000, v22
    v_mul_f32 v38, 0x41000000, v21
    v_mul_f32 v39, 0x41000000, v22
    v_exp_f32 v36, v36
    v_fract_f32 v37, v37
    v_exp_f32 v38, v38
    v_fract_f32 v39, v39
    v_fmac_f32 v37, 0x43000000, v23
    v_fmac_f32 v39, 0x41000000, v23
    v_cos_f32 v26, v37
    v_sin_f32 v27, v37
    v_cos_f32 v28, v39
    v_sin_f32 v29, v39
    v_mul_f32 v26, v26, v36
    v_mul_f32 v27, v27, v36
    v_mul_f32 v28, v28, v38
    v_mul_f32 v29, v29, v38
    v_mov_b32 v44, 1.0
    v_mov_b32 v45, 0
    v_pk_mul_f32 v[56:57], v[24:25], v[28:29] op_sel:[0,0] op_sel_hi:[0,1]
    v_pk_mul_f32 v[50:51], v[28:29], v[28:29] op_sel:[0,0] op_sel_hi:[0,1]
    v_pk_fma_f32 v[56:57], v[24:25], v[28:29], v[56:57] op_sel:[1,1,0] op_sel_hi:[1,0,1] neg_lo:[1,0,0]
    v_pk_fma_f32 v[50:51], v[28:29], v[28:29], v[50:51] op_sel:[1,1,0] op_sel_hi:[1,0,1] neg_lo:[1,0,0]
    v_pk_mul_f32 v[58:59], v[56:57], v[26:27] op_sel:[0,0] op_sel_hi:[0,1]
    v_pk_fma_f32 v[58:59], v[56:57], v[26:27], v[58:59] op_sel:[1,1,0] op_sel_hi:[1,0,1] neg_lo:[1,0,0]
    v_cvt_pk_bf16_f32 v40, v56, v57
    ds_write_addtid_b32 v40 offset:4352
    v_pk_mul_f32 v[56:57], v[58:59], v[26:27] op_sel:[0,0] op_sel_hi:[0,1]
    v_pk_mul_f32 v[54:55], v[50:51], v[28:29] op_sel:[0,0] op_sel_hi:[0,1]
    v_pk_fma_f32 v[56:57], v[58:59], v[26:27], v[56:57] op_sel:[1,1,0] op_sel_hi:[1,0,1] neg_lo:[1,0,0]
    v_pk_fma_f32 v[54:55], v[50:51], v[28:29], v[54:55] op_sel:[1,1,0] op_sel_hi:[1,0,1] neg_lo:[1,0,0]
    v_cvt_pk_bf16_f32 v41, v58, v59
    ds_write_addtid_b32 v41 offset:9248
    v_cvt_pk_bf16_f32 v42, v44, -v45
    s_mov_b32 m0, s70
    s_nop 0
    ds_write_addtid_b32 v42 offset:41472
    v_cvt_pk_bf16_f32 v43, v28, -v29
    ds_write_addtid_b32 v43 offset:42016
    v_cvt_pk_bf16_f32 v40, v50, -v51
    ds_write_addtid_b32 v40 offset:42560
    v_pk_mul_f32 v[58:59], v[56:57], v[26:27] op_sel:[0,0] op_sel_hi:[0,1]
    v_pk_mul_f32 v[50:51], v[54:55], v[28:29] op_sel:[0,0] op_sel_hi:[0,1]
    v_pk_fma_f32 v[58:59], v[56:57], v[26:27], v[58:59] op_sel:[1,1,0] op_sel_hi:[1,0,1] neg_lo:[1,0,0]
    v_pk_fma_f32 v[50:51], v[54:55], v[28:29], v[50:51] op_sel:[1,1,0] op_sel_hi:[1,0,1] neg_lo:[1,0,0]
    v_cvt_pk_bf16_f32 v41, v56, v57
    s_mov_b32 m0, s66
    s_nop 0
    ds_write_addtid_b32 v41 offset:11968
    v_cvt_pk_bf16_f32 v42, v54, -v55
    s_mov_b32 m0, s70
    s_nop 0
    ds_write_addtid_b32 v42 offset:43104
    v_pk_mul_f32 v[56:57], v[58:59], v[26:27] op_sel:[0,0] op_sel_hi:[0,1]
    v_pk_mul_f32 v[54:55], v[50:51], v[28:29] op_sel:[0,0] op_sel_hi:[0,1]
    v_pk_fma_f32 v[56:57], v[58:59], v[26:27], v[56:57] op_sel:[1,1,0] op_sel_hi:[1,0,1] neg_lo:[1,0,0]
    v_pk_fma_f32 v[54:55], v[50:51], v[28:29], v[54:55] op_sel:[1,1,0] op_sel_hi:[1,0,1] neg_lo:[1,0,0]
    v_cvt_pk_bf16_f32 v43, v58, v59
    s_mov_b32 m0, s66
    s_nop 0
    ds_write_addtid_b32 v43 offset:15232
    v_cvt_pk_bf16_f32 v40, v50, -v51
    s_mov_b32 m0, s70
    s_nop 0
    ds_write_addtid_b32 v40 offset:43648
    v_pk_mul_f32 v[58:59], v[56:57], v[26:27] op_sel:[0,0] op_sel_hi:[0,1]
    v_pk_mul_f32 v[50:51], v[54:55], v[28:29] op_sel:[0,0] op_sel_hi:[0,1]
    v_pk_fma_f32 v[58:59], v[56:57], v[26:27], v[58:59] op_sel:[1,1,0] op_sel_hi:[1,0,1] neg_lo:[1,0,0]
    v_pk_fma_f32 v[50:51], v[54:55], v[28:29], v[50:51] op_sel:[1,1,0] op_sel_hi:[1,0,1] neg_lo:[1,0,0]
    v_cvt_pk_bf16_f32 v41, v56, v57
    ds_write_addtid_b32 v41 offset:33312
    v_cvt_pk_bf16_f32 v42, v54, -v55
    ds_write_addtid_b32 v42 offset:44192
    v_pk_mul_f32 v[56:57], v[58:59], v[26:27] op_sel:[0,0] op_sel_hi:[0,1]
    v_pk_mul_f32 v[54:55], v[50:51], v[28:29] op_sel:[0,0] op_sel_hi:[0,1]
    v_pk_fma_f32 v[56:57], v[58:59], v[26:27], v[56:57] op_sel:[1,1,0] op_sel_hi:[1,0,1] neg_lo:[1,0,0]
    v_pk_fma_f32 v[54:55], v[50:51], v[28:29], v[54:55] op_sel:[1,1,0] op_sel_hi:[1,0,1] neg_lo:[1,0,0]
    v_cvt_pk_bf16_f32 v43, v58, v59
    ds_write_addtid_b32 v43 offset:34400
    v_cvt_pk_bf16_f32 v40, v50, -v51
    ds_write_addtid_b32 v40 offset:44736
    v_pk_mul_f32 v[58:59], v[56:57], v[26:27] op_sel:[0,0] op_sel_hi:[0,1]
    v_pk_mul_f32 v[50:51], v[54:55], v[28:29] op_sel:[0,0] op_sel_hi:[0,1]
    v_pk_fma_f32 v[58:59], v[56:57], v[26:27], v[58:59] op_sel:[1,1,0] op_sel_hi:[1,0,1] neg_lo:[1,0,0]
    v_pk_fma_f32 v[50:51], v[54:55], v[28:29], v[50:51] op_sel:[1,1,0] op_sel_hi:[1,0,1] neg_lo:[1,0,0]
    v_cvt_pk_bf16_f32 v41, v56, v57
    ds_write_addtid_b32 v41 offset:37664
    v_cvt_pk_bf16_f32 v42, v54, -v55
    ds_write_addtid_b32 v42 offset:45280
    v_pk_mul_f32 v[56:57], v[58:59], v[26:27] op_sel:[0,0] op_sel_hi:[0,1]
    v_pk_mul_f32 v[54:55], v[50:51], v[28:29] op_sel:[0,0] op_sel_hi:[0,1]
    v_pk_fma_f32 v[56:57], v[58:59], v[26:27], v[56:57] op_sel:[1,1,0] op_sel_hi:[1,0,1] neg_lo:[1,0,0]
    v_pk_fma_f32 v[54:55], v[50:51], v[28:29], v[54:55] op_sel:[1,1,0] op_sel_hi:[1,0,1] neg_lo:[1,0,0]
    v_cvt_pk_bf16_f32 v43, v58, v59
    ds_write_addtid_b32 v43 offset:38752
    v_cvt_pk_bf16_f32 v40, v50, -v51
    ds_write_addtid_b32 v40 offset:45824
    v_pk_mul_f32 v[58:59], v[56:57], v[26:27] op_sel:[0,0] op_sel_hi:[0,1]
    v_pk_mul_f32 v[50:51], v[54:55], v[28:29] op_sel:[0,0] op_sel_hi:[0,1]
    v_pk_fma_f32 v[58:59], v[56:57], v[26:27], v[58:59] op_sel:[1,1,0] op_sel_hi:[1,0,1] neg_lo:[1,0,0]
    v_pk_fma_f32 v[50:51], v[54:55], v[28:29], v[50:51] op_sel:[1,1,0] op_sel_hi:[1,0,1] neg_lo:[1,0,0]
    v_cvt_pk_bf16_f32 v41, v56, v57
    ds_write_addtid_b32 v41 offset:39296
    v_cvt_pk_bf16_f32 v42, v54, -v55
    ds_write_addtid_b32 v42 offset:46368
    v_pk_mul_f32 v[56:57], v[58:59], v[26:27] op_sel:[0,0] op_sel_hi:[0,1]
    v_pk_mul_f32 v[54:55], v[50:51], v[28:29] op_sel:[0,0] op_sel_hi:[0,1]
    v_pk_fma_f32 v[56:57], v[58:59], v[26:27], v[56:57] op_sel:[1,1,0] op_sel_hi:[1,0,1] neg_lo:[1,0,0]
    v_pk_fma_f32 v[54:55], v[50:51], v[28:29], v[54:55] op_sel:[1,1,0] op_sel_hi:[1,0,1] neg_lo:[1,0,0]
    v_cvt_pk_bf16_f32 v43, v58, v59
    ds_write_addtid_b32 v43 offset:39840
    v_cvt_pk_bf16_f32 v40, v50, -v51
    ds_write_addtid_b32 v40 offset:46912
    v_pk_mul_f32 v[58:59], v[56:57], v[26:27] op_sel:[0,0] op_sel_hi:[0,1]
    v_pk_mul_f32 v[50:51], v[54:55], v[28:29] op_sel:[0,0] op_sel_hi:[0,1]
    v_pk_fma_f32 v[58:59], v[56:57], v[26:27], v[58:59] op_sel:[1,1,0] op_sel_hi:[1,0,1] neg_lo:[1,0,0]
    v_pk_fma_f32 v[50:51], v[54:55], v[28:29], v[50:51] op_sel:[1,1,0] op_sel_hi:[1,0,1] neg_lo:[1,0,0]
    v_cvt_pk_bf16_f32 v41, v56, v57
    ds_write_addtid_b32 v41 offset:40384
    v_cvt_pk_bf16_f32 v42, v54, -v55
    ds_write_addtid_b32 v42 offset:47456
    v_pk_mul_f32 v[56:57], v[58:59], v[26:27] op_sel:[0,0] op_sel_hi:[0,1]
    v_pk_mul_f32 v[54:55], v[50:51], v[28:29] op_sel:[0,0] op_sel_hi:[0,1]
    v_pk_fma_f32 v[56:57], v[58:59], v[26:27], v[56:57] op_sel:[1,1,0] op_sel_hi:[1,0,1] neg_lo:[1,0,0]
    v_pk_fma_f32 v[54:55], v[50:51], v[28:29], v[54:55] op_sel:[1,1,0] op_sel_hi:[1,0,1] neg_lo:[1,0,0]
    v_cvt_pk_bf16_f32 v43, v58, v59
    ds_write_addtid_b32 v43 offset:40928
    v_cvt_pk_bf16_f32 v40, v50, -v51
    ds_write_addtid_b32 v40 offset:48000
    v_pk_mul_f32 v[58:59], v[56:57], v[26:27] op_sel:[0,0] op_sel_hi:[0,1]
    v_pk_mul_f32 v[50:51], v[54:55], v[28:29] op_sel:[0,0] op_sel_hi:[0,1]
    v_pk_fma_f32 v[58:59], v[56:57], v[26:27], v[58:59] op_sel:[1,1,0] op_sel_hi:[1,0,1] neg_lo:[1,0,0]
    v_pk_fma_f32 v[50:51], v[54:55], v[28:29], v[50:51] op_sel:[1,1,0] op_sel_hi:[1,0,1] neg_lo:[1,0,0]
    v_cvt_pk_bf16_f32 v41, v56, v57
    ds_write_addtid_b32 v41 offset:34944
    v_cvt_pk_bf16_f32 v42, v54, -v55
    ds_write_addtid_b32 v42 offset:48544
    v_pk_mul_f32 v[56:57], v[58:59], v[26:27] op_sel:[0,0] op_sel_hi:[0,1]
    v_pk_mul_f32 v[54:55], v[50:51], v[28:29] op_sel:[0,0] op_sel_hi:[0,1]
    v_pk_fma_f32 v[56:57], v[58:59], v[26:27], v[56:57] op_sel:[1,1,0] op_sel_hi:[1,0,1] neg_lo:[1,0,0]
    v_pk_fma_f32 v[54:55], v[50:51], v[28:29], v[54:55] op_sel:[1,1,0] op_sel_hi:[1,0,1] neg_lo:[1,0,0]
    v_cvt_pk_bf16_f32 v43, v58, v59
    ds_write_addtid_b32 v43 offset:35488
    v_cvt_pk_bf16_f32 v40, v50, -v51
    ds_write_addtid_b32 v40 offset:49088
    v_pk_mul_f32 v[58:59], v[56:57], v[26:27] op_sel:[0,0] op_sel_hi:[0,1]
    v_pk_fma_f32 v[58:59], v[56:57], v[26:27], v[58:59] op_sel:[1,1,0] op_sel_hi:[1,0,1] neg_lo:[1,0,0]
    v_cvt_pk_bf16_f32 v41, v56, v57
    ds_write_addtid_b32 v41 offset:36032
    v_cvt_pk_bf16_f32 v42, v54, -v55
    ds_write_addtid_b32 v42 offset:49632
    v_cvt_pk_bf16_f32 v43, v58, v59
    ds_write_addtid_b32 v43 offset:36576
    s_branch C_MFMA
C_ROLE1:
    v_mul_f32 v36, 0x43000000, v21
    v_mul_f32 v37, 0x43000000, v22
    v_mul_f32 v38, 0x3f800000, v21
    v_mul_f32 v39, 0x3f800000, v22
    v_exp_f32 v36, v36
    v_fract_f32 v37, v37
    v_exp_f32 v38, v38
    v_fract_f32 v39, v39
    v_fmac_f32 v37, 0x43000000, v23
    v_fmac_f32 v39, 0x3f800000, v23
    v_cos_f32 v26, v37
    v_sin_f32 v27, v37
    v_cos_f32 v28, v39
    v_sin_f32 v29, v39
    v_mul_f32 v26, v26, v36
    v_mul_f32 v27, v27, v36
    v_mul_f32 v28, v28, v38
    v_mul_f32 v29, v29, v38
    v_pk_mul_f32 v[44:45], v[24:25], v[26:27] op_sel:[0,0] op_sel_hi:[0,1]
    v_pk_mul_f32 v[46:47], v[28:29], v[28:29] op_sel:[0,0] op_sel_hi:[0,1]
    v_pk_mul_f32 v[48:49], v[24:25], v[28:29] op_sel:[0,0] op_sel_hi:[0,1]
    v_pk_fma_f32 v[44:45], v[24:25], v[26:27], v[44:45] op_sel:[1,1,0] op_sel_hi:[1,0,1] neg_lo:[1,0,0]
    v_pk_fma_f32 v[46:47], v[28:29], v[28:29], v[46:47] op_sel:[1,1,0] op_sel_hi:[1,0,1] neg_lo:[1,0,0]
    v_pk_fma_f32 v[48:49], v[24:25], v[28:29], v[48:49] op_sel:[1,1,0] op_sel_hi:[1,0,1] neg_lo:[1,0,0]
    v_cvt_pk_bf16_f32 v40, v24, v25
    ds_write_addtid_b32 v40 offset:0
    v_pk_mul_f32 v[50:51], v[44:45], v[26:27] op_sel:[0,0] op_sel_hi:[0,1]
    v_pk_mul_f32 v[52:53], v[44:45], v[28:29] op_sel:[0,0] op_sel_hi:[0,1]
    v_pk_mul_f32 v[54:55], v[48:49], v[28:29] op_sel:[0,0] op_sel_hi:[0,1]
    v_pk_mul_f32 v[62:63], v[46:47], v[46:47] op_sel:[0,0] op_sel_hi:[0,1]
    v_pk_fma_f32 v[50:51], v[44:45], v[26:27], v[50:51] op_sel:[1,1,0] op_sel_hi:[1,0,1] neg_lo:[1,0,0]
    v_pk_fma_f32 v[52:53], v[44:45], v[28:29], v[52:53] op_sel:[1,1,0] op_sel_hi:[1,0,1] neg_lo:[1,0,0]
    v_pk_fma_f32 v[54:55], v[48:49], v[28:29], v[54:55] op_sel:[1,1,0] op_sel_hi:[1,0,1] neg_lo:[1,0,0]
    v_pk_fma_f32 v[62:63], v[46:47], v[46:47], v[62:63] op_sel:[1,1,0] op_sel_hi:[1,0,1] neg_lo:[1,0,0]
    v_cvt_pk_bf16_f32 v41, v44, v45
    ds_write_addtid_b32 v41 offset:4896
    v_cvt_pk_bf16_f32 v42, v48, v49
    ds_write_addtid_b32 v42 offset:544
    v_pk_mul_f32 v[56:57], v[50:51], v[26:27] op_sel:[0,0] op_sel_hi:[0,1]
    v_pk_mul_f32 v[58:59], v[50:51], v[46:47] op_sel:[0,0] op_sel_hi:[0,1]
    v_pk_mul_f32 v[44:45], v[52:53], v[28:29] op_sel:[0,0] op_sel_hi:[0,1]
    v_pk_mul_f32 v[48:49], v[54:55], v[28:29] op_sel:[0,0] op_sel_hi:[0,1]
    v_pk_fma_f32 v[56:57], v[50:51], v[26:27], v[56:57] op_sel:[1,1,0] op_sel_hi:[1,0,1] neg_lo:[1,0,0]
    v_pk_fma_f32 v[58:59], v[50:51], v[46:47], v[58:59] op_sel:[1,1,0] op_sel_hi:[1,0,1] neg_lo:[1,0,0]
    v_pk_fma_f32 v[44:45], v[52:53], v[28:29], v[44:45] op_sel:[1,1,0] op_sel_hi:[1,0,1] neg_lo:[1,0,0]
    v_pk_fma_f32 v[48:49], v[54:55], v[28:29], v[48:49] op_sel:[1,1,0] op_sel_hi:[1,0,1] neg_lo:[1,0,0]
    v_cvt_pk_bf16_f32 v43, v50, v51
    ds_write_addtid_b32 v43 offset:9792
    v_cvt_pk_bf16_f32 v40, v52, v53
    ds_write_addtid_b32 v40 offset:5440
    v_cvt_pk_bf16_f32 v41, v54, v55
    ds_write_addtid_b32 v41 offset:1088
    v_pk_mul_f32 v[54:55], v[48:49], v[28:29] op_sel:[0,0] op_sel_hi:[0,1]
    v_pk_mul_f32 v[52:53], v[44:45], v[28:29] op_sel:[0,0] op_sel_hi:[0,1]
    v_pk_mul_f32 v[50:51], v[58:59], v[46:47] op_sel:[0,0] op_sel_hi:[0,1]
    v_pk_mul_f32 v[24:25], v[56:57], v[46:47] op_sel:[0,0] op_sel_hi:[0,1]
    v_pk_fma_f32 v[54:55], v[48:49], v[28:29], v[54:55] op_sel:[1,1,0] op_sel_hi:[1,0,1] neg_lo:[1,0,0]
    v_pk_fma_f32 v[52:53], v[44:45], v[28:29], v[52:53] op_sel:[1,1,0] op_sel_hi:[1,0,1] neg_lo:[1,0,0]
    v_pk_fma_f32 v[50:51], v[58:59], v[46:47], v[50:51] op_sel:[1,1,0] op_sel_hi:[1,0,1] neg_lo:[1,0,0]
    v_pk_fma_f32 v[24:25], v[56:57], v[46:47], v[24:25] op_sel:[1,1,0] op_sel_hi:[1,0,1] neg_lo:[1,0,0]
    v_cvt_pk_bf16_f32 v42, v48, v49
    ds_write_addtid_b32 v42 offset:1632
    v_cvt_pk_bf16_f32 v43, v44, v45
    ds_write_addtid_b32 v43 offset:5984
    v_cvt_pk_bf16_f32 v40, v58, v59
    ds_write_addtid_b32 v40 offset:10336
    v_pk_mul_f32 v[48:49], v[54:55], v[28:29] op_sel:[0,0] op_sel_hi:[0,1]
    v_pk_mul_f32 v[44:45], v[52:53], v[28:29] op_sel:[0,0] op_sel_hi:[0,1]
    v_pk_mul_f32 v[58:59], v[50:51], v[46:47] op_sel:[0,0] op_sel_hi:[0,1]
    v_pk_mul_f32 v[56:57], v[24:25], v[46:47] op_sel:[0,0] op_sel_hi:[0,1]
    v_pk_fma_f32 v[48:49], v[54:55], v[28:29], v[48:49] op_sel:[1,1,0] op_sel_hi:[1,0,1] neg_lo:[1,0,0]
    v_pk_fma_f32 v[44:45], v[52:53], v[28:29], v[44:45] op_sel:[1,1,0] op_sel_hi:[1,0,1] neg_lo:[1,0,0]
    v_pk_fma_f32 v[58:59], v[50:51], v[46:47], v[58:59] op_sel:[1,1,0] op_sel_hi:[1,0,1] neg_lo:[1,0,0]
    v_pk_fma_f32 v[56:57], v[24:25], v[46:47], v[56:57] op_sel:[1,1,0] op_sel_hi:[1,0,1] neg_lo:[1,0,0]
    v_cvt_pk_bf16_f32 v41, v54, v55
    ds_write_addtid_b32 v41 offset:2176
    v_cvt_pk_bf16_f32 v42, v52, v53
    ds_write_addtid_b32 v42 offset:6528
    v_cvt_pk_bf16_f32 v43, v50, v51
    ds_write_addtid_b32 v43 offset:10880
    v_cvt_pk_bf16_f32 v40, v24, v25
    ds_write_addtid_b32 v40 offset:13600
    v_pk_mul_f32 v[54:55], v[48:49], v[28:29] op_sel:[0,0] op_sel_hi:[0,1]
    v_pk_mul_f32 v[52:53], v[44:45], v[28:29] op_sel:[0,0] op_sel_hi:[0,1]
    v_pk_mul_f32 v[50:51], v[58:59], v[62:63] op_sel:[0,0] op_sel_hi:[0,1]
    v_pk_mul_f32 v[24:25], v[56:57], v[46:47] op_sel:[0,0] op_sel_hi:[0,1]
    v_pk_mul_f32 v[64:65], v[56:57], v[26:27] op_sel:[0,0] op_sel_hi:[0,1]
    v_pk_fma_f32 v[54:55], v[48:49], v[28:29], v[54:55] op_sel:[1,1,0] op_sel_hi:[1,0,1] neg_lo:[1,0,0]
    v_pk_fma_f32 v[52:53], v[44:45], v[28:29], v[52:53] op_sel:[1,1,0] op_sel_hi:[1,0,1] neg_lo:[1,0,0]
    v_pk_fma_f32 v[50:51], v[58:59], v[62:63], v[50:51] op_sel:[1,1,0] op_sel_hi:[1,0,1] neg_lo:[1,0,0]
    v_pk_fma_f32 v[24:25], v[56:57], v[46:47], v[24:25] op_sel:[1,1,0] op_sel_hi:[1,0,1] neg_lo:[1,0,0]
    v_pk_fma_f32 v[64:65], v[56:57], v[26:27], v[64:65] op_sel:[1,1,0] op_sel_hi:[1,0,1] neg_lo:[1,0,0]
    v_cvt_pk_bf16_f32 v41, v48, v49
    ds_write_addtid_b32 v41 offset:2720
    v_cvt_pk_bf16_f32 v42, v44, v45
    ds_write_addtid_b32 v42 offset:7072
    v_cvt_pk_bf16_f32 v43, v58, v59
    ds_write_addtid_b32 v43 offset:11424
    v_cvt_pk_bf16_f32 v40, v56, v57
    ds_write_addtid_b32 v40 offset:14144
    v_pk_mul_f32 v[48:49], v[54:55], v[28:29] op_sel:[0,0] op_sel_hi:[0,1]
    v_pk_mul_f32 v[44:45], v[52:53], v[28:29] op_sel:[0,0] op_sel_hi:[0,1]
    v_pk_mul_f32 v[56:57], v[24:25], v[62:63] op_sel:[0,0] op_sel_hi:[0,1]
    v_pk_mul_f32 v[66:67], v[64:65], v[26:27] op_sel:[0,0] op_sel_hi:[0,1]
    v_pk_fma_f32 v[48:49], v[54:55], v[28:29], v[48:49] op_sel:[1,1,0] op_sel_hi:[1,0,1] neg_lo:[1,0,0]
    v_pk_fma_f32 v[44:45], v[52:53], v[28:29], v[44:45] op_sel:[1,1,0] op_sel_hi:[1,0,1] neg_lo:[1,0,0]
    v_pk_fma_f32 v[56:57], v[24:25], v[62:63], v[56:57] op_sel:[1,1,0] op_sel_hi:[1,0,1] neg_lo:[1,0,0]
    v_pk_fma_f32 v[66:67], v[64:65], v[26:27], v[66:67] op_sel:[1,1,0] op_sel_hi:[1,0,1] neg_lo:[1,0,0]
    v_cvt_pk_bf16_f32 v41, v54, v55
    ds_write_addtid_b32 v41 offset:3264
    v_cvt_pk_bf16_f32 v42, v52, v53
    ds_write_addtid_b32 v42 offset:7616
    v_cvt_pk_bf16_f32 v43, v50, v51
    ds_write_addtid_b32 v43 offset:12512
    v_cvt_pk_bf16_f32 v40, v24, v25
    ds_write_addtid_b32 v40 offset:14688
    v_cvt_pk_bf16_f32 v41, v64, v65
    s_mov_b32 m0, s70
    s_nop 0
    ds_write_addtid_b32 v41 offset:32768
    v_pk_mul_f32 v[52:53], v[44:45], v[28:29] op_sel:[0,0] op_sel_hi:[0,1]
    v_pk_mul_f32 v[64:65], v[66:67], v[26:27] op_sel:[0,0] op_sel_hi:[0,1]
    v_pk_fma_f32 v[52:53], v[44:45], v[28:29], v[52:53] op_sel:[1,1,0] op_sel_hi:[1,0,1] neg_lo:[1,0,0]
    v_pk_fma_f32 v[64:65], v[66:67], v[26:27], v[64:65] op_sel:[1,1,0] op_sel_hi:[1,0,1] neg_lo:[1,0,0]
    v_cvt_pk_bf16_f32 v42, v48, v49
    s_mov_b32 m0, s66
    s_nop 0
    ds_write_addtid_b32 v42 offset:3808
    v_cvt_pk_bf16_f32 v43, v44, v45
    ds_write_addtid_b32 v43 offset:8160
    v_cvt_pk_bf16_f32 v40, v56, v57
    ds_write_addtid_b32 v40 offset:15776
    v_cvt_pk_bf16_f32 v41, v66, v67
    s_mov_b32 m0, s70
    s_nop 0
    ds_write_addtid_b32 v41 offset:33856
    v_pk_mul_f32 v[66:67], v[64:65], v[26:27] op_sel:[0,0] op_sel_hi:[0,1]
    v_pk_fma_f32 v[66:67], v[64:65], v[26:27], v[66:67] op_sel:[1,1,0] op_sel_hi:[1,0,1] neg_lo:[1,0,0]
    v_cvt_pk_bf16_f32 v42, v52, v53
    s_mov_b32 m0, s66
    s_nop 0
    ds_write_addtid_b32 v42 offset:8704
    v_cvt_pk_bf16_f32 v43, v64, v65
    s_mov_b32 m0, s70
    s_nop 0
    ds_write_addtid_b32 v43 offset:37120
    v_cvt_pk_bf16_f32 v40, v66, v67
    ds_write_addtid_b32 v40 offset:38208
C_MFMA:
    s_mul_i32 s56, s2, 16384
    s_lshl_b32 s57, s38, 12
    s_add_u32 s56, s56, s57
    s_add_u32 s56, s56, 49152
    s_mov_b64 exec, 0x1
    ds_inc_u32 v166, v166 offset:12
    s_mov_b64 exec, -1
    ds_write_b32 v113, v112
    s_setprio 2
    s_movk_i32 s60, 4000
C_KG:
    ds_read_b32 v16, v166 offset:12
    s_sub_u32 s60, s60, 1
    s_cmp_gt_i32 s60, 0
    s_waitcnt lgkmcnt(0)
    v_readfirstlane_b32 s52, v16
    s_nop 0
    s_cselect_b32 s52, s52, 4
    s_cmp_lg_u32 s52, 4
    s_cbranch_scc1 C_KG
    ds_read_b128 v[16:19], v111 offset:0
    ds_read_b128 v[20:23], v110 offset:0
    ds_read_b128 v[24:27], v111 offset:64
    ds_read_b128 v[28:31], v110 offset:64
    ds_read_b128 v[32:35], v111 offset:128
    ds_read_b128 v[36:39], v110 offset:128
    ds_read_b128 v[40:43], v111 offset:192
    ds_read_b128 v[44:47], v110 offset:192
    ds_read_b128 v[48:51], v111 offset:256
    ds_read_b128 v[52:55], v110 offset:256
    ds_read_b128 v[56:59], v111 offset:320
    ds_read_b128 v[60:63], v110 offset:320
    ds_read_b128 v[64:67], v111 offset:384
    ds_read_b128 v[68:71], v110 offset:384
    ds_read_b128 v[72:75], v111 offset:448
    ds_read_b128 v[76:79], v110 offset:448
    s_lshl_b32 s53, s63, 10
    s_sub_u32 s52, s64, s53
    s_add_u32 s52, s52, 3576
    v_and_b32 v165, 1, v5
    v_lshl_add_u32 v165, v6, 1, v165
    s_mul_i32 s53, s65, 384
    s_add_u32 s53, s53, 161920
    v_lshl_add_u32 v165, v165, 4, s53
    v_lshlrev_b32 v2, 3, v2
    v_sub_u32 v2, s52, v2
    s_mul_i32 s68, s63, 1088
    s_add_u32 s68, s68, s71
    v_lshl_add_u32 v15, v15, 3, s68
    s_cmp_lg_u32 s63, 0
    s_cbranch_scc1 C_LA1
    s_lshr_b32 s52, s2, 3
    s_mul_i32 s52, s52, 3
    s_add_u32 s52, s52, s65
    s_lshl_b32 s52, s52, 3
    s_and_b32 s53, s2, 7
    v_and_b32 v11, 7, v1
    v_add_u32 v11, s52, v11
    v_and_b32 v12, 56, v1
    v_mul_u32_u24 v13, 0x48, v11
    v_add3_u32 v14, v12, v13, s53
    v_lshlrev_b32 v14, 7, v14
    s_add_u32 s53, s53, 64
    v_add_lshl_u32 v13, v13, s53, 7
    s_mul_i32 s53, s53, 0x240
    v_add_lshl_u32 v12, v11, s53, 7
    v_mov_b32 v10, 0
    v_lshrrev_b32 v9, 3, v1
    v_mul_u32_u24 v9, 3328, v9
    v_add3_u32 v9, v9, v3, s59
    s_branch C_LA2
C_LA1:
    v_and_b32 v93, 3, v5
    v_lshl_add_u32 v94, v6, 3, v11
    v_and_b32 v92, 1, v11
    v_mul_u32_u24 v92, 3456, v92
    v_add_u32 v92, s59, v92
    v_sub_u32 v93, v93, v94
    v_sub_u32 v94, v93, v94
    v_add_u32 v95, 44, v93
    v_lshrrev_b32 v96, 4, v95
    v_add_u32 v95, v95, v96
    v_lshl_add_u32 v11, v95, 3, v92
    v_add_u32 v95, 75, v94
    v_lshrrev_b32 v96, 4, v95
    v_add_u32 v95, v95, v96
    v_lshl_add_u32 v13, v95, 3, v92
    v_add_u32 v95, 40, v93
    v_lshrrev_b32 v96, 4, v95
    v_add_u32 v95, v95, v96
    v_lshl_add_u32 v12, v95, 3, v92
    v_add_u32 v95, 67, v94
    v_lshrrev_b32 v96, 4, v95
    v_add_u32 v95, v95, v96
    v_lshl_add_u32 v14, v95, 3, v92
C_LA2:
    s_cmp_eq_u32 s69, 2
    s_cbranch_scc1 C_T2
    v_lshrrev_b32 v89, 1, v6
    v_xor_b32 v88, v89, v6
    v_and_b32 v88, 1, v88
    v_lshlrev_b32 v88, 8, v88
    v_lshl_add_u32 v88, v89, 3, v88
    v_lshl_add_u32 v88, v5, 4, v88
    s_cmp_eq_u32 s69, 1
    s_cbranch_scc1 C_T1
    s_lshr_b32 s52, s69, 1
    s_mul_i32 s53, s52, 1600
    s_add_u32 s53, s53, s67
    v_add_u32 v88, s53, v88
    v_add_u32 v89, 3200, v88
    s_xor_b32 s52, s52, 1
    s_mov_b32 s53, 0
    s_waitcnt lgkmcnt(14)
    v_mfma_f32_16x16x32_bf16 v[80:83], v[16:19], v[20:23], 0
    s_waitcnt lgkmcnt(12)
    v_mfma_f32_16x16x32_bf16 v[84:87], v[24:27], v[28:31], 0
    s_waitcnt lgkmcnt(10)
    v_mfma_f32_16x16x32_bf16 v[80:83], v[32:35], v[36:39], v[80:83]
    s_waitcnt lgkmcnt(8)
    v_mfma_f32_16x16x32_bf16 v[84:87], v[40:43], v[44:47], v[84:87]
    s_waitcnt lgkmcnt(6)
    v_mfma_f32_16x16x32_bf16 v[80:83], v[48:51], v[52:55], v[80:83]
    s_waitcnt lgkmcnt(4)
    v_mfma_f32_16x16x32_bf16 v[84:87], v[56:59], v[60:63], v[84:87]
    s_waitcnt lgkmcnt(2)
    v_mfma_f32_16x16x32_bf16 v[80:83], v[64:67], v[68:71], v[80:83]
    s_waitcnt lgkmcnt(0)
    v_mfma_f32_16x16x32_bf16 v[84:87], v[72:75], v[76:79], v[84:87]
    s_nop 7
    v_pk_add_f32 v[80:81], v[80:81], v[84:85]
    v_pk_add_f32 v[82:83], v[82:83], v[86:87]
    v_cvt_pk_bf16_f32 v80, v80, v81
    v_cvt_pk_bf16_f32 v81, v82, v83
    ds_write_b64 v88, v[80:81] offset:32
    ds_write2_b32 v89, v80, v81 offset0:7 offset1:8
    s_mov_b64 exec, s[52:53]
    ds_write_b16 v88, v80 offset:1630
    ds_write_b16 v88, v80 offset:4826
    s_mov_b64 exec, -1
    s_branch C_B3
C_T1:
    s_add_u32 s53, s67, 544
    v_add_u32 v88, s53, v88
    v_add_u32 v89, 1600, v88
    s_waitcnt lgkmcnt(14)
    v_mfma_f32_16x16x32_bf16 v[80:83], v[16:19], v[20:23], 0
    s_waitcnt lgkmcnt(12)
    v_mfma_f32_16x16x32_bf16 v[84:87], v[24:27], v[28:31], 0
    s_waitcnt lgkmcnt(10)
    v_mfma_f32_16x16x32_bf16 v[80:83], v[32:35], v[36:39], v[80:83]
    s_waitcnt lgkmcnt(8)
    v_mfma_f32_16x16x32_bf16 v[84:87], v[40:43], v[44:47], v[84:87]
    s_waitcnt lgkmcnt(6)
    v_mfma_f32_16x16x32_bf16 v[80:83], v[48:51], v[52:55], v[80:83]
    s_waitcnt lgkmcnt(4)
    v_mfma_f32_16x16x32_bf16 v[84:87], v[56:59], v[60:63], v[84:87]
    s_waitcnt lgkmcnt(2)
    v_mfma_f32_16x16x32_bf16 v[80:83], v[64:67], v[68:71], v[80:83]
    s_waitcnt lgkmcnt(0)
    v_mfma_f32_16x16x32_bf16 v[84:87], v[72:75], v[76:79], v[84:87]
    s_nop 7
    v_pk_add_f32 v[80:81], v[80:81], v[84:85]
    v_pk_add_f32 v[82:83], v[82:83], v[86:87]
    v_cvt_pk_bf16_f32 v16, v81, v82
    v_cvt_pk_bf16_f32 v17, v82, v82
    v_cvt_pk_bf16_f32 v18, v82, v82
    v_cvt_pk_bf16_f32 v19, v82, v83
    ds_write2_b32 v88, v16, v17 offset0:1 offset1:2
    ds_write_b64 v88, v[16:17] offset:3200
    ds_write2_b32 v89, v18, v19 offset0:1 offset1:2
    ds_write_b64 v88, v[18:19] offset:4800
    v_cvt_pk_bf16_f32 v20, v80, v80
    v_cvt_pk_bf16_f32 v21, v80, v81
    s_mov_b64 exec, 0x1
    ds_write_b32 v88, v20
    ds_write_b32 v88, v20 offset:3196
    ds_write_b32 v88, v21 offset:1600
    ds_write_b32 v88, v21 offset:4796
    s_mov_b32 exec_lo, 0x0
    s_mov_b32 exec_hi, 0x8000
    ds_write_b16 v88, v17 offset:12
    ds_write_b16 v88, v17 offset:1610
    ds_write_b16 v88, v17 offset:3208
    ds_write_b16 v88, v17 offset:4806
    s_mov_b64 exec, -1
    s_branch C_B3
C_T2:
    v_lshlrev_b32 v88, 7, v6
    v_lshl_add_u32 v89, v5, 1, v88
    v_lshl_add_u32 v88, v5, 2, v88
    s_add_u32 s52, s64, 4728
    v_add_u32 v88, s52, v88
    s_add_u32 s52, s64, 4920
    v_add_u32 v89, s52, v89
    v_mov_b32 v90, s67
    s_waitcnt lgkmcnt(14)
    v_mfma_f32_16x16x32_bf16 v[80:83], v[16:19], v[20:23], 0
    s_waitcnt lgkmcnt(12)
    v_mfma_f32_16x16x32_bf16 v[84:87], v[24:27], v[28:31], 0
    s_waitcnt lgkmcnt(10)
    v_mfma_f32_16x16x32_bf16 v[80:83], v[32:35], v[36:39], v[80:83]
    s_waitcnt lgkmcnt(8)
    v_mfma_f32_16x16x32_bf16 v[84:87], v[40:43], v[44:47], v[84:87]
    s_waitcnt lgkmcnt(6)
    v_mfma_f32_16x16x32_bf16 v[80:83], v[48:51], v[52:55], v[80:83]
    s_waitcnt lgkmcnt(4)
    v_mfma_f32_16x16x32_bf16 v[84:87], v[56:59], v[60:63], v[84:87]
    s_waitcnt lgkmcnt(2)
    v_mfma_f32_16x16x32_bf16 v[80:83], v[64:67], v[68:71], v[80:83]
    s_waitcnt lgkmcnt(0)
    v_mfma_f32_16x16x32_bf16 v[84:87], v[72:75], v[76:79], v[84:87]
    s_nop 7
    v_pk_add_f32 v[80:81], v[80:81], v[84:85]
    v_pk_add_f32 v[82:83], v[82:83], v[86:87]
    v_cvt_pk_bf16_f32 v80, v80, v81
    v_cvt_pk_bf16_f32 v81, v82, v83
    s_mov_b32 exec_hi, 0
    ds_write2_b32 v88, v80, v81 offset0:0 offset1:16
    s_not_b64 exec, exec
    ds_write_b16 v89, v80 offset:4
    ds_write_b16_d16_hi v89, v80 offset:36
    ds_write_b16 v89, v81 offset:68
    ds_write_b16_d16_hi v89, v81 offset:100
    ds_write_b16 v89, v80 offset:384
    ds_write_b16_d16_hi v89, v80 offset:416
    ds_write_b16 v89, v81 offset:448
    ds_write_b16_d16_hi v89, v81 offset:480
    s_mov_b32 exec_lo, 0x80000000
    s_mov_b32 exec_hi, 0x0
    ds_write_b16_d16_hi v90, v81 offset:1126
    ds_write_b16_d16_hi v90, v81 offset:1128
    ds_write_b16_d16_hi v90, v81 offset:2724
    ds_write_b16_d16_hi v90, v81 offset:2726
    ds_write_b16_d16_hi v90, v81 offset:4322
    ds_write_b16_d16_hi v90, v81 offset:4324
    ds_write_b16_d16_hi v90, v81 offset:5920
    ds_write_b16_d16_hi v90, v81 offset:5922
    s_mov_b64 exec, -1
C_B3:
    s_mov_b64 exec, 0x1
    ds_inc_u32 v166, v166 offset:128
    s_mov_b64 exec, -1
    s_mov_b32 s61, s65
    s_cmp_lg_u32 s65, 1
    s_cbranch_scc1 C_NOUL
    s_waitcnt vmcnt(0)
    buffer_load_dwordx4 v[24:27], v3, s[40:43], s56 offen offset:0 sc1
    buffer_load_dwordx4 v[28:31], v3, s[40:43], s56 offen offset:1024 sc1
    buffer_load_dwordx4 v[32:35], v3, s[40:43], s56 offen offset:2048 sc1
    buffer_load_dwordx4 v[36:39], v3, s[40:43], s56 offen offset:3072 sc1
C_NOUL:
    s_movk_i32 s60, 4000
C_KM:
    ds_read_b128 v[16:19], v166 offset:128
    s_sub_u32 s60, s60, 1
    s_cmp_gt_i32 s60, 0
    s_waitcnt lgkmcnt(0)
    v_add_u32 v16, v16, v18
    s_nop 0
    v_readfirstlane_b32 s52, v16
    s_nop 0
    s_cselect_b32 s52, s52, 5
    s_cmp_lg_u32 s52, 5
    s_cbranch_scc1 C_KM
    s_setprio 3
    ds_read_b64 v[48:49], v7 offset:0
    ds_read_b64 v[50:51], v7 offset:8
    ds_read_b64 v[52:53], v7 offset:64
    ds_read_b64 v[54:55], v7 offset:72
    ds_read_b64 v[56:57], v7 offset:128
    ds_read_b64 v[58:59], v7 offset:136
    ds_read_b64 v[60:61], v7 offset:192
    ds_read_b64 v[62:63], v7 offset:200
    ds_read_b64 v[64:65], v7 offset:256
    ds_read_b64 v[66:67], v7 offset:264
    ds_read_b64 v[68:69], v7 offset:320
    ds_read_b64 v[70:71], v7 offset:328
    ds_read_b64 v[72:73], v7 offset:384
    ds_read_b64 v[74:75], v7 offset:392
    ds_read_b64 v[76:77], v7 offset:448
    ds_read_b64 v[78:79], v7 offset:456
    ds_read_b64 v[80:81], v7 offset:512
    ds_read_b64 v[82:83], v7 offset:520
    ds_read_b64 v[84:85], v7 offset:576
    ds_read_b64 v[86:87], v7 offset:584
    ds_read_b64 v[88:89], v7 offset:640
    ds_read_b64 v[90:91], v7 offset:648
    ds_read_b64 v[92:93], v7 offset:704
    ds_read_b64 v[94:95], v7 offset:712
    ds_read_b64 v[96:97], v7 offset:768
    ds_read_b64 v[98:99], v7 offset:776
    ds_read_b64 v[100:101], v7 offset:832
    ds_read_b64 v[102:103], v7 offset:840
    ds_read_b64 v[104:105], v7 offset:896
    ds_read_b64 v[106:107], v7 offset:904
    ds_read_b64 v[108:109], v7 offset:960
    ds_read_b64 v[110:111], v7 offset:968
    s_cmp_eq_u32 s63, 1
    s_cbranch_scc1 C_E1
    s_cmp_eq_u32 s63, 2
    s_cbranch_scc1 C_E2
    s_cmp_eq_u32 s63, 3
    s_cbranch_scc1 C_E3
    ds_read_b64 v[112:113], v7 offset:1152
    ds_read_b64 v[114:115], v7 offset:1160
    ds_read_b64 v[116:117], v7 offset:1216
    ds_read_b64 v[118:119], v7 offset:1224
    ds_read_b64 v[128:129], v7 offset:1280
    ds_read_b64 v[130:131], v7 offset:1288
    ds_read_b64 v[132:133], v7 offset:1344
    ds_read_b64 v[134:135], v7 offset:1352
    s_mov_b32 exec_hi, 0
    ds_write_b128 v9, v[160:163]
    s_mov_b64 exec, -1
    s_branch C_EE
C_E1:
    ds_read_b64 v[128:129], v7 offset:1152
    ds_read_b64 v[130:131], v7 offset:1160
    ds_read_b64 v[132:133], v7 offset:1216
    ds_read_b64 v[134:135], v7 offset:1224
    ds_read_b64 v[136:137], v7 offset:1280
    ds_read_b64 v[138:139], v7 offset:1288
    ds_read_b64 v[140:141], v7 offset:1344
    ds_read_b64 v[142:143], v7 offset:1352
    ds_read_b64 v[112:113], v7 offset:1024
    ds_read_b64 v[114:115], v7 offset:1032
    s_branch C_EE
C_E2:
    ds_read_b64 v[152:153], v7 offset:1152
    ds_read_b64 v[154:155], v7 offset:1160
    ds_read_b64 v[156:157], v7 offset:1216
    ds_read_b64 v[158:159], v7 offset:1224
    ds_read_b64 v[112:113], v7 offset:1024
    ds_read_b64 v[114:115], v7 offset:1032
    ds_read_b64 v[128:129], v9 offset:4608
    ds_read_b64 v[130:131], v9 offset:4616
    ds_read_b64 v[132:133], v9 offset:4672
    ds_read_b64 v[134:135], v9 offset:4680
    ds_read_b64 v[136:137], v9 offset:4736
    ds_read_b64 v[138:139], v9 offset:4744
    ds_read_b64 v[140:141], v9 offset:4800
    ds_read_b64 v[142:143], v9 offset:4808
    ds_read_b64 v[144:145], v9 offset:4864
    ds_read_b64 v[146:147], v9 offset:4872
    ds_read_b64 v[148:149], v9 offset:4928
    ds_read_b64 v[150:151], v9 offset:4936
    s_branch C_EE
C_E3:
    ds_read_b64 v[112:113], v7 offset:1024
    ds_read_b64 v[114:115], v7 offset:1032
    ds_read_b64 v[116:117], v7 offset:1088
    ds_read_b64 v[118:119], v7 offset:1096
    ds_read_b64 v[128:129], v9 offset:4608
    ds_read_b64 v[130:131], v9 offset:4616
    ds_read_b64 v[132:133], v9 offset:4672
    ds_read_b64 v[134:135], v9 offset:4680
    ds_read_b64 v[136:137], v9 offset:4736
    ds_read_b64 v[138:139], v9 offset:4744
    ds_read_b64 v[140:141], v9 offset:4800
    ds_read_b64 v[142:143], v9 offset:4808
    ds_read_b64 v[144:145], v9 offset:4864
    ds_read_b64 v[146:147], v9 offset:4872
    ds_read_b64 v[148:149], v9 offset:4928
    ds_read_b64 v[150:151], v9 offset:4936
    ds_read_b64 v[152:153], v10 offset:5120
    ds_read_b64 v[154:155], v10 offset:5128
    ds_read_b64 v[156:157], v10 offset:5184
    ds_read_b64 v[158:159], v10 offset:5192
    ds_read_b64 v[120:121], v10 offset:5248
    ds_read_b64 v[122:123], v10 offset:5256
    ds_read_b64 v[124:125], v10 offset:5312
    ds_read_b64 v[126:127], v10 offset:5320
C_EE:
    v_mov_b32 v167, v19
    v_readfirstlane_b32 s39, v19
    v_mul_u32_u24 v5, 37, v1
    v_lshrrev_b32 v5, 8, v5
    v_mul_u32_u24 v5, 1040, v5
    v_add_u32 v5, v5, v3
    v_add_u32 v6, 0x2400, v5
    s_mul_i32 s44, s2, 18432
    s_mul_i32 s45, s38, 96
    s_add_u32 s44, s44, s45
    s_add_u32 s72, s4, s44
    s_addc_u32 s73, s5, 0
    s_add_u32 s74, s24, s45
    s_addc_u32 s75, s25, 0
    s_mul_i32 s58, s69, 1920
    s_add_u32 s58, s58, s71
    s_add_u32 s58, s58, 4352
    s_cmp_lt_u32 s38, 4
    s_cbranch_scc1 C_B5
    v_mov_b32 v40, -1
    v_mov_b32 v41, -1
    v_mov_b32 v42, -1
    v_mov_b32 v43, -1
    v_lshlrev_b32 v20, 4, v0
    v_lshlrev_b32 v21, 2, v0
    s_cmp_lg_u32 s61, 1
    s_cbranch_scc1 C_PO
    s_movk_i32 s60, 4000
    s_branch C_UP_W
C_UP:
    buffer_load_dwordx4 v[24:27], v3, s[40:43], s56 offen offset:0 sc1
    buffer_load_dwordx4 v[28:31], v3, s[40:43], s56 offen offset:1024 sc1
    buffer_load_dwordx4 v[32:35], v3, s[40:43], s56 offen offset:2048 sc1
    buffer_load_dwordx4 v[36:39], v3, s[40:43], s56 offen offset:3072 sc1
C_UP_W:
    s_waitcnt vmcnt(0)
C_UP_C:
    v_xor_b32 v44, v167, v27
    v_xor_b32 v45, v167, v31
    v_xor_b32 v46, v167, v35
    v_xor_b32 v47, v167, v39
    v_or3_b32 v44, v44, v45, v46
    v_or_b32 v44, v44, v47
    v_cmp_ne_u32 vcc, 0, v44
    s_nop 0
    s_and_b64 exec, exec, vcc
    s_cbranch_execz C_UP_D
    s_wqm_b64 exec, exec
    s_sub_u32 s60, s60, 1
    s_cmp_gt_i32 s60, 0
    s_sleep 2
    s_cbranch_scc1 C_UP
C_UP_D:
    s_mov_b64 exec, -1
    s_lshl_b32 s52, s38, 10
    s_add_u32 m0, s52, 47936
    v_add_u32 v18, 161412, v3
    ds_write_addtid_b32 v25 offset:55040
    ds_write_addtid_b32 v29 offset:55296
    ds_write_addtid_b32 v33 offset:55552
    ds_write_addtid_b32 v37 offset:55808
    s_mov_b64 exec, 0x2
    ds_inc_u32 v18, v18
    s_mov_b64 exec, -1
    ds_write_addtid_b32 v26 offset:60928
    ds_write_addtid_b32 v30 offset:61184
    ds_write_addtid_b32 v34 offset:61440
    ds_write_addtid_b32 v38 offset:61696
    s_mov_b64 exec, 0x4
    ds_inc_u32 v18, v18
    s_mov_b64 exec, -1
    ds_write_addtid_b32 v24 offset:49152
    ds_write_addtid_b32 v28 offset:49408
    ds_write_addtid_b32 v32 offset:49664
    ds_write_addtid_b32 v36 offset:49920
    s_mov_b64 exec, 0x1
    ds_inc_u32 v18, v18
    s_mov_b64 exec, -1
C_PO:
    s_cmp_ge_u32 s50, 144
    s_cbranch_scc1 C_B5
    buffer_store_dwordx4 v[40:43], v20, s[40:43], s48 offen sc1
    buffer_store_dword v40, v21, s[40:43], s49 offen sc1
C_B5:
    s_mov_b32 s56, 0xf7efdfbf
    s_mov_b32 s57, 0x7efdfb
    s_movk_i32 s60, 4000
C_UF:
    ds_read_b32 v16, v166 offset:132
    s_sub_u32 s60, s60, 1
    s_cmp_gt_i32 s60, 0
    s_waitcnt lgkmcnt(0)
    v_readfirstlane_b32 s52, v16
    s_nop 0
    s_cselect_b32 s52, s52, 4
    s_cmp_lg_u32 s52, 4
    s_cbranch_scc1 C_UF
    s_movk_i32 s60, 4000
    s_cmp_eq_u32 s63, 1
    s_cbranch_scc1 C_P1
    s_cmp_eq_u32 s63, 2
    s_cbranch_scc1 C_P2
    s_cmp_eq_u32 s63, 3
    s_cbranch_scc1 C_P3
    s_setprio 2
    ds_read_b128 v[32:35], v8 offset:3552
    ds_read_b128 v[36:39], v8 offset:4064
    ds_read_b128 v[40:43], v8 offset:3680
    s_waitcnt lgkmcnt(2)
    v_mfma_f32_16x16x32_bf16 v[136:139], v[112:115], v[32:35], 0
    v_mfma_f32_16x16x32_bf16 v[140:143], v[116:119], v[32:35], 0
    v_mfma_f32_16x16x32_bf16 v[144:147], v[128:131], v[32:35], 0
    v_mfma_f32_16x16x32_bf16 v[148:151], v[132:135], v[32:35], 0
    v_mfma_f32_16x16x32_bf16 v[28:31], v[52:55], v[32:35], 0
    v_mfma_f32_16x16x32_bf16 v[20:23], v[48:51], v[32:35], 0
    ds_read_b128 v[44:47], v8 offset:3808
    s_waitcnt lgkmcnt(2)
    v_mfma_f32_16x16x32_bf16 v[152:155], v[112:115], v[36:39], 0
    v_mfma_f32_16x16x32_bf16 v[156:159], v[116:119], v[36:39], 0
    v_mfma_f32_16x16x32_bf16 v[120:123], v[128:131], v[36:39], 0
    v_mfma_f32_16x16x32_bf16 v[124:127], v[132:135], v[36:39], 0
    v_mfma_f32_16x16x32_bf16 v[28:31], v[84:87], v[36:39], v[28:31]
    v_mfma_f32_16x16x32_bf16 v[20:23], v[80:83], v[36:39], v[20:23]
    v_mfma_f32_16x16x32_bf16 v[24:27], v[52:55], v[36:39], 0
    v_mfma_f32_16x16x32_bf16 v[16:19], v[48:51], v[36:39], 0
    v_cvt_pk_bf16_f32 v136, v136, v137
    v_cvt_pk_bf16_f32 v137, v138, v139
    ds_write_b64 v4, v[136:137] offset:680
    v_cvt_pk_bf16_f32 v140, v140, v141
    v_cvt_pk_bf16_f32 v141, v142, v143
    ds_write_b64 v4, v[140:141] offset:4136
    v_cvt_pk_bf16_f32 v144, v144, v145
    v_cvt_pk_bf16_f32 v145, v146, v147
    ds_write_b64 v4, v[144:145] offset:7592
    v_cvt_pk_bf16_f32 v148, v148, v149
    v_cvt_pk_bf16_f32 v149, v150, v151
    ds_write_b64 v4, v[148:149] offset:11048
    ds_read_b128 v[32:35], v8 offset:3936
    s_waitcnt lgkmcnt(6)
    v_mfma_f32_16x16x32_bf16 v[28:31], v[60:63], v[40:43], v[28:31]
    v_mfma_f32_16x16x32_bf16 v[20:23], v[56:59], v[40:43], v[20:23]
    v_cvt_pk_bf16_f32 v152, v152, v153
    v_cvt_pk_bf16_f32 v153, v154, v155
    ds_write_b64 v4, v[152:153] offset:136
    v_cvt_pk_bf16_f32 v156, v156, v157
    v_cvt_pk_bf16_f32 v157, v158, v159
    ds_write_b64 v4, v[156:157] offset:3592
    v_cvt_pk_bf16_f32 v120, v120, v121
    v_cvt_pk_bf16_f32 v121, v122, v123
    ds_write_b64 v4, v[120:121] offset:7048
    v_cvt_pk_bf16_f32 v124, v124, v125
    v_cvt_pk_bf16_f32 v125, v126, v127
    ds_write_b64 v4, v[124:125] offset:10504
    s_mov_b64 exec, 0x1
    ds_write_b32 v166, v166 offset:0
    s_mov_b64 exec, -1
    s_setprio 0
    ds_read_b128 v[84:87], v8 offset:4192
    ds_read_b64 v[160:161], v2 offset:512
    ds_read_b64 v[162:163], v2
    s_or_b32 s52, s38, s2
    s_cbranch_scc1 C_NOEP
    s_mov_b64 exec, 0x1
    buffer_store_dword v167, v10, s[40:43], 0 offen sc1
    s_mov_b64 exec, -1
C_NOEP:
    s_cmp_ge_u32 s2, 128
    s_cbranch_scc1 C_NX0
    s_mov_b32 m0, s58
    s_mov_b64 exec, s[56:57]
    global_load_lds_dwordx4 v5, s[72:73]
    s_add_u32 m0, s58, 896
    s_nop 0
    global_load_lds_dwordx4 v6, s[72:73]
    s_add_u32 m0, s58, 1792
    s_mov_b64 exec, 0x3f
    global_load_lds_dwordx4 v3, s[74:75]
    s_mov_b64 exec, -1
C_NX0:
    s_mov_b32 m0, 163328
    s_nop 0
    global_load_lds_dword v14, s[28:29]
    s_mov_b64 exec, 0xff
    global_load_lds_dword v13, s[28:29]
    global_load_lds_dword v13, s[26:27]
    global_load_lds_dword v12, s[30:31]
    s_mov_b64 exec, -1
    s_waitcnt lgkmcnt(13)
    v_mfma_f32_16x16x32_bf16 v[28:31], v[68:71], v[44:47], v[28:31]
    v_mfma_f32_16x16x32_bf16 v[20:23], v[64:67], v[44:47], v[20:23]
    ds_read_b128 v[80:83], v8 offset:4320
    s_waitcnt lgkmcnt(9)
    v_mfma_f32_16x16x32_bf16 v[28:31], v[76:79], v[32:35], v[28:31]
    v_mfma_f32_16x16x32_bf16 v[20:23], v[72:75], v[32:35], v[20:23]
    ds_read_b128 v[36:39], v8 offset:4448
    s_waitcnt lgkmcnt(2)
    v_and_b32 v48, 0xffff0000, v161
    v_lshlrev_b32 v49, 16, v161
    v_and_b32 v50, 0xffff0000, v160
    v_lshlrev_b32 v51, 16, v160
    v_mul_f32 v48, v48, v164
    v_mul_f32 v49, v49, v164
    v_mul_f32 v50, v50, v164
    v_mul_f32 v51, v51, v164
    v_cvt_pk_bf16_f32 v49, v48, v49
    v_lshlrev_b32 v48, 16, v49
    v_and_b32 v49, 0xffff0000, v49
    v_cvt_pk_bf16_f32 v51, v50, v51
    v_lshlrev_b32 v50, 16, v51
    v_and_b32 v51, 0xffff0000, v51
    v_and_b32 v52, 0xffff0000, v163
    v_lshlrev_b32 v53, 16, v163
    v_and_b32 v54, 0xffff0000, v162
    v_lshlrev_b32 v55, 16, v162
    v_mul_f32 v52, v52, v164
    v_mul_f32 v53, v53, v164
    v_mul_f32 v54, v54, v164
    v_mul_f32 v55, v55, v164
    v_cvt_pk_bf16_f32 v53, v52, v53
    v_lshlrev_b32 v52, 16, v53
    v_and_b32 v53, 0xffff0000, v53
    v_cvt_pk_bf16_f32 v55, v54, v55
    v_lshlrev_b32 v54, 16, v55
    v_and_b32 v55, 0xffff0000, v55
    v_mfma_f32_16x16x32_bf16 v[28:31], v[92:95], v[84:87], v[28:31]
    v_mfma_f32_16x16x32_bf16 v[20:23], v[88:91], v[84:87], v[20:23]
    v_mfma_f32_16x16x32_bf16 v[24:27], v[60:63], v[84:87], v[24:27]
    v_mfma_f32_16x16x32_bf16 v[16:19], v[56:59], v[84:87], v[16:19]
    s_waitcnt lgkmcnt(1)
    v_mfma_f32_16x16x32_bf16 v[28:31], v[100:103], v[80:83], v[28:31]
    v_mfma_f32_16x16x32_bf16 v[20:23], v[96:99], v[80:83], v[20:23]
    v_mfma_f32_16x16x32_bf16 v[24:27], v[68:71], v[80:83], v[24:27]
    v_mfma_f32_16x16x32_bf16 v[16:19], v[64:67], v[80:83], v[16:19]
    s_waitcnt lgkmcnt(0)
    v_mfma_f32_16x16x32_bf16 v[28:31], v[108:111], v[36:39], v[28:31]
    v_mfma_f32_16x16x32_bf16 v[20:23], v[104:107], v[36:39], v[20:23]
    v_mfma_f32_16x16x32_bf16 v[24:27], v[76:79], v[36:39], v[24:27]
    v_mfma_f32_16x16x32_bf16 v[16:19], v[72:75], v[36:39], v[16:19]
    s_mov_b32 exec_lo, 0xc000c000
    s_mov_b32 exec_hi, 0xc000c000
    s_nop 2
    ds_write_b128 v165, v[28:31] offset:128
    ds_write_b32 v166, v166 offset:64
    s_mov_b64 exec, -1
    s_setprio 0
    s_waitcnt vmcnt(7)
    s_cmp_lt_u32 s2, 128
    s_cbranch_scc1 C_EPI
    s_waitcnt vmcnt(4)
    s_branch C_EPI
C_P1:
    s_setprio 2
    ds_read_b128 v[32:35], v8 offset:2528
    ds_read_b128 v[36:39], v8 offset:3040
    ds_read_b128 v[40:43], v8 offset:2656
    s_waitcnt lgkmcnt(2)
    v_mfma_f32_16x16x32_bf16 v[144:147], v[128:131], v[32:35], 0
    v_mfma_f32_16x16x32_bf16 v[148:151], v[132:135], v[32:35], 0
    v_mfma_f32_16x16x32_bf16 v[152:155], v[136:139], v[32:35], 0
    v_mfma_f32_16x16x32_bf16 v[156:159], v[140:143], v[32:35], 0
    v_mfma_f32_16x16x32_bf16 v[28:31], v[52:55], v[32:35], 0
    v_mfma_f32_16x16x32_bf16 v[20:23], v[48:51], v[32:35], 0
    ds_read_b128 v[44:47], v8 offset:2784
    s_waitcnt lgkmcnt(2)
    v_mfma_f32_16x16x32_bf16 v[116:119], v[128:131], v[36:39], 0
    v_mfma_f32_16x16x32_bf16 v[160:163], v[132:135], v[36:39], 0
    v_mfma_f32_16x16x32_bf16 v[120:123], v[136:139], v[36:39], 0
    v_mfma_f32_16x16x32_bf16 v[124:127], v[140:143], v[36:39], 0
    v_mfma_f32_16x16x32_bf16 v[28:31], v[84:87], v[36:39], v[28:31]
    v_mfma_f32_16x16x32_bf16 v[20:23], v[80:83], v[36:39], v[20:23]
    v_mfma_f32_16x16x32_bf16 v[24:27], v[52:55], v[36:39], 0
    v_mfma_f32_16x16x32_bf16 v[16:19], v[48:51], v[36:39], 0
    v_cvt_pk_bf16_f32 v144, v144, v145
    v_cvt_pk_bf16_f32 v145, v146, v147
    ds_write_b64 v4, v[144:145] offset:1768
    v_cvt_pk_bf16_f32 v148, v148, v149
    v_cvt_pk_bf16_f32 v149, v150, v151
    ds_write_b64 v4, v[148:149] offset:5224
    v_cvt_pk_bf16_f32 v152, v152, v153
    v_cvt_pk_bf16_f32 v153, v154, v155
    ds_write_b64 v4, v[152:153] offset:8680
    v_cvt_pk_bf16_f32 v156, v156, v157
    v_cvt_pk_bf16_f32 v157, v158, v159
    ds_write_b64 v4, v[156:157] offset:12136
    ds_read_b128 v[32:35], v8 offset:2912
    s_waitcnt lgkmcnt(6)
    v_mfma_f32_16x16x32_bf16 v[28:31], v[60:63], v[40:43], v[28:31]
    v_mfma_f32_16x16x32_bf16 v[20:23], v[56:59], v[40:43], v[20:23]
    v_cvt_pk_bf16_f32 v116, v116, v117
    v_cvt_pk_bf16_f32 v117, v118, v119
    ds_write_b64 v4, v[116:117] offset:1224
    v_cvt_pk_bf16_f32 v160, v160, v161
    v_cvt_pk_bf16_f32 v161, v162, v163
    ds_write_b64 v4, v[160:161] offset:4680
    v_cvt_pk_bf16_f32 v120, v120, v121
    v_cvt_pk_bf16_f32 v121, v122, v123
    ds_write_b64 v4, v[120:121] offset:8136
    v_cvt_pk_bf16_f32 v124, v124, v125
    v_cvt_pk_bf16_f32 v125, v126, v127
    ds_write_b64 v4, v[124:125] offset:11592
    s_mov_b64 exec, 0x1
    ds_write_b32 v166, v166 offset:4
    s_mov_b64 exec, -1
    s_setprio 1
    ds_read_b128 v[36:39], v8 offset:3168
    ds_read_b64 v[144:145], v9 offset:4608
    ds_read_b64 v[146:147], v9 offset:4616
    ds_read_b64 v[148:149], v9 offset:4672
    ds_read_b64 v[150:151], v9 offset:4680
    ds_read_b64 v[152:153], v9 offset:4736
    ds_read_b64 v[154:155], v9 offset:4744
    ds_read_b64 v[156:157], v9 offset:4800
    ds_read_b64 v[158:159], v9 offset:4808
    ds_read_b64 v[160:161], v2 offset:512
    ds_read_b64 v[162:163], v2
    s_cmp_ge_u32 s2, 128
    s_cbranch_scc1 C_NX1
    s_mov_b32 m0, s58
    s_mov_b64 exec, s[56:57]
    global_load_lds_dwordx4 v5, s[72:73]
    s_add_u32 m0, s58, 896
    s_nop 0
    global_load_lds_dwordx4 v6, s[72:73]
    s_add_u32 m0, s58, 1792
    s_mov_b64 exec, 0x3f
    global_load_lds_dwordx4 v3, s[74:75]
    s_mov_b64 exec, -1
C_NX1:
    s_waitcnt lgkmcnt(15)
    v_mfma_f32_16x16x32_bf16 v[28:31], v[68:71], v[44:47], v[28:31]
    v_mfma_f32_16x16x32_bf16 v[20:23], v[64:67], v[44:47], v[20:23]
    ds_read_b128 v[40:43], v8 offset:3296
    v_mfma_f32_16x16x32_bf16 v[28:31], v[76:79], v[32:35], v[28:31]
    v_mfma_f32_16x16x32_bf16 v[20:23], v[72:75], v[32:35], v[20:23]
    ds_read_b128 v[128:131], v8 offset:3424
    s_waitcnt lgkmcnt(2)
    v_and_b32 v48, 0xffff0000, v161
    v_lshlrev_b32 v49, 16, v161
    v_and_b32 v50, 0xffff0000, v160
    v_lshlrev_b32 v51, 16, v160
    v_mul_f32 v48, v48, v164
    v_mul_f32 v49, v49, v164
    v_mul_f32 v50, v50, v164
    v_mul_f32 v51, v51, v164
    v_cvt_pk_bf16_f32 v49, v48, v49
    v_lshlrev_b32 v48, 16, v49
    v_and_b32 v49, 0xffff0000, v49
    v_cvt_pk_bf16_f32 v51, v50, v51
    v_lshlrev_b32 v50, 16, v51
    v_and_b32 v51, 0xffff0000, v51
    v_and_b32 v52, 0xffff0000, v163
    v_lshlrev_b32 v53, 16, v163
    v_and_b32 v54, 0xffff0000, v162
    v_lshlrev_b32 v55, 16, v162
    v_mul_f32 v52, v52, v164
    v_mul_f32 v53, v53, v164
    v_mul_f32 v54, v54, v164
    v_mul_f32 v55, v55, v164
    v_cvt_pk_bf16_f32 v53, v52, v53
    v_lshlrev_b32 v52, 16, v53
    v_and_b32 v53, 0xffff0000, v53
    v_cvt_pk_bf16_f32 v55, v54, v55
    v_lshlrev_b32 v54, 16, v55
    v_and_b32 v55, 0xffff0000, v55
    v_mfma_f32_16x16x32_bf16 v[28:31], v[92:95], v[36:39], v[28:31]
    v_mfma_f32_16x16x32_bf16 v[20:23], v[88:91], v[36:39], v[20:23]
    v_mfma_f32_16x16x32_bf16 v[24:27], v[60:63], v[36:39], v[24:27]
    v_mfma_f32_16x16x32_bf16 v[16:19], v[56:59], v[36:39], v[16:19]
    ds_read_b128 v[132:135], v8 offset:3552
    s_waitcnt lgkmcnt(2)
    v_mfma_f32_16x16x32_bf16 v[28:31], v[100:103], v[40:43], v[28:31]
    v_mfma_f32_16x16x32_bf16 v[20:23], v[96:99], v[40:43], v[20:23]
    v_mfma_f32_16x16x32_bf16 v[24:27], v[68:71], v[40:43], v[24:27]
    v_mfma_f32_16x16x32_bf16 v[16:19], v[64:67], v[40:43], v[16:19]
    ds_read_b96 v[60:62], v166
    ds_read_b128 v[136:139], v8 offset:3680
    s_waitcnt lgkmcnt(3)
    v_mfma_f32_16x16x32_bf16 v[28:31], v[108:111], v[128:131], v[28:31]
    v_mfma_f32_16x16x32_bf16 v[20:23], v[104:107], v[128:131], v[20:23]
    v_mfma_f32_16x16x32_bf16 v[24:27], v[76:79], v[128:131], v[24:27]
    v_mfma_f32_16x16x32_bf16 v[16:19], v[72:75], v[128:131], v[16:19]
    s_waitcnt lgkmcnt(1)
C_FL1:
    v_min3_u32 v60, v60, v61, v62
    v_cmp_eq_u32 vcc, 0, v60
    s_nop 4
    s_cbranch_vccz C_FD1
    ds_read_b96 v[60:62], v166
    s_sub_u32 s60, s60, 1
    s_cmp_gt_i32 s60, 0
    s_waitcnt lgkmcnt(0)
    s_cbranch_scc1 C_FL1
C_FD1:
    ds_read_b128 v[140:143], v8 offset:3808
    v_mfma_f32_16x16x32_bf16 v[20:23], v[112:115], v[132:135], v[20:23]
    v_mfma_f32_16x16x32_bf16 v[24:27], v[84:87], v[132:135], v[24:27]
    v_mfma_f32_16x16x32_bf16 v[16:19], v[80:83], v[132:135], v[16:19]
    s_mov_b32 exec_lo, 0xc000c000
    s_mov_b32 exec_hi, 0xc000c000
    ds_write_b128 v165, v[28:31] offset:256
    ds_write_b32 v166, v166 offset:68
    s_mov_b64 exec, -1
    ds_read_b128 v[44:47], v8 offset:3936
    s_waitcnt lgkmcnt(4)
    v_mfma_f32_16x16x32_bf16 v[24:27], v[92:95], v[136:139], v[24:27]
    v_mfma_f32_16x16x32_bf16 v[16:19], v[88:91], v[136:139], v[16:19]
    ds_read_b128 v[32:35], v8 offset:4064
    ds_read_b64_tr_b16 v[36:37], v11 offset:0
    ds_read_b64_tr_b16 v[38:39], v12 offset:0
    ds_read_b64_tr_b16 v[68:69], v11 offset:272
    ds_read_b64_tr_b16 v[70:71], v12 offset:272
    s_waitcnt lgkmcnt(8)
    v_mfma_f32_16x16x32_bf16 v[24:27], v[100:103], v[140:143], v[24:27]
    v_mfma_f32_16x16x32_bf16 v[16:19], v[96:99], v[140:143], v[16:19]
    ds_read_b64_tr_b16 v[64:65], v11 offset:544
    ds_read_b64_tr_b16 v[66:67], v12 offset:544
    s_waitcnt lgkmcnt(7)
    v_mfma_f32_16x16x32_bf16 v[24:27], v[108:111], v[44:47], v[24:27]
    v_mfma_f32_16x16x32_bf16 v[16:19], v[104:107], v[44:47], v[16:19]
    ds_read_b64_tr_b16 v[40:41], v11 offset:816
    ds_read_b64_tr_b16 v[42:43], v12 offset:816
    s_waitcnt lgkmcnt(8)
    v_mfma_f32_16x16x32_bf16 v[16:19], v[112:115], v[32:35], v[16:19]
    s_waitcnt lgkmcnt(6)
    v_mfma_f32_16x16x32_bf16 v[20:23], v[36:39], v[156:159], v[20:23]
    v_mfma_f32_16x16x32_bf16 v[16:19], v[36:39], v[148:151], v[16:19]
    s_waitcnt lgkmcnt(4)
    v_mfma_f32_16x16x32_bf16 v[20:23], v[68:71], v[152:155], v[20:23]
    v_mfma_f32_16x16x32_bf16 v[16:19], v[68:71], v[144:147], v[16:19]
    ds_read_b32 v60, v166 offset:64
    ds_read_b128 v[56:59], v165 offset:128
    s_waitcnt lgkmcnt(4)
    v_mfma_f32_16x16x32_bf16 v[20:23], v[64:67], v[148:151], v[20:23]
    s_waitcnt lgkmcnt(2)
    v_mfma_f32_16x16x32_bf16 v[20:23], v[40:43], v[144:147], v[20:23]
    s_setprio 0
    s_waitcnt lgkmcnt(0)
C_CL1:
    v_cmp_eq_u32 vcc, 0, v60
    s_nop 4
    s_cbranch_vccz C_CD
    ds_read_b32 v60, v166 offset:64
    ds_read_b128 v[56:59], v165 offset:128
    s_sub_u32 s60, s60, 1
    s_cmp_gt_i32 s60, 0
    s_waitcnt lgkmcnt(0)
    s_cbranch_scc1 C_CL1
    s_branch C_CD
C_P2:
    s_setprio 2
    ds_read_b128 v[32:35], v8 offset:1504
    ds_read_b128 v[36:39], v8 offset:2016
    ds_read_b128 v[40:43], v8 offset:1632
    s_waitcnt lgkmcnt(2)
    v_mfma_f32_16x16x32_bf16 v[116:119], v[152:155], v[32:35], 0
    v_mfma_f32_16x16x32_bf16 v[160:163], v[156:159], v[32:35], 0
    v_mfma_f32_16x16x32_bf16 v[28:31], v[52:55], v[32:35], 0
    v_mfma_f32_16x16x32_bf16 v[20:23], v[48:51], v[32:35], 0
    ds_read_b128 v[44:47], v8 offset:1760
    s_waitcnt lgkmcnt(2)
    v_mfma_f32_16x16x32_bf16 v[120:123], v[152:155], v[36:39], 0
    v_mfma_f32_16x16x32_bf16 v[124:127], v[156:159], v[36:39], 0
    v_mfma_f32_16x16x32_bf16 v[28:31], v[84:87], v[36:39], v[28:31]
    v_mfma_f32_16x16x32_bf16 v[20:23], v[80:83], v[36:39], v[20:23]
    v_mfma_f32_16x16x32_bf16 v[24:27], v[52:55], v[36:39], 0
    v_mfma_f32_16x16x32_bf16 v[16:19], v[48:51], v[36:39], 0
    v_cvt_pk_bf16_f32 v116, v116, v117
    v_cvt_pk_bf16_f32 v117, v118, v119
    ds_write_b64 v4, v[116:117] offset:2856
    v_cvt_pk_bf16_f32 v160, v160, v161
    v_cvt_pk_bf16_f32 v161, v162, v163
    ds_write_b64 v4, v[160:161] offset:6312
    ds_read_b128 v[32:35], v8 offset:1888
    s_waitcnt lgkmcnt(4)
    v_mfma_f32_16x16x32_bf16 v[28:31], v[60:63], v[40:43], v[28:31]
    v_mfma_f32_16x16x32_bf16 v[20:23], v[56:59], v[40:43], v[20:23]
    v_cvt_pk_bf16_f32 v120, v120, v121
    v_cvt_pk_bf16_f32 v121, v122, v123
    ds_write_b64 v4, v[120:121] offset:2312
    v_cvt_pk_bf16_f32 v124, v124, v125
    v_cvt_pk_bf16_f32 v125, v126, v127
    ds_write_b64 v4, v[124:125] offset:5768
    s_mov_b64 exec, 0x1
    ds_write_b32 v166, v166 offset:8
    s_mov_b64 exec, -1
    s_setprio 1
    ds_read_b128 v[36:39], v8 offset:2144
    ds_read_b64 v[116:117], v7 offset:1088
    ds_read_b64 v[118:119], v7 offset:1096
    ds_read_b64 v[120:121], v10 offset:5120
    ds_read_b64 v[122:123], v10 offset:5128
    ds_read_b64 v[124:125], v10 offset:5184
    ds_read_b64 v[126:127], v10 offset:5192
    ds_read_b64 v[160:161], v2 offset:512
    ds_read_b64 v[162:163], v2
    s_cmp_ge_u32 s2, 128
    s_cbranch_scc1 C_NX2
    s_mov_b32 m0, s58
    s_mov_b64 exec, s[56:57]
    global_load_lds_dwordx4 v5, s[72:73]
    s_add_u32 m0, s58, 896
    s_nop 0
    global_load_lds_dwordx4 v6, s[72:73]
    s_add_u32 m0, s58, 1792
    s_mov_b64 exec, 0x3f
    global_load_lds_dwordx4 v3, s[74:75]
    s_mov_b64 exec, -1
C_NX2:
    s_waitcnt lgkmcnt(15)
    v_mfma_f32_16x16x32_bf16 v[28:31], v[68:71], v[44:47], v[28:31]
    v_mfma_f32_16x16x32_bf16 v[20:23], v[64:67], v[44:47], v[20:23]
    ds_read_b128 v[40:43], v8 offset:2272
    s_waitcnt lgkmcnt(13)
    v_mfma_f32_16x16x32_bf16 v[28:31], v[76:79], v[32:35], v[28:31]
    v_mfma_f32_16x16x32_bf16 v[20:23], v[72:75], v[32:35], v[20:23]
    ds_read_b128 v[152:155], v8 offset:2400
    s_waitcnt lgkmcnt(2)
    v_and_b32 v48, 0xffff0000, v161
    v_lshlrev_b32 v49, 16, v161
    v_and_b32 v50, 0xffff0000, v160
    v_lshlrev_b32 v51, 16, v160
    v_mul_f32 v48, v48, v164
    v_mul_f32 v49, v49, v164
    v_mul_f32 v50, v50, v164
    v_mul_f32 v51, v51, v164
    v_cvt_pk_bf16_f32 v49, v48, v49
    v_lshlrev_b32 v48, 16, v49
    v_and_b32 v49, 0xffff0000, v49
    v_cvt_pk_bf16_f32 v51, v50, v51
    v_lshlrev_b32 v50, 16, v51
    v_and_b32 v51, 0xffff0000, v51
    v_and_b32 v52, 0xffff0000, v163
    v_lshlrev_b32 v53, 16, v163
    v_and_b32 v54, 0xffff0000, v162
    v_lshlrev_b32 v55, 16, v162
    v_mul_f32 v52, v52, v164
    v_mul_f32 v53, v53, v164
    v_mul_f32 v54, v54, v164
    v_mul_f32 v55, v55, v164
    v_cvt_pk_bf16_f32 v53, v52, v53
    v_lshlrev_b32 v52, 16, v53
    v_and_b32 v53, 0xffff0000, v53
    v_cvt_pk_bf16_f32 v55, v54, v55
    v_lshlrev_b32 v54, 16, v55
    v_and_b32 v55, 0xffff0000, v55
    v_mfma_f32_16x16x32_bf16 v[28:31], v[92:95], v[36:39], v[28:31]
    v_mfma_f32_16x16x32_bf16 v[20:23], v[88:91], v[36:39], v[20:23]
    v_mfma_f32_16x16x32_bf16 v[24:27], v[60:63], v[36:39], v[24:27]
    v_mfma_f32_16x16x32_bf16 v[16:19], v[56:59], v[36:39], v[16:19]
    ds_read_b128 v[156:159], v8 offset:2528
    s_waitcnt lgkmcnt(2)
    v_mfma_f32_16x16x32_bf16 v[28:31], v[100:103], v[40:43], v[28:31]
    v_mfma_f32_16x16x32_bf16 v[20:23], v[96:99], v[40:43], v[20:23]
    v_mfma_f32_16x16x32_bf16 v[24:27], v[68:71], v[40:43], v[24:27]
    v_mfma_f32_16x16x32_bf16 v[16:19], v[64:67], v[40:43], v[16:19]
    ds_read_b128 v[44:47], v8 offset:2656
    s_waitcnt lgkmcnt(2)
    v_mfma_f32_16x16x32_bf16 v[28:31], v[108:111], v[152:155], v[28:31]
    v_mfma_f32_16x16x32_bf16 v[20:23], v[104:107], v[152:155], v[20:23]
    v_mfma_f32_16x16x32_bf16 v[24:27], v[76:79], v[152:155], v[24:27]
    v_mfma_f32_16x16x32_bf16 v[16:19], v[72:75], v[152:155], v[16:19]
    ds_read_b128 v[32:35], v8 offset:2784
    s_waitcnt lgkmcnt(2)
    v_mfma_f32_16x16x32_bf16 v[20:23], v[112:115], v[156:159], v[20:23]
    v_mfma_f32_16x16x32_bf16 v[24:27], v[84:87], v[156:159], v[24:27]
    v_mfma_f32_16x16x32_bf16 v[16:19], v[80:83], v[156:159], v[16:19]
    s_mov_b32 exec_lo, 0xc000c000
    s_mov_b32 exec_hi, 0xc000c000
    ds_write_b128 v165, v[28:31] offset:384
    ds_write_b32 v166, v166 offset:72
    s_mov_b64 exec, -1
    ds_read_b96 v[60:62], v166
    ds_read_b128 v[36:39], v8 offset:2912
    s_waitcnt lgkmcnt(5)
    v_mfma_f32_16x16x32_bf16 v[24:27], v[92:95], v[44:47], v[24:27]
    v_mfma_f32_16x16x32_bf16 v[16:19], v[88:91], v[44:47], v[16:19]
    s_waitcnt lgkmcnt(1)
C_FL2:
    v_min3_u32 v60, v60, v61, v62
    v_cmp_eq_u32 vcc, 0, v60
    s_nop 4
    s_cbranch_vccz C_FD2
    ds_read_b96 v[60:62], v166
    s_sub_u32 s60, s60, 1
    s_cmp_gt_i32 s60, 0
    s_waitcnt lgkmcnt(0)
    s_cbranch_scc1 C_FL2
C_FD2:
    ds_read_b128 v[68:71], v8 offset:3040
    v_mfma_f32_16x16x32_bf16 v[24:27], v[100:103], v[32:35], v[24:27]
    v_mfma_f32_16x16x32_bf16 v[16:19], v[96:99], v[32:35], v[16:19]
    ds_read_b128 v[64:67], v8 offset:3552
    s_waitcnt lgkmcnt(2)
    v_mfma_f32_16x16x32_bf16 v[24:27], v[108:111], v[36:39], v[24:27]
    v_mfma_f32_16x16x32_bf16 v[16:19], v[104:107], v[36:39], v[16:19]
    ds_read_b128 v[40:43], v8 offset:4064
    ds_read_b64_tr_b16 v[76:77], v13 offset:6912
    ds_read_b64_tr_b16 v[78:79], v14 offset:6912
    ds_read_b64_tr_b16 v[72:73], v13 offset:7456
    ds_read_b64_tr_b16 v[74:75], v14 offset:7456
    s_waitcnt lgkmcnt(6)
    v_mfma_f32_16x16x32_bf16 v[16:19], v[112:115], v[68:71], v[16:19]
    ds_read_b64_tr_b16 v[152:153], v11 offset:0
    ds_read_b64_tr_b16 v[154:155], v12 offset:0
    s_waitcnt lgkmcnt(7)
    v_mfma_f32_16x16x32_bf16 v[20:23], v[116:119], v[64:67], v[20:23]
    ds_read_b64_tr_b16 v[84:85], v11 offset:272
    ds_read_b64_tr_b16 v[86:87], v12 offset:272
    s_waitcnt lgkmcnt(8)
    v_mfma_f32_16x16x32_bf16 v[16:19], v[116:119], v[40:43], v[16:19]
    ds_read_b64_tr_b16 v[80:81], v11 offset:544
    ds_read_b64_tr_b16 v[82:83], v12 offset:544
    s_waitcnt lgkmcnt(8)
    v_mfma_f32_16x16x32_bf16 v[20:23], v[76:79], v[124:127], v[20:23]
    v_mfma_f32_16x16x32_bf16 v[16:19], v[76:79], v[120:123], v[16:19]
    ds_read_b64_tr_b16 v[156:157], v11 offset:816
    ds_read_b64_tr_b16 v[158:159], v12 offset:816
    s_waitcnt lgkmcnt(8)
    v_mfma_f32_16x16x32_bf16 v[20:23], v[72:75], v[120:123], v[20:23]
    ds_read_b64_tr_b16 v[92:93], v11 offset:1088
    ds_read_b64_tr_b16 v[94:95], v12 offset:1088
    s_waitcnt lgkmcnt(8)
    v_mfma_f32_16x16x32_bf16 v[16:19], v[152:155], v[148:151], v[16:19]
    ds_read_b64_tr_b16 v[88:89], v11 offset:1360
    ds_read_b64_tr_b16 v[90:91], v12 offset:1360
    s_waitcnt lgkmcnt(8)
    v_mfma_f32_16x16x32_bf16 v[16:19], v[84:87], v[144:147], v[16:19]
    ds_read_b64_tr_b16 v[44:45], v11 offset:1632
    ds_read_b64_tr_b16 v[46:47], v12 offset:1632
    s_waitcnt lgkmcnt(8)
    v_mfma_f32_16x16x32_bf16 v[20:23], v[80:83], v[148:151], v[20:23]
    v_mfma_f32_16x16x32_bf16 v[16:19], v[80:83], v[140:143], v[16:19]
    ds_read_b64_tr_b16 v[100:101], v11 offset:1904
    ds_read_b64_tr_b16 v[102:103], v12 offset:1904
    s_waitcnt lgkmcnt(8)
    v_mfma_f32_16x16x32_bf16 v[20:23], v[156:159], v[144:147], v[20:23]
    v_mfma_f32_16x16x32_bf16 v[16:19], v[156:159], v[136:139], v[16:19]
    s_waitcnt lgkmcnt(6)
    v_mfma_f32_16x16x32_bf16 v[20:23], v[92:95], v[140:143], v[20:23]
    v_mfma_f32_16x16x32_bf16 v[16:19], v[92:95], v[132:135], v[16:19]
    s_waitcnt lgkmcnt(4)
    v_mfma_f32_16x16x32_bf16 v[20:23], v[88:91], v[136:139], v[20:23]
    v_mfma_f32_16x16x32_bf16 v[16:19], v[88:91], v[128:131], v[16:19]
    ds_read_b32 v60, v166 offset:68
    ds_read_b128 v[56:59], v165 offset:256
    s_waitcnt lgkmcnt(4)
    v_mfma_f32_16x16x32_bf16 v[20:23], v[44:47], v[132:135], v[20:23]
    s_waitcnt lgkmcnt(2)
    v_mfma_f32_16x16x32_bf16 v[20:23], v[100:103], v[128:131], v[20:23]
    s_setprio 0
    s_waitcnt lgkmcnt(0)
C_CL2:
    v_cmp_eq_u32 vcc, 0, v60
    s_nop 4
    s_cbranch_vccz C_CD
    ds_read_b32 v60, v166 offset:68
    ds_read_b128 v[56:59], v165 offset:256
    s_sub_u32 s60, s60, 1
    s_cmp_gt_i32 s60, 0
    s_waitcnt lgkmcnt(0)
    s_cbranch_scc1 C_CL2
    s_branch C_CD
C_P3:
    s_setprio 1
    ds_read_b128 v[32:35], v8 offset:480
    ds_read_b128 v[36:39], v8 offset:608
    ds_read_b128 v[40:43], v8 offset:736
    ds_read_b64 v[160:161], v2 offset:512
    ds_read_b64 v[162:163], v2
    s_waitcnt lgkmcnt(4)
    v_mfma_f32_16x16x32_bf16 v[28:31], v[52:55], v[32:35], 0
    v_mfma_f32_16x16x32_bf16 v[20:23], v[48:51], v[32:35], 0
    ds_read_b128 v[44:47], v8 offset:864
    s_waitcnt lgkmcnt(4)
    v_mfma_f32_16x16x32_bf16 v[28:31], v[60:63], v[36:39], v[28:31]
    v_mfma_f32_16x16x32_bf16 v[20:23], v[56:59], v[36:39], v[20:23]
    s_cmp_ge_u32 s2, 128
    s_cbranch_scc1 C_NX3
    s_mov_b32 m0, s58
    s_mov_b64 exec, s[56:57]
    global_load_lds_dwordx4 v5, s[72:73]
    s_add_u32 m0, s58, 896
    s_nop 0
    global_load_lds_dwordx4 v6, s[72:73]
    s_add_u32 m0, s58, 1792
    s_mov_b64 exec, 0x3f
    global_load_lds_dwordx4 v3, s[74:75]
    s_mov_b64 exec, -1
C_NX3:
    ds_read_b128 v[32:35], v8 offset:992
    s_waitcnt lgkmcnt(4)
    v_mfma_f32_16x16x32_bf16 v[28:31], v[68:71], v[40:43], v[28:31]
    v_mfma_f32_16x16x32_bf16 v[20:23], v[64:67], v[40:43], v[20:23]
    ds_read_b128 v[36:39], v8 offset:1120
    s_waitcnt lgkmcnt(2)
    v_mfma_f32_16x16x32_bf16 v[28:31], v[76:79], v[44:47], v[28:31]
    v_mfma_f32_16x16x32_bf16 v[20:23], v[72:75], v[44:47], v[20:23]
    ds_read_b128 v[40:43], v8 offset:1248
    s_waitcnt lgkmcnt(2)
    v_mfma_f32_16x16x32_bf16 v[28:31], v[84:87], v[32:35], v[28:31]
    v_mfma_f32_16x16x32_bf16 v[20:23], v[80:83], v[32:35], v[20:23]
    v_mfma_f32_16x16x32_bf16 v[24:27], v[52:55], v[32:35], 0
    v_mfma_f32_16x16x32_bf16 v[16:19], v[48:51], v[32:35], 0
    ds_read_b128 v[44:47], v8 offset:1376
    s_waitcnt lgkmcnt(2)
    v_mfma_f32_16x16x32_bf16 v[28:31], v[92:95], v[36:39], v[28:31]
    v_mfma_f32_16x16x32_bf16 v[20:23], v[88:91], v[36:39], v[20:23]
    v_mfma_f32_16x16x32_bf16 v[24:27], v[60:63], v[36:39], v[24:27]
    v_mfma_f32_16x16x32_bf16 v[16:19], v[56:59], v[36:39], v[16:19]
    ds_read_b128 v[32:35], v8 offset:1504
    v_and_b32 v48, 0xffff0000, v161
    v_lshlrev_b32 v49, 16, v161
    v_and_b32 v50, 0xffff0000, v160
    v_lshlrev_b32 v51, 16, v160
    v_mul_f32 v48, v48, v164
    v_mul_f32 v49, v49, v164
    v_mul_f32 v50, v50, v164
    v_mul_f32 v51, v51, v164
    v_cvt_pk_bf16_f32 v49, v48, v49
    v_lshlrev_b32 v48, 16, v49
    v_and_b32 v49, 0xffff0000, v49
    v_cvt_pk_bf16_f32 v51, v50, v51
    v_lshlrev_b32 v50, 16, v51
    v_and_b32 v51, 0xffff0000, v51
    v_and_b32 v52, 0xffff0000, v163
    v_lshlrev_b32 v53, 16, v163
    v_and_b32 v54, 0xffff0000, v162
    v_lshlrev_b32 v55, 16, v162
    v_mul_f32 v52, v52, v164
    v_mul_f32 v53, v53, v164
    v_mul_f32 v54, v54, v164
    v_mul_f32 v55, v55, v164
    v_cvt_pk_bf16_f32 v53, v52, v53
    v_lshlrev_b32 v52, 16, v53
    v_and_b32 v53, 0xffff0000, v53
    v_cvt_pk_bf16_f32 v55, v54, v55
    v_lshlrev_b32 v54, 16, v55
    v_and_b32 v55, 0xffff0000, v55
    s_waitcnt lgkmcnt(2)
    v_mfma_f32_16x16x32_bf16 v[28:31], v[100:103], v[40:43], v[28:31]
    v_mfma_f32_16x16x32_bf16 v[20:23], v[96:99], v[40:43], v[20:23]
    v_mfma_f32_16x16x32_bf16 v[24:27], v[68:71], v[40:43], v[24:27]
    v_mfma_f32_16x16x32_bf16 v[16:19], v[64:67], v[40:43], v[16:19]
    ds_read_b128 v[36:39], v8 offset:1632
    s_waitcnt lgkmcnt(2)
    v_mfma_f32_16x16x32_bf16 v[28:31], v[108:111], v[44:47], v[28:31]
    v_mfma_f32_16x16x32_bf16 v[20:23], v[104:107], v[44:47], v[20:23]
    v_mfma_f32_16x16x32_bf16 v[24:27], v[76:79], v[44:47], v[24:27]
    v_mfma_f32_16x16x32_bf16 v[16:19], v[72:75], v[44:47], v[16:19]
    ds_read_b128 v[68:71], v8 offset:1760
    s_waitcnt lgkmcnt(2)
    v_mfma_f32_16x16x32_bf16 v[20:23], v[112:115], v[32:35], v[20:23]
    v_mfma_f32_16x16x32_bf16 v[24:27], v[84:87], v[32:35], v[24:27]
    v_mfma_f32_16x16x32_bf16 v[16:19], v[80:83], v[32:35], v[16:19]
    ds_read_b96 v[60:62], v166
    ds_read_b128 v[64:67], v8 offset:1888
    s_waitcnt lgkmcnt(3)
    v_mfma_f32_16x16x32_bf16 v[24:27], v[92:95], v[36:39], v[24:27]
    v_mfma_f32_16x16x32_bf16 v[16:19], v[88:91], v[36:39], v[16:19]
    s_waitcnt lgkmcnt(1)
C_FL3:
    v_min3_u32 v60, v60, v61, v62
    v_cmp_eq_u32 vcc, 0, v60
    s_nop 4
    s_cbranch_vccz C_FD3
    ds_read_b96 v[60:62], v166
    s_sub_u32 s60, s60, 1
    s_cmp_gt_i32 s60, 0
    s_waitcnt lgkmcnt(0)
    s_cbranch_scc1 C_FL3
C_FD3:
    ds_read_b128 v[40:43], v8 offset:2016
    v_mfma_f32_16x16x32_bf16 v[24:27], v[100:103], v[68:71], v[24:27]
    v_mfma_f32_16x16x32_bf16 v[16:19], v[96:99], v[68:71], v[16:19]
    ds_read_b128 v[76:79], v8 offset:2528
    s_waitcnt lgkmcnt(2)
    v_mfma_f32_16x16x32_bf16 v[24:27], v[108:111], v[64:67], v[24:27]
    v_mfma_f32_16x16x32_bf16 v[16:19], v[104:107], v[64:67], v[16:19]
    ds_read_b128 v[72:75], v8 offset:3040
    ds_read_b64_tr_b16 v[44:45], v13 offset:6912
    ds_read_b64_tr_b16 v[46:47], v14 offset:6912
    ds_read_b64_tr_b16 v[84:85], v13 offset:7456
    ds_read_b64_tr_b16 v[86:87], v14 offset:7456
    s_waitcnt lgkmcnt(6)
    v_mfma_f32_16x16x32_bf16 v[16:19], v[112:115], v[40:43], v[16:19]
    ds_read_b64_tr_b16 v[80:81], v13 offset:8000
    ds_read_b64_tr_b16 v[82:83], v14 offset:8000
    s_waitcnt lgkmcnt(7)
    v_mfma_f32_16x16x32_bf16 v[20:23], v[116:119], v[76:79], v[20:23]
    ds_read_b64_tr_b16 v[32:33], v13 offset:8544
    ds_read_b64_tr_b16 v[34:35], v14 offset:8544
    s_waitcnt lgkmcnt(8)
    v_mfma_f32_16x16x32_bf16 v[16:19], v[116:119], v[72:75], v[16:19]
    ds_read_b64_tr_b16 v[92:93], v11 offset:1088
    ds_read_b64_tr_b16 v[94:95], v12 offset:1088
    s_waitcnt lgkmcnt(8)
    v_mfma_f32_16x16x32_bf16 v[20:23], v[44:47], v[124:127], v[20:23]
    v_mfma_f32_16x16x32_bf16 v[16:19], v[44:47], v[120:123], v[16:19]
    ds_read_b64_tr_b16 v[88:89], v11 offset:1360
    ds_read_b64_tr_b16 v[90:91], v12 offset:1360
    s_waitcnt lgkmcnt(8)
    v_mfma_f32_16x16x32_bf16 v[20:23], v[84:87], v[120:123], v[20:23]
    v_mfma_f32_16x16x32_bf16 v[16:19], v[84:87], v[156:159], v[16:19]
    ds_read_b64_tr_b16 v[36:37], v11 offset:1632
    ds_read_b64_tr_b16 v[38:39], v12 offset:1632
    s_waitcnt lgkmcnt(8)
    v_mfma_f32_16x16x32_bf16 v[20:23], v[80:83], v[156:159], v[20:23]
    v_mfma_f32_16x16x32_bf16 v[16:19], v[80:83], v[152:155], v[16:19]
    ds_read_b64_tr_b16 v[100:101], v11 offset:1904
    ds_read_b64_tr_b16 v[102:103], v12 offset:1904
    s_waitcnt lgkmcnt(8)
    v_mfma_f32_16x16x32_bf16 v[20:23], v[32:35], v[152:155], v[20:23]
    ds_read_b64_tr_b16 v[96:97], v11 offset:2176
    ds_read_b64_tr_b16 v[98:99], v12 offset:2176
    s_waitcnt lgkmcnt(8)
    v_mfma_f32_16x16x32_bf16 v[16:19], v[92:95], v[148:151], v[16:19]
    ds_read_b64_tr_b16 v[68:69], v11 offset:2448
    ds_read_b64_tr_b16 v[70:71], v12 offset:2448
    s_waitcnt lgkmcnt(8)
    v_mfma_f32_16x16x32_bf16 v[16:19], v[88:91], v[144:147], v[16:19]
    ds_read_b64_tr_b16 v[108:109], v11 offset:2720
    ds_read_b64_tr_b16 v[110:111], v12 offset:2720
    s_waitcnt lgkmcnt(8)
    v_mfma_f32_16x16x32_bf16 v[20:23], v[36:39], v[148:151], v[20:23]
    v_mfma_f32_16x16x32_bf16 v[16:19], v[36:39], v[140:143], v[16:19]
    ds_read_b64_tr_b16 v[104:105], v11 offset:2992
    ds_read_b64_tr_b16 v[106:107], v12 offset:2992
    s_waitcnt lgkmcnt(8)
    v_mfma_f32_16x16x32_bf16 v[20:23], v[100:103], v[144:147], v[20:23]
    v_mfma_f32_16x16x32_bf16 v[16:19], v[100:103], v[136:139], v[16:19]
    s_waitcnt lgkmcnt(6)
    v_mfma_f32_16x16x32_bf16 v[20:23], v[96:99], v[140:143], v[20:23]
    v_mfma_f32_16x16x32_bf16 v[16:19], v[96:99], v[132:135], v[16:19]
    s_waitcnt lgkmcnt(4)
    v_mfma_f32_16x16x32_bf16 v[20:23], v[68:71], v[136:139], v[20:23]
    v_mfma_f32_16x16x32_bf16 v[16:19], v[68:71], v[128:131], v[16:19]
    ds_read_b32 v60, v166 offset:72
    ds_read_b128 v[56:59], v165 offset:384
    s_waitcnt lgkmcnt(4)
    v_mfma_f32_16x16x32_bf16 v[20:23], v[108:111], v[132:135], v[20:23]
    s_waitcnt lgkmcnt(2)
    v_mfma_f32_16x16x32_bf16 v[20:23], v[104:107], v[128:131], v[20:23]
    s_setprio 0
    s_waitcnt lgkmcnt(0)
C_CL3:
    v_cmp_eq_u32 vcc, 0, v60
    s_nop 4
    s_cbranch_vccz C_CD
    ds_read_b32 v60, v166 offset:72
    ds_read_b128 v[56:59], v165 offset:384
    s_sub_u32 s60, s60, 1
    s_cmp_gt_i32 s60, 0
    s_waitcnt lgkmcnt(0)
    s_cbranch_scc1 C_CL3
C_CD:
    s_waitcnt vmcnt(3)
    s_cmp_lt_u32 s2, 128
    s_cbranch_scc1 C_CD2
    s_waitcnt vmcnt(0)
C_CD2:
    s_mov_b32 exec_lo, 0x30003
    s_mov_b32 exec_hi, 0x30003
    s_nop 4
    v_pk_add_f32 v[16:17], v[16:17], v[56:57]
    v_pk_add_f32 v[18:19], v[18:19], v[58:59]
    s_mov_b64 exec, -1
C_EPI:
    s_nop 3
    s_movk_i32 s54, 0x3f80
    s_mov_b32 s55, 1.0
    v_add_f32_dpp v16, v24, v16 row_shr:2 row_mask:0xf bank_mask:0xf
    v_add_f32_dpp v17, v25, v17 row_shr:2 row_mask:0xf bank_mask:0xf
    v_add_f32_dpp v18, v26, v18 row_shr:2 row_mask:0xf bank_mask:0xf
    v_add_f32_dpp v19, v27, v19 row_shr:2 row_mask:0xf bank_mask:0xf
    v_add_f32_dpp v20, v28, v20 row_shr:2 row_mask:0xf bank_mask:0xf
    v_add_f32_dpp v21, v29, v21 row_shr:2 row_mask:0xf bank_mask:0xf
    v_add_f32_dpp v22, v30, v22 row_shr:2 row_mask:0xf bank_mask:0xf
    v_add_f32_dpp v23, v31, v23 row_shr:2 row_mask:0xf bank_mask:0xf
    v_add_f32_dpp v20, v24, v20 row_shl:14 row_mask:0xf bank_mask:0xf
    v_add_f32_dpp v21, v25, v21 row_shl:14 row_mask:0xf bank_mask:0xf
    v_add_f32_dpp v22, v26, v22 row_shl:14 row_mask:0xf bank_mask:0xf
    v_add_f32_dpp v23, v27, v23 row_shl:14 row_mask:0xf bank_mask:0xf
    v_cvt_pk_bf16_f32 v16, v16, v17
    v_cvt_pk_bf16_f32 v17, v18, v19
    v_cvt_pk_bf16_f32 v18, v20, v21
    v_cvt_pk_bf16_f32 v19, v22, v23
    v_dot2c_f32_bf16 v48, s54, v16
    v_dot2c_f32_bf16 v49, s55, v16
    v_dot2c_f32_bf16 v50, s54, v17
    v_dot2c_f32_bf16 v51, s55, v17
    v_dot2c_f32_bf16 v52, s54, v18
    v_dot2c_f32_bf16 v53, s55, v18
    v_dot2c_f32_bf16 v54, s54, v19
    v_dot2c_f32_bf16 v55, s55, v19
    v_cvt_pk_bf16_f32 v48, v48, v49
    v_cvt_pk_bf16_f32 v49, v50, v51
    ds_write_b64 v15, v[48:49] offset:0
    v_cvt_pk_bf16_f32 v52, v52, v53
    v_cvt_pk_bf16_f32 v53, v54, v55
    ds_write_b64 v15, v[52:53] offset:544
    s_cmp_ge_u32 s38, 8
    s_cbranch_scc1 C_NOGA
    v_lshrrev_b32 v7, 5, v0
    v_lshlrev_b32 v7, 3, v7
    v_lshl_add_u32 v7, v0, 2, v7
    v_add_u32 v7, 48960, v7
    v_lshrrev_b32 v8, 3, v0
    v_mul_u32_u24 v8, 24576, v8
    v_and_b32 v9, 7, v0
    v_lshl_add_u32 v8, v9, 4, v8
    s_lshr_b32 s52, s2, 4
    s_lshl_b32 s52, s52, 11
    s_and_b32 s53, s2, 1
    s_lshl_b32 s53, s53, 10
    s_add_u32 s52, s52, s53
    s_bfe_u32 s53, s2, 0x30001
    s_lshl_b32 s53, s53, 7
    s_add_u32 s52, s52, s53
    s_add_u32 s52, s52, 3211264
    s_add_u32 s53, s52, 1572864
    v_mov_b32 v27, v167
    v_mov_b32 v31, v167
C_NOGA:
    s_waitcnt lgkmcnt(0)
    s_barrier
    s_sub_u32 s45, s38, 0
    s_cmp_ge_u32 s45, 8
    s_cbranch_scc1 C_NOST
    ds_read_b32 v24, v7 offset:0
    ds_read_b32 v25, v7 offset:17408
    ds_read_b32 v26, v7 offset:34816
    ds_read_b32 v28, v7 offset:2176
    ds_read_b32 v29, v7 offset:19584
    ds_read_b32 v30, v7 offset:36992
    s_waitcnt lgkmcnt(3)
    buffer_store_dwordx4 v[24:27], v8, s[40:43], s52 offen sc1
    s_waitcnt lgkmcnt(0)
    buffer_store_dwordx4 v[28:31], v8, s[40:43], s53 offen sc1
C_NOST:
    s_cmp_ge_u32 s2, 176
    s_cbranch_scc1 FFN_LATE
    s_cmp_ge_u32 s2, 128
    s_cbranch_scc1 FINAL
    v_and_b32 v7, 7, v1
    v_lshrrev_b32 v8, 3, v1
    s_mul_i32 s44, s2, 18432
    s_mul_i32 s45, s38, 96
    v_mul_u32_u24 v9, 0xe0, v7
    v_mad_u32_u24 v9, v8, 12, v9
    v_add_u32 v9, s58, v9
    v_xor_b32 v10, 1, v8
    v_mad_u32_u24 v13, v10, 12, s58
    s_mul_i32 s47, s2, 24576
    s_lshl_b32 s48, s38, 11
    s_add_u32 s47, s47, s48
    s_add_u32 s47, s47, 3211264
    v_mul_u32_u24 v84, 48, v7
    v_bfe_u32 v10, v1, 3, 1
    v_lshl_add_u32 v84, v10, 2, v84
    s_lshl_b32 s49, s69, 3
    s_add_u32 s49, s49, s71
    s_add_u32 s49, s49, 14336
    v_add_u32 v84, s49, v84
    v_mul_u32_u24 v85, 48, v1
    v_add_u32 v85, 60992, v85
    s_mov_b32 exec_lo, 0xf0000f
    s_mov_b32 exec_hi, 0xf0000f00
    v_subrev_u32 v84, 1536, v84
    s_mov_b32 exec_lo, 0xff000000
    s_mov_b32 exec_hi, 0xff0000
    v_subrev_u32 v84, 768, v84
    s_mov_b32 exec_lo, 0xff00
    s_mov_b32 exec_hi, 0xff
    v_subrev_u32 v84, 2304, v84
    s_mov_b64 exec, -1
    s_add_u32 s48, s48, 0
    v_and_b32 v10, 6, v7
    v_xor_b32 v10, v10, v8
    v_lshl_add_u32 v10, v7, 3, v10
    v_lshl_add_u32 v86, v10, 4, s48
    v_and_b32 v10, 6, v8
    v_xor_b32 v10, v10, v1
    v_lshl_add_u32 v87, v10, 4, s48
    v_mul_u32_u24 v88, 2944, v8
    v_add_u32 v88, v88, v3
    s_mul_i32 s48, s2, 24576
    s_lshl_b32 s49, s38, 7
    s_add_u32 s48, s48, s49
    s_add_u32 s48, s48, 6553600
    v_mul_u32_u24 v89, 2336, v7
    v_mad_u32_u24 v89, v8, 12, v89
    s_add_u32 s45, s45, 24576
    v_add_u32 v89, s45, v89
    v_add_u32 v10, 1536, v0
    v_add_u32 v11, 0, v0
    v_mul_u32_u24 v11, 911, v11
    v_lshrrev_b32 v11, 16, v11
    v_add_lshl_u32 v90, v10, v11, 4
    v_add_u32 v10, 2304, v0
    v_add_u32 v11, 768, v0
    v_mul_u32_u24 v11, 911, v11
    v_lshrrev_b32 v11, 16, v11
    v_add_lshl_u32 v91, v10, v11, 4
    v_lshl_add_u32 v92, v0, 4, s44
    v_bfe_u32 v10, v1, 3, 1
    v_lshl_add_u32 v10, v7, 1, v10
    s_lshl_b32 s49, s2, 4
    v_add_u32 v93, s49, v10
    v_sub_u32 v12, 0x7ff, v93
    v_lshlrev_b32 v93, 2, v93
    s_mov_b32 s49, 32768
    v_mov_b32 v51, 0
    v_mov_b32 v55, 0
    v_mov_b32 v76, 0
    v_mov_b32 v56, 0
    v_mov_b32 v57, 0
    v_mov_b32 v58, 0
    v_mov_b32 v59, 0
    v_mov_b32 v60, 0
    v_mov_b32 v61, 0
    v_mov_b32 v62, 0
    v_mov_b32 v63, 0
    s_lshl_b32 s50, s2, 6
    s_lshl_b32 s51, s38, 2
    s_add_u32 s50, s50, s51
    s_add_u32 s50, s50, 8192
    s_mov_b32 s56, 0x00100001
    s_mov_b32 s57, 0x10000100
    s_mov_b32 s58, 0xffff0000
    s_waitcnt vmcnt(0)
    buffer_load_dwordx4 v[28:31], v3, s[40:43], s47 offen sc1
    buffer_load_dwordx4 v[32:35], v3, s[40:43], s47 offen offset:1024 sc1
    ds_read_b32 v24, v13 offset:1792
    ds_read_b32 v25, v13 offset:1796
    ds_read_b32 v26, v13 offset:1800
    ds_read2_b32 v[16:17], v9 offset0:0 offset1:1
    ds_read2_b32 v[18:19], v9 offset0:2 offset1:28
    ds_read2_b32 v[20:21], v9 offset0:29 offset1:30
    s_waitcnt lgkmcnt(0)
    v_dot2c_f32_bf16 v76, 0x3f803f80, v24
    v_dot2c_f32_bf16 v76, 0x3f803f80, v25
    v_dot2c_f32_bf16 v76, 0x3f803f80, v26
    v_lshlrev_b32 v36, 16, v16
    v_and_b32 v37, 0xffff0000, v16
    v_lshlrev_b32 v42, 16, v19
    v_and_b32 v43, 0xffff0000, v19
    v_lshlrev_b32 v38, 16, v17
    v_and_b32 v39, 0xffff0000, v17
    v_lshlrev_b32 v44, 16, v20
    v_and_b32 v45, 0xffff0000, v20
    v_lshlrev_b32 v40, 16, v18
    v_and_b32 v41, 0xffff0000, v18
    v_lshlrev_b32 v46, 16, v21
    v_and_b32 v47, 0xffff0000, v21
    v_mov_b32 v77, v76
    s_nop 1
    v_permlane16_swap_b32 v76, v77
    v_add_f32 v76, v76, v77
    v_mov_b32 v77, v76
    s_nop 1
    v_permlane32_swap_b32 v76, v77
    v_add_f32 v76, v76, v77
    s_mov_b32 exec_lo, 0xf00f0
    s_mov_b32 exec_hi, 0xf00f000
    ds_write2_b32 v84, v76, v76 offset0:0 offset1:96
    s_mov_b32 exec_lo, 0xf0f0f0f
    s_mov_b32 exec_hi, 0xf0f0f0f
    v_mov_b32 v24, 0x3f803f80
    v_mov_b32 v25, 0x3f803f80
    v_mov_b32 v26, 0x3f803f80
    s_mov_b32 exec_lo, 0x11111111
    s_mov_b32 exec_hi, 0x11111111
    v_mov_b32 v56, v24
    v_mov_b32 v57, v25
    v_mov_b32 v58, v26
    s_mov_b32 exec_lo, 0x22222222
    s_mov_b32 exec_hi, 0x22222222
    v_mov_b32 v60, v24
    v_mov_b32 v61, v25
    v_mov_b32 v62, v26
    s_mov_b64 exec, -1
    s_movk_i32 s60, 4000
    s_branch L_YP_W
L_YP:
    buffer_load_dwordx4 v[28:31], v3, s[40:43], s47 offen sc1
    buffer_load_dwordx4 v[32:35], v3, s[40:43], s47 offen offset:1024 sc1
L_YP_W:
    s_waitcnt vmcnt(0)
L_YP_C:
    v_xor_b32 v10, v167, v31
    v_xor_b32 v11, v167, v35
    v_or_b32 v10, v10, v11
    v_cmp_ne_u32 vcc, 0, v10
    s_nop 0
    s_and_b64 exec, exec, vcc
    s_cbranch_execz L_YP_D
    s_wqm_b64 exec, exec
    s_sub_u32 s60, s60, 1
    s_cmp_gt_i32 s60, 0
    s_sleep 1
    s_cbranch_scc1 L_YP
L_YP_D:
    s_mov_b64 exec, -1
    v_dot2c_f32_bf16 v36, s54, v28
    v_dot2c_f32_bf16 v37, s54, v29
    v_dot2c_f32_bf16 v38, s54, v30
    v_dot2c_f32_bf16 v39, s54, v34
    v_dot2c_f32_bf16 v40, s54, v32
    v_dot2c_f32_bf16 v41, s54, v33
    v_dot2c_f32_bf16 v42, s55, v28
    v_dot2c_f32_bf16 v43, s55, v29
    v_dot2c_f32_bf16 v44, s55, v30
    v_dot2c_f32_bf16 v45, s55, v34
    v_cvt_pk_bf16_f32 v48, v36, v37
    v_dot2c_f32_bf16 v46, s55, v32
    v_cvt_pk_bf16_f32 v49, v38, v39
    v_dot2c_f32_bf16 v47, s55, v33
    v_cvt_pk_bf16_f32 v50, v40, v41
    v_cvt_pk_bf16_f32 v52, v42, v43
    v_cvt_pk_bf16_f32 v53, v44, v45
    v_mfma_f32_16x16x32_bf16 v[68:71], v[48:51], v[48:51], 0
    v_cvt_pk_bf16_f32 v54, v46, v47
    v_mfma_f32_16x16x32_bf16 v[64:67], v[56:59], v[48:51], 0
    s_nop 0
    v_mfma_f32_16x16x32_bf16 v[64:67], v[60:63], v[52:55], v[64:67]
    v_mfma_f32_16x16x32_bf16 v[72:75], v[52:55], v[52:55], 0
    v_lshlrev_b32 v36, 16, v48
    v_and_b32 v37, 0xffff0000, v48
    v_lshlrev_b32 v38, 16, v49
    v_and_b32 v39, 0xffff0000, v49
    v_lshlrev_b32 v40, 16, v50
    v_and_b32 v41, 0xffff0000, v50
    s_mov_b64 exec, s[56:57]
    v_mov_b32 v64, v68
    v_mov_b32 v65, v72
    s_lshl_b64 exec, exec, 1
    v_mov_b32 v64, v69
    v_mov_b32 v65, v73
    s_lshl_b64 exec, exec, 1
    v_mov_b32 v64, v70
    v_mov_b32 v65, v74
    s_lshl_b64 exec, exec, 1
    v_mov_b32 v64, v71
    v_mov_b32 v65, v75
    s_mov_b32 exec_lo, 0xfff0ff0f
    s_mov_b32 exec_hi, 0xf0ff0fff
    ds_write2_b32 v84, v64, v65 offset0:0 offset1:96
    s_mov_b64 exec, -1
    v_lshlrev_b32 v42, 16, v52
    v_and_b32 v43, 0xffff0000, v52
    v_lshlrev_b32 v44, 16, v53
    v_and_b32 v45, 0xffff0000, v53
    v_lshlrev_b32 v46, 16, v54
    v_and_b32 v47, 0xffff0000, v54
    s_cmp_eq_u32 s38, 0
    s_cbranch_scc0 L_NP
    s_setprio 3
L_NP:
    s_waitcnt lgkmcnt(0)
    s_barrier
    ds_read_b128 v[52:55], v85 offset:0
    ds_read_b128 v[56:59], v85 offset:16
    ds_read_b128 v[60:63], v85 offset:17408
    ds_read_b128 v[64:67], v85 offset:17424
    ds_read_b128 v[68:71], v85 offset:34816
    ds_read_b128 v[72:75], v85 offset:34832
    s_waitcnt lgkmcnt(4)
    s_waitcnt lgkmcnt(2)
    v_pk_add_f32 v[52:53], v[52:53], v[60:61]
    v_pk_add_f32 v[54:55], v[54:55], v[62:63]
    v_pk_add_f32 v[56:57], v[56:57], v[64:65]
    v_pk_add_f32 v[58:59], v[58:59], v[66:67]
    s_waitcnt lgkmcnt(0)
    v_pk_add_f32 v[52:53], v[52:53], v[68:69]
    v_pk_add_f32 v[54:55], v[54:55], v[70:71]
    v_pk_add_f32 v[56:57], v[56:57], v[72:73]
    v_pk_add_f32 v[58:59], v[58:59], v[74:75]
    v_pk_add_f32 v[52:53], v[52:53], v[54:55]
    v_pk_add_f32 v[56:57], v[56:57], v[58:59]
    v_pk_add_f32 v[52:53], v[52:53], v[56:57]
    v_add_f32 v76, v52, v53
    v_add_f32 v78, v52, v53
    s_nop 1
    v_permlane16_swap_b32 v76, v78
    v_mov_b32 v77, v76
    v_mov_b32 v13, v78
    s_nop 0
    v_permlane32_swap_b32 v76, v77
    v_permlane32_swap_b32 v78, v13
    v_mul_f32 v76, 0x3ae38e39, v76
    v_mul_f32 v78, 0x3ae38e39, v78
    v_fma_f32 v78, -v76, v76, v78
    v_max_f32 v78, 0, v78
    v_cvt_pk_bf16_f32 v78, v76, v78
    v_and_b32 v82, 0xffff0000, v78
    v_lshlrev_b32 v80, 16, v78
    v_add_f32 v82, 0x3727c5ac, v82
    v_lshlrev_b32 v81, 16, v78
    v_cvt_pk_bf16_f32 v82, v82, v82
    v_lshlrev_b32 v82, 16, v82
    v_sqrt_f32 v82, v82
    v_fma_f32 v77, -v80, v13, v77
    v_cvt_pk_bf16_f32 v82, v82, v82
    v_lshlrev_b32 v82, 16, v82
    v_rcp_f32 v83, v82
    v_rcp_f32 v82, v82
    s_cbranch_scc0 L_NK
    v_mul_f32 v77, v77, v83
    v_cvt_pk_bf16_f32 v77, v77, v77
    v_ashrrev_i32 v76, 31, v77
    v_or_b32 v76, 0x80000000, v76
    v_xor_b32 v76, v76, v77
    v_and_or_b32 v76, v76, s58, v12
    s_mov_b64 exec, 0xffff
    buffer_store_dword v76, v93, s[40:43], s49 offen sc1
    s_mov_b64 exec, -1
    s_setprio 0
L_NK:
    v_mov_b32_dpp v80, v80 row_ror:8 row_mask:0xf bank_mask:0xc
    v_mov_b32_dpp v81, v81 row_ror:8 row_mask:0xf bank_mask:0x3
    v_mov_b32_dpp v82, v82 row_ror:8 row_mask:0xf bank_mask:0xc
    v_mov_b32_dpp v83, v83 row_ror:8 row_mask:0xf bank_mask:0x3
    v_pk_add_f32 v[56:57], v[36:37], v[80:81] op_sel_hi:[1,0] neg_lo:[0,1] neg_hi:[0,1]
    v_pk_add_f32 v[58:59], v[38:39], v[80:81] op_sel_hi:[1,0] neg_lo:[0,1] neg_hi:[0,1]
    v_pk_add_f32 v[60:61], v[40:41], v[80:81] op_sel_hi:[1,0] neg_lo:[0,1] neg_hi:[0,1]
    v_pk_add_f32 v[62:63], v[42:43], v[80:81] op_sel:[0,1] neg_lo:[0,1] neg_hi:[0,1]
    v_pk_add_f32 v[64:65], v[44:45], v[80:81] op_sel:[0,1] neg_lo:[0,1] neg_hi:[0,1]
    v_pk_add_f32 v[66:67], v[46:47], v[80:81] op_sel:[0,1] neg_lo:[0,1] neg_hi:[0,1]
    v_cvt_pk_bf16_f32 v57, v56, v57
    v_cvt_pk_bf16_f32 v59, v58, v59
    v_cvt_pk_bf16_f32 v61, v60, v61
    v_cvt_pk_bf16_f32 v63, v62, v63
    v_cvt_pk_bf16_f32 v65, v64, v65
    v_cvt_pk_bf16_f32 v67, v66, v67
    v_lshlrev_b32 v56, 16, v57
    v_and_b32 v57, 0xffff0000, v57
    v_lshlrev_b32 v58, 16, v59
    v_and_b32 v59, 0xffff0000, v59
    v_lshlrev_b32 v60, 16, v61
    v_and_b32 v61, 0xffff0000, v61
    v_lshlrev_b32 v62, 16, v63
    v_and_b32 v63, 0xffff0000, v63
    v_lshlrev_b32 v64, 16, v65
    v_and_b32 v65, 0xffff0000, v65
    v_lshlrev_b32 v66, 16, v67
    v_and_b32 v67, 0xffff0000, v67
    v_pk_mul_f32 v[56:57], v[56:57], v[82:83] op_sel_hi:[1,0]
    v_pk_mul_f32 v[58:59], v[58:59], v[82:83] op_sel_hi:[1,0]
    v_pk_mul_f32 v[60:61], v[60:61], v[82:83] op_sel_hi:[1,0]
    v_pk_mul_f32 v[62:63], v[62:63], v[82:83] op_sel:[0,1]
    v_pk_mul_f32 v[64:65], v[64:65], v[82:83] op_sel:[0,1]
    v_pk_mul_f32 v[66:67], v[66:67], v[82:83] op_sel:[0,1]
    v_cvt_pk_bf16_f32 v28, v56, v57
    v_cvt_pk_bf16_f32 v29, v58, v59
    v_cvt_pk_bf16_f32 v30, v60, v61
    ds_write_b128 v86, v[28:31]
    v_cvt_pk_bf16_f32 v32, v62, v63
    v_cvt_pk_bf16_f32 v33, v64, v65
    v_cvt_pk_bf16_f32 v34, v66, v67
    ds_write_b128 v86, v[32:35] offset:1024
    ds_read_b128 v[56:59], v87
    ds_read_b128 v[60:63], v87 offset:1024
    v_dot2c_f32_bf16 v36, s54, v28
    v_dot2c_f32_bf16 v37, s55, v28
    v_dot2c_f32_bf16 v38, s54, v29
    v_dot2c_f32_bf16 v39, s55, v29
    v_dot2c_f32_bf16 v40, s54, v30
    v_dot2c_f32_bf16 v41, s55, v30
    v_dot2c_f32_bf16 v42, s54, v32
    v_dot2c_f32_bf16 v43, s55, v32
    v_dot2c_f32_bf16 v44, s54, v33
    v_dot2c_f32_bf16 v45, s55, v33
    v_dot2c_f32_bf16 v46, s54, v34
    v_dot2c_f32_bf16 v47, s55, v34
    s_waitcnt lgkmcnt(1)
    buffer_store_dwordx4 v[56:59], v88, s[40:43], s48 offen sc1
    s_waitcnt lgkmcnt(0)
    buffer_store_dwordx4 v[60:63], v88, s[40:43], s48 offen offset:1536 sc1
    v_cvt_pk_bf16_f32 v48, v36, v37
    v_cvt_pk_bf16_f32 v49, v38, v39
    v_cvt_pk_bf16_f32 v50, v40, v41
    v_cvt_pk_bf16_f32 v51, v42, v43
    v_cvt_pk_bf16_f32 v52, v44, v45
    v_cvt_pk_bf16_f32 v53, v46, v47
    v_add_u32 v10, 1168, v89
    ds_write2_b32 v89, v48, v49 offset0:0 offset1:1
    ds_write_b32 v89, v50 offset:8
    ds_write2_b32 v10, v51, v52 offset0:0 offset1:1
    ds_write_b32 v10, v53 offset:8
    v_add_u32 v11, 12288, v92
    s_waitcnt lgkmcnt(0)
    s_barrier
    ds_read_b128 v[16:19], v90
    ds_read_b128 v[20:23], v91
    v_mov_b32 v10, 0
    s_waitcnt lgkmcnt(1)
    global_store_dwordx4 v92, v[16:19], s[32:33] sc1
    s_cmp_ge_u32 s38, 6
    s_cbranch_scc1 L_O1
    s_waitcnt lgkmcnt(0)
    global_store_dwordx4 v11, v[20:23], s[32:33] sc1
L_O1:
    s_cmp_eq_u32 s38, 11
    s_cbranch_scc1 TOP8
    s_waitcnt vmcnt(0)
    s_mov_b64 exec, 0x1
    buffer_store_dword v167, v10, s[40:43], s50 offen sc1
    s_mov_b64 exec, -1
    s_branch END
FFN_DMA0:
    s_sub_u32 s58, s2, 192
    s_lshl_b32 s61, s58, 1
    s_mov_b32 s59, 8
    s_mov_b32 s57, 73728
    s_add_u32 s56, s38, 1
    s_bfe_u32 s50, s56, 0x10003
    s_and_b32 s51, s56, 1
    s_bfe_u32 s52, s56, 0x10001
    s_mul_i32 s52, s52, 36
    s_add_u32 s52, s52, s51
    s_mul_i32 s48, s52, 73728
    s_lshl_b32 s53, s61, 6
    s_add_u32 s48, s48, s53
    s_lshl_b32 s49, s52, 10
    s_mul_i32 s53, s50, 73728
    s_add_u32 s49, s49, s53
    s_lshl_b32 s51, s51, 1
    s_lshl_b32 s53, s50, 2
    s_or_b32 s51, s51, s53
    v_bfe_u32 v2, v1, 4, 1
    v_and_b32 v4, 7, v1
    v_xor_b32 v2, v2, v4
    v_xor_b32 v2, s51, v2
    v_lshrrev_b32 v4, 3, v1
    v_mul_u32_u24 v4, 0x2400, v4
    v_lshl_add_u32 v2, v2, 4, v4
    s_mov_b32 s46, 5308416
    s_mov_b32 s47, 0x00020000
    s_waitcnt lgkmcnt(0)
    s_cmp_eq_u32 s50, 0
    s_cselect_b32 s44, s26, s28
    s_cselect_b32 s45, s27, s29
    s_mov_b32 s40, s36
    s_mov_b32 s41, s37
    s_barrier
    s_sub_u32 s51, s38, 3
    s_cmp_ge_u32 s51, 8
    s_cbranch_scc1 F_B0
    s_add_u32 m0, s49, 0
    s_add_u32 s53, s48, 0
    buffer_load_dwordx4 v2, s[44:47], s53 offen lds
    s_add_u32 m0, s49, 2048
    s_add_u32 s53, s48, 147456
    buffer_load_dwordx4 v2, s[44:47], s53 offen lds
    s_barrier
    s_branch F_B2
FFN_LATE:
    s_and_b32 s61, s2, 7
    s_lshl_b32 s61, s61, 1
    s_bitcmp0_b32 s2, 3
    s_addc_u32 s61, s61, 128
    s_sub_u32 s58, s2, 112
    s_mov_b32 s59, 4
    s_mov_b32 s57, 0
    v_mov_b32 v32, 0
    v_mov_b32 v33, 0
    v_mov_b32 v34, 0
    v_mov_b32 v35, 0
    v_mov_b32 v36, 0
    v_mov_b32 v37, 0
    v_mov_b32 v38, 0
    v_mov_b32 v39, 0
    v_mov_b32 v40, 0
    v_mov_b32 v41, 0
    v_mov_b32 v42, 0
    v_mov_b32 v43, 0
    v_mov_b32 v44, 0
    v_mov_b32 v45, 0
    v_mov_b32 v46, 0
    v_mov_b32 v47, 0
    s_sub_u32 s51, s38, 3
    s_cmp_ge_u32 s51, 8
    s_cbranch_scc1 F_B0
    s_add_u32 s56, s38, 1
    s_bfe_u32 s50, s56, 0x10003
    s_and_b32 s51, s56, 1
    s_bfe_u32 s52, s56, 0x10001
    s_lshl1_add_u32 s52, s50, s52
    s_mul_i32 s52, s52, 18
    s_add_u32 s52, s52, s51
    s_mul_i32 s48, s52, 73728
    s_lshl_b32 s53, s61, 6
    s_add_u32 s48, s48, s53
    s_lshl_b32 m0, s52, 10
    s_lshl_b32 s51, s51, 1
    s_add_u32 s44, s26, s48
    s_addc_u32 s45, s27, 0
    s_add_u32 s46, s28, s48
    s_addc_u32 s47, s29, 0
    v_bfe_u32 v2, v1, 4, 1
    v_xor_b32 v2, v2, v1
    v_xor_b32 v2, s51, v2
    v_and_b32 v2, 3, v2
    v_lshrrev_b32 v4, 3, v1
    v_mul_u32_u24 v4, 0x2400, v4
    v_lshl_add_u32 v2, v2, 4, v4
    v_mov_b32 v4, s44
    v_mov_b32 v5, s45
    s_mov_b32 exec_lo, 0xf0f0f0f0
    s_mov_b32 exec_hi, 0xf0f0f0f0
    v_mov_b32 v4, s46
    v_mov_b32 v5, s47
    s_mov_b64 exec, -1
    v_add_co_u32 v4, vcc, v4, v2
    s_nop 1
    v_addc_co_u32 v5, vcc, 0, v5, vcc
    s_barrier
    global_load_lds_dwordx4 v[4:5], off
    v_add_co_u32 v4, vcc, 147456, v4
    s_add_u32 m0, m0, 2048
    s_nop 0
    v_addc_co_u32 v5, vcc, 0, v5, vcc
    global_load_lds_dwordx4 v[4:5], off
    v_add_co_u32 v4, vcc, 147456, v4
    s_add_u32 m0, m0, 2048
    s_nop 0
    v_addc_co_u32 v5, vcc, 0, v5, vcc
    global_load_lds_dwordx4 v[4:5], off
    v_add_co_u32 v4, vcc, 147456, v4
    s_add_u32 m0, m0, 2048
    s_nop 0
    v_addc_co_u32 v5, vcc, 0, v5, vcc
    global_load_lds_dwordx4 v[4:5], off
    v_add_co_u32 v4, vcc, 147456, v4
    s_add_u32 m0, m0, 2048
    s_nop 0
    v_addc_co_u32 v5, vcc, 0, v5, vcc
    global_load_lds_dwordx4 v[4:5], off
    v_add_co_u32 v4, vcc, 147456, v4
    s_add_u32 m0, m0, 2048
    s_nop 0
    v_addc_co_u32 v5, vcc, 0, v5, vcc
    global_load_lds_dwordx4 v[4:5], off
    v_add_co_u32 v4, vcc, 147456, v4
    s_add_u32 m0, m0, 2048
    s_nop 0
    v_addc_co_u32 v5, vcc, 0, v5, vcc
    global_load_lds_dwordx4 v[4:5], off
    v_add_co_u32 v4, vcc, 147456, v4
    s_add_u32 m0, m0, 2048
    s_nop 0
    v_addc_co_u32 v5, vcc, 0, v5, vcc
    global_load_lds_dwordx4 v[4:5], off
    v_add_co_u32 v4, vcc, 147456, v4
    s_add_u32 m0, m0, 2048
    s_nop 0
    v_addc_co_u32 v5, vcc, 0, v5, vcc
    global_load_lds_dwordx4 v[4:5], off
    s_branch F_W
F_L2:
    s_sub_u32 s51, s38, 3
    s_cmp_ge_u32 s51, 8
    s_cbranch_scc1 F_B0
    s_add_u32 s56, s38, 1
    s_bfe_u32 s50, s56, 0x10003
    s_and_b32 s51, s56, 1
    s_bfe_u32 s52, s56, 0x10001
    s_mul_i32 s52, s52, 36
    s_add_u32 s52, s52, s51
    s_mul_i32 s48, s52, 73728
    s_lshl_b32 s53, s61, 6
    s_add_u32 s48, s48, s53
    s_lshl_b32 s49, s52, 10
    s_mul_i32 s53, s50, 73728
    s_add_u32 s49, s49, s53
    s_lshl_b32 s51, s51, 1
    s_lshl_b32 s53, s50, 2
    s_or_b32 s51, s51, s53
    v_bfe_u32 v2, v1, 4, 1
    v_and_b32 v4, 7, v1
    v_xor_b32 v2, v2, v4
    v_xor_b32 v2, s51, v2
    v_lshrrev_b32 v4, 3, v1
    v_mul_u32_u24 v4, 0x2400, v4
    v_lshl_add_u32 v2, v2, 4, v4
    s_mov_b32 s46, 5308416
    s_mov_b32 s47, 0x00020000
    s_cmp_eq_u32 s50, 0
    s_cselect_b32 s44, s26, s28
    s_cselect_b32 s45, s27, s29
    s_barrier
    s_add_u32 m0, s49, 0
    s_add_u32 s53, s48, 0
    buffer_load_dwordx4 v2, s[44:47], s53 offen lds
    s_add_u32 m0, s49, 2048
    s_add_u32 s53, s48, 147456
    buffer_load_dwordx4 v2, s[44:47], s53 offen lds
F_B2:
    s_add_u32 m0, s49, 4096
    s_add_u32 s53, s48, 294912
    buffer_load_dwordx4 v2, s[44:47], s53 offen lds
    s_add_u32 m0, s49, 6144
    s_add_u32 s53, s48, 442368
    buffer_load_dwordx4 v2, s[44:47], s53 offen lds
    s_add_u32 m0, s49, 8192
    s_add_u32 s53, s48, 589824
    buffer_load_dwordx4 v2, s[44:47], s53 offen lds
    s_add_u32 m0, s49, 10240
    s_add_u32 s53, s48, 737280
    buffer_load_dwordx4 v2, s[44:47], s53 offen lds
    s_add_u32 m0, s49, 12288
    s_add_u32 s53, s48, 884736
    buffer_load_dwordx4 v2, s[44:47], s53 offen lds
    s_add_u32 m0, s49, 14336
    s_add_u32 s53, s48, 1032192
    buffer_load_dwordx4 v2, s[44:47], s53 offen lds
    s_add_u32 m0, s49, 16384
    s_add_u32 s53, s48, 1179648
    buffer_load_dwordx4 v2, s[44:47], s53 offen lds
    s_add_u32 m0, s49, 18432
    s_add_u32 s53, s48, 1327104
    buffer_load_dwordx4 v2, s[44:47], s53 offen lds
    s_add_u32 m0, s49, 20480
    s_add_u32 s53, s48, 1474560
    buffer_load_dwordx4 v2, s[44:47], s53 offen lds
    s_add_u32 m0, s49, 22528
    s_add_u32 s53, s48, 1622016
    buffer_load_dwordx4 v2, s[44:47], s53 offen lds
    s_add_u32 m0, s49, 24576
    s_add_u32 s53, s48, 1769472
    buffer_load_dwordx4 v2, s[44:47], s53 offen lds
    s_add_u32 m0, s49, 26624
    s_add_u32 s53, s48, 1916928
    buffer_load_dwordx4 v2, s[44:47], s53 offen lds
    s_add_u32 m0, s49, 28672
    s_add_u32 s53, s48, 2064384
    buffer_load_dwordx4 v2, s[44:47], s53 offen lds
    s_add_u32 m0, s49, 30720
    s_add_u32 s53, s48, 2211840
    buffer_load_dwordx4 v2, s[44:47], s53 offen lds
    s_add_u32 m0, s49, 32768
    s_add_u32 s53, s48, 2359296
    buffer_load_dwordx4 v2, s[44:47], s53 offen lds
    s_add_u32 m0, s49, 34816
    s_add_u32 s53, s48, 2506752
    buffer_load_dwordx4 v2, s[44:47], s53 offen lds
    s_branch F_W
FFN_DMA:
    s_setprio 0
    s_sub_u32 s58, s2, 192
    s_lshl_b32 s61, s58, 1
    s_mov_b32 s59, 8
    s_mov_b32 s57, 73728
    s_waitcnt vmcnt(0)
    s_branch F_L2
F_B0:
    s_setprio 3
    s_barrier
F_W:
    s_mov_b64 exec, -1
    v_mov_b32 v167, 156684
    ds_read_b32 v167, v167
    v_and_b32 v7, 7, v1
    v_lshrrev_b32 v8, 3, v1
    v_and_b32 v5, 15, v1
    v_lshrrev_b32 v6, 4, v1
    s_mul_i32 s52, s61, 36864
    s_mul_i32 s53, s38, 96
    s_add_u32 s52, s52, s53
    v_mul_u32_u24 v9, 0x480, v8
    v_mad_u32_u24 v9, v7, 12, v9
    v_add_u32 v9, s52, v9
    global_load_dwordx3 v[16:18], v9, s[30:31]
    v_add_u32 v9, 0x2400, v9
    global_load_dwordx3 v[20:22], v9, s[30:31]
    v_add_u32 v9, 0x2400, v9
    global_load_dwordx3 v[24:26], v9, s[30:31]
    v_add_u32 v9, 0x2400, v9
    global_load_dwordx3 v[28:30], v9, s[30:31]
    v_add_u32 v9, 0x2400, v9
    s_cmp_eq_u32 s59, 4
    s_cbranch_scc1 F_W4
    global_load_dwordx3 v[32:34], v9, s[30:31]
    v_add_u32 v9, 0x2400, v9
    global_load_dwordx3 v[36:38], v9, s[30:31]
    v_add_u32 v9, 0x2400, v9
    global_load_dwordx3 v[40:42], v9, s[30:31]
    v_add_u32 v9, 0x2400, v9
    global_load_dwordx3 v[44:46], v9, s[30:31]
F_W4:
    v_mul_u32_u24 v10, 683, v0
    v_lshrrev_b32 v10, 16, v10
    v_mul_u32_u24 v11, 0x60, v10
    v_sub_u32 v11, v0, v11
    s_mov_b32 s52, 161920
    v_lshl_add_u32 v160, v10, 2, s52
    v_and_b32 v63, 4, v10
    v_lshl_add_u32 v160, v63, 2, v160
    v_mov_b32 v63, 161492
    s_mov_b32 s52, 3144192
    v_lshl_add_u32 v161, v11, 4, s52
    v_mul_u32_u24 v162, 608, v10
    v_mad_u32_u24 v162, v11, 6, v162
    v_and_b32 v11, 1, v11
    v_mul_u32_u24 v11, 4862, v11
    v_sub_u32 v2, v162, v11
    v_add_u32 v2, 152320, v2
    v_add_u32 v162, 147456, v162
    v_add_u32 v162, v11, v162
    v_mul_u32_u24 v163, 608, v5
    v_lshl_add_u32 v163, v6, 4, v163
    v_add_u32 v163, 147456, v163
    s_lshr_b32 s52, s38, 2
    s_lshl_b32 s52, s52, 10
    s_and_b32 s53, s38, 3
    s_lshl_b32 s53, s53, 2
    s_add_u32 s52, s52, s53
    s_add_u32 s52, s52, 157184
    v_add_u32 v164, s52, v3
    v_mov_b32 v10, 0
    ds_write_b32 v164, v10
    v_add_u32 v60, 157184, v3
    v_xor_b32 v61, 0x80, v60
    v_and_b32 v10, 6, v1
    v_and_b32 v11, 9, v1
    v_lshl_add_u32 v164, v10, 7, s52
    v_lshl_add_u32 v164, v11, 1, v164
    v_and_b32 v10, 16, v1
    v_and_b32 v11, 32, v1
    v_lshl_add_u32 v164, v10, 2, v164
    v_add_u32 v164, v11, v164
    v_and_b32 v10, 1, v6
    v_mul_u32_u24 v10, 0x48, v10
    v_and_b32 v11, 1, v8
    v_add3_u32 v166, v10, v11, 2
    v_lshl_add_u32 v10, v11, 2, v10
    v_lshrrev_b32 v11, 1, v6
    v_add_u32 v165, v10, v11
    v_mul_u32_u24 v165, 10240, v165
    v_mul_u32_u24 v166, 10240, v166
    v_lshl_add_u32 v165, v7, 4, v165
    v_lshl_add_u32 v166, v7, 4, v166
    s_mul_i32 s62, s38, 61440
    s_lshl_b32 s53, s58, 7
    s_add_u32 s62, s62, s53
    s_add_u32 s62, s62, 9699328
    s_mov_b32 s63, 6553600
    s_movk_i32 s64, -1536
    v_bfe_u32 v10, v1, 1, 1
    v_bfe_u32 v11, v1, 3, 2
    v_lshl_add_u32 v11, v10, 2, v11
    v_xor_b32 v11, s38, v11
    v_mul_u32_u24 v12, s57, v10
    v_lshl_add_u32 v12, v11, 4, v12
    v_and_b32 v10, 1, v1
    v_lshl_add_u32 v12, v10, 3, v12
    v_bfe_u32 v10, v1, 2, 2
    v_lshl_add_u32 v10, v6, 3, v10
    v_lshl_add_u32 v12, v10, 7, v12
    v_add_u32 v13, 36864, v12
    v_mov_b32 v14, 161488
    v_mov_b32 v15, 1
    s_mov_b32 s52, 0x05040100
    s_mov_b32 s53, 0x07060302
    v_mov_b32 v10, s52
    v_mov_b32 v4, 0x05040c0c
    v_mov_b32 v5, 0x01000c0c
    v_mov_b32 v6, 0x44444444
    s_mov_b32 exec_lo, 0xff00ff00
    s_mov_b32 exec_hi, 0xff00ff00
    v_mov_b32 v10, 0x03020706
    v_mov_b32 v4, 0x03020c0c
    v_mov_b32 v5, 0x07060c0c
    v_mov_b32 v6, 0xeeeeeeee
    s_mov_b64 exec, -1
    s_waitcnt lgkmcnt(0)
    v_readfirstlane_b32 s39, v167
    s_cmp_eq_u32 s59, 4
    s_cbranch_scc0 F_W8
    s_waitcnt vmcnt(0)
F_W8:
    s_sub_u32 s51, s38, 3
    s_cmp_ge_u32 s51, 8
    s_cbranch_scc1 F_NC
    s_waitcnt vmcnt(8)
    s_mov_b64 exec, 0x1
    ds_add_u32 v14, v15
    s_mov_b64 exec, -1
F_NC:
    s_waitcnt vmcnt(7)
    v_mov_b32 v19, v16
    v_mov_b32_dpp v11, v17 row_ror:8 row_mask:0xf bank_mask:0xf
    v_mov_b32_dpp v16, v18 row_ror:8 row_mask:0xf bank_mask:0xc
    v_mov_b32_dpp v18, v19 row_ror:8 row_mask:0xf bank_mask:0x3
    v_perm_b32 v152, v11, v17, v10
    v_perm_b32 v136, v18, v16, s52
    v_perm_b32 v144, v18, v16, s53
    s_waitcnt vmcnt(6)
    v_mov_b32 v23, v20
    v_mov_b32_dpp v11, v21 row_ror:8 row_mask:0xf bank_mask:0xf
    v_mov_b32_dpp v20, v22 row_ror:8 row_mask:0xf bank_mask:0xc
    v_mov_b32_dpp v22, v23 row_ror:8 row_mask:0xf bank_mask:0x3
    v_perm_b32 v153, v11, v21, v10
    v_perm_b32 v137, v22, v20, s52
    v_perm_b32 v145, v22, v20, s53
    s_waitcnt vmcnt(5)
    v_mov_b32 v27, v24
    v_mov_b32_dpp v11, v25 row_ror:8 row_mask:0xf bank_mask:0xf
    v_mov_b32_dpp v24, v26 row_ror:8 row_mask:0xf bank_mask:0xc
    v_mov_b32_dpp v26, v27 row_ror:8 row_mask:0xf bank_mask:0x3
    v_perm_b32 v154, v11, v25, v10
    v_perm_b32 v138, v26, v24, s52
    v_perm_b32 v146, v26, v24, s53
    s_waitcnt vmcnt(4)
    v_mov_b32 v31, v28
    v_mov_b32_dpp v11, v29 row_ror:8 row_mask:0xf bank_mask:0xf
    v_mov_b32_dpp v28, v30 row_ror:8 row_mask:0xf bank_mask:0xc
    v_mov_b32_dpp v30, v31 row_ror:8 row_mask:0xf bank_mask:0x3
    v_perm_b32 v155, v11, v29, v10
    v_perm_b32 v139, v30, v28, s52
    v_perm_b32 v147, v30, v28, s53
    s_waitcnt vmcnt(3)
    v_mov_b32 v35, v32
    v_mov_b32_dpp v11, v33 row_ror:8 row_mask:0xf bank_mask:0xf
    v_mov_b32_dpp v32, v34 row_ror:8 row_mask:0xf bank_mask:0xc
    v_mov_b32_dpp v34, v35 row_ror:8 row_mask:0xf bank_mask:0x3
    v_perm_b32 v156, v11, v33, v10
    v_perm_b32 v140, v34, v32, s52
    v_perm_b32 v148, v34, v32, s53
    s_waitcnt vmcnt(2)
    v_mov_b32 v39, v36
    v_mov_b32_dpp v11, v37 row_ror:8 row_mask:0xf bank_mask:0xf
    v_mov_b32_dpp v36, v38 row_ror:8 row_mask:0xf bank_mask:0xc
    v_mov_b32_dpp v38, v39 row_ror:8 row_mask:0xf bank_mask:0x3
    v_perm_b32 v157, v11, v37, v10
    v_perm_b32 v141, v38, v36, s52
    v_perm_b32 v149, v38, v36, s53
    s_waitcnt vmcnt(1)
    v_mov_b32 v43, v40
    v_mov_b32_dpp v11, v41 row_ror:8 row_mask:0xf bank_mask:0xf
    v_mov_b32_dpp v40, v42 row_ror:8 row_mask:0xf bank_mask:0xc
    v_mov_b32_dpp v42, v43 row_ror:8 row_mask:0xf bank_mask:0x3
    v_perm_b32 v158, v11, v41, v10
    v_perm_b32 v142, v42, v40, s52
    v_perm_b32 v150, v42, v40, s53
    s_waitcnt vmcnt(0)
    v_mov_b32 v47, v44
    v_mov_b32_dpp v11, v45 row_ror:8 row_mask:0xf bank_mask:0xf
    v_mov_b32_dpp v44, v46 row_ror:8 row_mask:0xf bank_mask:0xc
    v_mov_b32_dpp v46, v47 row_ror:8 row_mask:0xf bank_mask:0x3
    v_perm_b32 v159, v11, v45, v10
    v_perm_b32 v143, v46, v44, s52
    v_perm_b32 v151, v46, v44, s53
    s_cmp_ge_u32 s38, s59
    s_cbranch_scc1 F_NT
    s_movk_i32 s60, 4000
F_CP:
    ds_read_b32 v15, v14
    s_sub_u32 s60, s60, 1
    s_cmp_gt_i32 s60, 0
    s_waitcnt lgkmcnt(0)
    v_readfirstlane_b32 s52, v15
    s_nop 0
    s_cselect_b32 s52, s52, 8
    s_cmp_eq_u32 s52, 8
    s_cbranch_scc1 F_CD
    s_sleep 2
    s_branch F_CP
F_CD:
    ds_read_b64_tr_b16 v[64:65], v12 offset:0
    ds_read_b64_tr_b16 v[66:67], v12 offset:512
    ds_read_b64_tr_b16 v[68:69], v12 offset:4096
    ds_read_b64_tr_b16 v[70:71], v12 offset:4608
    ds_read_b64_tr_b16 v[72:73], v12 offset:8192
    ds_read_b64_tr_b16 v[74:75], v12 offset:8704
    ds_read_b64_tr_b16 v[76:77], v12 offset:12288
    ds_read_b64_tr_b16 v[78:79], v12 offset:12800
    ds_read_b64_tr_b16 v[80:81], v12 offset:16384
    ds_read_b64_tr_b16 v[82:83], v12 offset:16896
    ds_read_b64_tr_b16 v[84:85], v12 offset:20480
    ds_read_b64_tr_b16 v[86:87], v12 offset:20992
    ds_read_b64_tr_b16 v[88:89], v12 offset:24576
    ds_read_b64_tr_b16 v[90:91], v12 offset:25088
    ds_read_b64_tr_b16 v[92:93], v12 offset:28672
    ds_read_b64_tr_b16 v[94:95], v12 offset:29184
    ds_read_b64_tr_b16 v[96:97], v12 offset:32768
    ds_read_b64_tr_b16 v[98:99], v12 offset:33280
    ds_read_b64_tr_b16 v[100:101], v13 offset:0
    ds_read_b64_tr_b16 v[102:103], v13 offset:512
    ds_read_b64_tr_b16 v[104:105], v13 offset:4096
    ds_read_b64_tr_b16 v[106:107], v13 offset:4608
    ds_read_b64_tr_b16 v[108:109], v13 offset:8192
    ds_read_b64_tr_b16 v[110:111], v13 offset:8704
    ds_read_b64_tr_b16 v[112:113], v13 offset:12288
    ds_read_b64_tr_b16 v[114:115], v13 offset:12800
    ds_read_b64_tr_b16 v[116:117], v13 offset:16384
    ds_read_b64_tr_b16 v[118:119], v13 offset:16896
    ds_read_b64_tr_b16 v[120:121], v13 offset:20480
    ds_read_b64_tr_b16 v[122:123], v13 offset:20992
    ds_read_b64_tr_b16 v[124:125], v13 offset:24576
    ds_read_b64_tr_b16 v[126:127], v13 offset:25088
    ds_read_b64_tr_b16 v[128:129], v13 offset:28672
    ds_read_b64_tr_b16 v[130:131], v13 offset:29184
    ds_read_b64_tr_b16 v[132:133], v13 offset:32768
    ds_read_b64_tr_b16 v[134:135], v13 offset:33280
    s_waitcnt lgkmcnt(0)
    v_mov_b32 v12, 0
    v_mov_b32 v13, 0
    v_mov_b32 v14, 0
    v_mov_b32 v15, 0
F_NT:
    s_cmp_lg_u32 s38, 11
    s_cbranch_scc1 F_SEL
    s_branch T_EV
FINAL:
    s_cmp_ge_u32 s2, 144
    s_cbranch_scc1 END
    s_cmp_lg_u32 s38, 11
    s_cbranch_scc1 END
    s_branch T_EV
TOP8:
    s_mov_b32 s65, 32768
    s_mov_b32 s66, 36864
    s_waitcnt lgkmcnt(0)
    buffer_load_dwordx4 v[16:19], v3, s[40:43], s65 offen offset:0 sc1
    buffer_load_dwordx4 v[20:23], v3, s[40:43], s65 offen offset:1024 sc1
    buffer_load_dwordx4 v[24:27], v3, s[40:43], s65 offen offset:2048 sc1
    buffer_load_dwordx4 v[28:31], v3, s[40:43], s65 offen offset:3072 sc1
    buffer_load_dwordx4 v[32:35], v3, s[40:43], s66 offen offset:0 sc1
    buffer_load_dwordx4 v[36:39], v3, s[40:43], s66 offen offset:1024 sc1
    buffer_load_dwordx4 v[40:43], v3, s[40:43], s66 offen offset:2048 sc1
    buffer_load_dwordx4 v[44:47], v3, s[40:43], s66 offen offset:3072 sc1
T_EV:
    v_bfe_i32 v7, v1, 0, 1
    v_bfe_i32 v8, v1, 1, 1
    v_bfe_i32 v9, v1, 3, 1
    v_bfe_i32 v11, v1, 4, 1
    v_bfe_i32 v13, v1, 5, 1
    v_xor_b32 v48, v7, v8
    v_xor_b32 v49, v8, v9
    v_xor_b32 v50, v7, v9
    v_xor_b32 v11, v11, v13
    v_xor_b32 v51, v9, v11
    v_xor_b32 v52, v8, v11
    v_xor_b32 v53, v7, v11
    v_mov_b32 v63, 161492
    v_lshl_add_u32 v13, v1, 2, v63
    v_add_u32 v13, 428, v13
    v_sub_u32 v54, 148464, v3
    v_and_b32 v7, 4, v1
    v_and_b32 v8, 48, v1
    v_lshlrev_b32 v8, 6, v8
    v_lshl_add_u32 v55, v7, 1, v8
    v_add_u32 v55, 147456, v55
    s_mov_b32 s65, 32768
    s_mov_b32 s66, 36864
    s_and_b32 s67, s2, 127
    s_lshl_b32 s68, s67, 6
    s_add_u32 s68, s68, 32768
    v_mov_b32 v10, 0
    s_cmp_lt_u32 s2, 128
    s_cbranch_scc0 T_E2
    s_movk_i32 s60, 4000
    s_mov_b64 exec, 0x1
    s_waitcnt vmcnt(8)
    buffer_store_dword v167, v10, s[40:43], s50 offen sc1
    s_mov_b64 exec, -1
    s_waitcnt vmcnt(1)
    s_branch T_KP_C
T_E2:
    v_mov_b32 v16, -1
    v_mov_b32 v17, -1
    v_mov_b32 v18, -1
    v_mov_b32 v19, -1
    v_mov_b32 v20, -1
    v_mov_b32 v21, -1
    v_mov_b32 v22, -1
    v_mov_b32 v23, -1
    v_mov_b32 v24, -1
    v_mov_b32 v25, -1
    v_mov_b32 v26, -1
    v_mov_b32 v27, -1
    v_mov_b32 v28, -1
    v_mov_b32 v29, -1
    v_mov_b32 v30, -1
    v_mov_b32 v31, -1
    v_mov_b32 v32, -1
    v_mov_b32 v33, -1
    v_mov_b32 v34, -1
    v_mov_b32 v35, -1
    v_mov_b32 v36, -1
    v_mov_b32 v37, -1
    v_mov_b32 v38, -1
    v_mov_b32 v39, -1
    v_mov_b32 v40, -1
    v_mov_b32 v41, -1
    v_mov_b32 v42, -1
    v_mov_b32 v43, -1
    v_mov_b32 v44, -1
    v_mov_b32 v45, -1
    v_mov_b32 v46, -1
    v_mov_b32 v47, -1
    s_mul_i32 s67, s67, 24576
    s_add_u32 s67, s67, 3230092
    s_mov_b64 exec, 0xf
    s_movk_i32 s60, 4000
T_EP:
    buffer_load_dword v11, v3, s[40:43], s67 offen sc1
T_EP_W:
    s_waitcnt vmcnt(0)
T_EP_C:
    v_cmp_ne_u32 vcc, s39, v11
    s_nop 0
    s_and_b64 exec, exec, vcc
    s_cbranch_execz T_EP_D
    s_sub_u32 s60, s60, 1
    s_cmp_gt_i32 s60, 0
    s_sleep 2
    s_cbranch_scc1 T_EP
T_EP_D:
T_H:
    s_mov_b64 exec, 0x1
    s_movk_i32 s60, 4000
T_HP:
    buffer_load_dword v11, v10, s[40:43], s68 offen sc1
T_HP_W:
    s_waitcnt vmcnt(0)
T_HP_C:
    v_cmp_eq_u32 vcc, -1, v11
    s_nop 0
    s_and_b64 exec, exec, vcc
    s_cbranch_execz T_HP_D
    s_sub_u32 s60, s60, 1
    s_cmp_gt_i32 s60, 0
    s_sleep 1
    s_cbranch_scc1 T_HP
T_HP_D:
    s_mov_b64 exec, -1
    s_cmp_ge_u32 s2, 144
    s_cbranch_scc0 T_KQ
    s_movk_i32 s60, 4000
T_KN:
    buffer_load_dwordx4 v[16:19], v3, s[40:43], s65 offen offset:0 sc1
    buffer_load_dwordx4 v[20:23], v3, s[40:43], s65 offen offset:1024 sc1
    buffer_load_dwordx4 v[24:27], v3, s[40:43], s65 offen offset:2048 sc1
    buffer_load_dwordx4 v[28:31], v3, s[40:43], s65 offen offset:3072 sc1
    buffer_load_dwordx4 v[32:35], v3, s[40:43], s66 offen offset:0 sc1
    buffer_load_dwordx4 v[36:39], v3, s[40:43], s66 offen offset:1024 sc1
    buffer_load_dwordx4 v[40:43], v3, s[40:43], s66 offen offset:2048 sc1
    buffer_load_dwordx4 v[44:47], v3, s[40:43], s66 offen offset:3072 sc1
    s_waitcnt vmcnt(16)
    s_sub_u32 s60, s60, 1
    v_max3_u32 v56, v16, v17, v18
    v_max3_u32 v58, v19, v20, v21
    v_max3_u32 v57, v32, v33, v34
    v_max3_u32 v59, v35, v36, v37
    v_max3_u32 v56, v56, v22, v23
    v_max3_u32 v58, v58, v24, v25
    v_max3_u32 v57, v57, v38, v39
    v_max3_u32 v59, v59, v40, v41
    v_max3_u32 v56, v56, v26, v27
    v_max3_u32 v58, v58, v28, v29
    v_max3_u32 v57, v57, v42, v43
    v_max3_u32 v59, v59, v44, v45
    v_max3_u32 v58, v58, v30, v31
    v_max3_u32 v59, v59, v46, v47
    v_max_u32 v56, v56, v58
    v_max_u32 v57, v57, v59
    v_max_u32 v58, v56, v57
    v_cmp_eq_u32 vcc, -1, v58
    s_nop 0
    s_and_b64 exec, exec, vcc
    s_cselect_b32 s60, s60, 0
    s_cmp_gt_i32 s60, 0
    s_cbranch_scc1 T_KN
    s_branch T_KP_D
T_KQ:
    s_movk_i32 s60, 4000
T_KP:
    buffer_load_dwordx4 v[16:19], v3, s[40:43], s65 offen offset:0 sc1
    buffer_load_dwordx4 v[20:23], v3, s[40:43], s65 offen offset:1024 sc1
    buffer_load_dwordx4 v[24:27], v3, s[40:43], s65 offen offset:2048 sc1
    buffer_load_dwordx4 v[28:31], v3, s[40:43], s65 offen offset:3072 sc1
    buffer_load_dwordx4 v[32:35], v3, s[40:43], s66 offen offset:0 sc1
    buffer_load_dwordx4 v[36:39], v3, s[40:43], s66 offen offset:1024 sc1
    buffer_load_dwordx4 v[40:43], v3, s[40:43], s66 offen offset:2048 sc1
    buffer_load_dwordx4 v[44:47], v3, s[40:43], s66 offen offset:3072 sc1
T_KP_W:
    s_waitcnt vmcnt(0)
T_KP_C:
    v_max3_u32 v56, v16, v17, v18
    v_max3_u32 v58, v19, v20, v21
    v_max3_u32 v57, v32, v33, v34
    v_max3_u32 v59, v35, v36, v37
    v_max3_u32 v56, v56, v22, v23
    v_max3_u32 v58, v58, v24, v25
    v_max3_u32 v57, v57, v38, v39
    v_max3_u32 v59, v59, v40, v41
    v_max3_u32 v56, v56, v26, v27
    v_max3_u32 v58, v58, v28, v29
    v_max3_u32 v57, v57, v42, v43
    v_max3_u32 v59, v59, v44, v45
    v_max3_u32 v58, v58, v30, v31
    v_max3_u32 v59, v59, v46, v47
    v_max_u32 v56, v56, v58
    v_max_u32 v57, v57, v59
    v_max_u32 v58, v56, v57
    v_cmp_eq_u32 vcc, -1, v58
    s_nop 0
    s_and_b64 exec, exec, vcc
    s_cbranch_execz T_KP_D
    s_sub_u32 s60, s60, 1
    s_cmp_gt_i32 s60, 0
    s_cbranch_scc1 T_KP
T_KP_D:
    s_mov_b64 exec, -1
    v_mov_b32_dpp v58, v56 quad_perm:[1,0,3,2] row_mask:0xf bank_mask:0xf
    v_mov_b32_dpp v59, v57 quad_perm:[1,0,3,2] row_mask:0xf bank_mask:0xf
    v_med3_u32 v56, v56, v58, v48
    v_med3_u32 v57, v57, v59, v48
    ds_write_b128 v54, v[16:19] offset:7168
    v_mov_b32_dpp v58, v56 quad_perm:[2,3,0,1] row_mask:0xf bank_mask:0xf
    v_mov_b32_dpp v59, v57 quad_perm:[2,3,0,1] row_mask:0xf bank_mask:0xf
    v_med3_u32 v56, v56, v58, v49
    v_med3_u32 v57, v57, v59, v49
    ds_write_b128 v54, v[20:23] offset:6144
    v_mov_b32_dpp v58, v56 quad_perm:[1,0,3,2] row_mask:0xf bank_mask:0xf
    v_mov_b32_dpp v59, v57 quad_perm:[1,0,3,2] row_mask:0xf bank_mask:0xf
    v_med3_u32 v56, v56, v58, v50
    v_med3_u32 v57, v57, v59, v50
    ds_write_b128 v54, v[24:27] offset:5120
    v_mov_b32_dpp v58, v56 row_ror:8 row_mask:0xf bank_mask:0xf
    v_mov_b32_dpp v59, v57 row_ror:8 row_mask:0xf bank_mask:0xf
    v_med3_u32 v56, v56, v58, v51
    v_med3_u32 v57, v57, v59, v51
    ds_write_b128 v54, v[28:31] offset:4096
    v_mov_b32_dpp v58, v56 quad_perm:[2,3,0,1] row_mask:0xf bank_mask:0xf
    v_mov_b32_dpp v59, v57 quad_perm:[2,3,0,1] row_mask:0xf bank_mask:0xf
    v_med3_u32 v56, v56, v58, v52
    v_med3_u32 v57, v57, v59, v52
    ds_write_b128 v54, v[32:35] offset:3072
    v_mov_b32_dpp v58, v56 quad_perm:[1,0,3,2] row_mask:0xf bank_mask:0xf
    v_mov_b32_dpp v59, v57 quad_perm:[1,0,3,2] row_mask:0xf bank_mask:0xf
    v_med3_u32 v56, v56, v58, v53
    v_med3_u32 v57, v57, v59, v53
    ds_write_b128 v54, v[36:39] offset:2048
    s_nop 0
    v_max_u32_dpp v56, v57, v56 row_mirror row_mask:0xf bank_mask:0xf
    ds_write_b128 v54, v[40:43] offset:1024
    s_nop 0
    v_mov_b32_dpp v58, v56 row_ror:8 row_mask:0xf bank_mask:0xf
    v_med3_u32 v56, v56, v58, v51
    ds_write_b128 v54, v[44:47] offset:0
    s_nop 0
    v_mov_b32_dpp v58, v56 quad_perm:[2,3,0,1] row_mask:0xf bank_mask:0xf
    v_med3_u32 v56, v56, v58, v52
    s_nop 1
    v_mov_b32_dpp v58, v56 quad_perm:[1,0,3,2] row_mask:0xf bank_mask:0xf
    v_med3_u32 v56, v56, v58, v53
    s_nop 1
    v_max_u32_dpp v56, v56, v56 row_mirror row_mask:0xf bank_mask:0xf
    s_nop 1
    v_mov_b32_dpp v58, v56 row_ror:8 row_mask:0xf bank_mask:0xf
    v_med3_u32 v56, v56, v58, v51
    s_nop 1
    v_mov_b32_dpp v58, v56 quad_perm:[2,3,0,1] row_mask:0xf bank_mask:0xf
    v_med3_u32 v56, v56, v58, v52
    s_nop 1
    v_mov_b32_dpp v58, v56 quad_perm:[1,0,3,2] row_mask:0xf bank_mask:0xf
    v_med3_u32 v57, v56, v58, v53
    v_med3_u32 v56, v56, v58, v53
    s_nop 1
    v_permlane16_swap_b32 v56, v57
    v_max_u32 v56, v56, v57
    s_nop 1
    v_mov_b32_dpp v58, v56 row_ror:8 row_mask:0xf bank_mask:0xf
    v_med3_u32 v56, v56, v58, v51
    s_nop 1
    v_mov_b32_dpp v58, v56 quad_perm:[2,3,0,1] row_mask:0xf bank_mask:0xf
    v_med3_u32 v56, v56, v58, v52
    s_nop 1
    v_mov_b32_dpp v58, v56 quad_perm:[1,0,3,2] row_mask:0xf bank_mask:0xf
    v_med3_u32 v57, v56, v58, v53
    v_med3_u32 v56, v56, v58, v53
    s_nop 1
    v_permlane32_swap_b32 v56, v57
    v_max_u32 v56, v56, v57
    ds_write_b32 v13, v56
    s_cmp_lt_u32 s2, 144
    v_and_b32 v58, 0x4fc, v56
    v_lshl_or_b32 v58, v58, 2, v55
    v_mov_b32 v62, v56
    ds_read_b64 v[56:57], v58
    s_cbranch_scc1 T_V
    s_waitcnt lgkmcnt(0)
    s_barrier
    ds_read_b32 v7, v160
    s_waitcnt lgkmcnt(0)
    v_and_b32 v7, 0x7ff, v7
    v_mad_i32_i24 v7, v7, s64, v161
    buffer_load_dwordx4 v[8:11], v7, s[40:43], s63 offen sc1
T_V:
    v_min_u32_dpp v58, v62, v62 quad_perm:[1,0,3,2] row_mask:0xf bank_mask:0xf
    s_nop 1
    v_min_u32_dpp v58, v58, v58 quad_perm:[2,3,0,1] row_mask:0xf bank_mask:0xf
    s_nop 1
    v_min_u32_dpp v58, v58, v58 row_ror:8 row_mask:0xf bank_mask:0xf
    s_waitcnt lgkmcnt(0)
    v_cmp_ge_u32 vcc, v56, v58
    v_cmp_ge_u32 s[52:53], v57, v58
    s_bcnt1_i32_b64 s54, vcc
    s_bcnt1_i32_b64 s52, s[52:53]
    s_add_u32 s52, s52, s54
    s_cmp_eq_u32 s52, 8
    s_cbranch_scc0 T_M
T_OK:
    s_movk_i32 s60, 4000
    s_cmp_lt_u32 s2, 144
    s_cbranch_scc1 FIN
    s_setprio 0
    s_branch F_ZP_W
T_M:
    v_cmp_ne_u32 s[56:57], v62, v56
    v_cmp_ne_u32 s[74:75], v62, v57
    s_nop 0
    v_cndmask_b32 v56, 0, v56, s[56:57]
    v_cndmask_b32 v57, 0, v57, s[74:75]
    s_mov_b64 s[72:73], -1
T_L:
    v_max_u32 v59, v56, v57
    v_cmp_gt_u32 vcc, v59, v58
    s_nop 4
    s_cbranch_vccz T_X
    s_ff1_i32_b64 s52, vcc
    v_cmp_eq_u32 vcc, v62, v58
    v_readlane_b32 s53, v59, s52
    s_ff1_i32_b64 s54, vcc
    s_cmp_lt_u32 s2, 144
    s_cbranch_scc1 T_L2
    s_and_b32 s55, s53, 0x7ff
    s_mul_i32 s55, s55, s64
    s_add_u32 s55, s55, 9697792
    buffer_load_dwordx4 v[64:67], v3, s[40:43], s55 offen sc1
    buffer_load_dwordx4 v[68:71], v3, s[40:43], s55 offen offset:1024 sc1
T_L2:
    v_mov_b32 v59, s53
    v_cndmask_b32 v62, v62, v59, vcc
    v_cmp_ne_u32 s[56:57], s53, v56
    v_cmp_ne_u32 s[74:75], s53, v57
    s_nop 0
    v_cndmask_b32 v56, 0, v56, s[56:57]
    v_cndmask_b32 v57, 0, v57, s[74:75]
    v_min_u32_dpp v58, v62, v62 quad_perm:[1,0,3,2] row_mask:0xf bank_mask:0xf
    s_nop 1
    v_min_u32_dpp v58, v58, v58 quad_perm:[2,3,0,1] row_mask:0xf bank_mask:0xf
    s_nop 1
    v_min_u32_dpp v58, v58, v58 row_ror:8 row_mask:0xf bank_mask:0xf
    s_cmp_lt_u32 s2, 144
    s_cbranch_scc1 T_L
    s_lshr_b32 s52, s54, 1
    s_and_b32 s52, s52, 4
    s_and_b32 s54, s54, 3
    s_add_u32 s54, s54, s52
    s_mul_i32 s54, s54, 608
    s_add_u32 s54, s54, 147456
    v_and_b32 v72, 1, v1
    v_mul_u32_u24 v72, 4862, v72
    v_mul_u32_u24 v73, 6, v1
    v_sub_u32 v74, v73, v72
    v_add_u32 v73, v73, v72
    v_add_u32 v75, s54, v73
    v_add_u32 v76, s54, v74
    s_mov_b64 exec, s[72:73]
    s_movk_i32 s60, 4000
    s_branch T_Z_W
T_Z:
    buffer_load_dwordx4 v[8:11], v7, s[40:43], s63 offen sc1
T_Z_W:
    s_waitcnt vmcnt(0)
T_Z_C:
    v_cmp_ne_u32 vcc, s39, v11
    s_nop 0
    s_and_b64 exec, exec, vcc
    s_cbranch_execz T_Z_D
    s_wqm_b64 exec, exec
    s_sub_u32 s60, s60, 1
    s_cmp_gt_i32 s60, 0
    s_cbranch_scc1 T_Z
T_Z_D:
    s_mov_b64 exec, s[72:73]
    ds_write2_b32 v162, v8, v10 offset0:0 offset1:1
    ds_write_b32 v2, v9
    s_mov_b64 s[72:73], 0
    s_mov_b64 exec, -1
    s_movk_i32 s60, 4000
    s_branch T_F_W
T_F:
    buffer_load_dwordx4 v[64:67], v3, s[40:43], s55 offen sc1
    buffer_load_dwordx4 v[68:71], v3, s[40:43], s55 offen offset:1024 sc1
T_F_W:
    s_waitcnt vmcnt(0)
T_F_C:
    v_cmp_ne_u32 vcc, s39, v67
    v_cmp_ne_u32 s[56:57], s39, v71
    s_nop 0
    s_or_b32 vcc_lo, vcc_lo, s56
    s_and_b64 exec, exec, vcc
    s_cbranch_execz T_F_D
    s_wqm_b64 exec, exec
    s_sub_u32 s60, s60, 1
    s_cmp_gt_i32 s60, 0
    s_cbranch_scc1 T_F
T_F_D:
    s_mov_b64 exec, -1
    s_movk_i32 s60, 4000
T_C:
    ds_read_b32 v72, v63 offset:0
    s_sub_u32 s60, s60, 1
    s_cmp_gt_i32 s60, 0
    s_waitcnt lgkmcnt(0)
    v_readfirstlane_b32 s52, v72
    s_nop 0
    s_cselect_b32 s52, s52, 11
    s_cmp_lg_u32 s52, 11
    s_cbranch_scc1 T_C
    ds_write2_b32 v75, v64, v66 offset0:0 offset1:1
    ds_write_b32 v76, v65 offset:4864
    s_mov_b32 exec_hi, 0
    ds_write2_b32 v75, v68, v70 offset0:96 offset1:97
    ds_write_b32 v76, v69 offset:5248
    s_mov_b64 exec, -1
    s_branch T_L
T_X:
    s_movk_i32 s60, 4000
    s_cmp_lt_u32 s2, 144
    s_cbranch_scc1 FIN
    s_setprio 0
    s_branch F_BQ
F_SEL:
    s_setprio 0
    s_waitcnt lgkmcnt(0)
    s_barrier
    ds_read_b32 v7, v160
    s_waitcnt lgkmcnt(0)
    v_and_b32 v7, 0x7ff, v7
    v_mad_i32_i24 v7, v7, s64, v161
    s_movk_i32 s60, 4000
F_ZP:
    buffer_load_dwordx4 v[8:11], v7, s[40:43], s63 offen sc1
F_ZP_W:
    s_waitcnt vmcnt(0)
F_ZP_C:
    v_cmp_ne_u32 vcc, s39, v11
    s_nop 0
    s_and_b64 exec, exec, vcc
    s_cbranch_execz F_ZP_D
    s_wqm_b64 exec, exec
    s_sub_u32 s60, s60, 1
    s_cmp_gt_i32 s60, 0
    s_cbranch_scc1 F_ZP
F_ZP_D:
    s_mov_b64 exec, -1
    ds_write2_b32 v162, v8, v10 offset0:0 offset1:1
    ds_write_b32 v2, v9
    s_mov_b64 exec, 0x1
    ds_inc_u32 v63, v63 offset:0
    s_mov_b64 exec, -1
F_BQ:
    s_cmp_ge_u32 s38, s59
    s_waitcnt lgkmcnt(0)
    s_barrier
    s_cbranch_scc1 F_H
    ds_read_b128 v[16:19], v163 offset:0
    ds_read_b128 v[20:23], v163 offset:64
    ds_read_b128 v[24:27], v163 offset:128
    ds_read_b128 v[28:31], v163 offset:192
    ds_read_b128 v[32:35], v163 offset:256
    ds_read_b128 v[36:39], v163 offset:320
    ds_read_b128 v[40:43], v163 offset:384
    ds_read_b128 v[44:47], v163 offset:448
    ds_read_b128 v[48:51], v163 offset:512
    s_waitcnt lgkmcnt(8)
    v_smfmac_f32_16x16x64_bf16 v[12:15], v[16:19], v[64:71], v6
    s_waitcnt lgkmcnt(7)
    v_smfmac_f32_16x16x64_bf16 v[12:15], v[20:23], v[72:79], v6
    s_waitcnt lgkmcnt(6)
    v_smfmac_f32_16x16x64_bf16 v[12:15], v[24:27], v[80:87], v6
    s_waitcnt lgkmcnt(5)
    v_smfmac_f32_16x16x64_bf16 v[12:15], v[28:31], v[88:95], v6
    s_waitcnt lgkmcnt(4)
    v_smfmac_f32_16x16x64_bf16 v[12:15], v[32:35], v[96:103], v6
    s_waitcnt lgkmcnt(3)
    v_smfmac_f32_16x16x64_bf16 v[12:15], v[36:39], v[104:111], v6
    s_waitcnt lgkmcnt(2)
    v_smfmac_f32_16x16x64_bf16 v[12:15], v[40:43], v[112:119], v6
    s_waitcnt lgkmcnt(1)
    v_smfmac_f32_16x16x64_bf16 v[12:15], v[44:47], v[120:127], v6
    s_waitcnt lgkmcnt(0)
    v_smfmac_f32_16x16x64_bf16 v[12:15], v[48:51], v[128:135], v6
    s_nop 7
    v_permlane32_swap_b32 v12, v14
    v_permlane32_swap_b32 v13, v15
    v_add_f32 v12, v12, v14
    v_add_f32 v13, v13, v15
    v_cvt_pk_bf16_f32 v12, v12, v13
    s_nop 1
    v_mov_b32_dpp v13, v12 row_ror:8 row_mask:0xf bank_mask:0xf
    v_perm_b32 v8, v12, v13, v4
    v_mul_f32 v10, 0xbfb8aa3b, v8
    v_exp_f32 v10, v10
    v_perm_b32 v9, v12, v13, v5
    v_add_f32 v10, 1.0, v10
    v_rcp_f32 v10, v10
    s_nop 0
    v_mul_f32 v8, v8, v10
    v_cvt_pk_bf16_f32 v8, v8, v8
    v_lshlrev_b32 v8, 16, v8
    v_mul_f32 v8, v8, v9
    v_cvt_pk_bf16_f32 v8, v8, v8
    ds_write_b16 v164, v8
F_H:
    s_waitcnt lgkmcnt(0)
    s_barrier
    ds_read_b128 v[16:19], v60
    ds_read_b128 v[20:23], v60 offset:1024
    ds_read_b128 v[24:27], v61
    ds_read_b128 v[28:31], v61 offset:1024
    s_waitcnt lgkmcnt(3)
    v_mfma_f32_16x16x32_bf16 v[12:15], v[16:19], v[152:155], 0
    v_mfma_f32_16x16x32_bf16 v[8:11], v[16:19], v[136:139], 0
    s_waitcnt lgkmcnt(2)
    v_mfma_f32_16x16x32_bf16 v[12:15], v[20:23], v[156:159], v[12:15]
    v_mfma_f32_16x16x32_bf16 v[8:11], v[20:23], v[140:143], v[8:11]
    s_waitcnt lgkmcnt(1)
    v_mfma_f32_16x16x32_bf16 v[8:11], v[24:27], v[144:147], v[8:11]
    s_waitcnt lgkmcnt(0)
    v_mfma_f32_16x16x32_bf16 v[8:11], v[28:31], v[148:151], v[8:11]
    s_mov_b32 exec_hi, 0
    s_nop 1
    buffer_store_dwordx4 v[12:15], v166, s[40:43], s62 offen sc1
    s_mov_b64 exec, -1
    s_nop 2
    buffer_store_dwordx4 v[8:11], v165, s[40:43], s62 offen sc1
    s_branch END
FIN:
    s_cmp_ge_u32 s2, 72
    s_cselect_b32 s44, 32, 0
    s_cselect_b32 s45, 72, 0
    s_sub_u32 s45, s2, s45
    s_mul_i32 s46, s45, 43
    s_lshr_b32 s46, s46, 8
    s_mul_i32 s47, s46, 6
    s_sub_u32 s47, s45, s47
    v_lshrrev_b32 v6, 4, v1
    s_mul_i32 s55, s2, 10240
    s_add_u32 s55, s55, 9699328
    v_mov_b32 v15, 0
    s_mov_b64 exec, 0x1
    buffer_load_dword v14, v15, s[40:43], s55 offen sc1
    s_mov_b64 exec, -1
    v_lshl_add_u32 v7, v6, 2, s44
    ds_bpermute_b32 v7, v7, v62
    v_and_b32 v8, 7, v1
    v_and_b32 v5, 15, v1
    s_lshl_b32 s48, s47, 2
    s_add_u32 s49, s48, 1024 - 16
    s_cmp_eq_u32 s47, 3
    s_cselect_b32 s49, 1024 + 8, s49
    s_cmp_lt_u32 s47, 3
    s_cselect_b32 s48, s48, s49
    s_lshl_b32 s49, s46, 11
    s_add_u32 s48, s48, s49
    s_add_u32 s48, s48, 3211264
    s_lshl_b32 s47, s47, 1
    s_lshl_b32 s49, s46, 7
    s_add_u32 s49, s49, s47
    s_add_u32 s49, s49, 6553600
    s_mul_i32 s46, s46, 96
    s_add_u32 s46, s46, s47
    s_movk_i32 s47, 8192
    s_mul_i32 s52, s2, 10240
    s_add_u32 s52, s52, 9699328
    s_add_u32 s53, s52, 4096
    s_add_u32 s54, s52, 8192
    v_mov_b32 v60, 0
    v_mov_b32 v61, 0
    v_mov_b32 v62, 0
    s_waitcnt lgkmcnt(0)
    v_and_b32 v9, 0x7ff, v7
    v_sub_u32 v9, 0x7ff, v9
    v_lshrrev_b32 v10, 4, v9
    v_lshlrev_b32 v11, 6, v10
    v_min_u32 v5, 11, v5
    v_lshl_add_u32 v11, v5, 2, v11
    v_mul_u32_u24 v12, 0x480, v9
    v_mad_u32_u24 v12, v8, 12, v12
    v_add_u32 v12, s46, v12
    v_mul_u32_u24 v10, 24576, v10
    v_lshl_add_u32 v10, v8, 7, v10
    v_and_b32 v13, 14, v9
    v_lshl_add_u32 v10, v13, 3, v10
    v_and_b32 v13, 1, v9
    v_lshl_add_u32 v10, v13, 1, v10
    v_mul_u32_u24 v9, 0x600, v9
    v_lshl_add_u32 v9, v8, 4, v9
    global_load_short_d16_hi v60, v12, s[4:5]
    buffer_load_short_d16_hi v61, v10, s[40:43], s48 offen sc1
    v_ashrrev_i32 v13, 31, v7
    v_not_b32 v13, v13
    v_or_b32 v13, 0x80000000, v13
    v_xor_b32 v7, v7, v13
    v_and_b32 v7, 0xffff0000, v7
    v_mul_f32 v7, 0xbfb8aa3b, v7
    v_exp_f32 v7, v7
    s_nop 0
    v_add_f32 v7, 1.0, v7
    v_rcp_f32 v7, v7
    s_nop 0
    v_cvt_pk_bf16_f32 v7, v7, v7
    v_lshlrev_b32 v7, 16, v7
    s_mov_b64 exec, 0x1
    s_movk_i32 s60, 4000
    s_waitcnt vmcnt(2)
    s_branch FN_HP_C
    s_movk_i32 s60, 4000
FN_HP:
    buffer_load_dword v14, v15, s[40:43], s55 offen sc1
FN_HP_W:
    s_waitcnt vmcnt(0)
FN_HP_C:
    v_cmp_eq_u32 vcc, -1, v14
    s_nop 0
    s_and_b64 exec, exec, vcc
    s_cbranch_execz FN_HP_D
    s_sub_u32 s60, s60, 1
    s_cmp_gt_i32 s60, 0
    s_cbranch_scc1 FN_HP
FN_HP_D:
    s_mov_b64 exec, -1
    buffer_load_dword v13, v11, s[40:43], s47 offen sc1
    buffer_load_short_d16_hi v62, v9, s[40:43], s49 offen sc1
    buffer_load_dwordx4 v[16:19], v3, s[40:43], s52 offen offset:0 sc1
    buffer_load_dwordx4 v[20:23], v3, s[40:43], s52 offen offset:1024 sc1
    buffer_load_dwordx4 v[24:27], v3, s[40:43], s52 offen offset:2048 sc1
    buffer_load_dwordx4 v[28:31], v3, s[40:43], s52 offen offset:3072 sc1
    buffer_load_dwordx4 v[32:35], v3, s[40:43], s53 offen offset:0 sc1
    buffer_load_dwordx4 v[36:39], v3, s[40:43], s53 offen offset:1024 sc1
    buffer_load_dwordx4 v[40:43], v3, s[40:43], s53 offen offset:2048 sc1
    buffer_load_dwordx4 v[44:47], v3, s[40:43], s53 offen offset:3072 sc1
    buffer_load_dwordx4 v[48:51], v3, s[40:43], s54 offen offset:0 sc1
    buffer_load_dwordx4 v[52:55], v3, s[40:43], s54 offen offset:1024 sc1
    s_waitcnt vmcnt(12)
    v_add_f32 v60, v60, v61
    v_cvt_pk_bf16_f32 v60, v60, v60
    v_lshlrev_b32 v60, 16, v60
    s_movk_i32 s60, 4000
    s_branch FN_PP_W
FN_PP:
    buffer_load_dword v13, v11, s[40:43], s47 offen sc1
    buffer_load_short_d16_hi v62, v9, s[40:43], s49 offen sc1
    buffer_load_dwordx4 v[16:19], v3, s[40:43], s52 offen offset:0 sc1
    buffer_load_dwordx4 v[20:23], v3, s[40:43], s52 offen offset:1024 sc1
    buffer_load_dwordx4 v[24:27], v3, s[40:43], s52 offen offset:2048 sc1
    buffer_load_dwordx4 v[28:31], v3, s[40:43], s52 offen offset:3072 sc1
    buffer_load_dwordx4 v[32:35], v3, s[40:43], s53 offen offset:0 sc1
    buffer_load_dwordx4 v[36:39], v3, s[40:43], s53 offen offset:1024 sc1
    buffer_load_dwordx4 v[40:43], v3, s[40:43], s53 offen offset:2048 sc1
    buffer_load_dwordx4 v[44:47], v3, s[40:43], s53 offen offset:3072 sc1
    buffer_load_dwordx4 v[48:51], v3, s[40:43], s54 offen offset:0 sc1
    buffer_load_dwordx4 v[52:55], v3, s[40:43], s54 offen offset:1024 sc1
FN_PP_W:
    s_waitcnt vmcnt(0)
FN_PP_C:
    v_cmp_ne_u32 s[56:57], s39, v13
    v_pk_add_f32 v[64:65], v[16:17], v[20:21]
    v_pk_add_f32 v[68:69], v[24:25], v[28:29]
    v_pk_add_f32 v[66:67], v[18:19], v[22:23]
    v_pk_add_f32 v[70:71], v[26:27], v[30:31]
    v_pk_add_f32 v[64:65], v[64:65], v[32:33]
    v_pk_add_f32 v[66:67], v[66:67], v[34:35]
    v_pk_add_f32 v[68:69], v[68:69], v[36:37]
    v_pk_add_f32 v[70:71], v[70:71], v[38:39]
    v_pk_add_f32 v[64:65], v[64:65], v[40:41]
    v_pk_add_f32 v[66:67], v[66:67], v[42:43]
    v_pk_add_f32 v[68:69], v[68:69], v[44:45]
    v_pk_add_f32 v[70:71], v[70:71], v[46:47]
    v_pk_add_f32 v[64:65], v[64:65], v[48:49]
    v_pk_add_f32 v[66:67], v[66:67], v[50:51]
    v_pk_add_f32 v[68:69], v[68:69], v[52:53]
    v_pk_add_f32 v[70:71], v[70:71], v[54:55]
    v_pk_add_f32 v[64:65], v[64:65], v[68:69]
    v_pk_add_f32 v[66:67], v[66:67], v[70:71]
    v_pk_add_f32 v[68:69], v[64:65], v[66:67]
    v_cmp_u_f32 vcc, v68, v69
    s_nop 0
    s_or_b64 vcc, vcc, s[56:57]
    s_and_b64 exec, exec, vcc
    s_cbranch_execz FN_PP_D
    s_sub_u32 s60, s60, 1
    s_cmp_gt_i32 s60, 0
    s_cbranch_scc1 FN_PP
FN_PP_D:
    s_mov_b64 exec, -1
    v_permlane32_swap_b32 v64, v66
    v_permlane32_swap_b32 v65, v67
    v_add_f32 v64, v64, v66
    v_add_f32 v65, v65, v67
    s_nop 1
    v_permlane16_swap_b32 v64, v65
    v_add_f32 v64, v64, v65
    s_nop 1
    v_add_f32_dpp v64, v64, v64 row_ror:8 row_mask:0xf bank_mask:0xf
    v_cvt_pk_bf16_f32 v64, v64, v64
    v_lshlrev_b32 v64, 16, v64
    v_mul_f32 v64, v64, v7
    v_cvt_pk_bf16_f32 v64, v64, v64
    v_lshlrev_b32 v64, 16, v64
    v_add_f32 v64, v64, v62
    v_cvt_pk_bf16_f32 v64, v64, v64
    v_lshlrev_b32 v64, 16, v64
    v_add_f32 v64, v64, v60
    v_cvt_pk_bf16_f32 v64, v64, v64
    s_mov_b32 exec_lo, 0xff00ff
    s_mov_b32 exec_hi, 0xff00ff
    global_store_short v12, v64, s[32:33]
    s_mov_b64 exec, -1
END:
    s_endpgm
CODE_END:
.section .rodata,"a"
.p2align 6
.amdhsa_kernel sequential_preLN__ssm_conv_s4__moe_arch_mod__prompt_kernel
  .amdhsa_next_free_vgpr 168
  .amdhsa_next_free_sgpr 102
  .amdhsa_accum_offset 168
  .amdhsa_group_segment_fixed_size 0
  .amdhsa_kernarg_size 136
  .amdhsa_user_sgpr_count 2
  .amdhsa_user_sgpr_kernarg_segment_ptr 1
  .amdhsa_system_sgpr_workgroup_id_x 1
.end_amdhsa_kernel
```

```asm
; @launch grid=(256,1,1) block=(768,1,1) lds=163840
.amdgcn_target "amdgcn-amd-amdhsa--gfx950"
    .text
    .globl sequential_preLN__ssm_conv_s4__moe_arch_mod__prompt_kernel
    .p2align 8
    .type sequential_preLN__ssm_conv_s4__moe_arch_mod__prompt_kernel,@function
sequential_preLN__ssm_conv_s4__moe_arch_mod__prompt_kernel:
    s_cmp_ge_u32 s2, 256
    s_cbranch_scc1 END
    s_load_dwordx16 s[4:19], s[0:1], 0
    s_load_dwordx2 s[36:37], s[0:1], 128
    s_load_dwordx16 s[20:35], s[0:1], 64
    s_getpc_b64 s[70:71]
    s_lshr_b32 s3, s2, 3
    s_mul_i32 s3, s3, 7
    v_subrev_u32 v2, 320, v0
    v_cmp_gt_u32 vcc, 7, v2
    v_add_lshl_u32 v2, v2, s3, 7
    v_min_u32 v2, CODE_END-sequential_preLN__ssm_conv_s4__moe_arch_mod__prompt_kernel-64, v2
    v_mov_b32 v3, s71
    s_mov_b64 exec, vcc
    v_add_co_u32 v2, vcc, s70, v2
    s_nop 1
    v_addc_co_u32 v3, vcc, 0, v3, vcc
    s_cbranch_execz P_NC
    global_load_dword v159, v[2:3], off
P_NC:
    s_mov_b64 exec, -1
    v_lshrrev_b32 v2, 6, v0
    v_and_b32 v1, 63, v0
    v_readfirstlane_b32 s38, v2
    v_lshlrev_b32 v3, 4, v1
    s_mov_b32 s42, 0x10000000
    s_mov_b32 s43, 0x00020000
    s_cmp_lt_u32 s2, 192
    s_cselect_b32 s3, 4, -1
    s_cmp_lg_u32 s38, s3
    s_cbranch_scc1 P_NP
    s_mul_i32 s52, s2, 768
    v_add_u32 v16, s52, v3
    s_mul_i32 s52, s2, 6
    s_and_b32 s52, s52, -4
    v_lshl_add_u32 v17, v1, 2, s52
    v_mov_b32 v18, 161536
    v_mov_b32 v19, 0
    ds_write_b32 v18, v19
    v_mov_b32 v20, s70
    v_mov_b32 v21, s71
    s_waitcnt lgkmcnt(0)
    s_mov_b32 exec_lo, 0xffffffff
    s_mov_b32 exec_hi, 0xffff
    s_mov_b32 m0, 138048
    s_nop 0
    global_load_lds_dwordx4 v16, s[6:7]
    s_mov_b32 m0, 138816
    s_nop 0
    global_load_lds_dwordx4 v16, s[8:9]
    s_mov_b32 m0, 139584
    s_nop 0
    global_load_lds_dwordx4 v16, s[10:11]
    s_mov_b32 m0, 140352
    s_nop 0
    global_load_lds_dwordx4 v16, s[12:13]
    s_mov_b32 m0, 141120
    s_nop 0
    global_load_lds_dwordx4 v16, s[14:15]
    s_mov_b32 m0, 141888
    s_nop 0
    global_load_lds_dwordx4 v16, s[16:17]
    s_mov_b64 exec, 0x3
    s_mov_b32 m0, 142656
    s_nop 0
    global_load_lds_dword v17, s[18:19]
    s_mov_b32 m0, 142672
    s_nop 0
    global_load_lds_dword v17, s[20:21]
    s_mov_b64 exec, 0x1
    s_mov_b32 m0, 161536
    s_nop 0
    global_load_lds_dword v[20:21], off
    s_mov_b64 exec, -1
P_NP:
    s_cmp_ge_u32 s38, 4
    s_cbranch_scc1 P_B
    s_setprio 3
    v_lshrrev_b32 v147, 5, v0
    v_and_b32 v148, 31, v0
    v_mul_u32_u24 v140, 0x480, v147
    s_mul_i32 s44, s2, 9216
    v_mad_u32_u24 v140, v148, 12, v140
    v_mov_b32 v104, 0
    v_mov_b32 v105, 0
    v_mov_b32 v106, 0
    v_mov_b32 v107, 0
    v_add_u32 v140, s44, v140
    v_add_u32 v149, 161280, v3
    s_mov_b64 exec, 0xffff
    ds_write_b128 v149, v[104:107]
    s_mov_b64 exec, -1
    v_mov_b32 v94, 1
    v_and_b32 v147, 1, v147
    v_mul_u32_u24 v141, 0x90, v148
    v_lshl_add_u32 v141, v147, 6, v141
    s_lshl_b32 s45, s38, 4
    s_sub_u32 s45, 147504, s45
    v_add_u32 v141, s45, v141
    v_lshrrev_b32 v142, 3, v1
    v_add_u32 v142, v142, v1
    s_mul_i32 s45, s38, 3456
    s_add_u32 s45, s45, 147456
    v_lshl_add_u32 v142, v142, 4, s45
    v_lshrrev_b32 v143, 2, v1
    v_mul_u32_u24 v143, 16320, v143
    v_add_u32 v143, v143, v3
    s_lshl_b32 s46, s2, 6
    s_sub_u32 s46, 5259200, s46
    s_mul_i32 s45, s38, 786432
    s_add_u32 s46, s46, s45
    s_add_u32 s47, s46, 262144
    s_add_u32 s48, s46, 524288
    s_mov_b32 s49, 0x05040100
    s_mov_b32 s50, 0x07060302
    v_mov_b32 v144, s49
    s_mov_b32 exec_lo, 0
    v_mov_b32 v144, s50
    s_mov_b64 exec, -1
    v_mov_b32 v145, 161328
    s_lshl_b32 s45, s38, 2
    v_add_u32 v146, s45, v145
    s_waitcnt lgkmcnt(0)
    global_load_dword v95, v104, s[36:37] offset:0
    global_load_dwordx3 v[60:62], v140, s[4:5] offset:0
    global_load_dwordx3 v[64:66], v140, s[4:5] offset:384
    global_load_dwordx3 v[68:70], v140, s[4:5] offset:768
    s_mov_b32 s40, s36
    s_mov_b32 s41, s37
    s_cmp_ge_u32 s2, 192
    s_cbranch_scc1 P_C
    s_lshr_b32 s65, s38, 2
    s_bitcmp1_b32 s2, 0
    s_addc_u32 s51, s65, 0
    s_cmp_eq_u32 s51, 3
    s_cselect_b32 s51, 0, s51
    s_lshl_b32 s52, s51, 8
    s_add_u32 s52, s52, 138048
    v_and_b32 v114, 0x7f, v0
    v_lshl_add_u32 v114, v114, 1, s52
    s_and_b32 s52, s2, 1
    s_add_u32 s52, s52, s51
    s_lshl_b32 s52, s52, 1
    s_add_u32 s52, s52, 142656
    v_mov_b32 v115, s52
    v_mov_b32 v119, 161536
    v_mov_b32 v29, 0
    v_mov_b32 v30, 0
    v_mov_b32 v31, 0
    v_mov_b32 v32, 0
    v_mov_b32 v33, 0
    v_mov_b32 v34, 0
    v_mov_b32 v35, 0
    v_mov_b32 v160, 0
    v_mov_b32 v161, 0
    v_mov_b32 v162, 0
    v_mov_b32 v163, 0
    v_mov_b32 v164, 0
    v_lshlrev_b32 v16, 4, v0
    v_add_u32 v17, 101184, v16
    ds_write_b128 v17, v[160:163] offset:0
    ds_write_b128 v17, v[160:163] offset:12288
    ds_write_b128 v17, v[160:163] offset:24576
    s_mul_i32 s59, s65, 16320
    s_mul_i32 s67, s65, 17408
    s_add_u32 s71, s67, 48960
    s_and_b32 s66, s38, 1
    s_lshl_b32 s66, s66, 8
    s_add_u32 s70, s66, s67
    s_add_u32 s70, s70, 16192
    s_add_u32 s66, s66, s59
    s_mov_b32 m0, s66
    s_mul_i32 s64, s65, 5888
    s_add_u32 s64, s64, 101184
    s_and_b32 s69, s38, 3
    v_and_b32 v5, 15, v0
    v_bfe_u32 v6, v0, 4, 2
    v_and_b32 v17, 48, v0
    v_mul_u32_u24 v110, 544, v5
    s_mov_b32 s52, 0
    s_movk_i32 s53, 2176
    s_movk_i32 s54, 4896
    s_cmp_eq_u32 s69, 1
    s_cselect_b32 s52, 9792, s52
    s_cselect_b32 s53, 1088, s53
    s_cselect_b32 s54, 3264, s54
    s_cmp_eq_u32 s69, 3
    s_cselect_b32 s52, 544, s52
    s_add_u32 s52, s52, s59
    s_cmp_eq_u32 s69, 2
    s_cselect_b32 s52, s71, s52
    s_cselect_b32 s54, 4352, s54
    s_add_u32 s67, s71, 8704
    v_and_b32 v111, 3, v0
    v_mul_u32_u24 v111, 544, v111
    v_bfe_u32 v18, v0, 2, 1
    v_bfe_u32 v19, v0, 3, 1
    v_xor_b32 v18, v18, v19
    v_mad_u32_u24 v111, v19, s53, v111
    v_mad_u32_u24 v111, v18, s54, v111
    v_add3_u32 v111, v111, v17, s52
    v_add3_u32 v110, v110, v17, s67
    s_barrier
    v_lshl_add_u32 v18, v5, 1, v6
    s_sub_u32 s52, s69, 11
    v_add_u32 v18, s52, v18
    v_add_u32 v19, 1, v18
    v_lshl_add_u32 v20, v6, 1, 2
    v_cmp_le_u32 s[52:53], v18, v20
    v_cmp_le_u32 s[54:55], v19, v20
    v_mov_b32 v18, 0x3f80
    v_cndmask_b32 v112, 0, v18, s[52:53]
    v_cndmask_b32 v19, 0, 1.0, s[54:55]
    v_or_b32 v112, v112, v19
    s_mul_i32 s52, s38, 1600
    s_add_u32 s52, s52, 120016
    v_lshl_add_u32 v113, v1, 2, s52
    s_mul_i32 s67, s65, 6400
    s_add_u32 s67, s67, 118848
    s_sub_u32 s63, s69, s65
    s_cselect_b32 s52, 3, 0
    s_add_u32 s63, s63, s52
    s_min_u32 s52, s63, 1
    s_add_u32 s63, s63, s52
    s_cmp_eq_u32 s69, 3
    s_cselect_b32 s63, 1, s63
    v_add_u32 v7, 1, v5
    v_and_b32 v8, 3, v7
    v_mul_u32_u24 v8, 1598, v8
    v_lshl_add_u32 v7, v7, 1, v8
    v_add3_u32 v7, v7, v17, s67
    v_add_u32 v18, s64, v17
    v_lshl_add_u32 v9, v5, 3, v18
    v_and_b32 v10, 1, v5
    v_mul_u32_u24 v10, 380, v10
    v_lshl_add_u32 v10, v5, 2, v10
    v_add_u32 v10, v18, v10
    v_lshlrev_b32 v8, 5, v5
    v_sub_u32 v8, v18, v8
    v_lshrrev_b32 v11, 2, v5
    v_lshl_add_u32 v2, v5, 2, v6
    v_add_u32 v15, v2, v11
    v_lshl_add_u32 v4, v15, 3, s59
    s_lshl_b32 s52, s65, 4
    s_add_u32 s52, s52, 161280
    v_mov_b32 v166, s52
    s_branch P_D
P_C:
    v_mov_b32 v8, 0
    v_mov_b32 v10, 0
    v_mov_b32 v166, 0
    v_mov_b32 v9, 0
    s_barrier
P_D:
    s_waitcnt vmcnt(0)
LN1:
    v_dot2c_f32_bf16 v104, 0x3f803f80, v60
    v_dot2c_f32_bf16 v106, v60, v60
    v_dot2c_f32_bf16 v105, 0x3f803f80, v61
    v_dot2c_f32_bf16 v107, v61, v61
    v_dot2c_f32_bf16 v104, 0x3f803f80, v62
    v_dot2c_f32_bf16 v106, v62, v62
    v_dot2c_f32_bf16 v105, 0x3f803f80, v64
    v_dot2c_f32_bf16 v107, v64, v64
    v_dot2c_f32_bf16 v104, 0x3f803f80, v65
    v_dot2c_f32_bf16 v106, v65, v65
    v_dot2c_f32_bf16 v105, 0x3f803f80, v66
    v_dot2c_f32_bf16 v107, v66, v66
    v_dot2c_f32_bf16 v104, 0x3f803f80, v68
    v_dot2c_f32_bf16 v106, v68, v68
    v_dot2c_f32_bf16 v105, 0x3f803f80, v69
    v_dot2c_f32_bf16 v107, v69, v69
    v_dot2c_f32_bf16 v104, 0x3f803f80, v70
    v_dot2c_f32_bf16 v106, v70, v70
    v_add_u32 v95, 1, v95
    s_mov_b64 exec, 0x7
    ds_write_b64 v149, v[94:95] offset:136
    s_mov_b64 exec, -1
    v_add_f32 v104, v104, v105
    v_add_f32 v106, v106, v107
    v_lshlrev_b32 v72, 16, v60
    v_and_b32 v73, 0xffff0000, v60
    v_permlane16_swap_b32 v104, v106
    v_add_f32 v104, v104, v106
    v_lshlrev_b32 v74, 16, v61
    v_and_b32 v75, 0xffff0000, v61
    v_add_f32_dpp v104, v104, v104 quad_perm:[1,0,3,2] row_mask:0xf bank_mask:0xf
    v_lshlrev_b32 v76, 16, v62
    v_and_b32 v77, 0xffff0000, v62
    v_add_f32_dpp v104, v104, v104 quad_perm:[2,3,0,1] row_mask:0xf bank_mask:0xf
    v_lshlrev_b32 v78, 16, v64
    v_and_b32 v79, 0xffff0000, v64
    v_add_f32_dpp v104, v104, v104 row_half_mirror row_mask:0xf bank_mask:0xf
    v_lshlrev_b32 v80, 16, v65
    v_and_b32 v81, 0xffff0000, v65
    v_add_f32_dpp v104, v104, v104 row_mirror row_mask:0xf bank_mask:0xf
    v_mul_f32 v104, 0x3ae38e39, v104
    v_mov_b32 v105, v104
    v_lshlrev_b32 v82, 16, v66
    v_and_b32 v83, 0xffff0000, v66
    v_permlane16_swap_b32 v104, v105
    v_fma_f32 v105, -v104, v104, v105
    v_max_f32 v105, 0, v105
    v_cvt_pk_bf16_f32 v105, v104, v105
    v_lshlrev_b32 v104, 16, v105
    v_and_b32 v105, 0xffff0000, v105
    v_lshlrev_b32 v84, 16, v68
    v_and_b32 v85, 0xffff0000, v68
    v_lshlrev_b32 v86, 16, v69
    v_and_b32 v87, 0xffff0000, v69
    v_lshlrev_b32 v88, 16, v70
    v_and_b32 v89, 0xffff0000, v70
    v_mov_b32 v99, v95
    v_mov_b32 v103, v95
    v_readfirstlane_b32 s39, v95
    v_add_f32 v105, 0x3727c5ac, v105
    v_cvt_pk_bf16_f32 v105, v105, v105
    v_lshlrev_b32 v105, 16, v105
    v_sqrt_f32 v106, v105
    v_pk_add_f32 v[72:73], v[72:73], v[104:105] op_sel_hi:[1,0] neg_lo:[0,1] neg_hi:[0,1]
    v_pk_add_f32 v[74:75], v[74:75], v[104:105] op_sel_hi:[1,0] neg_lo:[0,1] neg_hi:[0,1]
    v_pk_add_f32 v[76:77], v[76:77], v[104:105] op_sel_hi:[1,0] neg_lo:[0,1] neg_hi:[0,1]
    v_cvt_pk_bf16_f32 v106, v106, v106
    v_lshlrev_b32 v106, 16, v106
    v_rcp_f32 v106, v106
    v_pk_add_f32 v[78:79], v[78:79], v[104:105] op_sel_hi:[1,0] neg_lo:[0,1] neg_hi:[0,1]
    v_pk_add_f32 v[80:81], v[80:81], v[104:105] op_sel_hi:[1,0] neg_lo:[0,1] neg_hi:[0,1]
    v_pk_add_f32 v[82:83], v[82:83], v[104:105] op_sel_hi:[1,0] neg_lo:[0,1] neg_hi:[0,1]
    v_pk_add_f32 v[84:85], v[84:85], v[104:105] op_sel_hi:[1,0] neg_lo:[0,1] neg_hi:[0,1]
    v_pk_add_f32 v[86:87], v[86:87], v[104:105] op_sel_hi:[1,0] neg_lo:[0,1] neg_hi:[0,1]
    v_pk_add_f32 v[88:89], v[88:89], v[104:105] op_sel_hi:[1,0] neg_lo:[0,1] neg_hi:[0,1]
    v_cvt_pk_bf16_f32 v73, v72, v73
    v_cvt_pk_bf16_f32 v75, v74, v75
    v_cvt_pk_bf16_f32 v77, v76, v77
    v_cvt_pk_bf16_f32 v79, v78, v79
    v_cvt_pk_bf16_f32 v81, v80, v81
    v_cvt_pk_bf16_f32 v83, v82, v83
    v_cvt_pk_bf16_f32 v85, v84, v85
    v_cvt_pk_bf16_f32 v87, v86, v87
    v_cvt_pk_bf16_f32 v89, v88, v89
    v_lshlrev_b32 v72, 16, v73
    v_and_b32 v73, 0xffff0000, v73
    v_lshlrev_b32 v74, 16, v75
    v_and_b32 v75, 0xffff0000, v75
    v_lshlrev_b32 v76, 16, v77
    v_and_b32 v77, 0xffff0000, v77
    v_pk_mul_f32 v[72:73], v[72:73], v[106:107] op_sel_hi:[1,0]
    v_pk_mul_f32 v[74:75], v[74:75], v[106:107] op_sel_hi:[1,0]
    v_pk_mul_f32 v[76:77], v[76:77], v[106:107] op_sel_hi:[1,0]
    v_cvt_pk_bf16_f32 v60, v72, v73
    v_cvt_pk_bf16_f32 v62, v76, v77
    v_cvt_pk_bf16_f32 v61, v74, v75
    v_cvt_pk_bf16_f32 v63, v74, v75
    v_permlane32_swap_b32 v60, v62
    s_nop 0
    v_permlane32_swap_b32 v61, v63
    v_perm_b32 v92, v60, v62, s49
    v_perm_b32 v93, v60, v62, s50
    v_lshlrev_b32 v78, 16, v79
    v_and_b32 v79, 0xffff0000, v79
    v_lshlrev_b32 v80, 16, v81
    v_and_b32 v81, 0xffff0000, v81
    v_lshlrev_b32 v82, 16, v83
    v_and_b32 v83, 0xffff0000, v83
    v_pk_mul_f32 v[78:79], v[78:79], v[106:107] op_sel_hi:[1,0]
    v_pk_mul_f32 v[80:81], v[80:81], v[106:107] op_sel_hi:[1,0]
    v_pk_mul_f32 v[82:83], v[82:83], v[106:107] op_sel_hi:[1,0]
    v_cvt_pk_bf16_f32 v64, v78, v79
    v_cvt_pk_bf16_f32 v66, v82, v83
    v_cvt_pk_bf16_f32 v65, v80, v81
    v_cvt_pk_bf16_f32 v67, v80, v81
    v_perm_b32 v94, v61, v63, v144
    ds_write_b128 v141, v[92:95] offset:0
    v_permlane32_swap_b32 v64, v66
    v_permlane32_swap_b32 v65, v67
    v_perm_b32 v96, v64, v66, s49
    v_perm_b32 v97, v64, v66, s50
    v_lshlrev_b32 v84, 16, v85
    v_and_b32 v85, 0xffff0000, v85
    v_lshlrev_b32 v86, 16, v87
    v_and_b32 v87, 0xffff0000, v87
    v_lshlrev_b32 v88, 16, v89
    v_and_b32 v89, 0xffff0000, v89
    v_pk_mul_f32 v[84:85], v[84:85], v[106:107] op_sel_hi:[1,0]
    v_pk_mul_f32 v[86:87], v[86:87], v[106:107] op_sel_hi:[1,0]
    v_pk_mul_f32 v[88:89], v[88:89], v[106:107] op_sel_hi:[1,0]
    v_cvt_pk_bf16_f32 v68, v84, v85
    v_cvt_pk_bf16_f32 v70, v88, v89
    v_cvt_pk_bf16_f32 v69, v86, v87
    v_cvt_pk_bf16_f32 v71, v86, v87
    v_perm_b32 v98, v65, v67, v144
    ds_write_b128 v141, v[96:99] offset:4608
    v_permlane32_swap_b32 v68, v70
    v_permlane32_swap_b32 v69, v71
    v_perm_b32 v100, v68, v70, s49
    v_perm_b32 v101, v68, v70, s50
    v_perm_b32 v102, v69, v71, v144
    ds_write_b128 v141, v[100:103] offset:9216
    s_mov_b64 exec, 0x1
    ds_write_b32 v146, v144
    s_mov_b64 exec, -1
LN1_U:
    s_movk_i32 s60, 4000
LN1_R:
    ds_read_b128 v[104:107], v145
    ds_read_b128 v[72:75], v142 offset:0
    ds_read_b128 v[76:79], v142 offset:1152
    ds_read_b128 v[80:83], v142 offset:2304
    s_sub_u32 s60, s60, 1
    s_waitcnt lgkmcnt(3)
    v_min3_u32 v104, v104, v105, v106
    v_min_u32 v104, v104, v107
    v_cmp_eq_u32 vcc, 0, v104
    s_cmp_gt_i32 s60, 0
    s_cselect_b64 s[52:53], vcc, 0
    s_cmp_lg_u64 s[52:53], 0
    s_waitcnt lgkmcnt(0)
    s_cbranch_scc1 LN1_R
    buffer_store_dwordx4 v[72:75], v143, s[40:43], s46 offen sc1
    buffer_store_dwordx4 v[76:79], v143, s[40:43], s47 offen sc1
    buffer_store_dwordx4 v[80:83], v143, s[40:43], s48 offen sc1
    s_cmp_ge_u32 s2, 192
    s_cbranch_scc1 FFN_DMA
    s_branch C_KS
P_B:
    s_cmp_ge_u32 s2, 192
    s_cbranch_scc1 FFN_DMA0
P_B2:
    s_lshr_b32 s65, s38, 2
    s_bitcmp1_b32 s2, 0
    s_addc_u32 s51, s65, 0
    s_cmp_eq_u32 s51, 3
    s_cselect_b32 s51, 0, s51
    s_lshl_b32 s52, s51, 8
    s_add_u32 s52, s52, 138048
    v_and_b32 v114, 0x7f, v0
    v_lshl_add_u32 v114, v114, 1, s52
    s_and_b32 s52, s2, 1
    s_add_u32 s52, s52, s51
    s_lshl_b32 s52, s52, 1
    s_add_u32 s52, s52, 142656
    v_mov_b32 v115, s52
    v_mov_b32 v119, 161536
    v_mov_b32 v29, 0
    v_mov_b32 v30, 0
    v_mov_b32 v31, 0
    v_mov_b32 v32, 0
    v_mov_b32 v33, 0
    v_mov_b32 v34, 0
    v_mov_b32 v35, 0
    v_mov_b32 v160, 0
    v_mov_b32 v161, 0
    v_mov_b32 v162, 0
    v_mov_b32 v163, 0
    v_mov_b32 v164, 0
    v_lshlrev_b32 v16, 4, v0
    v_add_u32 v17, 101184, v16
    ds_write_b128 v17, v[160:163] offset:0
    ds_write_b128 v17, v[160:163] offset:12288
    ds_write_b128 v17, v[160:163] offset:24576
    s_mul_i32 s59, s65, 16320
    s_mul_i32 s67, s65, 17408
    s_add_u32 s71, s67, 48960
    s_and_b32 s66, s38, 1
    s_lshl_b32 s66, s66, 8
    s_add_u32 s70, s66, s67
    s_add_u32 s70, s70, 16192
    s_add_u32 s66, s66, s59
    s_mov_b32 m0, s66
    s_mul_i32 s64, s65, 5888
    s_add_u32 s64, s64, 101184
    s_and_b32 s69, s38, 3
    v_and_b32 v5, 15, v0
    v_bfe_u32 v6, v0, 4, 2
    v_and_b32 v17, 48, v0
    v_mul_u32_u24 v110, 544, v5
    s_mov_b32 s52, 0
    s_movk_i32 s53, 2176
    s_movk_i32 s54, 4896
    s_cmp_eq_u32 s69, 1
    s_cselect_b32 s52, 9792, s52
    s_cselect_b32 s53, 1088, s53
    s_cselect_b32 s54, 3264, s54
    s_cmp_eq_u32 s69, 3
    s_cselect_b32 s52, 544, s52
    s_add_u32 s52, s52, s59
    s_cmp_eq_u32 s69, 2
    s_cselect_b32 s52, s71, s52
    s_cselect_b32 s54, 4352, s54
    s_add_u32 s67, s71, 8704
    v_and_b32 v111, 3, v0
    v_mul_u32_u24 v111, 544, v111
    v_bfe_u32 v18, v0, 2, 1
    v_bfe_u32 v19, v0, 3, 1
    v_xor_b32 v18, v18, v19
    v_mad_u32_u24 v111, v19, s53, v111
    v_mad_u32_u24 v111, v18, s54, v111
    v_add3_u32 v111, v111, v17, s52
    v_add3_u32 v110, v110, v17, s67
    s_barrier
    v_lshl_add_u32 v18, v5, 1, v6
    s_sub_u32 s52, s69, 11
    v_add_u32 v18, s52, v18
    v_add_u32 v19, 1, v18
    v_lshl_add_u32 v20, v6, 1, 2
    v_cmp_le_u32 s[52:53], v18, v20
    v_cmp_le_u32 s[54:55], v19, v20
    v_mov_b32 v18, 0x3f80
    v_cndmask_b32 v112, 0, v18, s[52:53]
    v_cndmask_b32 v19, 0, 1.0, s[54:55]
    v_or_b32 v112, v112, v19
    s_mul_i32 s52, s38, 1600
    s_add_u32 s52, s52, 120016
    v_lshl_add_u32 v113, v1, 2, s52
    s_mul_i32 s67, s65, 6400
    s_add_u32 s67, s67, 118848
    s_sub_u32 s63, s69, s65
    s_cselect_b32 s52, 3, 0
    s_add_u32 s63, s63, s52
    s_min_u32 s52, s63, 1
    s_add_u32 s63, s63, s52
    s_cmp_eq_u32 s69, 3
    s_cselect_b32 s63, 1, s63
    v_add_u32 v7, 1, v5
    v_and_b32 v8, 3, v7
    v_mul_u32_u24 v8, 1598, v8
    v_lshl_add_u32 v7, v7, 1, v8
    v_add3_u32 v7, v7, v17, s67
    v_add_u32 v18, s64, v17
    v_lshl_add_u32 v9, v5, 3, v18
    v_and_b32 v10, 1, v5
    v_mul_u32_u24 v10, 380, v10
    v_lshl_add_u32 v10, v5, 2, v10
    v_add_u32 v10, v18, v10
    v_lshlrev_b32 v8, 5, v5
    v_sub_u32 v8, v18, v8
    v_lshrrev_b32 v11, 2, v5
    v_lshl_add_u32 v2, v5, 2, v6
    v_add_u32 v15, v2, v11
    v_lshl_add_u32 v4, v15, 3, s59
    s_lshl_b32 s52, s65, 4
    s_add_u32 s52, s52, 161280
    v_mov_b32 v166, s52
    s_lshl_b32 s48, s2, 13
    s_add_u32 s48, s48, 258048
    s_mov_b32 s50, s2
    s_lshl_b32 s49, s2, 11
    s_add_u32 s49, s49, 1440768
    s_waitcnt lgkmcnt(0)
    s_mov_b32 s40, s36
    s_mov_b32 s41, s37
C_KS:
    s_movk_i32 s60, 4000
C_KP:
    ds_read_b32 v20, v119
    s_sub_u32 s60, s60, 1
    s_cmp_gt_i32 s60, 0
    s_waitcnt lgkmcnt(0)
    v_readfirstlane_b32 s52, v20
    s_nop 0
    s_cselect_b32 s52, s52, 1
    s_cmp_eq_u32 s52, 0
    s_cbranch_scc1 C_KP
    ds_read_u16_d16_hi v29, v115
    ds_read_u16_d16_hi v30, v114 offset:0
    ds_read_u16_d16_hi v31, v114 offset:768
    ds_read_u16_d16_hi v32, v114 offset:1536
    ds_read_u16_d16_hi v33, v114 offset:2304
    ds_read_u16_d16_hi v34, v114 offset:3072
    ds_read_u16_d16_hi v35, v114 offset:3840
    ds_read_u16_d16_hi v164, v115 offset:16
    s_setprio 2
    s_cmp_lt_u32 s38, 4
    s_cbranch_scc1 PG1
    s_setprio 3
PG1:
    s_waitcnt lgkmcnt(0)
    v_mul_f32 v20, 0x3fb8aa3b, v29
    v_mov_b32 v21, 0x3fb8aa3b
    v_fma_f32 v21, v29, v21, -v20
    v_fmac_f32 v21, 0x32a57060, v29
    v_exp_f32 v20, v20
    v_mul_f32 v21, 0x3f317218, v21
    v_fma_f32 v20, v20, v21, v20
    v_cvt_pk_bf16_f32 v20, v20, v20
    v_lshlrev_b32 v20, 16, v20
    v_mul_f32 v21, v30, v20
    v_mul_f32 v36, v31, v20
    v_mul_f32 v32, v32, v20
    v_mul_f32 v33, v33, v20
    v_mul_f32 v21, 0x3fb8aa3b, v21
    v_mul_f32 v22, 0x3e22f983, v36
    v_mov_b32 v23, 0x3e22f983
    v_fma_f32 v23, v36, v23, -v22
    v_fmac_f32 v23, 0x31dc9c88, v36
    v_pk_mul_f32 v[24:25], v[34:35], v[32:33] op_sel:[0,0] op_sel_hi:[0,1]
    v_pk_fma_f32 v[24:25], v[34:35], v[32:33], v[24:25] op_sel:[1,1,0] op_sel_hi:[1,0,1] neg_lo:[1,0,0]
    s_bitcmp1_b32 s38, 1
    s_cbranch_scc1 C_ROLE1
    v_mul_f32 v36, 0x43000000, v21
    v_mul_f32 v37, 0x43000000, v22
    v_mul_f32 v38, 0x41000000, v21
    v_mul_f32 v39, 0x41000000, v22
    v_exp_f32 v36, v36
    v_fract_f32 v37, v37
    v_exp_f32 v38, v38
    v_fract_f32 v39, v39
    v_fmac_f32 v37, 0x43000000, v23
    v_fmac_f32 v39, 0x41000000, v23
    v_cos_f32 v26, v37
    v_sin_f32 v27, v37
    v_cos_f32 v28, v39
    v_sin_f32 v29, v39
    v_mul_f32 v26, v26, v36
    v_mul_f32 v27, v27, v36
    v_mul_f32 v28, v28, v38
    v_mul_f32 v29, v29, v38
    v_mov_b32 v44, 1.0
    v_mov_b32 v45, 0
    v_pk_mul_f32 v[56:57], v[24:25], v[28:29] op_sel:[0,0] op_sel_hi:[0,1]
    v_pk_mul_f32 v[50:51], v[28:29], v[28:29] op_sel:[0,0] op_sel_hi:[0,1]
    v_pk_fma_f32 v[56:57], v[24:25], v[28:29], v[56:57] op_sel:[1,1,0] op_sel_hi:[1,0,1] neg_lo:[1,0,0]
    v_pk_fma_f32 v[50:51], v[28:29], v[28:29], v[50:51] op_sel:[1,1,0] op_sel_hi:[1,0,1] neg_lo:[1,0,0]
    v_pk_mul_f32 v[58:59], v[56:57], v[26:27] op_sel:[0,0] op_sel_hi:[0,1]
    v_pk_fma_f32 v[58:59], v[56:57], v[26:27], v[58:59] op_sel:[1,1,0] op_sel_hi:[1,0,1] neg_lo:[1,0,0]
    v_cvt_pk_bf16_f32 v40, v56, v57
    ds_write_addtid_b32 v40 offset:4352
    v_pk_mul_f32 v[56:57], v[58:59], v[26:27] op_sel:[0,0] op_sel_hi:[0,1]
    v_pk_mul_f32 v[54:55], v[50:51], v[28:29] op_sel:[0,0] op_sel_hi:[0,1]
    v_pk_fma_f32 v[56:57], v[58:59], v[26:27], v[56:57] op_sel:[1,1,0] op_sel_hi:[1,0,1] neg_lo:[1,0,0]
    v_pk_fma_f32 v[54:55], v[50:51], v[28:29], v[54:55] op_sel:[1,1,0] op_sel_hi:[1,0,1] neg_lo:[1,0,0]
    v_cvt_pk_bf16_f32 v41, v58, v59
    ds_write_addtid_b32 v41 offset:9248
    v_cvt_pk_bf16_f32 v42, v44, -v45
    s_mov_b32 m0, s70
    s_nop 0
    ds_write_addtid_b32 v42 offset:41472
    v_cvt_pk_bf16_f32 v43, v28, -v29
    ds_write_addtid_b32 v43 offset:42016
    v_cvt_pk_bf16_f32 v40, v50, -v51
    ds_write_addtid_b32 v40 offset:42560
    v_pk_mul_f32 v[58:59], v[56:57], v[26:27] op_sel:[0,0] op_sel_hi:[0,1]
    v_pk_mul_f32 v[50:51], v[54:55], v[28:29] op_sel:[0,0] op_sel_hi:[0,1]
    v_pk_fma_f32 v[58:59], v[56:57], v[26:27], v[58:59] op_sel:[1,1,0] op_sel_hi:[1,0,1] neg_lo:[1,0,0]
    v_pk_fma_f32 v[50:51], v[54:55], v[28:29], v[50:51] op_sel:[1,1,0] op_sel_hi:[1,0,1] neg_lo:[1,0,0]
    v_cvt_pk_bf16_f32 v41, v56, v57
    s_mov_b32 m0, s66
    s_nop 0
    ds_write_addtid_b32 v41 offset:11968
    v_cvt_pk_bf16_f32 v42, v54, -v55
    s_mov_b32 m0, s70
    s_nop 0
    ds_write_addtid_b32 v42 offset:43104
    v_pk_mul_f32 v[56:57], v[58:59], v[26:27] op_sel:[0,0] op_sel_hi:[0,1]
    v_pk_mul_f32 v[54:55], v[50:51], v[28:29] op_sel:[0,0] op_sel_hi:[0,1]
    v_pk_fma_f32 v[56:57], v[58:59], v[26:27], v[56:57] op_sel:[1,1,0] op_sel_hi:[1,0,1] neg_lo:[1,0,0]
    v_pk_fma_f32 v[54:55], v[50:51], v[28:29], v[54:55] op_sel:[1,1,0] op_sel_hi:[1,0,1] neg_lo:[1,0,0]
    v_cvt_pk_bf16_f32 v43, v58, v59
    s_mov_b32 m0, s66
    s_nop 0
    ds_write_addtid_b32 v43 offset:15232
    v_cvt_pk_bf16_f32 v40, v50, -v51
    s_mov_b32 m0, s70
    s_nop 0
    ds_write_addtid_b32 v40 offset:43648
    v_pk_mul_f32 v[58:59], v[56:57], v[26:27] op_sel:[0,0] op_sel_hi:[0,1]
    v_pk_mul_f32 v[50:51], v[54:55], v[28:29] op_sel:[0,0] op_sel_hi:[0,1]
    v_pk_fma_f32 v[58:59], v[56:57], v[26:27], v[58:59] op_sel:[1,1,0] op_sel_hi:[1,0,1] neg_lo:[1,0,0]
    v_pk_fma_f32 v[50:51], v[54:55], v[28:29], v[50:51] op_sel:[1,1,0] op_sel_hi:[1,0,1] neg_lo:[1,0,0]
    v_cvt_pk_bf16_f32 v41, v56, v57
    ds_write_addtid_b32 v41 offset:33312
    v_cvt_pk_bf16_f32 v42, v54, -v55
    ds_write_addtid_b32 v42 offset:44192
    v_pk_mul_f32 v[56:57], v[58:59], v[26:27] op_sel:[0,0] op_sel_hi:[0,1]
    v_pk_mul_f32 v[54:55], v[50:51], v[28:29] op_sel:[0,0] op_sel_hi:[0,1]
    v_pk_fma_f32 v[56:57], v[58:59], v[26:27], v[56:57] op_sel:[1,1,0] op_sel_hi:[1,0,1] neg_lo:[1,0,0]
    v_pk_fma_f32 v[54:55], v[50:51], v[28:29], v[54:55] op_sel:[1,1,0] op_sel_hi:[1,0,1] neg_lo:[1,0,0]
    v_cvt_pk_bf16_f32 v43, v58, v59
    ds_write_addtid_b32 v43 offset:34400
    v_cvt_pk_bf16_f32 v40, v50, -v51
    ds_write_addtid_b32 v40 offset:44736
    v_pk_mul_f32 v[58:59], v[56:57], v[26:27] op_sel:[0,0] op_sel_hi:[0,1]
    v_pk_mul_f32 v[50:51], v[54:55], v[28:29] op_sel:[0,0] op_sel_hi:[0,1]
    v_pk_fma_f32 v[58:59], v[56:57], v[26:27], v[58:59] op_sel:[1,1,0] op_sel_hi:[1,0,1] neg_lo:[1,0,0]
    v_pk_fma_f32 v[50:51], v[54:55], v[28:29], v[50:51] op_sel:[1,1,0] op_sel_hi:[1,0,1] neg_lo:[1,0,0]
    v_cvt_pk_bf16_f32 v41, v56, v57
    ds_write_addtid_b32 v41 offset:37664
    v_cvt_pk_bf16_f32 v42, v54, -v55
    ds_write_addtid_b32 v42 offset:45280
    v_pk_mul_f32 v[56:57], v[58:59], v[26:27] op_sel:[0,0] op_sel_hi:[0,1]
    v_pk_mul_f32 v[54:55], v[50:51], v[28:29] op_sel:[0,0] op_sel_hi:[0,1]
    v_pk_fma_f32 v[56:57], v[58:59], v[26:27], v[56:57] op_sel:[1,1,0] op_sel_hi:[1,0,1] neg_lo:[1,0,0]
    v_pk_fma_f32 v[54:55], v[50:51], v[28:29], v[54:55] op_sel:[1,1,0] op_sel_hi:[1,0,1] neg_lo:[1,0,0]
    v_cvt_pk_bf16_f32 v43, v58, v59
    ds_write_addtid_b32 v43 offset:38752
    v_cvt_pk_bf16_f32 v40, v50, -v51
    ds_write_addtid_b32 v40 offset:45824
    v_pk_mul_f32 v[58:59], v[56:57], v[26:27] op_sel:[0,0] op_sel_hi:[0,1]
    v_pk_mul_f32 v[50:51], v[54:55], v[28:29] op_sel:[0,0] op_sel_hi:[0,1]
    v_pk_fma_f32 v[58:59], v[56:57], v[26:27], v[58:59] op_sel:[1,1,0] op_sel_hi:[1,0,1] neg_lo:[1,0,0]
    v_pk_fma_f32 v[50:51], v[54:55], v[28:29], v[50:51] op_sel:[1,1,0] op_sel_hi:[1,0,1] neg_lo:[1,0,0]
    v_cvt_pk_bf16_f32 v41, v56, v57
    ds_write_addtid_b32 v41 offset:39296
    v_cvt_pk_bf16_f32 v42, v54, -v55
    ds_write_addtid_b32 v42 offset:46368
    v_pk_mul_f32 v[56:57], v[58:59], v[26:27] op_sel:[0,0] op_sel_hi:[0,1]
    v_pk_mul_f32 v[54:55], v[50:51], v[28:29] op_sel:[0,0] op_sel_hi:[0,1]
    v_pk_fma_f32 v[56:57], v[58:59], v[26:27], v[56:57] op_sel:[1,1,0] op_sel_hi:[1,0,1] neg_lo:[1,0,0]
    v_pk_fma_f32 v[54:55], v[50:51], v[28:29], v[54:55] op_sel:[1,1,0] op_sel_hi:[1,0,1] neg_lo:[1,0,0]
    v_cvt_pk_bf16_f32 v43, v58, v59
    ds_write_addtid_b32 v43 offset:39840
    v_cvt_pk_bf16_f32 v40, v50, -v51
    ds_write_addtid_b32 v40 offset:46912
    v_pk_mul_f32 v[58:59], v[56:57], v[26:27] op_sel:[0,0] op_sel_hi:[0,1]
    v_pk_mul_f32 v[50:51], v[54:55], v[28:29] op_sel:[0,0] op_sel_hi:[0,1]
    v_pk_fma_f32 v[58:59], v[56:57], v[26:27], v[58:59] op_sel:[1,1,0] op_sel_hi:[1,0,1] neg_lo:[1,0,0]
    v_pk_fma_f32 v[50:51], v[54:55], v[28:29], v[50:51] op_sel:[1,1,0] op_sel_hi:[1,0,1] neg_lo:[1,0,0]
    v_cvt_pk_bf16_f32 v41, v56, v57
    ds_write_addtid_b32 v41 offset:40384
    v_cvt_pk_bf16_f32 v42, v54, -v55
    ds_write_addtid_b32 v42 offset:47456
    v_pk_mul_f32 v[56:57], v[58:59], v[26:27] op_sel:[0,0] op_sel_hi:[0,1]
    v_pk_mul_f32 v[54:55], v[50:51], v[28:29] op_sel:[0,0] op_sel_hi:[0,1]
    v_pk_fma_f32 v[56:57], v[58:59], v[26:27], v[56:57] op_sel:[1,1,0] op_sel_hi:[1,0,1] neg_lo:[1,0,0]
    v_pk_fma_f32 v[54:55], v[50:51], v[28:29], v[54:55] op_sel:[1,1,0] op_sel_hi:[1,0,1] neg_lo:[1,0,0]
    v_cvt_pk_bf16_f32 v43, v58, v59
    ds_write_addtid_b32 v43 offset:40928
    v_cvt_pk_bf16_f32 v40, v50, -v51
    ds_write_addtid_b32 v40 offset:48000
    v_pk_mul_f32 v[58:59], v[56:57], v[26:27] op_sel:[0,0] op_sel_hi:[0,1]
    v_pk_mul_f32 v[50:51], v[54:55], v[28:29] op_sel:[0,0] op_sel_hi:[0,1]
    v_pk_fma_f32 v[58:59], v[56:57], v[26:27], v[58:59] op_sel:[1,1,0] op_sel_hi:[1,0,1] neg_lo:[1,0,0]
    v_pk_fma_f32 v[50:51], v[54:55], v[28:29], v[50:51] op_sel:[1,1,0] op_sel_hi:[1,0,1] neg_lo:[1,0,0]
    v_cvt_pk_bf16_f32 v41, v56, v57
    ds_write_addtid_b32 v41 offset:34944
    v_cvt_pk_bf16_f32 v42, v54, -v55
    ds_write_addtid_b32 v42 offset:48544
    v_pk_mul_f32 v[56:57], v[58:59], v[26:27] op_sel:[0,0] op_sel_hi:[0,1]
    v_pk_mul_f32 v[54:55], v[50:51], v[28:29] op_sel:[0,0] op_sel_hi:[0,1]
    v_pk_fma_f32 v[56:57], v[58:59], v[26:27], v[56:57] op_sel:[1,1,0] op_sel_hi:[1,0,1] neg_lo:[1,0,0]
    v_pk_fma_f32 v[54:55], v[50:51], v[28:29], v[54:55] op_sel:[1,1,0] op_sel_hi:[1,0,1] neg_lo:[1,0,0]
    v_cvt_pk_bf16_f32 v43, v58, v59
    ds_write_addtid_b32 v43 offset:35488
    v_cvt_pk_bf16_f32 v40, v50, -v51
    ds_write_addtid_b32 v40 offset:49088
    v_pk_mul_f32 v[58:59], v[56:57], v[26:27] op_sel:[0,0] op_sel_hi:[0,1]
    v_pk_fma_f32 v[58:59], v[56:57], v[26:27], v[58:59] op_sel:[1,1,0] op_sel_hi:[1,0,1] neg_lo:[1,0,0]
    v_cvt_pk_bf16_f32 v41, v56, v57
    ds_write_addtid_b32 v41 offset:36032
    v_cvt_pk_bf16_f32 v42, v54, -v55
    ds_write_addtid_b32 v42 offset:49632
    v_cvt_pk_bf16_f32 v43, v58, v59
    ds_write_addtid_b32 v43 offset:36576
    s_branch C_MFMA
C_ROLE1:
    v_mul_f32 v36, 0x43000000, v21
    v_mul_f32 v37, 0x43000000, v22
    v_mul_f32 v38, 0x3f800000, v21
    v_mul_f32 v39, 0x3f800000, v22
    v_exp_f32 v36, v36
    v_fract_f32 v37, v37
    v_exp_f32 v38, v38
    v_fract_f32 v39, v39
    v_fmac_f32 v37, 0x43000000, v23
    v_fmac_f32 v39, 0x3f800000, v23
    v_cos_f32 v26, v37
    v_sin_f32 v27, v37
    v_cos_f32 v28, v39
    v_sin_f32 v29, v39
    v_mul_f32 v26, v26, v36
    v_mul_f32 v27, v27, v36
    v_mul_f32 v28, v28, v38
    v_mul_f32 v29, v29, v38
    v_pk_mul_f32 v[44:45], v[24:25], v[26:27] op_sel:[0,0] op_sel_hi:[0,1]
    v_pk_mul_f32 v[46:47], v[28:29], v[28:29] op_sel:[0,0] op_sel_hi:[0,1]
    v_pk_mul_f32 v[48:49], v[24:25], v[28:29] op_sel:[0,0] op_sel_hi:[0,1]
    v_pk_fma_f32 v[44:45], v[24:25], v[26:27], v[44:45] op_sel:[1,1,0] op_sel_hi:[1,0,1] neg_lo:[1,0,0]
    v_pk_fma_f32 v[46:47], v[28:29], v[28:29], v[46:47] op_sel:[1,1,0] op_sel_hi:[1,0,1] neg_lo:[1,0,0]
    v_pk_fma_f32 v[48:49], v[24:25], v[28:29], v[48:49] op_sel:[1,1,0] op_sel_hi:[1,0,1] neg_lo:[1,0,0]
    v_cvt_pk_bf16_f32 v40, v24, v25
    ds_write_addtid_b32 v40 offset:0
    v_pk_mul_f32 v[50:51], v[44:45], v[26:27] op_sel:[0,0] op_sel_hi:[0,1]
    v_pk_mul_f32 v[52:53], v[44:45], v[28:29] op_sel:[0,0] op_sel_hi:[0,1]
    v_pk_mul_f32 v[54:55], v[48:49], v[28:29] op_sel:[0,0] op_sel_hi:[0,1]
    v_pk_mul_f32 v[62:63], v[46:47], v[46:47] op_sel:[0,0] op_sel_hi:[0,1]
    v_pk_fma_f32 v[50:51], v[44:45], v[26:27], v[50:51] op_sel:[1,1,0] op_sel_hi:[1,0,1] neg_lo:[1,0,0]
    v_pk_fma_f32 v[52:53], v[44:45], v[28:29], v[52:53] op_sel:[1,1,0] op_sel_hi:[1,0,1] neg_lo:[1,0,0]
    v_pk_fma_f32 v[54:55], v[48:49], v[28:29], v[54:55] op_sel:[1,1,0] op_sel_hi:[1,0,1] neg_lo:[1,0,0]
    v_pk_fma_f32 v[62:63], v[46:47], v[46:47], v[62:63] op_sel:[1,1,0] op_sel_hi:[1,0,1] neg_lo:[1,0,0]
    v_cvt_pk_bf16_f32 v41, v44, v45
    ds_write_addtid_b32 v41 offset:4896
    v_cvt_pk_bf16_f32 v42, v48, v49
    ds_write_addtid_b32 v42 offset:544
    v_pk_mul_f32 v[56:57], v[50:51], v[26:27] op_sel:[0,0] op_sel_hi:[0,1]
    v_pk_mul_f32 v[58:59], v[50:51], v[46:47] op_sel:[0,0] op_sel_hi:[0,1]
    v_pk_mul_f32 v[44:45], v[52:53], v[28:29] op_sel:[0,0] op_sel_hi:[0,1]
    v_pk_mul_f32 v[48:49], v[54:55], v[28:29] op_sel:[0,0] op_sel_hi:[0,1]
    v_pk_fma_f32 v[56:57], v[50:51], v[26:27], v[56:57] op_sel:[1,1,0] op_sel_hi:[1,0,1] neg_lo:[1,0,0]
    v_pk_fma_f32 v[58:59], v[50:51], v[46:47], v[58:59] op_sel:[1,1,0] op_sel_hi:[1,0,1] neg_lo:[1,0,0]
    v_pk_fma_f32 v[44:45], v[52:53], v[28:29], v[44:45] op_sel:[1,1,0] op_sel_hi:[1,0,1] neg_lo:[1,0,0]
    v_pk_fma_f32 v[48:49], v[54:55], v[28:29], v[48:49] op_sel:[1,1,0] op_sel_hi:[1,0,1] neg_lo:[1,0,0]
    v_cvt_pk_bf16_f32 v43, v50, v51
    ds_write_addtid_b32 v43 offset:9792
    v_cvt_pk_bf16_f32 v40, v52, v53
    ds_write_addtid_b32 v40 offset:5440
    v_cvt_pk_bf16_f32 v41, v54, v55
    ds_write_addtid_b32 v41 offset:1088
    v_pk_mul_f32 v[54:55], v[48:49], v[28:29] op_sel:[0,0] op_sel_hi:[0,1]
    v_pk_mul_f32 v[52:53], v[44:45], v[28:29] op_sel:[0,0] op_sel_hi:[0,1]
    v_pk_mul_f32 v[50:51], v[58:59], v[46:47] op_sel:[0,0] op_sel_hi:[0,1]
    v_pk_mul_f32 v[24:25], v[56:57], v[46:47] op_sel:[0,0] op_sel_hi:[0,1]
    v_pk_fma_f32 v[54:55], v[48:49], v[28:29], v[54:55] op_sel:[1,1,0] op_sel_hi:[1,0,1] neg_lo:[1,0,0]
    v_pk_fma_f32 v[52:53], v[44:45], v[28:29], v[52:53] op_sel:[1,1,0] op_sel_hi:[1,0,1] neg_lo:[1,0,0]
    v_pk_fma_f32 v[50:51], v[58:59], v[46:47], v[50:51] op_sel:[1,1,0] op_sel_hi:[1,0,1] neg_lo:[1,0,0]
    v_pk_fma_f32 v[24:25], v[56:57], v[46:47], v[24:25] op_sel:[1,1,0] op_sel_hi:[1,0,1] neg_lo:[1,0,0]
    v_cvt_pk_bf16_f32 v42, v48, v49
    ds_write_addtid_b32 v42 offset:1632
    v_cvt_pk_bf16_f32 v43, v44, v45
    ds_write_addtid_b32 v43 offset:5984
    v_cvt_pk_bf16_f32 v40, v58, v59
    ds_write_addtid_b32 v40 offset:10336
    v_pk_mul_f32 v[48:49], v[54:55], v[28:29] op_sel:[0,0] op_sel_hi:[0,1]
    v_pk_mul_f32 v[44:45], v[52:53], v[28:29] op_sel:[0,0] op_sel_hi:[0,1]
    v_pk_mul_f32 v[58:59], v[50:51], v[46:47] op_sel:[0,0] op_sel_hi:[0,1]
    v_pk_mul_f32 v[56:57], v[24:25], v[46:47] op_sel:[0,0] op_sel_hi:[0,1]
    v_pk_fma_f32 v[48:49], v[54:55], v[28:29], v[48:49] op_sel:[1,1,0] op_sel_hi:[1,0,1] neg_lo:[1,0,0]
    v_pk_fma_f32 v[44:45], v[52:53], v[28:29], v[44:45] op_sel:[1,1,0] op_sel_hi:[1,0,1] neg_lo:[1,0,0]
    v_pk_fma_f32 v[58:59], v[50:51], v[46:47], v[58:59] op_sel:[1,1,0] op_sel_hi:[1,0,1] neg_lo:[1,0,0]
    v_pk_fma_f32 v[56:57], v[24:25], v[46:47], v[56:57] op_sel:[1,1,0] op_sel_hi:[1,0,1] neg_lo:[1,0,0]
    v_cvt_pk_bf16_f32 v41, v54, v55
    ds_write_addtid_b32 v41 offset:2176
    v_cvt_pk_bf16_f32 v42, v52, v53
    ds_write_addtid_b32 v42 offset:6528
    v_cvt_pk_bf16_f32 v43, v50, v51
    ds_write_addtid_b32 v43 offset:10880
    v_cvt_pk_bf16_f32 v40, v24, v25
    ds_write_addtid_b32 v40 offset:13600
    v_pk_mul_f32 v[54:55], v[48:49], v[28:29] op_sel:[0,0] op_sel_hi:[0,1]
    v_pk_mul_f32 v[52:53], v[44:45], v[28:29] op_sel:[0,0] op_sel_hi:[0,1]
    v_pk_mul_f32 v[50:51], v[58:59], v[62:63] op_sel:[0,0] op_sel_hi:[0,1]
    v_pk_mul_f32 v[24:25], v[56:57], v[46:47] op_sel:[0,0] op_sel_hi:[0,1]
    v_pk_mul_f32 v[64:65], v[56:57], v[26:27] op_sel:[0,0] op_sel_hi:[0,1]
    v_pk_fma_f32 v[54:55], v[48:49], v[28:29], v[54:55] op_sel:[1,1,0] op_sel_hi:[1,0,1] neg_lo:[1,0,0]
    v_pk_fma_f32 v[52:53], v[44:45], v[28:29], v[52:53] op_sel:[1,1,0] op_sel_hi:[1,0,1] neg_lo:[1,0,0]
    v_pk_fma_f32 v[50:51], v[58:59], v[62:63], v[50:51] op_sel:[1,1,0] op_sel_hi:[1,0,1] neg_lo:[1,0,0]
    v_pk_fma_f32 v[24:25], v[56:57], v[46:47], v[24:25] op_sel:[1,1,0] op_sel_hi:[1,0,1] neg_lo:[1,0,0]
    v_pk_fma_f32 v[64:65], v[56:57], v[26:27], v[64:65] op_sel:[1,1,0] op_sel_hi:[1,0,1] neg_lo:[1,0,0]
    v_cvt_pk_bf16_f32 v41, v48, v49
    ds_write_addtid_b32 v41 offset:2720
    v_cvt_pk_bf16_f32 v42, v44, v45
    ds_write_addtid_b32 v42 offset:7072
    v_cvt_pk_bf16_f32 v43, v58, v59
    ds_write_addtid_b32 v43 offset:11424
    v_cvt_pk_bf16_f32 v40, v56, v57
    ds_write_addtid_b32 v40 offset:14144
    v_pk_mul_f32 v[48:49], v[54:55], v[28:29] op_sel:[0,0] op_sel_hi:[0,1]
    v_pk_mul_f32 v[44:45], v[52:53], v[28:29] op_sel:[0,0] op_sel_hi:[0,1]
    v_pk_mul_f32 v[56:57], v[24:25], v[62:63] op_sel:[0,0] op_sel_hi:[0,1]
    v_pk_mul_f32 v[66:67], v[64:65], v[26:27] op_sel:[0,0] op_sel_hi:[0,1]
    v_pk_fma_f32 v[48:49], v[54:55], v[28:29], v[48:49] op_sel:[1,1,0] op_sel_hi:[1,0,1] neg_lo:[1,0,0]
    v_pk_fma_f32 v[44:45], v[52:53], v[28:29], v[44:45] op_sel:[1,1,0] op_sel_hi:[1,0,1] neg_lo:[1,0,0]
    v_pk_fma_f32 v[56:57], v[24:25], v[62:63], v[56:57] op_sel:[1,1,0] op_sel_hi:[1,0,1] neg_lo:[1,0,0]
    v_pk_fma_f32 v[66:67], v[64:65], v[26:27], v[66:67] op_sel:[1,1,0] op_sel_hi:[1,0,1] neg_lo:[1,0,0]
    v_cvt_pk_bf16_f32 v41, v54, v55
    ds_write_addtid_b32 v41 offset:3264
    v_cvt_pk_bf16_f32 v42, v52, v53
    ds_write_addtid_b32 v42 offset:7616
    v_cvt_pk_bf16_f32 v43, v50, v51
    ds_write_addtid_b32 v43 offset:12512
    v_cvt_pk_bf16_f32 v40, v24, v25
    ds_write_addtid_b32 v40 offset:14688
    v_cvt_pk_bf16_f32 v41, v64, v65
    s_mov_b32 m0, s70
    s_nop 0
    ds_write_addtid_b32 v41 offset:32768
    v_pk_mul_f32 v[52:53], v[44:45], v[28:29] op_sel:[0,0] op_sel_hi:[0,1]
    v_pk_mul_f32 v[64:65], v[66:67], v[26:27] op_sel:[0,0] op_sel_hi:[0,1]
    v_pk_fma_f32 v[52:53], v[44:45], v[28:29], v[52:53] op_sel:[1,1,0] op_sel_hi:[1,0,1] neg_lo:[1,0,0]
    v_pk_fma_f32 v[64:65], v[66:67], v[26:27], v[64:65] op_sel:[1,1,0] op_sel_hi:[1,0,1] neg_lo:[1,0,0]
    v_cvt_pk_bf16_f32 v42, v48, v49
    s_mov_b32 m0, s66
    s_nop 0
    ds_write_addtid_b32 v42 offset:3808
    v_cvt_pk_bf16_f32 v43, v44, v45
    ds_write_addtid_b32 v43 offset:8160
    v_cvt_pk_bf16_f32 v40, v56, v57
    ds_write_addtid_b32 v40 offset:15776
    v_cvt_pk_bf16_f32 v41, v66, v67
    s_mov_b32 m0, s70
    s_nop 0
    ds_write_addtid_b32 v41 offset:33856
    v_pk_mul_f32 v[66:67], v[64:65], v[26:27] op_sel:[0,0] op_sel_hi:[0,1]
    v_pk_fma_f32 v[66:67], v[64:65], v[26:27], v[66:67] op_sel:[1,1,0] op_sel_hi:[1,0,1] neg_lo:[1,0,0]
    v_cvt_pk_bf16_f32 v42, v52, v53
    s_mov_b32 m0, s66
    s_nop 0
    ds_write_addtid_b32 v42 offset:8704
    v_cvt_pk_bf16_f32 v43, v64, v65
    s_mov_b32 m0, s70
    s_nop 0
    ds_write_addtid_b32 v43 offset:37120
    v_cvt_pk_bf16_f32 v40, v66, v67
    ds_write_addtid_b32 v40 offset:38208
C_MFMA:
    s_mul_i32 s56, s2, 16384
    s_lshl_b32 s57, s38, 12
    s_add_u32 s56, s56, s57
    s_add_u32 s56, s56, 5226496
    s_mov_b64 exec, 0x1
    ds_inc_u32 v166, v166 offset:12
    s_mov_b64 exec, -1
    ds_write_b32 v113, v112
    s_setprio 2
    s_movk_i32 s60, 4000
C_KG:
    ds_read_b32 v16, v166 offset:12
    s_sub_u32 s60, s60, 1
    s_cmp_gt_i32 s60, 0
    s_waitcnt lgkmcnt(0)
    v_readfirstlane_b32 s52, v16
    s_nop 0
    s_cselect_b32 s52, s52, 4
    s_cmp_lg_u32 s52, 4
    s_cbranch_scc1 C_KG
    ds_read_b128 v[16:19], v111 offset:0
    ds_read_b128 v[20:23], v110 offset:0
    ds_read_b128 v[24:27], v111 offset:64
    ds_read_b128 v[28:31], v110 offset:64
    ds_read_b128 v[32:35], v111 offset:128
    ds_read_b128 v[36:39], v110 offset:128
    ds_read_b128 v[40:43], v111 offset:192
    ds_read_b128 v[44:47], v110 offset:192
    ds_read_b128 v[48:51], v111 offset:256
    ds_read_b128 v[52:55], v110 offset:256
    ds_read_b128 v[56:59], v111 offset:320
    ds_read_b128 v[60:63], v110 offset:320
    ds_read_b128 v[64:67], v111 offset:384
    ds_read_b128 v[68:71], v110 offset:384
    ds_read_b128 v[72:75], v111 offset:448
    ds_read_b128 v[76:79], v110 offset:448
    s_lshl_b32 s53, s63, 10
    s_sub_u32 s52, s64, s53
    s_add_u32 s52, s52, 3576
    v_and_b32 v165, 1, v5
    v_lshl_add_u32 v165, v6, 1, v165
    s_mul_i32 s53, s65, 384
    s_add_u32 s53, s53, 161920
    v_lshl_add_u32 v165, v165, 4, s53
    v_lshlrev_b32 v2, 3, v2
    v_sub_u32 v2, s52, v2
    s_mul_i32 s68, s63, 1088
    s_add_u32 s68, s68, s71
    v_lshl_add_u32 v15, v15, 3, s68
    s_cmp_lg_u32 s63, 0
    s_cbranch_scc1 C_LA1
    s_lshr_b32 s52, s2, 3
    s_mul_i32 s52, s52, 3
    s_add_u32 s52, s52, s65
    s_lshl_b32 s52, s52, 3
    s_and_b32 s53, s2, 7
    v_and_b32 v11, 7, v1
    v_add_u32 v11, s52, v11
    v_and_b32 v12, 56, v1
    v_mul_u32_u24 v13, 0x48, v11
    v_add3_u32 v14, v12, v13, s53
    v_lshlrev_b32 v14, 7, v14
    s_add_u32 s53, s53, 64
    v_add_lshl_u32 v13, v13, s53, 7
    s_mul_i32 s53, s53, 0x240
    v_add_lshl_u32 v12, v11, s53, 7
    v_mov_b32 v10, 0
    v_lshrrev_b32 v9, 3, v1
    v_mul_u32_u24 v9, 3328, v9
    v_add3_u32 v9, v9, v3, s59
    s_branch C_LA2
C_LA1:
    v_and_b32 v93, 3, v5
    v_lshl_add_u32 v94, v6, 3, v11
    v_and_b32 v92, 1, v11
    v_mul_u32_u24 v92, 3456, v92
    v_add_u32 v92, s59, v92
    v_sub_u32 v93, v93, v94
    v_sub_u32 v94, v93, v94
    v_add_u32 v95, 44, v93
    v_lshrrev_b32 v96, 4, v95
    v_add_u32 v95, v95, v96
    v_lshl_add_u32 v11, v95, 3, v92
    v_add_u32 v95, 75, v94
    v_lshrrev_b32 v96, 4, v95
    v_add_u32 v95, v95, v96
    v_lshl_add_u32 v13, v95, 3, v92
    v_add_u32 v95, 40, v93
    v_lshrrev_b32 v96, 4, v95
    v_add_u32 v95, v95, v96
    v_lshl_add_u32 v12, v95, 3, v92
    v_add_u32 v95, 67, v94
    v_lshrrev_b32 v96, 4, v95
    v_add_u32 v95, v95, v96
    v_lshl_add_u32 v14, v95, 3, v92
C_LA2:
    s_cmp_eq_u32 s69, 2
    s_cbranch_scc1 C_T2
    v_lshrrev_b32 v89, 1, v6
    v_xor_b32 v88, v89, v6
    v_and_b32 v88, 1, v88
    v_lshlrev_b32 v88, 8, v88
    v_lshl_add_u32 v88, v89, 3, v88
    v_lshl_add_u32 v88, v5, 4, v88
    s_cmp_eq_u32 s69, 1
    s_cbranch_scc1 C_T1
    s_lshr_b32 s52, s69, 1
    s_mul_i32 s53, s52, 1600
    s_add_u32 s53, s53, s67
    v_add_u32 v88, s53, v88
    v_add_u32 v89, 3200, v88
    s_xor_b32 s52, s52, 1
    s_mov_b32 s53, 0
    s_waitcnt lgkmcnt(14)
    v_mfma_f32_16x16x32_bf16 v[80:83], v[16:19], v[20:23], 0
    s_waitcnt lgkmcnt(12)
    v_mfma_f32_16x16x32_bf16 v[84:87], v[24:27], v[28:31], 0
    s_waitcnt lgkmcnt(10)
    v_mfma_f32_16x16x32_bf16 v[80:83], v[32:35], v[36:39], v[80:83]
    s_waitcnt lgkmcnt(8)
    v_mfma_f32_16x16x32_bf16 v[84:87], v[40:43], v[44:47], v[84:87]
    s_waitcnt lgkmcnt(6)
    v_mfma_f32_16x16x32_bf16 v[80:83], v[48:51], v[52:55], v[80:83]
    s_waitcnt lgkmcnt(4)
    v_mfma_f32_16x16x32_bf16 v[84:87], v[56:59], v[60:63], v[84:87]
    s_waitcnt lgkmcnt(2)
    v_mfma_f32_16x16x32_bf16 v[80:83], v[64:67], v[68:71], v[80:83]
    s_waitcnt lgkmcnt(0)
    v_mfma_f32_16x16x32_bf16 v[84:87], v[72:75], v[76:79], v[84:87]
    s_nop 7
    v_pk_add_f32 v[80:81], v[80:81], v[84:85]
    v_pk_add_f32 v[82:83], v[82:83], v[86:87]
    v_cvt_pk_bf16_f32 v80, v80, v81
    v_cvt_pk_bf16_f32 v81, v82, v83
    ds_write_b64 v88, v[80:81] offset:32
    ds_write2_b32 v89, v80, v81 offset0:7 offset1:8
    s_mov_b64 exec, s[52:53]
    ds_write_b16 v88, v80 offset:1630
    ds_write_b16 v88, v80 offset:4826
    s_mov_b64 exec, -1
    s_branch C_B3
C_T1:
    s_add_u32 s53, s67, 544
    v_add_u32 v88, s53, v88
    v_add_u32 v89, 1600, v88
    s_waitcnt lgkmcnt(14)
    v_mfma_f32_16x16x32_bf16 v[80:83], v[16:19], v[20:23], 0
    s_waitcnt lgkmcnt(12)
    v_mfma_f32_16x16x32_bf16 v[84:87], v[24:27], v[28:31], 0
    s_waitcnt lgkmcnt(10)
    v_mfma_f32_16x16x32_bf16 v[80:83], v[32:35], v[36:39], v[80:83]
    s_waitcnt lgkmcnt(8)
    v_mfma_f32_16x16x32_bf16 v[84:87], v[40:43], v[44:47], v[84:87]
    s_waitcnt lgkmcnt(6)
    v_mfma_f32_16x16x32_bf16 v[80:83], v[48:51], v[52:55], v[80:83]
    s_waitcnt lgkmcnt(4)
    v_mfma_f32_16x16x32_bf16 v[84:87], v[56:59], v[60:63], v[84:87]
    s_waitcnt lgkmcnt(2)
    v_mfma_f32_16x16x32_bf16 v[80:83], v[64:67], v[68:71], v[80:83]
    s_waitcnt lgkmcnt(0)
    v_mfma_f32_16x16x32_bf16 v[84:87], v[72:75], v[76:79], v[84:87]
    s_nop 7
    v_pk_add_f32 v[80:81], v[80:81], v[84:85]
    v_pk_add_f32 v[82:83], v[82:83], v[86:87]
    v_cvt_pk_bf16_f32 v16, v81, v82
    v_cvt_pk_bf16_f32 v17, v82, v82
    v_cvt_pk_bf16_f32 v18, v82, v82
    v_cvt_pk_bf16_f32 v19, v82, v83
    ds_write2_b32 v88, v16, v17 offset0:1 offset1:2
    ds_write_b64 v88, v[16:17] offset:3200
    ds_write2_b32 v89, v18, v19 offset0:1 offset1:2
    ds_write_b64 v88, v[18:19] offset:4800
    v_cvt_pk_bf16_f32 v20, v80, v80
    v_cvt_pk_bf16_f32 v21, v80, v81
    s_mov_b64 exec, 0x1
    ds_write_b32 v88, v20
    ds_write_b32 v88, v20 offset:3196
    ds_write_b32 v88, v21 offset:1600
    ds_write_b32 v88, v21 offset:4796
    s_mov_b32 exec_lo, 0x0
    s_mov_b32 exec_hi, 0x8000
    ds_write_b16 v88, v17 offset:12
    ds_write_b16 v88, v17 offset:1610
    ds_write_b16 v88, v17 offset:3208
    ds_write_b16 v88, v17 offset:4806
    s_mov_b64 exec, -1
    s_branch C_B3
C_T2:
    v_lshlrev_b32 v88, 7, v6
    v_lshl_add_u32 v89, v5, 1, v88
    v_lshl_add_u32 v88, v5, 2, v88
    s_add_u32 s52, s64, 4728
    v_add_u32 v88, s52, v88
    s_add_u32 s52, s64, 4920
    v_add_u32 v89, s52, v89
    v_mov_b32 v90, s67
    s_waitcnt lgkmcnt(14)
    v_mfma_f32_16x16x32_bf16 v[80:83], v[16:19], v[20:23], 0
    s_waitcnt lgkmcnt(12)
    v_mfma_f32_16x16x32_bf16 v[84:87], v[24:27], v[28:31], 0
    s_waitcnt lgkmcnt(10)
    v_mfma_f32_16x16x32_bf16 v[80:83], v[32:35], v[36:39], v[80:83]
    s_waitcnt lgkmcnt(8)
    v_mfma_f32_16x16x32_bf16 v[84:87], v[40:43], v[44:47], v[84:87]
    s_waitcnt lgkmcnt(6)
    v_mfma_f32_16x16x32_bf16 v[80:83], v[48:51], v[52:55], v[80:83]
    s_waitcnt lgkmcnt(4)
    v_mfma_f32_16x16x32_bf16 v[84:87], v[56:59], v[60:63], v[84:87]
    s_waitcnt lgkmcnt(2)
    v_mfma_f32_16x16x32_bf16 v[80:83], v[64:67], v[68:71], v[80:83]
    s_waitcnt lgkmcnt(0)
    v_mfma_f32_16x16x32_bf16 v[84:87], v[72:75], v[76:79], v[84:87]
    s_nop 7
    v_pk_add_f32 v[80:81], v[80:81], v[84:85]
    v_pk_add_f32 v[82:83], v[82:83], v[86:87]
    v_cvt_pk_bf16_f32 v80, v80, v81
    v_cvt_pk_bf16_f32 v81, v82, v83
    s_mov_b32 exec_hi, 0
    ds_write2_b32 v88, v80, v81 offset0:0 offset1:16
    s_not_b64 exec, exec
    ds_write_b16 v89, v80 offset:4
    ds_write_b16_d16_hi v89, v80 offset:36
    ds_write_b16 v89, v81 offset:68
    ds_write_b16_d16_hi v89, v81 offset:100
    ds_write_b16 v89, v80 offset:384
    ds_write_b16_d16_hi v89, v80 offset:416
    ds_write_b16 v89, v81 offset:448
    ds_write_b16_d16_hi v89, v81 offset:480
    s_mov_b32 exec_lo, 0x80000000
    s_mov_b32 exec_hi, 0x0
    ds_write_b16_d16_hi v90, v81 offset:1126
    ds_write_b16_d16_hi v90, v81 offset:1128
    ds_write_b16_d16_hi v90, v81 offset:2724
    ds_write_b16_d16_hi v90, v81 offset:2726
    ds_write_b16_d16_hi v90, v81 offset:4322
    ds_write_b16_d16_hi v90, v81 offset:4324
    ds_write_b16_d16_hi v90, v81 offset:5920
    ds_write_b16_d16_hi v90, v81 offset:5922
    s_mov_b64 exec, -1
C_B3:
    s_mov_b64 exec, 0x1
    ds_inc_u32 v166, v166 offset:128
    s_mov_b64 exec, -1
    s_mov_b32 s61, s65
    s_cmp_lg_u32 s65, 1
    s_cbranch_scc1 C_NOUL
    s_waitcnt vmcnt(0)
    buffer_load_dwordx4 v[24:27], v3, s[40:43], s56 offen offset:0 sc1
    buffer_load_dwordx4 v[28:31], v3, s[40:43], s56 offen offset:1024 sc1
    buffer_load_dwordx4 v[32:35], v3, s[40:43], s56 offen offset:2048 sc1
    buffer_load_dwordx4 v[36:39], v3, s[40:43], s56 offen offset:3072 sc1
C_NOUL:
    s_movk_i32 s60, 4000
C_KM:
    ds_read_b128 v[16:19], v166 offset:128
    s_sub_u32 s60, s60, 1
    s_cmp_gt_i32 s60, 0
    s_waitcnt lgkmcnt(0)
    v_add_u32 v16, v16, v18
    s_nop 0
    v_readfirstlane_b32 s52, v16
    s_nop 0
    s_cselect_b32 s52, s52, 5
    s_cmp_lg_u32 s52, 5
    s_cbranch_scc1 C_KM
    s_setprio 3
    ds_read_b64 v[48:49], v7 offset:0
    ds_read_b64 v[50:51], v7 offset:8
    ds_read_b64 v[52:53], v7 offset:64
    ds_read_b64 v[54:55], v7 offset:72
    ds_read_b64 v[56:57], v7 offset:128
    ds_read_b64 v[58:59], v7 offset:136
    ds_read_b64 v[60:61], v7 offset:192
    ds_read_b64 v[62:63], v7 offset:200
    ds_read_b64 v[64:65], v7 offset:256
    ds_read_b64 v[66:67], v7 offset:264
    ds_read_b64 v[68:69], v7 offset:320
    ds_read_b64 v[70:71], v7 offset:328
    ds_read_b64 v[72:73], v7 offset:384
    ds_read_b64 v[74:75], v7 offset:392
    ds_read_b64 v[76:77], v7 offset:448
    ds_read_b64 v[78:79], v7 offset:456
    ds_read_b64 v[80:81], v7 offset:512
    ds_read_b64 v[82:83], v7 offset:520
    ds_read_b64 v[84:85], v7 offset:576
    ds_read_b64 v[86:87], v7 offset:584
    ds_read_b64 v[88:89], v7 offset:640
    ds_read_b64 v[90:91], v7 offset:648
    ds_read_b64 v[92:93], v7 offset:704
    ds_read_b64 v[94:95], v7 offset:712
    ds_read_b64 v[96:97], v7 offset:768
    ds_read_b64 v[98:99], v7 offset:776
    ds_read_b64 v[100:101], v7 offset:832
    ds_read_b64 v[102:103], v7 offset:840
    ds_read_b64 v[104:105], v7 offset:896
    ds_read_b64 v[106:107], v7 offset:904
    ds_read_b64 v[108:109], v7 offset:960
    ds_read_b64 v[110:111], v7 offset:968
    s_cmp_eq_u32 s63, 1
    s_cbranch_scc1 C_E1
    s_cmp_eq_u32 s63, 2
    s_cbranch_scc1 C_E2
    s_cmp_eq_u32 s63, 3
    s_cbranch_scc1 C_E3
    ds_read_b64 v[112:113], v7 offset:1152
    ds_read_b64 v[114:115], v7 offset:1160
    ds_read_b64 v[116:117], v7 offset:1216
    ds_read_b64 v[118:119], v7 offset:1224
    ds_read_b64 v[128:129], v7 offset:1280
    ds_read_b64 v[130:131], v7 offset:1288
    ds_read_b64 v[132:133], v7 offset:1344
    ds_read_b64 v[134:135], v7 offset:1352
    s_mov_b32 exec_hi, 0
    ds_write_b128 v9, v[160:163]
    s_mov_b64 exec, -1
    s_branch C_EE
C_E1:
    ds_read_b64 v[128:129], v7 offset:1152
    ds_read_b64 v[130:131], v7 offset:1160
    ds_read_b64 v[132:133], v7 offset:1216
    ds_read_b64 v[134:135], v7 offset:1224
    ds_read_b64 v[136:137], v7 offset:1280
    ds_read_b64 v[138:139], v7 offset:1288
    ds_read_b64 v[140:141], v7 offset:1344
    ds_read_b64 v[142:143], v7 offset:1352
    ds_read_b64 v[112:113], v7 offset:1024
    ds_read_b64 v[114:115], v7 offset:1032
    s_branch C_EE
C_E2:
    ds_read_b64 v[152:153], v7 offset:1152
    ds_read_b64 v[154:155], v7 offset:1160
    ds_read_b64 v[156:157], v7 offset:1216
    ds_read_b64 v[158:159], v7 offset:1224
    ds_read_b64 v[112:113], v7 offset:1024
    ds_read_b64 v[114:115], v7 offset:1032
    ds_read_b64 v[128:129], v9 offset:4608
    ds_read_b64 v[130:131], v9 offset:4616
    ds_read_b64 v[132:133], v9 offset:4672
    ds_read_b64 v[134:135], v9 offset:4680
    ds_read_b64 v[136:137], v9 offset:4736
    ds_read_b64 v[138:139], v9 offset:4744
    ds_read_b64 v[140:141], v9 offset:4800
    ds_read_b64 v[142:143], v9 offset:4808
    ds_read_b64 v[144:145], v9 offset:4864
    ds_read_b64 v[146:147], v9 offset:4872
    ds_read_b64 v[148:149], v9 offset:4928
    ds_read_b64 v[150:151], v9 offset:4936
    s_branch C_EE
C_E3:
    ds_read_b64 v[112:113], v7 offset:1024
    ds_read_b64 v[114:115], v7 offset:1032
    ds_read_b64 v[116:117], v7 offset:1088
    ds_read_b64 v[118:119], v7 offset:1096
    ds_read_b64 v[128:129], v9 offset:4608
    ds_read_b64 v[130:131], v9 offset:4616
    ds_read_b64 v[132:133], v9 offset:4672
    ds_read_b64 v[134:135], v9 offset:4680
    ds_read_b64 v[136:137], v9 offset:4736
    ds_read_b64 v[138:139], v9 offset:4744
    ds_read_b64 v[140:141], v9 offset:4800
    ds_read_b64 v[142:143], v9 offset:4808
    ds_read_b64 v[144:145], v9 offset:4864
    ds_read_b64 v[146:147], v9 offset:4872
    ds_read_b64 v[148:149], v9 offset:4928
    ds_read_b64 v[150:151], v9 offset:4936
    ds_read_b64 v[152:153], v10 offset:5120
    ds_read_b64 v[154:155], v10 offset:5128
    ds_read_b64 v[156:157], v10 offset:5184
    ds_read_b64 v[158:159], v10 offset:5192
    ds_read_b64 v[120:121], v10 offset:5248
    ds_read_b64 v[122:123], v10 offset:5256
    ds_read_b64 v[124:125], v10 offset:5312
    ds_read_b64 v[126:127], v10 offset:5320
C_EE:
    v_mov_b32 v167, v19
    v_readfirstlane_b32 s39, v19
    v_mul_u32_u24 v5, 37, v1
    v_lshrrev_b32 v5, 8, v5
    v_mul_u32_u24 v5, 1040, v5
    v_add_u32 v5, v5, v3
    v_add_u32 v6, 0x2400, v5
    s_mul_i32 s44, s2, 18432
    s_mul_i32 s45, s38, 96
    s_add_u32 s44, s44, s45
    s_add_u32 s72, s4, s44
    s_addc_u32 s73, s5, 0
    s_add_u32 s74, s24, s45
    s_addc_u32 s75, s25, 0
    s_mul_i32 s58, s69, 1920
    s_add_u32 s58, s58, s71
    s_add_u32 s58, s58, 4352
    s_cmp_lt_u32 s38, 4
    s_cbranch_scc1 C_B5
    v_mov_b32 v40, -1
    v_mov_b32 v41, -1
    v_mov_b32 v42, -1
    v_mov_b32 v43, -1
    v_lshlrev_b32 v20, 4, v0
    v_lshlrev_b32 v21, 2, v0
    s_cmp_lg_u32 s61, 1
    s_cbranch_scc1 C_PO
    s_movk_i32 s60, 4000
    s_branch C_UP_W
C_UP:
    buffer_load_dwordx4 v[24:27], v3, s[40:43], s56 offen offset:0 sc1
    buffer_load_dwordx4 v[28:31], v3, s[40:43], s56 offen offset:1024 sc1
    buffer_load_dwordx4 v[32:35], v3, s[40:43], s56 offen offset:2048 sc1
    buffer_load_dwordx4 v[36:39], v3, s[40:43], s56 offen offset:3072 sc1
C_UP_W:
    s_waitcnt vmcnt(0)
C_UP_C:
    v_xor_b32 v44, v167, v27
    v_xor_b32 v45, v167, v31
    v_xor_b32 v46, v167, v35
    v_xor_b32 v47, v167, v39
    v_or3_b32 v44, v44, v45, v46
    v_or_b32 v44, v44, v47
    v_cmp_ne_u32 vcc, 0, v44
    s_nop 0
    s_and_b64 exec, exec, vcc
    s_cbranch_execz C_UP_D
    s_wqm_b64 exec, exec
    s_sub_u32 s60, s60, 1
    s_cmp_gt_i32 s60, 0
    s_sleep 2
    s_cbranch_scc1 C_UP
C_UP_D:
    s_mov_b64 exec, -1
    s_lshl_b32 s52, s38, 10
    s_add_u32 m0, s52, 47936
    v_add_u32 v18, 161412, v3
    ds_write_addtid_b32 v25 offset:55040
    ds_write_addtid_b32 v29 offset:55296
    ds_write_addtid_b32 v33 offset:55552
    ds_write_addtid_b32 v37 offset:55808
    s_mov_b64 exec, 0x2
    ds_inc_u32 v18, v18
    s_mov_b64 exec, -1
    ds_write_addtid_b32 v26 offset:60928
    ds_write_addtid_b32 v30 offset:61184
    ds_write_addtid_b32 v34 offset:61440
    ds_write_addtid_b32 v38 offset:61696
    s_mov_b64 exec, 0x4
    ds_inc_u32 v18, v18
    s_mov_b64 exec, -1
    ds_write_addtid_b32 v24 offset:49152
    ds_write_addtid_b32 v28 offset:49408
    ds_write_addtid_b32 v32 offset:49664
    ds_write_addtid_b32 v36 offset:49920
    s_mov_b64 exec, 0x1
    ds_inc_u32 v18, v18
    s_mov_b64 exec, -1
C_PO:
    s_cmp_ge_u32 s50, 144
    s_cbranch_scc1 C_B5
    buffer_store_dwordx4 v[40:43], v20, s[40:43], s48 offen sc1
    buffer_store_dword v40, v21, s[40:43], s49 offen sc1
    s_cmp_lt_u32 s2, 128
    s_cselect_b32 s52, 8, -1
    s_cmp_lg_u32 s38, s52
    s_cbranch_scc1 C_B5
    v_lshrrev_b32 v22, 2, v1
    v_mul_u32_u24 v22, 8128, v22
    v_add_u32 v22, v22, v3
    s_mul_i32 s52, s2, 64
    s_add_u32 s52, s52, 65536
    s_mov_b32 exec_lo, 0xffffffff
    s_mov_b32 exec_hi, 0x0
    buffer_store_dwordx4 v[40:43], v22, s[40:43], s52 offen sc1
    s_mov_b64 exec, -1
C_B5:
    s_mov_b32 s56, 0xf7efdfbf
    s_mov_b32 s57, 0x7efdfb
    s_movk_i32 s60, 4000
C_UF:
    ds_read_b32 v16, v166 offset:132
    s_sub_u32 s60, s60, 1
    s_cmp_gt_i32 s60, 0
    s_waitcnt lgkmcnt(0)
    v_readfirstlane_b32 s52, v16
    s_nop 0
    s_cselect_b32 s52, s52, 4
    s_cmp_lg_u32 s52, 4
    s_cbranch_scc1 C_UF
    s_movk_i32 s60, 4000
    s_cmp_eq_u32 s63, 1
    s_cbranch_scc1 C_P1
    s_cmp_eq_u32 s63, 2
    s_cbranch_scc1 C_P2
    s_cmp_eq_u32 s63, 3
    s_cbranch_scc1 C_P3
    s_setprio 2
    ds_read_b128 v[32:35], v8 offset:3552
    ds_read_b128 v[36:39], v8 offset:4064
    ds_read_b128 v[40:43], v8 offset:3680
    s_waitcnt lgkmcnt(2)
    v_mfma_f32_16x16x32_bf16 v[136:139], v[112:115], v[32:35], 0
    v_mfma_f32_16x16x32_bf16 v[140:143], v[116:119], v[32:35], 0
    v_mfma_f32_16x16x32_bf16 v[144:147], v[128:131], v[32:35], 0
    v_mfma_f32_16x16x32_bf16 v[148:151], v[132:135], v[32:35], 0
    v_mfma_f32_16x16x32_bf16 v[28:31], v[52:55], v[32:35], 0
    v_mfma_f32_16x16x32_bf16 v[20:23], v[48:51], v[32:35], 0
    ds_read_b128 v[44:47], v8 offset:3808
    s_waitcnt lgkmcnt(2)
    v_mfma_f32_16x16x32_bf16 v[152:155], v[112:115], v[36:39], 0
    v_mfma_f32_16x16x32_bf16 v[156:159], v[116:119], v[36:39], 0
    v_mfma_f32_16x16x32_bf16 v[120:123], v[128:131], v[36:39], 0
    v_mfma_f32_16x16x32_bf16 v[124:127], v[132:135], v[36:39], 0
    v_mfma_f32_16x16x32_bf16 v[28:31], v[84:87], v[36:39], v[28:31]
    v_mfma_f32_16x16x32_bf16 v[20:23], v[80:83], v[36:39], v[20:23]
    v_mfma_f32_16x16x32_bf16 v[24:27], v[52:55], v[36:39], 0
    v_mfma_f32_16x16x32_bf16 v[16:19], v[48:51], v[36:39], 0
    v_cvt_pk_bf16_f32 v136, v136, v137
    v_cvt_pk_bf16_f32 v137, v138, v139
    ds_write_b64 v4, v[136:137] offset:680
    v_cvt_pk_bf16_f32 v140, v140, v141
    v_cvt_pk_bf16_f32 v141, v142, v143
    ds_write_b64 v4, v[140:141] offset:4136
    v_cvt_pk_bf16_f32 v144, v144, v145
    v_cvt_pk_bf16_f32 v145, v146, v147
    ds_write_b64 v4, v[144:145] offset:7592
    v_cvt_pk_bf16_f32 v148, v148, v149
    v_cvt_pk_bf16_f32 v149, v150, v151
    ds_write_b64 v4, v[148:149] offset:11048
    ds_read_b128 v[32:35], v8 offset:3936
    s_waitcnt lgkmcnt(6)
    v_mfma_f32_16x16x32_bf16 v[28:31], v[60:63], v[40:43], v[28:31]
    v_mfma_f32_16x16x32_bf16 v[20:23], v[56:59], v[40:43], v[20:23]
    v_cvt_pk_bf16_f32 v152, v152, v153
    v_cvt_pk_bf16_f32 v153, v154, v155
    ds_write_b64 v4, v[152:153] offset:136
    v_cvt_pk_bf16_f32 v156, v156, v157
    v_cvt_pk_bf16_f32 v157, v158, v159
    ds_write_b64 v4, v[156:157] offset:3592
    v_cvt_pk_bf16_f32 v120, v120, v121
    v_cvt_pk_bf16_f32 v121, v122, v123
    ds_write_b64 v4, v[120:121] offset:7048
    v_cvt_pk_bf16_f32 v124, v124, v125
    v_cvt_pk_bf16_f32 v125, v126, v127
    ds_write_b64 v4, v[124:125] offset:10504
    s_mov_b64 exec, 0x1
    ds_write_b32 v166, v166 offset:0
    s_mov_b64 exec, -1
    s_setprio 0
    ds_read_b128 v[84:87], v8 offset:4192
    ds_read_b64 v[160:161], v2 offset:512
    ds_read_b64 v[162:163], v2
    s_or_b32 s52, s38, s2
    s_cbranch_scc1 C_NOEP
    s_mov_b64 exec, 0x1
    buffer_store_dword v167, v10, s[40:43], 0 offen sc1
    s_mov_b64 exec, -1
C_NOEP:
    s_cmp_ge_u32 s2, 128
    s_cbranch_scc1 C_NX0
    s_mov_b32 m0, s58
    s_mov_b64 exec, s[56:57]
    global_load_lds_dwordx4 v5, s[72:73]
    s_add_u32 m0, s58, 896
    s_nop 0
    global_load_lds_dwordx4 v6, s[72:73]
    s_add_u32 m0, s58, 1792
    s_mov_b64 exec, 0x3f
    global_load_lds_dwordx4 v3, s[74:75]
    s_mov_b64 exec, -1
C_NX0:
    s_mov_b32 m0, 163328
    s_nop 0
    global_load_lds_dword v14, s[28:29]
    s_mov_b64 exec, 0xff
    global_load_lds_dword v13, s[28:29]
    global_load_lds_dword v13, s[26:27]
    global_load_lds_dword v12, s[30:31]
    s_mov_b64 exec, -1
    s_waitcnt lgkmcnt(13)
    v_mfma_f32_16x16x32_bf16 v[28:31], v[68:71], v[44:47], v[28:31]
    v_mfma_f32_16x16x32_bf16 v[20:23], v[64:67], v[44:47], v[20:23]
    ds_read_b128 v[80:83], v8 offset:4320
    s_waitcnt lgkmcnt(9)
    v_mfma_f32_16x16x32_bf16 v[28:31], v[76:79], v[32:35], v[28:31]
    v_mfma_f32_16x16x32_bf16 v[20:23], v[72:75], v[32:35], v[20:23]
    ds_read_b128 v[36:39], v8 offset:4448
    s_waitcnt lgkmcnt(2)
    v_and_b32 v48, 0xffff0000, v161
    v_lshlrev_b32 v49, 16, v161
    v_and_b32 v50, 0xffff0000, v160
    v_lshlrev_b32 v51, 16, v160
    v_mul_f32 v48, v48, v164
    v_mul_f32 v49, v49, v164
    v_mul_f32 v50, v50, v164
    v_mul_f32 v51, v51, v164
    v_cvt_pk_bf16_f32 v49, v48, v49
    v_lshlrev_b32 v48, 16, v49
    v_and_b32 v49, 0xffff0000, v49
    v_cvt_pk_bf16_f32 v51, v50, v51
    v_lshlrev_b32 v50, 16, v51
    v_and_b32 v51, 0xffff0000, v51
    v_and_b32 v52, 0xffff0000, v163
    v_lshlrev_b32 v53, 16, v163
    v_and_b32 v54, 0xffff0000, v162
    v_lshlrev_b32 v55, 16, v162
    v_mul_f32 v52, v52, v164
    v_mul_f32 v53, v53, v164
    v_mul_f32 v54, v54, v164
    v_mul_f32 v55, v55, v164
    v_cvt_pk_bf16_f32 v53, v52, v53
    v_lshlrev_b32 v52, 16, v53
    v_and_b32 v53, 0xffff0000, v53
    v_cvt_pk_bf16_f32 v55, v54, v55
    v_lshlrev_b32 v54, 16, v55
    v_and_b32 v55, 0xffff0000, v55
    v_mfma_f32_16x16x32_bf16 v[28:31], v[92:95], v[84:87], v[28:31]
    v_mfma_f32_16x16x32_bf16 v[20:23], v[88:91], v[84:87], v[20:23]
    v_mfma_f32_16x16x32_bf16 v[24:27], v[60:63], v[84:87], v[24:27]
    v_mfma_f32_16x16x32_bf16 v[16:19], v[56:59], v[84:87], v[16:19]
    s_waitcnt lgkmcnt(1)
    v_mfma_f32_16x16x32_bf16 v[28:31], v[100:103], v[80:83], v[28:31]
    v_mfma_f32_16x16x32_bf16 v[20:23], v[96:99], v[80:83], v[20:23]
    v_mfma_f32_16x16x32_bf16 v[24:27], v[68:71], v[80:83], v[24:27]
    v_mfma_f32_16x16x32_bf16 v[16:19], v[64:67], v[80:83], v[16:19]
    s_waitcnt lgkmcnt(0)
    v_mfma_f32_16x16x32_bf16 v[28:31], v[108:111], v[36:39], v[28:31]
    v_mfma_f32_16x16x32_bf16 v[20:23], v[104:107], v[36:39], v[20:23]
    v_mfma_f32_16x16x32_bf16 v[24:27], v[76:79], v[36:39], v[24:27]
    v_mfma_f32_16x16x32_bf16 v[16:19], v[72:75], v[36:39], v[16:19]
    s_mov_b32 exec_lo, 0xc000c000
    s_mov_b32 exec_hi, 0xc000c000
    s_nop 2
    ds_write_b128 v165, v[28:31] offset:128
    ds_write_b32 v166, v166 offset:64
    s_mov_b64 exec, -1
    s_setprio 0
    s_waitcnt vmcnt(7)
    s_cmp_lt_u32 s2, 128
    s_cbranch_scc1 C_EPI
    s_waitcnt vmcnt(4)
    s_branch C_EPI
C_P1:
    s_setprio 2
    ds_read_b128 v[32:35], v8 offset:2528
    ds_read_b128 v[36:39], v8 offset:3040
    ds_read_b128 v[40:43], v8 offset:2656
    s_waitcnt lgkmcnt(2)
    v_mfma_f32_16x16x32_bf16 v[144:147], v[128:131], v[32:35], 0
    v_mfma_f32_16x16x32_bf16 v[148:151], v[132:135], v[32:35], 0
    v_mfma_f32_16x16x32_bf16 v[152:155], v[136:139], v[32:35], 0
    v_mfma_f32_16x16x32_bf16 v[156:159], v[140:143], v[32:35], 0
    v_mfma_f32_16x16x32_bf16 v[28:31], v[52:55], v[32:35], 0
    v_mfma_f32_16x16x32_bf16 v[20:23], v[48:51], v[32:35], 0
    ds_read_b128 v[44:47], v8 offset:2784
    s_waitcnt lgkmcnt(2)
    v_mfma_f32_16x16x32_bf16 v[116:119], v[128:131], v[36:39], 0
    v_mfma_f32_16x16x32_bf16 v[160:163], v[132:135], v[36:39], 0
    v_mfma_f32_16x16x32_bf16 v[120:123], v[136:139], v[36:39], 0
    v_mfma_f32_16x16x32_bf16 v[124:127], v[140:143], v[36:39], 0
    v_mfma_f32_16x16x32_bf16 v[28:31], v[84:87], v[36:39], v[28:31]
    v_mfma_f32_16x16x32_bf16 v[20:23], v[80:83], v[36:39], v[20:23]
    v_mfma_f32_16x16x32_bf16 v[24:27], v[52:55], v[36:39], 0
    v_mfma_f32_16x16x32_bf16 v[16:19], v[48:51], v[36:39], 0
    v_cvt_pk_bf16_f32 v144, v144, v145
    v_cvt_pk_bf16_f32 v145, v146, v147
    ds_write_b64 v4, v[144:145] offset:1768
    v_cvt_pk_bf16_f32 v148, v148, v149
    v_cvt_pk_bf16_f32 v149, v150, v151
    ds_write_b64 v4, v[148:149] offset:5224
    v_cvt_pk_bf16_f32 v152, v152, v153
    v_cvt_pk_bf16_f32 v153, v154, v155
    ds_write_b64 v4, v[152:153] offset:8680
    v_cvt_pk_bf16_f32 v156, v156, v157
    v_cvt_pk_bf16_f32 v157, v158, v159
    ds_write_b64 v4, v[156:157] offset:12136
    ds_read_b128 v[32:35], v8 offset:2912
    s_waitcnt lgkmcnt(6)
    v_mfma_f32_16x16x32_bf16 v[28:31], v[60:63], v[40:43], v[28:31]
    v_mfma_f32_16x16x32_bf16 v[20:23], v[56:59], v[40:43], v[20:23]
    v_cvt_pk_bf16_f32 v116, v116, v117
    v_cvt_pk_bf16_f32 v117, v118, v119
    ds_write_b64 v4, v[116:117] offset:1224
    v_cvt_pk_bf16_f32 v160, v160, v161
    v_cvt_pk_bf16_f32 v161, v162, v163
    ds_write_b64 v4, v[160:161] offset:4680
    v_cvt_pk_bf16_f32 v120, v120, v121
    v_cvt_pk_bf16_f32 v121, v122, v123
    ds_write_b64 v4, v[120:121] offset:8136
    v_cvt_pk_bf16_f32 v124, v124, v125
    v_cvt_pk_bf16_f32 v125, v126, v127
    ds_write_b64 v4, v[124:125] offset:11592
    s_mov_b64 exec, 0x1
    ds_write_b32 v166, v166 offset:4
    s_mov_b64 exec, -1
    s_setprio 1
    ds_read_b128 v[36:39], v8 offset:3168
    ds_read_b64 v[144:145], v9 offset:4608
    ds_read_b64 v[146:147], v9 offset:4616
    ds_read_b64 v[148:149], v9 offset:4672
    ds_read_b64 v[150:151], v9 offset:4680
    ds_read_b64 v[152:153], v9 offset:4736
    ds_read_b64 v[154:155], v9 offset:4744
    ds_read_b64 v[156:157], v9 offset:4800
    ds_read_b64 v[158:159], v9 offset:4808
    ds_read_b64 v[160:161], v2 offset:512
    ds_read_b64 v[162:163], v2
    s_cmp_ge_u32 s2, 128
    s_cbranch_scc1 C_NX1
    s_mov_b32 m0, s58
    s_mov_b64 exec, s[56:57]
    global_load_lds_dwordx4 v5, s[72:73]
    s_add_u32 m0, s58, 896
    s_nop 0
    global_load_lds_dwordx4 v6, s[72:73]
    s_add_u32 m0, s58, 1792
    s_mov_b64 exec, 0x3f
    global_load_lds_dwordx4 v3, s[74:75]
    s_mov_b64 exec, -1
C_NX1:
    s_waitcnt lgkmcnt(15)
    v_mfma_f32_16x16x32_bf16 v[28:31], v[68:71], v[44:47], v[28:31]
    v_mfma_f32_16x16x32_bf16 v[20:23], v[64:67], v[44:47], v[20:23]
    ds_read_b128 v[40:43], v8 offset:3296
    v_mfma_f32_16x16x32_bf16 v[28:31], v[76:79], v[32:35], v[28:31]
    v_mfma_f32_16x16x32_bf16 v[20:23], v[72:75], v[32:35], v[20:23]
    ds_read_b128 v[128:131], v8 offset:3424
    s_waitcnt lgkmcnt(2)
    v_and_b32 v48, 0xffff0000, v161
    v_lshlrev_b32 v49, 16, v161
    v_and_b32 v50, 0xffff0000, v160
    v_lshlrev_b32 v51, 16, v160
    v_mul_f32 v48, v48, v164
    v_mul_f32 v49, v49, v164
    v_mul_f32 v50, v50, v164
    v_mul_f32 v51, v51, v164
    v_cvt_pk_bf16_f32 v49, v48, v49
    v_lshlrev_b32 v48, 16, v49
    v_and_b32 v49, 0xffff0000, v49
    v_cvt_pk_bf16_f32 v51, v50, v51
    v_lshlrev_b32 v50, 16, v51
    v_and_b32 v51, 0xffff0000, v51
    v_and_b32 v52, 0xffff0000, v163
    v_lshlrev_b32 v53, 16, v163
    v_and_b32 v54, 0xffff0000, v162
    v_lshlrev_b32 v55, 16, v162
    v_mul_f32 v52, v52, v164
    v_mul_f32 v53, v53, v164
    v_mul_f32 v54, v54, v164
    v_mul_f32 v55, v55, v164
    v_cvt_pk_bf16_f32 v53, v52, v53
    v_lshlrev_b32 v52, 16, v53
    v_and_b32 v53, 0xffff0000, v53
    v_cvt_pk_bf16_f32 v55, v54, v55
    v_lshlrev_b32 v54, 16, v55
    v_and_b32 v55, 0xffff0000, v55
    v_mfma_f32_16x16x32_bf16 v[28:31], v[92:95], v[36:39], v[28:31]
    v_mfma_f32_16x16x32_bf16 v[20:23], v[88:91], v[36:39], v[20:23]
    v_mfma_f32_16x16x32_bf16 v[24:27], v[60:63], v[36:39], v[24:27]
    v_mfma_f32_16x16x32_bf16 v[16:19], v[56:59], v[36:39], v[16:19]
    ds_read_b128 v[132:135], v8 offset:3552
    s_waitcnt lgkmcnt(2)
    v_mfma_f32_16x16x32_bf16 v[28:31], v[100:103], v[40:43], v[28:31]
    v_mfma_f32_16x16x32_bf16 v[20:23], v[96:99], v[40:43], v[20:23]
    v_mfma_f32_16x16x32_bf16 v[24:27], v[68:71], v[40:43], v[24:27]
    v_mfma_f32_16x16x32_bf16 v[16:19], v[64:67], v[40:43], v[16:19]
    ds_read_b96 v[60:62], v166
    ds_read_b128 v[136:139], v8 offset:3680
    s_waitcnt lgkmcnt(3)
    v_mfma_f32_16x16x32_bf16 v[28:31], v[108:111], v[128:131], v[28:31]
    v_mfma_f32_16x16x32_bf16 v[20:23], v[104:107], v[128:131], v[20:23]
    v_mfma_f32_16x16x32_bf16 v[24:27], v[76:79], v[128:131], v[24:27]
    v_mfma_f32_16x16x32_bf16 v[16:19], v[72:75], v[128:131], v[16:19]
    s_waitcnt lgkmcnt(1)
C_FL1:
    v_min3_u32 v60, v60, v61, v62
    v_cmp_eq_u32 vcc, 0, v60
    s_nop 4
    s_cbranch_vccz C_FD1
    ds_read_b96 v[60:62], v166
    s_sub_u32 s60, s60, 1
    s_cmp_gt_i32 s60, 0
    s_waitcnt lgkmcnt(0)
    s_cbranch_scc1 C_FL1
C_FD1:
    ds_read_b128 v[140:143], v8 offset:3808
    v_mfma_f32_16x16x32_bf16 v[20:23], v[112:115], v[132:135], v[20:23]
    v_mfma_f32_16x16x32_bf16 v[24:27], v[84:87], v[132:135], v[24:27]
    v_mfma_f32_16x16x32_bf16 v[16:19], v[80:83], v[132:135], v[16:19]
    s_mov_b32 exec_lo, 0xc000c000
    s_mov_b32 exec_hi, 0xc000c000
    ds_write_b128 v165, v[28:31] offset:256
    ds_write_b32 v166, v166 offset:68
    s_mov_b64 exec, -1
    ds_read_b128 v[44:47], v8 offset:3936
    s_waitcnt lgkmcnt(4)
    v_mfma_f32_16x16x32_bf16 v[24:27], v[92:95], v[136:139], v[24:27]
    v_mfma_f32_16x16x32_bf16 v[16:19], v[88:91], v[136:139], v[16:19]
    ds_read_b128 v[32:35], v8 offset:4064
    ds_read_b64_tr_b16 v[36:37], v11 offset:0
    ds_read_b64_tr_b16 v[38:39], v12 offset:0
    ds_read_b64_tr_b16 v[68:69], v11 offset:272
    ds_read_b64_tr_b16 v[70:71], v12 offset:272
    s_waitcnt lgkmcnt(8)
    v_mfma_f32_16x16x32_bf16 v[24:27], v[100:103], v[140:143], v[24:27]
    v_mfma_f32_16x16x32_bf16 v[16:19], v[96:99], v[140:143], v[16:19]
    ds_read_b64_tr_b16 v[64:65], v11 offset:544
    ds_read_b64_tr_b16 v[66:67], v12 offset:544
    s_waitcnt lgkmcnt(7)
    v_mfma_f32_16x16x32_bf16 v[24:27], v[108:111], v[44:47], v[24:27]
    v_mfma_f32_16x16x32_bf16 v[16:19], v[104:107], v[44:47], v[16:19]
    ds_read_b64_tr_b16 v[40:41], v11 offset:816
    ds_read_b64_tr_b16 v[42:43], v12 offset:816
    s_waitcnt lgkmcnt(8)
    v_mfma_f32_16x16x32_bf16 v[16:19], v[112:115], v[32:35], v[16:19]
    s_waitcnt lgkmcnt(6)
    v_mfma_f32_16x16x32_bf16 v[20:23], v[36:39], v[156:159], v[20:23]
    v_mfma_f32_16x16x32_bf16 v[16:19], v[36:39], v[148:151], v[16:19]
    s_waitcnt lgkmcnt(4)
    v_mfma_f32_16x16x32_bf16 v[20:23], v[68:71], v[152:155], v[20:23]
    v_mfma_f32_16x16x32_bf16 v[16:19], v[68:71], v[144:147], v[16:19]
    ds_read_b32 v60, v166 offset:64
    ds_read_b128 v[56:59], v165 offset:128
    s_waitcnt lgkmcnt(4)
    v_mfma_f32_16x16x32_bf16 v[20:23], v[64:67], v[148:151], v[20:23]
    s_waitcnt lgkmcnt(2)
    v_mfma_f32_16x16x32_bf16 v[20:23], v[40:43], v[144:147], v[20:23]
    s_setprio 0
    s_waitcnt lgkmcnt(0)
C_CL1:
    v_cmp_eq_u32 vcc, 0, v60
    s_nop 4
    s_cbranch_vccz C_CD
    ds_read_b32 v60, v166 offset:64
    ds_read_b128 v[56:59], v165 offset:128
    s_sub_u32 s60, s60, 1
    s_cmp_gt_i32 s60, 0
    s_waitcnt lgkmcnt(0)
    s_cbranch_scc1 C_CL1
    s_branch C_CD
C_P2:
    s_setprio 2
    ds_read_b128 v[32:35], v8 offset:1504
    ds_read_b128 v[36:39], v8 offset:2016
    ds_read_b128 v[40:43], v8 offset:1632
    s_waitcnt lgkmcnt(2)
    v_mfma_f32_16x16x32_bf16 v[116:119], v[152:155], v[32:35], 0
    v_mfma_f32_16x16x32_bf16 v[160:163], v[156:159], v[32:35], 0
    v_mfma_f32_16x16x32_bf16 v[28:31], v[52:55], v[32:35], 0
    v_mfma_f32_16x16x32_bf16 v[20:23], v[48:51], v[32:35], 0
    ds_read_b128 v[44:47], v8 offset:1760
    s_waitcnt lgkmcnt(2)
    v_mfma_f32_16x16x32_bf16 v[120:123], v[152:155], v[36:39], 0
    v_mfma_f32_16x16x32_bf16 v[124:127], v[156:159], v[36:39], 0
    v_mfma_f32_16x16x32_bf16 v[28:31], v[84:87], v[36:39], v[28:31]
    v_mfma_f32_16x16x32_bf16 v[20:23], v[80:83], v[36:39], v[20:23]
    v_mfma_f32_16x16x32_bf16 v[24:27], v[52:55], v[36:39], 0
    v_mfma_f32_16x16x32_bf16 v[16:19], v[48:51], v[36:39], 0
    v_cvt_pk_bf16_f32 v116, v116, v117
    v_cvt_pk_bf16_f32 v117, v118, v119
    ds_write_b64 v4, v[116:117] offset:2856
    v_cvt_pk_bf16_f32 v160, v160, v161
    v_cvt_pk_bf16_f32 v161, v162, v163
    ds_write_b64 v4, v[160:161] offset:6312
    ds_read_b128 v[32:35], v8 offset:1888
    s_waitcnt lgkmcnt(4)
    v_mfma_f32_16x16x32_bf16 v[28:31], v[60:63], v[40:43], v[28:31]
    v_mfma_f32_16x16x32_bf16 v[20:23], v[56:59], v[40:43], v[20:23]
    v_cvt_pk_bf16_f32 v120, v120, v121
    v_cvt_pk_bf16_f32 v121, v122, v123
    ds_write_b64 v4, v[120:121] offset:2312
    v_cvt_pk_bf16_f32 v124, v124, v125
    v_cvt_pk_bf16_f32 v125, v126, v127
    ds_write_b64 v4, v[124:125] offset:5768
    s_mov_b64 exec, 0x1
    ds_write_b32 v166, v166 offset:8
    s_mov_b64 exec, -1
    s_setprio 1
    ds_read_b128 v[36:39], v8 offset:2144
    ds_read_b64 v[116:117], v7 offset:1088
    ds_read_b64 v[118:119], v7 offset:1096
    ds_read_b64 v[120:121], v10 offset:5120
    ds_read_b64 v[122:123], v10 offset:5128
    ds_read_b64 v[124:125], v10 offset:5184
    ds_read_b64 v[126:127], v10 offset:5192
    ds_read_b64 v[160:161], v2 offset:512
    ds_read_b64 v[162:163], v2
    s_cmp_ge_u32 s2, 128
    s_cbranch_scc1 C_NX2
    s_mov_b32 m0, s58
    s_mov_b64 exec, s[56:57]
    global_load_lds_dwordx4 v5, s[72:73]
    s_add_u32 m0, s58, 896
    s_nop 0
    global_load_lds_dwordx4 v6, s[72:73]
    s_add_u32 m0, s58, 1792
    s_mov_b64 exec, 0x3f
    global_load_lds_dwordx4 v3, s[74:75]
    s_mov_b64 exec, -1
C_NX2:
    s_waitcnt lgkmcnt(15)
    v_mfma_f32_16x16x32_bf16 v[28:31], v[68:71], v[44:47], v[28:31]
    v_mfma_f32_16x16x32_bf16 v[20:23], v[64:67], v[44:47], v[20:23]
    ds_read_b128 v[40:43], v8 offset:2272
    s_waitcnt lgkmcnt(13)
    v_mfma_f32_16x16x32_bf16 v[28:31], v[76:79], v[32:35], v[28:31]
    v_mfma_f32_16x16x32_bf16 v[20:23], v[72:75], v[32:35], v[20:23]
    ds_read_b128 v[152:155], v8 offset:2400
    s_waitcnt lgkmcnt(2)
    v_and_b32 v48, 0xffff0000, v161
    v_lshlrev_b32 v49, 16, v161
    v_and_b32 v50, 0xffff0000, v160
    v_lshlrev_b32 v51, 16, v160
    v_mul_f32 v48, v48, v164
    v_mul_f32 v49, v49, v164
    v_mul_f32 v50, v50, v164
    v_mul_f32 v51, v51, v164
    v_cvt_pk_bf16_f32 v49, v48, v49
    v_lshlrev_b32 v48, 16, v49
    v_and_b32 v49, 0xffff0000, v49
    v_cvt_pk_bf16_f32 v51, v50, v51
    v_lshlrev_b32 v50, 16, v51
    v_and_b32 v51, 0xffff0000, v51
    v_and_b32 v52, 0xffff0000, v163
    v_lshlrev_b32 v53, 16, v163
    v_and_b32 v54, 0xffff0000, v162
    v_lshlrev_b32 v55, 16, v162
    v_mul_f32 v52, v52, v164
    v_mul_f32 v53, v53, v164
    v_mul_f32 v54, v54, v164
    v_mul_f32 v55, v55, v164
    v_cvt_pk_bf16_f32 v53, v52, v53
    v_lshlrev_b32 v52, 16, v53
    v_and_b32 v53, 0xffff0000, v53
    v_cvt_pk_bf16_f32 v55, v54, v55
    v_lshlrev_b32 v54, 16, v55
    v_and_b32 v55, 0xffff0000, v55
    v_mfma_f32_16x16x32_bf16 v[28:31], v[92:95], v[36:39], v[28:31]
    v_mfma_f32_16x16x32_bf16 v[20:23], v[88:91], v[36:39], v[20:23]
    v_mfma_f32_16x16x32_bf16 v[24:27], v[60:63], v[36:39], v[24:27]
    v_mfma_f32_16x16x32_bf16 v[16:19], v[56:59], v[36:39], v[16:19]
    ds_read_b128 v[156:159], v8 offset:2528
    s_waitcnt lgkmcnt(2)
    v_mfma_f32_16x16x32_bf16 v[28:31], v[100:103], v[40:43], v[28:31]
    v_mfma_f32_16x16x32_bf16 v[20:23], v[96:99], v[40:43], v[20:23]
    v_mfma_f32_16x16x32_bf16 v[24:27], v[68:71], v[40:43], v[24:27]
    v_mfma_f32_16x16x32_bf16 v[16:19], v[64:67], v[40:43], v[16:19]
    ds_read_b128 v[44:47], v8 offset:2656
    s_waitcnt lgkmcnt(2)
    v_mfma_f32_16x16x32_bf16 v[28:31], v[108:111], v[152:155], v[28:31]
    v_mfma_f32_16x16x32_bf16 v[20:23], v[104:107], v[152:155], v[20:23]
    v_mfma_f32_16x16x32_bf16 v[24:27], v[76:79], v[152:155], v[24:27]
    v_mfma_f32_16x16x32_bf16 v[16:19], v[72:75], v[152:155], v[16:19]
    ds_read_b128 v[32:35], v8 offset:2784
    s_waitcnt lgkmcnt(2)
    v_mfma_f32_16x16x32_bf16 v[20:23], v[112:115], v[156:159], v[20:23]
    v_mfma_f32_16x16x32_bf16 v[24:27], v[84:87], v[156:159], v[24:27]
    v_mfma_f32_16x16x32_bf16 v[16:19], v[80:83], v[156:159], v[16:19]
    s_mov_b32 exec_lo, 0xc000c000
    s_mov_b32 exec_hi, 0xc000c000
    ds_write_b128 v165, v[28:31] offset:384
    ds_write_b32 v166, v166 offset:72
    s_mov_b64 exec, -1
    ds_read_b96 v[60:62], v166
    ds_read_b128 v[36:39], v8 offset:2912
    s_waitcnt lgkmcnt(5)
    v_mfma_f32_16x16x32_bf16 v[24:27], v[92:95], v[44:47], v[24:27]
    v_mfma_f32_16x16x32_bf16 v[16:19], v[88:91], v[44:47], v[16:19]
    s_waitcnt lgkmcnt(1)
C_FL2:
    v_min3_u32 v60, v60, v61, v62
    v_cmp_eq_u32 vcc, 0, v60
    s_nop 4
    s_cbranch_vccz C_FD2
    ds_read_b96 v[60:62], v166
    s_sub_u32 s60, s60, 1
    s_cmp_gt_i32 s60, 0
    s_waitcnt lgkmcnt(0)
    s_cbranch_scc1 C_FL2
C_FD2:
    ds_read_b128 v[68:71], v8 offset:3040
    v_mfma_f32_16x16x32_bf16 v[24:27], v[100:103], v[32:35], v[24:27]
    v_mfma_f32_16x16x32_bf16 v[16:19], v[96:99], v[32:35], v[16:19]
    ds_read_b128 v[64:67], v8 offset:3552
    s_waitcnt lgkmcnt(2)
    v_mfma_f32_16x16x32_bf16 v[24:27], v[108:111], v[36:39], v[24:27]
    v_mfma_f32_16x16x32_bf16 v[16:19], v[104:107], v[36:39], v[16:19]
    ds_read_b128 v[40:43], v8 offset:4064
    ds_read_b64_tr_b16 v[76:77], v13 offset:6912
    ds_read_b64_tr_b16 v[78:79], v14 offset:6912
    ds_read_b64_tr_b16 v[72:73], v13 offset:7456
    ds_read_b64_tr_b16 v[74:75], v14 offset:7456
    s_waitcnt lgkmcnt(6)
    v_mfma_f32_16x16x32_bf16 v[16:19], v[112:115], v[68:71], v[16:19]
    ds_read_b64_tr_b16 v[152:153], v11 offset:0
    ds_read_b64_tr_b16 v[154:155], v12 offset:0
    s_waitcnt lgkmcnt(7)
    v_mfma_f32_16x16x32_bf16 v[20:23], v[116:119], v[64:67], v[20:23]
    ds_read_b64_tr_b16 v[84:85], v11 offset:272
    ds_read_b64_tr_b16 v[86:87], v12 offset:272
    s_waitcnt lgkmcnt(8)
    v_mfma_f32_16x16x32_bf16 v[16:19], v[116:119], v[40:43], v[16:19]
    ds_read_b64_tr_b16 v[80:81], v11 offset:544
    ds_read_b64_tr_b16 v[82:83], v12 offset:544
    s_waitcnt lgkmcnt(8)
    v_mfma_f32_16x16x32_bf16 v[20:23], v[76:79], v[124:127], v[20:23]
    v_mfma_f32_16x16x32_bf16 v[16:19], v[76:79], v[120:123], v[16:19]
    ds_read_b64_tr_b16 v[156:157], v11 offset:816
    ds_read_b64_tr_b16 v[158:159], v12 offset:816
    s_waitcnt lgkmcnt(8)
    v_mfma_f32_16x16x32_bf16 v[20:23], v[72:75], v[120:123], v[20:23]
    ds_read_b64_tr_b16 v[92:93], v11 offset:1088
    ds_read_b64_tr_b16 v[94:95], v12 offset:1088
    s_waitcnt lgkmcnt(8)
    v_mfma_f32_16x16x32_bf16 v[16:19], v[152:155], v[148:151], v[16:19]
    ds_read_b64_tr_b16 v[88:89], v11 offset:1360
    ds_read_b64_tr_b16 v[90:91], v12 offset:1360
    s_waitcnt lgkmcnt(8)
    v_mfma_f32_16x16x32_bf16 v[16:19], v[84:87], v[144:147], v[16:19]
    ds_read_b64_tr_b16 v[44:45], v11 offset:1632
    ds_read_b64_tr_b16 v[46:47], v12 offset:1632
    s_waitcnt lgkmcnt(8)
    v_mfma_f32_16x16x32_bf16 v[20:23], v[80:83], v[148:151], v[20:23]
    v_mfma_f32_16x16x32_bf16 v[16:19], v[80:83], v[140:143], v[16:19]
    ds_read_b64_tr_b16 v[100:101], v11 offset:1904
    ds_read_b64_tr_b16 v[102:103], v12 offset:1904
    s_waitcnt lgkmcnt(8)
    v_mfma_f32_16x16x32_bf16 v[20:23], v[156:159], v[144:147], v[20:23]
    v_mfma_f32_16x16x32_bf16 v[16:19], v[156:159], v[136:139], v[16:19]
    s_waitcnt lgkmcnt(6)
    v_mfma_f32_16x16x32_bf16 v[20:23], v[92:95], v[140:143], v[20:23]
    v_mfma_f32_16x16x32_bf16 v[16:19], v[92:95], v[132:135], v[16:19]
    s_waitcnt lgkmcnt(4)
    v_mfma_f32_16x16x32_bf16 v[20:23], v[88:91], v[136:139], v[20:23]
    v_mfma_f32_16x16x32_bf16 v[16:19], v[88:91], v[128:131], v[16:19]
    ds_read_b32 v60, v166 offset:68
    ds_read_b128 v[56:59], v165 offset:256
    s_waitcnt lgkmcnt(4)
    v_mfma_f32_16x16x32_bf16 v[20:23], v[44:47], v[132:135], v[20:23]
    s_waitcnt lgkmcnt(2)
    v_mfma_f32_16x16x32_bf16 v[20:23], v[100:103], v[128:131], v[20:23]
    s_setprio 0
    s_waitcnt lgkmcnt(0)
C_CL2:
    v_cmp_eq_u32 vcc, 0, v60
    s_nop 4
    s_cbranch_vccz C_CD
    ds_read_b32 v60, v166 offset:68
    ds_read_b128 v[56:59], v165 offset:256
    s_sub_u32 s60, s60, 1
    s_cmp_gt_i32 s60, 0
    s_waitcnt lgkmcnt(0)
    s_cbranch_scc1 C_CL2
    s_branch C_CD
C_P3:
    s_setprio 1
    ds_read_b128 v[32:35], v8 offset:480
    ds_read_b128 v[36:39], v8 offset:608
    ds_read_b128 v[40:43], v8 offset:736
    ds_read_b64 v[160:161], v2 offset:512
    ds_read_b64 v[162:163], v2
    s_waitcnt lgkmcnt(4)
    v_mfma_f32_16x16x32_bf16 v[28:31], v[52:55], v[32:35], 0
    v_mfma_f32_16x16x32_bf16 v[20:23], v[48:51], v[32:35], 0
    ds_read_b128 v[44:47], v8 offset:864
    s_waitcnt lgkmcnt(4)
    v_mfma_f32_16x16x32_bf16 v[28:31], v[60:63], v[36:39], v[28:31]
    v_mfma_f32_16x16x32_bf16 v[20:23], v[56:59], v[36:39], v[20:23]
    s_cmp_lg_u32 s38, 9
    s_cbranch_scc1 C_NPL0
    s_lshr_b32 s52, s2, 7
    s_lshl3_add_u32 s52, s52, 8
    v_lshrrev_b32 v9, 1, v3
    v_writelane_b32 v9, s52, 3
    s_mov_b64 exec, 0xf
    buffer_load_dword v10, v9, s[40:43], 0 offen offset:2048 sc1
    s_mov_b64 exec, -1
C_NPL0:
    s_cmp_ge_u32 s2, 128
    s_cbranch_scc1 C_NX3
    s_mov_b32 m0, s58
    s_mov_b64 exec, s[56:57]
    global_load_lds_dwordx4 v5, s[72:73]
    s_add_u32 m0, s58, 896
    s_nop 0
    global_load_lds_dwordx4 v6, s[72:73]
    s_add_u32 m0, s58, 1792
    s_mov_b64 exec, 0x3f
    global_load_lds_dwordx4 v3, s[74:75]
    s_mov_b64 exec, -1
C_NX3:
    ds_read_b128 v[32:35], v8 offset:992
    s_waitcnt lgkmcnt(4)
    v_mfma_f32_16x16x32_bf16 v[28:31], v[68:71], v[40:43], v[28:31]
    v_mfma_f32_16x16x32_bf16 v[20:23], v[64:67], v[40:43], v[20:23]
    ds_read_b128 v[36:39], v8 offset:1120
    s_waitcnt lgkmcnt(2)
    v_mfma_f32_16x16x32_bf16 v[28:31], v[76:79], v[44:47], v[28:31]
    v_mfma_f32_16x16x32_bf16 v[20:23], v[72:75], v[44:47], v[20:23]
    ds_read_b128 v[40:43], v8 offset:1248
    s_waitcnt lgkmcnt(2)
    v_mfma_f32_16x16x32_bf16 v[28:31], v[84:87], v[32:35], v[28:31]
    v_mfma_f32_16x16x32_bf16 v[20:23], v[80:83], v[32:35], v[20:23]
    v_mfma_f32_16x16x32_bf16 v[24:27], v[52:55], v[32:35], 0
    v_mfma_f32_16x16x32_bf16 v[16:19], v[48:51], v[32:35], 0
    ds_read_b128 v[44:47], v8 offset:1376
    s_waitcnt lgkmcnt(2)
    v_mfma_f32_16x16x32_bf16 v[28:31], v[92:95], v[36:39], v[28:31]
    v_mfma_f32_16x16x32_bf16 v[20:23], v[88:91], v[36:39], v[20:23]
    v_mfma_f32_16x16x32_bf16 v[24:27], v[60:63], v[36:39], v[24:27]
    v_mfma_f32_16x16x32_bf16 v[16:19], v[56:59], v[36:39], v[16:19]
    ds_read_b128 v[32:35], v8 offset:1504
    v_and_b32 v48, 0xffff0000, v161
    v_lshlrev_b32 v49, 16, v161
    v_and_b32 v50, 0xffff0000, v160
    v_lshlrev_b32 v51, 16, v160
    v_mul_f32 v48, v48, v164
    v_mul_f32 v49, v49, v164
    v_mul_f32 v50, v50, v164
    v_mul_f32 v51, v51, v164
    v_cvt_pk_bf16_f32 v49, v48, v49
    v_lshlrev_b32 v48, 16, v49
    v_and_b32 v49, 0xffff0000, v49
    v_cvt_pk_bf16_f32 v51, v50, v51
    v_lshlrev_b32 v50, 16, v51
    v_and_b32 v51, 0xffff0000, v51
    v_and_b32 v52, 0xffff0000, v163
    v_lshlrev_b32 v53, 16, v163
    v_and_b32 v54, 0xffff0000, v162
    v_lshlrev_b32 v55, 16, v162
    v_mul_f32 v52, v52, v164
    v_mul_f32 v53, v53, v164
    v_mul_f32 v54, v54, v164
    v_mul_f32 v55, v55, v164
    v_cvt_pk_bf16_f32 v53, v52, v53
    v_lshlrev_b32 v52, 16, v53
    v_and_b32 v53, 0xffff0000, v53
    v_cvt_pk_bf16_f32 v55, v54, v55
    v_lshlrev_b32 v54, 16, v55
    v_and_b32 v55, 0xffff0000, v55
    s_waitcnt lgkmcnt(2)
    v_mfma_f32_16x16x32_bf16 v[28:31], v[100:103], v[40:43], v[28:31]
    v_mfma_f32_16x16x32_bf16 v[20:23], v[96:99], v[40:43], v[20:23]
    v_mfma_f32_16x16x32_bf16 v[24:27], v[68:71], v[40:43], v[24:27]
    v_mfma_f32_16x16x32_bf16 v[16:19], v[64:67], v[40:43], v[16:19]
    ds_read_b128 v[36:39], v8 offset:1632
    s_waitcnt lgkmcnt(2)
    v_mfma_f32_16x16x32_bf16 v[28:31], v[108:111], v[44:47], v[28:31]
    v_mfma_f32_16x16x32_bf16 v[20:23], v[104:107], v[44:47], v[20:23]
    v_mfma_f32_16x16x32_bf16 v[24:27], v[76:79], v[44:47], v[24:27]
    v_mfma_f32_16x16x32_bf16 v[16:19], v[72:75], v[44:47], v[16:19]
    ds_read_b128 v[68:71], v8 offset:1760
    s_waitcnt lgkmcnt(2)
    v_mfma_f32_16x16x32_bf16 v[20:23], v[112:115], v[32:35], v[20:23]
    v_mfma_f32_16x16x32_bf16 v[24:27], v[84:87], v[32:35], v[24:27]
    v_mfma_f32_16x16x32_bf16 v[16:19], v[80:83], v[32:35], v[16:19]
    ds_read_b96 v[60:62], v166
    ds_read_b128 v[64:67], v8 offset:1888
    s_waitcnt lgkmcnt(3)
    v_mfma_f32_16x16x32_bf16 v[24:27], v[92:95], v[36:39], v[24:27]
    v_mfma_f32_16x16x32_bf16 v[16:19], v[88:91], v[36:39], v[16:19]
    s_waitcnt lgkmcnt(1)
C_FL3:
    v_min3_u32 v60, v60, v61, v62
    v_cmp_eq_u32 vcc, 0, v60
    s_nop 4
    s_cbranch_vccz C_FD3
    ds_read_b96 v[60:62], v166
    s_sub_u32 s60, s60, 1
    s_cmp_gt_i32 s60, 0
    s_waitcnt lgkmcnt(0)
    s_cbranch_scc1 C_FL3
C_FD3:
    ds_read_b128 v[40:43], v8 offset:2016
    v_mfma_f32_16x16x32_bf16 v[24:27], v[100:103], v[68:71], v[24:27]
    v_mfma_f32_16x16x32_bf16 v[16:19], v[96:99], v[68:71], v[16:19]
    ds_read_b128 v[76:79], v8 offset:2528
    s_waitcnt lgkmcnt(2)
    v_mfma_f32_16x16x32_bf16 v[24:27], v[108:111], v[64:67], v[24:27]
    v_mfma_f32_16x16x32_bf16 v[16:19], v[104:107], v[64:67], v[16:19]
    ds_read_b128 v[72:75], v8 offset:3040
    ds_read_b64_tr_b16 v[44:45], v13 offset:6912
    ds_read_b64_tr_b16 v[46:47], v14 offset:6912
    ds_read_b64_tr_b16 v[84:85], v13 offset:7456
    ds_read_b64_tr_b16 v[86:87], v14 offset:7456
    s_waitcnt lgkmcnt(6)
    v_mfma_f32_16x16x32_bf16 v[16:19], v[112:115], v[40:43], v[16:19]
    ds_read_b64_tr_b16 v[80:81], v13 offset:8000
    ds_read_b64_tr_b16 v[82:83], v14 offset:8000
    s_waitcnt lgkmcnt(7)
    v_mfma_f32_16x16x32_bf16 v[20:23], v[116:119], v[76:79], v[20:23]
    ds_read_b64_tr_b16 v[32:33], v13 offset:8544
    ds_read_b64_tr_b16 v[34:35], v14 offset:8544
    s_waitcnt lgkmcnt(8)
    v_mfma_f32_16x16x32_bf16 v[16:19], v[116:119], v[72:75], v[16:19]
    ds_read_b64_tr_b16 v[92:93], v11 offset:1088
    ds_read_b64_tr_b16 v[94:95], v12 offset:1088
    s_waitcnt lgkmcnt(8)
    v_mfma_f32_16x16x32_bf16 v[20:23], v[44:47], v[124:127], v[20:23]
    v_mfma_f32_16x16x32_bf16 v[16:19], v[44:47], v[120:123], v[16:19]
    ds_read_b64_tr_b16 v[88:89], v11 offset:1360
    ds_read_b64_tr_b16 v[90:91], v12 offset:1360
    s_waitcnt lgkmcnt(8)
    v_mfma_f32_16x16x32_bf16 v[20:23], v[84:87], v[120:123], v[20:23]
    v_mfma_f32_16x16x32_bf16 v[16:19], v[84:87], v[156:159], v[16:19]
    ds_read_b64_tr_b16 v[36:37], v11 offset:1632
    ds_read_b64_tr_b16 v[38:39], v12 offset:1632
    s_waitcnt lgkmcnt(8)
    v_mfma_f32_16x16x32_bf16 v[20:23], v[80:83], v[156:159], v[20:23]
    v_mfma_f32_16x16x32_bf16 v[16:19], v[80:83], v[152:155], v[16:19]
    ds_read_b64_tr_b16 v[100:101], v11 offset:1904
    ds_read_b64_tr_b16 v[102:103], v12 offset:1904
    s_waitcnt lgkmcnt(8)
    v_mfma_f32_16x16x32_bf16 v[20:23], v[32:35], v[152:155], v[20:23]
    ds_read_b64_tr_b16 v[96:97], v11 offset:2176
    ds_read_b64_tr_b16 v[98:99], v12 offset:2176
    s_waitcnt lgkmcnt(8)
    v_mfma_f32_16x16x32_bf16 v[16:19], v[92:95], v[148:151], v[16:19]
    ds_read_b64_tr_b16 v[68:69], v11 offset:2448
    ds_read_b64_tr_b16 v[70:71], v12 offset:2448
    s_cmp_lg_u32 s38, 9
    s_cbranch_scc1 C_NPL
    s_mov_b64 exec, 0xf
    buffer_load_dword v4, v9, s[40:43], 0 offen offset:2048 sc1
    s_mov_b64 exec, -1
C_NPL:
    s_waitcnt lgkmcnt(8)
    v_mfma_f32_16x16x32_bf16 v[16:19], v[88:91], v[144:147], v[16:19]
    ds_read_b64_tr_b16 v[108:109], v11 offset:2720
    ds_read_b64_tr_b16 v[110:111], v12 offset:2720
    s_waitcnt lgkmcnt(8)
    v_mfma_f32_16x16x32_bf16 v[20:23], v[36:39], v[148:151], v[20:23]
    v_mfma_f32_16x16x32_bf16 v[16:19], v[36:39], v[140:143], v[16:19]
    ds_read_b64_tr_b16 v[104:105], v11 offset:2992
    ds_read_b64_tr_b16 v[106:107], v12 offset:2992
    s_waitcnt lgkmcnt(8)
    v_mfma_f32_16x16x32_bf16 v[20:23], v[100:103], v[144:147], v[20:23]
    v_mfma_f32_16x16x32_bf16 v[16:19], v[100:103], v[136:139], v[16:19]
    s_waitcnt lgkmcnt(6)
    v_mfma_f32_16x16x32_bf16 v[20:23], v[96:99], v[140:143], v[20:23]
    v_mfma_f32_16x16x32_bf16 v[16:19], v[96:99], v[132:135], v[16:19]
    s_waitcnt lgkmcnt(4)
    v_mfma_f32_16x16x32_bf16 v[20:23], v[68:71], v[136:139], v[20:23]
    v_mfma_f32_16x16x32_bf16 v[16:19], v[68:71], v[128:131], v[16:19]
    ds_read_b32 v60, v166 offset:72
    ds_read_b128 v[56:59], v165 offset:384
    s_waitcnt lgkmcnt(4)
    v_mfma_f32_16x16x32_bf16 v[20:23], v[108:111], v[132:135], v[20:23]
    s_waitcnt lgkmcnt(2)
    v_mfma_f32_16x16x32_bf16 v[20:23], v[104:107], v[128:131], v[20:23]
    s_setprio 0
    s_waitcnt lgkmcnt(0)
C_CL3:
    v_cmp_eq_u32 vcc, 0, v60
    s_nop 4
    s_cbranch_vccz C_CD
    ds_read_b32 v60, v166 offset:72
    ds_read_b128 v[56:59], v165 offset:384
    s_sub_u32 s60, s60, 1
    s_cmp_gt_i32 s60, 0
    s_waitcnt lgkmcnt(0)
    s_cbranch_scc1 C_CL3
C_CD:
    s_waitcnt vmcnt(4)
    s_cmp_eq_u32 s38, 9
    s_cselect_b32 s52, s2, 255
    s_cmp_lt_u32 s52, 128
    s_cbranch_scc1 C_CD2
    s_waitcnt vmcnt(3)
    s_cmp_lt_u32 s2, 128
    s_cbranch_scc1 C_CD2
    s_waitcnt vmcnt(0)
C_CD2:
    s_mov_b32 exec_lo, 0x30003
    s_mov_b32 exec_hi, 0x30003
    s_nop 4
    v_pk_add_f32 v[16:17], v[16:17], v[56:57]
    v_pk_add_f32 v[18:19], v[18:19], v[58:59]
    s_mov_b64 exec, -1
C_EPI:
    s_nop 3
    s_movk_i32 s54, 0x3f80
    s_mov_b32 s55, 1.0
    v_add_f32_dpp v16, v24, v16 row_shr:2 row_mask:0xf bank_mask:0xf
    v_add_f32_dpp v17, v25, v17 row_shr:2 row_mask:0xf bank_mask:0xf
    v_add_f32_dpp v18, v26, v18 row_shr:2 row_mask:0xf bank_mask:0xf
    v_add_f32_dpp v19, v27, v19 row_shr:2 row_mask:0xf bank_mask:0xf
    v_add_f32_dpp v20, v28, v20 row_shr:2 row_mask:0xf bank_mask:0xf
    v_add_f32_dpp v21, v29, v21 row_shr:2 row_mask:0xf bank_mask:0xf
    v_add_f32_dpp v22, v30, v22 row_shr:2 row_mask:0xf bank_mask:0xf
    v_add_f32_dpp v23, v31, v23 row_shr:2 row_mask:0xf bank_mask:0xf
    v_add_f32_dpp v20, v24, v20 row_shl:14 row_mask:0xf bank_mask:0xf
    v_add_f32_dpp v21, v25, v21 row_shl:14 row_mask:0xf bank_mask:0xf
    v_add_f32_dpp v22, v26, v22 row_shl:14 row_mask:0xf bank_mask:0xf
    v_add_f32_dpp v23, v27, v23 row_shl:14 row_mask:0xf bank_mask:0xf
    v_cvt_pk_bf16_f32 v16, v16, v17
    v_cvt_pk_bf16_f32 v17, v18, v19
    v_cvt_pk_bf16_f32 v18, v20, v21
    v_cvt_pk_bf16_f32 v19, v22, v23
    v_dot2c_f32_bf16 v48, s54, v16
    v_dot2c_f32_bf16 v49, s55, v16
    v_dot2c_f32_bf16 v50, s54, v17
    v_dot2c_f32_bf16 v51, s55, v17
    v_dot2c_f32_bf16 v52, s54, v18
    v_dot2c_f32_bf16 v53, s55, v18
    v_dot2c_f32_bf16 v54, s54, v19
    v_dot2c_f32_bf16 v55, s55, v19
    v_cvt_pk_bf16_f32 v48, v48, v49
    v_cvt_pk_bf16_f32 v49, v50, v51
    ds_write_b64 v15, v[48:49] offset:0
    v_cvt_pk_bf16_f32 v52, v52, v53
    v_cvt_pk_bf16_f32 v53, v54, v55
    ds_write_b64 v15, v[52:53] offset:544
    v_mov_b32 v20, 161504
    s_cmp_lt_u32 s38, 8
    s_cbranch_scc1 C_GA
    s_cmp_lg_u32 s38, 9
    s_cbranch_scc1 C_NOGA
    s_mov_b64 exec, 0xf
    v_xor_b32 v5, s39, v10
    v_and_b32 v5, 0xffffdfff, v5
    v_cmp_ne_u32 vcc, 0, v5
    s_nop 4
    s_cbranch_vccz C_PL_K
    s_movk_i32 s60, 4000
    s_branch C_PL_W
C_PL:
    buffer_load_dword v4, v9, s[40:43], 0 offen offset:2048 sc1
C_PL_W:
    s_waitcnt vmcnt(0)
C_PL_C:
    v_xor_b32 v5, s39, v4
    v_and_b32 v5, 0xffffdfff, v5
    v_cmp_ne_u32 vcc, 0, v5
    s_nop 0
    s_and_b64 exec, exec, vcc
    s_cbranch_execz C_PL_D
    s_sub_u32 s60, s60, 1
    s_cmp_gt_i32 s60, 0
    s_sleep 2
    s_cbranch_scc1 C_PL
C_PL_D:
    s_mov_b64 exec, 0xf
    v_mov_b32 v10, v4
C_PL_K:
    v_lshrrev_b32 v9, 2, v3
    v_add_u32 v9, 161504, v9
    v_and_b32 v10, 0x2000, v10
    ds_write_b32 v9, v10
    s_mov_b64 exec, -1
    s_branch C_NOGA
C_GA:
    v_lshrrev_b32 v7, 5, v0
    v_lshlrev_b32 v7, 3, v7
    v_lshl_add_u32 v7, v0, 2, v7
    v_add_u32 v7, 48960, v7
    v_and_b32 v8, 24, v1
    v_and_b32 v9, 32, v1
    v_lshlrev_b32 v8, 11, v8
    v_lshl_add_u32 v8, v9, 8, v8
    v_and_b32 v9, 0x70, v3
    v_add_u32 v8, v9, v8
    s_lshl_b32 s52, s38, 16
    s_add_u32 s52, s52, 2097152
    s_lshr_b32 s53, s2, 6
    s_lshl_b32 s53, s53, 20
    s_add_u32 s52, s52, s53
    s_and_b32 s53, s2, 48
    s_lshl_b32 s53, s53, 7
    s_add_u32 s52, s52, s53
    s_and_b32 s53, s2, 1
    s_lshl_b32 s53, s53, 10
    s_add_u32 s52, s52, s53
    s_and_b32 s53, s2, 14
    s_lshl_b32 s53, s53, 6
    s_add_u32 s52, s52, s53
    s_add_u32 s53, s52, 524288
    v_mov_b32 v27, v167
    v_mov_b32 v31, v167
C_NOGA:
    s_waitcnt lgkmcnt(0)
    s_barrier
    ds_read_b128 v[16:19], v20
    s_sub_u32 s45, s38, 0
    s_cmp_ge_u32 s45, 8
    s_cbranch_scc1 C_NOST
    ds_read_b32 v24, v7 offset:0
    ds_read_b32 v25, v7 offset:17408
    ds_read_b32 v26, v7 offset:34816
    ds_read_b32 v28, v7 offset:2176
    ds_read_b32 v29, v7 offset:19584
    ds_read_b32 v30, v7 offset:36992
    s_waitcnt lgkmcnt(3)
    v_xor_b32 v8, v19, v8
    buffer_store_dwordx4 v[24:27], v8, s[40:43], s52 offen sc1
    s_waitcnt lgkmcnt(0)
    buffer_store_dwordx4 v[28:31], v8, s[40:43], s53 offen sc1
C_NOST:
    s_waitcnt lgkmcnt(0)
    v_readfirstlane_b32 s0, v16
    v_readfirstlane_b32 s1, v17
    v_readfirstlane_b32 s22, v18
    s_cmp_ge_u32 s2, 176
    s_cbranch_scc1 FFN_LATE
    s_cmp_ge_u32 s2, 128
    s_cbranch_scc1 FINAL
    v_and_b32 v7, 7, v1
    v_lshrrev_b32 v8, 3, v1
    s_mul_i32 s44, s2, 18432
    s_mul_i32 s45, s38, 96
    v_mul_u32_u24 v9, 0xe0, v7
    v_mad_u32_u24 v9, v8, 12, v9
    v_add_u32 v9, s58, v9
    v_xor_b32 v10, 1, v8
    v_mad_u32_u24 v13, v10, 12, s58
    s_lshr_b32 s47, s2, 3
    s_lshl_b32 s47, s47, 16
    s_and_b32 s48, s2, 3
    s_lshl_b32 s48, s48, 14
    s_or_b32 s47, s47, s48
    s_and_b32 s48, s2, 4
    s_lshl_b32 s48, s48, 11
    s_or_b32 s47, s47, s48
    s_cmp_lt_u32 s38, 8
    s_cselect_b32 s48, s1, s22
    s_xor_b32 s47, s47, s48
    s_lshl_b32 s48, s65, 20
    s_add_u32 s47, s47, s48
    s_lshl_b32 s48, s69, 11
    s_add_u32 s47, s47, s48
    s_lshl_b32 s48, s38, 11
    s_add_u32 s47, s47, 2097152
    v_mul_u32_u24 v84, 48, v7
    v_bfe_u32 v10, v1, 3, 1
    v_lshl_add_u32 v84, v10, 2, v84
    s_lshl_b32 s49, s69, 3
    s_add_u32 s49, s49, s71
    s_add_u32 s49, s49, 14336
    v_add_u32 v84, s49, v84
    v_mul_u32_u24 v85, 48, v1
    v_add_u32 v85, 60992, v85
    s_mov_b32 exec_lo, 0xf0000f
    s_mov_b32 exec_hi, 0xf0000f00
    v_subrev_u32 v84, 1536, v84
    s_mov_b32 exec_lo, 0xff000000
    s_mov_b32 exec_hi, 0xff0000
    v_subrev_u32 v84, 768, v84
    s_mov_b32 exec_lo, 0xff00
    s_mov_b32 exec_hi, 0xff
    v_subrev_u32 v84, 2304, v84
    s_mov_b64 exec, -1
    s_add_u32 s48, s48, 0
    v_and_b32 v10, 6, v7
    v_xor_b32 v10, v10, v8
    v_lshl_add_u32 v10, v7, 3, v10
    v_lshl_add_u32 v86, v10, 4, s48
    v_and_b32 v10, 6, v8
    v_xor_b32 v10, v10, v1
    v_lshl_add_u32 v87, v10, 4, s48
    v_mul_u32_u24 v88, 2944, v8
    v_add_u32 v88, v88, v3
    s_mul_i32 s48, s2, 24576
    s_lshl_b32 s49, s38, 7
    s_add_u32 s48, s48, s49
    s_add_u32 s48, s48, 8388608
    v_mul_u32_u24 v89, 2336, v7
    v_mad_u32_u24 v89, v8, 12, v89
    s_add_u32 s45, s45, 24576
    v_add_u32 v89, s45, v89
    v_add_u32 v10, 1536, v0
    v_add_u32 v11, 0, v0
    v_mul_u32_u24 v11, 911, v11
    v_lshrrev_b32 v11, 16, v11
    v_add_lshl_u32 v90, v10, v11, 4
    v_add_u32 v10, 2304, v0
    v_add_u32 v11, 768, v0
    v_mul_u32_u24 v11, 911, v11
    v_lshrrev_b32 v11, 16, v11
    v_add_lshl_u32 v91, v10, v11, 4
    v_lshl_add_u32 v92, v0, 4, s44
    v_bfe_u32 v10, v1, 3, 1
    v_lshl_add_u32 v10, v7, 1, v10
    s_lshl_b32 s49, s2, 4
    v_add_u32 v93, s49, v10
    v_sub_u32 v12, 0x7ff, v93
    v_lshrrev_b32 v93, 4, v1
    v_mul_u32_u24 v93, 8192, v93
    v_lshl_add_u32 v93, v10, 2, v93
    s_mul_i32 s49, s2, 64
    s_add_u32 s49, s49, 65536
    s_add_u32 s59, s49, 32768
    v_mov_b32 v51, 0
    v_mov_b32 v55, 0
    v_mov_b32 v76, 0
    v_mov_b32 v56, 0
    v_mov_b32 v57, 0
    v_mov_b32 v58, 0
    v_mov_b32 v59, 0
    v_mov_b32 v60, 0
    v_mov_b32 v61, 0
    v_mov_b32 v62, 0
    v_mov_b32 v63, 0
    s_lshl_b32 s50, s2, 6
    s_lshl_b32 s51, s38, 2
    s_add_u32 s50, s50, s51
    s_add_u32 s50, s50, 8192
    s_mov_b32 s56, 0x00100001
    s_mov_b32 s57, 0x10000100
    s_mov_b32 s58, 0xffff0000
    s_waitcnt vmcnt(0)
    buffer_load_dwordx4 v[28:31], v3, s[40:43], s47 offen sc1
    buffer_load_dwordx4 v[32:35], v3, s[40:43], s47 offen offset:1024 sc1
    ds_read_b32 v24, v13 offset:1792
    ds_read_b32 v25, v13 offset:1796
    ds_read_b32 v26, v13 offset:1800
    ds_read2_b32 v[16:17], v9 offset0:0 offset1:1
    ds_read2_b32 v[18:19], v9 offset0:2 offset1:28
    ds_read2_b32 v[20:21], v9 offset0:29 offset1:30
    s_waitcnt lgkmcnt(0)
    v_dot2c_f32_bf16 v76, 0x3f803f80, v24
    v_dot2c_f32_bf16 v76, 0x3f803f80, v25
    v_dot2c_f32_bf16 v76, 0x3f803f80, v26
    v_lshlrev_b32 v36, 16, v16
    v_and_b32 v37, 0xffff0000, v16
    v_lshlrev_b32 v42, 16, v19
    v_and_b32 v43, 0xffff0000, v19
    v_lshlrev_b32 v38, 16, v17
    v_and_b32 v39, 0xffff0000, v17
    v_lshlrev_b32 v44, 16, v20
    v_and_b32 v45, 0xffff0000, v20
    v_lshlrev_b32 v40, 16, v18
    v_and_b32 v41, 0xffff0000, v18
    v_lshlrev_b32 v46, 16, v21
    v_and_b32 v47, 0xffff0000, v21
    v_mov_b32 v77, v76
    s_nop 1
    v_permlane16_swap_b32 v76, v77
    v_add_f32 v76, v76, v77
    v_mov_b32 v77, v76
    s_nop 1
    v_permlane32_swap_b32 v76, v77
    v_add_f32 v76, v76, v77
    s_mov_b32 exec_lo, 0xf00f0
    s_mov_b32 exec_hi, 0xf00f000
    ds_write2_b32 v84, v76, v76 offset0:0 offset1:96
    s_mov_b32 exec_lo, 0xf0f0f0f
    s_mov_b32 exec_hi, 0xf0f0f0f
    v_mov_b32 v24, 0x3f803f80
    v_mov_b32 v25, 0x3f803f80
    v_mov_b32 v26, 0x3f803f80
    s_mov_b32 exec_lo, 0x11111111
    s_mov_b32 exec_hi, 0x11111111
    v_mov_b32 v56, v24
    v_mov_b32 v57, v25
    v_mov_b32 v58, v26
    s_mov_b32 exec_lo, 0x22222222
    s_mov_b32 exec_hi, 0x22222222
    v_mov_b32 v60, v24
    v_mov_b32 v61, v25
    v_mov_b32 v62, v26
    s_mov_b64 exec, -1
    s_movk_i32 s60, 4000
    s_branch L_YP_W
L_YP:
    buffer_load_dwordx4 v[28:31], v3, s[40:43], s47 offen sc1
    buffer_load_dwordx4 v[32:35], v3, s[40:43], s47 offen offset:1024 sc1
L_YP_W:
    s_waitcnt vmcnt(0)
L_YP_C:
    v_xor_b32 v10, v167, v31
    v_xor_b32 v11, v167, v35
    v_or_b32 v10, v10, v11
    v_cmp_ne_u32 vcc, 0, v10
    s_nop 0
    s_and_b64 exec, exec, vcc
    s_cbranch_execz L_YP_D
    s_wqm_b64 exec, exec
    s_sub_u32 s60, s60, 1
    s_cmp_gt_i32 s60, 0
    s_sleep 1
    s_cbranch_scc1 L_YP
L_YP_D:
    s_mov_b64 exec, -1
    v_dot2c_f32_bf16 v36, s54, v28
    v_dot2c_f32_bf16 v37, s54, v29
    v_dot2c_f32_bf16 v38, s54, v30
    v_dot2c_f32_bf16 v39, s54, v34
    v_dot2c_f32_bf16 v40, s54, v32
    v_dot2c_f32_bf16 v41, s54, v33
    v_dot2c_f32_bf16 v42, s55, v28
    v_dot2c_f32_bf16 v43, s55, v29
    v_dot2c_f32_bf16 v44, s55, v30
    v_dot2c_f32_bf16 v45, s55, v34
    v_cvt_pk_bf16_f32 v48, v36, v37
    v_dot2c_f32_bf16 v46, s55, v32
    v_cvt_pk_bf16_f32 v49, v38, v39
    v_dot2c_f32_bf16 v47, s55, v33
    v_cvt_pk_bf16_f32 v50, v40, v41
    v_cvt_pk_bf16_f32 v52, v42, v43
    v_cvt_pk_bf16_f32 v53, v44, v45
    v_mfma_f32_16x16x32_bf16 v[68:71], v[48:51], v[48:51], 0
    v_cvt_pk_bf16_f32 v54, v46, v47
    v_mfma_f32_16x16x32_bf16 v[64:67], v[56:59], v[48:51], 0
    s_nop 0
    v_mfma_f32_16x16x32_bf16 v[64:67], v[60:63], v[52:55], v[64:67]
    v_mfma_f32_16x16x32_bf16 v[72:75], v[52:55], v[52:55], 0
    v_lshlrev_b32 v36, 16, v48
    v_and_b32 v37, 0xffff0000, v48
    v_lshlrev_b32 v38, 16, v49
    v_and_b32 v39, 0xffff0000, v49
    v_lshlrev_b32 v40, 16, v50
    v_and_b32 v41, 0xffff0000, v50
    s_mov_b64 exec, s[56:57]
    v_mov_b32 v64, v68
    v_mov_b32 v65, v72
    s_lshl_b64 exec, exec, 1
    v_mov_b32 v64, v69
    v_mov_b32 v65, v73
    s_lshl_b64 exec, exec, 1
    v_mov_b32 v64, v70
    v_mov_b32 v65, v74
    s_lshl_b64 exec, exec, 1
    v_mov_b32 v64, v71
    v_mov_b32 v65, v75
    s_mov_b32 exec_lo, 0xfff0ff0f
    s_mov_b32 exec_hi, 0xf0ff0fff
    ds_write2_b32 v84, v64, v65 offset0:0 offset1:96
    s_mov_b64 exec, -1
    v_lshlrev_b32 v42, 16, v52
    v_and_b32 v43, 0xffff0000, v52
    v_lshlrev_b32 v44, 16, v53
    v_and_b32 v45, 0xffff0000, v53
    v_lshlrev_b32 v46, 16, v54
    v_and_b32 v47, 0xffff0000, v54
    s_cmp_eq_u32 s38, 0
    s_cbranch_scc0 L_NP
    s_setprio 3
L_NP:
    s_waitcnt lgkmcnt(0)
    s_barrier
    ds_read_b128 v[52:55], v85 offset:0
    ds_read_b128 v[56:59], v85 offset:16
    ds_read_b128 v[60:63], v85 offset:17408
    ds_read_b128 v[64:67], v85 offset:17424
    ds_read_b128 v[68:71], v85 offset:34816
    ds_read_b128 v[72:75], v85 offset:34832
    s_waitcnt lgkmcnt(4)
    s_waitcnt lgkmcnt(2)
    v_pk_add_f32 v[52:53], v[52:53], v[60:61]
    v_pk_add_f32 v[54:55], v[54:55], v[62:63]
    v_pk_add_f32 v[56:57], v[56:57], v[64:65]
    v_pk_add_f32 v[58:59], v[58:59], v[66:67]
    s_waitcnt lgkmcnt(0)
    v_pk_add_f32 v[52:53], v[52:53], v[68:69]
    v_pk_add_f32 v[54:55], v[54:55], v[70:71]
    v_pk_add_f32 v[56:57], v[56:57], v[72:73]
    v_pk_add_f32 v[58:59], v[58:59], v[74:75]
    v_pk_add_f32 v[52:53], v[52:53], v[54:55]
    v_pk_add_f32 v[56:57], v[56:57], v[58:59]
    v_pk_add_f32 v[52:53], v[52:53], v[56:57]
    v_add_f32 v76, v52, v53
    v_add_f32 v78, v52, v53
    s_nop 1
    v_permlane16_swap_b32 v76, v78
    v_mov_b32 v77, v76
    v_mov_b32 v13, v78
    s_nop 0
    v_permlane32_swap_b32 v76, v77
    v_permlane32_swap_b32 v78, v13
    v_mul_f32 v76, 0x3ae38e39, v76
    v_mul_f32 v78, 0x3ae38e39, v78
    v_fma_f32 v78, -v76, v76, v78
    v_max_f32 v78, 0, v78
    v_cvt_pk_bf16_f32 v78, v76, v78
    v_and_b32 v82, 0xffff0000, v78
    v_lshlrev_b32 v80, 16, v78
    v_add_f32 v82, 0x3727c5ac, v82
    v_lshlrev_b32 v81, 16, v78
    v_cvt_pk_bf16_f32 v82, v82, v82
    v_lshlrev_b32 v82, 16, v82
    v_sqrt_f32 v82, v82
    v_fma_f32 v77, -v80, v13, v77
    v_cvt_pk_bf16_f32 v82, v82, v82
    v_lshlrev_b32 v82, 16, v82
    v_rcp_f32 v83, v82
    v_rcp_f32 v82, v82
    s_cbranch_scc0 L_NK
    v_mul_f32 v77, v77, v83
    v_cvt_pk_bf16_f32 v77, v77, v77
    v_ashrrev_i32 v76, 31, v77
    v_or_b32 v76, 0x80000000, v76
    v_xor_b32 v76, v76, v77
    v_and_or_b32 v76, v76, s58, v12
    buffer_store_dword v76, v93, s[40:43], s49 offen sc1
    buffer_store_dword v76, v93, s[40:43], s59 offen sc1
    s_setprio 0
L_NK:
    v_mov_b32_dpp v80, v80 row_ror:8 row_mask:0xf bank_mask:0xc
    v_mov_b32_dpp v81, v81 row_ror:8 row_mask:0xf bank_mask:0x3
    v_mov_b32_dpp v82, v82 row_ror:8 row_mask:0xf bank_mask:0xc
    v_mov_b32_dpp v83, v83 row_ror:8 row_mask:0xf bank_mask:0x3
    v_pk_add_f32 v[56:57], v[36:37], v[80:81] op_sel_hi:[1,0] neg_lo:[0,1] neg_hi:[0,1]
    v_pk_add_f32 v[58:59], v[38:39], v[80:81] op_sel_hi:[1,0] neg_lo:[0,1] neg_hi:[0,1]
    v_pk_add_f32 v[60:61], v[40:41], v[80:81] op_sel_hi:[1,0] neg_lo:[0,1] neg_hi:[0,1]
    v_pk_add_f32 v[62:63], v[42:43], v[80:81] op_sel:[0,1] neg_lo:[0,1] neg_hi:[0,1]
    v_pk_add_f32 v[64:65], v[44:45], v[80:81] op_sel:[0,1] neg_lo:[0,1] neg_hi:[0,1]
    v_pk_add_f32 v[66:67], v[46:47], v[80:81] op_sel:[0,1] neg_lo:[0,1] neg_hi:[0,1]
    v_cvt_pk_bf16_f32 v57, v56, v57
    v_cvt_pk_bf16_f32 v59, v58, v59
    v_cvt_pk_bf16_f32 v61, v60, v61
    v_cvt_pk_bf16_f32 v63, v62, v63
    v_cvt_pk_bf16_f32 v65, v64, v65
    v_cvt_pk_bf16_f32 v67, v66, v67
    v_lshlrev_b32 v56, 16, v57
    v_and_b32 v57, 0xffff0000, v57
    v_lshlrev_b32 v58, 16, v59
    v_and_b32 v59, 0xffff0000, v59
    v_lshlrev_b32 v60, 16, v61
    v_and_b32 v61, 0xffff0000, v61
    v_lshlrev_b32 v62, 16, v63
    v_and_b32 v63, 0xffff0000, v63
    v_lshlrev_b32 v64, 16, v65
    v_and_b32 v65, 0xffff0000, v65
    v_lshlrev_b32 v66, 16, v67
    v_and_b32 v67, 0xffff0000, v67
    v_pk_mul_f32 v[56:57], v[56:57], v[82:83] op_sel_hi:[1,0]
    v_pk_mul_f32 v[58:59], v[58:59], v[82:83] op_sel_hi:[1,0]
    v_pk_mul_f32 v[60:61], v[60:61], v[82:83] op_sel_hi:[1,0]
    v_pk_mul_f32 v[62:63], v[62:63], v[82:83] op_sel:[0,1]
    v_pk_mul_f32 v[64:65], v[64:65], v[82:83] op_sel:[0,1]
    v_pk_mul_f32 v[66:67], v[66:67], v[82:83] op_sel:[0,1]
    v_cvt_pk_bf16_f32 v28, v56, v57
    v_cvt_pk_bf16_f32 v29, v58, v59
    v_cvt_pk_bf16_f32 v30, v60, v61
    ds_write_b128 v86, v[28:31]
    v_cvt_pk_bf16_f32 v32, v62, v63
    v_cvt_pk_bf16_f32 v33, v64, v65
    v_cvt_pk_bf16_f32 v34, v66, v67
    ds_write_b128 v86, v[32:35] offset:1024
    ds_read_b128 v[56:59], v87
    ds_read_b128 v[60:63], v87 offset:1024
    v_dot2c_f32_bf16 v36, s54, v28
    v_dot2c_f32_bf16 v37, s55, v28
    v_dot2c_f32_bf16 v38, s54, v29
    v_dot2c_f32_bf16 v39, s55, v29
    v_dot2c_f32_bf16 v40, s54, v30
    v_dot2c_f32_bf16 v41, s55, v30
    v_dot2c_f32_bf16 v42, s54, v32
    v_dot2c_f32_bf16 v43, s55, v32
    v_dot2c_f32_bf16 v44, s54, v33
    v_dot2c_f32_bf16 v45, s55, v33
    v_dot2c_f32_bf16 v46, s54, v34
    v_dot2c_f32_bf16 v47, s55, v34
    s_waitcnt lgkmcnt(1)
    buffer_store_dwordx4 v[56:59], v88, s[40:43], s48 offen sc1
    s_waitcnt lgkmcnt(0)
    buffer_store_dwordx4 v[60:63], v88, s[40:43], s48 offen offset:1536 sc1
    v_cvt_pk_bf16_f32 v48, v36, v37
    v_cvt_pk_bf16_f32 v49, v38, v39
    v_cvt_pk_bf16_f32 v50, v40, v41
    v_cvt_pk_bf16_f32 v51, v42, v43
    v_cvt_pk_bf16_f32 v52, v44, v45
    v_cvt_pk_bf16_f32 v53, v46, v47
    v_add_u32 v10, 1168, v89
    ds_write2_b32 v89, v48, v49 offset0:0 offset1:1
    ds_write_b32 v89, v50 offset:8
    ds_write2_b32 v10, v51, v52 offset0:0 offset1:1
    ds_write_b32 v10, v53 offset:8
    v_add_u32 v11, 12288, v92
    s_waitcnt lgkmcnt(0)
    s_barrier
    ds_read_b128 v[16:19], v90
    ds_read_b128 v[20:23], v91
    v_mov_b32 v10, 0
    s_waitcnt lgkmcnt(1)
    global_store_dwordx4 v92, v[16:19], s[32:33] sc1
    s_cmp_ge_u32 s38, 6
    s_cbranch_scc1 L_O1
    s_waitcnt lgkmcnt(0)
    global_store_dwordx4 v11, v[20:23], s[32:33] sc1
L_O1:
    s_cmp_eq_u32 s38, 11
    s_cbranch_scc1 TOP8
    s_waitcnt vmcnt(0)
    s_mov_b64 exec, 0x1
    buffer_store_dword v167, v10, s[40:43], s50 offen sc1
    s_mov_b64 exec, -1
    s_branch END
FFN_DMA0:
    s_sub_u32 s58, s2, 192
    s_lshl_b32 s61, s58, 1
    s_mov_b32 s59, 8
    s_mov_b32 s57, 73728
    s_add_u32 s56, s38, 1
    s_bfe_u32 s50, s56, 0x10003
    s_and_b32 s51, s56, 1
    s_bfe_u32 s52, s56, 0x10001
    s_mul_i32 s52, s52, 36
    s_add_u32 s52, s52, s51
    s_mul_i32 s48, s52, 73728
    s_lshl_b32 s53, s61, 6
    s_add_u32 s48, s48, s53
    s_lshl_b32 s49, s52, 10
    s_mul_i32 s53, s50, 73728
    s_add_u32 s49, s49, s53
    s_lshl_b32 s51, s51, 1
    s_lshl_b32 s53, s50, 2
    s_or_b32 s51, s51, s53
    v_bfe_u32 v2, v1, 4, 1
    v_and_b32 v4, 7, v1
    v_xor_b32 v2, v2, v4
    v_xor_b32 v2, s51, v2
    v_lshrrev_b32 v4, 3, v1
    v_mul_u32_u24 v4, 0x2400, v4
    v_lshl_add_u32 v2, v2, 4, v4
    s_mov_b32 s46, 5308416
    s_mov_b32 s47, 0x00020000
    s_waitcnt lgkmcnt(0)
    s_cmp_eq_u32 s50, 0
    s_cselect_b32 s44, s26, s28
    s_cselect_b32 s45, s27, s29
    s_mov_b32 s40, s36
    s_mov_b32 s41, s37
    s_barrier
    s_sub_u32 s51, s38, 3
    s_cmp_ge_u32 s51, 8
    s_cbranch_scc1 F_B0
    s_add_u32 m0, s49, 0
    s_add_u32 s53, s48, 0
    buffer_load_dwordx4 v2, s[44:47], s53 offen lds
    s_add_u32 m0, s49, 2048
    s_add_u32 s53, s48, 147456
    buffer_load_dwordx4 v2, s[44:47], s53 offen lds
    s_barrier
    s_branch F_B2
FFN_LATE:
    s_and_b32 s61, s2, 7
    s_lshl_b32 s61, s61, 1
    s_bitcmp0_b32 s2, 3
    s_addc_u32 s61, s61, 128
    s_sub_u32 s58, s2, 112
    s_mov_b32 s59, 4
    s_mov_b32 s57, 0
    v_mov_b32 v32, 0
    v_mov_b32 v33, 0
    v_mov_b32 v34, 0
    v_mov_b32 v35, 0
    v_mov_b32 v36, 0
    v_mov_b32 v37, 0
    v_mov_b32 v38, 0
    v_mov_b32 v39, 0
    v_mov_b32 v40, 0
    v_mov_b32 v41, 0
    v_mov_b32 v42, 0
    v_mov_b32 v43, 0
    v_mov_b32 v44, 0
    v_mov_b32 v45, 0
    v_mov_b32 v46, 0
    v_mov_b32 v47, 0
    s_sub_u32 s51, s38, 3
    s_cmp_ge_u32 s51, 8
    s_cbranch_scc1 F_B0
    s_add_u32 s56, s38, 1
    s_bfe_u32 s50, s56, 0x10003
    s_and_b32 s51, s56, 1
    s_bfe_u32 s52, s56, 0x10001
    s_lshl1_add_u32 s52, s50, s52
    s_mul_i32 s52, s52, 18
    s_add_u32 s52, s52, s51
    s_mul_i32 s48, s52, 73728
    s_lshl_b32 s53, s61, 6
    s_add_u32 s48, s48, s53
    s_lshl_b32 m0, s52, 10
    s_lshl_b32 s51, s51, 1
    s_add_u32 s44, s26, s48
    s_addc_u32 s45, s27, 0
    s_add_u32 s46, s28, s48
    s_addc_u32 s47, s29, 0
    v_bfe_u32 v2, v1, 4, 1
    v_xor_b32 v2, v2, v1
    v_xor_b32 v2, s51, v2
    v_and_b32 v2, 3, v2
    v_lshrrev_b32 v4, 3, v1
    v_mul_u32_u24 v4, 0x2400, v4
    v_lshl_add_u32 v2, v2, 4, v4
    v_mov_b32 v4, s44
    v_mov_b32 v5, s45
    s_mov_b32 exec_lo, 0xf0f0f0f0
    s_mov_b32 exec_hi, 0xf0f0f0f0
    v_mov_b32 v4, s46
    v_mov_b32 v5, s47
    s_mov_b64 exec, -1
    v_add_co_u32 v4, vcc, v4, v2
    s_nop 1
    v_addc_co_u32 v5, vcc, 0, v5, vcc
    s_barrier
    global_load_lds_dwordx4 v[4:5], off
    v_add_co_u32 v4, vcc, 147456, v4
    s_add_u32 m0, m0, 2048
    s_nop 0
    v_addc_co_u32 v5, vcc, 0, v5, vcc
    global_load_lds_dwordx4 v[4:5], off
    v_add_co_u32 v4, vcc, 147456, v4
    s_add_u32 m0, m0, 2048
    s_nop 0
    v_addc_co_u32 v5, vcc, 0, v5, vcc
    global_load_lds_dwordx4 v[4:5], off
    v_add_co_u32 v4, vcc, 147456, v4
    s_add_u32 m0, m0, 2048
    s_nop 0
    v_addc_co_u32 v5, vcc, 0, v5, vcc
    global_load_lds_dwordx4 v[4:5], off
    v_add_co_u32 v4, vcc, 147456, v4
    s_add_u32 m0, m0, 2048
    s_nop 0
    v_addc_co_u32 v5, vcc, 0, v5, vcc
    global_load_lds_dwordx4 v[4:5], off
    v_add_co_u32 v4, vcc, 147456, v4
    s_add_u32 m0, m0, 2048
    s_nop 0
    v_addc_co_u32 v5, vcc, 0, v5, vcc
    global_load_lds_dwordx4 v[4:5], off
    v_add_co_u32 v4, vcc, 147456, v4
    s_add_u32 m0, m0, 2048
    s_nop 0
    v_addc_co_u32 v5, vcc, 0, v5, vcc
    global_load_lds_dwordx4 v[4:5], off
    v_add_co_u32 v4, vcc, 147456, v4
    s_add_u32 m0, m0, 2048
    s_nop 0
    v_addc_co_u32 v5, vcc, 0, v5, vcc
    global_load_lds_dwordx4 v[4:5], off
    v_add_co_u32 v4, vcc, 147456, v4
    s_add_u32 m0, m0, 2048
    s_nop 0
    v_addc_co_u32 v5, vcc, 0, v5, vcc
    global_load_lds_dwordx4 v[4:5], off
    s_branch F_W
F_L2:
    s_sub_u32 s51, s38, 3
    s_cmp_ge_u32 s51, 8
    s_cbranch_scc1 F_B0
    s_add_u32 s56, s38, 1
    s_bfe_u32 s50, s56, 0x10003
    s_and_b32 s51, s56, 1
    s_bfe_u32 s52, s56, 0x10001
    s_mul_i32 s52, s52, 36
    s_add_u32 s52, s52, s51
    s_mul_i32 s48, s52, 73728
    s_lshl_b32 s53, s61, 6
    s_add_u32 s48, s48, s53
    s_lshl_b32 s49, s52, 10
    s_mul_i32 s53, s50, 73728
    s_add_u32 s49, s49, s53
    s_lshl_b32 s51, s51, 1
    s_lshl_b32 s53, s50, 2
    s_or_b32 s51, s51, s53
    v_bfe_u32 v2, v1, 4, 1
    v_and_b32 v4, 7, v1
    v_xor_b32 v2, v2, v4
    v_xor_b32 v2, s51, v2
    v_lshrrev_b32 v4, 3, v1
    v_mul_u32_u24 v4, 0x2400, v4
    v_lshl_add_u32 v2, v2, 4, v4
    s_mov_b32 s46, 5308416
    s_mov_b32 s47, 0x00020000
    s_cmp_eq_u32 s50, 0
    s_cselect_b32 s44, s26, s28
    s_cselect_b32 s45, s27, s29
    s_barrier
    s_add_u32 m0, s49, 0
    s_add_u32 s53, s48, 0
    buffer_load_dwordx4 v2, s[44:47], s53 offen lds
    s_add_u32 m0, s49, 2048
    s_add_u32 s53, s48, 147456
    buffer_load_dwordx4 v2, s[44:47], s53 offen lds
F_B2:
    s_add_u32 m0, s49, 4096
    s_add_u32 s53, s48, 294912
    buffer_load_dwordx4 v2, s[44:47], s53 offen lds
    s_add_u32 m0, s49, 6144
    s_add_u32 s53, s48, 442368
    buffer_load_dwordx4 v2, s[44:47], s53 offen lds
    s_add_u32 m0, s49, 8192
    s_add_u32 s53, s48, 589824
    buffer_load_dwordx4 v2, s[44:47], s53 offen lds
    s_add_u32 m0, s49, 10240
    s_add_u32 s53, s48, 737280
    buffer_load_dwordx4 v2, s[44:47], s53 offen lds
    s_add_u32 m0, s49, 12288
    s_add_u32 s53, s48, 884736
    buffer_load_dwordx4 v2, s[44:47], s53 offen lds
    s_add_u32 m0, s49, 14336
    s_add_u32 s53, s48, 1032192
    buffer_load_dwordx4 v2, s[44:47], s53 offen lds
    s_add_u32 m0, s49, 16384
    s_add_u32 s53, s48, 1179648
    buffer_load_dwordx4 v2, s[44:47], s53 offen lds
    s_add_u32 m0, s49, 18432
    s_add_u32 s53, s48, 1327104
    buffer_load_dwordx4 v2, s[44:47], s53 offen lds
    s_add_u32 m0, s49, 20480
    s_add_u32 s53, s48, 1474560
    buffer_load_dwordx4 v2, s[44:47], s53 offen lds
    s_add_u32 m0, s49, 22528
    s_add_u32 s53, s48, 1622016
    buffer_load_dwordx4 v2, s[44:47], s53 offen lds
    s_add_u32 m0, s49, 24576
    s_add_u32 s53, s48, 1769472
    buffer_load_dwordx4 v2, s[44:47], s53 offen lds
    s_add_u32 m0, s49, 26624
    s_add_u32 s53, s48, 1916928
    buffer_load_dwordx4 v2, s[44:47], s53 offen lds
    s_add_u32 m0, s49, 28672
    s_add_u32 s53, s48, 2064384
    buffer_load_dwordx4 v2, s[44:47], s53 offen lds
    s_add_u32 m0, s49, 30720
    s_add_u32 s53, s48, 2211840
    buffer_load_dwordx4 v2, s[44:47], s53 offen lds
    s_add_u32 m0, s49, 32768
    s_add_u32 s53, s48, 2359296
    buffer_load_dwordx4 v2, s[44:47], s53 offen lds
    s_add_u32 m0, s49, 34816
    s_add_u32 s53, s48, 2506752
    buffer_load_dwordx4 v2, s[44:47], s53 offen lds
    s_branch F_W
FFN_DMA:
    s_setprio 0
    s_sub_u32 s58, s2, 192
    s_lshl_b32 s61, s58, 1
    s_mov_b32 s59, 8
    s_mov_b32 s57, 73728
    s_waitcnt vmcnt(0)
    s_branch F_L2
F_B0:
    s_setprio 3
    s_sub_u32 s52, s2, 192
    s_and_b32 s53, s52, 0xffffffe7
    s_xor_b32 s54, s38, 11
    s_or_b32 s53, s53, s54
    s_cbranch_scc1 F_NM
    s_cmp_eq_u32 s52, 24
    s_cbranch_scc1 F_NM
    s_lshl_b32 s53, s52, 18
    s_add_u32 s53, s53, 16384
    s_add_u32 s54, s53, 8192
    v_mov_b32 v10, 0
    v_mov_b32 v11, 161416
    s_mov_b64 exec, 0x1
    s_mov_b32 s62, -1
    s_movk_i32 s60, 8
F_ML:
    s_xor_b32 s53, s53, 0x2000
    s_xor_b32 s54, s54, 0x2000
    buffer_store_dword v10, v10, s[40:43], s53 offen offset:0 sc1
    buffer_store_dword v10, v10, s[40:43], s54 offen offset:0 sc1
    v_add_u32 v10, 0x80, v10
    s_waitcnt vmcnt(1)
    s_memtime s[64:65]
    s_waitcnt vmcnt(0)
    s_memtime s[66:67]
    s_sub_u32 s60, s60, 1
    s_cselect_b32 s62, 0, s62
    s_waitcnt lgkmcnt(0)
    s_sub_u32 s64, s66, s64
    s_cmp_lt_u32 s64, s62
    s_movk_i32 s62, 64
    s_cbranch_scc1 F_ML
    v_mov_b32 v10, 0
    s_bitcmp1_b32 s53, 13
    s_cselect_b32 s53, 0x2000, 0
    s_movk_i32 s60, 4000
F_MT:
    ds_read_b64 v[12:13], v11
    s_sub_u32 s60, s60, 1
    s_cmp_gt_i32 s60, 0
    s_waitcnt lgkmcnt(0)
    v_readfirstlane_b32 s54, v12
    s_nop 0
    s_cselect_b32 s54, s54, 1
    s_cmp_lg_u32 s54, 1
    s_cbranch_scc1 F_MT
    v_and_b32 v13, 0xffffdfff, v13
    v_or_b32 v13, s53, v13
    buffer_store_dword v13, v10, s[40:43], s52 offen offset:2048 sc1
    s_mov_b64 exec, -1
F_NM:
    s_barrier
F_W:
    s_mov_b64 exec, -1
    v_mov_b32 v167, 156684
    ds_read_b32 v167, v167
    v_and_b32 v7, 7, v1
    v_lshrrev_b32 v8, 3, v1
    v_and_b32 v5, 15, v1
    v_lshrrev_b32 v6, 4, v1
    s_mul_i32 s52, s61, 36864
    s_mul_i32 s53, s38, 96
    s_add_u32 s52, s52, s53
    v_mul_u32_u24 v9, 0x480, v8
    v_mad_u32_u24 v9, v7, 12, v9
    v_add_u32 v9, s52, v9
    global_load_dwordx3 v[16:18], v9, s[30:31]
    v_add_u32 v9, 0x2400, v9
    global_load_dwordx3 v[20:22], v9, s[30:31]
    v_add_u32 v9, 0x2400, v9
    global_load_dwordx3 v[24:26], v9, s[30:31]
    v_add_u32 v9, 0x2400, v9
    global_load_dwordx3 v[28:30], v9, s[30:31]
    v_add_u32 v9, 0x2400, v9
    s_cmp_eq_u32 s59, 4
    s_cbranch_scc1 F_W4
    global_load_dwordx3 v[32:34], v9, s[30:31]
    v_add_u32 v9, 0x2400, v9
    global_load_dwordx3 v[36:38], v9, s[30:31]
    v_add_u32 v9, 0x2400, v9
    global_load_dwordx3 v[40:42], v9, s[30:31]
    v_add_u32 v9, 0x2400, v9
    global_load_dwordx3 v[44:46], v9, s[30:31]
F_W4:
    v_mul_u32_u24 v10, 683, v0
    v_lshrrev_b32 v10, 16, v10
    v_mul_u32_u24 v11, 0x60, v10
    v_sub_u32 v11, v0, v11
    s_mov_b32 s52, 161920
    v_lshl_add_u32 v160, v10, 2, s52
    v_and_b32 v63, 4, v10
    v_lshl_add_u32 v160, v63, 2, v160
    v_mov_b32 v63, 161492
    s_mov_b32 s52, 3144192
    v_lshl_add_u32 v161, v11, 4, s52
    v_mul_u32_u24 v162, 608, v10
    v_mad_u32_u24 v162, v11, 6, v162
    v_and_b32 v11, 1, v11
    v_mul_u32_u24 v11, 4862, v11
    v_sub_u32 v2, v162, v11
    v_add_u32 v2, 152320, v2
    v_add_u32 v162, 147456, v162
    v_add_u32 v162, v11, v162
    v_mul_u32_u24 v163, 608, v5
    v_lshl_add_u32 v163, v6, 4, v163
    v_add_u32 v163, 147456, v163
    s_lshr_b32 s52, s38, 2
    s_lshl_b32 s52, s52, 10
    s_and_b32 s53, s38, 3
    s_lshl_b32 s53, s53, 2
    s_add_u32 s52, s52, s53
    s_add_u32 s52, s52, 157184
    v_add_u32 v164, s52, v3
    v_mov_b32 v10, 0
    ds_write_b32 v164, v10
    v_add_u32 v60, 157184, v3
    v_xor_b32 v61, 0x80, v60
    v_and_b32 v10, 6, v1
    v_and_b32 v11, 9, v1
    v_lshl_add_u32 v164, v10, 7, s52
    v_lshl_add_u32 v164, v11, 1, v164
    v_and_b32 v10, 16, v1
    v_and_b32 v11, 32, v1
    v_lshl_add_u32 v164, v10, 2, v164
    v_add_u32 v164, v11, v164
    v_and_b32 v10, 1, v6
    v_mul_u32_u24 v10, 0x48, v10
    v_and_b32 v11, 1, v8
    v_add3_u32 v166, v10, v11, 2
    v_lshl_add_u32 v10, v11, 2, v10
    v_lshrrev_b32 v11, 1, v6
    v_add_u32 v165, v10, v11
    s_mul_i32 s62, s38, 6
    s_cmp_lt_u32 s58, 64
    s_cselect_b32 s53, 13, 11
    s_cselect_b32 s54, 14, 11
    v_add_u32 v165, s62, v165
    v_and_b32 v10, 3, v165
    v_lshlrev_b32 v10, s54, v10
    v_lshl_add_u32 v10, v7, 4, v10
    v_and_b32 v11, 4, v165
    v_lshl_add_u32 v10, v11, 11, v10
    v_and_b32 v165, 0xf8, v165
    v_lshl_add_u32 v165, v165, s53, v10
    v_add_u32 v166, s62, v166
    v_and_b32 v10, 3, v166
    v_lshlrev_b32 v10, s54, v10
    v_lshl_add_u32 v10, v7, 4, v10
    v_and_b32 v11, 4, v166
    v_lshl_add_u32 v10, v11, 11, v10
    v_and_b32 v166, 0xf8, v166
    v_lshl_add_u32 v166, v166, s53, v10
    s_cselect_b32 s62, 0, 1171456
    s_lshl_b32 s53, s58, 7
    s_add_u32 s62, s62, s53
    s_add_u32 s62, s62, 262144
    s_mov_b32 s63, 8388608
    s_movk_i32 s64, -1536
    v_bfe_u32 v10, v1, 1, 1
    v_bfe_u32 v11, v1, 3, 2
    v_lshl_add_u32 v11, v10, 2, v11
    v_xor_b32 v11, s38, v11
    v_mul_u32_u24 v12, s57, v10
    v_lshl_add_u32 v12, v11, 4, v12
    v_and_b32 v10, 1, v1
    v_lshl_add_u32 v12, v10, 3, v12
    v_bfe_u32 v10, v1, 2, 2
    v_lshl_add_u32 v10, v6, 3, v10
    v_lshl_add_u32 v12, v10, 7, v12
    v_add_u32 v13, 36864, v12
    v_mov_b32 v14, 161488
    v_mov_b32 v15, 1
    s_mov_b32 s52, 0x05040100
    s_mov_b32 s53, 0x07060302
    v_mov_b32 v10, s52
    v_mov_b32 v4, 0x05040c0c
    v_mov_b32 v5, 0x01000c0c
    v_mov_b32 v6, 0x44444444
    s_mov_b32 exec_lo, 0xff00ff00
    s_mov_b32 exec_hi, 0xff00ff00
    v_mov_b32 v10, 0x03020706
    v_mov_b32 v4, 0x03020c0c
    v_mov_b32 v5, 0x07060c0c
    v_mov_b32 v6, 0xeeeeeeee
    s_mov_b64 exec, -1
    s_waitcnt lgkmcnt(0)
    v_readfirstlane_b32 s39, v167
    s_cmp_eq_u32 s59, 4
    s_cbranch_scc0 F_W8
    s_waitcnt vmcnt(0)
F_W8:
    s_sub_u32 s51, s38, 3
    s_cmp_ge_u32 s51, 8
    s_cbranch_scc1 F_NC
    s_waitcnt vmcnt(8)
    s_mov_b64 exec, 0x1
    ds_add_u32 v14, v15
    s_mov_b64 exec, -1
F_NC:
    s_waitcnt vmcnt(7)
    v_mov_b32 v19, v16
    v_mov_b32_dpp v11, v17 row_ror:8 row_mask:0xf bank_mask:0xf
    v_mov_b32_dpp v16, v18 row_ror:8 row_mask:0xf bank_mask:0xc
    v_mov_b32_dpp v18, v19 row_ror:8 row_mask:0xf bank_mask:0x3
    v_perm_b32 v152, v11, v17, v10
    v_perm_b32 v136, v18, v16, s52
    v_perm_b32 v144, v18, v16, s53
    s_waitcnt vmcnt(6)
    v_mov_b32 v23, v20
    v_mov_b32_dpp v11, v21 row_ror:8 row_mask:0xf bank_mask:0xf
    v_mov_b32_dpp v20, v22 row_ror:8 row_mask:0xf bank_mask:0xc
    v_mov_b32_dpp v22, v23 row_ror:8 row_mask:0xf bank_mask:0x3
    v_perm_b32 v153, v11, v21, v10
    v_perm_b32 v137, v22, v20, s52
    v_perm_b32 v145, v22, v20, s53
    s_waitcnt vmcnt(5)
    v_mov_b32 v27, v24
    v_mov_b32_dpp v11, v25 row_ror:8 row_mask:0xf bank_mask:0xf
    v_mov_b32_dpp v24, v26 row_ror:8 row_mask:0xf bank_mask:0xc
    v_mov_b32_dpp v26, v27 row_ror:8 row_mask:0xf bank_mask:0x3
    v_perm_b32 v154, v11, v25, v10
    v_perm_b32 v138, v26, v24, s52
    v_perm_b32 v146, v26, v24, s53
    s_waitcnt vmcnt(4)
    v_mov_b32 v31, v28
    v_mov_b32_dpp v11, v29 row_ror:8 row_mask:0xf bank_mask:0xf
    v_mov_b32_dpp v28, v30 row_ror:8 row_mask:0xf bank_mask:0xc
    v_mov_b32_dpp v30, v31 row_ror:8 row_mask:0xf bank_mask:0x3
    v_perm_b32 v155, v11, v29, v10
    v_perm_b32 v139, v30, v28, s52
    v_perm_b32 v147, v30, v28, s53
    s_waitcnt vmcnt(3)
    v_mov_b32 v35, v32
    v_mov_b32_dpp v11, v33 row_ror:8 row_mask:0xf bank_mask:0xf
    v_mov_b32_dpp v32, v34 row_ror:8 row_mask:0xf bank_mask:0xc
    v_mov_b32_dpp v34, v35 row_ror:8 row_mask:0xf bank_mask:0x3
    v_perm_b32 v156, v11, v33, v10
    v_perm_b32 v140, v34, v32, s52
    v_perm_b32 v148, v34, v32, s53
    s_waitcnt vmcnt(2)
    v_mov_b32 v39, v36
    v_mov_b32_dpp v11, v37 row_ror:8 row_mask:0xf bank_mask:0xf
    v_mov_b32_dpp v36, v38 row_ror:8 row_mask:0xf bank_mask:0xc
    v_mov_b32_dpp v38, v39 row_ror:8 row_mask:0xf bank_mask:0x3
    v_perm_b32 v157, v11, v37, v10
    v_perm_b32 v141, v38, v36, s52
    v_perm_b32 v149, v38, v36, s53
    s_waitcnt vmcnt(1)
    v_mov_b32 v43, v40
    v_mov_b32_dpp v11, v41 row_ror:8 row_mask:0xf bank_mask:0xf
    v_mov_b32_dpp v40, v42 row_ror:8 row_mask:0xf bank_mask:0xc
    v_mov_b32_dpp v42, v43 row_ror:8 row_mask:0xf bank_mask:0x3
    v_perm_b32 v158, v11, v41, v10
    v_perm_b32 v142, v42, v40, s52
    v_perm_b32 v150, v42, v40, s53
    s_waitcnt vmcnt(0)
    v_mov_b32 v47, v44
    v_mov_b32_dpp v11, v45 row_ror:8 row_mask:0xf bank_mask:0xf
    v_mov_b32_dpp v44, v46 row_ror:8 row_mask:0xf bank_mask:0xc
    v_mov_b32_dpp v46, v47 row_ror:8 row_mask:0xf bank_mask:0x3
    v_perm_b32 v159, v11, v45, v10
    v_perm_b32 v143, v46, v44, s52
    v_perm_b32 v151, v46, v44, s53
    s_cmp_ge_u32 s38, s59
    s_cbranch_scc1 F_NT
    s_movk_i32 s60, 4000
F_CP:
    ds_read_b32 v15, v14
    s_sub_u32 s60, s60, 1
    s_cmp_gt_i32 s60, 0
    s_waitcnt lgkmcnt(0)
    v_readfirstlane_b32 s52, v15
    s_nop 0
    s_cselect_b32 s52, s52, 8
    s_cmp_eq_u32 s52, 8
    s_cbranch_scc1 F_CD
    s_sleep 2
    s_branch F_CP
F_CD:
    ds_read_b64_tr_b16 v[64:65], v12 offset:0
    ds_read_b64_tr_b16 v[66:67], v12 offset:512
    ds_read_b64_tr_b16 v[68:69], v12 offset:4096
    ds_read_b64_tr_b16 v[70:71], v12 offset:4608
    ds_read_b64_tr_b16 v[72:73], v12 offset:8192
    ds_read_b64_tr_b16 v[74:75], v12 offset:8704
    ds_read_b64_tr_b16 v[76:77], v12 offset:12288
    ds_read_b64_tr_b16 v[78:79], v12 offset:12800
    ds_read_b64_tr_b16 v[80:81], v12 offset:16384
    ds_read_b64_tr_b16 v[82:83], v12 offset:16896
    ds_read_b64_tr_b16 v[84:85], v12 offset:20480
    ds_read_b64_tr_b16 v[86:87], v12 offset:20992
    ds_read_b64_tr_b16 v[88:89], v12 offset:24576
    ds_read_b64_tr_b16 v[90:91], v12 offset:25088
    ds_read_b64_tr_b16 v[92:93], v12 offset:28672
    ds_read_b64_tr_b16 v[94:95], v12 offset:29184
    ds_read_b64_tr_b16 v[96:97], v12 offset:32768
    ds_read_b64_tr_b16 v[98:99], v12 offset:33280
    ds_read_b64_tr_b16 v[100:101], v13 offset:0
    ds_read_b64_tr_b16 v[102:103], v13 offset:512
    ds_read_b64_tr_b16 v[104:105], v13 offset:4096
    ds_read_b64_tr_b16 v[106:107], v13 offset:4608
    ds_read_b64_tr_b16 v[108:109], v13 offset:8192
    ds_read_b64_tr_b16 v[110:111], v13 offset:8704
    ds_read_b64_tr_b16 v[112:113], v13 offset:12288
    ds_read_b64_tr_b16 v[114:115], v13 offset:12800
    ds_read_b64_tr_b16 v[116:117], v13 offset:16384
    ds_read_b64_tr_b16 v[118:119], v13 offset:16896
    ds_read_b64_tr_b16 v[120:121], v13 offset:20480
    ds_read_b64_tr_b16 v[122:123], v13 offset:20992
    ds_read_b64_tr_b16 v[124:125], v13 offset:24576
    ds_read_b64_tr_b16 v[126:127], v13 offset:25088
    ds_read_b64_tr_b16 v[128:129], v13 offset:28672
    ds_read_b64_tr_b16 v[130:131], v13 offset:29184
    ds_read_b64_tr_b16 v[132:133], v13 offset:32768
    ds_read_b64_tr_b16 v[134:135], v13 offset:33280
    s_waitcnt lgkmcnt(0)
    v_mov_b32 v12, 0
    v_mov_b32 v13, 0
    v_mov_b32 v14, 0
    v_mov_b32 v15, 0
F_NT:
    s_cmp_lg_u32 s38, 11
    s_cbranch_scc1 F_SEL
    s_cmp_lt_u32 s2, 192
    s_cbranch_scc1 T_EV
    v_lshrrev_b32 v7, 1, v3
    v_min_u32 v7, 16, v7
    s_mov_b64 exec, 0xf
    s_movk_i32 s60, 4000
F_PL:
    buffer_load_dword v8, v7, s[40:43], 0 offen offset:2048 sc1
F_PL_W:
    s_waitcnt vmcnt(0)
F_PL_C:
    v_xor_b32 v9, s39, v8
    v_and_b32 v9, 0xffffdfff, v9
    v_cmp_ne_u32 vcc, 0, v9
    s_nop 0
    s_and_b64 exec, exec, vcc
    s_cbranch_execz F_PL_D
    s_sub_u32 s60, s60, 1
    s_cmp_gt_i32 s60, 0
    s_sleep 2
    s_cbranch_scc1 F_PL
F_PL_D:
    s_mov_b64 exec, 0xf
F_PL_K:
    v_lshrrev_b32 v7, 2, v3
    v_add_u32 v7, 161504, v7
    v_and_b32 v8, 0x2000, v8
    ds_write_b32 v7, v8
    s_mov_b64 exec, -1
    v_readlane_b32 s0, v8, 0
    v_readlane_b32 s1, v8, 1
    s_branch T_EV
FINAL:
    s_cmp_ge_u32 s2, 144
    s_cbranch_scc1 END
    s_cmp_lg_u32 s38, 11
    s_cbranch_scc1 END
    s_branch T_EV
TOP8:
    s_and_b32 s65, s2, 3
    s_lshl_b32 s65, s65, 14
    s_and_b32 s66, s2, 4
    s_lshl_b32 s66, s66, 11
    s_xor_b32 s66, s66, s0
    s_add_u32 s65, s65, s66
    s_add_u32 s65, s65, 65536
    s_add_u32 s66, s65, 4096
    s_waitcnt lgkmcnt(0)
    buffer_load_dwordx4 v[16:19], v3, s[40:43], s65 offen offset:0 sc1
    buffer_load_dwordx4 v[20:23], v3, s[40:43], s65 offen offset:1024 sc1
    buffer_load_dwordx4 v[24:27], v3, s[40:43], s65 offen offset:2048 sc1
    buffer_load_dwordx4 v[28:31], v3, s[40:43], s65 offen offset:3072 sc1
    buffer_load_dwordx4 v[32:35], v3, s[40:43], s66 offen offset:0 sc1
    buffer_load_dwordx4 v[36:39], v3, s[40:43], s66 offen offset:1024 sc1
    buffer_load_dwordx4 v[40:43], v3, s[40:43], s66 offen offset:2048 sc1
    buffer_load_dwordx4 v[44:47], v3, s[40:43], s66 offen offset:3072 sc1
T_EV:
    v_bfe_i32 v7, v1, 0, 1
    v_bfe_i32 v8, v1, 1, 1
    v_bfe_i32 v9, v1, 3, 1
    v_bfe_i32 v11, v1, 4, 1
    v_bfe_i32 v13, v1, 5, 1
    v_xor_b32 v48, v7, v8
    v_xor_b32 v49, v8, v9
    v_xor_b32 v50, v7, v9
    v_xor_b32 v11, v11, v13
    v_xor_b32 v51, v9, v11
    v_xor_b32 v52, v8, v11
    v_xor_b32 v53, v7, v11
    v_mov_b32 v63, 161492
    v_lshl_add_u32 v13, v1, 2, v63
    v_add_u32 v13, 428, v13
    v_sub_u32 v54, 148464, v3
    v_and_b32 v7, 4, v1
    v_and_b32 v8, 48, v1
    v_lshlrev_b32 v8, 6, v8
    v_lshl_add_u32 v55, v7, 1, v8
    v_add_u32 v55, 147456, v55
    s_and_b32 s65, s2, 3
    s_lshl_b32 s65, s65, 14
    s_and_b32 s66, s2, 4
    s_lshl_b32 s66, s66, 11
    s_xor_b32 s66, s66, s0
    s_add_u32 s65, s65, s66
    s_add_u32 s65, s65, 65536
    s_add_u32 s66, s65, 4096
    s_and_b32 s67, s2, 127
    s_mul_i32 s68, s67, 64
    s_add_u32 s68, s68, s65
    v_mov_b32 v10, 0
    s_cmp_lt_u32 s2, 128
    s_cbranch_scc0 T_E2
    s_movk_i32 s60, 4000
    s_mov_b64 exec, 0x1
    s_waitcnt vmcnt(8)
    buffer_store_dword v167, v10, s[40:43], s50 offen sc1
    s_mov_b64 exec, -1
    s_waitcnt vmcnt(1)
    s_branch T_KP_C
T_E2:
    v_mov_b32 v16, -1
    v_mov_b32 v17, -1
    v_mov_b32 v18, -1
    v_mov_b32 v19, -1
    v_mov_b32 v20, -1
    v_mov_b32 v21, -1
    v_mov_b32 v22, -1
    v_mov_b32 v23, -1
    v_mov_b32 v24, -1
    v_mov_b32 v25, -1
    v_mov_b32 v26, -1
    v_mov_b32 v27, -1
    v_mov_b32 v28, -1
    v_mov_b32 v29, -1
    v_mov_b32 v30, -1
    v_mov_b32 v31, -1
    v_mov_b32 v32, -1
    v_mov_b32 v33, -1
    v_mov_b32 v34, -1
    v_mov_b32 v35, -1
    v_mov_b32 v36, -1
    v_mov_b32 v37, -1
    v_mov_b32 v38, -1
    v_mov_b32 v39, -1
    v_mov_b32 v40, -1
    v_mov_b32 v41, -1
    v_mov_b32 v42, -1
    v_mov_b32 v43, -1
    v_mov_b32 v44, -1
    v_mov_b32 v45, -1
    v_mov_b32 v46, -1
    v_mov_b32 v47, -1
    s_lshr_b32 s52, s67, 3
    s_lshl_b32 s52, s52, 16
    s_and_b32 s53, s67, 3
    s_lshl_b32 s53, s53, 14
    s_or_b32 s52, s52, s53
    s_and_b32 s53, s67, 4
    s_lshl_b32 s53, s53, 11
    s_or_b32 s52, s52, s53
    s_xor_b32 s52, s52, s1
    s_lshr_b32 s53, s67, 6
    s_lshl_b32 s53, s53, 20
    s_add_u32 s52, s52, s53
    s_and_b32 s53, s67, 48
    s_lshl_b32 s53, s53, 7
    s_add_u32 s52, s52, s53
    s_and_b32 s53, s67, 1
    s_lshl_b32 s53, s53, 10
    s_add_u32 s52, s52, s53
    s_and_b32 s53, s67, 14
    s_lshl_b32 s53, s53, 6
    s_add_u32 s52, s52, s53
    s_add_u32 s67, s52, 2097164
    s_mov_b64 exec, 0xf
    s_movk_i32 s60, 4000
T_EP:
    buffer_load_dword v11, v3, s[40:43], s67 offen sc1
T_EP_W:
    s_waitcnt vmcnt(0)
T_EP_C:
    v_cmp_ne_u32 vcc, s39, v11
    s_nop 0
    s_and_b64 exec, exec, vcc
    s_cbranch_execz T_EP_D
    s_sub_u32 s60, s60, 1
    s_cmp_gt_i32 s60, 0
    s_sleep 2
    s_cbranch_scc1 T_EP
T_EP_D:
T_H:
    s_mov_b64 exec, 0x1
    s_movk_i32 s60, 4000
T_HP:
    buffer_load_dword v11, v10, s[40:43], s68 offen sc1
T_HP_W:
    s_waitcnt vmcnt(0)
T_HP_C:
    v_cmp_eq_u32 vcc, -1, v11
    s_nop 0
    s_and_b64 exec, exec, vcc
    s_cbranch_execz T_HP_D
    s_sub_u32 s60, s60, 1
    s_cmp_gt_i32 s60, 0
    s_sleep 1
    s_cbranch_scc1 T_HP
T_HP_D:
    s_mov_b64 exec, -1
    s_cmp_ge_u32 s2, 144
    s_cbranch_scc0 T_KQ
    s_movk_i32 s60, 4000
T_KN:
    buffer_load_dwordx4 v[16:19], v3, s[40:43], s65 offen offset:0 sc1
    buffer_load_dwordx4 v[20:23], v3, s[40:43], s65 offen offset:1024 sc1
    buffer_load_dwordx4 v[24:27], v3, s[40:43], s65 offen offset:2048 sc1
    buffer_load_dwordx4 v[28:31], v3, s[40:43], s65 offen offset:3072 sc1
    buffer_load_dwordx4 v[32:35], v3, s[40:43], s66 offen offset:0 sc1
    buffer_load_dwordx4 v[36:39], v3, s[40:43], s66 offen offset:1024 sc1
    buffer_load_dwordx4 v[40:43], v3, s[40:43], s66 offen offset:2048 sc1
    buffer_load_dwordx4 v[44:47], v3, s[40:43], s66 offen offset:3072 sc1
    s_waitcnt vmcnt(16)
    s_sub_u32 s60, s60, 1
    v_max3_u32 v56, v16, v17, v18
    v_max3_u32 v58, v19, v20, v21
    v_max3_u32 v57, v32, v33, v34
    v_max3_u32 v59, v35, v36, v37
    v_max3_u32 v56, v56, v22, v23
    v_max3_u32 v58, v58, v24, v25
    v_max3_u32 v57, v57, v38, v39
    v_max3_u32 v59, v59, v40, v41
    v_max3_u32 v56, v56, v26, v27
    v_max3_u32 v58, v58, v28, v29
    v_max3_u32 v57, v57, v42, v43
    v_max3_u32 v59, v59, v44, v45
    v_max3_u32 v58, v58, v30, v31
    v_max3_u32 v59, v59, v46, v47
    v_max_u32 v56, v56, v58
    v_max_u32 v57, v57, v59
    v_max_u32 v58, v56, v57
    v_cmp_eq_u32 vcc, -1, v58
    s_nop 0
    s_and_b64 exec, exec, vcc
    s_cselect_b32 s60, s60, 0
    s_cmp_gt_i32 s60, 0
    s_cbranch_scc1 T_KN
    s_branch T_KP_D
T_KQ:
    s_movk_i32 s60, 4000
T_KP:
    buffer_load_dwordx4 v[16:19], v3, s[40:43], s65 offen offset:0 sc1
    buffer_load_dwordx4 v[20:23], v3, s[40:43], s65 offen offset:1024 sc1
    buffer_load_dwordx4 v[24:27], v3, s[40:43], s65 offen offset:2048 sc1
    buffer_load_dwordx4 v[28:31], v3, s[40:43], s65 offen offset:3072 sc1
    buffer_load_dwordx4 v[32:35], v3, s[40:43], s66 offen offset:0 sc1
    buffer_load_dwordx4 v[36:39], v3, s[40:43], s66 offen offset:1024 sc1
    buffer_load_dwordx4 v[40:43], v3, s[40:43], s66 offen offset:2048 sc1
    buffer_load_dwordx4 v[44:47], v3, s[40:43], s66 offen offset:3072 sc1
T_KP_W:
    s_waitcnt vmcnt(0)
T_KP_C:
    v_max3_u32 v56, v16, v17, v18
    v_max3_u32 v58, v19, v20, v21
    v_max3_u32 v57, v32, v33, v34
    v_max3_u32 v59, v35, v36, v37
    v_max3_u32 v56, v56, v22, v23
    v_max3_u32 v58, v58, v24, v25
    v_max3_u32 v57, v57, v38, v39
    v_max3_u32 v59, v59, v40, v41
    v_max3_u32 v56, v56, v26, v27
    v_max3_u32 v58, v58, v28, v29
    v_max3_u32 v57, v57, v42, v43
    v_max3_u32 v59, v59, v44, v45
    v_max3_u32 v58, v58, v30, v31
    v_max3_u32 v59, v59, v46, v47
    v_max_u32 v56, v56, v58
    v_max_u32 v57, v57, v59
    v_max_u32 v58, v56, v57
    v_cmp_eq_u32 vcc, -1, v58
    s_nop 0
    s_and_b64 exec, exec, vcc
    s_cbranch_execz T_KP_D
    s_sub_u32 s60, s60, 1
    s_cmp_gt_i32 s60, 0
    s_cbranch_scc1 T_KP
T_KP_D:
    s_mov_b64 exec, -1
    v_mov_b32_dpp v58, v56 quad_perm:[1,0,3,2] row_mask:0xf bank_mask:0xf
    v_mov_b32_dpp v59, v57 quad_perm:[1,0,3,2] row_mask:0xf bank_mask:0xf
    v_med3_u32 v56, v56, v58, v48
    v_med3_u32 v57, v57, v59, v48
    ds_write_b128 v54, v[16:19] offset:7168
    v_mov_b32_dpp v58, v56 quad_perm:[2,3,0,1] row_mask:0xf bank_mask:0xf
    v_mov_b32_dpp v59, v57 quad_perm:[2,3,0,1] row_mask:0xf bank_mask:0xf
    v_med3_u32 v56, v56, v58, v49
    v_med3_u32 v57, v57, v59, v49
    ds_write_b128 v54, v[20:23] offset:6144
    v_mov_b32_dpp v58, v56 quad_perm:[1,0,3,2] row_mask:0xf bank_mask:0xf
    v_mov_b32_dpp v59, v57 quad_perm:[1,0,3,2] row_mask:0xf bank_mask:0xf
    v_med3_u32 v56, v56, v58, v50
    v_med3_u32 v57, v57, v59, v50
    ds_write_b128 v54, v[24:27] offset:5120
    v_mov_b32_dpp v58, v56 row_ror:8 row_mask:0xf bank_mask:0xf
    v_mov_b32_dpp v59, v57 row_ror:8 row_mask:0xf bank_mask:0xf
    v_med3_u32 v56, v56, v58, v51
    v_med3_u32 v57, v57, v59, v51
    ds_write_b128 v54, v[28:31] offset:4096
    v_mov_b32_dpp v58, v56 quad_perm:[2,3,0,1] row_mask:0xf bank_mask:0xf
    v_mov_b32_dpp v59, v57 quad_perm:[2,3,0,1] row_mask:0xf bank_mask:0xf
    v_med3_u32 v56, v56, v58, v52
    v_med3_u32 v57, v57, v59, v52
    ds_write_b128 v54, v[32:35] offset:3072
    v_mov_b32_dpp v58, v56 quad_perm:[1,0,3,2] row_mask:0xf bank_mask:0xf
    v_mov_b32_dpp v59, v57 quad_perm:[1,0,3,2] row_mask:0xf bank_mask:0xf
    v_med3_u32 v56, v56, v58, v53
    v_med3_u32 v57, v57, v59, v53
    ds_write_b128 v54, v[36:39] offset:2048
    s_nop 0
    v_max_u32_dpp v56, v57, v56 row_mirror row_mask:0xf bank_mask:0xf
    ds_write_b128 v54, v[40:43] offset:1024
    s_nop 0
    v_mov_b32_dpp v58, v56 row_ror:8 row_mask:0xf bank_mask:0xf
    v_med3_u32 v56, v56, v58, v51
    ds_write_b128 v54, v[44:47] offset:0
    s_nop 0
    v_mov_b32_dpp v58, v56 quad_perm:[2,3,0,1] row_mask:0xf bank_mask:0xf
    v_med3_u32 v56, v56, v58, v52
    s_nop 1
    v_mov_b32_dpp v58, v56 quad_perm:[1,0,3,2] row_mask:0xf bank_mask:0xf
    v_med3_u32 v56, v56, v58, v53
    s_nop 1
    v_max_u32_dpp v56, v56, v56 row_mirror row_mask:0xf bank_mask:0xf
    s_nop 1
    v_mov_b32_dpp v58, v56 row_ror:8 row_mask:0xf bank_mask:0xf
    v_med3_u32 v56, v56, v58, v51
    s_nop 1
    v_mov_b32_dpp v58, v56 quad_perm:[2,3,0,1] row_mask:0xf bank_mask:0xf
    v_med3_u32 v56, v56, v58, v52
    s_nop 1
    v_mov_b32_dpp v58, v56 quad_perm:[1,0,3,2] row_mask:0xf bank_mask:0xf
    v_med3_u32 v57, v56, v58, v53
    v_med3_u32 v56, v56, v58, v53
    s_nop 1
    v_permlane16_swap_b32 v56, v57
    v_max_u32 v56, v56, v57
    s_nop 1
    v_mov_b32_dpp v58, v56 row_ror:8 row_mask:0xf bank_mask:0xf
    v_med3_u32 v56, v56, v58, v51
    s_nop 1
    v_mov_b32_dpp v58, v56 quad_perm:[2,3,0,1] row_mask:0xf bank_mask:0xf
    v_med3_u32 v56, v56, v58, v52
    s_nop 1
    v_mov_b32_dpp v58, v56 quad_perm:[1,0,3,2] row_mask:0xf bank_mask:0xf
    v_med3_u32 v57, v56, v58, v53
    v_med3_u32 v56, v56, v58, v53
    s_nop 1
    v_permlane32_swap_b32 v56, v57
    v_max_u32 v56, v56, v57
    ds_write_b32 v13, v56
    s_cmp_lt_u32 s2, 144
    v_and_b32 v58, 0x4fc, v56
    v_lshl_or_b32 v58, v58, 2, v55
    v_mov_b32 v62, v56
    ds_read_b64 v[56:57], v58
    s_cbranch_scc1 T_V
    s_waitcnt lgkmcnt(0)
    s_barrier
    ds_read_b32 v7, v160
    s_waitcnt lgkmcnt(0)
    v_and_b32 v7, 0x7ff, v7
    v_mad_i32_i24 v7, v7, s64, v161
    buffer_load_dwordx4 v[8:11], v7, s[40:43], s63 offen sc1
T_V:
    v_min_u32_dpp v58, v62, v62 quad_perm:[1,0,3,2] row_mask:0xf bank_mask:0xf
    s_nop 1
    v_min_u32_dpp v58, v58, v58 quad_perm:[2,3,0,1] row_mask:0xf bank_mask:0xf
    s_nop 1
    v_min_u32_dpp v58, v58, v58 row_ror:8 row_mask:0xf bank_mask:0xf
    s_waitcnt lgkmcnt(0)
    v_cmp_ge_u32 vcc, v56, v58
    v_cmp_ge_u32 s[52:53], v57, v58
    s_bcnt1_i32_b64 s54, vcc
    s_bcnt1_i32_b64 s52, s[52:53]
    s_add_u32 s52, s52, s54
    s_cmp_eq_u32 s52, 8
    s_cbranch_scc0 T_M
T_OK:
    s_movk_i32 s60, 4000
    s_cmp_lt_u32 s2, 144
    s_cbranch_scc1 FIN
    s_setprio 0
    s_branch F_ZP_W
T_M:
    v_cmp_ne_u32 s[56:57], v62, v56
    v_cmp_ne_u32 s[74:75], v62, v57
    s_nop 0
    v_cndmask_b32 v56, 0, v56, s[56:57]
    v_cndmask_b32 v57, 0, v57, s[74:75]
    s_mov_b64 s[72:73], -1
T_L:
    v_max_u32 v59, v56, v57
    v_cmp_gt_u32 vcc, v59, v58
    s_nop 4
    s_cbranch_vccz T_X
    s_ff1_i32_b64 s52, vcc
    v_cmp_eq_u32 vcc, v62, v58
    v_readlane_b32 s53, v59, s52
    s_ff1_i32_b64 s54, vcc
    s_cmp_lt_u32 s2, 144
    s_cbranch_scc1 T_L2
    s_and_b32 s55, s53, 0x7ff
    s_mul_i32 s55, s55, s64
    s_add_u32 s55, s55, 11532800
    buffer_load_dwordx4 v[64:67], v3, s[40:43], s55 offen sc1
    buffer_load_dwordx4 v[68:71], v3, s[40:43], s55 offen offset:1024 sc1
T_L2:
    v_mov_b32 v59, s53
    v_cndmask_b32 v62, v62, v59, vcc
    v_cmp_ne_u32 s[56:57], s53, v56
    v_cmp_ne_u32 s[74:75], s53, v57
    s_nop 0
    v_cndmask_b32 v56, 0, v56, s[56:57]
    v_cndmask_b32 v57, 0, v57, s[74:75]
    v_min_u32_dpp v58, v62, v62 quad_perm:[1,0,3,2] row_mask:0xf bank_mask:0xf
    s_nop 1
    v_min_u32_dpp v58, v58, v58 quad_perm:[2,3,0,1] row_mask:0xf bank_mask:0xf
    s_nop 1
    v_min_u32_dpp v58, v58, v58 row_ror:8 row_mask:0xf bank_mask:0xf
    s_cmp_lt_u32 s2, 144
    s_cbranch_scc1 T_L
    s_lshr_b32 s52, s54, 1
    s_and_b32 s52, s52, 4
    s_and_b32 s54, s54, 3
    s_add_u32 s54, s54, s52
    s_mul_i32 s54, s54, 608
    s_add_u32 s54, s54, 147456
    v_and_b32 v72, 1, v1
    v_mul_u32_u24 v72, 4862, v72
    v_mul_u32_u24 v73, 6, v1
    v_sub_u32 v74, v73, v72
    v_add_u32 v73, v73, v72
    v_add_u32 v75, s54, v73
    v_add_u32 v76, s54, v74
    s_mov_b64 exec, s[72:73]
    s_movk_i32 s60, 4000
    s_branch T_Z_W
T_Z:
    buffer_load_dwordx4 v[8:11], v7, s[40:43], s63 offen sc1
T_Z_W:
    s_waitcnt vmcnt(0)
T_Z_C:
    v_cmp_ne_u32 vcc, s39, v11
    s_nop 0
    s_and_b64 exec, exec, vcc
    s_cbranch_execz T_Z_D
    s_wqm_b64 exec, exec
    s_sub_u32 s60, s60, 1
    s_cmp_gt_i32 s60, 0
    s_cbranch_scc1 T_Z
T_Z_D:
    s_mov_b64 exec, s[72:73]
    ds_write2_b32 v162, v8, v10 offset0:0 offset1:1
    ds_write_b32 v2, v9
    s_mov_b64 s[72:73], 0
    s_mov_b64 exec, -1
    s_movk_i32 s60, 4000
    s_branch T_F_W
T_F:
    buffer_load_dwordx4 v[64:67], v3, s[40:43], s55 offen sc1
    buffer_load_dwordx4 v[68:71], v3, s[40:43], s55 offen offset:1024 sc1
T_F_W:
    s_waitcnt vmcnt(0)
T_F_C:
    v_cmp_ne_u32 vcc, s39, v67
    v_cmp_ne_u32 s[56:57], s39, v71
    s_nop 0
    s_or_b32 vcc_lo, vcc_lo, s56
    s_and_b64 exec, exec, vcc
    s_cbranch_execz T_F_D
    s_wqm_b64 exec, exec
    s_sub_u32 s60, s60, 1
    s_cmp_gt_i32 s60, 0
    s_cbranch_scc1 T_F
T_F_D:
    s_mov_b64 exec, -1
    s_movk_i32 s60, 4000
T_C:
    ds_read_b32 v72, v63 offset:0
    s_sub_u32 s60, s60, 1
    s_cmp_gt_i32 s60, 0
    s_waitcnt lgkmcnt(0)
    v_readfirstlane_b32 s52, v72
    s_nop 0
    s_cselect_b32 s52, s52, 11
    s_cmp_lg_u32 s52, 11
    s_cbranch_scc1 T_C
    ds_write2_b32 v75, v64, v66 offset0:0 offset1:1
    ds_write_b32 v76, v65 offset:4864
    s_mov_b32 exec_hi, 0
    ds_write2_b32 v75, v68, v70 offset0:96 offset1:97
    ds_write_b32 v76, v69 offset:5248
    s_mov_b64 exec, -1
    s_branch T_L
T_X:
    s_movk_i32 s60, 4000
    s_cmp_lt_u32 s2, 144
    s_cbranch_scc1 FIN
    s_setprio 0
    s_branch F_BQ
F_SEL:
    s_setprio 0
    s_waitcnt lgkmcnt(0)
    s_barrier
    ds_read_b32 v7, v160
    s_waitcnt lgkmcnt(0)
    v_and_b32 v7, 0x7ff, v7
    v_mad_i32_i24 v7, v7, s64, v161
    s_movk_i32 s60, 4000
F_ZP:
    buffer_load_dwordx4 v[8:11], v7, s[40:43], s63 offen sc1
F_ZP_W:
    s_waitcnt vmcnt(0)
F_ZP_C:
    v_cmp_ne_u32 vcc, s39, v11
    s_nop 0
    s_and_b64 exec, exec, vcc
    s_cbranch_execz F_ZP_D
    s_wqm_b64 exec, exec
    s_sub_u32 s60, s60, 1
    s_cmp_gt_i32 s60, 0
    s_cbranch_scc1 F_ZP
F_ZP_D:
    s_mov_b64 exec, -1
    ds_write2_b32 v162, v8, v10 offset0:0 offset1:1
    ds_write_b32 v2, v9
    s_mov_b64 exec, 0x1
    ds_inc_u32 v63, v63 offset:0
    s_mov_b64 exec, -1
F_BQ:
    s_cmp_ge_u32 s38, s59
    s_waitcnt lgkmcnt(0)
    s_barrier
    s_cbranch_scc1 F_H
    ds_read_b128 v[16:19], v163 offset:0
    ds_read_b128 v[20:23], v163 offset:64
    ds_read_b128 v[24:27], v163 offset:128
    ds_read_b128 v[28:31], v163 offset:192
    ds_read_b128 v[32:35], v163 offset:256
    ds_read_b128 v[36:39], v163 offset:320
    ds_read_b128 v[40:43], v163 offset:384
    ds_read_b128 v[44:47], v163 offset:448
    ds_read_b128 v[48:51], v163 offset:512
    s_waitcnt lgkmcnt(8)
    v_smfmac_f32_16x16x64_bf16 v[12:15], v[16:19], v[64:71], v6
    s_waitcnt lgkmcnt(7)
    v_smfmac_f32_16x16x64_bf16 v[12:15], v[20:23], v[72:79], v6
    s_waitcnt lgkmcnt(6)
    v_smfmac_f32_16x16x64_bf16 v[12:15], v[24:27], v[80:87], v6
    s_waitcnt lgkmcnt(5)
    v_smfmac_f32_16x16x64_bf16 v[12:15], v[28:31], v[88:95], v6
    s_waitcnt lgkmcnt(4)
    v_smfmac_f32_16x16x64_bf16 v[12:15], v[32:35], v[96:103], v6
    s_waitcnt lgkmcnt(3)
    v_smfmac_f32_16x16x64_bf16 v[12:15], v[36:39], v[104:111], v6
    s_waitcnt lgkmcnt(2)
    v_smfmac_f32_16x16x64_bf16 v[12:15], v[40:43], v[112:119], v6
    s_waitcnt lgkmcnt(1)
    v_smfmac_f32_16x16x64_bf16 v[12:15], v[44:47], v[120:127], v6
    s_waitcnt lgkmcnt(0)
    v_smfmac_f32_16x16x64_bf16 v[12:15], v[48:51], v[128:135], v6
    s_nop 7
    v_permlane32_swap_b32 v12, v14
    v_permlane32_swap_b32 v13, v15
    v_add_f32 v12, v12, v14
    v_add_f32 v13, v13, v15
    v_cvt_pk_bf16_f32 v12, v12, v13
    s_nop 1
    v_mov_b32_dpp v13, v12 row_ror:8 row_mask:0xf bank_mask:0xf
    v_perm_b32 v8, v12, v13, v4
    v_mul_f32 v10, 0xbfb8aa3b, v8
    v_exp_f32 v10, v10
    v_perm_b32 v9, v12, v13, v5
    v_add_f32 v10, 1.0, v10
    v_rcp_f32 v10, v10
    s_nop 0
    v_mul_f32 v8, v8, v10
    v_cvt_pk_bf16_f32 v8, v8, v8
    v_lshlrev_b32 v8, 16, v8
    v_mul_f32 v8, v8, v9
    v_cvt_pk_bf16_f32 v8, v8, v8
    ds_write_b16 v164, v8
F_H:
    ds_read_b32 v56, v63 offset:12
    s_waitcnt lgkmcnt(0)
    s_barrier
    ds_read_b128 v[16:19], v60
    ds_read_b128 v[20:23], v60 offset:1024
    ds_read_b128 v[24:27], v61
    ds_read_b128 v[28:31], v61 offset:1024
    v_xor_b32 v165, v56, v165
    v_xor_b32 v166, v56, v166
    s_waitcnt lgkmcnt(3)
    v_mfma_f32_16x16x32_bf16 v[12:15], v[16:19], v[152:155], 0
    v_mfma_f32_16x16x32_bf16 v[8:11], v[16:19], v[136:139], 0
    s_waitcnt lgkmcnt(2)
    v_mfma_f32_16x16x32_bf16 v[12:15], v[20:23], v[156:159], v[12:15]
    v_mfma_f32_16x16x32_bf16 v[8:11], v[20:23], v[140:143], v[8:11]
    s_waitcnt lgkmcnt(1)
    v_mfma_f32_16x16x32_bf16 v[8:11], v[24:27], v[144:147], v[8:11]
    s_waitcnt lgkmcnt(0)
    v_mfma_f32_16x16x32_bf16 v[8:11], v[28:31], v[148:151], v[8:11]
    s_mov_b32 exec_hi, 0
    s_nop 1
    buffer_store_dwordx4 v[12:15], v166, s[40:43], s62 offen sc1
    s_mov_b64 exec, -1
    s_nop 2
    buffer_store_dwordx4 v[8:11], v165, s[40:43], s62 offen sc1
    s_branch END
FIN:
    s_cmp_ge_u32 s2, 72
    s_cselect_b32 s44, 32, 0
    s_cselect_b32 s45, 72, 0
    s_sub_u32 s45, s2, s45
    s_mul_i32 s46, s45, 43
    s_lshr_b32 s46, s46, 8
    s_mul_i32 s47, s46, 6
    s_sub_u32 s47, s45, s47
    v_lshrrev_b32 v6, 4, v1
    s_lshr_b32 s54, s2, 3
    s_lshl_b32 s55, s54, 16
    s_add_u32 s55, s55, s65
    s_add_u32 s55, s55, 196608
    v_mov_b32 v15, 0
    s_mov_b64 exec, 0x1
    buffer_load_dword v14, v15, s[40:43], s55 offen sc1
    s_mov_b64 exec, -1
    v_lshl_add_u32 v7, v6, 2, s44
    ds_bpermute_b32 v7, v7, v62
    v_and_b32 v8, 7, v1
    v_and_b32 v5, 15, v1
    s_lshl_b32 s48, s47, 2
    s_add_u32 s49, s48, 1024 - 16
    s_cmp_eq_u32 s47, 3
    s_cselect_b32 s49, 1024 + 8, s49
    s_cmp_lt_u32 s47, 3
    s_cselect_b32 s48, s48, s49
    s_and_b32 s49, s46, 3
    s_lshl_b32 s49, s49, 11
    s_add_u32 s48, s48, s49
    s_lshr_b32 s49, s46, 2
    s_lshl_b32 s49, s49, 20
    s_cmp_lt_u32 s46, 8
    s_cselect_b32 s1, s1, s22
    s_add_u32 s48, s48, s49
    s_add_u32 s48, s48, 2097152
    s_lshl_b32 s47, s47, 1
    s_lshl_b32 s49, s46, 7
    s_add_u32 s49, s49, s47
    s_add_u32 s49, s49, 8388608
    s_mul_i32 s46, s46, 96
    s_add_u32 s46, s46, s47
    s_movk_i32 s47, 8192
    s_mov_b32 s52, s55
    s_lshl_b32 s54, s54, 14
    s_and_b32 s53, s55, 0x2000
    s_add_u32 s54, s54, s53
    s_and_b32 s53, s2, 3
    s_lshl_b32 s53, s53, 11
    s_add_u32 s54, s54, s53
    s_add_u32 s54, s54, 1441792
    s_add_u32 s53, s52, 4096
    v_mov_b32 v60, 0
    v_mov_b32 v61, 0
    v_mov_b32 v62, 0
    s_waitcnt lgkmcnt(0)
    v_and_b32 v9, 0x7ff, v7
    v_sub_u32 v9, 0x7ff, v9
    v_lshrrev_b32 v10, 4, v9
    v_lshlrev_b32 v11, 6, v10
    v_min_u32 v5, 11, v5
    v_lshl_add_u32 v11, v5, 2, v11
    v_mul_u32_u24 v12, 0x480, v9
    v_mad_u32_u24 v12, v8, 12, v12
    v_add_u32 v12, s46, v12
    v_and_b32 v13, 0x30, v9
    v_and_b32 v10, 0x780, v9
    v_lshlrev_b32 v10, 9, v10
    v_lshl_add_u32 v10, v13, 10, v10
    v_and_b32 v13, 0x40, v9
    v_lshl_add_u32 v10, v13, 7, v10
    v_xor_b32 v10, s1, v10
    v_lshl_add_u32 v10, v8, 7, v10
    v_and_b32 v13, 14, v9
    v_lshl_add_u32 v10, v13, 3, v10
    v_and_b32 v13, 1, v9
    v_lshl_add_u32 v10, v13, 1, v10
    v_mul_u32_u24 v9, 0x600, v9
    v_lshl_add_u32 v9, v8, 4, v9
    global_load_short_d16_hi v60, v12, s[4:5]
    buffer_load_short_d16_hi v61, v10, s[40:43], s48 offen sc1
    v_ashrrev_i32 v6, 31, v7
    v_not_b32 v6, v6
    v_or_b32 v6, 0x80000000, v6
    v_xor_b32 v7, v7, v6
    v_and_b32 v7, 0xffff0000, v7
    v_mul_f32 v7, 0xbfb8aa3b, v7
    v_exp_f32 v7, v7
    s_nop 0
    v_add_f32 v7, 1.0, v7
    v_rcp_f32 v7, v7
    s_nop 0
    v_cvt_pk_bf16_f32 v7, v7, v7
    v_lshlrev_b32 v7, 16, v7
    s_mov_b64 exec, 0x1
    s_movk_i32 s60, 4000
    s_waitcnt vmcnt(2)
    s_branch FN_HP_C
    s_movk_i32 s60, 4000
FN_HP:
    buffer_load_dword v14, v15, s[40:43], s55 offen sc1
FN_HP_W:
    s_waitcnt vmcnt(0)
FN_HP_C:
    v_cmp_eq_u32 vcc, -1, v14
    s_nop 0
    s_and_b64 exec, exec, vcc
    s_cbranch_execz FN_HP_D
    s_sub_u32 s60, s60, 1
    s_cmp_gt_i32 s60, 0
    s_cbranch_scc1 FN_HP
FN_HP_D:
    s_mov_b64 exec, -1
    buffer_load_dword v13, v11, s[40:43], s47 offen sc1
    buffer_load_short_d16_hi v62, v9, s[40:43], s49 offen sc1
    buffer_load_dwordx4 v[16:19], v3, s[40:43], s52 offen offset:0 sc1
    buffer_load_dwordx4 v[20:23], v3, s[40:43], s52 offen offset:1024 sc1
    buffer_load_dwordx4 v[24:27], v3, s[40:43], s52 offen offset:2048 sc1
    buffer_load_dwordx4 v[28:31], v3, s[40:43], s52 offen offset:3072 sc1
    buffer_load_dwordx4 v[32:35], v3, s[40:43], s53 offen offset:0 sc1
    buffer_load_dwordx4 v[36:39], v3, s[40:43], s53 offen offset:1024 sc1
    buffer_load_dwordx4 v[40:43], v3, s[40:43], s53 offen offset:2048 sc1
    buffer_load_dwordx4 v[44:47], v3, s[40:43], s53 offen offset:3072 sc1
    buffer_load_dwordx4 v[48:51], v3, s[40:43], s54 offen offset:0 sc1
    buffer_load_dwordx4 v[52:55], v3, s[40:43], s54 offen offset:1024 sc1
    s_waitcnt vmcnt(12)
    v_add_f32 v60, v60, v61
    v_cvt_pk_bf16_f32 v60, v60, v60
    v_lshlrev_b32 v60, 16, v60
    s_movk_i32 s60, 4000
    s_branch FN_PP_W
FN_PP:
    buffer_load_dword v13, v11, s[40:43], s47 offen sc1
    buffer_load_short_d16_hi v62, v9, s[40:43], s49 offen sc1
    buffer_load_dwordx4 v[16:19], v3, s[40:43], s52 offen offset:0 sc1
    buffer_load_dwordx4 v[20:23], v3, s[40:43], s52 offen offset:1024 sc1
    buffer_load_dwordx4 v[24:27], v3, s[40:43], s52 offen offset:2048 sc1
    buffer_load_dwordx4 v[28:31], v3, s[40:43], s52 offen offset:3072 sc1
    buffer_load_dwordx4 v[32:35], v3, s[40:43], s53 offen offset:0 sc1
    buffer_load_dwordx4 v[36:39], v3, s[40:43], s53 offen offset:1024 sc1
    buffer_load_dwordx4 v[40:43], v3, s[40:43], s53 offen offset:2048 sc1
    buffer_load_dwordx4 v[44:47], v3, s[40:43], s53 offen offset:3072 sc1
    buffer_load_dwordx4 v[48:51], v3, s[40:43], s54 offen offset:0 sc1
    buffer_load_dwordx4 v[52:55], v3, s[40:43], s54 offen offset:1024 sc1
FN_PP_W:
    s_waitcnt vmcnt(0)
FN_PP_C:
    v_cmp_ne_u32 s[56:57], s39, v13
    v_pk_add_f32 v[64:65], v[16:17], v[20:21]
    v_pk_add_f32 v[68:69], v[24:25], v[28:29]
    v_pk_add_f32 v[66:67], v[18:19], v[22:23]
    v_pk_add_f32 v[70:71], v[26:27], v[30:31]
    v_pk_add_f32 v[64:65], v[64:65], v[32:33]
    v_pk_add_f32 v[66:67], v[66:67], v[34:35]
    v_pk_add_f32 v[68:69], v[68:69], v[36:37]
    v_pk_add_f32 v[70:71], v[70:71], v[38:39]
    v_pk_add_f32 v[64:65], v[64:65], v[40:41]
    v_pk_add_f32 v[66:67], v[66:67], v[42:43]
    v_pk_add_f32 v[68:69], v[68:69], v[44:45]
    v_pk_add_f32 v[70:71], v[70:71], v[46:47]
    v_pk_add_f32 v[64:65], v[64:65], v[48:49]
    v_pk_add_f32 v[66:67], v[66:67], v[50:51]
    v_pk_add_f32 v[68:69], v[68:69], v[52:53]
    v_pk_add_f32 v[70:71], v[70:71], v[54:55]
    v_pk_add_f32 v[64:65], v[64:65], v[68:69]
    v_pk_add_f32 v[66:67], v[66:67], v[70:71]
    v_pk_add_f32 v[68:69], v[64:65], v[66:67]
    v_cmp_u_f32 vcc, v68, v69
    s_nop 0
    s_or_b64 vcc, vcc, s[56:57]
    s_and_b64 exec, exec, vcc
    s_cbranch_execz FN_PP_D
    s_sub_u32 s60, s60, 1
    s_cmp_gt_i32 s60, 0
    s_cbranch_scc1 FN_PP
FN_PP_D:
    s_mov_b64 exec, -1
    v_permlane32_swap_b32 v64, v66
    v_permlane32_swap_b32 v65, v67
    v_add_f32 v64, v64, v66
    v_add_f32 v65, v65, v67
    s_nop 1
    v_permlane16_swap_b32 v64, v65
    v_add_f32 v64, v64, v65
    s_nop 1
    v_add_f32_dpp v64, v64, v64 row_ror:8 row_mask:0xf bank_mask:0xf
    v_cvt_pk_bf16_f32 v64, v64, v64
    v_lshlrev_b32 v64, 16, v64
    v_mul_f32 v64, v64, v7
    v_cvt_pk_bf16_f32 v64, v64, v64
    v_lshlrev_b32 v64, 16, v64
    v_add_f32 v64, v64, v62
    v_cvt_pk_bf16_f32 v64, v64, v64
    v_lshlrev_b32 v64, 16, v64
    v_add_f32 v64, v64, v60
    v_cvt_pk_bf16_f32 v64, v64, v64
    s_mov_b32 exec_lo, 0xff00ff
    s_mov_b32 exec_hi, 0xff00ff
    global_store_short v12, v64, s[32:33]
    s_mov_b64 exec, -1
END:
    s_endpgm
CODE_END:
.section .rodata,"a"
.p2align 6
.amdhsa_kernel sequential_preLN__ssm_conv_s4__moe_arch_mod__prompt_kernel
  .amdhsa_next_free_vgpr 168
  .amdhsa_next_free_sgpr 102
  .amdhsa_accum_offset 168
  .amdhsa_group_segment_fixed_size 0
  .amdhsa_kernarg_size 136
  .amdhsa_user_sgpr_count 2
  .amdhsa_user_sgpr_kernarg_segment_ptr 1
  .amdhsa_system_sgpr_workgroup_id_x 1
.end_amdhsa_kernel
```

```asm
; @launch grid=(256,1,1) block=(768,1,1) lds=163840
.amdgcn_target "amdgcn-amd-amdhsa--gfx950"
    .text
    .globl sequential_preLN__ssm_conv_s4__moe_arch_mod__prompt_kernel
    .p2align 8
    .type sequential_preLN__ssm_conv_s4__moe_arch_mod__prompt_kernel,@function
sequential_preLN__ssm_conv_s4__moe_arch_mod__prompt_kernel:
    s_cmp_ge_u32 s2, 256
    s_cbranch_scc1 END
    s_load_dwordx16 s[4:19], s[0:1], 0
    s_load_dwordx2 s[36:37], s[0:1], 128
    s_load_dwordx16 s[20:35], s[0:1], 64
    s_getpc_b64 s[70:71]
    s_lshr_b32 s3, s2, 3
    s_mul_i32 s3, s3, 7
    v_subrev_u32 v2, 320, v0
    v_cmp_gt_u32 vcc, 7, v2
    v_add_lshl_u32 v2, v2, s3, 7
    v_min_u32 v2, CODE_END-sequential_preLN__ssm_conv_s4__moe_arch_mod__prompt_kernel-64, v2
    v_mov_b32 v3, s71
    s_mov_b64 exec, vcc
    v_add_co_u32 v2, vcc, s70, v2
    s_nop 1
    v_addc_co_u32 v3, vcc, 0, v3, vcc
    s_cbranch_execz P_NC
    global_load_dword v159, v[2:3], off
P_NC:
    s_mov_b64 exec, -1
    v_lshrrev_b32 v2, 6, v0
    v_and_b32 v1, 63, v0
    v_readfirstlane_b32 s38, v2
    v_lshlrev_b32 v3, 4, v1
    s_mov_b32 s42, 0x10000000
    s_mov_b32 s43, 0x00020000
    s_cmp_lt_u32 s2, 192
    s_cselect_b32 s3, 4, -1
    s_cmp_lg_u32 s38, s3
    s_cbranch_scc1 P_NP
    s_mul_i32 s52, s2, 768
    v_add_u32 v16, s52, v3
    s_mul_i32 s52, s2, 6
    s_and_b32 s52, s52, -4
    v_lshl_add_u32 v17, v1, 2, s52
    v_mov_b32 v18, 161536
    v_mov_b32 v19, 0
    ds_write_b32 v18, v19
    v_mov_b32 v20, s70
    v_mov_b32 v21, s71
    s_waitcnt lgkmcnt(0)
    s_mov_b32 exec_lo, 0xffffffff
    s_mov_b32 exec_hi, 0xffff
    s_mov_b32 m0, 138048
    s_nop 0
    global_load_lds_dwordx4 v16, s[6:7]
    s_mov_b32 m0, 138816
    s_nop 0
    global_load_lds_dwordx4 v16, s[8:9]
    s_mov_b32 m0, 139584
    s_nop 0
    global_load_lds_dwordx4 v16, s[10:11]
    s_mov_b32 m0, 140352
    s_nop 0
    global_load_lds_dwordx4 v16, s[12:13]
    s_mov_b32 m0, 141120
    s_nop 0
    global_load_lds_dwordx4 v16, s[14:15]
    s_mov_b32 m0, 141888
    s_nop 0
    global_load_lds_dwordx4 v16, s[16:17]
    s_mov_b64 exec, 0x3
    s_mov_b32 m0, 142656
    s_nop 0
    global_load_lds_dword v17, s[18:19]
    s_mov_b32 m0, 142672
    s_nop 0
    global_load_lds_dword v17, s[20:21]
    s_mov_b64 exec, 0x1
    s_mov_b32 m0, 161536
    s_nop 0
    global_load_lds_dword v[20:21], off
    s_mov_b64 exec, -1
P_NP:
    s_cmp_ge_u32 s38, 4
    s_cbranch_scc1 P_B
    s_setprio 3
    v_lshrrev_b32 v147, 5, v0
    v_and_b32 v148, 31, v0
    v_mul_u32_u24 v140, 0x480, v147
    s_mul_i32 s44, s2, 9216
    v_mad_u32_u24 v140, v148, 12, v140
    v_mov_b32 v104, 0
    v_mov_b32 v105, 0
    v_mov_b32 v106, 0
    v_mov_b32 v107, 0
    v_add_u32 v140, s44, v140
    v_add_u32 v149, 161280, v3
    s_mov_b64 exec, 0xffff
    ds_write_b128 v149, v[104:107]
    s_mov_b64 exec, -1
    v_mov_b32 v94, 1
    v_and_b32 v147, 1, v147
    v_mul_u32_u24 v141, 0x90, v148
    v_lshl_add_u32 v141, v147, 6, v141
    s_lshl_b32 s45, s38, 4
    s_sub_u32 s45, 147504, s45
    v_add_u32 v141, s45, v141
    v_lshrrev_b32 v142, 3, v1
    v_add_u32 v142, v142, v1
    s_mul_i32 s45, s38, 3456
    s_add_u32 s45, s45, 147456
    v_lshl_add_u32 v142, v142, 4, s45
    v_lshrrev_b32 v143, 2, v1
    v_mul_u32_u24 v143, 16320, v143
    v_add_u32 v143, v143, v3
    s_lshl_b32 s46, s2, 6
    s_sub_u32 s46, 2637760, s46
    s_mul_i32 s45, s38, 786432
    s_add_u32 s46, s46, s45
    s_add_u32 s47, s46, 262144
    s_add_u32 s48, s46, 524288
    s_mov_b32 s49, 0x05040100
    s_mov_b32 s50, 0x07060302
    v_mov_b32 v144, s49
    s_mov_b32 exec_lo, 0
    v_mov_b32 v144, s50
    s_mov_b64 exec, -1
    v_mov_b32 v145, 161328
    s_lshl_b32 s45, s38, 2
    v_add_u32 v146, s45, v145
    s_waitcnt lgkmcnt(0)
    global_load_dword v95, v104, s[36:37] offset:0
    global_load_dwordx3 v[60:62], v140, s[4:5] offset:0
    global_load_dwordx3 v[64:66], v140, s[4:5] offset:384
    global_load_dwordx3 v[68:70], v140, s[4:5] offset:768
    s_mov_b32 s40, s36
    s_mov_b32 s41, s37
    s_cmp_ge_u32 s2, 192
    s_cbranch_scc1 P_C
    s_lshr_b32 s65, s38, 2
    s_bitcmp1_b32 s2, 0
    s_addc_u32 s51, s65, 0
    s_cmp_eq_u32 s51, 3
    s_cselect_b32 s51, 0, s51
    s_lshl_b32 s52, s51, 8
    s_add_u32 s52, s52, 138048
    v_and_b32 v114, 0x7f, v0
    v_lshl_add_u32 v114, v114, 1, s52
    s_and_b32 s52, s2, 1
    s_add_u32 s52, s52, s51
    s_lshl_b32 s52, s52, 1
    s_add_u32 s52, s52, 142656
    v_mov_b32 v115, s52
    v_mov_b32 v119, 161536
    v_mov_b32 v29, 0
    v_mov_b32 v30, 0
    v_mov_b32 v31, 0
    v_mov_b32 v32, 0
    v_mov_b32 v33, 0
    v_mov_b32 v34, 0
    v_mov_b32 v35, 0
    v_mov_b32 v160, 0
    v_mov_b32 v161, 0
    v_mov_b32 v162, 0
    v_mov_b32 v163, 0
    v_mov_b32 v164, 0
    v_lshlrev_b32 v16, 4, v0
    v_add_u32 v17, 101184, v16
    ds_write_b128 v17, v[160:163] offset:0
    ds_write_b128 v17, v[160:163] offset:12288
    ds_write_b128 v17, v[160:163] offset:24576
    s_mul_i32 s59, s65, 16320
    s_mul_i32 s67, s65, 17408
    s_add_u32 s71, s67, 48960
    s_and_b32 s66, s38, 1
    s_lshl_b32 s66, s66, 8
    s_add_u32 s70, s66, s67
    s_add_u32 s70, s70, 16192
    s_add_u32 s66, s66, s59
    s_mov_b32 m0, s66
    s_mul_i32 s64, s65, 5888
    s_add_u32 s64, s64, 101184
    s_and_b32 s69, s38, 3
    v_and_b32 v5, 15, v0
    v_bfe_u32 v6, v0, 4, 2
    v_and_b32 v17, 48, v0
    v_mul_u32_u24 v110, 544, v5
    s_mov_b32 s52, 0
    s_movk_i32 s53, 2176
    s_movk_i32 s54, 4896
    s_cmp_eq_u32 s69, 1
    s_cselect_b32 s52, 9792, s52
    s_cselect_b32 s53, 1088, s53
    s_cselect_b32 s54, 3264, s54
    s_cmp_eq_u32 s69, 3
    s_cselect_b32 s52, 544, s52
    s_add_u32 s52, s52, s59
    s_cmp_eq_u32 s69, 2
    s_cselect_b32 s52, s71, s52
    s_cselect_b32 s54, 4352, s54
    s_add_u32 s67, s71, 8704
    v_and_b32 v111, 3, v0
    v_mul_u32_u24 v111, 544, v111
    v_bfe_u32 v18, v0, 2, 1
    v_bfe_u32 v19, v0, 3, 1
    v_xor_b32 v18, v18, v19
    v_mad_u32_u24 v111, v19, s53, v111
    v_mad_u32_u24 v111, v18, s54, v111
    v_add3_u32 v111, v111, v17, s52
    v_add3_u32 v110, v110, v17, s67
    s_barrier
    v_lshl_add_u32 v18, v5, 1, v6
    s_sub_u32 s52, s69, 11
    v_add_u32 v18, s52, v18
    v_add_u32 v19, 1, v18
    v_lshl_add_u32 v20, v6, 1, 2
    v_cmp_le_u32 s[52:53], v18, v20
    v_cmp_le_u32 s[54:55], v19, v20
    v_mov_b32 v18, 0x3f80
    v_cndmask_b32 v112, 0, v18, s[52:53]
    v_cndmask_b32 v19, 0, 1.0, s[54:55]
    v_or_b32 v112, v112, v19
    s_mul_i32 s52, s38, 1600
    s_add_u32 s52, s52, 120016
    v_lshl_add_u32 v113, v1, 2, s52
    s_mul_i32 s67, s65, 6400
    s_add_u32 s67, s67, 118848
    s_sub_u32 s63, s69, s65
    s_cselect_b32 s52, 3, 0
    s_add_u32 s63, s63, s52
    s_min_u32 s52, s63, 1
    s_add_u32 s63, s63, s52
    s_cmp_eq_u32 s69, 3
    s_cselect_b32 s63, 1, s63
    v_add_u32 v7, 1, v5
    v_and_b32 v8, 3, v7
    v_mul_u32_u24 v8, 1598, v8
    v_lshl_add_u32 v7, v7, 1, v8
    v_add3_u32 v7, v7, v17, s67
    v_add_u32 v18, s64, v17
    v_lshl_add_u32 v9, v5, 3, v18
    v_and_b32 v10, 1, v5
    v_mul_u32_u24 v10, 380, v10
    v_lshl_add_u32 v10, v5, 2, v10
    v_add_u32 v10, v18, v10
    v_lshlrev_b32 v8, 5, v5
    v_sub_u32 v8, v18, v8
    v_lshrrev_b32 v11, 2, v5
    v_lshl_add_u32 v2, v5, 2, v6
    v_add_u32 v15, v2, v11
    v_lshl_add_u32 v4, v15, 3, s59
    s_lshl_b32 s52, s65, 4
    s_add_u32 s52, s52, 161280
    v_mov_b32 v166, s52
    s_branch P_D
P_C:
    v_mov_b32 v8, 0
    v_mov_b32 v10, 0
    v_mov_b32 v166, 0
    v_mov_b32 v9, 0
    s_barrier
P_D:
    v_mov_b32 v117, 0
    v_mov_b32 v118, 0
    v_mov_b32 v116, 0
    s_waitcnt vmcnt(0)
LN1:
    v_dot2c_f32_bf16 v104, 0x3f803f80, v60
    v_dot2c_f32_bf16 v106, v60, v60
    v_dot2c_f32_bf16 v105, 0x3f803f80, v61
    v_dot2c_f32_bf16 v107, v61, v61
    v_dot2c_f32_bf16 v104, 0x3f803f80, v62
    v_dot2c_f32_bf16 v106, v62, v62
    v_dot2c_f32_bf16 v105, 0x3f803f80, v64
    v_dot2c_f32_bf16 v107, v64, v64
    v_dot2c_f32_bf16 v104, 0x3f803f80, v65
    v_dot2c_f32_bf16 v106, v65, v65
    v_dot2c_f32_bf16 v105, 0x3f803f80, v66
    v_dot2c_f32_bf16 v107, v66, v66
    v_dot2c_f32_bf16 v104, 0x3f803f80, v68
    v_dot2c_f32_bf16 v106, v68, v68
    v_dot2c_f32_bf16 v105, 0x3f803f80, v69
    v_dot2c_f32_bf16 v107, v69, v69
    v_dot2c_f32_bf16 v104, 0x3f803f80, v70
    v_dot2c_f32_bf16 v106, v70, v70
    v_add_u32 v95, 1, v95
    s_mov_b64 exec, 0x7
    ds_write_b64 v149, v[94:95] offset:136
    s_mov_b64 exec, -1
    v_add_f32 v104, v104, v105
    v_add_f32 v106, v106, v107
    v_lshlrev_b32 v72, 16, v60
    v_and_b32 v73, 0xffff0000, v60
    v_permlane16_swap_b32 v104, v106
    v_add_f32 v104, v104, v106
    v_lshlrev_b32 v74, 16, v61
    v_and_b32 v75, 0xffff0000, v61
    v_add_f32_dpp v104, v104, v104 quad_perm:[1,0,3,2] row_mask:0xf bank_mask:0xf
    v_lshlrev_b32 v76, 16, v62
    v_and_b32 v77, 0xffff0000, v62
    v_add_f32_dpp v104, v104, v104 quad_perm:[2,3,0,1] row_mask:0xf bank_mask:0xf
    v_lshlrev_b32 v78, 16, v64
    v_and_b32 v79, 0xffff0000, v64
    v_add_f32_dpp v104, v104, v104 row_half_mirror row_mask:0xf bank_mask:0xf
    v_lshlrev_b32 v80, 16, v65
    v_and_b32 v81, 0xffff0000, v65
    v_add_f32_dpp v104, v104, v104 row_mirror row_mask:0xf bank_mask:0xf
    v_mul_f32 v104, 0x3ae38e39, v104
    v_mov_b32 v105, v104
    v_lshlrev_b32 v82, 16, v66
    v_and_b32 v83, 0xffff0000, v66
    v_permlane16_swap_b32 v104, v105
    v_fma_f32 v105, -v104, v104, v105
    v_max_f32 v105, 0, v105
    v_cvt_pk_bf16_f32 v105, v104, v105
    v_lshlrev_b32 v104, 16, v105
    v_and_b32 v105, 0xffff0000, v105
    v_lshlrev_b32 v84, 16, v68
    v_and_b32 v85, 0xffff0000, v68
    v_lshlrev_b32 v86, 16, v69
    v_and_b32 v87, 0xffff0000, v69
    v_lshlrev_b32 v88, 16, v70
    v_and_b32 v89, 0xffff0000, v70
    v_readfirstlane_b32 s39, v95
    v_xor_b32 v99, 0x80000000, v95
    v_xor_b32 v103, 0x80000000, v95
    v_xor_b32 v95, 0x80000000, v95
    v_add_f32 v105, 0x3727c5ac, v105
    v_cvt_pk_bf16_f32 v105, v105, v105
    v_lshlrev_b32 v105, 16, v105
    v_sqrt_f32 v106, v105
    v_pk_add_f32 v[72:73], v[72:73], v[104:105] op_sel_hi:[1,0] neg_lo:[0,1] neg_hi:[0,1]
    v_pk_add_f32 v[74:75], v[74:75], v[104:105] op_sel_hi:[1,0] neg_lo:[0,1] neg_hi:[0,1]
    v_pk_add_f32 v[76:77], v[76:77], v[104:105] op_sel_hi:[1,0] neg_lo:[0,1] neg_hi:[0,1]
    v_cvt_pk_bf16_f32 v106, v106, v106
    v_lshlrev_b32 v106, 16, v106
    v_rcp_f32 v106, v106
    v_pk_add_f32 v[78:79], v[78:79], v[104:105] op_sel_hi:[1,0] neg_lo:[0,1] neg_hi:[0,1]
    v_pk_add_f32 v[80:81], v[80:81], v[104:105] op_sel_hi:[1,0] neg_lo:[0,1] neg_hi:[0,1]
    v_pk_add_f32 v[82:83], v[82:83], v[104:105] op_sel_hi:[1,0] neg_lo:[0,1] neg_hi:[0,1]
    v_pk_add_f32 v[84:85], v[84:85], v[104:105] op_sel_hi:[1,0] neg_lo:[0,1] neg_hi:[0,1]
    v_pk_add_f32 v[86:87], v[86:87], v[104:105] op_sel_hi:[1,0] neg_lo:[0,1] neg_hi:[0,1]
    v_pk_add_f32 v[88:89], v[88:89], v[104:105] op_sel_hi:[1,0] neg_lo:[0,1] neg_hi:[0,1]
    v_cvt_pk_bf16_f32 v73, v72, v73
    v_cvt_pk_bf16_f32 v75, v74, v75
    v_cvt_pk_bf16_f32 v77, v76, v77
    v_cvt_pk_bf16_f32 v79, v78, v79
    v_cvt_pk_bf16_f32 v81, v80, v81
    v_cvt_pk_bf16_f32 v83, v82, v83
    v_cvt_pk_bf16_f32 v85, v84, v85
    v_cvt_pk_bf16_f32 v87, v86, v87
    v_cvt_pk_bf16_f32 v89, v88, v89
    v_lshlrev_b32 v72, 16, v73
    v_and_b32 v73, 0xffff0000, v73
    v_lshlrev_b32 v74, 16, v75
    v_and_b32 v75, 0xffff0000, v75
    v_lshlrev_b32 v76, 16, v77
    v_and_b32 v77, 0xffff0000, v77
    v_pk_mul_f32 v[72:73], v[72:73], v[106:107] op_sel_hi:[1,0]
    v_pk_mul_f32 v[74:75], v[74:75], v[106:107] op_sel_hi:[1,0]
    v_pk_mul_f32 v[76:77], v[76:77], v[106:107] op_sel_hi:[1,0]
    v_cvt_pk_bf16_f32 v60, v72, v73
    v_cvt_pk_bf16_f32 v62, v76, v77
    v_cvt_pk_bf16_f32 v61, v74, v75
    v_cvt_pk_bf16_f32 v63, v74, v75
    v_permlane32_swap_b32 v60, v62
    s_nop 0
    v_permlane32_swap_b32 v61, v63
    v_perm_b32 v92, v60, v62, s49
    v_perm_b32 v93, v60, v62, s50
    v_lshlrev_b32 v78, 16, v79
    v_and_b32 v79, 0xffff0000, v79
    v_lshlrev_b32 v80, 16, v81
    v_and_b32 v81, 0xffff0000, v81
    v_lshlrev_b32 v82, 16, v83
    v_and_b32 v83, 0xffff0000, v83
    v_pk_mul_f32 v[78:79], v[78:79], v[106:107] op_sel_hi:[1,0]
    v_pk_mul_f32 v[80:81], v[80:81], v[106:107] op_sel_hi:[1,0]
    v_pk_mul_f32 v[82:83], v[82:83], v[106:107] op_sel_hi:[1,0]
    v_cvt_pk_bf16_f32 v64, v78, v79
    v_cvt_pk_bf16_f32 v66, v82, v83
    v_cvt_pk_bf16_f32 v65, v80, v81
    v_cvt_pk_bf16_f32 v67, v80, v81
    v_perm_b32 v94, v61, v63, v144
    ds_write_b128 v141, v[92:95] offset:0
    v_permlane32_swap_b32 v64, v66
    v_permlane32_swap_b32 v65, v67
    v_perm_b32 v96, v64, v66, s49
    v_perm_b32 v97, v64, v66, s50
    v_lshlrev_b32 v84, 16, v85
    v_and_b32 v85, 0xffff0000, v85
    v_lshlrev_b32 v86, 16, v87
    v_and_b32 v87, 0xffff0000, v87
    v_lshlrev_b32 v88, 16, v89
    v_and_b32 v89, 0xffff0000, v89
    v_pk_mul_f32 v[84:85], v[84:85], v[106:107] op_sel_hi:[1,0]
    v_pk_mul_f32 v[86:87], v[86:87], v[106:107] op_sel_hi:[1,0]
    v_pk_mul_f32 v[88:89], v[88:89], v[106:107] op_sel_hi:[1,0]
    v_cvt_pk_bf16_f32 v68, v84, v85
    v_cvt_pk_bf16_f32 v70, v88, v89
    v_cvt_pk_bf16_f32 v69, v86, v87
    v_cvt_pk_bf16_f32 v71, v86, v87
    v_perm_b32 v98, v65, v67, v144
    ds_write_b128 v141, v[96:99] offset:4608
    v_permlane32_swap_b32 v68, v70
    v_permlane32_swap_b32 v69, v71
    v_perm_b32 v100, v68, v70, s49
    v_perm_b32 v101, v68, v70, s50
    v_perm_b32 v102, v69, v71, v144
    ds_write_b128 v141, v[100:103] offset:9216
    s_mov_b64 exec, 0x1
    ds_write_b32 v146, v144
    s_mov_b64 exec, -1
LN1_U:
    s_movk_i32 s60, 4000
LN1_R:
    ds_read_b128 v[104:107], v145
    ds_read_b128 v[72:75], v142 offset:0
    ds_read_b128 v[76:79], v142 offset:1152
    ds_read_b128 v[80:83], v142 offset:2304
    s_sub_u32 s60, s60, 1
    s_waitcnt lgkmcnt(3)
    v_min3_u32 v104, v104, v105, v106
    v_min_u32 v104, v104, v107
    v_cmp_eq_u32 vcc, 0, v104
    s_cmp_gt_i32 s60, 0
    s_cselect_b64 s[52:53], vcc, 0
    s_cmp_lg_u64 s[52:53], 0
    s_waitcnt lgkmcnt(0)
    s_cbranch_scc1 LN1_R
    buffer_store_dwordx4 v[72:75], v143, s[40:43], s46 offen sc1
    buffer_store_dwordx4 v[76:79], v143, s[40:43], s47 offen sc1
    buffer_store_dwordx4 v[80:83], v143, s[40:43], s48 offen sc1
    s_cmp_ge_u32 s2, 192
    s_cbranch_scc1 FFN_DMA
    s_branch C_KS
P_B:
    s_cmp_ge_u32 s2, 192
    s_cbranch_scc1 FFN_DMA0
P_B2:
    s_lshr_b32 s65, s38, 2
    s_bitcmp1_b32 s2, 0
    s_addc_u32 s51, s65, 0
    s_cmp_eq_u32 s51, 3
    s_cselect_b32 s51, 0, s51
    s_lshl_b32 s52, s51, 8
    s_add_u32 s52, s52, 138048
    v_and_b32 v114, 0x7f, v0
    v_lshl_add_u32 v114, v114, 1, s52
    s_and_b32 s52, s2, 1
    s_add_u32 s52, s52, s51
    s_lshl_b32 s52, s52, 1
    s_add_u32 s52, s52, 142656
    v_mov_b32 v115, s52
    v_mov_b32 v119, 161536
    v_mov_b32 v29, 0
    v_mov_b32 v30, 0
    v_mov_b32 v31, 0
    v_mov_b32 v32, 0
    v_mov_b32 v33, 0
    v_mov_b32 v34, 0
    v_mov_b32 v35, 0
    v_mov_b32 v160, 0
    v_mov_b32 v161, 0
    v_mov_b32 v162, 0
    v_mov_b32 v163, 0
    v_mov_b32 v164, 0
    v_lshlrev_b32 v16, 4, v0
    v_add_u32 v17, 101184, v16
    ds_write_b128 v17, v[160:163] offset:0
    ds_write_b128 v17, v[160:163] offset:12288
    ds_write_b128 v17, v[160:163] offset:24576
    s_mul_i32 s59, s65, 16320
    s_mul_i32 s67, s65, 17408
    s_add_u32 s71, s67, 48960
    s_and_b32 s66, s38, 1
    s_lshl_b32 s66, s66, 8
    s_add_u32 s70, s66, s67
    s_add_u32 s70, s70, 16192
    s_add_u32 s66, s66, s59
    s_mov_b32 m0, s66
    s_mul_i32 s64, s65, 5888
    s_add_u32 s64, s64, 101184
    s_and_b32 s69, s38, 3
    v_and_b32 v5, 15, v0
    v_bfe_u32 v6, v0, 4, 2
    v_and_b32 v17, 48, v0
    v_mul_u32_u24 v110, 544, v5
    s_mov_b32 s52, 0
    s_movk_i32 s53, 2176
    s_movk_i32 s54, 4896
    s_cmp_eq_u32 s69, 1
    s_cselect_b32 s52, 9792, s52
    s_cselect_b32 s53, 1088, s53
    s_cselect_b32 s54, 3264, s54
    s_cmp_eq_u32 s69, 3
    s_cselect_b32 s52, 544, s52
    s_add_u32 s52, s52, s59
    s_cmp_eq_u32 s69, 2
    s_cselect_b32 s52, s71, s52
    s_cselect_b32 s54, 4352, s54
    s_add_u32 s67, s71, 8704
    v_and_b32 v111, 3, v0
    v_mul_u32_u24 v111, 544, v111
    v_bfe_u32 v18, v0, 2, 1
    v_bfe_u32 v19, v0, 3, 1
    v_xor_b32 v18, v18, v19
    v_mad_u32_u24 v111, v19, s53, v111
    v_mad_u32_u24 v111, v18, s54, v111
    v_add3_u32 v111, v111, v17, s52
    v_add3_u32 v110, v110, v17, s67
    s_barrier
    v_lshl_add_u32 v18, v5, 1, v6
    s_sub_u32 s52, s69, 11
    v_add_u32 v18, s52, v18
    v_add_u32 v19, 1, v18
    v_lshl_add_u32 v20, v6, 1, 2
    v_cmp_le_u32 s[52:53], v18, v20
    v_cmp_le_u32 s[54:55], v19, v20
    v_mov_b32 v18, 0x3f80
    v_cndmask_b32 v112, 0, v18, s[52:53]
    v_cndmask_b32 v19, 0, 1.0, s[54:55]
    v_or_b32 v112, v112, v19
    s_mul_i32 s52, s38, 1600
    s_add_u32 s52, s52, 120016
    v_lshl_add_u32 v113, v1, 2, s52
    s_mul_i32 s67, s65, 6400
    s_add_u32 s67, s67, 118848
    s_sub_u32 s63, s69, s65
    s_cselect_b32 s52, 3, 0
    s_add_u32 s63, s63, s52
    s_min_u32 s52, s63, 1
    s_add_u32 s63, s63, s52
    s_cmp_eq_u32 s69, 3
    s_cselect_b32 s63, 1, s63
    v_add_u32 v7, 1, v5
    v_and_b32 v8, 3, v7
    v_mul_u32_u24 v8, 1598, v8
    v_lshl_add_u32 v7, v7, 1, v8
    v_add3_u32 v7, v7, v17, s67
    v_add_u32 v18, s64, v17
    v_lshl_add_u32 v9, v5, 3, v18
    v_and_b32 v10, 1, v5
    v_mul_u32_u24 v10, 380, v10
    v_lshl_add_u32 v10, v5, 2, v10
    v_add_u32 v10, v18, v10
    v_lshlrev_b32 v8, 5, v5
    v_sub_u32 v8, v18, v8
    v_lshrrev_b32 v11, 2, v5
    v_lshl_add_u32 v2, v5, 2, v6
    v_add_u32 v15, v2, v11
    v_lshl_add_u32 v4, v15, 3, s59
    s_lshl_b32 s52, s65, 4
    s_add_u32 s52, s52, 161280
    v_mov_b32 v166, s52
    s_lshl_b32 s48, s2, 13
    s_add_u32 s48, s48, 258048
    s_mov_b32 s50, s2
    s_lshl_b32 s49, s2, 11
    s_add_u32 s49, s49, 1440768
    s_waitcnt lgkmcnt(0)
    s_mov_b32 s40, s36
    s_mov_b32 s41, s37
    s_bitcmp1_b32 s38, 0
    s_cselect_b32 s0, s26, s28
    s_cselect_b32 s1, s27, s29
    s_lshr_b32 s52, s2, 3
    s_mul_i32 s52, s52, 1728
    s_and_b32 s53, s2, 7
    s_lshl3_add_u32 s52, s53, s52
    s_add_u32 s52, s52, 3
    v_mul_u32_u24 v117, 0x48, v1
    v_add_lshl_u32 v117, v117, s52, 7
    s_lshr_b32 s52, s2, 3
    s_mul_i32 s52, s52, 3
    s_add_u32 s52, s52, s69
    s_lshl_b32 s52, s52, 3
    s_and_b32 s53, s2, 7
    s_lshl_b32 s53, s53, 3
    v_lshrrev_b32 v21, 3, v1
    v_add_u32 v21, s53, v21
    v_mul_u32_u24 v21, 0x240, v21
    v_and_b32 v22, 7, v1
    v_add3_u32 v21, v21, v22, s52
    v_lshlrev_b32 v118, 7, v21
C_KS:
    s_movk_i32 s60, 4000
C_KP:
    ds_read_b32 v20, v119
    s_sub_u32 s60, s60, 1
    s_cmp_gt_i32 s60, 0
    s_waitcnt lgkmcnt(0)
    v_readfirstlane_b32 s52, v20
    s_nop 0
    s_cselect_b32 s52, s52, 1
    s_cmp_eq_u32 s52, 0
    s_cbranch_scc1 C_KP
    ds_read_u16_d16_hi v29, v115
    ds_read_u16_d16_hi v30, v114 offset:0
    ds_read_u16_d16_hi v31, v114 offset:768
    ds_read_u16_d16_hi v32, v114 offset:1536
    ds_read_u16_d16_hi v33, v114 offset:2304
    ds_read_u16_d16_hi v34, v114 offset:3072
    ds_read_u16_d16_hi v35, v114 offset:3840
    ds_read_u16_d16_hi v164, v115 offset:16
    s_cmp_lt_u32 s38, 10
    s_cbranch_scc1 C_NPB
    s_mov_b32 s52, m0
    s_mov_b32 m0, 163328
    s_mov_b64 exec, 0xffffff
    global_load_lds_dword v117, s[0:1]
    s_mov_b64 exec, -1
    s_mov_b32 m0, s52
C_NPB:
    s_setprio 2
    s_cmp_lt_u32 s38, 4
    s_cbranch_scc1 PG1
    s_setprio 3
PG1:
    s_waitcnt lgkmcnt(0)
    v_mul_f32 v20, 0x3fb8aa3b, v29
    v_mov_b32 v21, 0x3fb8aa3b
    v_fma_f32 v21, v29, v21, -v20
    v_fmac_f32 v21, 0x32a57060, v29
    v_exp_f32 v20, v20
    v_mul_f32 v21, 0x3f317218, v21
    v_fma_f32 v20, v20, v21, v20
    v_cvt_pk_bf16_f32 v20, v20, v20
    v_lshlrev_b32 v20, 16, v20
    v_mul_f32 v21, v30, v20
    v_mul_f32 v36, v31, v20
    v_mul_f32 v32, v32, v20
    v_mul_f32 v33, v33, v20
    v_mul_f32 v21, 0x3fb8aa3b, v21
    v_mul_f32 v22, 0x3e22f983, v36
    v_mov_b32 v23, 0x3e22f983
    v_fma_f32 v23, v36, v23, -v22
    v_fmac_f32 v23, 0x31dc9c88, v36
    v_pk_mul_f32 v[24:25], v[34:35], v[32:33] op_sel:[0,0] op_sel_hi:[0,1]
    v_pk_fma_f32 v[24:25], v[34:35], v[32:33], v[24:25] op_sel:[1,1,0] op_sel_hi:[1,0,1] neg_lo:[1,0,0]
    s_bitcmp1_b32 s38, 1
    s_cbranch_scc1 C_ROLE1
    v_mul_f32 v36, 0x43000000, v21
    v_mul_f32 v37, 0x43000000, v22
    v_mul_f32 v38, 0x41000000, v21
    v_mul_f32 v39, 0x41000000, v22
    v_exp_f32 v36, v36
    v_fract_f32 v37, v37
    v_exp_f32 v38, v38
    v_fract_f32 v39, v39
    v_fmac_f32 v37, 0x43000000, v23
    v_fmac_f32 v39, 0x41000000, v23
    v_cos_f32 v26, v37
    v_sin_f32 v27, v37
    v_cos_f32 v28, v39
    v_sin_f32 v29, v39
    v_mul_f32 v26, v26, v36
    v_mul_f32 v27, v27, v36
    v_mul_f32 v28, v28, v38
    v_mul_f32 v29, v29, v38
    v_mov_b32 v44, 1.0
    v_mov_b32 v45, 0
    v_pk_mul_f32 v[56:57], v[24:25], v[28:29] op_sel:[0,0] op_sel_hi:[0,1]
    v_pk_mul_f32 v[50:51], v[28:29], v[28:29] op_sel:[0,0] op_sel_hi:[0,1]
    v_pk_fma_f32 v[56:57], v[24:25], v[28:29], v[56:57] op_sel:[1,1,0] op_sel_hi:[1,0,1] neg_lo:[1,0,0]
    v_pk_fma_f32 v[50:51], v[28:29], v[28:29], v[50:51] op_sel:[1,1,0] op_sel_hi:[1,0,1] neg_lo:[1,0,0]
    v_pk_mul_f32 v[58:59], v[56:57], v[26:27] op_sel:[0,0] op_sel_hi:[0,1]
    v_pk_fma_f32 v[58:59], v[56:57], v[26:27], v[58:59] op_sel:[1,1,0] op_sel_hi:[1,0,1] neg_lo:[1,0,0]
    v_cvt_pk_bf16_f32 v40, v56, v57
    ds_write_addtid_b32 v40 offset:4352
    v_pk_mul_f32 v[56:57], v[58:59], v[26:27] op_sel:[0,0] op_sel_hi:[0,1]
    v_pk_mul_f32 v[54:55], v[50:51], v[28:29] op_sel:[0,0] op_sel_hi:[0,1]
    v_pk_fma_f32 v[56:57], v[58:59], v[26:27], v[56:57] op_sel:[1,1,0] op_sel_hi:[1,0,1] neg_lo:[1,0,0]
    v_pk_fma_f32 v[54:55], v[50:51], v[28:29], v[54:55] op_sel:[1,1,0] op_sel_hi:[1,0,1] neg_lo:[1,0,0]
    v_cvt_pk_bf16_f32 v41, v58, v59
    ds_write_addtid_b32 v41 offset:9248
    v_cvt_pk_bf16_f32 v42, v44, -v45
    s_mov_b32 m0, s70
    s_nop 0
    ds_write_addtid_b32 v42 offset:41472
    v_cvt_pk_bf16_f32 v43, v28, -v29
    ds_write_addtid_b32 v43 offset:42016
    v_cvt_pk_bf16_f32 v40, v50, -v51
    ds_write_addtid_b32 v40 offset:42560
    v_pk_mul_f32 v[58:59], v[56:57], v[26:27] op_sel:[0,0] op_sel_hi:[0,1]
    v_pk_mul_f32 v[50:51], v[54:55], v[28:29] op_sel:[0,0] op_sel_hi:[0,1]
    v_pk_fma_f32 v[58:59], v[56:57], v[26:27], v[58:59] op_sel:[1,1,0] op_sel_hi:[1,0,1] neg_lo:[1,0,0]
    v_pk_fma_f32 v[50:51], v[54:55], v[28:29], v[50:51] op_sel:[1,1,0] op_sel_hi:[1,0,1] neg_lo:[1,0,0]
    v_cvt_pk_bf16_f32 v41, v56, v57
    s_mov_b32 m0, s66
    s_nop 0
    ds_write_addtid_b32 v41 offset:11968
    v_cvt_pk_bf16_f32 v42, v54, -v55
    s_mov_b32 m0, s70
    s_nop 0
    ds_write_addtid_b32 v42 offset:43104
    v_pk_mul_f32 v[56:57], v[58:59], v[26:27] op_sel:[0,0] op_sel_hi:[0,1]
    v_pk_mul_f32 v[54:55], v[50:51], v[28:29] op_sel:[0,0] op_sel_hi:[0,1]
    v_pk_fma_f32 v[56:57], v[58:59], v[26:27], v[56:57] op_sel:[1,1,0] op_sel_hi:[1,0,1] neg_lo:[1,0,0]
    v_pk_fma_f32 v[54:55], v[50:51], v[28:29], v[54:55] op_sel:[1,1,0] op_sel_hi:[1,0,1] neg_lo:[1,0,0]
    v_cvt_pk_bf16_f32 v43, v58, v59
    s_mov_b32 m0, s66
    s_nop 0
    ds_write_addtid_b32 v43 offset:15232
    v_cvt_pk_bf16_f32 v40, v50, -v51
    s_mov_b32 m0, s70
    s_nop 0
    ds_write_addtid_b32 v40 offset:43648
    v_pk_mul_f32 v[58:59], v[56:57], v[26:27] op_sel:[0,0] op_sel_hi:[0,1]
    v_pk_mul_f32 v[50:51], v[54:55], v[28:29] op_sel:[0,0] op_sel_hi:[0,1]
    v_pk_fma_f32 v[58:59], v[56:57], v[26:27], v[58:59] op_sel:[1,1,0] op_sel_hi:[1,0,1] neg_lo:[1,0,0]
    v_pk_fma_f32 v[50:51], v[54:55], v[28:29], v[50:51] op_sel:[1,1,0] op_sel_hi:[1,0,1] neg_lo:[1,0,0]
    v_cvt_pk_bf16_f32 v41, v56, v57
    ds_write_addtid_b32 v41 offset:33312
    v_cvt_pk_bf16_f32 v42, v54, -v55
    ds_write_addtid_b32 v42 offset:44192
    v_pk_mul_f32 v[56:57], v[58:59], v[26:27] op_sel:[0,0] op_sel_hi:[0,1]
    v_pk_mul_f32 v[54:55], v[50:51], v[28:29] op_sel:[0,0] op_sel_hi:[0,1]
    v_pk_fma_f32 v[56:57], v[58:59], v[26:27], v[56:57] op_sel:[1,1,0] op_sel_hi:[1,0,1] neg_lo:[1,0,0]
    v_pk_fma_f32 v[54:55], v[50:51], v[28:29], v[54:55] op_sel:[1,1,0] op_sel_hi:[1,0,1] neg_lo:[1,0,0]
    v_cvt_pk_bf16_f32 v43, v58, v59
    ds_write_addtid_b32 v43 offset:34400
    v_cvt_pk_bf16_f32 v40, v50, -v51
    ds_write_addtid_b32 v40 offset:44736
    v_pk_mul_f32 v[58:59], v[56:57], v[26:27] op_sel:[0,0] op_sel_hi:[0,1]
    v_pk_mul_f32 v[50:51], v[54:55], v[28:29] op_sel:[0,0] op_sel_hi:[0,1]
    v_pk_fma_f32 v[58:59], v[56:57], v[26:27], v[58:59] op_sel:[1,1,0] op_sel_hi:[1,0,1] neg_lo:[1,0,0]
    v_pk_fma_f32 v[50:51], v[54:55], v[28:29], v[50:51] op_sel:[1,1,0] op_sel_hi:[1,0,1] neg_lo:[1,0,0]
    v_cvt_pk_bf16_f32 v41, v56, v57
    ds_write_addtid_b32 v41 offset:37664
    v_cvt_pk_bf16_f32 v42, v54, -v55
    ds_write_addtid_b32 v42 offset:45280
    v_pk_mul_f32 v[56:57], v[58:59], v[26:27] op_sel:[0,0] op_sel_hi:[0,1]
    v_pk_mul_f32 v[54:55], v[50:51], v[28:29] op_sel:[0,0] op_sel_hi:[0,1]
    v_pk_fma_f32 v[56:57], v[58:59], v[26:27], v[56:57] op_sel:[1,1,0] op_sel_hi:[1,0,1] neg_lo:[1,0,0]
    v_pk_fma_f32 v[54:55], v[50:51], v[28:29], v[54:55] op_sel:[1,1,0] op_sel_hi:[1,0,1] neg_lo:[1,0,0]
    v_cvt_pk_bf16_f32 v43, v58, v59
    ds_write_addtid_b32 v43 offset:38752
    v_cvt_pk_bf16_f32 v40, v50, -v51
    ds_write_addtid_b32 v40 offset:45824
    v_pk_mul_f32 v[58:59], v[56:57], v[26:27] op_sel:[0,0] op_sel_hi:[0,1]
    v_pk_mul_f32 v[50:51], v[54:55], v[28:29] op_sel:[0,0] op_sel_hi:[0,1]
    v_pk_fma_f32 v[58:59], v[56:57], v[26:27], v[58:59] op_sel:[1,1,0] op_sel_hi:[1,0,1] neg_lo:[1,0,0]
    v_pk_fma_f32 v[50:51], v[54:55], v[28:29], v[50:51] op_sel:[1,1,0] op_sel_hi:[1,0,1] neg_lo:[1,0,0]
    v_cvt_pk_bf16_f32 v41, v56, v57
    ds_write_addtid_b32 v41 offset:39296
    v_cvt_pk_bf16_f32 v42, v54, -v55
    ds_write_addtid_b32 v42 offset:46368
    v_pk_mul_f32 v[56:57], v[58:59], v[26:27] op_sel:[0,0] op_sel_hi:[0,1]
    v_pk_mul_f32 v[54:55], v[50:51], v[28:29] op_sel:[0,0] op_sel_hi:[0,1]
    v_pk_fma_f32 v[56:57], v[58:59], v[26:27], v[56:57] op_sel:[1,1,0] op_sel_hi:[1,0,1] neg_lo:[1,0,0]
    v_pk_fma_f32 v[54:55], v[50:51], v[28:29], v[54:55] op_sel:[1,1,0] op_sel_hi:[1,0,1] neg_lo:[1,0,0]
    v_cvt_pk_bf16_f32 v43, v58, v59
    ds_write_addtid_b32 v43 offset:39840
    v_cvt_pk_bf16_f32 v40, v50, -v51
    ds_write_addtid_b32 v40 offset:46912
    v_pk_mul_f32 v[58:59], v[56:57], v[26:27] op_sel:[0,0] op_sel_hi:[0,1]
    v_pk_mul_f32 v[50:51], v[54:55], v[28:29] op_sel:[0,0] op_sel_hi:[0,1]
    v_pk_fma_f32 v[58:59], v[56:57], v[26:27], v[58:59] op_sel:[1,1,0] op_sel_hi:[1,0,1] neg_lo:[1,0,0]
    v_pk_fma_f32 v[50:51], v[54:55], v[28:29], v[50:51] op_sel:[1,1,0] op_sel_hi:[1,0,1] neg_lo:[1,0,0]
    v_cvt_pk_bf16_f32 v41, v56, v57
    ds_write_addtid_b32 v41 offset:40384
    v_cvt_pk_bf16_f32 v42, v54, -v55
    ds_write_addtid_b32 v42 offset:47456
    v_pk_mul_f32 v[56:57], v[58:59], v[26:27] op_sel:[0,0] op_sel_hi:[0,1]
    v_pk_mul_f32 v[54:55], v[50:51], v[28:29] op_sel:[0,0] op_sel_hi:[0,1]
    v_pk_fma_f32 v[56:57], v[58:59], v[26:27], v[56:57] op_sel:[1,1,0] op_sel_hi:[1,0,1] neg_lo:[1,0,0]
    v_pk_fma_f32 v[54:55], v[50:51], v[28:29], v[54:55] op_sel:[1,1,0] op_sel_hi:[1,0,1] neg_lo:[1,0,0]
    v_cvt_pk_bf16_f32 v43, v58, v59
    ds_write_addtid_b32 v43 offset:40928
    v_cvt_pk_bf16_f32 v40, v50, -v51
    ds_write_addtid_b32 v40 offset:48000
    v_pk_mul_f32 v[58:59], v[56:57], v[26:27] op_sel:[0,0] op_sel_hi:[0,1]
    v_pk_mul_f32 v[50:51], v[54:55], v[28:29] op_sel:[0,0] op_sel_hi:[0,1]
    v_pk_fma_f32 v[58:59], v[56:57], v[26:27], v[58:59] op_sel:[1,1,0] op_sel_hi:[1,0,1] neg_lo:[1,0,0]
    v_pk_fma_f32 v[50:51], v[54:55], v[28:29], v[50:51] op_sel:[1,1,0] op_sel_hi:[1,0,1] neg_lo:[1,0,0]
    v_cvt_pk_bf16_f32 v41, v56, v57
    ds_write_addtid_b32 v41 offset:34944
    v_cvt_pk_bf16_f32 v42, v54, -v55
    ds_write_addtid_b32 v42 offset:48544
    v_pk_mul_f32 v[56:57], v[58:59], v[26:27] op_sel:[0,0] op_sel_hi:[0,1]
    v_pk_mul_f32 v[54:55], v[50:51], v[28:29] op_sel:[0,0] op_sel_hi:[0,1]
    v_pk_fma_f32 v[56:57], v[58:59], v[26:27], v[56:57] op_sel:[1,1,0] op_sel_hi:[1,0,1] neg_lo:[1,0,0]
    v_pk_fma_f32 v[54:55], v[50:51], v[28:29], v[54:55] op_sel:[1,1,0] op_sel_hi:[1,0,1] neg_lo:[1,0,0]
    v_cvt_pk_bf16_f32 v43, v58, v59
    ds_write_addtid_b32 v43 offset:35488
    v_cvt_pk_bf16_f32 v40, v50, -v51
    ds_write_addtid_b32 v40 offset:49088
    v_pk_mul_f32 v[58:59], v[56:57], v[26:27] op_sel:[0,0] op_sel_hi:[0,1]
    v_pk_fma_f32 v[58:59], v[56:57], v[26:27], v[58:59] op_sel:[1,1,0] op_sel_hi:[1,0,1] neg_lo:[1,0,0]
    v_cvt_pk_bf16_f32 v41, v56, v57
    ds_write_addtid_b32 v41 offset:36032
    v_cvt_pk_bf16_f32 v42, v54, -v55
    ds_write_addtid_b32 v42 offset:49632
    v_cvt_pk_bf16_f32 v43, v58, v59
    ds_write_addtid_b32 v43 offset:36576
    s_branch C_MFMA
C_ROLE1:
    v_mul_f32 v36, 0x43000000, v21
    v_mul_f32 v37, 0x43000000, v22
    v_mul_f32 v38, 0x3f800000, v21
    v_mul_f32 v39, 0x3f800000, v22
    v_exp_f32 v36, v36
    v_fract_f32 v37, v37
    v_exp_f32 v38, v38
    v_fract_f32 v39, v39
    v_fmac_f32 v37, 0x43000000, v23
    v_fmac_f32 v39, 0x3f800000, v23
    v_cos_f32 v26, v37
    v_sin_f32 v27, v37
    v_cos_f32 v28, v39
    v_sin_f32 v29, v39
    v_mul_f32 v26, v26, v36
    v_mul_f32 v27, v27, v36
    v_mul_f32 v28, v28, v38
    v_mul_f32 v29, v29, v38
    v_pk_mul_f32 v[44:45], v[24:25], v[26:27] op_sel:[0,0] op_sel_hi:[0,1]
    v_pk_mul_f32 v[46:47], v[28:29], v[28:29] op_sel:[0,0] op_sel_hi:[0,1]
    v_pk_mul_f32 v[48:49], v[24:25], v[28:29] op_sel:[0,0] op_sel_hi:[0,1]
    v_pk_fma_f32 v[44:45], v[24:25], v[26:27], v[44:45] op_sel:[1,1,0] op_sel_hi:[1,0,1] neg_lo:[1,0,0]
    v_pk_fma_f32 v[46:47], v[28:29], v[28:29], v[46:47] op_sel:[1,1,0] op_sel_hi:[1,0,1] neg_lo:[1,0,0]
    v_pk_fma_f32 v[48:49], v[24:25], v[28:29], v[48:49] op_sel:[1,1,0] op_sel_hi:[1,0,1] neg_lo:[1,0,0]
    v_cvt_pk_bf16_f32 v40, v24, v25
    ds_write_addtid_b32 v40 offset:0
    v_pk_mul_f32 v[50:51], v[44:45], v[26:27] op_sel:[0,0] op_sel_hi:[0,1]
    v_pk_mul_f32 v[52:53], v[44:45], v[28:29] op_sel:[0,0] op_sel_hi:[0,1]
    v_pk_mul_f32 v[54:55], v[48:49], v[28:29] op_sel:[0,0] op_sel_hi:[0,1]
    v_pk_mul_f32 v[62:63], v[46:47], v[46:47] op_sel:[0,0] op_sel_hi:[0,1]
    v_pk_fma_f32 v[50:51], v[44:45], v[26:27], v[50:51] op_sel:[1,1,0] op_sel_hi:[1,0,1] neg_lo:[1,0,0]
    v_pk_fma_f32 v[52:53], v[44:45], v[28:29], v[52:53] op_sel:[1,1,0] op_sel_hi:[1,0,1] neg_lo:[1,0,0]
    v_pk_fma_f32 v[54:55], v[48:49], v[28:29], v[54:55] op_sel:[1,1,0] op_sel_hi:[1,0,1] neg_lo:[1,0,0]
    v_pk_fma_f32 v[62:63], v[46:47], v[46:47], v[62:63] op_sel:[1,1,0] op_sel_hi:[1,0,1] neg_lo:[1,0,0]
    v_cvt_pk_bf16_f32 v41, v44, v45
    ds_write_addtid_b32 v41 offset:4896
    v_cvt_pk_bf16_f32 v42, v48, v49
    ds_write_addtid_b32 v42 offset:544
    v_pk_mul_f32 v[56:57], v[50:51], v[26:27] op_sel:[0,0] op_sel_hi:[0,1]
    v_pk_mul_f32 v[58:59], v[50:51], v[46:47] op_sel:[0,0] op_sel_hi:[0,1]
    v_pk_mul_f32 v[44:45], v[52:53], v[28:29] op_sel:[0,0] op_sel_hi:[0,1]
    v_pk_mul_f32 v[48:49], v[54:55], v[28:29] op_sel:[0,0] op_sel_hi:[0,1]
    v_pk_fma_f32 v[56:57], v[50:51], v[26:27], v[56:57] op_sel:[1,1,0] op_sel_hi:[1,0,1] neg_lo:[1,0,0]
    v_pk_fma_f32 v[58:59], v[50:51], v[46:47], v[58:59] op_sel:[1,1,0] op_sel_hi:[1,0,1] neg_lo:[1,0,0]
    v_pk_fma_f32 v[44:45], v[52:53], v[28:29], v[44:45] op_sel:[1,1,0] op_sel_hi:[1,0,1] neg_lo:[1,0,0]
    v_pk_fma_f32 v[48:49], v[54:55], v[28:29], v[48:49] op_sel:[1,1,0] op_sel_hi:[1,0,1] neg_lo:[1,0,0]
    v_cvt_pk_bf16_f32 v43, v50, v51
    ds_write_addtid_b32 v43 offset:9792
    v_cvt_pk_bf16_f32 v40, v52, v53
    ds_write_addtid_b32 v40 offset:5440
    v_cvt_pk_bf16_f32 v41, v54, v55
    ds_write_addtid_b32 v41 offset:1088
    v_pk_mul_f32 v[54:55], v[48:49], v[28:29] op_sel:[0,0] op_sel_hi:[0,1]
    v_pk_mul_f32 v[52:53], v[44:45], v[28:29] op_sel:[0,0] op_sel_hi:[0,1]
    v_pk_mul_f32 v[50:51], v[58:59], v[46:47] op_sel:[0,0] op_sel_hi:[0,1]
    v_pk_mul_f32 v[24:25], v[56:57], v[46:47] op_sel:[0,0] op_sel_hi:[0,1]
    v_pk_fma_f32 v[54:55], v[48:49], v[28:29], v[54:55] op_sel:[1,1,0] op_sel_hi:[1,0,1] neg_lo:[1,0,0]
    v_pk_fma_f32 v[52:53], v[44:45], v[28:29], v[52:53] op_sel:[1,1,0] op_sel_hi:[1,0,1] neg_lo:[1,0,0]
    v_pk_fma_f32 v[50:51], v[58:59], v[46:47], v[50:51] op_sel:[1,1,0] op_sel_hi:[1,0,1] neg_lo:[1,0,0]
    v_pk_fma_f32 v[24:25], v[56:57], v[46:47], v[24:25] op_sel:[1,1,0] op_sel_hi:[1,0,1] neg_lo:[1,0,0]
    v_cvt_pk_bf16_f32 v42, v48, v49
    ds_write_addtid_b32 v42 offset:1632
    v_cvt_pk_bf16_f32 v43, v44, v45
    ds_write_addtid_b32 v43 offset:5984
    v_cvt_pk_bf16_f32 v40, v58, v59
    ds_write_addtid_b32 v40 offset:10336
    v_pk_mul_f32 v[48:49], v[54:55], v[28:29] op_sel:[0,0] op_sel_hi:[0,1]
    v_pk_mul_f32 v[44:45], v[52:53], v[28:29] op_sel:[0,0] op_sel_hi:[0,1]
    v_pk_mul_f32 v[58:59], v[50:51], v[46:47] op_sel:[0,0] op_sel_hi:[0,1]
    v_pk_mul_f32 v[56:57], v[24:25], v[46:47] op_sel:[0,0] op_sel_hi:[0,1]
    v_pk_fma_f32 v[48:49], v[54:55], v[28:29], v[48:49] op_sel:[1,1,0] op_sel_hi:[1,0,1] neg_lo:[1,0,0]
    v_pk_fma_f32 v[44:45], v[52:53], v[28:29], v[44:45] op_sel:[1,1,0] op_sel_hi:[1,0,1] neg_lo:[1,0,0]
    v_pk_fma_f32 v[58:59], v[50:51], v[46:47], v[58:59] op_sel:[1,1,0] op_sel_hi:[1,0,1] neg_lo:[1,0,0]
    v_pk_fma_f32 v[56:57], v[24:25], v[46:47], v[56:57] op_sel:[1,1,0] op_sel_hi:[1,0,1] neg_lo:[1,0,0]
    v_cvt_pk_bf16_f32 v41, v54, v55
    ds_write_addtid_b32 v41 offset:2176
    v_cvt_pk_bf16_f32 v42, v52, v53
    ds_write_addtid_b32 v42 offset:6528
    v_cvt_pk_bf16_f32 v43, v50, v51
    ds_write_addtid_b32 v43 offset:10880
    v_cvt_pk_bf16_f32 v40, v24, v25
    ds_write_addtid_b32 v40 offset:13600
    v_pk_mul_f32 v[54:55], v[48:49], v[28:29] op_sel:[0,0] op_sel_hi:[0,1]
    v_pk_mul_f32 v[52:53], v[44:45], v[28:29] op_sel:[0,0] op_sel_hi:[0,1]
    v_pk_mul_f32 v[50:51], v[58:59], v[62:63] op_sel:[0,0] op_sel_hi:[0,1]
    v_pk_mul_f32 v[24:25], v[56:57], v[46:47] op_sel:[0,0] op_sel_hi:[0,1]
    v_pk_mul_f32 v[64:65], v[56:57], v[26:27] op_sel:[0,0] op_sel_hi:[0,1]
    v_pk_fma_f32 v[54:55], v[48:49], v[28:29], v[54:55] op_sel:[1,1,0] op_sel_hi:[1,0,1] neg_lo:[1,0,0]
    v_pk_fma_f32 v[52:53], v[44:45], v[28:29], v[52:53] op_sel:[1,1,0] op_sel_hi:[1,0,1] neg_lo:[1,0,0]
    v_pk_fma_f32 v[50:51], v[58:59], v[62:63], v[50:51] op_sel:[1,1,0] op_sel_hi:[1,0,1] neg_lo:[1,0,0]
    v_pk_fma_f32 v[24:25], v[56:57], v[46:47], v[24:25] op_sel:[1,1,0] op_sel_hi:[1,0,1] neg_lo:[1,0,0]
    v_pk_fma_f32 v[64:65], v[56:57], v[26:27], v[64:65] op_sel:[1,1,0] op_sel_hi:[1,0,1] neg_lo:[1,0,0]
    v_cvt_pk_bf16_f32 v41, v48, v49
    ds_write_addtid_b32 v41 offset:2720
    v_cvt_pk_bf16_f32 v42, v44, v45
    ds_write_addtid_b32 v42 offset:7072
    v_cvt_pk_bf16_f32 v43, v58, v59
    ds_write_addtid_b32 v43 offset:11424
    v_cvt_pk_bf16_f32 v40, v56, v57
    ds_write_addtid_b32 v40 offset:14144
    v_pk_mul_f32 v[48:49], v[54:55], v[28:29] op_sel:[0,0] op_sel_hi:[0,1]
    v_pk_mul_f32 v[44:45], v[52:53], v[28:29] op_sel:[0,0] op_sel_hi:[0,1]
    v_pk_mul_f32 v[56:57], v[24:25], v[62:63] op_sel:[0,0] op_sel_hi:[0,1]
    v_pk_mul_f32 v[66:67], v[64:65], v[26:27] op_sel:[0,0] op_sel_hi:[0,1]
    v_pk_fma_f32 v[48:49], v[54:55], v[28:29], v[48:49] op_sel:[1,1,0] op_sel_hi:[1,0,1] neg_lo:[1,0,0]
    v_pk_fma_f32 v[44:45], v[52:53], v[28:29], v[44:45] op_sel:[1,1,0] op_sel_hi:[1,0,1] neg_lo:[1,0,0]
    v_pk_fma_f32 v[56:57], v[24:25], v[62:63], v[56:57] op_sel:[1,1,0] op_sel_hi:[1,0,1] neg_lo:[1,0,0]
    v_pk_fma_f32 v[66:67], v[64:65], v[26:27], v[66:67] op_sel:[1,1,0] op_sel_hi:[1,0,1] neg_lo:[1,0,0]
    v_cvt_pk_bf16_f32 v41, v54, v55
    ds_write_addtid_b32 v41 offset:3264
    v_cvt_pk_bf16_f32 v42, v52, v53
    ds_write_addtid_b32 v42 offset:7616
    v_cvt_pk_bf16_f32 v43, v50, v51
    ds_write_addtid_b32 v43 offset:12512
    v_cvt_pk_bf16_f32 v40, v24, v25
    ds_write_addtid_b32 v40 offset:14688
    v_cvt_pk_bf16_f32 v41, v64, v65
    s_mov_b32 m0, s70
    s_nop 0
    ds_write_addtid_b32 v41 offset:32768
    v_pk_mul_f32 v[52:53], v[44:45], v[28:29] op_sel:[0,0] op_sel_hi:[0,1]
    v_pk_mul_f32 v[64:65], v[66:67], v[26:27] op_sel:[0,0] op_sel_hi:[0,1]
    v_pk_fma_f32 v[52:53], v[44:45], v[28:29], v[52:53] op_sel:[1,1,0] op_sel_hi:[1,0,1] neg_lo:[1,0,0]
    v_pk_fma_f32 v[64:65], v[66:67], v[26:27], v[64:65] op_sel:[1,1,0] op_sel_hi:[1,0,1] neg_lo:[1,0,0]
    v_cvt_pk_bf16_f32 v42, v48, v49
    s_mov_b32 m0, s66
    s_nop 0
    ds_write_addtid_b32 v42 offset:3808
    v_cvt_pk_bf16_f32 v43, v44, v45
    ds_write_addtid_b32 v43 offset:8160
    v_cvt_pk_bf16_f32 v40, v56, v57
    ds_write_addtid_b32 v40 offset:15776
    v_cvt_pk_bf16_f32 v41, v66, v67
    s_mov_b32 m0, s70
    s_nop 0
    ds_write_addtid_b32 v41 offset:33856
    v_pk_mul_f32 v[66:67], v[64:65], v[26:27] op_sel:[0,0] op_sel_hi:[0,1]
    v_pk_fma_f32 v[66:67], v[64:65], v[26:27], v[66:67] op_sel:[1,1,0] op_sel_hi:[1,0,1] neg_lo:[1,0,0]
    v_cvt_pk_bf16_f32 v42, v52, v53
    s_mov_b32 m0, s66
    s_nop 0
    ds_write_addtid_b32 v42 offset:8704
    v_cvt_pk_bf16_f32 v43, v64, v65
    s_mov_b32 m0, s70
    s_nop 0
    ds_write_addtid_b32 v43 offset:37120
    v_cvt_pk_bf16_f32 v40, v66, v67
    ds_write_addtid_b32 v40 offset:38208
C_MFMA:
    s_mul_i32 s56, s2, 16384
    s_lshl_b32 s57, s38, 12
    s_add_u32 s56, s56, s57
    s_add_u32 s56, s56, 2605056
    s_mov_b64 exec, 0x1
    ds_inc_u32 v166, v166 offset:12
    s_mov_b64 exec, -1
    s_sub_u32 s52, s38, 8
    s_cmp_ge_u32 s52, 3
    s_cbranch_scc1 C_NPA
    s_mov_b32 s52, m0
    s_mov_b32 m0, 163328
    s_nop 0
    global_load_lds_dword v118, s[30:31]
    s_mov_b32 m0, s52
C_NPA:
    ds_write_b32 v113, v112
    s_setprio 2
    s_movk_i32 s60, 4000
C_KG:
    ds_read_b32 v16, v166 offset:12
    s_sub_u32 s60, s60, 1
    s_cmp_gt_i32 s60, 0
    s_waitcnt lgkmcnt(0)
    v_readfirstlane_b32 s52, v16
    s_nop 0
    s_cselect_b32 s52, s52, 4
    s_cmp_lg_u32 s52, 4
    s_cbranch_scc1 C_KG
    ds_read_b128 v[16:19], v111 offset:0
    ds_read_b128 v[20:23], v110 offset:0
    ds_read_b128 v[24:27], v111 offset:64
    ds_read_b128 v[28:31], v110 offset:64
    ds_read_b128 v[32:35], v111 offset:128
    ds_read_b128 v[36:39], v110 offset:128
    ds_read_b128 v[40:43], v111 offset:192
    ds_read_b128 v[44:47], v110 offset:192
    ds_read_b128 v[48:51], v111 offset:256
    ds_read_b128 v[52:55], v110 offset:256
    ds_read_b128 v[56:59], v111 offset:320
    ds_read_b128 v[60:63], v110 offset:320
    ds_read_b128 v[64:67], v111 offset:384
    ds_read_b128 v[68:71], v110 offset:384
    ds_read_b128 v[72:75], v111 offset:448
    ds_read_b128 v[76:79], v110 offset:448
    s_lshl_b32 s53, s63, 10
    s_sub_u32 s52, s64, s53
    s_add_u32 s52, s52, 3576
    v_and_b32 v165, 1, v5
    v_lshl_add_u32 v165, v6, 1, v165
    s_mul_i32 s53, s65, 384
    s_add_u32 s53, s53, 161920
    v_lshl_add_u32 v165, v165, 4, s53
    v_lshlrev_b32 v2, 3, v2
    v_sub_u32 v2, s52, v2
    s_mul_i32 s68, s63, 1088
    s_add_u32 s68, s68, s71
    v_lshl_add_u32 v15, v15, 3, s68
    s_cmp_lg_u32 s63, 0
    s_cbranch_scc1 C_LA1
    s_lshr_b32 s52, s2, 3
    s_mul_i32 s52, s52, 3
    s_add_u32 s52, s52, s65
    s_lshl_b32 s52, s52, 3
    s_and_b32 s53, s2, 7
    v_and_b32 v11, 7, v1
    v_add_u32 v11, s52, v11
    s_mul_i32 s54, s53, 7
    v_lshrrev_b32 v12, 3, v1
    v_add_u32 v12, s54, v12
    v_mul_u32_u24 v13, 0x48, v11
    v_add3_u32 v14, v12, v13, s53
    v_lshlrev_b32 v14, 7, v14
    s_add_u32 s53, s53, 64
    v_add_lshl_u32 v13, v13, s53, 7
    s_mul_i32 s53, s53, 0x240
    v_add_lshl_u32 v12, v11, s53, 7
    v_mov_b32 v10, 0
    v_lshrrev_b32 v9, 3, v1
    v_mul_u32_u24 v9, 3328, v9
    v_add3_u32 v9, v9, v3, s59
    s_branch C_LA2
C_LA1:
    v_and_b32 v93, 3, v5
    v_lshl_add_u32 v94, v6, 3, v11
    v_and_b32 v92, 1, v11
    v_mul_u32_u24 v92, 3456, v92
    v_add_u32 v92, s59, v92
    v_sub_u32 v93, v93, v94
    v_sub_u32 v94, v93, v94
    v_add_u32 v95, 44, v93
    v_lshrrev_b32 v96, 4, v95
    v_add_u32 v95, v95, v96
    v_lshl_add_u32 v11, v95, 3, v92
    v_add_u32 v95, 75, v94
    v_lshrrev_b32 v96, 4, v95
    v_add_u32 v95, v95, v96
    v_lshl_add_u32 v13, v95, 3, v92
    v_add_u32 v95, 40, v93
    v_lshrrev_b32 v96, 4, v95
    v_add_u32 v95, v95, v96
    v_lshl_add_u32 v12, v95, 3, v92
    v_add_u32 v95, 67, v94
    v_lshrrev_b32 v96, 4, v95
    v_add_u32 v95, v95, v96
    v_lshl_add_u32 v14, v95, 3, v92
C_LA2:
    s_cmp_eq_u32 s69, 2
    s_cbranch_scc1 C_T2
    v_lshrrev_b32 v89, 1, v6
    v_xor_b32 v88, v89, v6
    v_and_b32 v88, 1, v88
    v_lshlrev_b32 v88, 8, v88
    v_lshl_add_u32 v88, v89, 3, v88
    v_lshl_add_u32 v88, v5, 4, v88
    s_cmp_eq_u32 s69, 1
    s_cbranch_scc1 C_T1
    s_lshr_b32 s52, s69, 1
    s_mul_i32 s53, s52, 1600
    s_add_u32 s53, s53, s67
    v_add_u32 v88, s53, v88
    v_add_u32 v89, 3200, v88
    s_xor_b32 s52, s52, 1
    s_mov_b32 s53, 0
    s_waitcnt lgkmcnt(14)
    v_mfma_f32_16x16x32_bf16 v[80:83], v[16:19], v[20:23], 0
    s_waitcnt lgkmcnt(12)
    v_mfma_f32_16x16x32_bf16 v[84:87], v[24:27], v[28:31], 0
    s_waitcnt lgkmcnt(10)
    v_mfma_f32_16x16x32_bf16 v[80:83], v[32:35], v[36:39], v[80:83]
    s_waitcnt lgkmcnt(8)
    v_mfma_f32_16x16x32_bf16 v[84:87], v[40:43], v[44:47], v[84:87]
    s_waitcnt lgkmcnt(6)
    v_mfma_f32_16x16x32_bf16 v[80:83], v[48:51], v[52:55], v[80:83]
    s_waitcnt lgkmcnt(4)
    v_mfma_f32_16x16x32_bf16 v[84:87], v[56:59], v[60:63], v[84:87]
    s_waitcnt lgkmcnt(2)
    v_mfma_f32_16x16x32_bf16 v[80:83], v[64:67], v[68:71], v[80:83]
    s_waitcnt lgkmcnt(0)
    v_mfma_f32_16x16x32_bf16 v[84:87], v[72:75], v[76:79], v[84:87]
    s_nop 7
    v_pk_add_f32 v[80:81], v[80:81], v[84:85]
    v_pk_add_f32 v[82:83], v[82:83], v[86:87]
    v_cvt_pk_bf16_f32 v80, v80, v81
    v_cvt_pk_bf16_f32 v81, v82, v83
    ds_write_b64 v88, v[80:81] offset:32
    ds_write2_b32 v89, v80, v81 offset0:7 offset1:8
    s_mov_b64 exec, s[52:53]
    ds_write_b16 v88, v80 offset:1630
    ds_write_b16 v88, v80 offset:4826
    s_mov_b64 exec, -1
    s_branch C_B3
C_T1:
    s_add_u32 s53, s67, 544
    v_add_u32 v88, s53, v88
    v_add_u32 v89, 1600, v88
    s_waitcnt lgkmcnt(14)
    v_mfma_f32_16x16x32_bf16 v[80:83], v[16:19], v[20:23], 0
    s_waitcnt lgkmcnt(12)
    v_mfma_f32_16x16x32_bf16 v[84:87], v[24:27], v[28:31], 0
    s_waitcnt lgkmcnt(10)
    v_mfma_f32_16x16x32_bf16 v[80:83], v[32:35], v[36:39], v[80:83]
    s_waitcnt lgkmcnt(8)
    v_mfma_f32_16x16x32_bf16 v[84:87], v[40:43], v[44:47], v[84:87]
    s_waitcnt lgkmcnt(6)
    v_mfma_f32_16x16x32_bf16 v[80:83], v[48:51], v[52:55], v[80:83]
    s_waitcnt lgkmcnt(4)
    v_mfma_f32_16x16x32_bf16 v[84:87], v[56:59], v[60:63], v[84:87]
    s_waitcnt lgkmcnt(2)
    v_mfma_f32_16x16x32_bf16 v[80:83], v[64:67], v[68:71], v[80:83]
    s_waitcnt lgkmcnt(0)
    v_mfma_f32_16x16x32_bf16 v[84:87], v[72:75], v[76:79], v[84:87]
    s_nop 7
    v_pk_add_f32 v[80:81], v[80:81], v[84:85]
    v_pk_add_f32 v[82:83], v[82:83], v[86:87]
    v_cvt_pk_bf16_f32 v16, v81, v82
    v_cvt_pk_bf16_f32 v17, v82, v82
    v_cvt_pk_bf16_f32 v18, v82, v82
    v_cvt_pk_bf16_f32 v19, v82, v83
    ds_write2_b32 v88, v16, v17 offset0:1 offset1:2
    ds_write_b64 v88, v[16:17] offset:3200
    ds_write2_b32 v89, v18, v19 offset0:1 offset1:2
    ds_write_b64 v88, v[18:19] offset:4800
    v_cvt_pk_bf16_f32 v20, v80, v80
    v_cvt_pk_bf16_f32 v21, v80, v81
    s_mov_b64 exec, 0x1
    ds_write_b32 v88, v20
    ds_write_b32 v88, v20 offset:3196
    ds_write_b32 v88, v21 offset:1600
    ds_write_b32 v88, v21 offset:4796
    s_mov_b32 exec_lo, 0x0
    s_mov_b32 exec_hi, 0x8000
    ds_write_b16 v88, v17 offset:12
    ds_write_b16 v88, v17 offset:1610
    ds_write_b16 v88, v17 offset:3208
    ds_write_b16 v88, v17 offset:4806
    s_mov_b64 exec, -1
    s_branch C_B3
C_T2:
    v_lshlrev_b32 v88, 7, v6
    v_lshl_add_u32 v89, v5, 1, v88
    v_lshl_add_u32 v88, v5, 2, v88
    s_add_u32 s52, s64, 4728
    v_add_u32 v88, s52, v88
    s_add_u32 s52, s64, 4920
    v_add_u32 v89, s52, v89
    v_mov_b32 v90, s67
    s_waitcnt lgkmcnt(14)
    v_mfma_f32_16x16x32_bf16 v[80:83], v[16:19], v[20:23], 0
    s_waitcnt lgkmcnt(12)
    v_mfma_f32_16x16x32_bf16 v[84:87], v[24:27], v[28:31], 0
    s_waitcnt lgkmcnt(10)
    v_mfma_f32_16x16x32_bf16 v[80:83], v[32:35], v[36:39], v[80:83]
    s_waitcnt lgkmcnt(8)
    v_mfma_f32_16x16x32_bf16 v[84:87], v[40:43], v[44:47], v[84:87]
    s_waitcnt lgkmcnt(6)
    v_mfma_f32_16x16x32_bf16 v[80:83], v[48:51], v[52:55], v[80:83]
    s_waitcnt lgkmcnt(4)
    v_mfma_f32_16x16x32_bf16 v[84:87], v[56:59], v[60:63], v[84:87]
    s_waitcnt lgkmcnt(2)
    v_mfma_f32_16x16x32_bf16 v[80:83], v[64:67], v[68:71], v[80:83]
    s_waitcnt lgkmcnt(0)
    v_mfma_f32_16x16x32_bf16 v[84:87], v[72:75], v[76:79], v[84:87]
    s_nop 7
    v_pk_add_f32 v[80:81], v[80:81], v[84:85]
    v_pk_add_f32 v[82:83], v[82:83], v[86:87]
    v_cvt_pk_bf16_f32 v80, v80, v81
    v_cvt_pk_bf16_f32 v81, v82, v83
    s_mov_b32 exec_hi, 0
    ds_write2_b32 v88, v80, v81 offset0:0 offset1:16
    s_not_b64 exec, exec
    ds_write_b16 v89, v80 offset:4
    ds_write_b16_d16_hi v89, v80 offset:36
    ds_write_b16 v89, v81 offset:68
    ds_write_b16_d16_hi v89, v81 offset:100
    ds_write_b16 v89, v80 offset:384
    ds_write_b16_d16_hi v89, v80 offset:416
    ds_write_b16 v89, v81 offset:448
    ds_write_b16_d16_hi v89, v81 offset:480
    s_mov_b32 exec_lo, 0x80000000
    s_mov_b32 exec_hi, 0x0
    ds_write_b16_d16_hi v90, v81 offset:1126
    ds_write_b16_d16_hi v90, v81 offset:1128
    ds_write_b16_d16_hi v90, v81 offset:2724
    ds_write_b16_d16_hi v90, v81 offset:2726
    ds_write_b16_d16_hi v90, v81 offset:4322
    ds_write_b16_d16_hi v90, v81 offset:4324
    ds_write_b16_d16_hi v90, v81 offset:5920
    ds_write_b16_d16_hi v90, v81 offset:5922
    s_mov_b64 exec, -1
C_B3:
    s_mov_b64 exec, 0x1
    ds_inc_u32 v166, v166 offset:128
    s_mov_b64 exec, -1
    s_mov_b32 s61, s65
    s_cmp_lg_u32 s65, 1
    s_cbranch_scc1 C_NOUL
    s_waitcnt vmcnt(0)
    buffer_load_dwordx4 v[24:27], v3, s[40:43], s56 offen offset:0 sc1
    buffer_load_dwordx4 v[28:31], v3, s[40:43], s56 offen offset:1024 sc1
    buffer_load_dwordx4 v[32:35], v3, s[40:43], s56 offen offset:2048 sc1
    buffer_load_dwordx4 v[36:39], v3, s[40:43], s56 offen offset:3072 sc1
C_NOUL:
    s_movk_i32 s60, 4000
C_KM:
    ds_read_b128 v[16:19], v166 offset:128
    s_sub_u32 s60, s60, 1
    s_cmp_gt_i32 s60, 0
    s_waitcnt lgkmcnt(0)
    v_add_u32 v16, v16, v18
    s_nop 0
    v_readfirstlane_b32 s52, v16
    s_nop 0
    s_cselect_b32 s52, s52, 5
    s_cmp_lg_u32 s52, 5
    s_cbranch_scc1 C_KM
    s_setprio 3
    ds_read_b64 v[48:49], v7 offset:0
    ds_read_b64 v[50:51], v7 offset:8
    ds_read_b64 v[52:53], v7 offset:64
    ds_read_b64 v[54:55], v7 offset:72
    ds_read_b64 v[56:57], v7 offset:128
    ds_read_b64 v[58:59], v7 offset:136
    ds_read_b64 v[60:61], v7 offset:192
    ds_read_b64 v[62:63], v7 offset:200
    ds_read_b64 v[64:65], v7 offset:256
    ds_read_b64 v[66:67], v7 offset:264
    ds_read_b64 v[68:69], v7 offset:320
    ds_read_b64 v[70:71], v7 offset:328
    ds_read_b64 v[72:73], v7 offset:384
    ds_read_b64 v[74:75], v7 offset:392
    ds_read_b64 v[76:77], v7 offset:448
    ds_read_b64 v[78:79], v7 offset:456
    ds_read_b64 v[80:81], v7 offset:512
    ds_read_b64 v[82:83], v7 offset:520
    ds_read_b64 v[84:85], v7 offset:576
    ds_read_b64 v[86:87], v7 offset:584
    ds_read_b64 v[88:89], v7 offset:640
    ds_read_b64 v[90:91], v7 offset:648
    ds_read_b64 v[92:93], v7 offset:704
    ds_read_b64 v[94:95], v7 offset:712
    ds_read_b64 v[96:97], v7 offset:768
    ds_read_b64 v[98:99], v7 offset:776
    ds_read_b64 v[100:101], v7 offset:832
    ds_read_b64 v[102:103], v7 offset:840
    ds_read_b64 v[104:105], v7 offset:896
    ds_read_b64 v[106:107], v7 offset:904
    ds_read_b64 v[108:109], v7 offset:960
    ds_read_b64 v[110:111], v7 offset:968
    s_cmp_eq_u32 s63, 1
    s_cbranch_scc1 C_E1
    s_cmp_eq_u32 s63, 2
    s_cbranch_scc1 C_E2
    s_cmp_eq_u32 s63, 3
    s_cbranch_scc1 C_E3
    ds_read_b64 v[112:113], v7 offset:1152
    ds_read_b64 v[114:115], v7 offset:1160
    ds_read_b64 v[116:117], v7 offset:1216
    ds_read_b64 v[118:119], v7 offset:1224
    ds_read_b64 v[128:129], v7 offset:1280
    ds_read_b64 v[130:131], v7 offset:1288
    ds_read_b64 v[132:133], v7 offset:1344
    ds_read_b64 v[134:135], v7 offset:1352
    s_mov_b32 exec_hi, 0
    ds_write_b128 v9, v[160:163]
    s_mov_b64 exec, -1
    s_branch C_EE
C_E1:
    ds_read_b64 v[128:129], v7 offset:1152
    ds_read_b64 v[130:131], v7 offset:1160
    ds_read_b64 v[132:133], v7 offset:1216
    ds_read_b64 v[134:135], v7 offset:1224
    ds_read_b64 v[136:137], v7 offset:1280
    ds_read_b64 v[138:139], v7 offset:1288
    ds_read_b64 v[140:141], v7 offset:1344
    ds_read_b64 v[142:143], v7 offset:1352
    ds_read_b64 v[112:113], v7 offset:1024
    ds_read_b64 v[114:115], v7 offset:1032
    s_branch C_EE
C_E2:
    ds_read_b64 v[152:153], v7 offset:1152
    ds_read_b64 v[154:155], v7 offset:1160
    ds_read_b64 v[156:157], v7 offset:1216
    ds_read_b64 v[158:159], v7 offset:1224
    ds_read_b64 v[112:113], v7 offset:1024
    ds_read_b64 v[114:115], v7 offset:1032
    ds_read_b64 v[128:129], v9 offset:4608
    ds_read_b64 v[130:131], v9 offset:4616
    ds_read_b64 v[132:133], v9 offset:4672
    ds_read_b64 v[134:135], v9 offset:4680
    ds_read_b64 v[136:137], v9 offset:4736
    ds_read_b64 v[138:139], v9 offset:4744
    ds_read_b64 v[140:141], v9 offset:4800
    ds_read_b64 v[142:143], v9 offset:4808
    ds_read_b64 v[144:145], v9 offset:4864
    ds_read_b64 v[146:147], v9 offset:4872
    ds_read_b64 v[148:149], v9 offset:4928
    ds_read_b64 v[150:151], v9 offset:4936
    s_branch C_EE
C_E3:
    ds_read_b64 v[112:113], v7 offset:1024
    ds_read_b64 v[114:115], v7 offset:1032
    ds_read_b64 v[116:117], v7 offset:1088
    ds_read_b64 v[118:119], v7 offset:1096
    ds_read_b64 v[128:129], v9 offset:4608
    ds_read_b64 v[130:131], v9 offset:4616
    ds_read_b64 v[132:133], v9 offset:4672
    ds_read_b64 v[134:135], v9 offset:4680
    ds_read_b64 v[136:137], v9 offset:4736
    ds_read_b64 v[138:139], v9 offset:4744
    ds_read_b64 v[140:141], v9 offset:4800
    ds_read_b64 v[142:143], v9 offset:4808
    ds_read_b64 v[144:145], v9 offset:4864
    ds_read_b64 v[146:147], v9 offset:4872
    ds_read_b64 v[148:149], v9 offset:4928
    ds_read_b64 v[150:151], v9 offset:4936
    ds_read_b64 v[152:153], v10 offset:5120
    ds_read_b64 v[154:155], v10 offset:5128
    ds_read_b64 v[156:157], v10 offset:5184
    ds_read_b64 v[158:159], v10 offset:5192
    ds_read_b64 v[120:121], v10 offset:5248
    ds_read_b64 v[122:123], v10 offset:5256
    ds_read_b64 v[124:125], v10 offset:5312
    ds_read_b64 v[126:127], v10 offset:5320
C_EE:
    v_mov_b32 v167, v19
    v_readfirstlane_b32 s39, v19
    v_mul_u32_u24 v5, 37, v1
    v_lshrrev_b32 v5, 8, v5
    v_mul_u32_u24 v5, 1040, v5
    v_add_u32 v5, v5, v3
    v_add_u32 v6, 0x2400, v5
    s_mul_i32 s44, s2, 18432
    s_mul_i32 s45, s38, 96
    s_add_u32 s44, s44, s45
    s_add_u32 s72, s4, s44
    s_addc_u32 s73, s5, 0
    s_add_u32 s74, s24, s45
    s_addc_u32 s75, s25, 0
    s_mul_i32 s58, s69, 1920
    s_add_u32 s58, s58, s71
    s_add_u32 s58, s58, 4352
    s_cmp_lt_u32 s38, 4
    s_cbranch_scc1 C_B5
    v_mov_b32 v40, -1
    v_mov_b32 v41, -1
    v_mov_b32 v42, -1
    v_mov_b32 v43, -1
    v_lshlrev_b32 v20, 4, v0
    v_lshlrev_b32 v21, 2, v0
    s_cmp_lg_u32 s61, 1
    s_cbranch_scc1 C_PO
    v_xor_b32 v22, 0x80000000, v167
    s_movk_i32 s60, 4000
    s_branch C_UP_W
C_UP:
    buffer_load_dwordx4 v[24:27], v3, s[40:43], s56 offen offset:0 sc1
    buffer_load_dwordx4 v[28:31], v3, s[40:43], s56 offen offset:1024 sc1
    buffer_load_dwordx4 v[32:35], v3, s[40:43], s56 offen offset:2048 sc1
    buffer_load_dwordx4 v[36:39], v3, s[40:43], s56 offen offset:3072 sc1
C_UP_W:
    s_waitcnt vmcnt(0)
C_UP_C:
    v_xor_b32 v44, v22, v27
    v_xor_b32 v45, v22, v31
    v_xor_b32 v46, v22, v35
    v_xor_b32 v47, v22, v39
    v_or3_b32 v44, v44, v45, v46
    v_or_b32 v44, v44, v47
    v_cmp_ne_u32 vcc, 0, v44
    s_nop 0
    s_and_b64 exec, exec, vcc
    s_cbranch_execz C_UP_D
    s_wqm_b64 exec, exec
    s_sub_u32 s60, s60, 1
    s_cmp_gt_i32 s60, 0
    s_sleep 2
    s_cbranch_scc1 C_UP
C_UP_D:
    s_mov_b64 exec, -1
    s_lshl_b32 s52, s38, 10
    s_add_u32 m0, s52, 47936
    v_add_u32 v18, 161412, v3
    ds_write_addtid_b32 v25 offset:55040
    ds_write_addtid_b32 v29 offset:55296
    ds_write_addtid_b32 v33 offset:55552
    ds_write_addtid_b32 v37 offset:55808
    s_mov_b64 exec, 0x2
    ds_inc_u32 v18, v18
    s_mov_b64 exec, -1
    ds_write_addtid_b32 v26 offset:60928
    ds_write_addtid_b32 v30 offset:61184
    ds_write_addtid_b32 v34 offset:61440
    ds_write_addtid_b32 v38 offset:61696
    s_mov_b64 exec, 0x4
    ds_inc_u32 v18, v18
    s_mov_b64 exec, -1
    ds_write_addtid_b32 v24 offset:49152
    ds_write_addtid_b32 v28 offset:49408
    ds_write_addtid_b32 v32 offset:49664
    ds_write_addtid_b32 v36 offset:49920
    s_mov_b64 exec, 0x1
    ds_inc_u32 v18, v18
    s_mov_b64 exec, -1
C_PO:
    s_cmp_ge_u32 s50, 144
    s_cbranch_scc1 C_B5
    buffer_store_dwordx4 v[40:43], v20, s[40:43], s48 offen sc1
    buffer_store_dword v40, v21, s[40:43], s49 offen sc1
    s_cmp_lt_u32 s2, 128
    s_cselect_b32 s52, 8, -1
    s_cmp_lg_u32 s38, s52
    s_cbranch_scc1 C_B5
    v_lshrrev_b32 v22, 2, v1
    v_mul_u32_u24 v22, 8128, v22
    v_add_u32 v22, v22, v3
    s_mul_i32 s52, s2, 64
    s_add_u32 s52, s52, 65536
    s_mov_b32 exec_lo, 0xffffffff
    s_mov_b32 exec_hi, 0x0
    buffer_store_dwordx4 v[40:43], v22, s[40:43], s52 offen sc1
    s_mov_b64 exec, -1
C_B5:
    s_mov_b32 s56, 0xf7efdfbf
    s_mov_b32 s57, 0x7efdfb
    s_movk_i32 s60, 4000
C_UF:
    ds_read_b32 v16, v166 offset:132
    s_sub_u32 s60, s60, 1
    s_cmp_gt_i32 s60, 0
    s_waitcnt lgkmcnt(0)
    v_readfirstlane_b32 s52, v16
    s_nop 0
    s_cselect_b32 s52, s52, 4
    s_cmp_lg_u32 s52, 4
    s_cbranch_scc1 C_UF
    s_movk_i32 s60, 4000
    s_cmp_eq_u32 s63, 1
    s_cbranch_scc1 C_P1
    s_cmp_eq_u32 s63, 2
    s_cbranch_scc1 C_P2
    s_cmp_eq_u32 s63, 3
    s_cbranch_scc1 C_P3
    s_setprio 2
    ds_read_b128 v[32:35], v8 offset:3552
    ds_read_b128 v[36:39], v8 offset:4064
    ds_read_b128 v[40:43], v8 offset:3680
    s_waitcnt lgkmcnt(2)
    v_mfma_f32_16x16x32_bf16 v[136:139], v[112:115], v[32:35], 0
    v_mfma_f32_16x16x32_bf16 v[140:143], v[116:119], v[32:35], 0
    v_mfma_f32_16x16x32_bf16 v[144:147], v[128:131], v[32:35], 0
    v_mfma_f32_16x16x32_bf16 v[148:151], v[132:135], v[32:35], 0
    v_mfma_f32_16x16x32_bf16 v[28:31], v[52:55], v[32:35], 0
    v_mfma_f32_16x16x32_bf16 v[20:23], v[48:51], v[32:35], 0
    ds_read_b128 v[44:47], v8 offset:3808
    s_waitcnt lgkmcnt(2)
    v_mfma_f32_16x16x32_bf16 v[152:155], v[112:115], v[36:39], 0
    v_mfma_f32_16x16x32_bf16 v[156:159], v[116:119], v[36:39], 0
    v_mfma_f32_16x16x32_bf16 v[120:123], v[128:131], v[36:39], 0
    v_mfma_f32_16x16x32_bf16 v[124:127], v[132:135], v[36:39], 0
    v_mfma_f32_16x16x32_bf16 v[28:31], v[84:87], v[36:39], v[28:31]
    v_mfma_f32_16x16x32_bf16 v[20:23], v[80:83], v[36:39], v[20:23]
    v_mfma_f32_16x16x32_bf16 v[24:27], v[52:55], v[36:39], 0
    v_mfma_f32_16x16x32_bf16 v[16:19], v[48:51], v[36:39], 0
    v_cvt_pk_bf16_f32 v136, v136, v137
    v_cvt_pk_bf16_f32 v137, v138, v139
    ds_write_b64 v4, v[136:137] offset:680
    v_cvt_pk_bf16_f32 v140, v140, v141
    v_cvt_pk_bf16_f32 v141, v142, v143
    ds_write_b64 v4, v[140:141] offset:4136
    v_cvt_pk_bf16_f32 v144, v144, v145
    v_cvt_pk_bf16_f32 v145, v146, v147
    ds_write_b64 v4, v[144:145] offset:7592
    v_cvt_pk_bf16_f32 v148, v148, v149
    v_cvt_pk_bf16_f32 v149, v150, v151
    ds_write_b64 v4, v[148:149] offset:11048
    ds_read_b128 v[32:35], v8 offset:3936
    s_waitcnt lgkmcnt(6)
    v_mfma_f32_16x16x32_bf16 v[28:31], v[60:63], v[40:43], v[28:31]
    v_mfma_f32_16x16x32_bf16 v[20:23], v[56:59], v[40:43], v[20:23]
    v_cvt_pk_bf16_f32 v152, v152, v153
    v_cvt_pk_bf16_f32 v153, v154, v155
    ds_write_b64 v4, v[152:153] offset:136
    v_cvt_pk_bf16_f32 v156, v156, v157
    v_cvt_pk_bf16_f32 v157, v158, v159
    ds_write_b64 v4, v[156:157] offset:3592
    v_cvt_pk_bf16_f32 v120, v120, v121
    v_cvt_pk_bf16_f32 v121, v122, v123
    ds_write_b64 v4, v[120:121] offset:7048
    v_cvt_pk_bf16_f32 v124, v124, v125
    v_cvt_pk_bf16_f32 v125, v126, v127
    ds_write_b64 v4, v[124:125] offset:10504
    s_mov_b64 exec, 0x1
    ds_write_b32 v166, v166 offset:0
    s_mov_b64 exec, -1
    s_setprio 0
    ds_read_b128 v[84:87], v8 offset:4192
    ds_read_b64 v[160:161], v2 offset:512
    ds_read_b64 v[162:163], v2
    s_or_b32 s52, s38, s2
    s_cbranch_scc1 C_NOEP
    s_mov_b64 exec, 0x1
    buffer_store_dword v167, v10, s[40:43], 0 offen sc1
    s_mov_b64 exec, -1
C_NOEP:
    s_cmp_ge_u32 s2, 128
    s_cbranch_scc1 C_NX0
    s_mov_b32 m0, s58
    s_mov_b64 exec, s[56:57]
    global_load_lds_dwordx4 v5, s[72:73]
    s_add_u32 m0, s58, 896
    s_nop 0
    global_load_lds_dwordx4 v6, s[72:73]
    s_add_u32 m0, s58, 1792
    s_mov_b64 exec, 0x3f
    global_load_lds_dwordx4 v3, s[74:75]
    s_mov_b64 exec, -1
C_NX0:
    s_mov_b32 m0, 163328
    s_nop 0
    global_load_lds_dword v14, s[28:29]
    s_mov_b64 exec, 0xff
    global_load_lds_dword v13, s[28:29]
    global_load_lds_dword v13, s[26:27]
    global_load_lds_dword v12, s[30:31]
    s_mov_b64 exec, -1
    s_waitcnt lgkmcnt(13)
    v_mfma_f32_16x16x32_bf16 v[28:31], v[68:71], v[44:47], v[28:31]
    v_mfma_f32_16x16x32_bf16 v[20:23], v[64:67], v[44:47], v[20:23]
    ds_read_b128 v[80:83], v8 offset:4320
    s_waitcnt lgkmcnt(9)
    v_mfma_f32_16x16x32_bf16 v[28:31], v[76:79], v[32:35], v[28:31]
    v_mfma_f32_16x16x32_bf16 v[20:23], v[72:75], v[32:35], v[20:23]
    ds_read_b128 v[36:39], v8 offset:4448
    s_waitcnt lgkmcnt(2)
    v_and_b32 v48, 0xffff0000, v161
    v_lshlrev_b32 v49, 16, v161
    v_and_b32 v50, 0xffff0000, v160
    v_lshlrev_b32 v51, 16, v160
    v_mul_f32 v48, v48, v164
    v_mul_f32 v49, v49, v164
    v_mul_f32 v50, v50, v164
    v_mul_f32 v51, v51, v164
    v_cvt_pk_bf16_f32 v49, v48, v49
    v_lshlrev_b32 v48, 16, v49
    v_and_b32 v49, 0xffff0000, v49
    v_cvt_pk_bf16_f32 v51, v50, v51
    v_lshlrev_b32 v50, 16, v51
    v_and_b32 v51, 0xffff0000, v51
    v_and_b32 v52, 0xffff0000, v163
    v_lshlrev_b32 v53, 16, v163
    v_and_b32 v54, 0xffff0000, v162
    v_lshlrev_b32 v55, 16, v162
    v_mul_f32 v52, v52, v164
    v_mul_f32 v53, v53, v164
    v_mul_f32 v54, v54, v164
    v_mul_f32 v55, v55, v164
    v_cvt_pk_bf16_f32 v53, v52, v53
    v_lshlrev_b32 v52, 16, v53
    v_and_b32 v53, 0xffff0000, v53
    v_cvt_pk_bf16_f32 v55, v54, v55
    v_lshlrev_b32 v54, 16, v55
    v_and_b32 v55, 0xffff0000, v55
    v_mfma_f32_16x16x32_bf16 v[28:31], v[92:95], v[84:87], v[28:31]
    v_mfma_f32_16x16x32_bf16 v[20:23], v[88:91], v[84:87], v[20:23]
    v_mfma_f32_16x16x32_bf16 v[24:27], v[60:63], v[84:87], v[24:27]
    v_mfma_f32_16x16x32_bf16 v[16:19], v[56:59], v[84:87], v[16:19]
    s_waitcnt lgkmcnt(1)
    v_mfma_f32_16x16x32_bf16 v[28:31], v[100:103], v[80:83], v[28:31]
    v_mfma_f32_16x16x32_bf16 v[20:23], v[96:99], v[80:83], v[20:23]
    v_mfma_f32_16x16x32_bf16 v[24:27], v[68:71], v[80:83], v[24:27]
    v_mfma_f32_16x16x32_bf16 v[16:19], v[64:67], v[80:83], v[16:19]
    s_waitcnt lgkmcnt(0)
    v_mfma_f32_16x16x32_bf16 v[28:31], v[108:111], v[36:39], v[28:31]
    v_mfma_f32_16x16x32_bf16 v[20:23], v[104:107], v[36:39], v[20:23]
    v_mfma_f32_16x16x32_bf16 v[24:27], v[76:79], v[36:39], v[24:27]
    v_mfma_f32_16x16x32_bf16 v[16:19], v[72:75], v[36:39], v[16:19]
    s_mov_b32 exec_lo, 0xc000c000
    s_mov_b32 exec_hi, 0xc000c000
    s_nop 2
    ds_write_b128 v165, v[28:31] offset:128
    ds_write_b32 v166, v166 offset:64
    s_mov_b64 exec, -1
    s_setprio 0
    s_waitcnt vmcnt(7)
    s_cmp_lt_u32 s2, 128
    s_cbranch_scc1 C_EPI
    s_waitcnt vmcnt(4)
    s_branch C_EPI
C_P1:
    s_setprio 2
    ds_read_b128 v[32:35], v8 offset:2528
    ds_read_b128 v[36:39], v8 offset:3040
    ds_read_b128 v[40:43], v8 offset:2656
    s_waitcnt lgkmcnt(2)
    v_mfma_f32_16x16x32_bf16 v[144:147], v[128:131], v[32:35], 0
    v_mfma_f32_16x16x32_bf16 v[148:151], v[132:135], v[32:35], 0
    v_mfma_f32_16x16x32_bf16 v[152:155], v[136:139], v[32:35], 0
    v_mfma_f32_16x16x32_bf16 v[156:159], v[140:143], v[32:35], 0
    v_mfma_f32_16x16x32_bf16 v[28:31], v[52:55], v[32:35], 0
    v_mfma_f32_16x16x32_bf16 v[20:23], v[48:51], v[32:35], 0
    ds_read_b128 v[44:47], v8 offset:2784
    s_waitcnt lgkmcnt(2)
    v_mfma_f32_16x16x32_bf16 v[116:119], v[128:131], v[36:39], 0
    v_mfma_f32_16x16x32_bf16 v[160:163], v[132:135], v[36:39], 0
    v_mfma_f32_16x16x32_bf16 v[120:123], v[136:139], v[36:39], 0
    v_mfma_f32_16x16x32_bf16 v[124:127], v[140:143], v[36:39], 0
    v_mfma_f32_16x16x32_bf16 v[28:31], v[84:87], v[36:39], v[28:31]
    v_mfma_f32_16x16x32_bf16 v[20:23], v[80:83], v[36:39], v[20:23]
    v_mfma_f32_16x16x32_bf16 v[24:27], v[52:55], v[36:39], 0
    v_mfma_f32_16x16x32_bf16 v[16:19], v[48:51], v[36:39], 0
    v_cvt_pk_bf16_f32 v144, v144, v145
    v_cvt_pk_bf16_f32 v145, v146, v147
    ds_write_b64 v4, v[144:145] offset:1768
    v_cvt_pk_bf16_f32 v148, v148, v149
    v_cvt_pk_bf16_f32 v149, v150, v151
    ds_write_b64 v4, v[148:149] offset:5224
    v_cvt_pk_bf16_f32 v152, v152, v153
    v_cvt_pk_bf16_f32 v153, v154, v155
    ds_write_b64 v4, v[152:153] offset:8680
    v_cvt_pk_bf16_f32 v156, v156, v157
    v_cvt_pk_bf16_f32 v157, v158, v159
    ds_write_b64 v4, v[156:157] offset:12136
    ds_read_b128 v[32:35], v8 offset:2912
    s_waitcnt lgkmcnt(6)
    v_mfma_f32_16x16x32_bf16 v[28:31], v[60:63], v[40:43], v[28:31]
    v_mfma_f32_16x16x32_bf16 v[20:23], v[56:59], v[40:43], v[20:23]
    v_cvt_pk_bf16_f32 v116, v116, v117
    v_cvt_pk_bf16_f32 v117, v118, v119
    ds_write_b64 v4, v[116:117] offset:1224
    v_cvt_pk_bf16_f32 v160, v160, v161
    v_cvt_pk_bf16_f32 v161, v162, v163
    ds_write_b64 v4, v[160:161] offset:4680
    v_cvt_pk_bf16_f32 v120, v120, v121
    v_cvt_pk_bf16_f32 v121, v122, v123
    ds_write_b64 v4, v[120:121] offset:8136
    v_cvt_pk_bf16_f32 v124, v124, v125
    v_cvt_pk_bf16_f32 v125, v126, v127
    ds_write_b64 v4, v[124:125] offset:11592
    s_mov_b64 exec, 0x1
    ds_write_b32 v166, v166 offset:4
    s_mov_b64 exec, -1
    s_setprio 1
    ds_read_b128 v[36:39], v8 offset:3168
    ds_read_b64 v[144:145], v9 offset:4608
    ds_read_b64 v[146:147], v9 offset:4616
    ds_read_b64 v[148:149], v9 offset:4672
    ds_read_b64 v[150:151], v9 offset:4680
    ds_read_b64 v[152:153], v9 offset:4736
    ds_read_b64 v[154:155], v9 offset:4744
    ds_read_b64 v[156:157], v9 offset:4800
    ds_read_b64 v[158:159], v9 offset:4808
    ds_read_b64 v[160:161], v2 offset:512
    ds_read_b64 v[162:163], v2
    s_cmp_ge_u32 s2, 128
    s_cbranch_scc1 C_NX1
    s_mov_b32 m0, s58
    s_mov_b64 exec, s[56:57]
    global_load_lds_dwordx4 v5, s[72:73]
    s_add_u32 m0, s58, 896
    s_nop 0
    global_load_lds_dwordx4 v6, s[72:73]
    s_add_u32 m0, s58, 1792
    s_mov_b64 exec, 0x3f
    global_load_lds_dwordx4 v3, s[74:75]
    s_mov_b64 exec, -1
C_NX1:
    s_waitcnt lgkmcnt(15)
    v_mfma_f32_16x16x32_bf16 v[28:31], v[68:71], v[44:47], v[28:31]
    v_mfma_f32_16x16x32_bf16 v[20:23], v[64:67], v[44:47], v[20:23]
    ds_read_b128 v[40:43], v8 offset:3296
    v_mfma_f32_16x16x32_bf16 v[28:31], v[76:79], v[32:35], v[28:31]
    v_mfma_f32_16x16x32_bf16 v[20:23], v[72:75], v[32:35], v[20:23]
    ds_read_b128 v[128:131], v8 offset:3424
    s_waitcnt lgkmcnt(2)
    v_and_b32 v48, 0xffff0000, v161
    v_lshlrev_b32 v49, 16, v161
    v_and_b32 v50, 0xffff0000, v160
    v_lshlrev_b32 v51, 16, v160
    v_mul_f32 v48, v48, v164
    v_mul_f32 v49, v49, v164
    v_mul_f32 v50, v50, v164
    v_mul_f32 v51, v51, v164
    v_cvt_pk_bf16_f32 v49, v48, v49
    v_lshlrev_b32 v48, 16, v49
    v_and_b32 v49, 0xffff0000, v49
    v_cvt_pk_bf16_f32 v51, v50, v51
    v_lshlrev_b32 v50, 16, v51
    v_and_b32 v51, 0xffff0000, v51
    v_and_b32 v52, 0xffff0000, v163
    v_lshlrev_b32 v53, 16, v163
    v_and_b32 v54, 0xffff0000, v162
    v_lshlrev_b32 v55, 16, v162
    v_mul_f32 v52, v52, v164
    v_mul_f32 v53, v53, v164
    v_mul_f32 v54, v54, v164
    v_mul_f32 v55, v55, v164
    v_cvt_pk_bf16_f32 v53, v52, v53
    v_lshlrev_b32 v52, 16, v53
    v_and_b32 v53, 0xffff0000, v53
    v_cvt_pk_bf16_f32 v55, v54, v55
    v_lshlrev_b32 v54, 16, v55
    v_and_b32 v55, 0xffff0000, v55
    v_mfma_f32_16x16x32_bf16 v[28:31], v[92:95], v[36:39], v[28:31]
    v_mfma_f32_16x16x32_bf16 v[20:23], v[88:91], v[36:39], v[20:23]
    v_mfma_f32_16x16x32_bf16 v[24:27], v[60:63], v[36:39], v[24:27]
    v_mfma_f32_16x16x32_bf16 v[16:19], v[56:59], v[36:39], v[16:19]
    ds_read_b128 v[132:135], v8 offset:3552
    s_waitcnt lgkmcnt(2)
    v_mfma_f32_16x16x32_bf16 v[28:31], v[100:103], v[40:43], v[28:31]
    v_mfma_f32_16x16x32_bf16 v[20:23], v[96:99], v[40:43], v[20:23]
    v_mfma_f32_16x16x32_bf16 v[24:27], v[68:71], v[40:43], v[24:27]
    v_mfma_f32_16x16x32_bf16 v[16:19], v[64:67], v[40:43], v[16:19]
    ds_read_b96 v[60:62], v166
    ds_read_b128 v[136:139], v8 offset:3680
    s_waitcnt lgkmcnt(3)
    v_mfma_f32_16x16x32_bf16 v[28:31], v[108:111], v[128:131], v[28:31]
    v_mfma_f32_16x16x32_bf16 v[20:23], v[104:107], v[128:131], v[20:23]
    v_mfma_f32_16x16x32_bf16 v[24:27], v[76:79], v[128:131], v[24:27]
    v_mfma_f32_16x16x32_bf16 v[16:19], v[72:75], v[128:131], v[16:19]
    s_waitcnt lgkmcnt(1)
C_FL1:
    v_min3_u32 v60, v60, v61, v62
    v_cmp_eq_u32 vcc, 0, v60
    s_nop 4
    s_cbranch_vccz C_FD1
    ds_read_b96 v[60:62], v166
    s_sub_u32 s60, s60, 1
    s_cmp_gt_i32 s60, 0
    s_waitcnt lgkmcnt(0)
    s_cbranch_scc1 C_FL1
C_FD1:
    ds_read_b128 v[140:143], v8 offset:3808
    v_mfma_f32_16x16x32_bf16 v[20:23], v[112:115], v[132:135], v[20:23]
    v_mfma_f32_16x16x32_bf16 v[24:27], v[84:87], v[132:135], v[24:27]
    v_mfma_f32_16x16x32_bf16 v[16:19], v[80:83], v[132:135], v[16:19]
    s_mov_b32 exec_lo, 0xc000c000
    s_mov_b32 exec_hi, 0xc000c000
    ds_write_b128 v165, v[28:31] offset:256
    ds_write_b32 v166, v166 offset:68
    s_mov_b64 exec, -1
    ds_read_b128 v[44:47], v8 offset:3936
    s_waitcnt lgkmcnt(4)
    v_mfma_f32_16x16x32_bf16 v[24:27], v[92:95], v[136:139], v[24:27]
    v_mfma_f32_16x16x32_bf16 v[16:19], v[88:91], v[136:139], v[16:19]
    ds_read_b128 v[32:35], v8 offset:4064
    ds_read_b64_tr_b16 v[36:37], v11 offset:0
    ds_read_b64_tr_b16 v[38:39], v12 offset:0
    ds_read_b64_tr_b16 v[68:69], v11 offset:272
    ds_read_b64_tr_b16 v[70:71], v12 offset:272
    s_waitcnt lgkmcnt(8)
    v_mfma_f32_16x16x32_bf16 v[24:27], v[100:103], v[140:143], v[24:27]
    v_mfma_f32_16x16x32_bf16 v[16:19], v[96:99], v[140:143], v[16:19]
    ds_read_b64_tr_b16 v[64:65], v11 offset:544
    ds_read_b64_tr_b16 v[66:67], v12 offset:544
    s_waitcnt lgkmcnt(7)
    v_mfma_f32_16x16x32_bf16 v[24:27], v[108:111], v[44:47], v[24:27]
    v_mfma_f32_16x16x32_bf16 v[16:19], v[104:107], v[44:47], v[16:19]
    ds_read_b64_tr_b16 v[40:41], v11 offset:816
    ds_read_b64_tr_b16 v[42:43], v12 offset:816
    s_waitcnt lgkmcnt(8)
    v_mfma_f32_16x16x32_bf16 v[16:19], v[112:115], v[32:35], v[16:19]
    s_waitcnt lgkmcnt(6)
    v_mfma_f32_16x16x32_bf16 v[20:23], v[36:39], v[156:159], v[20:23]
    v_mfma_f32_16x16x32_bf16 v[16:19], v[36:39], v[148:151], v[16:19]
    s_waitcnt lgkmcnt(4)
    v_mfma_f32_16x16x32_bf16 v[20:23], v[68:71], v[152:155], v[20:23]
    v_mfma_f32_16x16x32_bf16 v[16:19], v[68:71], v[144:147], v[16:19]
    ds_read_b32 v60, v166 offset:64
    ds_read_b128 v[56:59], v165 offset:128
    s_waitcnt lgkmcnt(4)
    v_mfma_f32_16x16x32_bf16 v[20:23], v[64:67], v[148:151], v[20:23]
    s_waitcnt lgkmcnt(2)
    v_mfma_f32_16x16x32_bf16 v[20:23], v[40:43], v[144:147], v[20:23]
    s_setprio 0
    s_waitcnt lgkmcnt(0)
C_CL1:
    v_cmp_eq_u32 vcc, 0, v60
    s_nop 4
    s_cbranch_vccz C_CD
    ds_read_b32 v60, v166 offset:64
    ds_read_b128 v[56:59], v165 offset:128
    s_sub_u32 s60, s60, 1
    s_cmp_gt_i32 s60, 0
    s_waitcnt lgkmcnt(0)
    s_cbranch_scc1 C_CL1
    s_branch C_CD
C_P2:
    s_setprio 2
    ds_read_b128 v[32:35], v8 offset:1504
    ds_read_b128 v[36:39], v8 offset:2016
    ds_read_b128 v[40:43], v8 offset:1632
    s_waitcnt lgkmcnt(2)
    v_mfma_f32_16x16x32_bf16 v[116:119], v[152:155], v[32:35], 0
    v_mfma_f32_16x16x32_bf16 v[160:163], v[156:159], v[32:35], 0
    v_mfma_f32_16x16x32_bf16 v[28:31], v[52:55], v[32:35], 0
    v_mfma_f32_16x16x32_bf16 v[20:23], v[48:51], v[32:35], 0
    ds_read_b128 v[44:47], v8 offset:1760
    s_waitcnt lgkmcnt(2)
    v_mfma_f32_16x16x32_bf16 v[120:123], v[152:155], v[36:39], 0
    v_mfma_f32_16x16x32_bf16 v[124:127], v[156:159], v[36:39], 0
    v_mfma_f32_16x16x32_bf16 v[28:31], v[84:87], v[36:39], v[28:31]
    v_mfma_f32_16x16x32_bf16 v[20:23], v[80:83], v[36:39], v[20:23]
    v_mfma_f32_16x16x32_bf16 v[24:27], v[52:55], v[36:39], 0
    v_mfma_f32_16x16x32_bf16 v[16:19], v[48:51], v[36:39], 0
    v_cvt_pk_bf16_f32 v116, v116, v117
    v_cvt_pk_bf16_f32 v117, v118, v119
    ds_write_b64 v4, v[116:117] offset:2856
    v_cvt_pk_bf16_f32 v160, v160, v161
    v_cvt_pk_bf16_f32 v161, v162, v163
    ds_write_b64 v4, v[160:161] offset:6312
    ds_read_b128 v[32:35], v8 offset:1888
    s_waitcnt lgkmcnt(4)
    v_mfma_f32_16x16x32_bf16 v[28:31], v[60:63], v[40:43], v[28:31]
    v_mfma_f32_16x16x32_bf16 v[20:23], v[56:59], v[40:43], v[20:23]
    v_cvt_pk_bf16_f32 v120, v120, v121
    v_cvt_pk_bf16_f32 v121, v122, v123
    ds_write_b64 v4, v[120:121] offset:2312
    v_cvt_pk_bf16_f32 v124, v124, v125
    v_cvt_pk_bf16_f32 v125, v126, v127
    ds_write_b64 v4, v[124:125] offset:5768
    s_mov_b64 exec, 0x1
    ds_write_b32 v166, v166 offset:8
    s_mov_b64 exec, -1
    s_setprio 1
    ds_read_b128 v[36:39], v8 offset:2144
    ds_read_b64 v[116:117], v7 offset:1088
    ds_read_b64 v[118:119], v7 offset:1096
    ds_read_b64 v[120:121], v10 offset:5120
    ds_read_b64 v[122:123], v10 offset:5128
    ds_read_b64 v[124:125], v10 offset:5184
    ds_read_b64 v[126:127], v10 offset:5192
    ds_read_b64 v[160:161], v2 offset:512
    ds_read_b64 v[162:163], v2
    s_cmp_ge_u32 s2, 128
    s_cbranch_scc1 C_NX2
    s_mov_b32 m0, s58
    s_mov_b64 exec, s[56:57]
    global_load_lds_dwordx4 v5, s[72:73]
    s_add_u32 m0, s58, 896
    s_nop 0
    global_load_lds_dwordx4 v6, s[72:73]
    s_add_u32 m0, s58, 1792
    s_mov_b64 exec, 0x3f
    global_load_lds_dwordx4 v3, s[74:75]
    s_mov_b64 exec, -1
C_NX2:
    s_waitcnt lgkmcnt(15)
    v_mfma_f32_16x16x32_bf16 v[28:31], v[68:71], v[44:47], v[28:31]
    v_mfma_f32_16x16x32_bf16 v[20:23], v[64:67], v[44:47], v[20:23]
    ds_read_b128 v[40:43], v8 offset:2272
    s_waitcnt lgkmcnt(13)
    v_mfma_f32_16x16x32_bf16 v[28:31], v[76:79], v[32:35], v[28:31]
    v_mfma_f32_16x16x32_bf16 v[20:23], v[72:75], v[32:35], v[20:23]
    ds_read_b128 v[152:155], v8 offset:2400
    s_waitcnt lgkmcnt(2)
    v_and_b32 v48, 0xffff0000, v161
    v_lshlrev_b32 v49, 16, v161
    v_and_b32 v50, 0xffff0000, v160
    v_lshlrev_b32 v51, 16, v160
    v_mul_f32 v48, v48, v164
    v_mul_f32 v49, v49, v164
    v_mul_f32 v50, v50, v164
    v_mul_f32 v51, v51, v164
    v_cvt_pk_bf16_f32 v49, v48, v49
    v_lshlrev_b32 v48, 16, v49
    v_and_b32 v49, 0xffff0000, v49
    v_cvt_pk_bf16_f32 v51, v50, v51
    v_lshlrev_b32 v50, 16, v51
    v_and_b32 v51, 0xffff0000, v51
    v_and_b32 v52, 0xffff0000, v163
    v_lshlrev_b32 v53, 16, v163
    v_and_b32 v54, 0xffff0000, v162
    v_lshlrev_b32 v55, 16, v162
    v_mul_f32 v52, v52, v164
    v_mul_f32 v53, v53, v164
    v_mul_f32 v54, v54, v164
    v_mul_f32 v55, v55, v164
    v_cvt_pk_bf16_f32 v53, v52, v53
    v_lshlrev_b32 v52, 16, v53
    v_and_b32 v53, 0xffff0000, v53
    v_cvt_pk_bf16_f32 v55, v54, v55
    v_lshlrev_b32 v54, 16, v55
    v_and_b32 v55, 0xffff0000, v55
    v_mfma_f32_16x16x32_bf16 v[28:31], v[92:95], v[36:39], v[28:31]
    v_mfma_f32_16x16x32_bf16 v[20:23], v[88:91], v[36:39], v[20:23]
    v_mfma_f32_16x16x32_bf16 v[24:27], v[60:63], v[36:39], v[24:27]
    v_mfma_f32_16x16x32_bf16 v[16:19], v[56:59], v[36:39], v[16:19]
    ds_read_b128 v[156:159], v8 offset:2528
    s_waitcnt lgkmcnt(2)
    v_mfma_f32_16x16x32_bf16 v[28:31], v[100:103], v[40:43], v[28:31]
    v_mfma_f32_16x16x32_bf16 v[20:23], v[96:99], v[40:43], v[20:23]
    v_mfma_f32_16x16x32_bf16 v[24:27], v[68:71], v[40:43], v[24:27]
    v_mfma_f32_16x16x32_bf16 v[16:19], v[64:67], v[40:43], v[16:19]
    ds_read_b128 v[44:47], v8 offset:2656
    s_waitcnt lgkmcnt(2)
    v_mfma_f32_16x16x32_bf16 v[28:31], v[108:111], v[152:155], v[28:31]
    v_mfma_f32_16x16x32_bf16 v[20:23], v[104:107], v[152:155], v[20:23]
    v_mfma_f32_16x16x32_bf16 v[24:27], v[76:79], v[152:155], v[24:27]
    v_mfma_f32_16x16x32_bf16 v[16:19], v[72:75], v[152:155], v[16:19]
    ds_read_b128 v[32:35], v8 offset:2784
    s_waitcnt lgkmcnt(2)
    v_mfma_f32_16x16x32_bf16 v[20:23], v[112:115], v[156:159], v[20:23]
    v_mfma_f32_16x16x32_bf16 v[24:27], v[84:87], v[156:159], v[24:27]
    v_mfma_f32_16x16x32_bf16 v[16:19], v[80:83], v[156:159], v[16:19]
    s_mov_b32 exec_lo, 0xc000c000
    s_mov_b32 exec_hi, 0xc000c000
    ds_write_b128 v165, v[28:31] offset:384
    ds_write_b32 v166, v166 offset:72
    s_mov_b64 exec, -1
    ds_read_b96 v[60:62], v166
    ds_read_b128 v[36:39], v8 offset:2912
    s_waitcnt lgkmcnt(5)
    v_mfma_f32_16x16x32_bf16 v[24:27], v[92:95], v[44:47], v[24:27]
    v_mfma_f32_16x16x32_bf16 v[16:19], v[88:91], v[44:47], v[16:19]
    s_waitcnt lgkmcnt(1)
C_FL2:
    v_min3_u32 v60, v60, v61, v62
    v_cmp_eq_u32 vcc, 0, v60
    s_nop 4
    s_cbranch_vccz C_FD2
    ds_read_b96 v[60:62], v166
    s_sub_u32 s60, s60, 1
    s_cmp_gt_i32 s60, 0
    s_waitcnt lgkmcnt(0)
    s_cbranch_scc1 C_FL2
C_FD2:
    ds_read_b128 v[68:71], v8 offset:3040
    v_mfma_f32_16x16x32_bf16 v[24:27], v[100:103], v[32:35], v[24:27]
    v_mfma_f32_16x16x32_bf16 v[16:19], v[96:99], v[32:35], v[16:19]
    ds_read_b128 v[64:67], v8 offset:3552
    s_waitcnt lgkmcnt(2)
    v_mfma_f32_16x16x32_bf16 v[24:27], v[108:111], v[36:39], v[24:27]
    v_mfma_f32_16x16x32_bf16 v[16:19], v[104:107], v[36:39], v[16:19]
    ds_read_b128 v[40:43], v8 offset:4064
    ds_read_b64_tr_b16 v[76:77], v13 offset:6912
    ds_read_b64_tr_b16 v[78:79], v14 offset:6912
    ds_read_b64_tr_b16 v[72:73], v13 offset:7456
    ds_read_b64_tr_b16 v[74:75], v14 offset:7456
    s_waitcnt lgkmcnt(6)
    v_mfma_f32_16x16x32_bf16 v[16:19], v[112:115], v[68:71], v[16:19]
    ds_read_b64_tr_b16 v[152:153], v11 offset:0
    ds_read_b64_tr_b16 v[154:155], v12 offset:0
    s_waitcnt lgkmcnt(7)
    v_mfma_f32_16x16x32_bf16 v[20:23], v[116:119], v[64:67], v[20:23]
    ds_read_b64_tr_b16 v[84:85], v11 offset:272
    ds_read_b64_tr_b16 v[86:87], v12 offset:272
    s_waitcnt lgkmcnt(8)
    v_mfma_f32_16x16x32_bf16 v[16:19], v[116:119], v[40:43], v[16:19]
    ds_read_b64_tr_b16 v[80:81], v11 offset:544
    ds_read_b64_tr_b16 v[82:83], v12 offset:544
    s_waitcnt lgkmcnt(8)
    v_mfma_f32_16x16x32_bf16 v[20:23], v[76:79], v[124:127], v[20:23]
    v_mfma_f32_16x16x32_bf16 v[16:19], v[76:79], v[120:123], v[16:19]
    ds_read_b64_tr_b16 v[156:157], v11 offset:816
    ds_read_b64_tr_b16 v[158:159], v12 offset:816
    s_waitcnt lgkmcnt(8)
    v_mfma_f32_16x16x32_bf16 v[20:23], v[72:75], v[120:123], v[20:23]
    ds_read_b64_tr_b16 v[92:93], v11 offset:1088
    ds_read_b64_tr_b16 v[94:95], v12 offset:1088
    s_waitcnt lgkmcnt(8)
    v_mfma_f32_16x16x32_bf16 v[16:19], v[152:155], v[148:151], v[16:19]
    ds_read_b64_tr_b16 v[88:89], v11 offset:1360
    ds_read_b64_tr_b16 v[90:91], v12 offset:1360
    s_waitcnt lgkmcnt(8)
    v_mfma_f32_16x16x32_bf16 v[16:19], v[84:87], v[144:147], v[16:19]
    ds_read_b64_tr_b16 v[44:45], v11 offset:1632
    ds_read_b64_tr_b16 v[46:47], v12 offset:1632
    s_waitcnt lgkmcnt(8)
    v_mfma_f32_16x16x32_bf16 v[20:23], v[80:83], v[148:151], v[20:23]
    v_mfma_f32_16x16x32_bf16 v[16:19], v[80:83], v[140:143], v[16:19]
    ds_read_b64_tr_b16 v[100:101], v11 offset:1904
    ds_read_b64_tr_b16 v[102:103], v12 offset:1904
    s_waitcnt lgkmcnt(8)
    v_mfma_f32_16x16x32_bf16 v[20:23], v[156:159], v[144:147], v[20:23]
    v_mfma_f32_16x16x32_bf16 v[16:19], v[156:159], v[136:139], v[16:19]
    s_waitcnt lgkmcnt(6)
    v_mfma_f32_16x16x32_bf16 v[20:23], v[92:95], v[140:143], v[20:23]
    v_mfma_f32_16x16x32_bf16 v[16:19], v[92:95], v[132:135], v[16:19]
    s_waitcnt lgkmcnt(4)
    v_mfma_f32_16x16x32_bf16 v[20:23], v[88:91], v[136:139], v[20:23]
    v_mfma_f32_16x16x32_bf16 v[16:19], v[88:91], v[128:131], v[16:19]
    ds_read_b32 v60, v166 offset:68
    ds_read_b128 v[56:59], v165 offset:256
    s_waitcnt lgkmcnt(4)
    v_mfma_f32_16x16x32_bf16 v[20:23], v[44:47], v[132:135], v[20:23]
    s_waitcnt lgkmcnt(2)
    v_mfma_f32_16x16x32_bf16 v[20:23], v[100:103], v[128:131], v[20:23]
    s_setprio 0
    s_waitcnt lgkmcnt(0)
C_CL2:
    v_cmp_eq_u32 vcc, 0, v60
    s_nop 4
    s_cbranch_vccz C_CD
    ds_read_b32 v60, v166 offset:68
    ds_read_b128 v[56:59], v165 offset:256
    s_sub_u32 s60, s60, 1
    s_cmp_gt_i32 s60, 0
    s_waitcnt lgkmcnt(0)
    s_cbranch_scc1 C_CL2
    s_branch C_CD
C_P3:
    s_setprio 1
    ds_read_b128 v[32:35], v8 offset:480
    ds_read_b128 v[36:39], v8 offset:608
    ds_read_b128 v[40:43], v8 offset:736
    ds_read_b64 v[160:161], v2 offset:512
    ds_read_b64 v[162:163], v2
    s_waitcnt lgkmcnt(4)
    v_mfma_f32_16x16x32_bf16 v[28:31], v[52:55], v[32:35], 0
    v_mfma_f32_16x16x32_bf16 v[20:23], v[48:51], v[32:35], 0
    ds_read_b128 v[44:47], v8 offset:864
    s_waitcnt lgkmcnt(4)
    v_mfma_f32_16x16x32_bf16 v[28:31], v[60:63], v[36:39], v[28:31]
    v_mfma_f32_16x16x32_bf16 v[20:23], v[56:59], v[36:39], v[20:23]
    s_cmp_lg_u32 s38, 9
    s_cbranch_scc1 C_NPL0
    s_cmp_ge_u32 s2, 96
    s_cselect_b32 s52, 16, 8
    v_lshrrev_b32 v9, 1, v3
    v_writelane_b32 v9, s52, 3
    s_and_b32 s52, s2, 31
    s_lshl_b32 s52, s52, 7
    v_add_u32 v9, s52, v9
    s_mov_b64 exec, 0xf
    buffer_load_dword v10, v9, s[40:43], 0 offen offset:2048 sc1
    s_mov_b64 exec, -1
C_NPL0:
    s_cmp_ge_u32 s2, 128
    s_cbranch_scc1 C_NX3
    s_mov_b32 m0, s58
    s_mov_b64 exec, s[56:57]
    global_load_lds_dwordx4 v5, s[72:73]
    s_add_u32 m0, s58, 896
    s_nop 0
    global_load_lds_dwordx4 v6, s[72:73]
    s_add_u32 m0, s58, 1792
    s_mov_b64 exec, 0x3f
    global_load_lds_dwordx4 v3, s[74:75]
    s_mov_b64 exec, -1
C_NX3:
    ds_read_b128 v[32:35], v8 offset:992
    s_waitcnt lgkmcnt(4)
    v_mfma_f32_16x16x32_bf16 v[28:31], v[68:71], v[40:43], v[28:31]
    v_mfma_f32_16x16x32_bf16 v[20:23], v[64:67], v[40:43], v[20:23]
    ds_read_b128 v[36:39], v8 offset:1120
    s_waitcnt lgkmcnt(2)
    v_mfma_f32_16x16x32_bf16 v[28:31], v[76:79], v[44:47], v[28:31]
    v_mfma_f32_16x16x32_bf16 v[20:23], v[72:75], v[44:47], v[20:23]
    ds_read_b128 v[40:43], v8 offset:1248
    s_waitcnt lgkmcnt(2)
    v_mfma_f32_16x16x32_bf16 v[28:31], v[84:87], v[32:35], v[28:31]
    v_mfma_f32_16x16x32_bf16 v[20:23], v[80:83], v[32:35], v[20:23]
    v_mfma_f32_16x16x32_bf16 v[24:27], v[52:55], v[32:35], 0
    v_mfma_f32_16x16x32_bf16 v[16:19], v[48:51], v[32:35], 0
    ds_read_b128 v[44:47], v8 offset:1376
    s_waitcnt lgkmcnt(2)
    v_mfma_f32_16x16x32_bf16 v[28:31], v[92:95], v[36:39], v[28:31]
    v_mfma_f32_16x16x32_bf16 v[20:23], v[88:91], v[36:39], v[20:23]
    v_mfma_f32_16x16x32_bf16 v[24:27], v[60:63], v[36:39], v[24:27]
    v_mfma_f32_16x16x32_bf16 v[16:19], v[56:59], v[36:39], v[16:19]
    ds_read_b128 v[32:35], v8 offset:1504
    v_and_b32 v48, 0xffff0000, v161
    v_lshlrev_b32 v49, 16, v161
    v_and_b32 v50, 0xffff0000, v160
    v_lshlrev_b32 v51, 16, v160
    v_mul_f32 v48, v48, v164
    v_mul_f32 v49, v49, v164
    v_mul_f32 v50, v50, v164
    v_mul_f32 v51, v51, v164
    v_cvt_pk_bf16_f32 v49, v48, v49
    v_lshlrev_b32 v48, 16, v49
    v_and_b32 v49, 0xffff0000, v49
    v_cvt_pk_bf16_f32 v51, v50, v51
    v_lshlrev_b32 v50, 16, v51
    v_and_b32 v51, 0xffff0000, v51
    v_and_b32 v52, 0xffff0000, v163
    v_lshlrev_b32 v53, 16, v163
    v_and_b32 v54, 0xffff0000, v162
    v_lshlrev_b32 v55, 16, v162
    v_mul_f32 v52, v52, v164
    v_mul_f32 v53, v53, v164
    v_mul_f32 v54, v54, v164
    v_mul_f32 v55, v55, v164
    v_cvt_pk_bf16_f32 v53, v52, v53
    v_lshlrev_b32 v52, 16, v53
    v_and_b32 v53, 0xffff0000, v53
    v_cvt_pk_bf16_f32 v55, v54, v55
    v_lshlrev_b32 v54, 16, v55
    v_and_b32 v55, 0xffff0000, v55
    s_waitcnt lgkmcnt(2)
    v_mfma_f32_16x16x32_bf16 v[28:31], v[100:103], v[40:43], v[28:31]
    v_mfma_f32_16x16x32_bf16 v[20:23], v[96:99], v[40:43], v[20:23]
    v_mfma_f32_16x16x32_bf16 v[24:27], v[68:71], v[40:43], v[24:27]
    v_mfma_f32_16x16x32_bf16 v[16:19], v[64:67], v[40:43], v[16:19]
    ds_read_b128 v[36:39], v8 offset:1632
    s_waitcnt lgkmcnt(2)
    v_mfma_f32_16x16x32_bf16 v[28:31], v[108:111], v[44:47], v[28:31]
    v_mfma_f32_16x16x32_bf16 v[20:23], v[104:107], v[44:47], v[20:23]
    v_mfma_f32_16x16x32_bf16 v[24:27], v[76:79], v[44:47], v[24:27]
    v_mfma_f32_16x16x32_bf16 v[16:19], v[72:75], v[44:47], v[16:19]
    ds_read_b128 v[68:71], v8 offset:1760
    s_waitcnt lgkmcnt(2)
    v_mfma_f32_16x16x32_bf16 v[20:23], v[112:115], v[32:35], v[20:23]
    v_mfma_f32_16x16x32_bf16 v[24:27], v[84:87], v[32:35], v[24:27]
    v_mfma_f32_16x16x32_bf16 v[16:19], v[80:83], v[32:35], v[16:19]
    ds_read_b96 v[60:62], v166
    ds_read_b128 v[64:67], v8 offset:1888
    s_waitcnt lgkmcnt(3)
    v_mfma_f32_16x16x32_bf16 v[24:27], v[92:95], v[36:39], v[24:27]
    v_mfma_f32_16x16x32_bf16 v[16:19], v[88:91], v[36:39], v[16:19]
    s_waitcnt lgkmcnt(1)
C_FL3:
    v_min3_u32 v60, v60, v61, v62
    v_cmp_eq_u32 vcc, 0, v60
    s_nop 4
    s_cbranch_vccz C_FD3
    ds_read_b96 v[60:62], v166
    s_sub_u32 s60, s60, 1
    s_cmp_gt_i32 s60, 0
    s_waitcnt lgkmcnt(0)
    s_cbranch_scc1 C_FL3
C_FD3:
    ds_read_b128 v[40:43], v8 offset:2016
    v_mfma_f32_16x16x32_bf16 v[24:27], v[100:103], v[68:71], v[24:27]
    v_mfma_f32_16x16x32_bf16 v[16:19], v[96:99], v[68:71], v[16:19]
    ds_read_b128 v[76:79], v8 offset:2528
    s_waitcnt lgkmcnt(2)
    v_mfma_f32_16x16x32_bf16 v[24:27], v[108:111], v[64:67], v[24:27]
    v_mfma_f32_16x16x32_bf16 v[16:19], v[104:107], v[64:67], v[16:19]
    ds_read_b128 v[72:75], v8 offset:3040
    ds_read_b64_tr_b16 v[44:45], v13 offset:6912
    ds_read_b64_tr_b16 v[46:47], v14 offset:6912
    ds_read_b64_tr_b16 v[84:85], v13 offset:7456
    ds_read_b64_tr_b16 v[86:87], v14 offset:7456
    s_waitcnt lgkmcnt(6)
    v_mfma_f32_16x16x32_bf16 v[16:19], v[112:115], v[40:43], v[16:19]
    ds_read_b64_tr_b16 v[80:81], v13 offset:8000
    ds_read_b64_tr_b16 v[82:83], v14 offset:8000
    s_waitcnt lgkmcnt(7)
    v_mfma_f32_16x16x32_bf16 v[20:23], v[116:119], v[76:79], v[20:23]
    ds_read_b64_tr_b16 v[32:33], v13 offset:8544
    ds_read_b64_tr_b16 v[34:35], v14 offset:8544
    s_waitcnt lgkmcnt(8)
    v_mfma_f32_16x16x32_bf16 v[16:19], v[116:119], v[72:75], v[16:19]
    ds_read_b64_tr_b16 v[92:93], v11 offset:1088
    ds_read_b64_tr_b16 v[94:95], v12 offset:1088
    s_waitcnt lgkmcnt(8)
    v_mfma_f32_16x16x32_bf16 v[20:23], v[44:47], v[124:127], v[20:23]
    v_mfma_f32_16x16x32_bf16 v[16:19], v[44:47], v[120:123], v[16:19]
    ds_read_b64_tr_b16 v[88:89], v11 offset:1360
    ds_read_b64_tr_b16 v[90:91], v12 offset:1360
    s_waitcnt lgkmcnt(8)
    v_mfma_f32_16x16x32_bf16 v[20:23], v[84:87], v[120:123], v[20:23]
    v_mfma_f32_16x16x32_bf16 v[16:19], v[84:87], v[156:159], v[16:19]
    ds_read_b64_tr_b16 v[36:37], v11 offset:1632
    ds_read_b64_tr_b16 v[38:39], v12 offset:1632
    s_waitcnt lgkmcnt(8)
    v_mfma_f32_16x16x32_bf16 v[20:23], v[80:83], v[156:159], v[20:23]
    v_mfma_f32_16x16x32_bf16 v[16:19], v[80:83], v[152:155], v[16:19]
    ds_read_b64_tr_b16 v[100:101], v11 offset:1904
    ds_read_b64_tr_b16 v[102:103], v12 offset:1904
    s_waitcnt lgkmcnt(8)
    v_mfma_f32_16x16x32_bf16 v[20:23], v[32:35], v[152:155], v[20:23]
    ds_read_b64_tr_b16 v[96:97], v11 offset:2176
    ds_read_b64_tr_b16 v[98:99], v12 offset:2176
    s_waitcnt lgkmcnt(8)
    v_mfma_f32_16x16x32_bf16 v[16:19], v[92:95], v[148:151], v[16:19]
    ds_read_b64_tr_b16 v[68:69], v11 offset:2448
    ds_read_b64_tr_b16 v[70:71], v12 offset:2448
    s_cmp_lg_u32 s38, 9
    s_cbranch_scc1 C_NPL
    s_mov_b64 exec, 0xf
    s_waitcnt vmcnt(3)
    s_cmp_lt_u32 s2, 128
    s_cbranch_scc1 C_NPW
    s_waitcnt vmcnt(0)
C_NPW:
    v_xor_b32 v5, s39, v10
    v_and_b32 v5, 0xffffdfff, v5
    v_cmp_ne_u32 vcc, 0, v5
    s_nop 4
    s_cbranch_vccz C_NPL2
    buffer_load_dword v4, v9, s[40:43], 0 offen offset:2048 sc1
C_NPL2:
    s_mov_b64 exec, -1
C_NPL:
    s_waitcnt lgkmcnt(8)
    v_mfma_f32_16x16x32_bf16 v[16:19], v[88:91], v[144:147], v[16:19]
    ds_read_b64_tr_b16 v[108:109], v11 offset:2720
    ds_read_b64_tr_b16 v[110:111], v12 offset:2720
    s_waitcnt lgkmcnt(8)
    v_mfma_f32_16x16x32_bf16 v[20:23], v[36:39], v[148:151], v[20:23]
    v_mfma_f32_16x16x32_bf16 v[16:19], v[36:39], v[140:143], v[16:19]
    ds_read_b64_tr_b16 v[104:105], v11 offset:2992
    ds_read_b64_tr_b16 v[106:107], v12 offset:2992
    s_waitcnt lgkmcnt(8)
    v_mfma_f32_16x16x32_bf16 v[20:23], v[100:103], v[144:147], v[20:23]
    v_mfma_f32_16x16x32_bf16 v[16:19], v[100:103], v[136:139], v[16:19]
    s_waitcnt lgkmcnt(6)
    v_mfma_f32_16x16x32_bf16 v[20:23], v[96:99], v[140:143], v[20:23]
    v_mfma_f32_16x16x32_bf16 v[16:19], v[96:99], v[132:135], v[16:19]
    s_waitcnt lgkmcnt(4)
    v_mfma_f32_16x16x32_bf16 v[20:23], v[68:71], v[136:139], v[20:23]
    v_mfma_f32_16x16x32_bf16 v[16:19], v[68:71], v[128:131], v[16:19]
    ds_read_b32 v60, v166 offset:72
    ds_read_b128 v[56:59], v165 offset:384
    s_waitcnt lgkmcnt(4)
    v_mfma_f32_16x16x32_bf16 v[20:23], v[108:111], v[132:135], v[20:23]
    s_waitcnt lgkmcnt(2)
    v_mfma_f32_16x16x32_bf16 v[20:23], v[104:107], v[128:131], v[20:23]
    s_setprio 0
    s_waitcnt lgkmcnt(0)
C_CL3:
    v_cmp_eq_u32 vcc, 0, v60
    s_nop 4
    s_cbranch_vccz C_CD
    ds_read_b32 v60, v166 offset:72
    ds_read_b128 v[56:59], v165 offset:384
    s_sub_u32 s60, s60, 1
    s_cmp_gt_i32 s60, 0
    s_waitcnt lgkmcnt(0)
    s_cbranch_scc1 C_CL3
C_CD:
    s_cmp_eq_u32 s38, 9
    s_cbranch_scc1 C_CD2
    s_waitcnt vmcnt(3)
    s_cmp_lt_u32 s2, 128
    s_cbranch_scc1 C_CD2
    s_waitcnt vmcnt(0)
C_CD2:
    s_mov_b32 exec_lo, 0x30003
    s_mov_b32 exec_hi, 0x30003
    s_nop 4
    v_pk_add_f32 v[16:17], v[16:17], v[56:57]
    v_pk_add_f32 v[18:19], v[18:19], v[58:59]
    s_mov_b64 exec, -1
C_EPI:
    s_nop 3
    s_movk_i32 s54, 0x3f80
    s_mov_b32 s55, 1.0
    v_add_f32_dpp v16, v24, v16 row_shr:2 row_mask:0xf bank_mask:0xf
    v_add_f32_dpp v17, v25, v17 row_shr:2 row_mask:0xf bank_mask:0xf
    v_add_f32_dpp v18, v26, v18 row_shr:2 row_mask:0xf bank_mask:0xf
    v_add_f32_dpp v19, v27, v19 row_shr:2 row_mask:0xf bank_mask:0xf
    v_add_f32_dpp v20, v28, v20 row_shr:2 row_mask:0xf bank_mask:0xf
    v_add_f32_dpp v21, v29, v21 row_shr:2 row_mask:0xf bank_mask:0xf
    v_add_f32_dpp v22, v30, v22 row_shr:2 row_mask:0xf bank_mask:0xf
    v_add_f32_dpp v23, v31, v23 row_shr:2 row_mask:0xf bank_mask:0xf
    v_add_f32_dpp v20, v24, v20 row_shl:14 row_mask:0xf bank_mask:0xf
    v_add_f32_dpp v21, v25, v21 row_shl:14 row_mask:0xf bank_mask:0xf
    v_add_f32_dpp v22, v26, v22 row_shl:14 row_mask:0xf bank_mask:0xf
    v_add_f32_dpp v23, v27, v23 row_shl:14 row_mask:0xf bank_mask:0xf
    v_cvt_pk_bf16_f32 v16, v16, v17
    v_cvt_pk_bf16_f32 v17, v18, v19
    v_cvt_pk_bf16_f32 v18, v20, v21
    v_cvt_pk_bf16_f32 v19, v22, v23
    v_dot2c_f32_bf16 v48, s54, v16
    v_dot2c_f32_bf16 v49, s55, v16
    v_dot2c_f32_bf16 v50, s54, v17
    v_dot2c_f32_bf16 v51, s55, v17
    v_dot2c_f32_bf16 v52, s54, v18
    v_dot2c_f32_bf16 v53, s55, v18
    v_dot2c_f32_bf16 v54, s54, v19
    v_dot2c_f32_bf16 v55, s55, v19
    v_cvt_pk_bf16_f32 v48, v48, v49
    v_cvt_pk_bf16_f32 v49, v50, v51
    ds_write_b64 v15, v[48:49] offset:0
    v_cvt_pk_bf16_f32 v52, v52, v53
    v_cvt_pk_bf16_f32 v53, v54, v55
    ds_write_b64 v15, v[52:53] offset:544
    v_mov_b32 v20, 161504
    s_cmp_lt_u32 s38, 8
    s_cbranch_scc1 C_GA
    s_cmp_lg_u32 s38, 9
    s_cbranch_scc1 C_NOGA
    s_mov_b64 exec, 0xf
    v_xor_b32 v5, s39, v10
    v_and_b32 v5, 0xffffdfff, v5
    v_cmp_ne_u32 vcc, 0, v5
    s_nop 4
    s_cbranch_vccz C_PL_K
    s_movk_i32 s60, 4000
    s_branch C_PL_W
C_PL:
    buffer_load_dword v4, v9, s[40:43], 0 offen offset:2048 sc1
C_PL_W:
    s_waitcnt vmcnt(0)
C_PL_C:
    v_xor_b32 v5, s39, v4
    v_and_b32 v5, 0xffffdfff, v5
    v_cmp_ne_u32 vcc, 0, v5
    s_nop 0
    s_and_b64 exec, exec, vcc
    s_cbranch_execz C_PL_D
    s_sub_u32 s60, s60, 1
    s_cmp_gt_i32 s60, 0
    s_sleep 2
    s_cbranch_scc1 C_PL
C_PL_D:
    s_mov_b64 exec, 0xf
    v_mov_b32 v10, v4
C_PL_K:
    v_lshrrev_b32 v9, 2, v3
    v_add_u32 v9, 161504, v9
    v_and_b32 v10, 0x2000, v10
    ds_write_b32 v9, v10
    s_mov_b64 exec, -1
    s_branch C_NOGA
C_GA:
    v_lshrrev_b32 v7, 5, v0
    v_lshlrev_b32 v7, 3, v7
    v_lshl_add_u32 v7, v0, 2, v7
    v_add_u32 v7, 48960, v7
    v_and_b32 v8, 0x1f0, v3
    v_and_b32 v9, 32, v1
    v_lshl_add_u32 v8, v9, 8, v8
    s_lshl_b32 s52, s2, 6
    s_lshl_b32 s53, s38, 9
    s_xor_b32 s52, s52, s53
    s_and_b32 s53, s52, 0x180
    v_xor_b32 v8, s53, v8
    s_and_b32 s52, s52, 0x1e00
    s_lshl_b32 s53, s2, 14
    s_add_u32 s52, s52, s53
    s_add_u32 s52, s52, 2621440
    s_xor_b32 s53, s52, 0x1000
    v_mov_b32 v27, v167
    v_mov_b32 v31, v167
C_NOGA:
    s_waitcnt lgkmcnt(0)
    s_barrier
    ds_read_b128 v[16:19], v20
    s_sub_u32 s45, s38, 0
    s_cmp_ge_u32 s45, 8
    s_cbranch_scc1 C_NOST
    ds_read_b32 v24, v7 offset:0
    ds_read_b32 v25, v7 offset:17408
    ds_read_b32 v26, v7 offset:34816
    ds_read_b32 v28, v7 offset:2176
    ds_read_b32 v29, v7 offset:19584
    ds_read_b32 v30, v7 offset:36992
    s_waitcnt lgkmcnt(3)
    v_xor_b32 v8, v19, v8
    buffer_store_dwordx4 v[24:27], v8, s[40:43], s52 offen sc1
    s_waitcnt lgkmcnt(0)
    buffer_store_dwordx4 v[28:31], v8, s[40:43], s53 offen sc1
C_NOST:
    s_waitcnt lgkmcnt(0)
    v_readfirstlane_b32 s0, v16
    v_readfirstlane_b32 s1, v17
    v_readfirstlane_b32 s22, v18
    s_cmp_ge_u32 s2, 176
    s_cbranch_scc1 FFN_LATE
    s_cmp_ge_u32 s2, 128
    s_cbranch_scc1 FINAL
    v_and_b32 v7, 7, v1
    v_lshrrev_b32 v8, 3, v1
    s_mul_i32 s44, s2, 18432
    s_mul_i32 s45, s38, 96
    v_mul_u32_u24 v9, 0xe0, v7
    v_mad_u32_u24 v9, v8, 12, v9
    v_add_u32 v9, s58, v9
    v_xor_b32 v10, 1, v8
    v_mad_u32_u24 v13, v10, 12, s58
    s_lshr_b32 s47, s2, 3
    s_and_b32 s48, s2, 3
    s_lshl2_add_u32 s47, s47, s48
    s_lshl_b32 s48, s38, 3
    s_xor_b32 s47, s47, s48
    s_and_b32 s47, s47, 63
    s_lshl_b32 s47, s47, 7
    v_xor_b32 v94, s47, v3
    v_lshl_add_u32 v94, v8, 15, v94
    s_and_b32 s47, s2, 4
    s_lshl_b32 s47, s47, 11
    s_cmp_lt_u32 s38, 6
    s_cselect_b32 s48, s1, s22
    s_xor_b32 s47, s47, s48
    s_lshl_b32 s48, s38, 18
    s_add_u32 s47, s47, s48
    s_add_u32 s23, s47, 2637824
    s_lshl_b32 s48, s38, 11
    s_add_u32 s47, s47, 2621440
    v_mul_u32_u24 v84, 48, v7
    v_bfe_u32 v10, v1, 3, 1
    v_lshl_add_u32 v84, v10, 2, v84
    s_lshl_b32 s49, s69, 3
    s_add_u32 s49, s49, s71
    s_add_u32 s49, s49, 14336
    v_add_u32 v84, s49, v84
    v_mul_u32_u24 v85, 48, v1
    v_add_u32 v85, 60992, v85
    s_mov_b32 exec_lo, 0xf0000f
    s_mov_b32 exec_hi, 0xf0000f00
    v_subrev_u32 v84, 1536, v84
    s_mov_b32 exec_lo, 0xff000000
    s_mov_b32 exec_hi, 0xff0000
    v_subrev_u32 v84, 768, v84
    s_mov_b32 exec_lo, 0xff00
    s_mov_b32 exec_hi, 0xff
    v_subrev_u32 v84, 2304, v84
    s_mov_b64 exec, -1
    s_add_u32 s48, s48, 0
    v_and_b32 v10, 6, v7
    v_xor_b32 v10, v10, v8
    v_lshl_add_u32 v10, v7, 3, v10
    v_lshl_add_u32 v86, v10, 4, s48
    v_and_b32 v10, 6, v8
    v_xor_b32 v10, v10, v1
    v_lshl_add_u32 v87, v10, 4, s48
    v_mul_u32_u24 v88, 2944, v8
    v_add_u32 v88, v88, v3
    s_mul_i32 s48, s2, 24576
    s_lshl_b32 s49, s38, 7
    s_add_u32 s48, s48, s49
    s_add_u32 s48, s48, 6291456
    v_mul_u32_u24 v89, 2336, v7
    v_mad_u32_u24 v89, v8, 12, v89
    s_add_u32 s45, s45, 24576
    v_add_u32 v89, s45, v89
    v_add_u32 v10, 1536, v0
    v_add_u32 v11, 0, v0
    v_mul_u32_u24 v11, 911, v11
    v_lshrrev_b32 v11, 16, v11
    v_add_lshl_u32 v90, v10, v11, 4
    v_add_u32 v10, 2304, v0
    v_add_u32 v11, 768, v0
    v_mul_u32_u24 v11, 911, v11
    v_lshrrev_b32 v11, 16, v11
    v_add_lshl_u32 v91, v10, v11, 4
    v_lshl_add_u32 v92, v0, 4, s44
    v_bfe_u32 v10, v1, 3, 1
    v_lshl_add_u32 v10, v7, 1, v10
    s_lshl_b32 s49, s2, 4
    v_add_u32 v93, s49, v10
    v_sub_u32 v12, 0x7ff, v93
    v_lshrrev_b32 v93, 4, v1
    v_mul_u32_u24 v93, 8192, v93
    v_lshl_add_u32 v93, v10, 2, v93
    s_mul_i32 s49, s2, 64
    s_add_u32 s49, s49, 65536
    s_add_u32 s59, s49, 32768
    v_mov_b32 v51, 0
    v_mov_b32 v55, 0
    v_mov_b32 v76, 0
    v_mov_b32 v56, 0
    v_mov_b32 v57, 0
    v_mov_b32 v58, 0
    v_mov_b32 v59, 0
    v_mov_b32 v60, 0
    v_mov_b32 v61, 0
    v_mov_b32 v62, 0
    v_mov_b32 v63, 0
    s_lshl_b32 s50, s2, 6
    s_lshl_b32 s51, s38, 2
    s_add_u32 s50, s50, s51
    s_add_u32 s50, s50, 8192
    s_mov_b32 s56, 0x00100001
    s_mov_b32 s57, 0x10000100
    s_mov_b32 s58, 0xffff0000
    s_waitcnt vmcnt(0)
    buffer_load_dwordx4 v[28:31], v94, s[40:43], s47 offen sc1
    buffer_load_dwordx4 v[32:35], v94, s[40:43], s23 offen sc1
    ds_read_b32 v24, v13 offset:1792
    ds_read_b32 v25, v13 offset:1796
    ds_read_b32 v26, v13 offset:1800
    ds_read2_b32 v[16:17], v9 offset0:0 offset1:1
    ds_read2_b32 v[18:19], v9 offset0:2 offset1:28
    ds_read2_b32 v[20:21], v9 offset0:29 offset1:30
    s_waitcnt lgkmcnt(0)
    v_dot2c_f32_bf16 v76, 0x3f803f80, v24
    v_dot2c_f32_bf16 v76, 0x3f803f80, v25
    v_dot2c_f32_bf16 v76, 0x3f803f80, v26
    v_lshlrev_b32 v36, 16, v16
    v_and_b32 v37, 0xffff0000, v16
    v_lshlrev_b32 v42, 16, v19
    v_and_b32 v43, 0xffff0000, v19
    v_lshlrev_b32 v38, 16, v17
    v_and_b32 v39, 0xffff0000, v17
    v_lshlrev_b32 v44, 16, v20
    v_and_b32 v45, 0xffff0000, v20
    v_lshlrev_b32 v40, 16, v18
    v_and_b32 v41, 0xffff0000, v18
    v_lshlrev_b32 v46, 16, v21
    v_and_b32 v47, 0xffff0000, v21
    v_mov_b32 v77, v76
    s_nop 1
    v_permlane16_swap_b32 v76, v77
    v_add_f32 v76, v76, v77
    v_mov_b32 v77, v76
    s_nop 1
    v_permlane32_swap_b32 v76, v77
    v_add_f32 v76, v76, v77
    s_mov_b32 exec_lo, 0xf00f0
    s_mov_b32 exec_hi, 0xf00f000
    ds_write2_b32 v84, v76, v76 offset0:0 offset1:96
    s_mov_b32 exec_lo, 0xf0f0f0f
    s_mov_b32 exec_hi, 0xf0f0f0f
    v_mov_b32 v24, 0x3f803f80
    v_mov_b32 v25, 0x3f803f80
    v_mov_b32 v26, 0x3f803f80
    s_mov_b32 exec_lo, 0x11111111
    s_mov_b32 exec_hi, 0x11111111
    v_mov_b32 v56, v24
    v_mov_b32 v57, v25
    v_mov_b32 v58, v26
    s_mov_b32 exec_lo, 0x22222222
    s_mov_b32 exec_hi, 0x22222222
    v_mov_b32 v60, v24
    v_mov_b32 v61, v25
    v_mov_b32 v62, v26
    s_mov_b64 exec, -1
    s_movk_i32 s60, 4000
    s_branch L_YP_W
L_YP:
    buffer_load_dwordx4 v[28:31], v94, s[40:43], s47 offen sc1
    buffer_load_dwordx4 v[32:35], v94, s[40:43], s23 offen sc1
L_YP_W:
    s_waitcnt vmcnt(0)
L_YP_C:
    v_xor_b32 v10, v167, v31
    v_xor_b32 v11, v167, v35
    v_or_b32 v10, v10, v11
    v_cmp_ne_u32 vcc, 0, v10
    s_nop 0
    s_and_b64 exec, exec, vcc
    s_cbranch_execz L_YP_D
    s_wqm_b64 exec, exec
    s_sub_u32 s60, s60, 1
    s_cmp_gt_i32 s60, 0
    s_sleep 1
    s_cbranch_scc1 L_YP
L_YP_D:
    s_mov_b64 exec, -1
    v_dot2c_f32_bf16 v36, s54, v28
    v_dot2c_f32_bf16 v37, s54, v29
    v_dot2c_f32_bf16 v38, s54, v30
    v_dot2c_f32_bf16 v39, s54, v34
    v_dot2c_f32_bf16 v40, s54, v32
    v_dot2c_f32_bf16 v41, s54, v33
    v_dot2c_f32_bf16 v42, s55, v28
    v_dot2c_f32_bf16 v43, s55, v29
    v_dot2c_f32_bf16 v44, s55, v30
    v_dot2c_f32_bf16 v45, s55, v34
    v_cvt_pk_bf16_f32 v48, v36, v37
    v_dot2c_f32_bf16 v46, s55, v32
    v_cvt_pk_bf16_f32 v49, v38, v39
    v_dot2c_f32_bf16 v47, s55, v33
    v_cvt_pk_bf16_f32 v50, v40, v41
    v_cvt_pk_bf16_f32 v52, v42, v43
    v_cvt_pk_bf16_f32 v53, v44, v45
    v_mfma_f32_16x16x32_bf16 v[68:71], v[48:51], v[48:51], 0
    v_cvt_pk_bf16_f32 v54, v46, v47
    v_mfma_f32_16x16x32_bf16 v[64:67], v[56:59], v[48:51], 0
    s_nop 0
    v_mfma_f32_16x16x32_bf16 v[64:67], v[60:63], v[52:55], v[64:67]
    v_mfma_f32_16x16x32_bf16 v[72:75], v[52:55], v[52:55], 0
    v_lshlrev_b32 v36, 16, v48
    v_and_b32 v37, 0xffff0000, v48
    v_lshlrev_b32 v38, 16, v49
    v_and_b32 v39, 0xffff0000, v49
    v_lshlrev_b32 v40, 16, v50
    v_and_b32 v41, 0xffff0000, v50
    s_mov_b64 exec, s[56:57]
    v_mov_b32 v64, v68
    v_mov_b32 v65, v72
    s_lshl_b64 exec, exec, 1
    v_mov_b32 v64, v69
    v_mov_b32 v65, v73
    s_lshl_b64 exec, exec, 1
    v_mov_b32 v64, v70
    v_mov_b32 v65, v74
    s_lshl_b64 exec, exec, 1
    v_mov_b32 v64, v71
    v_mov_b32 v65, v75
    s_mov_b32 exec_lo, 0xfff0ff0f
    s_mov_b32 exec_hi, 0xf0ff0fff
    ds_write2_b32 v84, v64, v65 offset0:0 offset1:96
    s_mov_b64 exec, -1
    v_lshlrev_b32 v42, 16, v52
    v_and_b32 v43, 0xffff0000, v52
    v_lshlrev_b32 v44, 16, v53
    v_and_b32 v45, 0xffff0000, v53
    v_lshlrev_b32 v46, 16, v54
    v_and_b32 v47, 0xffff0000, v54
    s_cmp_eq_u32 s38, 0
    s_cbranch_scc0 L_NP
    s_setprio 3
L_NP:
    s_waitcnt lgkmcnt(0)
    s_barrier
    ds_read_b128 v[52:55], v85 offset:0
    ds_read_b128 v[56:59], v85 offset:16
    ds_read_b128 v[60:63], v85 offset:17408
    ds_read_b128 v[64:67], v85 offset:17424
    ds_read_b128 v[68:71], v85 offset:34816
    ds_read_b128 v[72:75], v85 offset:34832
    s_waitcnt lgkmcnt(4)
    s_waitcnt lgkmcnt(2)
    v_pk_add_f32 v[52:53], v[52:53], v[60:61]
    v_pk_add_f32 v[54:55], v[54:55], v[62:63]
    v_pk_add_f32 v[56:57], v[56:57], v[64:65]
    v_pk_add_f32 v[58:59], v[58:59], v[66:67]
    s_waitcnt lgkmcnt(0)
    v_pk_add_f32 v[52:53], v[52:53], v[68:69]
    v_pk_add_f32 v[54:55], v[54:55], v[70:71]
    v_pk_add_f32 v[56:57], v[56:57], v[72:73]
    v_pk_add_f32 v[58:59], v[58:59], v[74:75]
    v_pk_add_f32 v[52:53], v[52:53], v[54:55]
    v_pk_add_f32 v[56:57], v[56:57], v[58:59]
    v_pk_add_f32 v[52:53], v[52:53], v[56:57]
    v_add_f32 v76, v52, v53
    v_add_f32 v78, v52, v53
    s_nop 1
    v_permlane16_swap_b32 v76, v78
    v_mov_b32 v77, v76
    v_mov_b32 v13, v78
    s_nop 0
    v_permlane32_swap_b32 v76, v77
    v_permlane32_swap_b32 v78, v13
    v_mul_f32 v76, 0x3ae38e39, v76
    v_mul_f32 v78, 0x3ae38e39, v78
    v_fma_f32 v78, -v76, v76, v78
    v_max_f32 v78, 0, v78
    v_cvt_pk_bf16_f32 v78, v76, v78
    v_and_b32 v82, 0xffff0000, v78
    v_lshlrev_b32 v80, 16, v78
    v_add_f32 v82, 0x3727c5ac, v82
    v_lshlrev_b32 v81, 16, v78
    v_cvt_pk_bf16_f32 v82, v82, v82
    v_lshlrev_b32 v82, 16, v82
    v_sqrt_f32 v82, v82
    v_fma_f32 v77, -v80, v13, v77
    v_cvt_pk_bf16_f32 v82, v82, v82
    v_lshlrev_b32 v82, 16, v82
    v_rcp_f32 v83, v82
    v_rcp_f32 v82, v82
    s_cbranch_scc0 L_NK
    v_mul_f32 v77, v77, v83
    v_cvt_pk_bf16_f32 v77, v77, v77
    v_ashrrev_i32 v76, 31, v77
    v_or_b32 v76, 0x80000000, v76
    v_xor_b32 v76, v76, v77
    v_and_or_b32 v76, v76, s58, v12
    buffer_store_dword v76, v93, s[40:43], s49 offen sc1
    buffer_store_dword v76, v93, s[40:43], s59 offen sc1
    s_setprio 0
L_NK:
    v_mov_b32_dpp v80, v80 row_ror:8 row_mask:0xf bank_mask:0xc
    v_mov_b32_dpp v81, v81 row_ror:8 row_mask:0xf bank_mask:0x3
    v_mov_b32_dpp v82, v82 row_ror:8 row_mask:0xf bank_mask:0xc
    v_mov_b32_dpp v83, v83 row_ror:8 row_mask:0xf bank_mask:0x3
    v_pk_add_f32 v[56:57], v[36:37], v[80:81] op_sel_hi:[1,0] neg_lo:[0,1] neg_hi:[0,1]
    v_pk_add_f32 v[58:59], v[38:39], v[80:81] op_sel_hi:[1,0] neg_lo:[0,1] neg_hi:[0,1]
    v_pk_add_f32 v[60:61], v[40:41], v[80:81] op_sel_hi:[1,0] neg_lo:[0,1] neg_hi:[0,1]
    v_pk_add_f32 v[62:63], v[42:43], v[80:81] op_sel:[0,1] neg_lo:[0,1] neg_hi:[0,1]
    v_pk_add_f32 v[64:65], v[44:45], v[80:81] op_sel:[0,1] neg_lo:[0,1] neg_hi:[0,1]
    v_pk_add_f32 v[66:67], v[46:47], v[80:81] op_sel:[0,1] neg_lo:[0,1] neg_hi:[0,1]
    v_cvt_pk_bf16_f32 v57, v56, v57
    v_cvt_pk_bf16_f32 v59, v58, v59
    v_cvt_pk_bf16_f32 v61, v60, v61
    v_cvt_pk_bf16_f32 v63, v62, v63
    v_cvt_pk_bf16_f32 v65, v64, v65
    v_cvt_pk_bf16_f32 v67, v66, v67
    v_lshlrev_b32 v56, 16, v57
    v_and_b32 v57, 0xffff0000, v57
    v_lshlrev_b32 v58, 16, v59
    v_and_b32 v59, 0xffff0000, v59
    v_lshlrev_b32 v60, 16, v61
    v_and_b32 v61, 0xffff0000, v61
    v_lshlrev_b32 v62, 16, v63
    v_and_b32 v63, 0xffff0000, v63
    v_lshlrev_b32 v64, 16, v65
    v_and_b32 v65, 0xffff0000, v65
    v_lshlrev_b32 v66, 16, v67
    v_and_b32 v67, 0xffff0000, v67
    v_pk_mul_f32 v[56:57], v[56:57], v[82:83] op_sel_hi:[1,0]
    v_pk_mul_f32 v[58:59], v[58:59], v[82:83] op_sel_hi:[1,0]
    v_pk_mul_f32 v[60:61], v[60:61], v[82:83] op_sel_hi:[1,0]
    v_pk_mul_f32 v[62:63], v[62:63], v[82:83] op_sel:[0,1]
    v_pk_mul_f32 v[64:65], v[64:65], v[82:83] op_sel:[0,1]
    v_pk_mul_f32 v[66:67], v[66:67], v[82:83] op_sel:[0,1]
    v_cvt_pk_bf16_f32 v28, v56, v57
    v_cvt_pk_bf16_f32 v29, v58, v59
    v_cvt_pk_bf16_f32 v30, v60, v61
    ds_write_b128 v86, v[28:31]
    v_cvt_pk_bf16_f32 v32, v62, v63
    v_cvt_pk_bf16_f32 v33, v64, v65
    v_cvt_pk_bf16_f32 v34, v66, v67
    ds_write_b128 v86, v[32:35] offset:1024
    ds_read_b128 v[56:59], v87
    ds_read_b128 v[60:63], v87 offset:1024
    v_dot2c_f32_bf16 v36, s54, v28
    v_dot2c_f32_bf16 v37, s55, v28
    v_dot2c_f32_bf16 v38, s54, v29
    v_dot2c_f32_bf16 v39, s55, v29
    v_dot2c_f32_bf16 v40, s54, v30
    v_dot2c_f32_bf16 v41, s55, v30
    v_dot2c_f32_bf16 v42, s54, v32
    v_dot2c_f32_bf16 v43, s55, v32
    v_dot2c_f32_bf16 v44, s54, v33
    v_dot2c_f32_bf16 v45, s55, v33
    v_dot2c_f32_bf16 v46, s54, v34
    v_dot2c_f32_bf16 v47, s55, v34
    s_waitcnt lgkmcnt(1)
    buffer_store_dwordx4 v[56:59], v88, s[40:43], s48 offen sc1
    s_waitcnt lgkmcnt(0)
    buffer_store_dwordx4 v[60:63], v88, s[40:43], s48 offen offset:1536 sc1
    v_cvt_pk_bf16_f32 v48, v36, v37
    v_cvt_pk_bf16_f32 v49, v38, v39
    v_cvt_pk_bf16_f32 v50, v40, v41
    v_cvt_pk_bf16_f32 v51, v42, v43
    v_cvt_pk_bf16_f32 v52, v44, v45
    v_cvt_pk_bf16_f32 v53, v46, v47
    v_add_u32 v10, 1168, v89
    ds_write2_b32 v89, v48, v49 offset0:0 offset1:1
    ds_write_b32 v89, v50 offset:8
    ds_write2_b32 v10, v51, v52 offset0:0 offset1:1
    ds_write_b32 v10, v53 offset:8
    v_add_u32 v11, 12288, v92
    s_waitcnt lgkmcnt(0)
    s_barrier
    ds_read_b128 v[16:19], v90
    ds_read_b128 v[20:23], v91
    v_mov_b32 v10, 0
    s_waitcnt lgkmcnt(1)
    global_store_dwordx4 v92, v[16:19], s[32:33] sc1
    s_cmp_ge_u32 s38, 6
    s_cbranch_scc1 L_O1
    s_waitcnt lgkmcnt(0)
    global_store_dwordx4 v11, v[20:23], s[32:33] sc1
L_O1:
    s_cmp_eq_u32 s38, 11
    s_cbranch_scc1 TOP8
    s_waitcnt vmcnt(0)
    s_mov_b64 exec, 0x1
    buffer_store_dword v167, v10, s[40:43], s50 offen sc1
    s_mov_b64 exec, -1
    s_branch END
FFN_DMA0:
    s_sub_u32 s58, s2, 192
    s_and_b32 s61, s58, 7
    s_lshr_b32 s59, s58, 3
    s_lshl3_add_u32 s61, s61, s59
    s_lshl_b32 s61, s61, 1
    s_mov_b32 s59, 8
    s_mov_b32 s57, 73728
    s_add_u32 s56, s38, 1
    s_bfe_u32 s50, s56, 0x10003
    s_and_b32 s51, s56, 1
    s_bfe_u32 s52, s56, 0x10001
    s_mul_i32 s52, s52, 36
    s_add_u32 s52, s52, s51
    s_mul_i32 s48, s52, 73728
    s_lshl_b32 s53, s61, 6
    s_add_u32 s48, s48, s53
    s_lshl_b32 s49, s52, 10
    s_mul_i32 s53, s50, 73728
    s_add_u32 s49, s49, s53
    s_lshl_b32 s51, s51, 1
    s_lshl_b32 s53, s50, 2
    s_or_b32 s51, s51, s53
    v_bfe_u32 v2, v1, 4, 1
    v_and_b32 v4, 7, v1
    v_xor_b32 v2, v2, v4
    v_xor_b32 v2, s51, v2
    v_lshrrev_b32 v4, 3, v1
    v_mul_u32_u24 v4, 0x2400, v4
    v_lshl_add_u32 v2, v2, 4, v4
    s_mov_b32 s46, 5308416
    s_mov_b32 s47, 0x00020000
    s_waitcnt lgkmcnt(0)
    s_cmp_eq_u32 s50, 0
    s_cselect_b32 s44, s26, s28
    s_cselect_b32 s45, s27, s29
    s_mov_b32 s40, s36
    s_mov_b32 s41, s37
    s_barrier
    s_sub_u32 s51, s38, 3
    s_cmp_ge_u32 s51, 8
    s_cbranch_scc1 F_B0
    s_add_u32 m0, s49, 0
    s_add_u32 s53, s48, 0
    buffer_load_dwordx4 v2, s[44:47], s53 offen lds
    s_add_u32 m0, s49, 2048
    s_add_u32 s53, s48, 147456
    buffer_load_dwordx4 v2, s[44:47], s53 offen lds
    s_barrier
    s_branch F_B2
FFN_LATE:
    s_and_b32 s61, s2, 7
    s_lshl_b32 s61, s61, 1
    s_bitcmp0_b32 s2, 3
    s_addc_u32 s61, s61, 128
    s_sub_u32 s58, s2, 112
    s_mov_b32 s59, 4
    s_mov_b32 s57, 0
    v_mov_b32 v32, 0
    v_mov_b32 v33, 0
    v_mov_b32 v34, 0
    v_mov_b32 v35, 0
    v_mov_b32 v36, 0
    v_mov_b32 v37, 0
    v_mov_b32 v38, 0
    v_mov_b32 v39, 0
    v_mov_b32 v40, 0
    v_mov_b32 v41, 0
    v_mov_b32 v42, 0
    v_mov_b32 v43, 0
    v_mov_b32 v44, 0
    v_mov_b32 v45, 0
    v_mov_b32 v46, 0
    v_mov_b32 v47, 0
    s_sub_u32 s51, s38, 3
    s_cmp_ge_u32 s51, 8
    s_cbranch_scc1 F_B0
    s_add_u32 s56, s38, 1
    s_bfe_u32 s50, s56, 0x10003
    s_and_b32 s51, s56, 1
    s_bfe_u32 s52, s56, 0x10001
    s_lshl1_add_u32 s52, s50, s52
    s_mul_i32 s52, s52, 18
    s_add_u32 s52, s52, s51
    s_mul_i32 s48, s52, 73728
    s_lshl_b32 s53, s61, 6
    s_add_u32 s48, s48, s53
    s_lshl_b32 m0, s52, 10
    s_lshl_b32 s51, s51, 1
    s_add_u32 s44, s26, s48
    s_addc_u32 s45, s27, 0
    s_add_u32 s46, s28, s48
    s_addc_u32 s47, s29, 0
    v_bfe_u32 v2, v1, 4, 1
    v_xor_b32 v2, v2, v1
    v_xor_b32 v2, s51, v2
    v_and_b32 v2, 3, v2
    v_lshrrev_b32 v4, 3, v1
    v_mul_u32_u24 v4, 0x2400, v4
    v_lshl_add_u32 v2, v2, 4, v4
    v_mov_b32 v4, s44
    v_mov_b32 v5, s45
    s_mov_b32 exec_lo, 0xf0f0f0f0
    s_mov_b32 exec_hi, 0xf0f0f0f0
    v_mov_b32 v4, s46
    v_mov_b32 v5, s47
    s_mov_b64 exec, -1
    v_add_co_u32 v4, vcc, v4, v2
    s_nop 1
    v_addc_co_u32 v5, vcc, 0, v5, vcc
    s_barrier
    global_load_lds_dwordx4 v[4:5], off
    v_add_co_u32 v4, vcc, 147456, v4
    s_add_u32 m0, m0, 2048
    s_nop 0
    v_addc_co_u32 v5, vcc, 0, v5, vcc
    global_load_lds_dwordx4 v[4:5], off
    v_add_co_u32 v4, vcc, 147456, v4
    s_add_u32 m0, m0, 2048
    s_nop 0
    v_addc_co_u32 v5, vcc, 0, v5, vcc
    global_load_lds_dwordx4 v[4:5], off
    v_add_co_u32 v4, vcc, 147456, v4
    s_add_u32 m0, m0, 2048
    s_nop 0
    v_addc_co_u32 v5, vcc, 0, v5, vcc
    global_load_lds_dwordx4 v[4:5], off
    v_add_co_u32 v4, vcc, 147456, v4
    s_add_u32 m0, m0, 2048
    s_nop 0
    v_addc_co_u32 v5, vcc, 0, v5, vcc
    global_load_lds_dwordx4 v[4:5], off
    v_add_co_u32 v4, vcc, 147456, v4
    s_add_u32 m0, m0, 2048
    s_nop 0
    v_addc_co_u32 v5, vcc, 0, v5, vcc
    global_load_lds_dwordx4 v[4:5], off
    v_add_co_u32 v4, vcc, 147456, v4
    s_add_u32 m0, m0, 2048
    s_nop 0
    v_addc_co_u32 v5, vcc, 0, v5, vcc
    global_load_lds_dwordx4 v[4:5], off
    v_add_co_u32 v4, vcc, 147456, v4
    s_add_u32 m0, m0, 2048
    s_nop 0
    v_addc_co_u32 v5, vcc, 0, v5, vcc
    global_load_lds_dwordx4 v[4:5], off
    v_add_co_u32 v4, vcc, 147456, v4
    s_add_u32 m0, m0, 2048
    s_nop 0
    v_addc_co_u32 v5, vcc, 0, v5, vcc
    global_load_lds_dwordx4 v[4:5], off
    s_branch F_W
F_L2:
    s_sub_u32 s51, s38, 3
    s_cmp_ge_u32 s51, 8
    s_cbranch_scc1 F_B0
    s_add_u32 s56, s38, 1
    s_bfe_u32 s50, s56, 0x10003
    s_and_b32 s51, s56, 1
    s_bfe_u32 s52, s56, 0x10001
    s_mul_i32 s52, s52, 36
    s_add_u32 s52, s52, s51
    s_mul_i32 s48, s52, 73728
    s_lshl_b32 s53, s61, 6
    s_add_u32 s48, s48, s53
    s_lshl_b32 s49, s52, 10
    s_mul_i32 s53, s50, 73728
    s_add_u32 s49, s49, s53
    s_lshl_b32 s51, s51, 1
    s_lshl_b32 s53, s50, 2
    s_or_b32 s51, s51, s53
    v_bfe_u32 v2, v1, 4, 1
    v_and_b32 v4, 7, v1
    v_xor_b32 v2, v2, v4
    v_xor_b32 v2, s51, v2
    v_lshrrev_b32 v4, 3, v1
    v_mul_u32_u24 v4, 0x2400, v4
    v_lshl_add_u32 v2, v2, 4, v4
    s_mov_b32 s46, 5308416
    s_mov_b32 s47, 0x00020000
    s_cmp_eq_u32 s50, 0
    s_cselect_b32 s44, s26, s28
    s_cselect_b32 s45, s27, s29
    s_barrier
    s_add_u32 m0, s49, 0
    s_add_u32 s53, s48, 0
    buffer_load_dwordx4 v2, s[44:47], s53 offen lds
    s_add_u32 m0, s49, 2048
    s_add_u32 s53, s48, 147456
    buffer_load_dwordx4 v2, s[44:47], s53 offen lds
F_B2:
    s_add_u32 m0, s49, 4096
    s_add_u32 s53, s48, 294912
    buffer_load_dwordx4 v2, s[44:47], s53 offen lds
    s_add_u32 m0, s49, 6144
    s_add_u32 s53, s48, 442368
    buffer_load_dwordx4 v2, s[44:47], s53 offen lds
    s_add_u32 m0, s49, 8192
    s_add_u32 s53, s48, 589824
    buffer_load_dwordx4 v2, s[44:47], s53 offen lds
    s_add_u32 m0, s49, 10240
    s_add_u32 s53, s48, 737280
    buffer_load_dwordx4 v2, s[44:47], s53 offen lds
    s_add_u32 m0, s49, 12288
    s_add_u32 s53, s48, 884736
    buffer_load_dwordx4 v2, s[44:47], s53 offen lds
    s_add_u32 m0, s49, 14336
    s_add_u32 s53, s48, 1032192
    buffer_load_dwordx4 v2, s[44:47], s53 offen lds
    s_add_u32 m0, s49, 16384
    s_add_u32 s53, s48, 1179648
    buffer_load_dwordx4 v2, s[44:47], s53 offen lds
    s_add_u32 m0, s49, 18432
    s_add_u32 s53, s48, 1327104
    buffer_load_dwordx4 v2, s[44:47], s53 offen lds
    s_add_u32 m0, s49, 20480
    s_add_u32 s53, s48, 1474560
    buffer_load_dwordx4 v2, s[44:47], s53 offen lds
    s_add_u32 m0, s49, 22528
    s_add_u32 s53, s48, 1622016
    buffer_load_dwordx4 v2, s[44:47], s53 offen lds
    s_add_u32 m0, s49, 24576
    s_add_u32 s53, s48, 1769472
    buffer_load_dwordx4 v2, s[44:47], s53 offen lds
    s_add_u32 m0, s49, 26624
    s_add_u32 s53, s48, 1916928
    buffer_load_dwordx4 v2, s[44:47], s53 offen lds
    s_add_u32 m0, s49, 28672
    s_add_u32 s53, s48, 2064384
    buffer_load_dwordx4 v2, s[44:47], s53 offen lds
    s_add_u32 m0, s49, 30720
    s_add_u32 s53, s48, 2211840
    buffer_load_dwordx4 v2, s[44:47], s53 offen lds
    s_add_u32 m0, s49, 32768
    s_add_u32 s53, s48, 2359296
    buffer_load_dwordx4 v2, s[44:47], s53 offen lds
    s_add_u32 m0, s49, 34816
    s_add_u32 s53, s48, 2506752
    buffer_load_dwordx4 v2, s[44:47], s53 offen lds
    s_branch F_W
FFN_DMA:
    s_setprio 0
    s_sub_u32 s58, s2, 192
    s_and_b32 s61, s58, 7
    s_lshr_b32 s59, s58, 3
    s_lshl3_add_u32 s61, s61, s59
    s_lshl_b32 s61, s61, 1
    s_mov_b32 s59, 8
    s_mov_b32 s57, 73728
    s_waitcnt vmcnt(0)
    s_branch F_L2
F_B0:
    s_setprio 3
    s_sub_u32 s52, s2, 192
    s_and_b32 s53, s52, 0xffffffe7
    s_xor_b32 s54, s38, 11
    s_or_b32 s53, s53, s54
    s_cbranch_scc1 F_NM
    s_cmp_eq_u32 s52, 24
    s_cbranch_scc1 F_NM
    s_lshl_b32 s53, s52, 18
    s_cmp_eq_u32 s52, 16
    s_cselect_b32 s53, 5767168, s53
    s_add_u32 s53, s53, 16384
    s_add_u32 s54, s53, 8192
    v_mov_b32 v10, 0
    v_mov_b32 v11, 161416
    s_mov_b64 exec, 0x1
    s_mov_b32 s62, -1
    s_movk_i32 s60, 8
F_ML:
    s_xor_b32 s53, s53, 0x2000
    s_xor_b32 s54, s54, 0x2000
    buffer_store_dword v10, v10, s[40:43], s53 offen offset:0 sc1
    buffer_store_dword v10, v10, s[40:43], s54 offen offset:0 sc1
    v_add_u32 v10, 0x80, v10
    s_waitcnt vmcnt(1)
    s_memtime s[64:65]
    s_waitcnt vmcnt(0)
    s_memtime s[66:67]
    s_sub_u32 s60, s60, 1
    s_cselect_b32 s62, 0, s62
    s_waitcnt lgkmcnt(0)
    s_sub_u32 s64, s66, s64
    s_cmp_lt_u32 s64, s62
    s_movk_i32 s62, 64
    s_cbranch_scc1 F_ML
    v_mov_b32 v10, 0
    s_bitcmp1_b32 s53, 13
    s_cselect_b32 s53, 0x2000, 0
    s_movk_i32 s60, 4000
    s_mov_b32 exec_lo, 0xffffffff
    s_mov_b32 exec_hi, 0x0
    v_lshlrev_b32 v10, 7, v1
F_MT:
    ds_read_b64 v[12:13], v11
    s_sub_u32 s60, s60, 1
    s_cmp_gt_i32 s60, 0
    s_waitcnt lgkmcnt(0)
    v_readfirstlane_b32 s54, v12
    s_nop 0
    s_cselect_b32 s54, s54, 1
    s_cmp_lg_u32 s54, 1
    s_cbranch_scc1 F_MT
    v_and_b32 v13, 0xffffdfff, v13
    v_or_b32 v13, s53, v13
    buffer_store_dword v13, v10, s[40:43], s52 offen offset:2048 sc1
    s_mov_b64 exec, -1
F_NM:
    s_barrier
F_W:
    s_mov_b64 exec, -1
    v_mov_b32 v167, 161420
    ds_read_b32 v167, v167
    v_and_b32 v7, 7, v1
    v_lshrrev_b32 v8, 3, v1
    v_and_b32 v5, 15, v1
    v_lshrrev_b32 v6, 4, v1
    s_mul_i32 s52, s61, 36864
    s_mul_i32 s53, s38, 96
    s_add_u32 s52, s52, s53
    v_mul_u32_u24 v9, 0x480, v8
    v_mad_u32_u24 v9, v7, 12, v9
    v_add_u32 v9, s52, v9
    global_load_dwordx3 v[16:18], v9, s[30:31]
    v_add_u32 v9, 0x2400, v9
    global_load_dwordx3 v[20:22], v9, s[30:31]
    v_add_u32 v9, 0x2400, v9
    global_load_dwordx3 v[24:26], v9, s[30:31]
    v_add_u32 v9, 0x2400, v9
    global_load_dwordx3 v[28:30], v9, s[30:31]
    v_add_u32 v9, 0x2400, v9
    s_cmp_eq_u32 s59, 4
    s_cbranch_scc1 F_W4
    global_load_dwordx3 v[32:34], v9, s[30:31]
    v_add_u32 v9, 0x2400, v9
    global_load_dwordx3 v[36:38], v9, s[30:31]
    v_add_u32 v9, 0x2400, v9
    global_load_dwordx3 v[40:42], v9, s[30:31]
    v_add_u32 v9, 0x2400, v9
    global_load_dwordx3 v[44:46], v9, s[30:31]
F_W4:
    v_mul_u32_u24 v10, 683, v0
    v_lshrrev_b32 v10, 16, v10
    v_mul_u32_u24 v11, 0x60, v10
    v_sub_u32 v11, v0, v11
    s_mov_b32 s52, 161920
    v_lshl_add_u32 v160, v10, 2, s52
    v_and_b32 v63, 4, v10
    v_lshl_add_u32 v160, v63, 2, v160
    v_mov_b32 v63, 161492
    s_mov_b32 s52, 3144192
    v_lshl_add_u32 v161, v11, 4, s52
    v_mul_u32_u24 v162, 608, v10
    v_mad_u32_u24 v162, v11, 6, v162
    v_and_b32 v11, 1, v11
    v_mul_u32_u24 v11, 4862, v11
    v_sub_u32 v2, v162, v11
    v_add_u32 v2, 152320, v2
    v_add_u32 v162, 147456, v162
    v_add_u32 v162, v11, v162
    v_mul_u32_u24 v163, 608, v5
    v_lshl_add_u32 v163, v6, 4, v163
    v_add_u32 v163, 147456, v163
    s_lshr_b32 s52, s38, 2
    s_lshl_b32 s52, s52, 10
    s_and_b32 s53, s38, 3
    s_lshl_b32 s53, s53, 2
    s_add_u32 s52, s52, s53
    s_add_u32 s52, s52, 157184
    v_add_u32 v164, s52, v3
    v_mov_b32 v10, 0
    ds_write_b32 v164, v10
    v_add_u32 v60, 157184, v3
    v_xor_b32 v61, 0x80, v60
    v_and_b32 v10, 6, v1
    v_and_b32 v11, 9, v1
    v_lshl_add_u32 v164, v10, 7, s52
    v_lshl_add_u32 v164, v11, 1, v164
    v_and_b32 v10, 16, v1
    v_and_b32 v11, 32, v1
    v_lshl_add_u32 v164, v10, 2, v164
    v_add_u32 v164, v11, v164
    v_and_b32 v10, 1, v6
    v_mul_u32_u24 v10, 0x48, v10
    v_and_b32 v11, 1, v8
    v_add3_u32 v166, v10, v11, 2
    v_lshl_add_u32 v10, v11, 2, v10
    v_lshrrev_b32 v11, 1, v6
    v_add_u32 v165, v10, v11
    s_mul_i32 s62, s38, 6
    s_cmp_lt_u32 s58, 64
    s_cselect_b32 s53, 13, 11
    s_cselect_b32 s54, 14, 11
    v_add_u32 v165, s62, v165
    v_and_b32 v10, 3, v165
    v_lshlrev_b32 v10, s54, v10
    v_lshl_add_u32 v10, v7, 4, v10
    v_and_b32 v11, 4, v165
    v_lshl_add_u32 v10, v11, 11, v10
    v_and_b32 v165, 0xf8, v165
    v_lshl_add_u32 v165, v165, s53, v10
    v_add_u32 v166, s62, v166
    v_and_b32 v10, 3, v166
    v_lshlrev_b32 v10, s54, v10
    v_lshl_add_u32 v10, v7, 4, v10
    v_and_b32 v11, 4, v166
    v_lshl_add_u32 v10, v11, 11, v10
    v_and_b32 v166, 0xf8, v166
    v_lshl_add_u32 v166, v166, s53, v10
    s_cselect_b32 s62, 0, 1171456
    s_lshl_b32 s53, s58, 7
    s_add_u32 s62, s62, s53
    s_add_u32 s62, s62, 262144
    s_mov_b32 s63, 6291456
    s_movk_i32 s64, -1536
    v_bfe_u32 v10, v1, 1, 1
    v_bfe_u32 v11, v1, 3, 2
    v_lshl_add_u32 v11, v10, 2, v11
    v_xor_b32 v11, s38, v11
    v_mul_u32_u24 v12, s57, v10
    v_lshl_add_u32 v12, v11, 4, v12
    v_and_b32 v10, 1, v1
    v_lshl_add_u32 v12, v10, 3, v12
    v_bfe_u32 v10, v1, 2, 2
    v_lshl_add_u32 v10, v6, 3, v10
    v_lshl_add_u32 v12, v10, 7, v12
    v_add_u32 v13, 36864, v12
    v_mov_b32 v14, 161488
    v_mov_b32 v15, 1
    s_mov_b32 s52, 0x05040100
    s_mov_b32 s53, 0x07060302
    v_mov_b32 v10, s52
    v_mov_b32 v4, 0x05040c0c
    v_mov_b32 v5, 0x01000c0c
    v_mov_b32 v6, 0x44444444
    s_mov_b32 exec_lo, 0xff00ff00
    s_mov_b32 exec_hi, 0xff00ff00
    v_mov_b32 v10, 0x03020706
    v_mov_b32 v4, 0x03020c0c
    v_mov_b32 v5, 0x07060c0c
    v_mov_b32 v6, 0xeeeeeeee
    s_mov_b64 exec, -1
    s_waitcnt lgkmcnt(0)
    v_readfirstlane_b32 s39, v167
    s_cmp_eq_u32 s59, 4
    s_cbranch_scc0 F_W8
    s_waitcnt vmcnt(0)
F_W8:
    s_sub_u32 s51, s38, 3
    s_cmp_ge_u32 s51, 8
    s_cbranch_scc1 F_NC
    s_waitcnt vmcnt(8)
    s_mov_b64 exec, 0x1
    ds_add_u32 v14, v15
    s_mov_b64 exec, -1
F_NC:
    s_waitcnt vmcnt(7)
    v_mov_b32 v19, v16
    v_mov_b32_dpp v11, v17 row_ror:8 row_mask:0xf bank_mask:0xf
    v_mov_b32_dpp v16, v18 row_ror:8 row_mask:0xf bank_mask:0xc
    v_mov_b32_dpp v18, v19 row_ror:8 row_mask:0xf bank_mask:0x3
    v_perm_b32 v152, v11, v17, v10
    v_perm_b32 v136, v18, v16, s52
    v_perm_b32 v144, v18, v16, s53
    s_waitcnt vmcnt(6)
    v_mov_b32 v23, v20
    v_mov_b32_dpp v11, v21 row_ror:8 row_mask:0xf bank_mask:0xf
    v_mov_b32_dpp v20, v22 row_ror:8 row_mask:0xf bank_mask:0xc
    v_mov_b32_dpp v22, v23 row_ror:8 row_mask:0xf bank_mask:0x3
    v_perm_b32 v153, v11, v21, v10
    v_perm_b32 v137, v22, v20, s52
    v_perm_b32 v145, v22, v20, s53
    s_waitcnt vmcnt(5)
    v_mov_b32 v27, v24
    v_mov_b32_dpp v11, v25 row_ror:8 row_mask:0xf bank_mask:0xf
    v_mov_b32_dpp v24, v26 row_ror:8 row_mask:0xf bank_mask:0xc
    v_mov_b32_dpp v26, v27 row_ror:8 row_mask:0xf bank_mask:0x3
    v_perm_b32 v154, v11, v25, v10
    v_perm_b32 v138, v26, v24, s52
    v_perm_b32 v146, v26, v24, s53
    s_waitcnt vmcnt(4)
    v_mov_b32 v31, v28
    v_mov_b32_dpp v11, v29 row_ror:8 row_mask:0xf bank_mask:0xf
    v_mov_b32_dpp v28, v30 row_ror:8 row_mask:0xf bank_mask:0xc
    v_mov_b32_dpp v30, v31 row_ror:8 row_mask:0xf bank_mask:0x3
    v_perm_b32 v155, v11, v29, v10
    v_perm_b32 v139, v30, v28, s52
    v_perm_b32 v147, v30, v28, s53
    s_waitcnt vmcnt(3)
    v_mov_b32 v35, v32
    v_mov_b32_dpp v11, v33 row_ror:8 row_mask:0xf bank_mask:0xf
    v_mov_b32_dpp v32, v34 row_ror:8 row_mask:0xf bank_mask:0xc
    v_mov_b32_dpp v34, v35 row_ror:8 row_mask:0xf bank_mask:0x3
    v_perm_b32 v156, v11, v33, v10
    v_perm_b32 v140, v34, v32, s52
    v_perm_b32 v148, v34, v32, s53
    s_waitcnt vmcnt(2)
    v_mov_b32 v39, v36
    v_mov_b32_dpp v11, v37 row_ror:8 row_mask:0xf bank_mask:0xf
    v_mov_b32_dpp v36, v38 row_ror:8 row_mask:0xf bank_mask:0xc
    v_mov_b32_dpp v38, v39 row_ror:8 row_mask:0xf bank_mask:0x3
    v_perm_b32 v157, v11, v37, v10
    v_perm_b32 v141, v38, v36, s52
    v_perm_b32 v149, v38, v36, s53
    s_waitcnt vmcnt(1)
    v_mov_b32 v43, v40
    v_mov_b32_dpp v11, v41 row_ror:8 row_mask:0xf bank_mask:0xf
    v_mov_b32_dpp v40, v42 row_ror:8 row_mask:0xf bank_mask:0xc
    v_mov_b32_dpp v42, v43 row_ror:8 row_mask:0xf bank_mask:0x3
    v_perm_b32 v158, v11, v41, v10
    v_perm_b32 v142, v42, v40, s52
    v_perm_b32 v150, v42, v40, s53
    s_waitcnt vmcnt(0)
    v_mov_b32 v47, v44
    v_mov_b32_dpp v11, v45 row_ror:8 row_mask:0xf bank_mask:0xf
    v_mov_b32_dpp v44, v46 row_ror:8 row_mask:0xf bank_mask:0xc
    v_mov_b32_dpp v46, v47 row_ror:8 row_mask:0xf bank_mask:0x3
    v_perm_b32 v159, v11, v45, v10
    v_perm_b32 v143, v46, v44, s52
    v_perm_b32 v151, v46, v44, s53
    s_cmp_ge_u32 s38, s59
    s_cbranch_scc1 F_NT
    s_movk_i32 s60, 4000
F_CP:
    ds_read_b32 v15, v14
    s_sub_u32 s60, s60, 1
    s_cmp_gt_i32 s60, 0
    s_waitcnt lgkmcnt(0)
    v_readfirstlane_b32 s52, v15
    s_nop 0
    s_cselect_b32 s52, s52, 8
    s_cmp_eq_u32 s52, 8
    s_cbranch_scc1 F_CD
    s_sleep 2
    s_branch F_CP
F_CD:
    ds_read_b64_tr_b16 v[64:65], v12 offset:0
    ds_read_b64_tr_b16 v[66:67], v12 offset:512
    ds_read_b64_tr_b16 v[68:69], v12 offset:4096
    ds_read_b64_tr_b16 v[70:71], v12 offset:4608
    ds_read_b64_tr_b16 v[72:73], v12 offset:8192
    ds_read_b64_tr_b16 v[74:75], v12 offset:8704
    ds_read_b64_tr_b16 v[76:77], v12 offset:12288
    ds_read_b64_tr_b16 v[78:79], v12 offset:12800
    ds_read_b64_tr_b16 v[80:81], v12 offset:16384
    ds_read_b64_tr_b16 v[82:83], v12 offset:16896
    ds_read_b64_tr_b16 v[84:85], v12 offset:20480
    ds_read_b64_tr_b16 v[86:87], v12 offset:20992
    ds_read_b64_tr_b16 v[88:89], v12 offset:24576
    ds_read_b64_tr_b16 v[90:91], v12 offset:25088
    ds_read_b64_tr_b16 v[92:93], v12 offset:28672
    ds_read_b64_tr_b16 v[94:95], v12 offset:29184
    ds_read_b64_tr_b16 v[96:97], v12 offset:32768
    ds_read_b64_tr_b16 v[98:99], v12 offset:33280
    ds_read_b64_tr_b16 v[100:101], v13 offset:0
    ds_read_b64_tr_b16 v[102:103], v13 offset:512
    ds_read_b64_tr_b16 v[104:105], v13 offset:4096
    ds_read_b64_tr_b16 v[106:107], v13 offset:4608
    ds_read_b64_tr_b16 v[108:109], v13 offset:8192
    ds_read_b64_tr_b16 v[110:111], v13 offset:8704
    ds_read_b64_tr_b16 v[112:113], v13 offset:12288
    ds_read_b64_tr_b16 v[114:115], v13 offset:12800
    ds_read_b64_tr_b16 v[116:117], v13 offset:16384
    ds_read_b64_tr_b16 v[118:119], v13 offset:16896
    ds_read_b64_tr_b16 v[120:121], v13 offset:20480
    ds_read_b64_tr_b16 v[122:123], v13 offset:20992
    ds_read_b64_tr_b16 v[124:125], v13 offset:24576
    ds_read_b64_tr_b16 v[126:127], v13 offset:25088
    ds_read_b64_tr_b16 v[128:129], v13 offset:28672
    ds_read_b64_tr_b16 v[130:131], v13 offset:29184
    ds_read_b64_tr_b16 v[132:133], v13 offset:32768
    ds_read_b64_tr_b16 v[134:135], v13 offset:33280
    s_waitcnt lgkmcnt(0)
    v_mov_b32 v12, 0
    v_mov_b32 v13, 0
    v_mov_b32 v14, 0
    v_mov_b32 v15, 0
F_NT:
    s_cmp_lg_u32 s38, 11
    s_cbranch_scc1 F_SEL
    s_cmp_lt_u32 s2, 192
    s_cbranch_scc1 T_EV
    v_lshrrev_b32 v7, 1, v3
    v_min_u32 v7, 16, v7
    s_and_b32 s52, s2, 31
    s_lshl_b32 s52, s52, 7
    v_add_u32 v7, s52, v7
    s_mov_b64 exec, 0xf
    s_movk_i32 s60, 4000
F_PL:
    buffer_load_dword v8, v7, s[40:43], 0 offen offset:2048 sc1
F_PL_W:
    s_waitcnt vmcnt(0)
F_PL_C:
    v_xor_b32 v9, s39, v8
    v_and_b32 v9, 0xffffdfff, v9
    v_cmp_ne_u32 vcc, 0, v9
    s_nop 0
    s_and_b64 exec, exec, vcc
    s_cbranch_execz F_PL_D
    s_sub_u32 s60, s60, 1
    s_cmp_gt_i32 s60, 0
    s_sleep 2
    s_cbranch_scc1 F_PL
F_PL_D:
    s_mov_b64 exec, 0xf
F_PL_K:
    v_lshrrev_b32 v7, 2, v3
    v_add_u32 v7, 161504, v7
    v_and_b32 v8, 0x2000, v8
    ds_write_b32 v7, v8
    s_mov_b64 exec, -1
    v_readlane_b32 s0, v8, 0
    v_readlane_b32 s1, v8, 1
    v_readlane_b32 s22, v8, 2
    s_branch T_EV
FINAL:
    s_cmp_ge_u32 s2, 144
    s_cbranch_scc1 END
    s_cmp_lg_u32 s38, 11
    s_cbranch_scc1 END
    s_branch T_EV
TOP8:
    s_and_b32 s65, s2, 3
    s_lshl_b32 s65, s65, 14
    s_and_b32 s66, s2, 4
    s_lshl_b32 s66, s66, 11
    s_xor_b32 s66, s66, s0
    s_add_u32 s65, s65, s66
    s_add_u32 s65, s65, 65536
    s_add_u32 s66, s65, 4096
    s_waitcnt lgkmcnt(0)
    buffer_load_dwordx4 v[16:19], v3, s[40:43], s65 offen offset:0 sc1
    buffer_load_dwordx4 v[20:23], v3, s[40:43], s65 offen offset:1024 sc1
    buffer_load_dwordx4 v[24:27], v3, s[40:43], s65 offen offset:2048 sc1
    buffer_load_dwordx4 v[28:31], v3, s[40:43], s65 offen offset:3072 sc1
    buffer_load_dwordx4 v[32:35], v3, s[40:43], s66 offen offset:0 sc1
    buffer_load_dwordx4 v[36:39], v3, s[40:43], s66 offen offset:1024 sc1
    buffer_load_dwordx4 v[40:43], v3, s[40:43], s66 offen offset:2048 sc1
    buffer_load_dwordx4 v[44:47], v3, s[40:43], s66 offen offset:3072 sc1
T_EV:
    v_bfe_i32 v7, v1, 0, 1
    v_bfe_i32 v8, v1, 1, 1
    v_bfe_i32 v9, v1, 3, 1
    v_bfe_i32 v11, v1, 4, 1
    v_bfe_i32 v13, v1, 5, 1
    v_xor_b32 v48, v7, v8
    v_xor_b32 v49, v8, v9
    v_xor_b32 v50, v7, v9
    v_xor_b32 v11, v11, v13
    v_xor_b32 v51, v9, v11
    v_xor_b32 v52, v8, v11
    v_xor_b32 v53, v7, v11
    v_mov_b32 v63, 161492
    v_lshl_add_u32 v13, v1, 2, v63
    v_add_u32 v13, 428, v13
    v_sub_u32 v54, 148464, v3
    v_and_b32 v7, 4, v1
    v_and_b32 v8, 48, v1
    v_lshlrev_b32 v8, 6, v8
    v_lshl_add_u32 v55, v7, 1, v8
    v_add_u32 v55, 147456, v55
    s_and_b32 s65, s2, 3
    s_lshl_b32 s65, s65, 14
    s_and_b32 s66, s2, 4
    s_lshl_b32 s66, s66, 11
    s_xor_b32 s66, s66, s0
    s_add_u32 s65, s65, s66
    s_add_u32 s65, s65, 65536
    s_add_u32 s66, s65, 4096
    s_and_b32 s67, s2, 127
    s_mul_i32 s68, s67, 64
    s_add_u32 s68, s68, s65
    v_mov_b32 v10, 0
    s_cmp_lt_u32 s2, 128
    s_cbranch_scc0 T_E2
    s_movk_i32 s60, 4000
    s_mov_b64 exec, 0x1
    s_waitcnt vmcnt(8)
    buffer_store_dword v167, v10, s[40:43], s50 offen sc1
    s_mov_b64 exec, -1
    s_waitcnt vmcnt(1)
    s_branch T_KP_C
T_E2:
    v_mov_b32 v16, -1
    v_mov_b32 v17, -1
    v_mov_b32 v18, -1
    v_mov_b32 v19, -1
    v_mov_b32 v20, -1
    v_mov_b32 v21, -1
    v_mov_b32 v22, -1
    v_mov_b32 v23, -1
    v_mov_b32 v24, -1
    v_mov_b32 v25, -1
    v_mov_b32 v26, -1
    v_mov_b32 v27, -1
    v_mov_b32 v28, -1
    v_mov_b32 v29, -1
    v_mov_b32 v30, -1
    v_mov_b32 v31, -1
    v_mov_b32 v32, -1
    v_mov_b32 v33, -1
    v_mov_b32 v34, -1
    v_mov_b32 v35, -1
    v_mov_b32 v36, -1
    v_mov_b32 v37, -1
    v_mov_b32 v38, -1
    v_mov_b32 v39, -1
    v_mov_b32 v40, -1
    v_mov_b32 v41, -1
    v_mov_b32 v42, -1
    v_mov_b32 v43, -1
    v_mov_b32 v44, -1
    v_mov_b32 v45, -1
    v_mov_b32 v46, -1
    v_mov_b32 v47, -1
    s_lshr_b32 s52, s67, 3
    s_and_b32 s53, s67, 3
    s_lshl2_add_u32 s52, s52, s53
    s_lshr_b32 s53, s67, 1
    s_xor_b32 s52, s52, s53
    s_lshl_b32 s52, s52, 7
    s_and_b32 s53, s67, 4
    s_lshl_b32 s53, s53, 11
    s_add_u32 s52, s52, s53
    s_cmp_lt_u32 s67, 96
    s_cselect_b32 s53, s1, s22
    s_xor_b32 s52, s52, s53
    s_lshl_b32 s53, s67, 14
    s_add_u32 s52, s52, s53
    s_add_u32 s67, s52, 2621452
    s_mov_b64 exec, 0xf
    s_movk_i32 s60, 4000
T_EP:
    buffer_load_dword v11, v3, s[40:43], s67 offen sc1
T_EP_W:
    s_waitcnt vmcnt(0)
T_EP_C:
    v_cmp_ne_u32 vcc, s39, v11
    s_nop 0
    s_and_b64 exec, exec, vcc
    s_cbranch_execz T_EP_D
    s_sub_u32 s60, s60, 1
    s_cmp_gt_i32 s60, 0
    s_sleep 2
    s_cbranch_scc1 T_EP
T_EP_D:
T_H:
    s_mov_b64 exec, 0x1
    s_movk_i32 s60, 4000
T_HP:
    buffer_load_dword v11, v10, s[40:43], s68 offen sc1
T_HP_W:
    s_waitcnt vmcnt(0)
T_HP_C:
    v_cmp_eq_u32 vcc, -1, v11
    s_nop 0
    s_and_b64 exec, exec, vcc
    s_cbranch_execz T_HP_D
    s_sub_u32 s60, s60, 1
    s_cmp_gt_i32 s60, 0
    s_sleep 1
    s_cbranch_scc1 T_HP
T_HP_D:
    s_mov_b64 exec, -1
    s_cmp_ge_u32 s2, 144
    s_cbranch_scc0 T_KQ
    s_movk_i32 s60, 4000
T_KN:
    buffer_load_dwordx4 v[16:19], v3, s[40:43], s65 offen offset:0 sc1
    buffer_load_dwordx4 v[20:23], v3, s[40:43], s65 offen offset:1024 sc1
    buffer_load_dwordx4 v[24:27], v3, s[40:43], s65 offen offset:2048 sc1
    buffer_load_dwordx4 v[28:31], v3, s[40:43], s65 offen offset:3072 sc1
    buffer_load_dwordx4 v[32:35], v3, s[40:43], s66 offen offset:0 sc1
    buffer_load_dwordx4 v[36:39], v3, s[40:43], s66 offen offset:1024 sc1
    buffer_load_dwordx4 v[40:43], v3, s[40:43], s66 offen offset:2048 sc1
    buffer_load_dwordx4 v[44:47], v3, s[40:43], s66 offen offset:3072 sc1
    s_waitcnt vmcnt(16)
    s_sub_u32 s60, s60, 1
    v_max3_u32 v56, v16, v17, v18
    v_max3_u32 v58, v19, v20, v21
    v_max3_u32 v57, v32, v33, v34
    v_max3_u32 v59, v35, v36, v37
    v_max3_u32 v56, v56, v22, v23
    v_max3_u32 v58, v58, v24, v25
    v_max3_u32 v57, v57, v38, v39
    v_max3_u32 v59, v59, v40, v41
    v_max3_u32 v56, v56, v26, v27
    v_max3_u32 v58, v58, v28, v29
    v_max3_u32 v57, v57, v42, v43
    v_max3_u32 v59, v59, v44, v45
    v_max3_u32 v58, v58, v30, v31
    v_max3_u32 v59, v59, v46, v47
    v_max_u32 v56, v56, v58
    v_max_u32 v57, v57, v59
    v_max_u32 v58, v56, v57
    v_cmp_eq_u32 vcc, -1, v58
    s_nop 0
    s_and_b64 exec, exec, vcc
    s_cselect_b32 s60, s60, 0
    s_cmp_gt_i32 s60, 0
    s_cbranch_scc1 T_KN
    s_branch T_KP_D
T_KQ:
    s_movk_i32 s60, 4000
T_KP:
    buffer_load_dwordx4 v[16:19], v3, s[40:43], s65 offen offset:0 sc1
    buffer_load_dwordx4 v[20:23], v3, s[40:43], s65 offen offset:1024 sc1
    buffer_load_dwordx4 v[24:27], v3, s[40:43], s65 offen offset:2048 sc1
    buffer_load_dwordx4 v[28:31], v3, s[40:43], s65 offen offset:3072 sc1
    buffer_load_dwordx4 v[32:35], v3, s[40:43], s66 offen offset:0 sc1
    buffer_load_dwordx4 v[36:39], v3, s[40:43], s66 offen offset:1024 sc1
    buffer_load_dwordx4 v[40:43], v3, s[40:43], s66 offen offset:2048 sc1
    buffer_load_dwordx4 v[44:47], v3, s[40:43], s66 offen offset:3072 sc1
T_KP_W:
    s_waitcnt vmcnt(0)
T_KP_C:
    v_max3_u32 v56, v16, v17, v18
    v_max3_u32 v58, v19, v20, v21
    v_max3_u32 v57, v32, v33, v34
    v_max3_u32 v59, v35, v36, v37
    v_max3_u32 v56, v56, v22, v23
    v_max3_u32 v58, v58, v24, v25
    v_max3_u32 v57, v57, v38, v39
    v_max3_u32 v59, v59, v40, v41
    v_max3_u32 v56, v56, v26, v27
    v_max3_u32 v58, v58, v28, v29
    v_max3_u32 v57, v57, v42, v43
    v_max3_u32 v59, v59, v44, v45
    v_max3_u32 v58, v58, v30, v31
    v_max3_u32 v59, v59, v46, v47
    v_max_u32 v56, v56, v58
    v_max_u32 v57, v57, v59
    v_max_u32 v58, v56, v57
    v_cmp_eq_u32 vcc, -1, v58
    s_nop 0
    s_and_b64 exec, exec, vcc
    s_cbranch_execz T_KP_D
    s_sub_u32 s60, s60, 1
    s_cmp_gt_i32 s60, 0
    s_cbranch_scc1 T_KP
T_KP_D:
    s_mov_b64 exec, -1
    v_mov_b32_dpp v58, v56 quad_perm:[1,0,3,2] row_mask:0xf bank_mask:0xf
    v_mov_b32_dpp v59, v57 quad_perm:[1,0,3,2] row_mask:0xf bank_mask:0xf
    v_med3_u32 v56, v56, v58, v48
    v_med3_u32 v57, v57, v59, v48
    ds_write_b128 v54, v[16:19] offset:7168
    v_mov_b32_dpp v58, v56 quad_perm:[2,3,0,1] row_mask:0xf bank_mask:0xf
    v_mov_b32_dpp v59, v57 quad_perm:[2,3,0,1] row_mask:0xf bank_mask:0xf
    v_med3_u32 v56, v56, v58, v49
    v_med3_u32 v57, v57, v59, v49
    ds_write_b128 v54, v[20:23] offset:6144
    v_mov_b32_dpp v58, v56 quad_perm:[1,0,3,2] row_mask:0xf bank_mask:0xf
    v_mov_b32_dpp v59, v57 quad_perm:[1,0,3,2] row_mask:0xf bank_mask:0xf
    v_med3_u32 v56, v56, v58, v50
    v_med3_u32 v57, v57, v59, v50
    ds_write_b128 v54, v[24:27] offset:5120
    v_mov_b32_dpp v58, v56 row_ror:8 row_mask:0xf bank_mask:0xf
    v_mov_b32_dpp v59, v57 row_ror:8 row_mask:0xf bank_mask:0xf
    v_med3_u32 v56, v56, v58, v51
    v_med3_u32 v57, v57, v59, v51
    ds_write_b128 v54, v[28:31] offset:4096
    v_mov_b32_dpp v58, v56 quad_perm:[2,3,0,1] row_mask:0xf bank_mask:0xf
    v_mov_b32_dpp v59, v57 quad_perm:[2,3,0,1] row_mask:0xf bank_mask:0xf
    v_med3_u32 v56, v56, v58, v52
    v_med3_u32 v57, v57, v59, v52
    ds_write_b128 v54, v[32:35] offset:3072
    v_mov_b32_dpp v58, v56 quad_perm:[1,0,3,2] row_mask:0xf bank_mask:0xf
    v_mov_b32_dpp v59, v57 quad_perm:[1,0,3,2] row_mask:0xf bank_mask:0xf
    v_med3_u32 v56, v56, v58, v53
    v_med3_u32 v57, v57, v59, v53
    ds_write_b128 v54, v[36:39] offset:2048
    s_nop 0
    v_max_u32_dpp v56, v57, v56 row_mirror row_mask:0xf bank_mask:0xf
    ds_write_b128 v54, v[40:43] offset:1024
    s_nop 0
    v_mov_b32_dpp v58, v56 row_ror:8 row_mask:0xf bank_mask:0xf
    v_med3_u32 v56, v56, v58, v51
    ds_write_b128 v54, v[44:47] offset:0
    s_nop 0
    v_mov_b32_dpp v58, v56 quad_perm:[2,3,0,1] row_mask:0xf bank_mask:0xf
    v_med3_u32 v56, v56, v58, v52
    s_nop 1
    v_mov_b32_dpp v58, v56 quad_perm:[1,0,3,2] row_mask:0xf bank_mask:0xf
    v_med3_u32 v56, v56, v58, v53
    s_nop 1
    v_max_u32_dpp v56, v56, v56 row_mirror row_mask:0xf bank_mask:0xf
    s_nop 1
    v_mov_b32_dpp v58, v56 row_ror:8 row_mask:0xf bank_mask:0xf
    v_med3_u32 v56, v56, v58, v51
    s_nop 1
    v_mov_b32_dpp v58, v56 quad_perm:[2,3,0,1] row_mask:0xf bank_mask:0xf
    v_med3_u32 v56, v56, v58, v52
    s_nop 1
    v_mov_b32_dpp v58, v56 quad_perm:[1,0,3,2] row_mask:0xf bank_mask:0xf
    v_med3_u32 v57, v56, v58, v53
    v_med3_u32 v56, v56, v58, v53
    s_nop 1
    v_permlane16_swap_b32 v56, v57
    v_max_u32 v56, v56, v57
    s_nop 1
    v_mov_b32_dpp v58, v56 row_ror:8 row_mask:0xf bank_mask:0xf
    v_med3_u32 v56, v56, v58, v51
    s_nop 1
    v_mov_b32_dpp v58, v56 quad_perm:[2,3,0,1] row_mask:0xf bank_mask:0xf
    v_med3_u32 v56, v56, v58, v52
    s_nop 1
    v_mov_b32_dpp v58, v56 quad_perm:[1,0,3,2] row_mask:0xf bank_mask:0xf
    v_med3_u32 v57, v56, v58, v53
    v_med3_u32 v56, v56, v58, v53
    s_nop 1
    v_permlane32_swap_b32 v56, v57
    v_max_u32 v56, v56, v57
    ds_write_b32 v13, v56
    s_cmp_lt_u32 s2, 144
    v_and_b32 v58, 0x4fc, v56
    v_lshl_or_b32 v58, v58, 2, v55
    v_mov_b32 v62, v56
    ds_read_b64 v[56:57], v58
    s_cbranch_scc1 T_V
    s_waitcnt lgkmcnt(0)
    s_barrier
    ds_read_b32 v7, v160
    s_waitcnt lgkmcnt(0)
    v_and_b32 v7, 0x7ff, v7
    v_mad_i32_i24 v7, v7, s64, v161
    buffer_load_dwordx4 v[8:11], v7, s[40:43], s63 offen sc1
T_V:
    v_min_u32_dpp v58, v62, v62 quad_perm:[1,0,3,2] row_mask:0xf bank_mask:0xf
    s_nop 1
    v_min_u32_dpp v58, v58, v58 quad_perm:[2,3,0,1] row_mask:0xf bank_mask:0xf
    s_nop 1
    v_min_u32_dpp v58, v58, v58 row_ror:8 row_mask:0xf bank_mask:0xf
    s_waitcnt lgkmcnt(0)
    v_cmp_ge_u32 vcc, v56, v58
    v_cmp_ge_u32 s[52:53], v57, v58
    s_bcnt1_i32_b64 s54, vcc
    s_bcnt1_i32_b64 s52, s[52:53]
    s_add_u32 s52, s52, s54
    s_cmp_eq_u32 s52, 8
    s_cbranch_scc0 T_M
T_OK:
    s_movk_i32 s60, 4000
    s_cmp_lt_u32 s2, 144
    s_cbranch_scc1 FIN
    s_setprio 0
    s_branch F_ZP_W
T_M:
    v_cmp_ne_u32 s[56:57], v62, v56
    v_cmp_ne_u32 s[74:75], v62, v57
    s_nop 0
    v_cndmask_b32 v56, 0, v56, s[56:57]
    v_cndmask_b32 v57, 0, v57, s[74:75]
    s_mov_b64 s[72:73], -1
T_L:
    v_max_u32 v59, v56, v57
    v_cmp_gt_u32 vcc, v59, v58
    s_nop 4
    s_cbranch_vccz T_X
    s_ff1_i32_b64 s52, vcc
    v_cmp_eq_u32 vcc, v62, v58
    v_readlane_b32 s53, v59, s52
    s_ff1_i32_b64 s54, vcc
    s_cmp_lt_u32 s2, 144
    s_cbranch_scc1 T_L2
    s_and_b32 s55, s53, 0x7ff
    s_mul_i32 s55, s55, s64
    s_add_u32 s55, s55, 9435648
    buffer_load_dwordx4 v[64:67], v3, s[40:43], s55 offen sc1
    buffer_load_dwordx4 v[68:71], v3, s[40:43], s55 offen offset:1024 sc1
T_L2:
    v_mov_b32 v59, s53
    v_cndmask_b32 v62, v62, v59, vcc
    v_cmp_ne_u32 s[56:57], s53, v56
    v_cmp_ne_u32 s[74:75], s53, v57
    s_nop 0
    v_cndmask_b32 v56, 0, v56, s[56:57]
    v_cndmask_b32 v57, 0, v57, s[74:75]
    v_min_u32_dpp v58, v62, v62 quad_perm:[1,0,3,2] row_mask:0xf bank_mask:0xf
    s_nop 1
    v_min_u32_dpp v58, v58, v58 quad_perm:[2,3,0,1] row_mask:0xf bank_mask:0xf
    s_nop 1
    v_min_u32_dpp v58, v58, v58 row_ror:8 row_mask:0xf bank_mask:0xf
    s_cmp_lt_u32 s2, 144
    s_cbranch_scc1 T_L
    s_lshr_b32 s52, s54, 1
    s_and_b32 s52, s52, 4
    s_and_b32 s54, s54, 3
    s_add_u32 s54, s54, s52
    s_mul_i32 s54, s54, 608
    s_add_u32 s54, s54, 147456
    v_and_b32 v72, 1, v1
    v_mul_u32_u24 v72, 4862, v72
    v_mul_u32_u24 v73, 6, v1
    v_sub_u32 v74, v73, v72
    v_add_u32 v73, v73, v72
    v_add_u32 v75, s54, v73
    v_add_u32 v76, s54, v74
    s_mov_b64 exec, s[72:73]
    s_movk_i32 s60, 4000
    s_branch T_Z_W
T_Z:
    buffer_load_dwordx4 v[8:11], v7, s[40:43], s63 offen sc1
T_Z_W:
    s_waitcnt vmcnt(0)
T_Z_C:
    v_cmp_ne_u32 vcc, s39, v11
    s_nop 0
    s_and_b64 exec, exec, vcc
    s_cbranch_execz T_Z_D
    s_wqm_b64 exec, exec
    s_sub_u32 s60, s60, 1
    s_cmp_gt_i32 s60, 0
    s_cbranch_scc1 T_Z
T_Z_D:
    s_mov_b64 exec, s[72:73]
    ds_write2_b32 v162, v8, v10 offset0:0 offset1:1
    ds_write_b32 v2, v9
    s_mov_b64 s[72:73], 0
    s_mov_b64 exec, -1
    s_movk_i32 s60, 4000
    s_branch T_F_W
T_F:
    buffer_load_dwordx4 v[64:67], v3, s[40:43], s55 offen sc1
    buffer_load_dwordx4 v[68:71], v3, s[40:43], s55 offen offset:1024 sc1
T_F_W:
    s_waitcnt vmcnt(0)
T_F_C:
    v_cmp_ne_u32 vcc, s39, v67
    v_cmp_ne_u32 s[56:57], s39, v71
    s_nop 0
    s_or_b32 vcc_lo, vcc_lo, s56
    s_and_b64 exec, exec, vcc
    s_cbranch_execz T_F_D
    s_wqm_b64 exec, exec
    s_sub_u32 s60, s60, 1
    s_cmp_gt_i32 s60, 0
    s_cbranch_scc1 T_F
T_F_D:
    s_mov_b64 exec, -1
    s_movk_i32 s60, 4000
T_C:
    ds_read_b32 v72, v63 offset:0
    s_sub_u32 s60, s60, 1
    s_cmp_gt_i32 s60, 0
    s_waitcnt lgkmcnt(0)
    v_readfirstlane_b32 s52, v72
    s_nop 0
    s_cselect_b32 s52, s52, 11
    s_cmp_lg_u32 s52, 11
    s_cbranch_scc1 T_C
    ds_write2_b32 v75, v64, v66 offset0:0 offset1:1
    ds_write_b32 v76, v65 offset:4864
    s_mov_b32 exec_hi, 0
    ds_write2_b32 v75, v68, v70 offset0:96 offset1:97
    ds_write_b32 v76, v69 offset:5248
    s_mov_b64 exec, -1
    s_branch T_L
T_X:
    s_movk_i32 s60, 4000
    s_cmp_lt_u32 s2, 144
    s_cbranch_scc1 FIN
    s_setprio 0
    s_branch F_BQ
F_SEL:
    s_setprio 0
    s_waitcnt lgkmcnt(0)
    s_barrier
    ds_read_b32 v7, v160
    s_waitcnt lgkmcnt(0)
    v_and_b32 v7, 0x7ff, v7
    v_mad_i32_i24 v7, v7, s64, v161
    s_movk_i32 s60, 4000
F_ZP:
    buffer_load_dwordx4 v[8:11], v7, s[40:43], s63 offen sc1
F_ZP_W:
    s_waitcnt vmcnt(0)
F_ZP_C:
    v_cmp_ne_u32 vcc, s39, v11
    s_nop 0
    s_and_b64 exec, exec, vcc
    s_cbranch_execz F_ZP_D
    s_wqm_b64 exec, exec
    s_sub_u32 s60, s60, 1
    s_cmp_gt_i32 s60, 0
    s_cbranch_scc1 F_ZP
F_ZP_D:
    s_mov_b64 exec, -1
    ds_write2_b32 v162, v8, v10 offset0:0 offset1:1
    ds_write_b32 v2, v9
    s_mov_b64 exec, 0x1
    ds_inc_u32 v63, v63 offset:0
    s_mov_b64 exec, -1
F_BQ:
    s_cmp_ge_u32 s38, s59
    s_waitcnt lgkmcnt(0)
    s_barrier
    s_cbranch_scc1 F_H
    ds_read_b128 v[16:19], v163 offset:0
    ds_read_b128 v[20:23], v163 offset:64
    ds_read_b128 v[24:27], v163 offset:128
    ds_read_b128 v[28:31], v163 offset:192
    ds_read_b128 v[32:35], v163 offset:256
    ds_read_b128 v[36:39], v163 offset:320
    ds_read_b128 v[40:43], v163 offset:384
    ds_read_b128 v[44:47], v163 offset:448
    ds_read_b128 v[48:51], v163 offset:512
    s_waitcnt lgkmcnt(8)
    v_smfmac_f32_16x16x64_bf16 v[12:15], v[16:19], v[64:71], v6
    s_waitcnt lgkmcnt(7)
    v_smfmac_f32_16x16x64_bf16 v[12:15], v[20:23], v[72:79], v6
    s_waitcnt lgkmcnt(6)
    v_smfmac_f32_16x16x64_bf16 v[12:15], v[24:27], v[80:87], v6
    s_waitcnt lgkmcnt(5)
    v_smfmac_f32_16x16x64_bf16 v[12:15], v[28:31], v[88:95], v6
    s_waitcnt lgkmcnt(4)
    v_smfmac_f32_16x16x64_bf16 v[12:15], v[32:35], v[96:103], v6
    s_waitcnt lgkmcnt(3)
    v_smfmac_f32_16x16x64_bf16 v[12:15], v[36:39], v[104:111], v6
    s_waitcnt lgkmcnt(2)
    v_smfmac_f32_16x16x64_bf16 v[12:15], v[40:43], v[112:119], v6
    s_waitcnt lgkmcnt(1)
    v_smfmac_f32_16x16x64_bf16 v[12:15], v[44:47], v[120:127], v6
    s_waitcnt lgkmcnt(0)
    v_smfmac_f32_16x16x64_bf16 v[12:15], v[48:51], v[128:135], v6
    s_nop 7
    v_permlane32_swap_b32 v12, v14
    v_permlane32_swap_b32 v13, v15
    v_add_f32 v12, v12, v14
    v_add_f32 v13, v13, v15
    v_cvt_pk_bf16_f32 v12, v12, v13
    s_nop 1
    v_mov_b32_dpp v13, v12 row_ror:8 row_mask:0xf bank_mask:0xf
    v_perm_b32 v8, v12, v13, v4
    v_mul_f32 v10, 0xbfb8aa3b, v8
    v_exp_f32 v10, v10
    v_perm_b32 v9, v12, v13, v5
    v_add_f32 v10, 1.0, v10
    v_rcp_f32 v10, v10
    s_nop 0
    v_mul_f32 v8, v8, v10
    v_cvt_pk_bf16_f32 v8, v8, v8
    v_lshlrev_b32 v8, 16, v8
    v_mul_f32 v8, v8, v9
    v_cvt_pk_bf16_f32 v8, v8, v8
    ds_write_b16 v164, v8
F_H:
    ds_read_b32 v56, v63 offset:12
    s_waitcnt lgkmcnt(0)
    s_barrier
    ds_read_b128 v[16:19], v60
    ds_read_b128 v[20:23], v60 offset:1024
    ds_read_b128 v[24:27], v61
    ds_read_b128 v[28:31], v61 offset:1024
    v_xor_b32 v165, v56, v165
    v_xor_b32 v166, v56, v166
    s_waitcnt lgkmcnt(3)
    v_mfma_f32_16x16x32_bf16 v[12:15], v[16:19], v[152:155], 0
    v_mfma_f32_16x16x32_bf16 v[8:11], v[16:19], v[136:139], 0
    s_waitcnt lgkmcnt(2)
    v_mfma_f32_16x16x32_bf16 v[12:15], v[20:23], v[156:159], v[12:15]
    v_mfma_f32_16x16x32_bf16 v[8:11], v[20:23], v[140:143], v[8:11]
    s_waitcnt lgkmcnt(1)
    v_mfma_f32_16x16x32_bf16 v[8:11], v[24:27], v[144:147], v[8:11]
    s_waitcnt lgkmcnt(0)
    v_mfma_f32_16x16x32_bf16 v[8:11], v[28:31], v[148:151], v[8:11]
    s_mov_b32 exec_hi, 0
    s_nop 1
    buffer_store_dwordx4 v[12:15], v166, s[40:43], s62 offen sc1
    s_mov_b64 exec, -1
    s_nop 2
    buffer_store_dwordx4 v[8:11], v165, s[40:43], s62 offen sc1
    s_branch END
FIN:
    s_cmp_ge_u32 s2, 72
    s_cselect_b32 s44, 32, 0
    s_cselect_b32 s45, 72, 0
    s_sub_u32 s45, s2, s45
    s_mul_i32 s46, s45, 43
    s_lshr_b32 s46, s46, 8
    s_mul_i32 s47, s46, 6
    s_sub_u32 s47, s45, s47
    v_lshrrev_b32 v6, 4, v1
    s_lshr_b32 s54, s2, 3
    s_lshl_b32 s55, s54, 16
    s_add_u32 s55, s55, s65
    s_add_u32 s55, s55, 196608
    v_mov_b32 v15, 0
    s_mov_b64 exec, 0x1
    buffer_load_dword v14, v15, s[40:43], s55 offen sc1
    s_mov_b64 exec, -1
    v_lshl_add_u32 v7, v6, 2, s44
    ds_bpermute_b32 v7, v7, v62
    v_and_b32 v8, 7, v1
    v_and_b32 v5, 15, v1
    s_lshl_b32 s48, s47, 2
    s_add_u32 s49, s48, 16384 - 16
    s_cmp_eq_u32 s47, 3
    s_cselect_b32 s49, 16384 + 8, s49
    s_cmp_lt_u32 s47, 3
    s_cselect_b32 s48, s48, s49
    s_cmp_lt_u32 s46, 6
    s_cselect_b32 s1, s1, s22
    s_and_b32 s49, s46, 7
    s_lshl_b32 s49, s49, 10
    s_or_b32 s1, s1, s49
    s_lshl_b32 s49, s46, 18
    s_add_u32 s48, s48, s49
    s_add_u32 s48, s48, 2621440
    s_lshl_b32 s47, s47, 1
    s_lshl_b32 s49, s46, 7
    s_add_u32 s49, s49, s47
    s_add_u32 s49, s49, 6291456
    s_mul_i32 s46, s46, 96
    s_add_u32 s46, s46, s47
    s_movk_i32 s47, 8192
    s_mov_b32 s52, s55
    s_lshl_b32 s54, s54, 14
    s_and_b32 s53, s55, 0x2000
    s_add_u32 s54, s54, s53
    s_and_b32 s53, s2, 3
    s_lshl_b32 s53, s53, 11
    s_add_u32 s54, s54, s53
    s_add_u32 s54, s54, 1441792
    s_add_u32 s53, s52, 4096
    v_mov_b32 v60, 0
    v_mov_b32 v61, 0
    v_mov_b32 v62, 0
    s_waitcnt lgkmcnt(0)
    v_and_b32 v9, 0x7ff, v7
    v_sub_u32 v9, 0x7ff, v9
    v_lshrrev_b32 v10, 4, v9
    v_lshlrev_b32 v11, 6, v10
    v_min_u32 v5, 11, v5
    v_lshl_add_u32 v11, v5, 2, v11
    v_mul_u32_u24 v12, 0x480, v9
    v_mad_u32_u24 v12, v8, 12, v12
    v_add_u32 v12, s46, v12
    v_and_b32 v13, 0x30, v9
    v_and_b32 v10, 0x780, v9
    v_lshlrev_b32 v10, 2, v10
    v_lshl_add_u32 v10, v13, 3, v10
    v_and_b32 v13, 0x40, v9
    v_lshl_add_u32 v10, v13, 7, v10
    v_mul_u32_u24 v13, 0x8080, v8
    v_xor_b32 v10, v13, v10
    v_xor_b32 v10, s1, v10
    v_and_b32 v13, 14, v9
    v_lshl_add_u32 v10, v13, 3, v10
    v_and_b32 v13, 1, v9
    v_lshl_add_u32 v10, v13, 1, v10
    v_mul_u32_u24 v9, 0x600, v9
    v_lshl_add_u32 v9, v8, 4, v9
    global_load_short_d16_hi v60, v12, s[4:5]
    buffer_load_short_d16_hi v61, v10, s[40:43], s48 offen sc1
    v_ashrrev_i32 v6, 31, v7
    v_not_b32 v6, v6
    v_or_b32 v6, 0x80000000, v6
    v_xor_b32 v7, v7, v6
    v_and_b32 v7, 0xffff0000, v7
    v_mul_f32 v7, 0xbfb8aa3b, v7
    v_exp_f32 v7, v7
    s_nop 0
    v_add_f32 v7, 1.0, v7
    v_rcp_f32 v7, v7
    s_nop 0
    v_cvt_pk_bf16_f32 v7, v7, v7
    v_lshlrev_b32 v7, 16, v7
    s_mov_b64 exec, 0x1
    s_movk_i32 s60, 4000
    s_waitcnt vmcnt(2)
    s_branch FN_HP_C
    s_movk_i32 s60, 4000
FN_HP:
    buffer_load_dword v14, v15, s[40:43], s55 offen sc1
FN_HP_W:
    s_waitcnt vmcnt(0)
FN_HP_C:
    v_cmp_eq_u32 vcc, -1, v14
    s_nop 0
    s_and_b64 exec, exec, vcc
    s_cbranch_execz FN_HP_D
    s_sub_u32 s60, s60, 1
    s_cmp_gt_i32 s60, 0
    s_cbranch_scc1 FN_HP
FN_HP_D:
    s_mov_b64 exec, -1
    buffer_load_dword v13, v11, s[40:43], s47 offen sc1
    buffer_load_short_d16_hi v62, v9, s[40:43], s49 offen sc1
    buffer_load_dwordx4 v[16:19], v3, s[40:43], s52 offen offset:0 sc1
    buffer_load_dwordx4 v[20:23], v3, s[40:43], s52 offen offset:1024 sc1
    buffer_load_dwordx4 v[24:27], v3, s[40:43], s52 offen offset:2048 sc1
    buffer_load_dwordx4 v[28:31], v3, s[40:43], s52 offen offset:3072 sc1
    buffer_load_dwordx4 v[32:35], v3, s[40:43], s53 offen offset:0 sc1
    buffer_load_dwordx4 v[36:39], v3, s[40:43], s53 offen offset:1024 sc1
    buffer_load_dwordx4 v[40:43], v3, s[40:43], s53 offen offset:2048 sc1
    buffer_load_dwordx4 v[44:47], v3, s[40:43], s53 offen offset:3072 sc1
    buffer_load_dwordx4 v[48:51], v3, s[40:43], s54 offen offset:0 sc1
    buffer_load_dwordx4 v[52:55], v3, s[40:43], s54 offen offset:1024 sc1
    s_waitcnt vmcnt(12)
    v_add_f32 v60, v60, v61
    v_cvt_pk_bf16_f32 v60, v60, v60
    v_lshlrev_b32 v60, 16, v60
    s_movk_i32 s60, 4000
    s_branch FN_PP_W
FN_PP:
    buffer_load_dword v13, v11, s[40:43], s47 offen sc1
    buffer_load_short_d16_hi v62, v9, s[40:43], s49 offen sc1
    buffer_load_dwordx4 v[16:19], v3, s[40:43], s52 offen offset:0 sc1
    buffer_load_dwordx4 v[20:23], v3, s[40:43], s52 offen offset:1024 sc1
    buffer_load_dwordx4 v[24:27], v3, s[40:43], s52 offen offset:2048 sc1
    buffer_load_dwordx4 v[28:31], v3, s[40:43], s52 offen offset:3072 sc1
    buffer_load_dwordx4 v[32:35], v3, s[40:43], s53 offen offset:0 sc1
    buffer_load_dwordx4 v[36:39], v3, s[40:43], s53 offen offset:1024 sc1
    buffer_load_dwordx4 v[40:43], v3, s[40:43], s53 offen offset:2048 sc1
    buffer_load_dwordx4 v[44:47], v3, s[40:43], s53 offen offset:3072 sc1
    buffer_load_dwordx4 v[48:51], v3, s[40:43], s54 offen offset:0 sc1
    buffer_load_dwordx4 v[52:55], v3, s[40:43], s54 offen offset:1024 sc1
FN_PP_W:
    s_waitcnt vmcnt(0)
FN_PP_C:
    v_cmp_ne_u32 s[56:57], s39, v13
    v_pk_add_f32 v[64:65], v[16:17], v[20:21]
    v_pk_add_f32 v[68:69], v[24:25], v[28:29]
    v_pk_add_f32 v[66:67], v[18:19], v[22:23]
    v_pk_add_f32 v[70:71], v[26:27], v[30:31]
    v_pk_add_f32 v[64:65], v[64:65], v[32:33]
    v_pk_add_f32 v[66:67], v[66:67], v[34:35]
    v_pk_add_f32 v[68:69], v[68:69], v[36:37]
    v_pk_add_f32 v[70:71], v[70:71], v[38:39]
    v_pk_add_f32 v[64:65], v[64:65], v[40:41]
    v_pk_add_f32 v[66:67], v[66:67], v[42:43]
    v_pk_add_f32 v[68:69], v[68:69], v[44:45]
    v_pk_add_f32 v[70:71], v[70:71], v[46:47]
    v_pk_add_f32 v[64:65], v[64:65], v[48:49]
    v_pk_add_f32 v[66:67], v[66:67], v[50:51]
    v_pk_add_f32 v[68:69], v[68:69], v[52:53]
    v_pk_add_f32 v[70:71], v[70:71], v[54:55]
    v_pk_add_f32 v[64:65], v[64:65], v[68:69]
    v_pk_add_f32 v[66:67], v[66:67], v[70:71]
    v_pk_add_f32 v[68:69], v[64:65], v[66:67]
    v_cmp_u_f32 vcc, v68, v69
    s_nop 0
    s_or_b64 vcc, vcc, s[56:57]
    s_and_b64 exec, exec, vcc
    s_cbranch_execz FN_PP_D
    s_sub_u32 s60, s60, 1
    s_cmp_gt_i32 s60, 0
    s_cbranch_scc1 FN_PP
FN_PP_D:
    s_mov_b64 exec, -1
    v_permlane32_swap_b32 v64, v66
    v_permlane32_swap_b32 v65, v67
    v_add_f32 v64, v64, v66
    v_add_f32 v65, v65, v67
    s_nop 1
    v_permlane16_swap_b32 v64, v65
    v_add_f32 v64, v64, v65
    s_nop 1
    v_add_f32_dpp v64, v64, v64 row_ror:8 row_mask:0xf bank_mask:0xf
    v_cvt_pk_bf16_f32 v64, v64, v64
    v_lshlrev_b32 v64, 16, v64
    v_mul_f32 v64, v64, v7
    v_cvt_pk_bf16_f32 v64, v64, v64
    v_lshlrev_b32 v64, 16, v64
    v_add_f32 v64, v64, v62
    v_cvt_pk_bf16_f32 v64, v64, v64
    v_lshlrev_b32 v64, 16, v64
    v_add_f32 v64, v64, v60
    v_cvt_pk_bf16_f32 v64, v64, v64
    s_mov_b32 exec_lo, 0xff00ff
    s_mov_b32 exec_hi, 0xff00ff
    global_store_short v12, v64, s[32:33]
    s_mov_b64 exec, -1
END:
    s_endpgm
CODE_END:
.section .rodata,"a"
.p2align 6
.amdhsa_kernel sequential_preLN__ssm_conv_s4__moe_arch_mod__prompt_kernel
  .amdhsa_next_free_vgpr 168
  .amdhsa_next_free_sgpr 102
  .amdhsa_accum_offset 168
  .amdhsa_group_segment_fixed_size 0
  .amdhsa_kernarg_size 136
  .amdhsa_user_sgpr_count 2
  .amdhsa_user_sgpr_kernarg_segment_ptr 1
  .amdhsa_system_sgpr_workgroup_id_x 1
.end_amdhsa_kernel
```

```asm
; @launch grid=(256,1,1) block=(768,1,1) lds=163840
.amdgcn_target "amdgcn-amd-amdhsa--gfx950"
    .text
    .globl sequential_preLN__ssm_conv_s4__moe_arch_mod__prompt_kernel
    .p2align 8
    .type sequential_preLN__ssm_conv_s4__moe_arch_mod__prompt_kernel,@function
sequential_preLN__ssm_conv_s4__moe_arch_mod__prompt_kernel:
    s_cmp_ge_u32 s2, 256
    s_cbranch_scc1 END
    s_load_dwordx16 s[4:19], s[0:1], 0
    s_load_dwordx2 s[36:37], s[0:1], 128
    s_load_dwordx16 s[20:35], s[0:1], 64
    s_getpc_b64 s[70:71]
    s_lshr_b32 s3, s2, 3
    s_mul_i32 s3, s3, 7
    v_subrev_u32 v2, 320, v0
    v_cmp_gt_u32 vcc, 7, v2
    v_add_lshl_u32 v2, v2, s3, 7
    v_min_u32 v2, CODE_END-sequential_preLN__ssm_conv_s4__moe_arch_mod__prompt_kernel-64, v2
    v_mov_b32 v3, s71
    s_mov_b64 exec, vcc
    v_add_co_u32 v2, vcc, s70, v2
    s_nop 1
    v_addc_co_u32 v3, vcc, 0, v3, vcc
    s_cbranch_execz P_NC
    global_load_dword v159, v[2:3], off
P_NC:
    s_mov_b64 exec, -1
    v_lshrrev_b32 v2, 6, v0
    v_and_b32 v1, 63, v0
    v_readfirstlane_b32 s38, v2
    v_lshlrev_b32 v3, 4, v1
    s_mov_b32 s42, 0x10000000
    s_mov_b32 s43, 0x00020000
    s_cmp_lt_u32 s2, 192
    s_cselect_b32 s3, 4, -1
    s_cmp_lg_u32 s38, s3
    s_cbranch_scc1 P_NP
    s_mul_i32 s52, s2, 768
    v_add_u32 v16, s52, v3
    s_mul_i32 s52, s2, 6
    s_and_b32 s52, s52, -4
    v_lshl_add_u32 v17, v1, 2, s52
    v_mov_b32 v18, 161536
    v_mov_b32 v19, 0
    ds_write_b32 v18, v19
    v_mov_b32 v20, s70
    v_mov_b32 v21, s71
    s_waitcnt lgkmcnt(0)
    s_mov_b32 exec_lo, 0xffffffff
    s_mov_b32 exec_hi, 0xffff
    s_mov_b32 m0, 138048
    s_nop 0
    global_load_lds_dwordx4 v16, s[6:7]
    s_mov_b32 m0, 138816
    s_nop 0
    global_load_lds_dwordx4 v16, s[8:9]
    s_mov_b32 m0, 139584
    s_nop 0
    global_load_lds_dwordx4 v16, s[10:11]
    s_mov_b32 m0, 140352
    s_nop 0
    global_load_lds_dwordx4 v16, s[12:13]
    s_mov_b32 m0, 141120
    s_nop 0
    global_load_lds_dwordx4 v16, s[14:15]
    s_mov_b32 m0, 141888
    s_nop 0
    global_load_lds_dwordx4 v16, s[16:17]
    s_mov_b64 exec, 0x3
    s_mov_b32 m0, 142656
    s_nop 0
    global_load_lds_dword v17, s[18:19]
    s_mov_b32 m0, 142672
    s_nop 0
    global_load_lds_dword v17, s[20:21]
    s_mov_b64 exec, 0x1
    s_mov_b32 m0, 161536
    s_nop 0
    global_load_lds_dword v[20:21], off
    s_mov_b64 exec, -1
P_NP:
    s_cmp_ge_u32 s38, 4
    s_cbranch_scc1 P_B
    s_setprio 3
    v_lshrrev_b32 v147, 5, v0
    v_and_b32 v148, 31, v0
    v_mul_u32_u24 v140, 0x480, v147
    s_mul_i32 s44, s2, 9216
    v_mad_u32_u24 v140, v148, 12, v140
    v_mov_b32 v104, 0
    v_mov_b32 v105, 0
    v_mov_b32 v106, 0
    v_mov_b32 v107, 0
    v_add_u32 v140, s44, v140
    v_add_u32 v149, 161280, v3
    s_mov_b64 exec, 0xffff
    ds_write_b128 v149, v[104:107]
    s_mov_b64 exec, -1
    v_mov_b32 v94, 1
    v_and_b32 v147, 1, v147
    v_mul_u32_u24 v141, 0x90, v148
    v_lshl_add_u32 v141, v147, 6, v141
    s_lshl_b32 s45, s38, 4
    s_sub_u32 s45, 147504, s45
    v_add_u32 v141, s45, v141
    v_lshrrev_b32 v142, 3, v1
    v_add_u32 v142, v142, v1
    s_mul_i32 s45, s38, 3456
    s_add_u32 s45, s45, 147456
    v_lshl_add_u32 v142, v142, 4, s45
    v_lshrrev_b32 v143, 2, v1
    v_mul_u32_u24 v143, 16320, v143
    v_add_u32 v143, v143, v3
    s_lshl_b32 s46, s2, 6
    s_sub_u32 s46, 2637760, s46
    s_mul_i32 s45, s38, 786432
    s_add_u32 s46, s46, s45
    s_add_u32 s47, s46, 262144
    s_add_u32 s48, s46, 524288
    s_mov_b32 s49, 0x05040100
    s_mov_b32 s50, 0x07060302
    v_mov_b32 v144, s49
    s_mov_b32 exec_lo, 0
    v_mov_b32 v144, s50
    s_mov_b64 exec, -1
    v_mov_b32 v145, 161328
    s_lshl_b32 s45, s38, 2
    v_add_u32 v146, s45, v145
    s_waitcnt lgkmcnt(0)
    global_load_dword v95, v104, s[36:37] offset:0
    global_load_dwordx3 v[60:62], v140, s[4:5] offset:0
    global_load_dwordx3 v[64:66], v140, s[4:5] offset:384
    global_load_dwordx3 v[68:70], v140, s[4:5] offset:768
    s_mov_b32 s40, s36
    s_mov_b32 s41, s37
    s_cmp_ge_u32 s2, 192
    s_cbranch_scc1 P_C
    s_lshr_b32 s65, s38, 2
    s_bitcmp1_b32 s2, 0
    s_addc_u32 s51, s65, 0
    s_cmp_eq_u32 s51, 3
    s_cselect_b32 s51, 0, s51
    s_lshl_b32 s52, s51, 8
    s_add_u32 s52, s52, 138048
    v_and_b32 v114, 0x7f, v0
    v_lshl_add_u32 v114, v114, 1, s52
    s_and_b32 s52, s2, 1
    s_add_u32 s52, s52, s51
    s_lshl_b32 s52, s52, 1
    s_add_u32 s52, s52, 142656
    v_mov_b32 v115, s52
    v_mov_b32 v119, 161536
    v_mov_b32 v29, 0
    v_mov_b32 v30, 0
    v_mov_b32 v31, 0
    v_mov_b32 v32, 0
    v_mov_b32 v33, 0
    v_mov_b32 v34, 0
    v_mov_b32 v35, 0
    v_mov_b32 v160, 0
    v_mov_b32 v161, 0
    v_mov_b32 v162, 0
    v_mov_b32 v163, 0
    v_mov_b32 v164, 0
    v_lshlrev_b32 v16, 4, v0
    v_add_u32 v17, 101184, v16
    ds_write_b128 v17, v[160:163] offset:0
    ds_write_b128 v17, v[160:163] offset:12288
    ds_write_b128 v17, v[160:163] offset:24576
    s_mul_i32 s59, s65, 16320
    s_mul_i32 s67, s65, 17408
    s_add_u32 s71, s67, 48960
    s_and_b32 s66, s38, 1
    s_lshl_b32 s66, s66, 8
    s_add_u32 s70, s66, s67
    s_add_u32 s70, s70, 16192
    s_add_u32 s66, s66, s59
    s_mov_b32 m0, s66
    s_mul_i32 s64, s65, 5888
    s_add_u32 s64, s64, 101184
    s_and_b32 s69, s38, 3
    v_and_b32 v5, 15, v0
    v_bfe_u32 v6, v0, 4, 2
    v_and_b32 v17, 48, v0
    v_mul_u32_u24 v110, 544, v5
    s_mov_b32 s52, 0
    s_movk_i32 s53, 2176
    s_movk_i32 s54, 4896
    s_cmp_eq_u32 s69, 1
    s_cselect_b32 s52, 9792, s52
    s_cselect_b32 s53, 1088, s53
    s_cselect_b32 s54, 3264, s54
    s_cmp_eq_u32 s69, 3
    s_cselect_b32 s52, 544, s52
    s_add_u32 s52, s52, s59
    s_cmp_eq_u32 s69, 2
    s_cselect_b32 s52, s71, s52
    s_cselect_b32 s54, 4352, s54
    s_add_u32 s67, s71, 8704
    v_and_b32 v111, 3, v0
    v_mul_u32_u24 v111, 544, v111
    v_bfe_u32 v18, v0, 2, 1
    v_bfe_u32 v19, v0, 3, 1
    v_xor_b32 v18, v18, v19
    v_mad_u32_u24 v111, v19, s53, v111
    v_mad_u32_u24 v111, v18, s54, v111
    v_add3_u32 v111, v111, v17, s52
    v_add3_u32 v110, v110, v17, s67
    s_barrier
    v_lshl_add_u32 v18, v5, 1, v6
    s_sub_u32 s52, s69, 11
    v_add_u32 v18, s52, v18
    v_add_u32 v19, 1, v18
    v_lshl_add_u32 v20, v6, 1, 2
    v_cmp_le_u32 s[52:53], v18, v20
    v_cmp_le_u32 s[54:55], v19, v20
    v_mov_b32 v18, 0x3f80
    v_cndmask_b32 v112, 0, v18, s[52:53]
    v_cndmask_b32 v19, 0, 1.0, s[54:55]
    v_or_b32 v112, v112, v19
    s_mul_i32 s52, s38, 1600
    s_add_u32 s52, s52, 120016
    v_lshl_add_u32 v113, v1, 2, s52
    s_mul_i32 s67, s65, 6400
    s_add_u32 s67, s67, 118848
    s_sub_u32 s63, s69, s65
    s_cselect_b32 s52, 3, 0
    s_add_u32 s63, s63, s52
    s_min_u32 s52, s63, 1
    s_add_u32 s63, s63, s52
    s_cmp_eq_u32 s69, 3
    s_cselect_b32 s63, 1, s63
    v_add_u32 v7, 1, v5
    v_and_b32 v8, 3, v7
    v_mul_u32_u24 v8, 1598, v8
    v_lshl_add_u32 v7, v7, 1, v8
    v_add3_u32 v7, v7, v17, s67
    v_add_u32 v18, s64, v17
    v_lshl_add_u32 v9, v5, 3, v18
    v_and_b32 v10, 1, v5
    v_mul_u32_u24 v10, 380, v10
    v_lshl_add_u32 v10, v5, 2, v10
    v_add_u32 v10, v18, v10
    v_lshlrev_b32 v8, 5, v5
    v_sub_u32 v8, v18, v8
    v_lshrrev_b32 v11, 2, v5
    v_lshl_add_u32 v2, v5, 2, v6
    v_add_u32 v15, v2, v11
    v_lshl_add_u32 v4, v15, 3, s59
    s_lshl_b32 s52, s65, 4
    s_add_u32 s52, s52, 161280
    v_mov_b32 v166, s52
    s_branch P_D
P_C:
    v_mov_b32 v8, 0
    v_mov_b32 v10, 0
    v_mov_b32 v166, 0
    v_mov_b32 v9, 0
    s_barrier
P_D:
    v_mov_b32 v117, 0
    v_mov_b32 v118, 0
    v_mov_b32 v116, 0
    s_waitcnt vmcnt(0)
LN1:
    v_dot2c_f32_bf16 v104, 0x3f803f80, v60
    v_dot2c_f32_bf16 v106, v60, v60
    v_dot2c_f32_bf16 v105, 0x3f803f80, v61
    v_dot2c_f32_bf16 v107, v61, v61
    v_dot2c_f32_bf16 v104, 0x3f803f80, v62
    v_dot2c_f32_bf16 v106, v62, v62
    v_dot2c_f32_bf16 v105, 0x3f803f80, v64
    v_dot2c_f32_bf16 v107, v64, v64
    v_dot2c_f32_bf16 v104, 0x3f803f80, v65
    v_dot2c_f32_bf16 v106, v65, v65
    v_dot2c_f32_bf16 v105, 0x3f803f80, v66
    v_dot2c_f32_bf16 v107, v66, v66
    v_dot2c_f32_bf16 v104, 0x3f803f80, v68
    v_dot2c_f32_bf16 v106, v68, v68
    v_dot2c_f32_bf16 v105, 0x3f803f80, v69
    v_dot2c_f32_bf16 v107, v69, v69
    v_dot2c_f32_bf16 v104, 0x3f803f80, v70
    v_dot2c_f32_bf16 v106, v70, v70
    v_add_u32 v95, 1, v95
    s_mov_b64 exec, 0x7
    ds_write_b64 v149, v[94:95] offset:136
    s_mov_b64 exec, -1
    v_add_f32 v104, v104, v105
    v_add_f32 v106, v106, v107
    v_lshlrev_b32 v72, 16, v60
    v_and_b32 v73, 0xffff0000, v60
    v_permlane16_swap_b32 v104, v106
    v_add_f32 v104, v104, v106
    v_lshlrev_b32 v74, 16, v61
    v_and_b32 v75, 0xffff0000, v61
    v_add_f32_dpp v104, v104, v104 quad_perm:[1,0,3,2] row_mask:0xf bank_mask:0xf
    v_lshlrev_b32 v76, 16, v62
    v_and_b32 v77, 0xffff0000, v62
    v_add_f32_dpp v104, v104, v104 quad_perm:[2,3,0,1] row_mask:0xf bank_mask:0xf
    v_lshlrev_b32 v78, 16, v64
    v_and_b32 v79, 0xffff0000, v64
    v_add_f32_dpp v104, v104, v104 row_half_mirror row_mask:0xf bank_mask:0xf
    v_lshlrev_b32 v80, 16, v65
    v_and_b32 v81, 0xffff0000, v65
    v_add_f32_dpp v104, v104, v104 row_mirror row_mask:0xf bank_mask:0xf
    v_mul_f32 v104, 0x3ae38e39, v104
    v_mov_b32 v105, v104
    v_lshlrev_b32 v82, 16, v66
    v_and_b32 v83, 0xffff0000, v66
    v_permlane16_swap_b32 v104, v105
    v_fma_f32 v105, -v104, v104, v105
    v_max_f32 v105, 0, v105
    v_cvt_pk_bf16_f32 v105, v104, v105
    v_lshlrev_b32 v104, 16, v105
    v_and_b32 v105, 0xffff0000, v105
    v_lshlrev_b32 v84, 16, v68
    v_and_b32 v85, 0xffff0000, v68
    v_lshlrev_b32 v86, 16, v69
    v_and_b32 v87, 0xffff0000, v69
    v_lshlrev_b32 v88, 16, v70
    v_and_b32 v89, 0xffff0000, v70
    v_readfirstlane_b32 s39, v95
    v_xor_b32 v99, 0x80000000, v95
    v_xor_b32 v103, 0x80000000, v95
    v_xor_b32 v95, 0x80000000, v95
    v_add_f32 v105, 0x3727c5ac, v105
    v_cvt_pk_bf16_f32 v105, v105, v105
    v_lshlrev_b32 v105, 16, v105
    v_sqrt_f32 v106, v105
    v_pk_add_f32 v[72:73], v[72:73], v[104:105] op_sel_hi:[1,0] neg_lo:[0,1] neg_hi:[0,1]
    v_pk_add_f32 v[74:75], v[74:75], v[104:105] op_sel_hi:[1,0] neg_lo:[0,1] neg_hi:[0,1]
    v_pk_add_f32 v[76:77], v[76:77], v[104:105] op_sel_hi:[1,0] neg_lo:[0,1] neg_hi:[0,1]
    v_cvt_pk_bf16_f32 v106, v106, v106
    v_lshlrev_b32 v106, 16, v106
    v_rcp_f32 v106, v106
    v_pk_add_f32 v[78:79], v[78:79], v[104:105] op_sel_hi:[1,0] neg_lo:[0,1] neg_hi:[0,1]
    v_pk_add_f32 v[80:81], v[80:81], v[104:105] op_sel_hi:[1,0] neg_lo:[0,1] neg_hi:[0,1]
    v_pk_add_f32 v[82:83], v[82:83], v[104:105] op_sel_hi:[1,0] neg_lo:[0,1] neg_hi:[0,1]
    v_pk_add_f32 v[84:85], v[84:85], v[104:105] op_sel_hi:[1,0] neg_lo:[0,1] neg_hi:[0,1]
    v_pk_add_f32 v[86:87], v[86:87], v[104:105] op_sel_hi:[1,0] neg_lo:[0,1] neg_hi:[0,1]
    v_pk_add_f32 v[88:89], v[88:89], v[104:105] op_sel_hi:[1,0] neg_lo:[0,1] neg_hi:[0,1]
    v_cvt_pk_bf16_f32 v73, v72, v73
    v_cvt_pk_bf16_f32 v75, v74, v75
    v_cvt_pk_bf16_f32 v77, v76, v77
    v_cvt_pk_bf16_f32 v79, v78, v79
    v_cvt_pk_bf16_f32 v81, v80, v81
    v_cvt_pk_bf16_f32 v83, v82, v83
    v_cvt_pk_bf16_f32 v85, v84, v85
    v_cvt_pk_bf16_f32 v87, v86, v87
    v_cvt_pk_bf16_f32 v89, v88, v89
    v_lshlrev_b32 v72, 16, v73
    v_and_b32 v73, 0xffff0000, v73
    v_lshlrev_b32 v74, 16, v75
    v_and_b32 v75, 0xffff0000, v75
    v_lshlrev_b32 v76, 16, v77
    v_and_b32 v77, 0xffff0000, v77
    v_pk_mul_f32 v[72:73], v[72:73], v[106:107] op_sel_hi:[1,0]
    v_pk_mul_f32 v[74:75], v[74:75], v[106:107] op_sel_hi:[1,0]
    v_pk_mul_f32 v[76:77], v[76:77], v[106:107] op_sel_hi:[1,0]
    v_cvt_pk_bf16_f32 v60, v72, v73
    v_cvt_pk_bf16_f32 v62, v76, v77
    v_cvt_pk_bf16_f32 v61, v74, v75
    v_cvt_pk_bf16_f32 v63, v74, v75
    v_permlane32_swap_b32 v60, v62
    s_nop 0
    v_permlane32_swap_b32 v61, v63
    v_perm_b32 v92, v60, v62, s49
    v_perm_b32 v93, v60, v62, s50
    v_lshlrev_b32 v78, 16, v79
    v_and_b32 v79, 0xffff0000, v79
    v_lshlrev_b32 v80, 16, v81
    v_and_b32 v81, 0xffff0000, v81
    v_lshlrev_b32 v82, 16, v83
    v_and_b32 v83, 0xffff0000, v83
    v_pk_mul_f32 v[78:79], v[78:79], v[106:107] op_sel_hi:[1,0]
    v_pk_mul_f32 v[80:81], v[80:81], v[106:107] op_sel_hi:[1,0]
    v_pk_mul_f32 v[82:83], v[82:83], v[106:107] op_sel_hi:[1,0]
    v_cvt_pk_bf16_f32 v64, v78, v79
    v_cvt_pk_bf16_f32 v66, v82, v83
    v_cvt_pk_bf16_f32 v65, v80, v81
    v_cvt_pk_bf16_f32 v67, v80, v81
    v_perm_b32 v94, v61, v63, v144
    ds_write_b128 v141, v[92:95] offset:0
    v_permlane32_swap_b32 v64, v66
    v_permlane32_swap_b32 v65, v67
    v_perm_b32 v96, v64, v66, s49
    v_perm_b32 v97, v64, v66, s50
    v_lshlrev_b32 v84, 16, v85
    v_and_b32 v85, 0xffff0000, v85
    v_lshlrev_b32 v86, 16, v87
    v_and_b32 v87, 0xffff0000, v87
    v_lshlrev_b32 v88, 16, v89
    v_and_b32 v89, 0xffff0000, v89
    v_pk_mul_f32 v[84:85], v[84:85], v[106:107] op_sel_hi:[1,0]
    v_pk_mul_f32 v[86:87], v[86:87], v[106:107] op_sel_hi:[1,0]
    v_pk_mul_f32 v[88:89], v[88:89], v[106:107] op_sel_hi:[1,0]
    v_cvt_pk_bf16_f32 v68, v84, v85
    v_cvt_pk_bf16_f32 v70, v88, v89
    v_cvt_pk_bf16_f32 v69, v86, v87
    v_cvt_pk_bf16_f32 v71, v86, v87
    v_perm_b32 v98, v65, v67, v144
    ds_write_b128 v141, v[96:99] offset:4608
    v_permlane32_swap_b32 v68, v70
    v_permlane32_swap_b32 v69, v71
    v_perm_b32 v100, v68, v70, s49
    v_perm_b32 v101, v68, v70, s50
    v_perm_b32 v102, v69, v71, v144
    ds_write_b128 v141, v[100:103] offset:9216
    s_mov_b64 exec, 0x1
    ds_write_b32 v146, v144
    s_mov_b64 exec, -1
LN1_U:
    s_movk_i32 s60, 4000
LN1_R:
    ds_read_b128 v[104:107], v145
    ds_read_b128 v[72:75], v142 offset:0
    ds_read_b128 v[76:79], v142 offset:1152
    ds_read_b128 v[80:83], v142 offset:2304
    s_sub_u32 s60, s60, 1
    s_waitcnt lgkmcnt(3)
    v_min3_u32 v104, v104, v105, v106
    v_min_u32 v104, v104, v107
    v_cmp_eq_u32 vcc, 0, v104
    s_cmp_gt_i32 s60, 0
    s_cselect_b64 s[52:53], vcc, 0
    s_cmp_lg_u64 s[52:53], 0
    s_waitcnt lgkmcnt(0)
    s_cbranch_scc1 LN1_R
    buffer_store_dwordx4 v[72:75], v143, s[40:43], s46 offen sc1
    buffer_store_dwordx4 v[76:79], v143, s[40:43], s47 offen sc1
    buffer_store_dwordx4 v[80:83], v143, s[40:43], s48 offen sc1
    s_cmp_ge_u32 s2, 192
    s_cbranch_scc1 FFN_DMA
    s_branch C_KS
P_B:
    s_cmp_ge_u32 s2, 192
    s_cbranch_scc1 FFN_DMA0
P_B2:
    s_lshr_b32 s65, s38, 2
    s_bitcmp1_b32 s2, 0
    s_addc_u32 s51, s65, 0
    s_cmp_eq_u32 s51, 3
    s_cselect_b32 s51, 0, s51
    s_lshl_b32 s52, s51, 8
    s_add_u32 s52, s52, 138048
    v_and_b32 v114, 0x7f, v0
    v_lshl_add_u32 v114, v114, 1, s52
    s_and_b32 s52, s2, 1
    s_add_u32 s52, s52, s51
    s_lshl_b32 s52, s52, 1
    s_add_u32 s52, s52, 142656
    v_mov_b32 v115, s52
    v_mov_b32 v119, 161536
    v_mov_b32 v29, 0
    v_mov_b32 v30, 0
    v_mov_b32 v31, 0
    v_mov_b32 v32, 0
    v_mov_b32 v33, 0
    v_mov_b32 v34, 0
    v_mov_b32 v35, 0
    v_mov_b32 v160, 0
    v_mov_b32 v161, 0
    v_mov_b32 v162, 0
    v_mov_b32 v163, 0
    v_mov_b32 v164, 0
    v_lshlrev_b32 v16, 4, v0
    v_add_u32 v17, 101184, v16
    ds_write_b128 v17, v[160:163] offset:0
    ds_write_b128 v17, v[160:163] offset:12288
    ds_write_b128 v17, v[160:163] offset:24576
    s_mul_i32 s59, s65, 16320
    s_mul_i32 s67, s65, 17408
    s_add_u32 s71, s67, 48960
    s_and_b32 s66, s38, 1
    s_lshl_b32 s66, s66, 8
    s_add_u32 s70, s66, s67
    s_add_u32 s70, s70, 16192
    s_add_u32 s66, s66, s59
    s_mov_b32 m0, s66
    s_mul_i32 s64, s65, 5888
    s_add_u32 s64, s64, 101184
    s_and_b32 s69, s38, 3
    v_and_b32 v5, 15, v0
    v_bfe_u32 v6, v0, 4, 2
    v_and_b32 v17, 48, v0
    v_mul_u32_u24 v110, 544, v5
    s_mov_b32 s52, 0
    s_movk_i32 s53, 2176
    s_movk_i32 s54, 4896
    s_cmp_eq_u32 s69, 1
    s_cselect_b32 s52, 9792, s52
    s_cselect_b32 s53, 1088, s53
    s_cselect_b32 s54, 3264, s54
    s_cmp_eq_u32 s69, 3
    s_cselect_b32 s52, 544, s52
    s_add_u32 s52, s52, s59
    s_cmp_eq_u32 s69, 2
    s_cselect_b32 s52, s71, s52
    s_cselect_b32 s54, 4352, s54
    s_add_u32 s67, s71, 8704
    v_and_b32 v111, 3, v0
    v_mul_u32_u24 v111, 544, v111
    v_bfe_u32 v18, v0, 2, 1
    v_bfe_u32 v19, v0, 3, 1
    v_xor_b32 v18, v18, v19
    v_mad_u32_u24 v111, v19, s53, v111
    v_mad_u32_u24 v111, v18, s54, v111
    v_add3_u32 v111, v111, v17, s52
    v_add3_u32 v110, v110, v17, s67
    s_barrier
    v_lshl_add_u32 v18, v5, 1, v6
    s_sub_u32 s52, s69, 11
    v_add_u32 v18, s52, v18
    v_add_u32 v19, 1, v18
    v_lshl_add_u32 v20, v6, 1, 2
    v_cmp_le_u32 s[52:53], v18, v20
    v_cmp_le_u32 s[54:55], v19, v20
    v_mov_b32 v18, 0x3f80
    v_cndmask_b32 v112, 0, v18, s[52:53]
    v_cndmask_b32 v19, 0, 1.0, s[54:55]
    v_or_b32 v112, v112, v19
    s_mul_i32 s52, s38, 1600
    s_add_u32 s52, s52, 120016
    v_lshl_add_u32 v113, v1, 2, s52
    s_mul_i32 s67, s65, 6400
    s_add_u32 s67, s67, 118848
    s_sub_u32 s63, s69, s65
    s_cselect_b32 s52, 3, 0
    s_add_u32 s63, s63, s52
    s_min_u32 s52, s63, 1
    s_add_u32 s63, s63, s52
    s_cmp_eq_u32 s69, 3
    s_cselect_b32 s63, 1, s63
    v_add_u32 v7, 1, v5
    v_and_b32 v8, 3, v7
    v_mul_u32_u24 v8, 1598, v8
    v_lshl_add_u32 v7, v7, 1, v8
    v_add3_u32 v7, v7, v17, s67
    v_add_u32 v18, s64, v17
    v_lshl_add_u32 v9, v5, 3, v18
    v_and_b32 v10, 1, v5
    v_mul_u32_u24 v10, 380, v10
    v_lshl_add_u32 v10, v5, 2, v10
    v_add_u32 v10, v18, v10
    v_lshlrev_b32 v8, 5, v5
    v_sub_u32 v8, v18, v8
    v_lshrrev_b32 v11, 2, v5
    v_lshl_add_u32 v2, v5, 2, v6
    v_add_u32 v15, v2, v11
    v_lshl_add_u32 v4, v15, 3, s59
    s_lshl_b32 s52, s65, 4
    s_add_u32 s52, s52, 161280
    v_mov_b32 v166, s52
    s_lshl_b32 s48, s2, 13
    s_add_u32 s48, s48, 258048
    s_mov_b32 s50, s2
    s_lshl_b32 s49, s2, 11
    s_add_u32 s49, s49, 1440768
    s_waitcnt lgkmcnt(0)
    s_mov_b32 s40, s36
    s_mov_b32 s41, s37
    s_bitcmp1_b32 s38, 0
    s_cselect_b32 s0, s26, s28
    s_cselect_b32 s1, s27, s29
    s_lshr_b32 s52, s2, 3
    s_mul_i32 s52, s52, 1728
    s_and_b32 s53, s2, 7
    s_lshl3_add_u32 s52, s53, s52
    s_add_u32 s52, s52, 3
    v_mul_u32_u24 v117, 0x48, v1
    v_add_lshl_u32 v117, v117, s52, 7
    s_cmp_lt_u32 s38, 10
    s_cbranch_scc1 C_NPB
    s_mov_b32 s52, m0
    s_mov_b32 m0, 163328
    s_mov_b64 exec, 0xffffff
    global_load_lds_dword v117, s[0:1]
    s_mov_b64 exec, -1
    s_mov_b32 m0, s52
C_NPB:
    s_lshr_b32 s52, s2, 3
    s_mul_i32 s52, s52, 3
    s_add_u32 s52, s52, s69
    s_mul_i32 s52, s52, 576
    s_and_b32 s53, s2, 7
    s_lshl3_add_u32 s52, s53, s52
    v_lshrrev_b32 v21, 3, v1
    v_and_b32 v22, 7, v1
    v_mul_u32_u24 v22, 0x48, v22
    v_add3_u32 v21, v21, v22, s52
    v_lshlrev_b32 v118, 7, v21
C_KS:
    s_movk_i32 s60, 4000
C_KP:
    ds_read_b32 v20, v119
    ds_read_u16_d16_hi v29, v115
    ds_read_u16_d16_hi v30, v114 offset:0
    ds_read_u16_d16_hi v31, v114 offset:768
    ds_read_u16_d16_hi v32, v114 offset:1536
    ds_read_u16_d16_hi v33, v114 offset:2304
    ds_read_u16_d16_hi v34, v114 offset:3072
    ds_read_u16_d16_hi v35, v114 offset:3840
    s_sub_u32 s60, s60, 1
    s_cmp_gt_i32 s60, 0
    s_waitcnt lgkmcnt(7)
    v_readfirstlane_b32 s52, v20
    s_nop 0
    s_cselect_b32 s52, s52, 1
    s_cmp_eq_u32 s52, 0
    s_cbranch_scc1 C_KP
    ds_read_u16_d16_hi v164, v115 offset:16
    s_setprio 2
    s_cmp_lt_u32 s38, 4
    s_cbranch_scc1 PG1
    s_setprio 3
PG1:
    s_waitcnt lgkmcnt(7)
    v_mul_f32 v20, 0x3fb8aa3b, v29
    v_mov_b32 v21, 0x3fb8aa3b
    v_fma_f32 v21, v29, v21, -v20
    v_fmac_f32 v21, 0x32a57060, v29
    v_exp_f32 v20, v20
    v_mul_f32 v21, 0x3f317218, v21
    v_fma_f32 v20, v20, v21, v20
    v_cvt_pk_bf16_f32 v20, v20, v20
    v_lshlrev_b32 v20, 16, v20
    s_waitcnt lgkmcnt(0)
    v_mul_f32 v21, v30, v20
    v_mul_f32 v36, v31, v20
    v_mul_f32 v32, v32, v20
    v_mul_f32 v33, v33, v20
    v_mul_f32 v21, 0x3fb8aa3b, v21
    v_mul_f32 v22, 0x3e22f983, v36
    v_mov_b32 v23, 0x3e22f983
    v_fma_f32 v23, v36, v23, -v22
    v_fmac_f32 v23, 0x31dc9c88, v36
    v_pk_mul_f32 v[24:25], v[34:35], v[32:33] op_sel:[0,0] op_sel_hi:[0,1]
    v_pk_fma_f32 v[24:25], v[34:35], v[32:33], v[24:25] op_sel:[1,1,0] op_sel_hi:[1,0,1] neg_lo:[1,0,0]
    s_bitcmp1_b32 s38, 1
    s_cbranch_scc1 C_ROLE1
    v_mul_f32 v36, 0x43000000, v21
    v_mul_f32 v37, 0x43000000, v22
    v_mul_f32 v38, 0x41000000, v21
    v_mul_f32 v39, 0x41000000, v22
    v_exp_f32 v36, v36
    v_fract_f32 v37, v37
    v_exp_f32 v38, v38
    v_fract_f32 v39, v39
    v_fmac_f32 v37, 0x43000000, v23
    v_fmac_f32 v39, 0x41000000, v23
    v_cos_f32 v26, v37
    v_sin_f32 v27, v37
    v_cos_f32 v28, v39
    v_sin_f32 v29, v39
    v_mul_f32 v26, v26, v36
    v_mul_f32 v27, v27, v36
    v_mul_f32 v28, v28, v38
    v_mul_f32 v29, v29, v38
    v_mov_b32 v44, 1.0
    v_mov_b32 v45, 0
    v_pk_mul_f32 v[56:57], v[24:25], v[28:29] op_sel:[0,0] op_sel_hi:[0,1]
    v_pk_mul_f32 v[50:51], v[28:29], v[28:29] op_sel:[0,0] op_sel_hi:[0,1]
    v_pk_fma_f32 v[56:57], v[24:25], v[28:29], v[56:57] op_sel:[1,1,0] op_sel_hi:[1,0,1] neg_lo:[1,0,0]
    v_pk_fma_f32 v[50:51], v[28:29], v[28:29], v[50:51] op_sel:[1,1,0] op_sel_hi:[1,0,1] neg_lo:[1,0,0]
    v_pk_mul_f32 v[58:59], v[56:57], v[26:27] op_sel:[0,0] op_sel_hi:[0,1]
    v_pk_fma_f32 v[58:59], v[56:57], v[26:27], v[58:59] op_sel:[1,1,0] op_sel_hi:[1,0,1] neg_lo:[1,0,0]
    v_cvt_pk_bf16_f32 v40, v56, v57
    ds_write_addtid_b32 v40 offset:4352
    v_pk_mul_f32 v[56:57], v[58:59], v[26:27] op_sel:[0,0] op_sel_hi:[0,1]
    v_pk_mul_f32 v[54:55], v[50:51], v[28:29] op_sel:[0,0] op_sel_hi:[0,1]
    v_pk_fma_f32 v[56:57], v[58:59], v[26:27], v[56:57] op_sel:[1,1,0] op_sel_hi:[1,0,1] neg_lo:[1,0,0]
    v_pk_fma_f32 v[54:55], v[50:51], v[28:29], v[54:55] op_sel:[1,1,0] op_sel_hi:[1,0,1] neg_lo:[1,0,0]
    v_cvt_pk_bf16_f32 v41, v58, v59
    ds_write_addtid_b32 v41 offset:9248
    v_cvt_pk_bf16_f32 v42, v44, -v45
    s_mov_b32 m0, s70
    s_nop 0
    ds_write_addtid_b32 v42 offset:41472
    v_cvt_pk_bf16_f32 v43, v28, -v29
    ds_write_addtid_b32 v43 offset:42016
    v_cvt_pk_bf16_f32 v40, v50, -v51
    ds_write_addtid_b32 v40 offset:42560
    v_pk_mul_f32 v[58:59], v[56:57], v[26:27] op_sel:[0,0] op_sel_hi:[0,1]
    v_pk_mul_f32 v[50:51], v[54:55], v[28:29] op_sel:[0,0] op_sel_hi:[0,1]
    v_pk_fma_f32 v[58:59], v[56:57], v[26:27], v[58:59] op_sel:[1,1,0] op_sel_hi:[1,0,1] neg_lo:[1,0,0]
    v_pk_fma_f32 v[50:51], v[54:55], v[28:29], v[50:51] op_sel:[1,1,0] op_sel_hi:[1,0,1] neg_lo:[1,0,0]
    v_cvt_pk_bf16_f32 v41, v56, v57
    s_mov_b32 m0, s66
    s_nop 0
    ds_write_addtid_b32 v41 offset:11968
    v_cvt_pk_bf16_f32 v42, v54, -v55
    s_mov_b32 m0, s70
    s_nop 0
    ds_write_addtid_b32 v42 offset:43104
    v_pk_mul_f32 v[56:57], v[58:59], v[26:27] op_sel:[0,0] op_sel_hi:[0,1]
    v_pk_mul_f32 v[54:55], v[50:51], v[28:29] op_sel:[0,0] op_sel_hi:[0,1]
    v_pk_fma_f32 v[56:57], v[58:59], v[26:27], v[56:57] op_sel:[1,1,0] op_sel_hi:[1,0,1] neg_lo:[1,0,0]
    v_pk_fma_f32 v[54:55], v[50:51], v[28:29], v[54:55] op_sel:[1,1,0] op_sel_hi:[1,0,1] neg_lo:[1,0,0]
    v_cvt_pk_bf16_f32 v43, v58, v59
    s_mov_b32 m0, s66
    s_nop 0
    ds_write_addtid_b32 v43 offset:15232
    v_cvt_pk_bf16_f32 v40, v50, -v51
    s_mov_b32 m0, s70
    s_nop 0
    ds_write_addtid_b32 v40 offset:43648
    v_pk_mul_f32 v[58:59], v[56:57], v[26:27] op_sel:[0,0] op_sel_hi:[0,1]
    v_pk_mul_f32 v[50:51], v[54:55], v[28:29] op_sel:[0,0] op_sel_hi:[0,1]
    v_pk_fma_f32 v[58:59], v[56:57], v[26:27], v[58:59] op_sel:[1,1,0] op_sel_hi:[1,0,1] neg_lo:[1,0,0]
    v_pk_fma_f32 v[50:51], v[54:55], v[28:29], v[50:51] op_sel:[1,1,0] op_sel_hi:[1,0,1] neg_lo:[1,0,0]
    v_cvt_pk_bf16_f32 v41, v56, v57
    ds_write_addtid_b32 v41 offset:33312
    v_cvt_pk_bf16_f32 v42, v54, -v55
    ds_write_addtid_b32 v42 offset:44192
    v_pk_mul_f32 v[56:57], v[58:59], v[26:27] op_sel:[0,0] op_sel_hi:[0,1]
    v_pk_mul_f32 v[54:55], v[50:51], v[28:29] op_sel:[0,0] op_sel_hi:[0,1]
    v_pk_fma_f32 v[56:57], v[58:59], v[26:27], v[56:57] op_sel:[1,1,0] op_sel_hi:[1,0,1] neg_lo:[1,0,0]
    v_pk_fma_f32 v[54:55], v[50:51], v[28:29], v[54:55] op_sel:[1,1,0] op_sel_hi:[1,0,1] neg_lo:[1,0,0]
    v_cvt_pk_bf16_f32 v43, v58, v59
    ds_write_addtid_b32 v43 offset:34400
    v_cvt_pk_bf16_f32 v40, v50, -v51
    ds_write_addtid_b32 v40 offset:44736
    v_pk_mul_f32 v[58:59], v[56:57], v[26:27] op_sel:[0,0] op_sel_hi:[0,1]
    v_pk_mul_f32 v[50:51], v[54:55], v[28:29] op_sel:[0,0] op_sel_hi:[0,1]
    v_pk_fma_f32 v[58:59], v[56:57], v[26:27], v[58:59] op_sel:[1,1,0] op_sel_hi:[1,0,1] neg_lo:[1,0,0]
    v_pk_fma_f32 v[50:51], v[54:55], v[28:29], v[50:51] op_sel:[1,1,0] op_sel_hi:[1,0,1] neg_lo:[1,0,0]
    v_cvt_pk_bf16_f32 v41, v56, v57
    ds_write_addtid_b32 v41 offset:37664
    v_cvt_pk_bf16_f32 v42, v54, -v55
    ds_write_addtid_b32 v42 offset:45280
    v_pk_mul_f32 v[56:57], v[58:59], v[26:27] op_sel:[0,0] op_sel_hi:[0,1]
    v_pk_mul_f32 v[54:55], v[50:51], v[28:29] op_sel:[0,0] op_sel_hi:[0,1]
    v_pk_fma_f32 v[56:57], v[58:59], v[26:27], v[56:57] op_sel:[1,1,0] op_sel_hi:[1,0,1] neg_lo:[1,0,0]
    v_pk_fma_f32 v[54:55], v[50:51], v[28:29], v[54:55] op_sel:[1,1,0] op_sel_hi:[1,0,1] neg_lo:[1,0,0]
    v_cvt_pk_bf16_f32 v43, v58, v59
    ds_write_addtid_b32 v43 offset:38752
    v_cvt_pk_bf16_f32 v40, v50, -v51
    ds_write_addtid_b32 v40 offset:45824
    v_pk_mul_f32 v[58:59], v[56:57], v[26:27] op_sel:[0,0] op_sel_hi:[0,1]
    v_pk_mul_f32 v[50:51], v[54:55], v[28:29] op_sel:[0,0] op_sel_hi:[0,1]
    v_pk_fma_f32 v[58:59], v[56:57], v[26:27], v[58:59] op_sel:[1,1,0] op_sel_hi:[1,0,1] neg_lo:[1,0,0]
    v_pk_fma_f32 v[50:51], v[54:55], v[28:29], v[50:51] op_sel:[1,1,0] op_sel_hi:[1,0,1] neg_lo:[1,0,0]
    v_cvt_pk_bf16_f32 v41, v56, v57
    ds_write_addtid_b32 v41 offset:39296
    v_cvt_pk_bf16_f32 v42, v54, -v55
    ds_write_addtid_b32 v42 offset:46368
    v_pk_mul_f32 v[56:57], v[58:59], v[26:27] op_sel:[0,0] op_sel_hi:[0,1]
    v_pk_mul_f32 v[54:55], v[50:51], v[28:29] op_sel:[0,0] op_sel_hi:[0,1]
    v_pk_fma_f32 v[56:57], v[58:59], v[26:27], v[56:57] op_sel:[1,1,0] op_sel_hi:[1,0,1] neg_lo:[1,0,0]
    v_pk_fma_f32 v[54:55], v[50:51], v[28:29], v[54:55] op_sel:[1,1,0] op_sel_hi:[1,0,1] neg_lo:[1,0,0]
    v_cvt_pk_bf16_f32 v43, v58, v59
    ds_write_addtid_b32 v43 offset:39840
    v_cvt_pk_bf16_f32 v40, v50, -v51
    ds_write_addtid_b32 v40 offset:46912
    v_pk_mul_f32 v[58:59], v[56:57], v[26:27] op_sel:[0,0] op_sel_hi:[0,1]
    v_pk_mul_f32 v[50:51], v[54:55], v[28:29] op_sel:[0,0] op_sel_hi:[0,1]
    v_pk_fma_f32 v[58:59], v[56:57], v[26:27], v[58:59] op_sel:[1,1,0] op_sel_hi:[1,0,1] neg_lo:[1,0,0]
    v_pk_fma_f32 v[50:51], v[54:55], v[28:29], v[50:51] op_sel:[1,1,0] op_sel_hi:[1,0,1] neg_lo:[1,0,0]
    v_cvt_pk_bf16_f32 v41, v56, v57
    ds_write_addtid_b32 v41 offset:40384
    v_cvt_pk_bf16_f32 v42, v54, -v55
    ds_write_addtid_b32 v42 offset:47456
    v_pk_mul_f32 v[56:57], v[58:59], v[26:27] op_sel:[0,0] op_sel_hi:[0,1]
    v_pk_mul_f32 v[54:55], v[50:51], v[28:29] op_sel:[0,0] op_sel_hi:[0,1]
    v_pk_fma_f32 v[56:57], v[58:59], v[26:27], v[56:57] op_sel:[1,1,0] op_sel_hi:[1,0,1] neg_lo:[1,0,0]
    v_pk_fma_f32 v[54:55], v[50:51], v[28:29], v[54:55] op_sel:[1,1,0] op_sel_hi:[1,0,1] neg_lo:[1,0,0]
    v_cvt_pk_bf16_f32 v43, v58, v59
    ds_write_addtid_b32 v43 offset:40928
    v_cvt_pk_bf16_f32 v40, v50, -v51
    ds_write_addtid_b32 v40 offset:48000
    v_pk_mul_f32 v[58:59], v[56:57], v[26:27] op_sel:[0,0] op_sel_hi:[0,1]
    v_pk_mul_f32 v[50:51], v[54:55], v[28:29] op_sel:[0,0] op_sel_hi:[0,1]
    v_pk_fma_f32 v[58:59], v[56:57], v[26:27], v[58:59] op_sel:[1,1,0] op_sel_hi:[1,0,1] neg_lo:[1,0,0]
    v_pk_fma_f32 v[50:51], v[54:55], v[28:29], v[50:51] op_sel:[1,1,0] op_sel_hi:[1,0,1] neg_lo:[1,0,0]
    v_cvt_pk_bf16_f32 v41, v56, v57
    ds_write_addtid_b32 v41 offset:34944
    v_cvt_pk_bf16_f32 v42, v54, -v55
    ds_write_addtid_b32 v42 offset:48544
    v_pk_mul_f32 v[56:57], v[58:59], v[26:27] op_sel:[0,0] op_sel_hi:[0,1]
    v_pk_mul_f32 v[54:55], v[50:51], v[28:29] op_sel:[0,0] op_sel_hi:[0,1]
    v_pk_fma_f32 v[56:57], v[58:59], v[26:27], v[56:57] op_sel:[1,1,0] op_sel_hi:[1,0,1] neg_lo:[1,0,0]
    v_pk_fma_f32 v[54:55], v[50:51], v[28:29], v[54:55] op_sel:[1,1,0] op_sel_hi:[1,0,1] neg_lo:[1,0,0]
    v_cvt_pk_bf16_f32 v43, v58, v59
    ds_write_addtid_b32 v43 offset:35488
    v_cvt_pk_bf16_f32 v40, v50, -v51
    ds_write_addtid_b32 v40 offset:49088
    v_pk_mul_f32 v[58:59], v[56:57], v[26:27] op_sel:[0,0] op_sel_hi:[0,1]
    v_pk_fma_f32 v[58:59], v[56:57], v[26:27], v[58:59] op_sel:[1,1,0] op_sel_hi:[1,0,1] neg_lo:[1,0,0]
    v_cvt_pk_bf16_f32 v41, v56, v57
    ds_write_addtid_b32 v41 offset:36032
    v_cvt_pk_bf16_f32 v42, v54, -v55
    ds_write_addtid_b32 v42 offset:49632
    v_cvt_pk_bf16_f32 v43, v58, v59
    ds_write_addtid_b32 v43 offset:36576
    s_branch C_MFMA
C_ROLE1:
    v_mul_f32 v36, 0x43000000, v21
    v_mul_f32 v37, 0x43000000, v22
    v_mul_f32 v38, 0x3f800000, v21
    v_mul_f32 v39, 0x3f800000, v22
    v_exp_f32 v36, v36
    v_fract_f32 v37, v37
    v_exp_f32 v38, v38
    v_fract_f32 v39, v39
    v_fmac_f32 v37, 0x43000000, v23
    v_fmac_f32 v39, 0x3f800000, v23
    v_cos_f32 v26, v37
    v_sin_f32 v27, v37
    v_cos_f32 v28, v39
    v_sin_f32 v29, v39
    v_mul_f32 v26, v26, v36
    v_mul_f32 v27, v27, v36
    v_mul_f32 v28, v28, v38
    v_mul_f32 v29, v29, v38
    v_pk_mul_f32 v[44:45], v[24:25], v[26:27] op_sel:[0,0] op_sel_hi:[0,1]
    v_pk_mul_f32 v[46:47], v[28:29], v[28:29] op_sel:[0,0] op_sel_hi:[0,1]
    v_pk_mul_f32 v[48:49], v[24:25], v[28:29] op_sel:[0,0] op_sel_hi:[0,1]
    v_pk_fma_f32 v[44:45], v[24:25], v[26:27], v[44:45] op_sel:[1,1,0] op_sel_hi:[1,0,1] neg_lo:[1,0,0]
    v_pk_fma_f32 v[46:47], v[28:29], v[28:29], v[46:47] op_sel:[1,1,0] op_sel_hi:[1,0,1] neg_lo:[1,0,0]
    v_pk_fma_f32 v[48:49], v[24:25], v[28:29], v[48:49] op_sel:[1,1,0] op_sel_hi:[1,0,1] neg_lo:[1,0,0]
    v_cvt_pk_bf16_f32 v40, v24, v25
    ds_write_addtid_b32 v40 offset:0
    v_pk_mul_f32 v[50:51], v[44:45], v[26:27] op_sel:[0,0] op_sel_hi:[0,1]
    v_pk_mul_f32 v[52:53], v[44:45], v[28:29] op_sel:[0,0] op_sel_hi:[0,1]
    v_pk_mul_f32 v[54:55], v[48:49], v[28:29] op_sel:[0,0] op_sel_hi:[0,1]
    v_pk_mul_f32 v[62:63], v[46:47], v[46:47] op_sel:[0,0] op_sel_hi:[0,1]
    v_pk_fma_f32 v[50:51], v[44:45], v[26:27], v[50:51] op_sel:[1,1,0] op_sel_hi:[1,0,1] neg_lo:[1,0,0]
    v_pk_fma_f32 v[52:53], v[44:45], v[28:29], v[52:53] op_sel:[1,1,0] op_sel_hi:[1,0,1] neg_lo:[1,0,0]
    v_pk_fma_f32 v[54:55], v[48:49], v[28:29], v[54:55] op_sel:[1,1,0] op_sel_hi:[1,0,1] neg_lo:[1,0,0]
    v_pk_fma_f32 v[62:63], v[46:47], v[46:47], v[62:63] op_sel:[1,1,0] op_sel_hi:[1,0,1] neg_lo:[1,0,0]
    v_cvt_pk_bf16_f32 v41, v44, v45
    ds_write_addtid_b32 v41 offset:4896
    v_cvt_pk_bf16_f32 v42, v48, v49
    ds_write_addtid_b32 v42 offset:544
    v_pk_mul_f32 v[56:57], v[50:51], v[26:27] op_sel:[0,0] op_sel_hi:[0,1]
    v_pk_mul_f32 v[58:59], v[50:51], v[46:47] op_sel:[0,0] op_sel_hi:[0,1]
    v_pk_mul_f32 v[44:45], v[52:53], v[28:29] op_sel:[0,0] op_sel_hi:[0,1]
    v_pk_mul_f32 v[48:49], v[54:55], v[28:29] op_sel:[0,0] op_sel_hi:[0,1]
    v_pk_fma_f32 v[56:57], v[50:51], v[26:27], v[56:57] op_sel:[1,1,0] op_sel_hi:[1,0,1] neg_lo:[1,0,0]
    v_pk_fma_f32 v[58:59], v[50:51], v[46:47], v[58:59] op_sel:[1,1,0] op_sel_hi:[1,0,1] neg_lo:[1,0,0]
    v_pk_fma_f32 v[44:45], v[52:53], v[28:29], v[44:45] op_sel:[1,1,0] op_sel_hi:[1,0,1] neg_lo:[1,0,0]
    v_pk_fma_f32 v[48:49], v[54:55], v[28:29], v[48:49] op_sel:[1,1,0] op_sel_hi:[1,0,1] neg_lo:[1,0,0]
    v_cvt_pk_bf16_f32 v43, v50, v51
    ds_write_addtid_b32 v43 offset:9792
    v_cvt_pk_bf16_f32 v40, v52, v53
    ds_write_addtid_b32 v40 offset:5440
    v_cvt_pk_bf16_f32 v41, v54, v55
    ds_write_addtid_b32 v41 offset:1088
    v_pk_mul_f32 v[54:55], v[48:49], v[28:29] op_sel:[0,0] op_sel_hi:[0,1]
    v_pk_mul_f32 v[52:53], v[44:45], v[28:29] op_sel:[0,0] op_sel_hi:[0,1]
    v_pk_mul_f32 v[50:51], v[58:59], v[46:47] op_sel:[0,0] op_sel_hi:[0,1]
    v_pk_mul_f32 v[24:25], v[56:57], v[46:47] op_sel:[0,0] op_sel_hi:[0,1]
    v_pk_fma_f32 v[54:55], v[48:49], v[28:29], v[54:55] op_sel:[1,1,0] op_sel_hi:[1,0,1] neg_lo:[1,0,0]
    v_pk_fma_f32 v[52:53], v[44:45], v[28:29], v[52:53] op_sel:[1,1,0] op_sel_hi:[1,0,1] neg_lo:[1,0,0]
    v_pk_fma_f32 v[50:51], v[58:59], v[46:47], v[50:51] op_sel:[1,1,0] op_sel_hi:[1,0,1] neg_lo:[1,0,0]
    v_pk_fma_f32 v[24:25], v[56:57], v[46:47], v[24:25] op_sel:[1,1,0] op_sel_hi:[1,0,1] neg_lo:[1,0,0]
    v_cvt_pk_bf16_f32 v42, v48, v49
    ds_write_addtid_b32 v42 offset:1632
    v_cvt_pk_bf16_f32 v43, v44, v45
    ds_write_addtid_b32 v43 offset:5984
    v_cvt_pk_bf16_f32 v40, v58, v59
    ds_write_addtid_b32 v40 offset:10336
    v_pk_mul_f32 v[48:49], v[54:55], v[28:29] op_sel:[0,0] op_sel_hi:[0,1]
    v_pk_mul_f32 v[44:45], v[52:53], v[28:29] op_sel:[0,0] op_sel_hi:[0,1]
    v_pk_mul_f32 v[58:59], v[50:51], v[46:47] op_sel:[0,0] op_sel_hi:[0,1]
    v_pk_mul_f32 v[56:57], v[24:25], v[46:47] op_sel:[0,0] op_sel_hi:[0,1]
    v_pk_fma_f32 v[48:49], v[54:55], v[28:29], v[48:49] op_sel:[1,1,0] op_sel_hi:[1,0,1] neg_lo:[1,0,0]
    v_pk_fma_f32 v[44:45], v[52:53], v[28:29], v[44:45] op_sel:[1,1,0] op_sel_hi:[1,0,1] neg_lo:[1,0,0]
    v_pk_fma_f32 v[58:59], v[50:51], v[46:47], v[58:59] op_sel:[1,1,0] op_sel_hi:[1,0,1] neg_lo:[1,0,0]
    v_pk_fma_f32 v[56:57], v[24:25], v[46:47], v[56:57] op_sel:[1,1,0] op_sel_hi:[1,0,1] neg_lo:[1,0,0]
    v_cvt_pk_bf16_f32 v41, v54, v55
    ds_write_addtid_b32 v41 offset:2176
    v_cvt_pk_bf16_f32 v42, v52, v53
    ds_write_addtid_b32 v42 offset:6528
    v_cvt_pk_bf16_f32 v43, v50, v51
    ds_write_addtid_b32 v43 offset:10880
    v_cvt_pk_bf16_f32 v40, v24, v25
    ds_write_addtid_b32 v40 offset:13600
    v_pk_mul_f32 v[54:55], v[48:49], v[28:29] op_sel:[0,0] op_sel_hi:[0,1]
    v_pk_mul_f32 v[52:53], v[44:45], v[28:29] op_sel:[0,0] op_sel_hi:[0,1]
    v_pk_mul_f32 v[50:51], v[58:59], v[62:63] op_sel:[0,0] op_sel_hi:[0,1]
    v_pk_mul_f32 v[24:25], v[56:57], v[46:47] op_sel:[0,0] op_sel_hi:[0,1]
    v_pk_mul_f32 v[64:65], v[56:57], v[26:27] op_sel:[0,0] op_sel_hi:[0,1]
    v_pk_fma_f32 v[54:55], v[48:49], v[28:29], v[54:55] op_sel:[1,1,0] op_sel_hi:[1,0,1] neg_lo:[1,0,0]
    v_pk_fma_f32 v[52:53], v[44:45], v[28:29], v[52:53] op_sel:[1,1,0] op_sel_hi:[1,0,1] neg_lo:[1,0,0]
    v_pk_fma_f32 v[50:51], v[58:59], v[62:63], v[50:51] op_sel:[1,1,0] op_sel_hi:[1,0,1] neg_lo:[1,0,0]
    v_pk_fma_f32 v[24:25], v[56:57], v[46:47], v[24:25] op_sel:[1,1,0] op_sel_hi:[1,0,1] neg_lo:[1,0,0]
    v_pk_fma_f32 v[64:65], v[56:57], v[26:27], v[64:65] op_sel:[1,1,0] op_sel_hi:[1,0,1] neg_lo:[1,0,0]
    v_cvt_pk_bf16_f32 v41, v48, v49
    ds_write_addtid_b32 v41 offset:2720
    v_cvt_pk_bf16_f32 v42, v44, v45
    ds_write_addtid_b32 v42 offset:7072
    v_cvt_pk_bf16_f32 v43, v58, v59
    ds_write_addtid_b32 v43 offset:11424
    v_cvt_pk_bf16_f32 v40, v56, v57
    ds_write_addtid_b32 v40 offset:14144
    v_pk_mul_f32 v[48:49], v[54:55], v[28:29] op_sel:[0,0] op_sel_hi:[0,1]
    v_pk_mul_f32 v[44:45], v[52:53], v[28:29] op_sel:[0,0] op_sel_hi:[0,1]
    v_pk_mul_f32 v[56:57], v[24:25], v[62:63] op_sel:[0,0] op_sel_hi:[0,1]
    v_pk_mul_f32 v[66:67], v[64:65], v[26:27] op_sel:[0,0] op_sel_hi:[0,1]
    v_pk_fma_f32 v[48:49], v[54:55], v[28:29], v[48:49] op_sel:[1,1,0] op_sel_hi:[1,0,1] neg_lo:[1,0,0]
    v_pk_fma_f32 v[44:45], v[52:53], v[28:29], v[44:45] op_sel:[1,1,0] op_sel_hi:[1,0,1] neg_lo:[1,0,0]
    v_pk_fma_f32 v[56:57], v[24:25], v[62:63], v[56:57] op_sel:[1,1,0] op_sel_hi:[1,0,1] neg_lo:[1,0,0]
    v_pk_fma_f32 v[66:67], v[64:65], v[26:27], v[66:67] op_sel:[1,1,0] op_sel_hi:[1,0,1] neg_lo:[1,0,0]
    v_cvt_pk_bf16_f32 v41, v54, v55
    ds_write_addtid_b32 v41 offset:3264
    v_cvt_pk_bf16_f32 v42, v52, v53
    ds_write_addtid_b32 v42 offset:7616
    v_cvt_pk_bf16_f32 v43, v50, v51
    ds_write_addtid_b32 v43 offset:12512
    v_cvt_pk_bf16_f32 v40, v24, v25
    ds_write_addtid_b32 v40 offset:14688
    v_cvt_pk_bf16_f32 v41, v64, v65
    s_mov_b32 m0, s70
    s_nop 0
    ds_write_addtid_b32 v41 offset:32768
    v_pk_mul_f32 v[52:53], v[44:45], v[28:29] op_sel:[0,0] op_sel_hi:[0,1]
    v_pk_mul_f32 v[64:65], v[66:67], v[26:27] op_sel:[0,0] op_sel_hi:[0,1]
    v_pk_fma_f32 v[52:53], v[44:45], v[28:29], v[52:53] op_sel:[1,1,0] op_sel_hi:[1,0,1] neg_lo:[1,0,0]
    v_pk_fma_f32 v[64:65], v[66:67], v[26:27], v[64:65] op_sel:[1,1,0] op_sel_hi:[1,0,1] neg_lo:[1,0,0]
    v_cvt_pk_bf16_f32 v42, v48, v49
    s_mov_b32 m0, s66
    s_nop 0
    ds_write_addtid_b32 v42 offset:3808
    v_cvt_pk_bf16_f32 v43, v44, v45
    ds_write_addtid_b32 v43 offset:8160
    v_cvt_pk_bf16_f32 v40, v56, v57
    ds_write_addtid_b32 v40 offset:15776
    v_cvt_pk_bf16_f32 v41, v66, v67
    s_mov_b32 m0, s70
    s_nop 0
    ds_write_addtid_b32 v41 offset:33856
    v_pk_mul_f32 v[66:67], v[64:65], v[26:27] op_sel:[0,0] op_sel_hi:[0,1]
    v_pk_fma_f32 v[66:67], v[64:65], v[26:27], v[66:67] op_sel:[1,1,0] op_sel_hi:[1,0,1] neg_lo:[1,0,0]
    v_cvt_pk_bf16_f32 v42, v52, v53
    s_mov_b32 m0, s66
    s_nop 0
    ds_write_addtid_b32 v42 offset:8704
    v_cvt_pk_bf16_f32 v43, v64, v65
    s_mov_b32 m0, s70
    s_nop 0
    ds_write_addtid_b32 v43 offset:37120
    v_cvt_pk_bf16_f32 v40, v66, v67
    ds_write_addtid_b32 v40 offset:38208
C_MFMA:
    s_mul_i32 s56, s2, 16384
    s_lshl_b32 s57, s38, 12
    s_add_u32 s56, s56, s57
    s_add_u32 s56, s56, 2605056
    s_mov_b64 exec, 0x1
    ds_inc_u32 v166, v166 offset:12
    s_mov_b64 exec, -1
    ds_write_b32 v113, v112
    s_setprio 2
    s_movk_i32 s60, 4000
C_KG:
    ds_read_b32 v16, v166 offset:12
    s_sub_u32 s60, s60, 1
    s_cmp_gt_i32 s60, 0
    s_waitcnt lgkmcnt(0)
    v_readfirstlane_b32 s52, v16
    s_nop 0
    s_cselect_b32 s52, s52, 4
    s_cmp_lg_u32 s52, 4
    s_cbranch_scc1 C_KG
    ds_read_b128 v[16:19], v111 offset:0
    ds_read_b128 v[20:23], v110 offset:0
    ds_read_b128 v[24:27], v111 offset:64
    ds_read_b128 v[28:31], v110 offset:64
    ds_read_b128 v[32:35], v111 offset:128
    ds_read_b128 v[36:39], v110 offset:128
    ds_read_b128 v[40:43], v111 offset:192
    ds_read_b128 v[44:47], v110 offset:192
    ds_read_b128 v[48:51], v111 offset:256
    ds_read_b128 v[52:55], v110 offset:256
    ds_read_b128 v[56:59], v111 offset:320
    ds_read_b128 v[60:63], v110 offset:320
    ds_read_b128 v[64:67], v111 offset:384
    ds_read_b128 v[68:71], v110 offset:384
    ds_read_b128 v[72:75], v111 offset:448
    ds_read_b128 v[76:79], v110 offset:448
    s_lshl_b32 s53, s63, 10
    s_sub_u32 s52, s64, s53
    s_add_u32 s52, s52, 3576
    v_and_b32 v165, 1, v5
    v_lshl_add_u32 v165, v6, 1, v165
    s_mul_i32 s53, s65, 384
    s_add_u32 s53, s53, 161920
    v_lshl_add_u32 v165, v165, 4, s53
    v_lshlrev_b32 v2, 3, v2
    v_sub_u32 v2, s52, v2
    s_mul_i32 s68, s63, 1088
    s_add_u32 s68, s68, s71
    v_lshl_add_u32 v15, v15, 3, s68
    s_cmp_lg_u32 s63, 0
    s_cbranch_scc1 C_LA1
    s_lshr_b32 s52, s2, 3
    s_mul_i32 s52, s52, 3
    s_add_u32 s52, s52, s65
    s_lshl_b32 s52, s52, 3
    s_and_b32 s53, s2, 7
    v_and_b32 v11, 7, v1
    v_add_u32 v11, s52, v11
    s_mul_i32 s54, s53, 7
    v_lshrrev_b32 v12, 3, v1
    v_add_u32 v12, s54, v12
    v_mul_u32_u24 v13, 0x48, v11
    v_add3_u32 v14, v12, v13, s53
    v_lshlrev_b32 v14, 7, v14
    v_add_u32 v10, s53, v12
    v_mul_u32_u24 v10, 0x240, v10
    s_add_u32 s53, s53, 64
    v_add_lshl_u32 v13, v13, s53, 7
    s_mul_i32 s53, s53, 0x240
    v_add_lshl_u32 v12, v11, s53, 7
    v_add_lshl_u32 v11, v11, v10, 7
    v_mov_b32 v10, 0
    v_lshrrev_b32 v9, 3, v1
    v_mul_u32_u24 v9, 3328, v9
    v_add3_u32 v9, v9, v3, s59
    s_branch C_LA2
C_LA1:
    v_and_b32 v93, 3, v5
    v_lshl_add_u32 v94, v6, 3, v11
    v_and_b32 v92, 1, v11
    v_mul_u32_u24 v92, 3456, v92
    v_add_u32 v92, s59, v92
    v_sub_u32 v93, v93, v94
    v_sub_u32 v94, v93, v94
    v_add_u32 v95, 44, v93
    v_lshrrev_b32 v96, 4, v95
    v_add_u32 v95, v95, v96
    v_lshl_add_u32 v11, v95, 3, v92
    v_add_u32 v95, 75, v94
    v_lshrrev_b32 v96, 4, v95
    v_add_u32 v95, v95, v96
    v_lshl_add_u32 v13, v95, 3, v92
    v_add_u32 v95, 40, v93
    v_lshrrev_b32 v96, 4, v95
    v_add_u32 v95, v95, v96
    v_lshl_add_u32 v12, v95, 3, v92
    v_add_u32 v95, 67, v94
    v_lshrrev_b32 v96, 4, v95
    v_add_u32 v95, v95, v96
    v_lshl_add_u32 v14, v95, 3, v92
C_LA2:
    s_cmp_eq_u32 s69, 2
    s_cbranch_scc1 C_T2
    v_lshrrev_b32 v89, 1, v6
    v_xor_b32 v88, v89, v6
    v_and_b32 v88, 1, v88
    v_lshlrev_b32 v88, 8, v88
    v_lshl_add_u32 v88, v89, 3, v88
    v_lshl_add_u32 v88, v5, 4, v88
    s_cmp_eq_u32 s69, 1
    s_cbranch_scc1 C_T1
    s_lshr_b32 s52, s69, 1
    s_mul_i32 s53, s52, 1600
    s_add_u32 s53, s53, s67
    v_add_u32 v88, s53, v88
    v_add_u32 v89, 3200, v88
    s_xor_b32 s52, s52, 1
    s_mov_b32 s53, 0
    s_waitcnt lgkmcnt(14)
    v_mfma_f32_16x16x32_bf16 v[80:83], v[16:19], v[20:23], 0
    s_waitcnt lgkmcnt(12)
    v_mfma_f32_16x16x32_bf16 v[84:87], v[24:27], v[28:31], 0
    s_waitcnt lgkmcnt(10)
    v_mfma_f32_16x16x32_bf16 v[80:83], v[32:35], v[36:39], v[80:83]
    s_waitcnt lgkmcnt(8)
    v_mfma_f32_16x16x32_bf16 v[84:87], v[40:43], v[44:47], v[84:87]
    s_waitcnt lgkmcnt(6)
    v_mfma_f32_16x16x32_bf16 v[80:83], v[48:51], v[52:55], v[80:83]
    s_waitcnt lgkmcnt(4)
    v_mfma_f32_16x16x32_bf16 v[84:87], v[56:59], v[60:63], v[84:87]
    s_waitcnt lgkmcnt(2)
    v_mfma_f32_16x16x32_bf16 v[80:83], v[64:67], v[68:71], v[80:83]
    s_waitcnt lgkmcnt(0)
    v_mfma_f32_16x16x32_bf16 v[84:87], v[72:75], v[76:79], v[84:87]
    s_nop 7
    v_pk_add_f32 v[80:81], v[80:81], v[84:85]
    v_pk_add_f32 v[82:83], v[82:83], v[86:87]
    v_cvt_pk_bf16_f32 v80, v80, v81
    v_cvt_pk_bf16_f32 v81, v82, v83
    ds_write_b64 v88, v[80:81] offset:32
    ds_write2_b32 v89, v80, v81 offset0:7 offset1:8
    s_mov_b64 exec, s[52:53]
    ds_write_b16 v88, v80 offset:1630
    ds_write_b16 v88, v80 offset:4826
    s_mov_b64 exec, -1
    s_branch C_B3
C_T1:
    s_add_u32 s53, s67, 544
    v_add_u32 v88, s53, v88
    v_add_u32 v89, 1600, v88
    s_waitcnt lgkmcnt(14)
    v_mfma_f32_16x16x32_bf16 v[80:83], v[16:19], v[20:23], 0
    s_waitcnt lgkmcnt(12)
    v_mfma_f32_16x16x32_bf16 v[84:87], v[24:27], v[28:31], 0
    s_waitcnt lgkmcnt(10)
    v_mfma_f32_16x16x32_bf16 v[80:83], v[32:35], v[36:39], v[80:83]
    s_waitcnt lgkmcnt(8)
    v_mfma_f32_16x16x32_bf16 v[84:87], v[40:43], v[44:47], v[84:87]
    s_waitcnt lgkmcnt(6)
    v_mfma_f32_16x16x32_bf16 v[80:83], v[48:51], v[52:55], v[80:83]
    s_waitcnt lgkmcnt(4)
    v_mfma_f32_16x16x32_bf16 v[84:87], v[56:59], v[60:63], v[84:87]
    s_waitcnt lgkmcnt(2)
    v_mfma_f32_16x16x32_bf16 v[80:83], v[64:67], v[68:71], v[80:83]
    s_waitcnt lgkmcnt(0)
    v_mfma_f32_16x16x32_bf16 v[84:87], v[72:75], v[76:79], v[84:87]
    s_nop 7
    v_pk_add_f32 v[80:81], v[80:81], v[84:85]
    v_pk_add_f32 v[82:83], v[82:83], v[86:87]
    v_cvt_pk_bf16_f32 v16, v81, v82
    v_cvt_pk_bf16_f32 v17, v82, v82
    v_cvt_pk_bf16_f32 v18, v82, v82
    v_cvt_pk_bf16_f32 v19, v82, v83
    ds_write2_b32 v88, v16, v17 offset0:1 offset1:2
    ds_write_b64 v88, v[16:17] offset:3200
    ds_write2_b32 v89, v18, v19 offset0:1 offset1:2
    ds_write_b64 v88, v[18:19] offset:4800
    v_cvt_pk_bf16_f32 v20, v80, v80
    v_cvt_pk_bf16_f32 v21, v80, v81
    s_mov_b64 exec, 0x1
    ds_write_b32 v88, v20
    ds_write_b32 v88, v20 offset:3196
    ds_write_b32 v88, v21 offset:1600
    ds_write_b32 v88, v21 offset:4796
    s_mov_b32 exec_lo, 0x0
    s_mov_b32 exec_hi, 0x8000
    ds_write_b16 v88, v17 offset:12
    ds_write_b16 v88, v17 offset:1610
    ds_write_b16 v88, v17 offset:3208
    ds_write_b16 v88, v17 offset:4806
    s_mov_b64 exec, -1
    s_branch C_B3
C_T2:
    v_lshlrev_b32 v88, 7, v6
    v_lshl_add_u32 v89, v5, 1, v88
    v_lshl_add_u32 v88, v5, 2, v88
    s_add_u32 s52, s64, 4728
    v_add_u32 v88, s52, v88
    s_add_u32 s52, s64, 4920
    v_add_u32 v89, s52, v89
    v_mov_b32 v90, s67
    s_waitcnt lgkmcnt(14)
    v_mfma_f32_16x16x32_bf16 v[80:83], v[16:19], v[20:23], 0
    s_waitcnt lgkmcnt(12)
    v_mfma_f32_16x16x32_bf16 v[84:87], v[24:27], v[28:31], 0
    s_waitcnt lgkmcnt(10)
    v_mfma_f32_16x16x32_bf16 v[80:83], v[32:35], v[36:39], v[80:83]
    s_waitcnt lgkmcnt(8)
    v_mfma_f32_16x16x32_bf16 v[84:87], v[40:43], v[44:47], v[84:87]
    s_waitcnt lgkmcnt(6)
    v_mfma_f32_16x16x32_bf16 v[80:83], v[48:51], v[52:55], v[80:83]
    s_waitcnt lgkmcnt(4)
    v_mfma_f32_16x16x32_bf16 v[84:87], v[56:59], v[60:63], v[84:87]
    s_waitcnt lgkmcnt(2)
    v_mfma_f32_16x16x32_bf16 v[80:83], v[64:67], v[68:71], v[80:83]
    s_waitcnt lgkmcnt(0)
    v_mfma_f32_16x16x32_bf16 v[84:87], v[72:75], v[76:79], v[84:87]
    s_nop 7
    v_pk_add_f32 v[80:81], v[80:81], v[84:85]
    v_pk_add_f32 v[82:83], v[82:83], v[86:87]
    v_cvt_pk_bf16_f32 v80, v80, v81
    v_cvt_pk_bf16_f32 v81, v82, v83
    s_mov_b32 exec_hi, 0
    ds_write2_b32 v88, v80, v81 offset0:0 offset1:16
    s_not_b64 exec, exec
    ds_write_b16 v89, v80 offset:4
    ds_write_b16_d16_hi v89, v80 offset:36
    ds_write_b16 v89, v81 offset:68
    ds_write_b16_d16_hi v89, v81 offset:100
    ds_write_b16 v89, v80 offset:384
    ds_write_b16_d16_hi v89, v80 offset:416
    ds_write_b16 v89, v81 offset:448
    ds_write_b16_d16_hi v89, v81 offset:480
    s_mov_b32 exec_lo, 0x80000000
    s_mov_b32 exec_hi, 0x0
    ds_write_b16_d16_hi v90, v81 offset:1126
    ds_write_b16_d16_hi v90, v81 offset:1128
    ds_write_b16_d16_hi v90, v81 offset:2724
    ds_write_b16_d16_hi v90, v81 offset:2726
    ds_write_b16_d16_hi v90, v81 offset:4322
    ds_write_b16_d16_hi v90, v81 offset:4324
    ds_write_b16_d16_hi v90, v81 offset:5920
    ds_write_b16_d16_hi v90, v81 offset:5922
    s_mov_b64 exec, -1
C_B3:
    s_mov_b64 exec, 0x1
    ds_inc_u32 v166, v166 offset:128
    s_mov_b64 exec, -1
    s_mov_b32 s61, s65
    s_cmp_lg_u32 s65, 1
    s_cbranch_scc1 C_NOUL
    s_waitcnt vmcnt(0)
    buffer_load_dwordx4 v[24:27], v3, s[40:43], s56 offen offset:0 sc1
    buffer_load_dwordx4 v[28:31], v3, s[40:43], s56 offen offset:1024 sc1
    buffer_load_dwordx4 v[32:35], v3, s[40:43], s56 offen offset:2048 sc1
    buffer_load_dwordx4 v[36:39], v3, s[40:43], s56 offen offset:3072 sc1
C_NOUL:
    s_movk_i32 s60, 4000
C_KM:
    ds_read_b128 v[16:19], v166 offset:128
    s_sub_u32 s60, s60, 1
    s_cmp_gt_i32 s60, 0
    s_waitcnt lgkmcnt(0)
    v_add_u32 v16, v16, v18
    s_nop 0
    v_readfirstlane_b32 s52, v16
    s_nop 0
    s_cselect_b32 s52, s52, 5
    s_cmp_lg_u32 s52, 5
    s_cbranch_scc1 C_KM
    s_sub_u32 s52, s38, 8
    s_cmp_ge_u32 s52, 3
    s_cbranch_scc1 C_NPA
    s_mov_b32 s52, m0
    s_mov_b32 m0, 163328
    s_nop 0
    global_load_lds_dword v118, s[28:29]
    s_mov_b32 m0, s52
C_NPA:
    s_setprio 3
    ds_read_b64 v[48:49], v7 offset:0
    ds_read_b64 v[50:51], v7 offset:8
    ds_read_b64 v[52:53], v7 offset:64
    ds_read_b64 v[54:55], v7 offset:72
    ds_read_b64 v[56:57], v7 offset:128
    ds_read_b64 v[58:59], v7 offset:136
    ds_read_b64 v[60:61], v7 offset:192
    ds_read_b64 v[62:63], v7 offset:200
    ds_read_b64 v[64:65], v7 offset:256
    ds_read_b64 v[66:67], v7 offset:264
    ds_read_b64 v[68:69], v7 offset:320
    ds_read_b64 v[70:71], v7 offset:328
    ds_read_b64 v[72:73], v7 offset:384
    ds_read_b64 v[74:75], v7 offset:392
    ds_read_b64 v[76:77], v7 offset:448
    ds_read_b64 v[78:79], v7 offset:456
    ds_read_b64 v[80:81], v7 offset:512
    ds_read_b64 v[82:83], v7 offset:520
    ds_read_b64 v[84:85], v7 offset:576
    ds_read_b64 v[86:87], v7 offset:584
    ds_read_b64 v[88:89], v7 offset:640
    ds_read_b64 v[90:91], v7 offset:648
    ds_read_b64 v[92:93], v7 offset:704
    ds_read_b64 v[94:95], v7 offset:712
    ds_read_b64 v[96:97], v7 offset:768
    ds_read_b64 v[98:99], v7 offset:776
    ds_read_b64 v[100:101], v7 offset:832
    ds_read_b64 v[102:103], v7 offset:840
    ds_read_b64 v[104:105], v7 offset:896
    ds_read_b64 v[106:107], v7 offset:904
    ds_read_b64 v[108:109], v7 offset:960
    ds_read_b64 v[110:111], v7 offset:968
    s_cmp_eq_u32 s63, 1
    s_cbranch_scc1 C_E1
    s_cmp_eq_u32 s63, 2
    s_cbranch_scc1 C_E2
    s_cmp_eq_u32 s63, 3
    s_cbranch_scc1 C_E3
    ds_read_b64 v[112:113], v7 offset:1152
    ds_read_b64 v[114:115], v7 offset:1160
    ds_read_b64 v[116:117], v7 offset:1216
    ds_read_b64 v[118:119], v7 offset:1224
    ds_read_b64 v[128:129], v7 offset:1280
    ds_read_b64 v[130:131], v7 offset:1288
    ds_read_b64 v[132:133], v7 offset:1344
    ds_read_b64 v[134:135], v7 offset:1352
    s_mov_b32 exec_hi, 0
    ds_write_b128 v9, v[160:163]
    s_mov_b64 exec, -1
    s_branch C_EE
C_E1:
    ds_read_b64 v[128:129], v7 offset:1152
    ds_read_b64 v[130:131], v7 offset:1160
    ds_read_b64 v[132:133], v7 offset:1216
    ds_read_b64 v[134:135], v7 offset:1224
    ds_read_b64 v[136:137], v7 offset:1280
    ds_read_b64 v[138:139], v7 offset:1288
    ds_read_b64 v[140:141], v7 offset:1344
    ds_read_b64 v[142:143], v7 offset:1352
    ds_read_b64 v[112:113], v7 offset:1024
    ds_read_b64 v[114:115], v7 offset:1032
    s_branch C_EE
C_E2:
    ds_read_b64 v[152:153], v7 offset:1152
    ds_read_b64 v[154:155], v7 offset:1160
    ds_read_b64 v[156:157], v7 offset:1216
    ds_read_b64 v[158:159], v7 offset:1224
    ds_read_b64 v[112:113], v7 offset:1024
    ds_read_b64 v[114:115], v7 offset:1032
    ds_read_b64 v[128:129], v9 offset:4608
    ds_read_b64 v[130:131], v9 offset:4616
    ds_read_b64 v[132:133], v9 offset:4672
    ds_read_b64 v[134:135], v9 offset:4680
    ds_read_b64 v[136:137], v9 offset:4736
    ds_read_b64 v[138:139], v9 offset:4744
    ds_read_b64 v[140:141], v9 offset:4800
    ds_read_b64 v[142:143], v9 offset:4808
    ds_read_b64 v[144:145], v9 offset:4864
    ds_read_b64 v[146:147], v9 offset:4872
    ds_read_b64 v[148:149], v9 offset:4928
    ds_read_b64 v[150:151], v9 offset:4936
    s_branch C_EE
C_E3:
    ds_read_b64 v[112:113], v7 offset:1024
    ds_read_b64 v[114:115], v7 offset:1032
    ds_read_b64 v[116:117], v7 offset:1088
    ds_read_b64 v[118:119], v7 offset:1096
    ds_read_b64 v[128:129], v9 offset:4608
    ds_read_b64 v[130:131], v9 offset:4616
    ds_read_b64 v[132:133], v9 offset:4672
    ds_read_b64 v[134:135], v9 offset:4680
    ds_read_b64 v[136:137], v9 offset:4736
    ds_read_b64 v[138:139], v9 offset:4744
    ds_read_b64 v[140:141], v9 offset:4800
    ds_read_b64 v[142:143], v9 offset:4808
    ds_read_b64 v[144:145], v9 offset:4864
    ds_read_b64 v[146:147], v9 offset:4872
    ds_read_b64 v[148:149], v9 offset:4928
    ds_read_b64 v[150:151], v9 offset:4936
    ds_read_b64 v[152:153], v10 offset:5120
    ds_read_b64 v[154:155], v10 offset:5128
    ds_read_b64 v[156:157], v10 offset:5184
    ds_read_b64 v[158:159], v10 offset:5192
    ds_read_b64 v[120:121], v10 offset:5248
    ds_read_b64 v[122:123], v10 offset:5256
    ds_read_b64 v[124:125], v10 offset:5312
    ds_read_b64 v[126:127], v10 offset:5320
C_EE:
    v_mov_b32 v167, v19
    v_readfirstlane_b32 s39, v19
    v_mul_u32_u24 v5, 37, v1
    v_lshrrev_b32 v5, 8, v5
    v_mul_u32_u24 v5, 1040, v5
    v_add_u32 v5, v5, v3
    v_add_u32 v6, 0x2400, v5
    s_mul_i32 s44, s2, 18432
    s_mul_i32 s45, s38, 96
    s_add_u32 s44, s44, s45
    s_add_u32 s72, s4, s44
    s_addc_u32 s73, s5, 0
    s_add_u32 s74, s24, s45
    s_addc_u32 s75, s25, 0
    s_mul_i32 s58, s69, 1920
    s_add_u32 s58, s58, s71
    s_add_u32 s58, s58, 4352
    s_cmp_lt_u32 s38, 4
    s_cbranch_scc1 C_B5
    v_mov_b32 v40, -1
    v_mov_b32 v41, -1
    v_mov_b32 v42, -1
    v_mov_b32 v43, -1
    v_lshlrev_b32 v20, 4, v0
    v_lshlrev_b32 v21, 2, v0
    s_cmp_lg_u32 s61, 1
    s_cbranch_scc1 C_PO
    v_xor_b32 v22, 0x80000000, v167
    s_movk_i32 s60, 4000
    s_branch C_UP_W
C_UP:
    buffer_load_dwordx4 v[24:27], v3, s[40:43], s56 offen offset:0 sc1
    buffer_load_dwordx4 v[28:31], v3, s[40:43], s56 offen offset:1024 sc1
    buffer_load_dwordx4 v[32:35], v3, s[40:43], s56 offen offset:2048 sc1
    buffer_load_dwordx4 v[36:39], v3, s[40:43], s56 offen offset:3072 sc1
C_UP_W:
    s_waitcnt vmcnt(0)
C_UP_C:
    v_xor_b32 v44, v22, v27
    v_xor_b32 v45, v22, v31
    v_xor_b32 v46, v22, v35
    v_xor_b32 v47, v22, v39
    v_or3_b32 v44, v44, v45, v46
    v_or_b32 v44, v44, v47
    v_cmp_ne_u32 vcc, 0, v44
    s_nop 0
    s_and_b64 exec, exec, vcc
    s_cbranch_execz C_UP_D
    s_wqm_b64 exec, exec
    s_sub_u32 s60, s60, 1
    s_cmp_gt_i32 s60, 0
    s_sleep 2
    s_cbranch_scc1 C_UP
C_UP_D:
    s_mov_b64 exec, -1
    s_lshl_b32 s52, s38, 10
    s_add_u32 m0, s52, 47936
    v_add_u32 v18, 161412, v3
    ds_write_addtid_b32 v25 offset:55040
    ds_write_addtid_b32 v29 offset:55296
    ds_write_addtid_b32 v33 offset:55552
    ds_write_addtid_b32 v37 offset:55808
    s_mov_b64 exec, 0x2
    ds_inc_u32 v18, v18
    s_mov_b64 exec, -1
    ds_write_addtid_b32 v26 offset:60928
    ds_write_addtid_b32 v30 offset:61184
    ds_write_addtid_b32 v34 offset:61440
    ds_write_addtid_b32 v38 offset:61696
    s_mov_b64 exec, 0x4
    ds_inc_u32 v18, v18
    s_mov_b64 exec, -1
    ds_write_addtid_b32 v24 offset:49152
    ds_write_addtid_b32 v28 offset:49408
    ds_write_addtid_b32 v32 offset:49664
    ds_write_addtid_b32 v36 offset:49920
    s_mov_b64 exec, 0x1
    ds_inc_u32 v18, v18
    s_mov_b64 exec, -1
C_PO:
    s_cmp_ge_u32 s50, 144
    s_cbranch_scc1 C_B5
    buffer_store_dwordx4 v[40:43], v20, s[40:43], s48 offen sc1
    buffer_store_dword v40, v21, s[40:43], s49 offen sc1
    s_cmp_lt_u32 s2, 128
    s_cselect_b32 s52, 8, -1
    s_cmp_lg_u32 s38, s52
    s_cbranch_scc1 C_B5
    v_lshrrev_b32 v22, 2, v1
    v_mul_u32_u24 v22, 8128, v22
    v_add_u32 v22, v22, v3
    s_mul_i32 s52, s2, 64
    s_add_u32 s52, s52, 65536
    s_mov_b32 exec_lo, 0xffffffff
    s_mov_b32 exec_hi, 0x0
    buffer_store_dwordx4 v[40:43], v22, s[40:43], s52 offen sc1
    s_mov_b64 exec, -1
C_B5:
    s_mov_b32 s56, 0xf7efdfbf
    s_mov_b32 s57, 0x7efdfb
    s_movk_i32 s60, 4000
C_UF:
    ds_read_b32 v16, v166 offset:132
    s_sub_u32 s60, s60, 1
    s_cmp_gt_i32 s60, 0
    s_waitcnt lgkmcnt(0)
    v_readfirstlane_b32 s52, v16
    s_nop 0
    s_cselect_b32 s52, s52, 4
    s_cmp_lg_u32 s52, 4
    s_cbranch_scc1 C_UF
    s_movk_i32 s60, 4000
    s_cmp_eq_u32 s63, 1
    s_cbranch_scc1 C_P1
    s_cmp_eq_u32 s63, 2
    s_cbranch_scc1 C_P2
    s_cmp_eq_u32 s63, 3
    s_cbranch_scc1 C_P3
    s_setprio 2
    ds_read_b128 v[32:35], v8 offset:3552
    ds_read_b128 v[36:39], v8 offset:4064
    ds_read_b128 v[40:43], v8 offset:3680
    s_waitcnt lgkmcnt(2)
    v_mfma_f32_16x16x32_bf16 v[136:139], v[112:115], v[32:35], 0
    v_mfma_f32_16x16x32_bf16 v[140:143], v[116:119], v[32:35], 0
    v_mfma_f32_16x16x32_bf16 v[144:147], v[128:131], v[32:35], 0
    v_mfma_f32_16x16x32_bf16 v[148:151], v[132:135], v[32:35], 0
    v_mfma_f32_16x16x32_bf16 v[28:31], v[52:55], v[32:35], 0
    v_mfma_f32_16x16x32_bf16 v[20:23], v[48:51], v[32:35], 0
    ds_read_b128 v[44:47], v8 offset:3808
    s_waitcnt lgkmcnt(2)
    v_mfma_f32_16x16x32_bf16 v[152:155], v[112:115], v[36:39], 0
    v_mfma_f32_16x16x32_bf16 v[156:159], v[116:119], v[36:39], 0
    v_mfma_f32_16x16x32_bf16 v[120:123], v[128:131], v[36:39], 0
    v_mfma_f32_16x16x32_bf16 v[124:127], v[132:135], v[36:39], 0
    v_mfma_f32_16x16x32_bf16 v[28:31], v[84:87], v[36:39], v[28:31]
    v_mfma_f32_16x16x32_bf16 v[20:23], v[80:83], v[36:39], v[20:23]
    v_mfma_f32_16x16x32_bf16 v[24:27], v[52:55], v[36:39], 0
    v_mfma_f32_16x16x32_bf16 v[16:19], v[48:51], v[36:39], 0
    v_cvt_pk_bf16_f32 v136, v136, v137
    v_cvt_pk_bf16_f32 v137, v138, v139
    ds_write_b64 v4, v[136:137] offset:680
    v_cvt_pk_bf16_f32 v140, v140, v141
    v_cvt_pk_bf16_f32 v141, v142, v143
    ds_write_b64 v4, v[140:141] offset:4136
    v_cvt_pk_bf16_f32 v144, v144, v145
    v_cvt_pk_bf16_f32 v145, v146, v147
    ds_write_b64 v4, v[144:145] offset:7592
    v_cvt_pk_bf16_f32 v148, v148, v149
    v_cvt_pk_bf16_f32 v149, v150, v151
    ds_write_b64 v4, v[148:149] offset:11048
    ds_read_b128 v[32:35], v8 offset:3936
    s_waitcnt lgkmcnt(6)
    v_mfma_f32_16x16x32_bf16 v[28:31], v[60:63], v[40:43], v[28:31]
    v_mfma_f32_16x16x32_bf16 v[20:23], v[56:59], v[40:43], v[20:23]
    v_cvt_pk_bf16_f32 v152, v152, v153
    v_cvt_pk_bf16_f32 v153, v154, v155
    ds_write_b64 v4, v[152:153] offset:136
    v_cvt_pk_bf16_f32 v156, v156, v157
    v_cvt_pk_bf16_f32 v157, v158, v159
    ds_write_b64 v4, v[156:157] offset:3592
    v_cvt_pk_bf16_f32 v120, v120, v121
    v_cvt_pk_bf16_f32 v121, v122, v123
    ds_write_b64 v4, v[120:121] offset:7048
    v_cvt_pk_bf16_f32 v124, v124, v125
    v_cvt_pk_bf16_f32 v125, v126, v127
    ds_write_b64 v4, v[124:125] offset:10504
    s_mov_b64 exec, 0x1
    ds_write_b32 v166, v166 offset:0
    s_mov_b64 exec, -1
    s_setprio 0
    ds_read_b128 v[84:87], v8 offset:4192
    ds_read_b64 v[160:161], v2 offset:512
    ds_read_b64 v[162:163], v2
    s_or_b32 s52, s38, s2
    s_cbranch_scc1 C_NOEP
    s_mov_b64 exec, 0x1
    buffer_store_dword v167, v10, s[40:43], 0 offen sc1
    s_mov_b64 exec, -1
C_NOEP:
    s_cmp_ge_u32 s2, 128
    s_cbranch_scc1 C_NX0
    s_mov_b32 m0, s58
    s_mov_b64 exec, s[56:57]
    global_load_lds_dwordx4 v5, s[72:73]
    s_add_u32 m0, s58, 896
    s_nop 0
    global_load_lds_dwordx4 v6, s[72:73]
    s_add_u32 m0, s58, 1792
    s_mov_b64 exec, 0x3f
    global_load_lds_dwordx4 v3, s[74:75]
    s_mov_b64 exec, -1
C_NX0:
    s_mov_b32 m0, 163328
    s_nop 0
    global_load_lds_dword v11, s[30:31]
    s_mov_b64 exec, 0xff
    global_load_lds_dword v13, s[28:29]
    global_load_lds_dword v13, s[26:27]
    global_load_lds_dword v12, s[30:31]
    s_mov_b64 exec, -1
    s_waitcnt lgkmcnt(13)
    v_mfma_f32_16x16x32_bf16 v[28:31], v[68:71], v[44:47], v[28:31]
    v_mfma_f32_16x16x32_bf16 v[20:23], v[64:67], v[44:47], v[20:23]
    ds_read_b128 v[80:83], v8 offset:4320
    s_waitcnt lgkmcnt(9)
    v_mfma_f32_16x16x32_bf16 v[28:31], v[76:79], v[32:35], v[28:31]
    v_mfma_f32_16x16x32_bf16 v[20:23], v[72:75], v[32:35], v[20:23]
    ds_read_b128 v[36:39], v8 offset:4448
    s_waitcnt lgkmcnt(2)
    v_and_b32 v48, 0xffff0000, v161
    v_lshlrev_b32 v49, 16, v161
    v_and_b32 v50, 0xffff0000, v160
    v_lshlrev_b32 v51, 16, v160
    v_mul_f32 v48, v48, v164
    v_mul_f32 v49, v49, v164
    v_mul_f32 v50, v50, v164
    v_mul_f32 v51, v51, v164
    v_cvt_pk_bf16_f32 v49, v48, v49
    v_lshlrev_b32 v48, 16, v49
    v_and_b32 v49, 0xffff0000, v49
    v_cvt_pk_bf16_f32 v51, v50, v51
    v_lshlrev_b32 v50, 16, v51
    v_and_b32 v51, 0xffff0000, v51
    v_and_b32 v52, 0xffff0000, v163
    v_lshlrev_b32 v53, 16, v163
    v_and_b32 v54, 0xffff0000, v162
    v_lshlrev_b32 v55, 16, v162
    v_mul_f32 v52, v52, v164
    v_mul_f32 v53, v53, v164
    v_mul_f32 v54, v54, v164
    v_mul_f32 v55, v55, v164
    v_cvt_pk_bf16_f32 v53, v52, v53
    v_lshlrev_b32 v52, 16, v53
    v_and_b32 v53, 0xffff0000, v53
    v_cvt_pk_bf16_f32 v55, v54, v55
    v_lshlrev_b32 v54, 16, v55
    v_and_b32 v55, 0xffff0000, v55
    v_mfma_f32_16x16x32_bf16 v[28:31], v[92:95], v[84:87], v[28:31]
    v_mfma_f32_16x16x32_bf16 v[20:23], v[88:91], v[84:87], v[20:23]
    v_mfma_f32_16x16x32_bf16 v[24:27], v[60:63], v[84:87], v[24:27]
    v_mfma_f32_16x16x32_bf16 v[16:19], v[56:59], v[84:87], v[16:19]
    s_waitcnt lgkmcnt(1)
    v_mfma_f32_16x16x32_bf16 v[28:31], v[100:103], v[80:83], v[28:31]
    v_mfma_f32_16x16x32_bf16 v[20:23], v[96:99], v[80:83], v[20:23]
    v_mfma_f32_16x16x32_bf16 v[24:27], v[68:71], v[80:83], v[24:27]
    v_mfma_f32_16x16x32_bf16 v[16:19], v[64:67], v[80:83], v[16:19]
    s_waitcnt lgkmcnt(0)
    v_mfma_f32_16x16x32_bf16 v[28:31], v[108:111], v[36:39], v[28:31]
    v_mfma_f32_16x16x32_bf16 v[20:23], v[104:107], v[36:39], v[20:23]
    v_mfma_f32_16x16x32_bf16 v[24:27], v[76:79], v[36:39], v[24:27]
    v_mfma_f32_16x16x32_bf16 v[16:19], v[72:75], v[36:39], v[16:19]
    s_mov_b32 exec_lo, 0xc000c000
    s_mov_b32 exec_hi, 0xc000c000
    s_nop 2
    ds_write_b128 v165, v[28:31] offset:128
    ds_write_b32 v166, v166 offset:64
    s_mov_b64 exec, -1
    s_setprio 0
    s_waitcnt vmcnt(7)
    s_cmp_lt_u32 s2, 128
    s_cbranch_scc1 C_EPI
    s_waitcnt vmcnt(4)
    s_branch C_EPI
C_P1:
    s_setprio 2
    ds_read_b128 v[32:35], v8 offset:2528
    ds_read_b128 v[36:39], v8 offset:3040
    ds_read_b128 v[40:43], v8 offset:2656
    s_waitcnt lgkmcnt(2)
    v_mfma_f32_16x16x32_bf16 v[144:147], v[128:131], v[32:35], 0
    v_mfma_f32_16x16x32_bf16 v[148:151], v[132:135], v[32:35], 0
    v_mfma_f32_16x16x32_bf16 v[152:155], v[136:139], v[32:35], 0
    v_mfma_f32_16x16x32_bf16 v[156:159], v[140:143], v[32:35], 0
    v_mfma_f32_16x16x32_bf16 v[28:31], v[52:55], v[32:35], 0
    v_mfma_f32_16x16x32_bf16 v[20:23], v[48:51], v[32:35], 0
    ds_read_b128 v[44:47], v8 offset:2784
    s_waitcnt lgkmcnt(2)
    v_mfma_f32_16x16x32_bf16 v[116:119], v[128:131], v[36:39], 0
    v_mfma_f32_16x16x32_bf16 v[160:163], v[132:135], v[36:39], 0
    v_mfma_f32_16x16x32_bf16 v[120:123], v[136:139], v[36:39], 0
    v_mfma_f32_16x16x32_bf16 v[124:127], v[140:143], v[36:39], 0
    v_mfma_f32_16x16x32_bf16 v[28:31], v[84:87], v[36:39], v[28:31]
    v_mfma_f32_16x16x32_bf16 v[20:23], v[80:83], v[36:39], v[20:23]
    v_mfma_f32_16x16x32_bf16 v[24:27], v[52:55], v[36:39], 0
    v_mfma_f32_16x16x32_bf16 v[16:19], v[48:51], v[36:39], 0
    v_cvt_pk_bf16_f32 v144, v144, v145
    v_cvt_pk_bf16_f32 v145, v146, v147
    ds_write_b64 v4, v[144:145] offset:1768
    v_cvt_pk_bf16_f32 v148, v148, v149
    v_cvt_pk_bf16_f32 v149, v150, v151
    ds_write_b64 v4, v[148:149] offset:5224
    v_cvt_pk_bf16_f32 v152, v152, v153
    v_cvt_pk_bf16_f32 v153, v154, v155
    ds_write_b64 v4, v[152:153] offset:8680
    v_cvt_pk_bf16_f32 v156, v156, v157
    v_cvt_pk_bf16_f32 v157, v158, v159
    ds_write_b64 v4, v[156:157] offset:12136
    ds_read_b128 v[32:35], v8 offset:2912
    s_waitcnt lgkmcnt(6)
    v_mfma_f32_16x16x32_bf16 v[28:31], v[60:63], v[40:43], v[28:31]
    v_mfma_f32_16x16x32_bf16 v[20:23], v[56:59], v[40:43], v[20:23]
    v_cvt_pk_bf16_f32 v116, v116, v117
    v_cvt_pk_bf16_f32 v117, v118, v119
    ds_write_b64 v4, v[116:117] offset:1224
    v_cvt_pk_bf16_f32 v160, v160, v161
    v_cvt_pk_bf16_f32 v161, v162, v163
    ds_write_b64 v4, v[160:161] offset:4680
    v_cvt_pk_bf16_f32 v120, v120, v121
    v_cvt_pk_bf16_f32 v121, v122, v123
    ds_write_b64 v4, v[120:121] offset:8136
    v_cvt_pk_bf16_f32 v124, v124, v125
    v_cvt_pk_bf16_f32 v125, v126, v127
    ds_write_b64 v4, v[124:125] offset:11592
    s_mov_b64 exec, 0x1
    ds_write_b32 v166, v166 offset:4
    s_mov_b64 exec, -1
    s_setprio 1
    ds_read_b128 v[36:39], v8 offset:3168
    ds_read_b64 v[144:145], v9 offset:4608
    ds_read_b64 v[146:147], v9 offset:4616
    ds_read_b64 v[148:149], v9 offset:4672
    ds_read_b64 v[150:151], v9 offset:4680
    ds_read_b64 v[152:153], v9 offset:4736
    ds_read_b64 v[154:155], v9 offset:4744
    ds_read_b64 v[156:157], v9 offset:4800
    ds_read_b64 v[158:159], v9 offset:4808
    ds_read_b64 v[160:161], v2 offset:512
    ds_read_b64 v[162:163], v2
    s_cmp_ge_u32 s2, 128
    s_cbranch_scc1 C_NX1
    s_mov_b32 m0, s58
    s_mov_b64 exec, s[56:57]
    global_load_lds_dwordx4 v5, s[72:73]
    s_add_u32 m0, s58, 896
    s_nop 0
    global_load_lds_dwordx4 v6, s[72:73]
    s_add_u32 m0, s58, 1792
    s_mov_b64 exec, 0x3f
    global_load_lds_dwordx4 v3, s[74:75]
    s_mov_b64 exec, -1
C_NX1:
    s_waitcnt lgkmcnt(15)
    v_mfma_f32_16x16x32_bf16 v[28:31], v[68:71], v[44:47], v[28:31]
    v_mfma_f32_16x16x32_bf16 v[20:23], v[64:67], v[44:47], v[20:23]
    ds_read_b128 v[40:43], v8 offset:3296
    v_mfma_f32_16x16x32_bf16 v[28:31], v[76:79], v[32:35], v[28:31]
    v_mfma_f32_16x16x32_bf16 v[20:23], v[72:75], v[32:35], v[20:23]
    ds_read_b128 v[128:131], v8 offset:3424
    s_waitcnt lgkmcnt(2)
    v_and_b32 v48, 0xffff0000, v161
    v_lshlrev_b32 v49, 16, v161
    v_and_b32 v50, 0xffff0000, v160
    v_lshlrev_b32 v51, 16, v160
    v_mul_f32 v48, v48, v164
    v_mul_f32 v49, v49, v164
    v_mul_f32 v50, v50, v164
    v_mul_f32 v51, v51, v164
    v_cvt_pk_bf16_f32 v49, v48, v49
    v_lshlrev_b32 v48, 16, v49
    v_and_b32 v49, 0xffff0000, v49
    v_cvt_pk_bf16_f32 v51, v50, v51
    v_lshlrev_b32 v50, 16, v51
    v_and_b32 v51, 0xffff0000, v51
    v_and_b32 v52, 0xffff0000, v163
    v_lshlrev_b32 v53, 16, v163
    v_and_b32 v54, 0xffff0000, v162
    v_lshlrev_b32 v55, 16, v162
    v_mul_f32 v52, v52, v164
    v_mul_f32 v53, v53, v164
    v_mul_f32 v54, v54, v164
    v_mul_f32 v55, v55, v164
    v_cvt_pk_bf16_f32 v53, v52, v53
    v_lshlrev_b32 v52, 16, v53
    v_and_b32 v53, 0xffff0000, v53
    v_cvt_pk_bf16_f32 v55, v54, v55
    v_lshlrev_b32 v54, 16, v55
    v_and_b32 v55, 0xffff0000, v55
    v_mfma_f32_16x16x32_bf16 v[28:31], v[92:95], v[36:39], v[28:31]
    v_mfma_f32_16x16x32_bf16 v[20:23], v[88:91], v[36:39], v[20:23]
    v_mfma_f32_16x16x32_bf16 v[24:27], v[60:63], v[36:39], v[24:27]
    v_mfma_f32_16x16x32_bf16 v[16:19], v[56:59], v[36:39], v[16:19]
    ds_read_b128 v[132:135], v8 offset:3552
    s_waitcnt lgkmcnt(2)
    v_mfma_f32_16x16x32_bf16 v[28:31], v[100:103], v[40:43], v[28:31]
    v_mfma_f32_16x16x32_bf16 v[20:23], v[96:99], v[40:43], v[20:23]
    v_mfma_f32_16x16x32_bf16 v[24:27], v[68:71], v[40:43], v[24:27]
    v_mfma_f32_16x16x32_bf16 v[16:19], v[64:67], v[40:43], v[16:19]
    ds_read_b96 v[60:62], v166
    ds_read_b128 v[136:139], v8 offset:3680
    s_waitcnt lgkmcnt(3)
    v_mfma_f32_16x16x32_bf16 v[28:31], v[108:111], v[128:131], v[28:31]
    v_mfma_f32_16x16x32_bf16 v[20:23], v[104:107], v[128:131], v[20:23]
    v_mfma_f32_16x16x32_bf16 v[24:27], v[76:79], v[128:131], v[24:27]
    v_mfma_f32_16x16x32_bf16 v[16:19], v[72:75], v[128:131], v[16:19]
    s_waitcnt lgkmcnt(1)
C_FL1:
    v_min3_u32 v60, v60, v61, v62
    v_cmp_eq_u32 vcc, 0, v60
    s_nop 4
    s_cbranch_vccz C_FD1
    ds_read_b96 v[60:62], v166
    s_sub_u32 s60, s60, 1
    s_cmp_gt_i32 s60, 0
    s_waitcnt lgkmcnt(0)
    s_cbranch_scc1 C_FL1
C_FD1:
    ds_read_b128 v[140:143], v8 offset:3808
    v_mfma_f32_16x16x32_bf16 v[20:23], v[112:115], v[132:135], v[20:23]
    v_mfma_f32_16x16x32_bf16 v[24:27], v[84:87], v[132:135], v[24:27]
    v_mfma_f32_16x16x32_bf16 v[16:19], v[80:83], v[132:135], v[16:19]
    s_mov_b32 exec_lo, 0xc000c000
    s_mov_b32 exec_hi, 0xc000c000
    ds_write_b128 v165, v[28:31] offset:256
    ds_write_b32 v166, v166 offset:68
    s_mov_b64 exec, -1
    ds_read_b128 v[44:47], v8 offset:3936
    s_waitcnt lgkmcnt(4)
    v_mfma_f32_16x16x32_bf16 v[24:27], v[92:95], v[136:139], v[24:27]
    v_mfma_f32_16x16x32_bf16 v[16:19], v[88:91], v[136:139], v[16:19]
    ds_read_b128 v[32:35], v8 offset:4064
    ds_read_b64_tr_b16 v[36:37], v11 offset:0
    ds_read_b64_tr_b16 v[38:39], v12 offset:0
    ds_read_b64_tr_b16 v[68:69], v11 offset:272
    ds_read_b64_tr_b16 v[70:71], v12 offset:272
    s_waitcnt lgkmcnt(8)
    v_mfma_f32_16x16x32_bf16 v[24:27], v[100:103], v[140:143], v[24:27]
    v_mfma_f32_16x16x32_bf16 v[16:19], v[96:99], v[140:143], v[16:19]
    ds_read_b64_tr_b16 v[64:65], v11 offset:544
    ds_read_b64_tr_b16 v[66:67], v12 offset:544
    s_waitcnt lgkmcnt(7)
    v_mfma_f32_16x16x32_bf16 v[24:27], v[108:111], v[44:47], v[24:27]
    v_mfma_f32_16x16x32_bf16 v[16:19], v[104:107], v[44:47], v[16:19]
    ds_read_b64_tr_b16 v[40:41], v11 offset:816
    ds_read_b64_tr_b16 v[42:43], v12 offset:816
    s_waitcnt lgkmcnt(8)
    v_mfma_f32_16x16x32_bf16 v[16:19], v[112:115], v[32:35], v[16:19]
    s_waitcnt lgkmcnt(6)
    v_mfma_f32_16x16x32_bf16 v[20:23], v[36:39], v[156:159], v[20:23]
    v_mfma_f32_16x16x32_bf16 v[16:19], v[36:39], v[148:151], v[16:19]
    s_waitcnt lgkmcnt(4)
    v_mfma_f32_16x16x32_bf16 v[20:23], v[68:71], v[152:155], v[20:23]
    v_mfma_f32_16x16x32_bf16 v[16:19], v[68:71], v[144:147], v[16:19]
    ds_read_b32 v60, v166 offset:64
    ds_read_b128 v[56:59], v165 offset:128
    s_waitcnt lgkmcnt(4)
    v_mfma_f32_16x16x32_bf16 v[20:23], v[64:67], v[148:151], v[20:23]
    s_waitcnt lgkmcnt(2)
    v_mfma_f32_16x16x32_bf16 v[20:23], v[40:43], v[144:147], v[20:23]
    s_setprio 0
    s_waitcnt lgkmcnt(0)
C_CL1:
    v_cmp_eq_u32 vcc, 0, v60
    s_nop 4
    s_cbranch_vccz C_CD
    ds_read_b32 v60, v166 offset:64
    ds_read_b128 v[56:59], v165 offset:128
    s_sub_u32 s60, s60, 1
    s_cmp_gt_i32 s60, 0
    s_waitcnt lgkmcnt(0)
    s_cbranch_scc1 C_CL1
    s_branch C_CD
C_P2:
    s_setprio 2
    ds_read_b128 v[32:35], v8 offset:1504
    ds_read_b128 v[36:39], v8 offset:2016
    ds_read_b128 v[40:43], v8 offset:1632
    s_waitcnt lgkmcnt(2)
    v_mfma_f32_16x16x32_bf16 v[116:119], v[152:155], v[32:35], 0
    v_mfma_f32_16x16x32_bf16 v[160:163], v[156:159], v[32:35], 0
    v_mfma_f32_16x16x32_bf16 v[28:31], v[52:55], v[32:35], 0
    v_mfma_f32_16x16x32_bf16 v[20:23], v[48:51], v[32:35], 0
    ds_read_b128 v[44:47], v8 offset:1760
    s_waitcnt lgkmcnt(2)
    v_mfma_f32_16x16x32_bf16 v[120:123], v[152:155], v[36:39], 0
    v_mfma_f32_16x16x32_bf16 v[124:127], v[156:159], v[36:39], 0
    v_mfma_f32_16x16x32_bf16 v[28:31], v[84:87], v[36:39], v[28:31]
    v_mfma_f32_16x16x32_bf16 v[20:23], v[80:83], v[36:39], v[20:23]
    v_mfma_f32_16x16x32_bf16 v[24:27], v[52:55], v[36:39], 0
    v_mfma_f32_16x16x32_bf16 v[16:19], v[48:51], v[36:39], 0
    v_cvt_pk_bf16_f32 v116, v116, v117
    v_cvt_pk_bf16_f32 v117, v118, v119
    ds_write_b64 v4, v[116:117] offset:2856
    v_cvt_pk_bf16_f32 v160, v160, v161
    v_cvt_pk_bf16_f32 v161, v162, v163
    ds_write_b64 v4, v[160:161] offset:6312
    ds_read_b128 v[32:35], v8 offset:1888
    s_waitcnt lgkmcnt(4)
    v_mfma_f32_16x16x32_bf16 v[28:31], v[60:63], v[40:43], v[28:31]
    v_mfma_f32_16x16x32_bf16 v[20:23], v[56:59], v[40:43], v[20:23]
    v_cvt_pk_bf16_f32 v120, v120, v121
    v_cvt_pk_bf16_f32 v121, v122, v123
    ds_write_b64 v4, v[120:121] offset:2312
    v_cvt_pk_bf16_f32 v124, v124, v125
    v_cvt_pk_bf16_f32 v125, v126, v127
    ds_write_b64 v4, v[124:125] offset:5768
    s_mov_b64 exec, 0x1
    ds_write_b32 v166, v166 offset:8
    s_mov_b64 exec, -1
    s_setprio 1
    ds_read_b128 v[36:39], v8 offset:2144
    ds_read_b64 v[116:117], v7 offset:1088
    ds_read_b64 v[118:119], v7 offset:1096
    ds_read_b64 v[120:121], v10 offset:5120
    ds_read_b64 v[122:123], v10 offset:5128
    ds_read_b64 v[124:125], v10 offset:5184
    ds_read_b64 v[126:127], v10 offset:5192
    ds_read_b64 v[160:161], v2 offset:512
    ds_read_b64 v[162:163], v2
    s_cmp_ge_u32 s2, 128
    s_cbranch_scc1 C_NX2
    s_mov_b32 m0, s58
    s_mov_b64 exec, s[56:57]
    global_load_lds_dwordx4 v5, s[72:73]
    s_add_u32 m0, s58, 896
    s_nop 0
    global_load_lds_dwordx4 v6, s[72:73]
    s_add_u32 m0, s58, 1792
    s_mov_b64 exec, 0x3f
    global_load_lds_dwordx4 v3, s[74:75]
    s_mov_b64 exec, -1
C_NX2:
    s_waitcnt lgkmcnt(15)
    v_mfma_f32_16x16x32_bf16 v[28:31], v[68:71], v[44:47], v[28:31]
    v_mfma_f32_16x16x32_bf16 v[20:23], v[64:67], v[44:47], v[20:23]
    ds_read_b128 v[40:43], v8 offset:2272
    s_waitcnt lgkmcnt(13)
    v_mfma_f32_16x16x32_bf16 v[28:31], v[76:79], v[32:35], v[28:31]
    v_mfma_f32_16x16x32_bf16 v[20:23], v[72:75], v[32:35], v[20:23]
    ds_read_b128 v[152:155], v8 offset:2400
    s_waitcnt lgkmcnt(2)
    v_and_b32 v48, 0xffff0000, v161
    v_lshlrev_b32 v49, 16, v161
    v_and_b32 v50, 0xffff0000, v160
    v_lshlrev_b32 v51, 16, v160
    v_mul_f32 v48, v48, v164
    v_mul_f32 v49, v49, v164
    v_mul_f32 v50, v50, v164
    v_mul_f32 v51, v51, v164
    v_cvt_pk_bf16_f32 v49, v48, v49
    v_lshlrev_b32 v48, 16, v49
    v_and_b32 v49, 0xffff0000, v49
    v_cvt_pk_bf16_f32 v51, v50, v51
    v_lshlrev_b32 v50, 16, v51
    v_and_b32 v51, 0xffff0000, v51
    v_and_b32 v52, 0xffff0000, v163
    v_lshlrev_b32 v53, 16, v163
    v_and_b32 v54, 0xffff0000, v162
    v_lshlrev_b32 v55, 16, v162
    v_mul_f32 v52, v52, v164
    v_mul_f32 v53, v53, v164
    v_mul_f32 v54, v54, v164
    v_mul_f32 v55, v55, v164
    v_cvt_pk_bf16_f32 v53, v52, v53
    v_lshlrev_b32 v52, 16, v53
    v_and_b32 v53, 0xffff0000, v53
    v_cvt_pk_bf16_f32 v55, v54, v55
    v_lshlrev_b32 v54, 16, v55
    v_and_b32 v55, 0xffff0000, v55
    v_mfma_f32_16x16x32_bf16 v[28:31], v[92:95], v[36:39], v[28:31]
    v_mfma_f32_16x16x32_bf16 v[20:23], v[88:91], v[36:39], v[20:23]
    v_mfma_f32_16x16x32_bf16 v[24:27], v[60:63], v[36:39], v[24:27]
    v_mfma_f32_16x16x32_bf16 v[16:19], v[56:59], v[36:39], v[16:19]
    ds_read_b128 v[156:159], v8 offset:2528
    s_waitcnt lgkmcnt(2)
    v_mfma_f32_16x16x32_bf16 v[28:31], v[100:103], v[40:43], v[28:31]
    v_mfma_f32_16x16x32_bf16 v[20:23], v[96:99], v[40:43], v[20:23]
    v_mfma_f32_16x16x32_bf16 v[24:27], v[68:71], v[40:43], v[24:27]
    v_mfma_f32_16x16x32_bf16 v[16:19], v[64:67], v[40:43], v[16:19]
    ds_read_b128 v[44:47], v8 offset:2656
    s_waitcnt lgkmcnt(2)
    v_mfma_f32_16x16x32_bf16 v[28:31], v[108:111], v[152:155], v[28:31]
    v_mfma_f32_16x16x32_bf16 v[20:23], v[104:107], v[152:155], v[20:23]
    v_mfma_f32_16x16x32_bf16 v[24:27], v[76:79], v[152:155], v[24:27]
    v_mfma_f32_16x16x32_bf16 v[16:19], v[72:75], v[152:155], v[16:19]
    ds_read_b128 v[32:35], v8 offset:2784
    s_waitcnt lgkmcnt(2)
    v_mfma_f32_16x16x32_bf16 v[20:23], v[112:115], v[156:159], v[20:23]
    v_mfma_f32_16x16x32_bf16 v[24:27], v[84:87], v[156:159], v[24:27]
    v_mfma_f32_16x16x32_bf16 v[16:19], v[80:83], v[156:159], v[16:19]
    s_mov_b32 exec_lo, 0xc000c000
    s_mov_b32 exec_hi, 0xc000c000
    ds_write_b128 v165, v[28:31] offset:384
    ds_write_b32 v166, v166 offset:72
    s_mov_b64 exec, -1
    ds_read_b96 v[60:62], v166
    ds_read_b128 v[36:39], v8 offset:2912
    s_waitcnt lgkmcnt(5)
    v_mfma_f32_16x16x32_bf16 v[24:27], v[92:95], v[44:47], v[24:27]
    v_mfma_f32_16x16x32_bf16 v[16:19], v[88:91], v[44:47], v[16:19]
    s_waitcnt lgkmcnt(1)
C_FL2:
    v_min3_u32 v60, v60, v61, v62
    v_cmp_eq_u32 vcc, 0, v60
    s_nop 4
    s_cbranch_vccz C_FD2
    ds_read_b96 v[60:62], v166
    s_sub_u32 s60, s60, 1
    s_cmp_gt_i32 s60, 0
    s_waitcnt lgkmcnt(0)
    s_cbranch_scc1 C_FL2
C_FD2:
    ds_read_b128 v[68:71], v8 offset:3040
    v_mfma_f32_16x16x32_bf16 v[24:27], v[100:103], v[32:35], v[24:27]
    v_mfma_f32_16x16x32_bf16 v[16:19], v[96:99], v[32:35], v[16:19]
    ds_read_b128 v[64:67], v8 offset:3552
    s_waitcnt lgkmcnt(2)
    v_mfma_f32_16x16x32_bf16 v[24:27], v[108:111], v[36:39], v[24:27]
    v_mfma_f32_16x16x32_bf16 v[16:19], v[104:107], v[36:39], v[16:19]
    ds_read_b128 v[40:43], v8 offset:4064
    ds_read_b64_tr_b16 v[76:77], v13 offset:6912
    ds_read_b64_tr_b16 v[78:79], v14 offset:6912
    ds_read_b64_tr_b16 v[72:73], v13 offset:7456
    ds_read_b64_tr_b16 v[74:75], v14 offset:7456
    s_waitcnt lgkmcnt(6)
    v_mfma_f32_16x16x32_bf16 v[16:19], v[112:115], v[68:71], v[16:19]
    ds_read_b64_tr_b16 v[152:153], v11 offset:0
    ds_read_b64_tr_b16 v[154:155], v12 offset:0
    s_waitcnt lgkmcnt(7)
    v_mfma_f32_16x16x32_bf16 v[20:23], v[116:119], v[64:67], v[20:23]
    ds_read_b64_tr_b16 v[84:85], v11 offset:272
    ds_read_b64_tr_b16 v[86:87], v12 offset:272
    s_waitcnt lgkmcnt(8)
    v_mfma_f32_16x16x32_bf16 v[16:19], v[116:119], v[40:43], v[16:19]
    ds_read_b64_tr_b16 v[80:81], v11 offset:544
    ds_read_b64_tr_b16 v[82:83], v12 offset:544
    s_waitcnt lgkmcnt(8)
    v_mfma_f32_16x16x32_bf16 v[20:23], v[76:79], v[124:127], v[20:23]
    v_mfma_f32_16x16x32_bf16 v[16:19], v[76:79], v[120:123], v[16:19]
    ds_read_b64_tr_b16 v[156:157], v11 offset:816
    ds_read_b64_tr_b16 v[158:159], v12 offset:816
    s_waitcnt lgkmcnt(8)
    v_mfma_f32_16x16x32_bf16 v[20:23], v[72:75], v[120:123], v[20:23]
    ds_read_b64_tr_b16 v[92:93], v11 offset:1088
    ds_read_b64_tr_b16 v[94:95], v12 offset:1088
    s_waitcnt lgkmcnt(8)
    v_mfma_f32_16x16x32_bf16 v[16:19], v[152:155], v[148:151], v[16:19]
    ds_read_b64_tr_b16 v[88:89], v11 offset:1360
    ds_read_b64_tr_b16 v[90:91], v12 offset:1360
    s_waitcnt lgkmcnt(8)
    v_mfma_f32_16x16x32_bf16 v[16:19], v[84:87], v[144:147], v[16:19]
    ds_read_b64_tr_b16 v[44:45], v11 offset:1632
    ds_read_b64_tr_b16 v[46:47], v12 offset:1632
    s_waitcnt lgkmcnt(8)
    v_mfma_f32_16x16x32_bf16 v[20:23], v[80:83], v[148:151], v[20:23]
    v_mfma_f32_16x16x32_bf16 v[16:19], v[80:83], v[140:143], v[16:19]
    ds_read_b64_tr_b16 v[100:101], v11 offset:1904
    ds_read_b64_tr_b16 v[102:103], v12 offset:1904
    s_waitcnt lgkmcnt(8)
    v_mfma_f32_16x16x32_bf16 v[20:23], v[156:159], v[144:147], v[20:23]
    v_mfma_f32_16x16x32_bf16 v[16:19], v[156:159], v[136:139], v[16:19]
    s_waitcnt lgkmcnt(6)
    v_mfma_f32_16x16x32_bf16 v[20:23], v[92:95], v[140:143], v[20:23]
    v_mfma_f32_16x16x32_bf16 v[16:19], v[92:95], v[132:135], v[16:19]
    s_waitcnt lgkmcnt(4)
    v_mfma_f32_16x16x32_bf16 v[20:23], v[88:91], v[136:139], v[20:23]
    v_mfma_f32_16x16x32_bf16 v[16:19], v[88:91], v[128:131], v[16:19]
    ds_read_b32 v60, v166 offset:68
    ds_read_b128 v[56:59], v165 offset:256
    s_waitcnt lgkmcnt(4)
    v_mfma_f32_16x16x32_bf16 v[20:23], v[44:47], v[132:135], v[20:23]
    s_waitcnt lgkmcnt(2)
    v_mfma_f32_16x16x32_bf16 v[20:23], v[100:103], v[128:131], v[20:23]
    s_setprio 0
    s_waitcnt lgkmcnt(0)
C_CL2:
    v_cmp_eq_u32 vcc, 0, v60
    s_nop 4
    s_cbranch_vccz C_CD
    ds_read_b32 v60, v166 offset:68
    ds_read_b128 v[56:59], v165 offset:256
    s_sub_u32 s60, s60, 1
    s_cmp_gt_i32 s60, 0
    s_waitcnt lgkmcnt(0)
    s_cbranch_scc1 C_CL2
    s_branch C_CD
C_P3:
    s_setprio 1
    ds_read_b128 v[32:35], v8 offset:480
    ds_read_b128 v[36:39], v8 offset:608
    ds_read_b128 v[40:43], v8 offset:736
    ds_read_b64 v[160:161], v2 offset:512
    ds_read_b64 v[162:163], v2
    s_waitcnt lgkmcnt(4)
    v_mfma_f32_16x16x32_bf16 v[28:31], v[52:55], v[32:35], 0
    v_mfma_f32_16x16x32_bf16 v[20:23], v[48:51], v[32:35], 0
    ds_read_b128 v[44:47], v8 offset:864
    s_waitcnt lgkmcnt(4)
    v_mfma_f32_16x16x32_bf16 v[28:31], v[60:63], v[36:39], v[28:31]
    v_mfma_f32_16x16x32_bf16 v[20:23], v[56:59], v[36:39], v[20:23]
    s_cmp_lg_u32 s38, 9
    s_cbranch_scc1 C_NPL0
    s_cmp_ge_u32 s2, 96
    s_cselect_b32 s52, 16, 8
    v_lshrrev_b32 v9, 1, v3
    v_writelane_b32 v9, s52, 3
    s_and_b32 s52, s2, 31
    s_lshl_b32 s52, s52, 7
    v_add_u32 v9, s52, v9
    s_mov_b64 exec, 0xf
    buffer_load_dword v10, v9, s[40:43], 0 offen offset:2048 sc1
    s_mov_b64 exec, -1
C_NPL0:
    s_cmp_ge_u32 s2, 128
    s_cbranch_scc1 C_NX3
    s_mov_b32 m0, s58
    s_mov_b64 exec, s[56:57]
    global_load_lds_dwordx4 v5, s[72:73]
    s_add_u32 m0, s58, 896
    s_nop 0
    global_load_lds_dwordx4 v6, s[72:73]
    s_add_u32 m0, s58, 1792
    s_mov_b64 exec, 0x3f
    global_load_lds_dwordx4 v3, s[74:75]
    s_mov_b64 exec, -1
C_NX3:
    ds_read_b128 v[32:35], v8 offset:992
    s_waitcnt lgkmcnt(4)
    v_mfma_f32_16x16x32_bf16 v[28:31], v[68:71], v[40:43], v[28:31]
    v_mfma_f32_16x16x32_bf16 v[20:23], v[64:67], v[40:43], v[20:23]
    ds_read_b128 v[36:39], v8 offset:1120
    s_waitcnt lgkmcnt(2)
    v_mfma_f32_16x16x32_bf16 v[28:31], v[76:79], v[44:47], v[28:31]
    v_mfma_f32_16x16x32_bf16 v[20:23], v[72:75], v[44:47], v[20:23]
    ds_read_b128 v[40:43], v8 offset:1248
    s_waitcnt lgkmcnt(2)
    v_mfma_f32_16x16x32_bf16 v[28:31], v[84:87], v[32:35], v[28:31]
    v_mfma_f32_16x16x32_bf16 v[20:23], v[80:83], v[32:35], v[20:23]
    v_mfma_f32_16x16x32_bf16 v[24:27], v[52:55], v[32:35], 0
    v_mfma_f32_16x16x32_bf16 v[16:19], v[48:51], v[32:35], 0
    ds_read_b128 v[44:47], v8 offset:1376
    s_waitcnt lgkmcnt(2)
    v_mfma_f32_16x16x32_bf16 v[28:31], v[92:95], v[36:39], v[28:31]
    v_mfma_f32_16x16x32_bf16 v[20:23], v[88:91], v[36:39], v[20:23]
    v_mfma_f32_16x16x32_bf16 v[24:27], v[60:63], v[36:39], v[24:27]
    v_mfma_f32_16x16x32_bf16 v[16:19], v[56:59], v[36:39], v[16:19]
    ds_read_b128 v[32:35], v8 offset:1504
    v_and_b32 v48, 0xffff0000, v161
    v_lshlrev_b32 v49, 16, v161
    v_and_b32 v50, 0xffff0000, v160
    v_lshlrev_b32 v51, 16, v160
    v_mul_f32 v48, v48, v164
    v_mul_f32 v49, v49, v164
    v_mul_f32 v50, v50, v164
    v_mul_f32 v51, v51, v164
    v_cvt_pk_bf16_f32 v49, v48, v49
    v_lshlrev_b32 v48, 16, v49
    v_and_b32 v49, 0xffff0000, v49
    v_cvt_pk_bf16_f32 v51, v50, v51
    v_lshlrev_b32 v50, 16, v51
    v_and_b32 v51, 0xffff0000, v51
    v_and_b32 v52, 0xffff0000, v163
    v_lshlrev_b32 v53, 16, v163
    v_and_b32 v54, 0xffff0000, v162
    v_lshlrev_b32 v55, 16, v162
    v_mul_f32 v52, v52, v164
    v_mul_f32 v53, v53, v164
    v_mul_f32 v54, v54, v164
    v_mul_f32 v55, v55, v164
    v_cvt_pk_bf16_f32 v53, v52, v53
    v_lshlrev_b32 v52, 16, v53
    v_and_b32 v53, 0xffff0000, v53
    v_cvt_pk_bf16_f32 v55, v54, v55
    v_lshlrev_b32 v54, 16, v55
    v_and_b32 v55, 0xffff0000, v55
    s_waitcnt lgkmcnt(2)
    v_mfma_f32_16x16x32_bf16 v[28:31], v[100:103], v[40:43], v[28:31]
    v_mfma_f32_16x16x32_bf16 v[20:23], v[96:99], v[40:43], v[20:23]
    v_mfma_f32_16x16x32_bf16 v[24:27], v[68:71], v[40:43], v[24:27]
    v_mfma_f32_16x16x32_bf16 v[16:19], v[64:67], v[40:43], v[16:19]
    ds_read_b128 v[36:39], v8 offset:1632
    s_waitcnt lgkmcnt(2)
    v_mfma_f32_16x16x32_bf16 v[28:31], v[108:111], v[44:47], v[28:31]
    v_mfma_f32_16x16x32_bf16 v[20:23], v[104:107], v[44:47], v[20:23]
    v_mfma_f32_16x16x32_bf16 v[24:27], v[76:79], v[44:47], v[24:27]
    v_mfma_f32_16x16x32_bf16 v[16:19], v[72:75], v[44:47], v[16:19]
    ds_read_b128 v[68:71], v8 offset:1760
    s_waitcnt lgkmcnt(2)
    v_mfma_f32_16x16x32_bf16 v[20:23], v[112:115], v[32:35], v[20:23]
    v_mfma_f32_16x16x32_bf16 v[24:27], v[84:87], v[32:35], v[24:27]
    v_mfma_f32_16x16x32_bf16 v[16:19], v[80:83], v[32:35], v[16:19]
    ds_read_b96 v[60:62], v166
    ds_read_b128 v[64:67], v8 offset:1888
    s_waitcnt lgkmcnt(3)
    v_mfma_f32_16x16x32_bf16 v[24:27], v[92:95], v[36:39], v[24:27]
    v_mfma_f32_16x16x32_bf16 v[16:19], v[88:91], v[36:39], v[16:19]
    s_waitcnt lgkmcnt(1)
C_FL3:
    v_min3_u32 v60, v60, v61, v62
    v_cmp_eq_u32 vcc, 0, v60
    s_nop 4
    s_cbranch_vccz C_FD3
    ds_read_b96 v[60:62], v166
    s_sub_u32 s60, s60, 1
    s_cmp_gt_i32 s60, 0
    s_waitcnt lgkmcnt(0)
    s_cbranch_scc1 C_FL3
C_FD3:
    ds_read_b128 v[40:43], v8 offset:2016
    v_mfma_f32_16x16x32_bf16 v[24:27], v[100:103], v[68:71], v[24:27]
    v_mfma_f32_16x16x32_bf16 v[16:19], v[96:99], v[68:71], v[16:19]
    ds_read_b128 v[76:79], v8 offset:2528
    s_waitcnt lgkmcnt(2)
    v_mfma_f32_16x16x32_bf16 v[24:27], v[108:111], v[64:67], v[24:27]
    v_mfma_f32_16x16x32_bf16 v[16:19], v[104:107], v[64:67], v[16:19]
    ds_read_b128 v[72:75], v8 offset:3040
    ds_read_b64_tr_b16 v[44:45], v13 offset:6912
    ds_read_b64_tr_b16 v[46:47], v14 offset:6912
    ds_read_b64_tr_b16 v[84:85], v13 offset:7456
    ds_read_b64_tr_b16 v[86:87], v14 offset:7456
    s_waitcnt lgkmcnt(6)
    v_mfma_f32_16x16x32_bf16 v[16:19], v[112:115], v[40:43], v[16:19]
    ds_read_b64_tr_b16 v[80:81], v13 offset:8000
    ds_read_b64_tr_b16 v[82:83], v14 offset:8000
    s_waitcnt lgkmcnt(7)
    v_mfma_f32_16x16x32_bf16 v[20:23], v[116:119], v[76:79], v[20:23]
    ds_read_b64_tr_b16 v[32:33], v13 offset:8544
    ds_read_b64_tr_b16 v[34:35], v14 offset:8544
    s_waitcnt lgkmcnt(8)
    v_mfma_f32_16x16x32_bf16 v[16:19], v[116:119], v[72:75], v[16:19]
    ds_read_b64_tr_b16 v[92:93], v11 offset:1088
    ds_read_b64_tr_b16 v[94:95], v12 offset:1088
    s_waitcnt lgkmcnt(8)
    v_mfma_f32_16x16x32_bf16 v[20:23], v[44:47], v[124:127], v[20:23]
    v_mfma_f32_16x16x32_bf16 v[16:19], v[44:47], v[120:123], v[16:19]
    ds_read_b64_tr_b16 v[88:89], v11 offset:1360
    ds_read_b64_tr_b16 v[90:91], v12 offset:1360
    s_waitcnt lgkmcnt(8)
    v_mfma_f32_16x16x32_bf16 v[20:23], v[84:87], v[120:123], v[20:23]
    v_mfma_f32_16x16x32_bf16 v[16:19], v[84:87], v[156:159], v[16:19]
    ds_read_b64_tr_b16 v[36:37], v11 offset:1632
    ds_read_b64_tr_b16 v[38:39], v12 offset:1632
    s_waitcnt lgkmcnt(8)
    v_mfma_f32_16x16x32_bf16 v[20:23], v[80:83], v[156:159], v[20:23]
    v_mfma_f32_16x16x32_bf16 v[16:19], v[80:83], v[152:155], v[16:19]
    ds_read_b64_tr_b16 v[100:101], v11 offset:1904
    ds_read_b64_tr_b16 v[102:103], v12 offset:1904
    s_waitcnt lgkmcnt(8)
    v_mfma_f32_16x16x32_bf16 v[20:23], v[32:35], v[152:155], v[20:23]
    ds_read_b64_tr_b16 v[96:97], v11 offset:2176
    ds_read_b64_tr_b16 v[98:99], v12 offset:2176
    s_waitcnt lgkmcnt(8)
    v_mfma_f32_16x16x32_bf16 v[16:19], v[92:95], v[148:151], v[16:19]
    ds_read_b64_tr_b16 v[68:69], v11 offset:2448
    ds_read_b64_tr_b16 v[70:71], v12 offset:2448
    s_cmp_lg_u32 s38, 9
    s_cbranch_scc1 C_NPL
    s_mov_b64 exec, 0xf
    s_waitcnt vmcnt(3)
    s_cmp_lt_u32 s2, 128
    s_cbranch_scc1 C_NPW
    s_waitcnt vmcnt(0)
C_NPW:
    v_xor_b32 v5, s39, v10
    v_and_b32 v5, 0xffffdfff, v5
    v_cmp_ne_u32 vcc, 0, v5
    s_nop 4
    s_cbranch_vccz C_NPL2
    buffer_load_dword v4, v9, s[40:43], 0 offen offset:2048 sc1
C_NPL2:
    s_mov_b64 exec, -1
C_NPL:
    s_waitcnt lgkmcnt(8)
    v_mfma_f32_16x16x32_bf16 v[16:19], v[88:91], v[144:147], v[16:19]
    ds_read_b64_tr_b16 v[108:109], v11 offset:2720
    ds_read_b64_tr_b16 v[110:111], v12 offset:2720
    s_waitcnt lgkmcnt(8)
    v_mfma_f32_16x16x32_bf16 v[20:23], v[36:39], v[148:151], v[20:23]
    v_mfma_f32_16x16x32_bf16 v[16:19], v[36:39], v[140:143], v[16:19]
    ds_read_b64_tr_b16 v[104:105], v11 offset:2992
    ds_read_b64_tr_b16 v[106:107], v12 offset:2992
    s_waitcnt lgkmcnt(8)
    v_mfma_f32_16x16x32_bf16 v[20:23], v[100:103], v[144:147], v[20:23]
    v_mfma_f32_16x16x32_bf16 v[16:19], v[100:103], v[136:139], v[16:19]
    s_waitcnt lgkmcnt(6)
    v_mfma_f32_16x16x32_bf16 v[20:23], v[96:99], v[140:143], v[20:23]
    v_mfma_f32_16x16x32_bf16 v[16:19], v[96:99], v[132:135], v[16:19]
    s_waitcnt lgkmcnt(4)
    v_mfma_f32_16x16x32_bf16 v[20:23], v[68:71], v[136:139], v[20:23]
    v_mfma_f32_16x16x32_bf16 v[16:19], v[68:71], v[128:131], v[16:19]
    ds_read_b32 v60, v166 offset:72
    ds_read_b128 v[56:59], v165 offset:384
    s_waitcnt lgkmcnt(4)
    v_mfma_f32_16x16x32_bf16 v[20:23], v[108:111], v[132:135], v[20:23]
    s_waitcnt lgkmcnt(2)
    v_mfma_f32_16x16x32_bf16 v[20:23], v[104:107], v[128:131], v[20:23]
    s_setprio 0
    s_waitcnt lgkmcnt(0)
C_CL3:
    v_cmp_eq_u32 vcc, 0, v60
    s_nop 4
    s_cbranch_vccz C_CD
    ds_read_b32 v60, v166 offset:72
    ds_read_b128 v[56:59], v165 offset:384
    s_sub_u32 s60, s60, 1
    s_cmp_gt_i32 s60, 0
    s_waitcnt lgkmcnt(0)
    s_cbranch_scc1 C_CL3
C_CD:
    s_cmp_eq_u32 s38, 9
    s_cbranch_scc1 C_CD2
    s_waitcnt vmcnt(3)
    s_cmp_lt_u32 s2, 128
    s_cbranch_scc1 C_CD2
    s_waitcnt vmcnt(0)
C_CD2:
    s_mov_b32 exec_lo, 0x30003
    s_mov_b32 exec_hi, 0x30003
    s_nop 4
    v_pk_add_f32 v[16:17], v[16:17], v[56:57]
    v_pk_add_f32 v[18:19], v[18:19], v[58:59]
    s_mov_b64 exec, -1
C_EPI:
    s_nop 3
    s_movk_i32 s54, 0x3f80
    s_mov_b32 s55, 1.0
    v_add_f32_dpp v16, v24, v16 row_shr:2 row_mask:0xf bank_mask:0xf
    v_add_f32_dpp v17, v25, v17 row_shr:2 row_mask:0xf bank_mask:0xf
    v_add_f32_dpp v18, v26, v18 row_shr:2 row_mask:0xf bank_mask:0xf
    v_add_f32_dpp v19, v27, v19 row_shr:2 row_mask:0xf bank_mask:0xf
    v_add_f32_dpp v20, v28, v20 row_shr:2 row_mask:0xf bank_mask:0xf
    v_add_f32_dpp v21, v29, v21 row_shr:2 row_mask:0xf bank_mask:0xf
    v_add_f32_dpp v22, v30, v22 row_shr:2 row_mask:0xf bank_mask:0xf
    v_add_f32_dpp v23, v31, v23 row_shr:2 row_mask:0xf bank_mask:0xf
    v_add_f32_dpp v20, v24, v20 row_shl:14 row_mask:0xf bank_mask:0xf
    v_add_f32_dpp v21, v25, v21 row_shl:14 row_mask:0xf bank_mask:0xf
    v_add_f32_dpp v22, v26, v22 row_shl:14 row_mask:0xf bank_mask:0xf
    v_add_f32_dpp v23, v27, v23 row_shl:14 row_mask:0xf bank_mask:0xf
    v_cvt_pk_bf16_f32 v16, v16, v17
    v_cvt_pk_bf16_f32 v17, v18, v19
    v_cvt_pk_bf16_f32 v18, v20, v21
    v_cvt_pk_bf16_f32 v19, v22, v23
    v_dot2c_f32_bf16 v48, s54, v16
    v_dot2c_f32_bf16 v49, s55, v16
    v_dot2c_f32_bf16 v50, s54, v17
    v_dot2c_f32_bf16 v51, s55, v17
    v_dot2c_f32_bf16 v52, s54, v18
    v_dot2c_f32_bf16 v53, s55, v18
    v_dot2c_f32_bf16 v54, s54, v19
    v_dot2c_f32_bf16 v55, s55, v19
    v_cvt_pk_bf16_f32 v48, v48, v49
    v_cvt_pk_bf16_f32 v49, v50, v51
    ds_write_b64 v15, v[48:49] offset:0
    v_cvt_pk_bf16_f32 v52, v52, v53
    v_cvt_pk_bf16_f32 v53, v54, v55
    ds_write_b64 v15, v[52:53] offset:544
    v_mov_b32 v20, 161504
    s_cmp_lt_u32 s38, 8
    s_cbranch_scc1 C_GA
    s_cmp_lg_u32 s38, 9
    s_cbranch_scc1 C_NOGA
    s_mov_b64 exec, 0xf
    v_xor_b32 v5, s39, v10
    v_and_b32 v5, 0xffffdfff, v5
    v_cmp_ne_u32 vcc, 0, v5
    s_nop 4
    s_cbranch_vccz C_PL_K
    s_movk_i32 s60, 4000
    s_branch C_PL_W
C_PL:
    buffer_load_dword v4, v9, s[40:43], 0 offen offset:2048 sc1
C_PL_W:
    s_waitcnt vmcnt(0)
C_PL_C:
    v_xor_b32 v5, s39, v4
    v_and_b32 v5, 0xffffdfff, v5
    v_cmp_ne_u32 vcc, 0, v5
    s_nop 0
    s_and_b64 exec, exec, vcc
    s_cbranch_execz C_PL_D
    s_sub_u32 s60, s60, 1
    s_cmp_gt_i32 s60, 0
    s_sleep 2
    s_cbranch_scc1 C_PL
C_PL_D:
    s_mov_b64 exec, 0xf
    v_mov_b32 v10, v4
C_PL_K:
    v_lshrrev_b32 v9, 2, v3
    v_add_u32 v9, 161504, v9
    v_and_b32 v10, 0x2000, v10
    ds_write_b32 v9, v10
    s_mov_b64 exec, -1
    s_branch C_NOGA
C_GA:
    v_lshrrev_b32 v7, 5, v0
    v_lshlrev_b32 v7, 3, v7
    v_lshl_add_u32 v7, v0, 2, v7
    v_add_u32 v7, 48960, v7
    v_and_b32 v8, 0x1f0, v3
    v_and_b32 v9, 32, v1
    v_lshl_add_u32 v8, v9, 8, v8
    s_lshl_b32 s52, s2, 6
    s_lshl_b32 s53, s38, 9
    s_xor_b32 s52, s52, s53
    s_and_b32 s53, s52, 0x180
    v_xor_b32 v8, s53, v8
    s_and_b32 s52, s52, 0x1e00
    s_lshl_b32 s53, s2, 14
    s_add_u32 s52, s52, s53
    s_add_u32 s52, s52, 2621440
    s_xor_b32 s53, s52, 0x1000
    v_mov_b32 v27, v167
    v_mov_b32 v31, v167
C_NOGA:
    s_waitcnt lgkmcnt(0)
    s_barrier
    ds_read_b128 v[16:19], v20
    s_sub_u32 s45, s38, 0
    s_cmp_ge_u32 s45, 8
    s_cbranch_scc1 C_NOST
    ds_read_b32 v24, v7 offset:0
    ds_read_b32 v25, v7 offset:17408
    ds_read_b32 v26, v7 offset:34816
    ds_read_b32 v28, v7 offset:2176
    ds_read_b32 v29, v7 offset:19584
    ds_read_b32 v30, v7 offset:36992
    s_waitcnt lgkmcnt(3)
    v_xor_b32 v8, v19, v8
    buffer_store_dwordx4 v[24:27], v8, s[40:43], s52 offen sc1
    s_waitcnt lgkmcnt(0)
    buffer_store_dwordx4 v[28:31], v8, s[40:43], s53 offen sc1
C_NOST:
    s_waitcnt lgkmcnt(0)
    v_readfirstlane_b32 s0, v16
    v_readfirstlane_b32 s1, v17
    v_readfirstlane_b32 s22, v18
    s_cmp_ge_u32 s2, 176
    s_cbranch_scc1 FFN_LATE
    s_cmp_ge_u32 s2, 128
    s_cbranch_scc1 FINAL
    v_and_b32 v7, 7, v1
    v_lshrrev_b32 v8, 3, v1
    s_mul_i32 s44, s2, 18432
    s_mul_i32 s45, s38, 96
    v_mul_u32_u24 v9, 0xe0, v7
    v_mad_u32_u24 v9, v8, 12, v9
    v_add_u32 v9, s58, v9
    v_xor_b32 v10, 1, v8
    v_mad_u32_u24 v13, v10, 12, s58
    s_lshr_b32 s47, s2, 3
    s_and_b32 s48, s2, 3
    s_lshl2_add_u32 s47, s47, s48
    s_lshl_b32 s48, s38, 3
    s_xor_b32 s47, s47, s48
    s_and_b32 s47, s47, 63
    s_lshl_b32 s47, s47, 7
    v_xor_b32 v94, s47, v3
    v_lshl_add_u32 v94, v8, 15, v94
    s_and_b32 s47, s2, 4
    s_lshl_b32 s47, s47, 11
    s_cmp_lt_u32 s38, 6
    s_cselect_b32 s48, s1, s22
    s_xor_b32 s47, s47, s48
    s_lshl_b32 s48, s38, 18
    s_add_u32 s47, s47, s48
    s_add_u32 s23, s47, 2637824
    s_lshl_b32 s48, s38, 11
    s_add_u32 s47, s47, 2621440
    v_mul_u32_u24 v84, 48, v7
    v_bfe_u32 v10, v1, 3, 1
    v_lshl_add_u32 v84, v10, 2, v84
    s_lshl_b32 s49, s69, 3
    s_add_u32 s49, s49, s71
    s_add_u32 s49, s49, 14336
    v_add_u32 v84, s49, v84
    v_mul_u32_u24 v85, 48, v1
    v_add_u32 v85, 60992, v85
    s_mov_b32 exec_lo, 0xf0000f
    s_mov_b32 exec_hi, 0xf0000f00
    v_subrev_u32 v84, 1536, v84
    s_mov_b32 exec_lo, 0xff000000
    s_mov_b32 exec_hi, 0xff0000
    v_subrev_u32 v84, 768, v84
    s_mov_b32 exec_lo, 0xff00
    s_mov_b32 exec_hi, 0xff
    v_subrev_u32 v84, 2304, v84
    s_mov_b64 exec, -1
    s_add_u32 s48, s48, 0
    v_and_b32 v10, 6, v7
    v_xor_b32 v10, v10, v8
    v_lshl_add_u32 v10, v7, 3, v10
    v_lshl_add_u32 v86, v10, 4, s48
    v_and_b32 v10, 6, v8
    v_xor_b32 v10, v10, v1
    v_lshl_add_u32 v87, v10, 4, s48
    v_mul_u32_u24 v88, 2944, v8
    v_add_u32 v88, v88, v3
    s_mul_i32 s48, s2, 24576
    s_lshl_b32 s49, s38, 7
    s_add_u32 s48, s48, s49
    s_add_u32 s48, s48, 6291456
    v_mul_u32_u24 v89, 2336, v7
    v_mad_u32_u24 v89, v8, 12, v89
    s_add_u32 s45, s45, 24576
    v_add_u32 v89, s45, v89
    v_add_u32 v10, 1536, v0
    v_add_u32 v11, 0, v0
    v_mul_u32_u24 v11, 911, v11
    v_lshrrev_b32 v11, 16, v11
    v_add_lshl_u32 v90, v10, v11, 4
    v_add_u32 v10, 2304, v0
    v_add_u32 v11, 768, v0
    v_mul_u32_u24 v11, 911, v11
    v_lshrrev_b32 v11, 16, v11
    v_add_lshl_u32 v91, v10, v11, 4
    v_lshl_add_u32 v92, v0, 4, s44
    v_bfe_u32 v10, v1, 3, 1
    v_lshl_add_u32 v10, v7, 1, v10
    s_lshl_b32 s49, s2, 4
    v_add_u32 v93, s49, v10
    v_sub_u32 v12, 0x7ff, v93
    v_lshrrev_b32 v93, 4, v1
    v_mul_u32_u24 v93, 8192, v93
    v_lshl_add_u32 v93, v10, 2, v93
    s_mul_i32 s49, s2, 64
    s_add_u32 s49, s49, 65536
    s_add_u32 s59, s49, 32768
    v_mov_b32 v51, 0
    v_mov_b32 v55, 0
    v_mov_b32 v76, 0
    v_mov_b32 v56, 0
    v_mov_b32 v57, 0
    v_mov_b32 v58, 0
    v_mov_b32 v59, 0
    v_mov_b32 v60, 0
    v_mov_b32 v61, 0
    v_mov_b32 v62, 0
    v_mov_b32 v63, 0
    s_lshl_b32 s50, s2, 6
    s_lshl_b32 s51, s38, 2
    s_add_u32 s50, s50, s51
    s_add_u32 s50, s50, 8192
    s_mov_b32 s56, 0x00100001
    s_mov_b32 s57, 0x10000100
    s_mov_b32 s58, 0xffff0000
    s_waitcnt vmcnt(0)
    buffer_load_dwordx4 v[28:31], v94, s[40:43], s47 offen sc1
    buffer_load_dwordx4 v[32:35], v94, s[40:43], s23 offen sc1
    ds_read_b32 v24, v13 offset:1792
    ds_read_b32 v25, v13 offset:1796
    ds_read_b32 v26, v13 offset:1800
    ds_read2_b32 v[16:17], v9 offset0:0 offset1:1
    ds_read2_b32 v[18:19], v9 offset0:2 offset1:28
    ds_read2_b32 v[20:21], v9 offset0:29 offset1:30
    s_waitcnt lgkmcnt(0)
    v_dot2c_f32_bf16 v76, 0x3f803f80, v24
    v_dot2c_f32_bf16 v76, 0x3f803f80, v25
    v_dot2c_f32_bf16 v76, 0x3f803f80, v26
    v_lshlrev_b32 v36, 16, v16
    v_and_b32 v37, 0xffff0000, v16
    v_lshlrev_b32 v42, 16, v19
    v_and_b32 v43, 0xffff0000, v19
    v_lshlrev_b32 v38, 16, v17
    v_and_b32 v39, 0xffff0000, v17
    v_lshlrev_b32 v44, 16, v20
    v_and_b32 v45, 0xffff0000, v20
    v_lshlrev_b32 v40, 16, v18
    v_and_b32 v41, 0xffff0000, v18
    v_lshlrev_b32 v46, 16, v21
    v_and_b32 v47, 0xffff0000, v21
    v_mov_b32 v77, v76
    s_nop 1
    v_permlane16_swap_b32 v76, v77
    v_add_f32 v76, v76, v77
    v_mov_b32 v77, v76
    s_nop 1
    v_permlane32_swap_b32 v76, v77
    v_add_f32 v76, v76, v77
    s_mov_b32 exec_lo, 0xf00f0
    s_mov_b32 exec_hi, 0xf00f000
    ds_write2_b32 v84, v76, v76 offset0:0 offset1:96
    s_mov_b32 exec_lo, 0xf0f0f0f
    s_mov_b32 exec_hi, 0xf0f0f0f
    v_mov_b32 v24, 0x3f803f80
    v_mov_b32 v25, 0x3f803f80
    v_mov_b32 v26, 0x3f803f80
    s_mov_b32 exec_lo, 0x11111111
    s_mov_b32 exec_hi, 0x11111111
    v_mov_b32 v56, v24
    v_mov_b32 v57, v25
    v_mov_b32 v58, v26
    s_mov_b32 exec_lo, 0x22222222
    s_mov_b32 exec_hi, 0x22222222
    v_mov_b32 v60, v24
    v_mov_b32 v61, v25
    v_mov_b32 v62, v26
    s_mov_b64 exec, -1
    s_movk_i32 s60, 4000
    s_branch L_YP_W
L_YP:
    buffer_load_dwordx4 v[28:31], v94, s[40:43], s47 offen sc1
    buffer_load_dwordx4 v[32:35], v94, s[40:43], s23 offen sc1
L_YP_W:
    s_waitcnt vmcnt(0)
L_YP_C:
    v_xor_b32 v10, v167, v31
    v_xor_b32 v11, v167, v35
    v_or_b32 v10, v10, v11
    v_cmp_ne_u32 vcc, 0, v10
    s_nop 0
    s_and_b64 exec, exec, vcc
    s_cbranch_execz L_YP_D
    s_wqm_b64 exec, exec
    s_sub_u32 s60, s60, 1
    s_cmp_gt_i32 s60, 0
    s_sleep 1
    s_cbranch_scc1 L_YP
L_YP_D:
    s_mov_b64 exec, -1
    v_dot2c_f32_bf16 v36, s54, v28
    v_dot2c_f32_bf16 v37, s54, v29
    v_dot2c_f32_bf16 v38, s54, v30
    v_dot2c_f32_bf16 v39, s54, v34
    v_dot2c_f32_bf16 v40, s54, v32
    v_dot2c_f32_bf16 v41, s54, v33
    v_dot2c_f32_bf16 v42, s55, v28
    v_dot2c_f32_bf16 v43, s55, v29
    v_dot2c_f32_bf16 v44, s55, v30
    v_dot2c_f32_bf16 v45, s55, v34
    v_cvt_pk_bf16_f32 v48, v36, v37
    v_dot2c_f32_bf16 v46, s55, v32
    v_cvt_pk_bf16_f32 v49, v38, v39
    v_dot2c_f32_bf16 v47, s55, v33
    v_cvt_pk_bf16_f32 v50, v40, v41
    v_cvt_pk_bf16_f32 v52, v42, v43
    v_cvt_pk_bf16_f32 v53, v44, v45
    v_mfma_f32_16x16x32_bf16 v[68:71], v[48:51], v[48:51], 0
    v_cvt_pk_bf16_f32 v54, v46, v47
    v_mfma_f32_16x16x32_bf16 v[64:67], v[56:59], v[48:51], 0
    s_nop 0
    v_mfma_f32_16x16x32_bf16 v[64:67], v[60:63], v[52:55], v[64:67]
    v_mfma_f32_16x16x32_bf16 v[72:75], v[52:55], v[52:55], 0
    v_lshlrev_b32 v36, 16, v48
    v_and_b32 v37, 0xffff0000, v48
    v_lshlrev_b32 v38, 16, v49
    v_and_b32 v39, 0xffff0000, v49
    v_lshlrev_b32 v40, 16, v50
    v_and_b32 v41, 0xffff0000, v50
    s_mov_b64 exec, s[56:57]
    v_mov_b32 v64, v68
    v_mov_b32 v65, v72
    s_lshl_b64 exec, exec, 1
    v_mov_b32 v64, v69
    v_mov_b32 v65, v73
    s_lshl_b64 exec, exec, 1
    v_mov_b32 v64, v70
    v_mov_b32 v65, v74
    s_lshl_b64 exec, exec, 1
    v_mov_b32 v64, v71
    v_mov_b32 v65, v75
    s_mov_b32 exec_lo, 0xfff0ff0f
    s_mov_b32 exec_hi, 0xf0ff0fff
    ds_write2_b32 v84, v64, v65 offset0:0 offset1:96
    s_mov_b64 exec, -1
    s_cmp_eq_u32 s38, 0
    s_cbranch_scc0 L_NP
    s_setprio 3
    v_lshlrev_b32 v42, 16, v52
    v_and_b32 v43, 0xffff0000, v52
    v_lshlrev_b32 v44, 16, v53
    v_and_b32 v45, 0xffff0000, v53
    v_lshlrev_b32 v46, 16, v54
    v_and_b32 v47, 0xffff0000, v54
    v_add_u32 v10, 1168, v89
    v_add_u32 v11, 12288, v92
L_NP:
    s_waitcnt lgkmcnt(0)
    s_barrier
    s_cbranch_scc1 L_HS
    v_lshlrev_b32 v42, 16, v52
    v_and_b32 v43, 0xffff0000, v52
    v_lshlrev_b32 v44, 16, v53
    v_and_b32 v45, 0xffff0000, v53
    v_lshlrev_b32 v46, 16, v54
    v_and_b32 v47, 0xffff0000, v54
    v_add_u32 v10, 1168, v89
    v_add_u32 v11, 12288, v92
L_HS:
    ds_read_b128 v[52:55], v85 offset:0
    ds_read_b128 v[56:59], v85 offset:16
    ds_read_b128 v[60:63], v85 offset:17408
    ds_read_b128 v[64:67], v85 offset:17424
    ds_read_b128 v[68:71], v85 offset:34816
    ds_read_b128 v[72:75], v85 offset:34832
    s_waitcnt lgkmcnt(4)
    s_waitcnt lgkmcnt(2)
    v_pk_add_f32 v[52:53], v[52:53], v[60:61]
    v_pk_add_f32 v[54:55], v[54:55], v[62:63]
    v_pk_add_f32 v[56:57], v[56:57], v[64:65]
    v_pk_add_f32 v[58:59], v[58:59], v[66:67]
    s_waitcnt lgkmcnt(0)
    v_pk_add_f32 v[52:53], v[52:53], v[68:69]
    v_pk_add_f32 v[54:55], v[54:55], v[70:71]
    v_pk_add_f32 v[56:57], v[56:57], v[72:73]
    v_pk_add_f32 v[58:59], v[58:59], v[74:75]
    v_pk_add_f32 v[52:53], v[52:53], v[54:55]
    v_pk_add_f32 v[56:57], v[56:57], v[58:59]
    v_pk_add_f32 v[52:53], v[52:53], v[56:57]
    v_add_f32 v76, v52, v53
    v_add_f32 v78, v52, v53
    s_nop 1
    v_permlane16_swap_b32 v76, v78
    v_mov_b32 v77, v76
    v_mov_b32 v13, v78
    s_nop 0
    v_permlane32_swap_b32 v76, v77
    v_permlane32_swap_b32 v78, v13
    v_mul_f32 v76, 0x3ae38e39, v76
    v_mul_f32 v78, 0x3ae38e39, v78
    v_fma_f32 v78, -v76, v76, v78
    v_max_f32 v78, 0, v78
    v_cvt_pk_bf16_f32 v78, v76, v78
    v_and_b32 v82, 0xffff0000, v78
    v_lshlrev_b32 v80, 16, v78
    v_add_f32 v82, 0x3727c5ac, v82
    v_lshlrev_b32 v81, 16, v78
    v_cvt_pk_bf16_f32 v82, v82, v82
    v_lshlrev_b32 v82, 16, v82
    v_sqrt_f32 v82, v82
    v_fma_f32 v77, -v80, v13, v77
    v_cvt_pk_bf16_f32 v82, v82, v82
    v_lshlrev_b32 v82, 16, v82
    v_rcp_f32 v83, v82
    v_rcp_f32 v82, v82
    s_cbranch_scc0 L_NK
    v_mul_f32 v77, v77, v83
    v_cvt_pk_bf16_f32 v77, v77, v77
    v_ashrrev_i32 v76, 31, v77
    v_or_b32 v76, 0x80000000, v76
    v_xor_b32 v76, v76, v77
    v_and_or_b32 v76, v76, s58, v12
    buffer_store_dword v76, v93, s[40:43], s49 offen sc1
    buffer_store_dword v76, v93, s[40:43], s59 offen sc1
    s_setprio 0
L_NK:
    v_mov_b32_dpp v80, v80 row_ror:8 row_mask:0xf bank_mask:0xc
    v_mov_b32_dpp v81, v81 row_ror:8 row_mask:0xf bank_mask:0x3
    v_mov_b32_dpp v82, v82 row_ror:8 row_mask:0xf bank_mask:0xc
    v_mov_b32_dpp v83, v83 row_ror:8 row_mask:0xf bank_mask:0x3
    v_pk_add_f32 v[56:57], v[36:37], v[80:81] op_sel_hi:[1,0] neg_lo:[0,1] neg_hi:[0,1]
    v_pk_add_f32 v[58:59], v[38:39], v[80:81] op_sel_hi:[1,0] neg_lo:[0,1] neg_hi:[0,1]
    v_pk_add_f32 v[60:61], v[40:41], v[80:81] op_sel_hi:[1,0] neg_lo:[0,1] neg_hi:[0,1]
    v_pk_add_f32 v[62:63], v[42:43], v[80:81] op_sel:[0,1] neg_lo:[0,1] neg_hi:[0,1]
    v_pk_add_f32 v[64:65], v[44:45], v[80:81] op_sel:[0,1] neg_lo:[0,1] neg_hi:[0,1]
    v_pk_add_f32 v[66:67], v[46:47], v[80:81] op_sel:[0,1] neg_lo:[0,1] neg_hi:[0,1]
    v_cvt_pk_bf16_f32 v57, v56, v57
    v_cvt_pk_bf16_f32 v59, v58, v59
    v_cvt_pk_bf16_f32 v61, v60, v61
    v_cvt_pk_bf16_f32 v63, v62, v63
    v_cvt_pk_bf16_f32 v65, v64, v65
    v_cvt_pk_bf16_f32 v67, v66, v67
    v_lshlrev_b32 v56, 16, v57
    v_and_b32 v57, 0xffff0000, v57
    v_lshlrev_b32 v58, 16, v59
    v_and_b32 v59, 0xffff0000, v59
    v_lshlrev_b32 v60, 16, v61
    v_and_b32 v61, 0xffff0000, v61
    v_lshlrev_b32 v62, 16, v63
    v_and_b32 v63, 0xffff0000, v63
    v_lshlrev_b32 v64, 16, v65
    v_and_b32 v65, 0xffff0000, v65
    v_lshlrev_b32 v66, 16, v67
    v_and_b32 v67, 0xffff0000, v67
    v_pk_mul_f32 v[56:57], v[56:57], v[82:83] op_sel_hi:[1,0]
    v_pk_mul_f32 v[58:59], v[58:59], v[82:83] op_sel_hi:[1,0]
    v_pk_mul_f32 v[60:61], v[60:61], v[82:83] op_sel_hi:[1,0]
    v_pk_mul_f32 v[62:63], v[62:63], v[82:83] op_sel:[0,1]
    v_pk_mul_f32 v[64:65], v[64:65], v[82:83] op_sel:[0,1]
    v_pk_mul_f32 v[66:67], v[66:67], v[82:83] op_sel:[0,1]
    v_cvt_pk_bf16_f32 v28, v56, v57
    v_cvt_pk_bf16_f32 v29, v58, v59
    v_cvt_pk_bf16_f32 v30, v60, v61
    ds_write_b128 v86, v[28:31]
    v_cvt_pk_bf16_f32 v32, v62, v63
    v_cvt_pk_bf16_f32 v33, v64, v65
    v_cvt_pk_bf16_f32 v34, v66, v67
    ds_write_b128 v86, v[32:35] offset:1024
    ds_read_b128 v[56:59], v87
    ds_read_b128 v[60:63], v87 offset:1024
    v_dot2c_f32_bf16 v36, s54, v28
    v_dot2c_f32_bf16 v37, s55, v28
    v_dot2c_f32_bf16 v38, s54, v29
    v_dot2c_f32_bf16 v39, s55, v29
    v_dot2c_f32_bf16 v40, s54, v30
    v_dot2c_f32_bf16 v41, s55, v30
    v_dot2c_f32_bf16 v42, s54, v32
    v_dot2c_f32_bf16 v43, s55, v32
    v_dot2c_f32_bf16 v44, s54, v33
    v_dot2c_f32_bf16 v45, s55, v33
    v_dot2c_f32_bf16 v46, s54, v34
    v_dot2c_f32_bf16 v47, s55, v34
    s_waitcnt lgkmcnt(1)
    buffer_store_dwordx4 v[56:59], v88, s[40:43], s48 offen sc1
    s_waitcnt lgkmcnt(0)
    buffer_store_dwordx4 v[60:63], v88, s[40:43], s48 offen offset:1536 sc1
    v_cvt_pk_bf16_f32 v48, v36, v37
    v_cvt_pk_bf16_f32 v49, v38, v39
    v_cvt_pk_bf16_f32 v50, v40, v41
    v_cvt_pk_bf16_f32 v51, v42, v43
    v_cvt_pk_bf16_f32 v52, v44, v45
    v_cvt_pk_bf16_f32 v53, v46, v47
    ds_write2_b32 v89, v48, v49 offset0:0 offset1:1
    ds_write_b32 v89, v50 offset:8
    ds_write2_b32 v10, v51, v52 offset0:0 offset1:1
    ds_write_b32 v10, v53 offset:8
    s_waitcnt lgkmcnt(0)
    s_barrier
    ds_read_b128 v[16:19], v90
    ds_read_b128 v[20:23], v91
    v_mov_b32 v10, 0
    s_waitcnt lgkmcnt(1)
    global_store_dwordx4 v92, v[16:19], s[32:33] sc1
    s_cmp_ge_u32 s38, 6
    s_cbranch_scc1 L_O1
    s_waitcnt lgkmcnt(0)
    global_store_dwordx4 v11, v[20:23], s[32:33] sc1
L_O1:
    s_cmp_eq_u32 s38, 11
    s_cbranch_scc1 TOP8
    s_waitcnt vmcnt(0)
    s_mov_b64 exec, 0x1
    buffer_store_dword v167, v10, s[40:43], s50 offen sc1
    s_mov_b64 exec, -1
    s_branch END
FFN_DMA0:
    s_sub_u32 s58, s2, 192
    s_and_b32 s61, s58, 7
    s_lshr_b32 s59, s58, 3
    s_lshl3_add_u32 s61, s61, s59
    s_lshl_b32 s61, s61, 1
    s_mov_b32 s59, 8
    s_mov_b32 s57, 73728
    s_add_u32 s56, s38, 1
    s_bfe_u32 s50, s56, 0x10003
    s_and_b32 s51, s56, 1
    s_bfe_u32 s52, s56, 0x10001
    s_mul_i32 s52, s52, 36
    s_add_u32 s52, s52, s51
    s_mul_i32 s48, s52, 73728
    s_lshl_b32 s53, s61, 6
    s_add_u32 s48, s48, s53
    s_lshl_b32 s49, s52, 10
    s_mul_i32 s53, s50, 73728
    s_add_u32 s49, s49, s53
    s_lshl_b32 s51, s51, 1
    s_lshl_b32 s53, s50, 2
    s_or_b32 s51, s51, s53
    v_bfe_u32 v2, v1, 4, 1
    v_and_b32 v4, 7, v1
    v_xor_b32 v2, v2, v4
    v_xor_b32 v2, s51, v2
    v_lshrrev_b32 v4, 3, v1
    v_mul_u32_u24 v4, 0x2400, v4
    v_lshl_add_u32 v2, v2, 4, v4
    s_mov_b32 s46, 5308416
    s_mov_b32 s47, 0x00020000
    s_waitcnt lgkmcnt(0)
    s_cmp_eq_u32 s50, 0
    s_cselect_b32 s44, s26, s28
    s_cselect_b32 s45, s27, s29
    s_mov_b32 s40, s36
    s_mov_b32 s41, s37
    s_barrier
    s_sub_u32 s51, s38, 3
    s_cmp_ge_u32 s51, 8
    s_cbranch_scc1 F_B0
    s_add_u32 m0, s49, 0
    s_add_u32 s53, s48, 0
    buffer_load_dwordx4 v2, s[44:47], s53 offen lds
    s_add_u32 m0, s49, 2048
    s_add_u32 s53, s48, 147456
    buffer_load_dwordx4 v2, s[44:47], s53 offen lds
    s_add_u32 m0, s49, 4096
    s_add_u32 s53, s48, 294912
    buffer_load_dwordx4 v2, s[44:47], s53 offen lds
    s_barrier
    s_branch F_B2
FFN_LATE:
    s_and_b32 s61, s2, 7
    s_lshl_b32 s61, s61, 1
    s_bitcmp0_b32 s2, 3
    s_addc_u32 s61, s61, 128
    s_sub_u32 s58, s2, 112
    s_mov_b32 s59, 4
    s_mov_b32 s57, 0
    v_mov_b32 v32, 0
    v_mov_b32 v33, 0
    v_mov_b32 v34, 0
    v_mov_b32 v35, 0
    v_mov_b32 v36, 0
    v_mov_b32 v37, 0
    v_mov_b32 v38, 0
    v_mov_b32 v39, 0
    v_mov_b32 v40, 0
    v_mov_b32 v41, 0
    v_mov_b32 v42, 0
    v_mov_b32 v43, 0
    v_mov_b32 v44, 0
    v_mov_b32 v45, 0
    v_mov_b32 v46, 0
    v_mov_b32 v47, 0
    s_sub_u32 s51, s38, 3
    s_cmp_ge_u32 s51, 8
    s_cbranch_scc1 F_B0
    s_add_u32 s56, s38, 1
    s_bfe_u32 s50, s56, 0x10003
    s_and_b32 s51, s56, 1
    s_bfe_u32 s52, s56, 0x10001
    s_lshl1_add_u32 s52, s50, s52
    s_mul_i32 s52, s52, 18
    s_add_u32 s52, s52, s51
    s_mul_i32 s48, s52, 73728
    s_lshl_b32 s53, s61, 6
    s_add_u32 s48, s48, s53
    s_lshl_b32 m0, s52, 10
    s_lshl_b32 s51, s51, 1
    s_add_u32 s44, s26, s48
    s_addc_u32 s45, s27, 0
    s_add_u32 s46, s28, s48
    s_addc_u32 s47, s29, 0
    v_bfe_u32 v2, v1, 4, 1
    v_xor_b32 v2, v2, v1
    v_xor_b32 v2, s51, v2
    v_and_b32 v2, 3, v2
    v_lshrrev_b32 v4, 3, v1
    v_mul_u32_u24 v4, 0x2400, v4
    v_lshl_add_u32 v2, v2, 4, v4
    v_mov_b32 v4, s44
    v_mov_b32 v5, s45
    s_mov_b32 exec_lo, 0xf0f0f0f0
    s_mov_b32 exec_hi, 0xf0f0f0f0
    v_mov_b32 v4, s46
    v_mov_b32 v5, s47
    s_mov_b64 exec, -1
    v_add_co_u32 v4, vcc, v4, v2
    s_nop 1
    v_addc_co_u32 v5, vcc, 0, v5, vcc
    s_barrier
    global_load_lds_dwordx4 v[4:5], off
    v_add_co_u32 v4, vcc, 147456, v4
    s_add_u32 m0, m0, 2048
    s_nop 0
    v_addc_co_u32 v5, vcc, 0, v5, vcc
    global_load_lds_dwordx4 v[4:5], off
    v_add_co_u32 v4, vcc, 147456, v4
    s_add_u32 m0, m0, 2048
    s_nop 0
    v_addc_co_u32 v5, vcc, 0, v5, vcc
    global_load_lds_dwordx4 v[4:5], off
    v_add_co_u32 v4, vcc, 147456, v4
    s_add_u32 m0, m0, 2048
    s_nop 0
    v_addc_co_u32 v5, vcc, 0, v5, vcc
    global_load_lds_dwordx4 v[4:5], off
    v_add_co_u32 v4, vcc, 147456, v4
    s_add_u32 m0, m0, 2048
    s_nop 0
    v_addc_co_u32 v5, vcc, 0, v5, vcc
    global_load_lds_dwordx4 v[4:5], off
    v_add_co_u32 v4, vcc, 147456, v4
    s_add_u32 m0, m0, 2048
    s_nop 0
    v_addc_co_u32 v5, vcc, 0, v5, vcc
    global_load_lds_dwordx4 v[4:5], off
    v_add_co_u32 v4, vcc, 147456, v4
    s_add_u32 m0, m0, 2048
    s_nop 0
    v_addc_co_u32 v5, vcc, 0, v5, vcc
    global_load_lds_dwordx4 v[4:5], off
    v_add_co_u32 v4, vcc, 147456, v4
    s_add_u32 m0, m0, 2048
    s_nop 0
    v_addc_co_u32 v5, vcc, 0, v5, vcc
    global_load_lds_dwordx4 v[4:5], off
    v_add_co_u32 v4, vcc, 147456, v4
    s_add_u32 m0, m0, 2048
    s_nop 0
    v_addc_co_u32 v5, vcc, 0, v5, vcc
    global_load_lds_dwordx4 v[4:5], off
    s_branch F_W
F_L2:
    s_sub_u32 s51, s38, 3
    s_cmp_ge_u32 s51, 8
    s_cbranch_scc1 F_B0
    s_add_u32 s56, s38, 1
    s_bfe_u32 s50, s56, 0x10003
    s_and_b32 s51, s56, 1
    s_bfe_u32 s52, s56, 0x10001
    s_mul_i32 s52, s52, 36
    s_add_u32 s52, s52, s51
    s_mul_i32 s48, s52, 73728
    s_lshl_b32 s53, s61, 6
    s_add_u32 s48, s48, s53
    s_lshl_b32 s49, s52, 10
    s_mul_i32 s53, s50, 73728
    s_add_u32 s49, s49, s53
    s_lshl_b32 s51, s51, 1
    s_lshl_b32 s53, s50, 2
    s_or_b32 s51, s51, s53
    v_bfe_u32 v2, v1, 4, 1
    v_and_b32 v4, 7, v1
    v_xor_b32 v2, v2, v4
    v_xor_b32 v2, s51, v2
    v_lshrrev_b32 v4, 3, v1
    v_mul_u32_u24 v4, 0x2400, v4
    v_lshl_add_u32 v2, v2, 4, v4
    s_mov_b32 s46, 5308416
    s_mov_b32 s47, 0x00020000
    s_cmp_eq_u32 s50, 0
    s_cselect_b32 s44, s26, s28
    s_cselect_b32 s45, s27, s29
    s_barrier
    s_add_u32 m0, s49, 0
    s_add_u32 s53, s48, 0
    buffer_load_dwordx4 v2, s[44:47], s53 offen lds
    s_add_u32 m0, s49, 2048
    s_add_u32 s53, s48, 147456
    buffer_load_dwordx4 v2, s[44:47], s53 offen lds
    s_add_u32 m0, s49, 4096
    s_add_u32 s53, s48, 294912
    buffer_load_dwordx4 v2, s[44:47], s53 offen lds
F_B2:
    s_add_u32 m0, s49, 6144
    s_add_u32 s53, s48, 442368
    buffer_load_dwordx4 v2, s[44:47], s53 offen lds
    s_add_u32 m0, s49, 8192
    s_add_u32 s53, s48, 589824
    buffer_load_dwordx4 v2, s[44:47], s53 offen lds
    s_add_u32 m0, s49, 10240
    s_add_u32 s53, s48, 737280
    buffer_load_dwordx4 v2, s[44:47], s53 offen lds
    s_add_u32 m0, s49, 12288
    s_add_u32 s53, s48, 884736
    buffer_load_dwordx4 v2, s[44:47], s53 offen lds
    s_add_u32 m0, s49, 14336
    s_add_u32 s53, s48, 1032192
    buffer_load_dwordx4 v2, s[44:47], s53 offen lds
    s_add_u32 m0, s49, 16384
    s_add_u32 s53, s48, 1179648
    buffer_load_dwordx4 v2, s[44:47], s53 offen lds
    s_add_u32 m0, s49, 18432
    s_add_u32 s53, s48, 1327104
    buffer_load_dwordx4 v2, s[44:47], s53 offen lds
    s_add_u32 m0, s49, 20480
    s_add_u32 s53, s48, 1474560
    buffer_load_dwordx4 v2, s[44:47], s53 offen lds
    s_add_u32 m0, s49, 22528
    s_add_u32 s53, s48, 1622016
    buffer_load_dwordx4 v2, s[44:47], s53 offen lds
    s_add_u32 m0, s49, 24576
    s_add_u32 s53, s48, 1769472
    buffer_load_dwordx4 v2, s[44:47], s53 offen lds
    s_add_u32 m0, s49, 26624
    s_add_u32 s53, s48, 1916928
    buffer_load_dwordx4 v2, s[44:47], s53 offen lds
    s_add_u32 m0, s49, 28672
    s_add_u32 s53, s48, 2064384
    buffer_load_dwordx4 v2, s[44:47], s53 offen lds
    s_add_u32 m0, s49, 30720
    s_add_u32 s53, s48, 2211840
    buffer_load_dwordx4 v2, s[44:47], s53 offen lds
    s_add_u32 m0, s49, 32768
    s_add_u32 s53, s48, 2359296
    buffer_load_dwordx4 v2, s[44:47], s53 offen lds
    s_add_u32 m0, s49, 34816
    s_add_u32 s53, s48, 2506752
    buffer_load_dwordx4 v2, s[44:47], s53 offen lds
    s_branch F_W
FFN_DMA:
    s_setprio 0
    s_sub_u32 s58, s2, 192
    s_and_b32 s61, s58, 7
    s_lshr_b32 s59, s58, 3
    s_lshl3_add_u32 s61, s61, s59
    s_lshl_b32 s61, s61, 1
    s_mov_b32 s59, 8
    s_mov_b32 s57, 73728
    s_branch F_L2
F_B0:
    s_setprio 3
    s_sub_u32 s52, s2, 192
    s_and_b32 s53, s52, 0xffffffe7
    s_xor_b32 s54, s38, 11
    s_or_b32 s53, s53, s54
    s_cbranch_scc1 F_NM
    s_cmp_eq_u32 s52, 24
    s_cbranch_scc1 F_NM
    s_lshl_b32 s53, s52, 18
    s_cmp_eq_u32 s52, 16
    s_cselect_b32 s53, 5767168, s53
    s_add_u32 s53, s53, 16384
    s_add_u32 s54, s53, 8192
    v_mov_b32 v10, 0
    v_mov_b32 v11, 161416
    s_mov_b64 exec, 0x1
    s_mov_b32 s62, -1
    s_movk_i32 s60, 8
F_ML:
    s_xor_b32 s53, s53, 0x2000
    s_xor_b32 s54, s54, 0x2000
    buffer_store_dword v10, v10, s[40:43], s53 offen offset:0 sc1
    buffer_store_dword v10, v10, s[40:43], s54 offen offset:0 sc1
    v_add_u32 v10, 0x80, v10
    s_waitcnt vmcnt(1)
    s_memtime s[64:65]
    s_waitcnt vmcnt(0)
    s_memtime s[66:67]
    s_sub_u32 s60, s60, 1
    s_cselect_b32 s62, 0, s62
    s_waitcnt lgkmcnt(0)
    s_sub_u32 s64, s66, s64
    s_cmp_lt_u32 s64, s62
    s_movk_i32 s62, 64
    s_cbranch_scc1 F_ML
    v_mov_b32 v10, 0
    s_bitcmp1_b32 s53, 13
    s_cselect_b32 s53, 0x2000, 0
    s_movk_i32 s60, 4000
    s_mov_b32 exec_lo, 0xffffffff
    s_mov_b32 exec_hi, 0x0
    v_lshlrev_b32 v10, 7, v1
F_MT:
    ds_read_b64 v[12:13], v11
    s_sub_u32 s60, s60, 1
    s_cmp_gt_i32 s60, 0
    s_waitcnt lgkmcnt(0)
    v_readfirstlane_b32 s54, v12
    s_nop 0
    s_cselect_b32 s54, s54, 1
    s_cmp_lg_u32 s54, 1
    s_cbranch_scc1 F_MT
    v_and_b32 v13, 0xffffdfff, v13
    v_or_b32 v13, s53, v13
    buffer_store_dword v13, v10, s[40:43], s52 offen offset:2048 sc1
    s_mov_b64 exec, -1
F_NM:
    s_barrier
F_W:
    s_mov_b64 exec, -1
    v_mov_b32 v167, 161420
    ds_read_b32 v167, v167
    v_and_b32 v7, 7, v1
    v_lshrrev_b32 v8, 3, v1
    v_and_b32 v5, 15, v1
    v_lshrrev_b32 v6, 4, v1
    s_mul_i32 s52, s61, 36864
    s_mul_i32 s53, s38, 96
    s_add_u32 s52, s52, s53
    v_mul_u32_u24 v9, 0x480, v8
    v_mad_u32_u24 v9, v7, 12, v9
    v_add_u32 v9, s52, v9
    global_load_dwordx3 v[16:18], v9, s[30:31]
    v_add_u32 v9, 0x2400, v9
    global_load_dwordx3 v[20:22], v9, s[30:31]
    v_add_u32 v9, 0x2400, v9
    global_load_dwordx3 v[24:26], v9, s[30:31]
    v_add_u32 v9, 0x2400, v9
    global_load_dwordx3 v[28:30], v9, s[30:31]
    v_add_u32 v9, 0x2400, v9
    s_cmp_eq_u32 s59, 4
    s_cbranch_scc1 F_W4
    global_load_dwordx3 v[32:34], v9, s[30:31]
    v_add_u32 v9, 0x2400, v9
    global_load_dwordx3 v[36:38], v9, s[30:31]
    v_add_u32 v9, 0x2400, v9
    global_load_dwordx3 v[40:42], v9, s[30:31]
    v_add_u32 v9, 0x2400, v9
    global_load_dwordx3 v[44:46], v9, s[30:31]
F_W4:
    v_mul_u32_u24 v10, 683, v0
    v_lshrrev_b32 v10, 16, v10
    v_mul_u32_u24 v11, 0x60, v10
    v_sub_u32 v11, v0, v11
    s_mov_b32 s52, 161920
    v_lshl_add_u32 v160, v10, 2, s52
    v_and_b32 v63, 4, v10
    v_lshl_add_u32 v160, v63, 2, v160
    v_mov_b32 v63, 161492
    s_mov_b32 s52, 3144192
    v_lshl_add_u32 v161, v11, 4, s52
    v_mul_u32_u24 v162, 608, v10
    v_mad_u32_u24 v162, v11, 6, v162
    v_and_b32 v11, 1, v11
    v_mul_u32_u24 v11, 4862, v11
    v_sub_u32 v2, v162, v11
    v_add_u32 v2, 152320, v2
    v_add_u32 v162, 147456, v162
    v_add_u32 v162, v11, v162
    v_mul_u32_u24 v163, 608, v5
    v_lshl_add_u32 v163, v6, 4, v163
    v_add_u32 v163, 147456, v163
    s_lshr_b32 s52, s38, 2
    s_lshl_b32 s52, s52, 10
    s_and_b32 s53, s38, 3
    s_lshl_b32 s53, s53, 2
    s_add_u32 s52, s52, s53
    s_add_u32 s52, s52, 157184
    v_add_u32 v164, s52, v3
    v_mov_b32 v10, 0
    ds_write_b32 v164, v10
    v_add_u32 v60, 157184, v3
    v_xor_b32 v61, 0x80, v60
    v_and_b32 v10, 6, v1
    v_and_b32 v11, 9, v1
    v_lshl_add_u32 v164, v10, 7, s52
    v_lshl_add_u32 v164, v11, 1, v164
    v_and_b32 v10, 16, v1
    v_and_b32 v11, 32, v1
    v_lshl_add_u32 v164, v10, 2, v164
    v_add_u32 v164, v11, v164
    v_and_b32 v10, 1, v6
    v_mul_u32_u24 v10, 0x48, v10
    v_and_b32 v11, 1, v8
    v_add3_u32 v166, v10, v11, 2
    v_lshl_add_u32 v10, v11, 2, v10
    v_lshrrev_b32 v11, 1, v6
    v_add_u32 v165, v10, v11
    s_mul_i32 s62, s38, 6
    s_cmp_lt_u32 s58, 64
    s_cselect_b32 s53, 13, 11
    s_cselect_b32 s54, 14, 11
    v_add_u32 v165, s62, v165
    v_and_b32 v10, 3, v165
    v_lshlrev_b32 v10, s54, v10
    v_lshl_add_u32 v10, v7, 4, v10
    v_and_b32 v11, 4, v165
    v_lshl_add_u32 v10, v11, 11, v10
    v_and_b32 v165, 0xf8, v165
    v_lshl_add_u32 v165, v165, s53, v10
    v_add_u32 v166, s62, v166
    v_and_b32 v10, 3, v166
    v_lshlrev_b32 v10, s54, v10
    v_lshl_add_u32 v10, v7, 4, v10
    v_and_b32 v11, 4, v166
    v_lshl_add_u32 v10, v11, 11, v10
    v_and_b32 v166, 0xf8, v166
    v_lshl_add_u32 v166, v166, s53, v10
    s_cselect_b32 s62, 0, 1171456
    s_lshl_b32 s53, s58, 7
    s_add_u32 s62, s62, s53
    s_add_u32 s62, s62, 262144
    s_mov_b32 s63, 6291456
    s_movk_i32 s64, -1536
    v_bfe_u32 v10, v1, 1, 1
    v_bfe_u32 v11, v1, 3, 2
    v_lshl_add_u32 v11, v10, 2, v11
    v_xor_b32 v11, s38, v11
    v_mul_u32_u24 v12, s57, v10
    v_lshl_add_u32 v12, v11, 4, v12
    v_and_b32 v10, 1, v1
    v_lshl_add_u32 v12, v10, 3, v12
    v_bfe_u32 v10, v1, 2, 2
    v_lshl_add_u32 v10, v6, 3, v10
    v_lshl_add_u32 v12, v10, 7, v12
    v_add_u32 v13, 36864, v12
    v_mov_b32 v14, 161488
    v_mov_b32 v15, 1
    s_mov_b32 s52, 0x05040100
    s_mov_b32 s53, 0x07060302
    v_mov_b32 v10, s52
    v_mov_b32 v4, 0x05040c0c
    v_mov_b32 v5, 0x01000c0c
    v_mov_b32 v6, 0x44444444
    s_mov_b32 exec_lo, 0xff00ff00
    s_mov_b32 exec_hi, 0xff00ff00
    v_mov_b32 v10, 0x03020706
    v_mov_b32 v4, 0x03020c0c
    v_mov_b32 v5, 0x07060c0c
    v_mov_b32 v6, 0xeeeeeeee
    s_mov_b64 exec, -1
    s_waitcnt lgkmcnt(0)
    v_readfirstlane_b32 s39, v167
    s_cmp_eq_u32 s59, 4
    s_cbranch_scc0 F_W8
    s_waitcnt vmcnt(0)
F_W8:
    s_sub_u32 s51, s38, 3
    s_cmp_ge_u32 s51, 8
    s_cbranch_scc1 F_NC
    s_waitcnt vmcnt(8)
    s_mov_b64 exec, 0x1
    ds_add_u32 v14, v15
    s_mov_b64 exec, -1
F_NC:
    s_waitcnt vmcnt(7)
    v_mov_b32 v19, v16
    v_mov_b32_dpp v11, v17 row_ror:8 row_mask:0xf bank_mask:0xf
    v_mov_b32_dpp v16, v18 row_ror:8 row_mask:0xf bank_mask:0xc
    v_mov_b32_dpp v18, v19 row_ror:8 row_mask:0xf bank_mask:0x3
    v_perm_b32 v152, v11, v17, v10
    v_perm_b32 v136, v18, v16, s52
    v_perm_b32 v144, v18, v16, s53
    s_waitcnt vmcnt(6)
    v_mov_b32 v23, v20
    v_mov_b32_dpp v11, v21 row_ror:8 row_mask:0xf bank_mask:0xf
    v_mov_b32_dpp v20, v22 row_ror:8 row_mask:0xf bank_mask:0xc
    v_mov_b32_dpp v22, v23 row_ror:8 row_mask:0xf bank_mask:0x3
    v_perm_b32 v153, v11, v21, v10
    v_perm_b32 v137, v22, v20, s52
    v_perm_b32 v145, v22, v20, s53
    s_waitcnt vmcnt(5)
    v_mov_b32 v27, v24
    v_mov_b32_dpp v11, v25 row_ror:8 row_mask:0xf bank_mask:0xf
    v_mov_b32_dpp v24, v26 row_ror:8 row_mask:0xf bank_mask:0xc
    v_mov_b32_dpp v26, v27 row_ror:8 row_mask:0xf bank_mask:0x3
    v_perm_b32 v154, v11, v25, v10
    v_perm_b32 v138, v26, v24, s52
    v_perm_b32 v146, v26, v24, s53
    s_waitcnt vmcnt(4)
    v_mov_b32 v31, v28
    v_mov_b32_dpp v11, v29 row_ror:8 row_mask:0xf bank_mask:0xf
    v_mov_b32_dpp v28, v30 row_ror:8 row_mask:0xf bank_mask:0xc
    v_mov_b32_dpp v30, v31 row_ror:8 row_mask:0xf bank_mask:0x3
    v_perm_b32 v155, v11, v29, v10
    v_perm_b32 v139, v30, v28, s52
    v_perm_b32 v147, v30, v28, s53
    s_waitcnt vmcnt(3)
    v_mov_b32 v35, v32
    v_mov_b32_dpp v11, v33 row_ror:8 row_mask:0xf bank_mask:0xf
    v_mov_b32_dpp v32, v34 row_ror:8 row_mask:0xf bank_mask:0xc
    v_mov_b32_dpp v34, v35 row_ror:8 row_mask:0xf bank_mask:0x3
    v_perm_b32 v156, v11, v33, v10
    v_perm_b32 v140, v34, v32, s52
    v_perm_b32 v148, v34, v32, s53
    s_waitcnt vmcnt(2)
    v_mov_b32 v39, v36
    v_mov_b32_dpp v11, v37 row_ror:8 row_mask:0xf bank_mask:0xf
    v_mov_b32_dpp v36, v38 row_ror:8 row_mask:0xf bank_mask:0xc
    v_mov_b32_dpp v38, v39 row_ror:8 row_mask:0xf bank_mask:0x3
    v_perm_b32 v157, v11, v37, v10
    v_perm_b32 v141, v38, v36, s52
    v_perm_b32 v149, v38, v36, s53
    s_waitcnt vmcnt(1)
    v_mov_b32 v43, v40
    v_mov_b32_dpp v11, v41 row_ror:8 row_mask:0xf bank_mask:0xf
    v_mov_b32_dpp v40, v42 row_ror:8 row_mask:0xf bank_mask:0xc
    v_mov_b32_dpp v42, v43 row_ror:8 row_mask:0xf bank_mask:0x3
    v_perm_b32 v158, v11, v41, v10
    v_perm_b32 v142, v42, v40, s52
    v_perm_b32 v150, v42, v40, s53
    s_waitcnt vmcnt(0)
    v_mov_b32 v47, v44
    v_mov_b32_dpp v11, v45 row_ror:8 row_mask:0xf bank_mask:0xf
    v_mov_b32_dpp v44, v46 row_ror:8 row_mask:0xf bank_mask:0xc
    v_mov_b32_dpp v46, v47 row_ror:8 row_mask:0xf bank_mask:0x3
    v_perm_b32 v159, v11, v45, v10
    v_perm_b32 v143, v46, v44, s52
    v_perm_b32 v151, v46, v44, s53
    s_cmp_ge_u32 s38, s59
    s_cbranch_scc1 F_NT
    s_movk_i32 s60, 4000
F_CP:
    ds_read_b32 v15, v14
    s_sub_u32 s60, s60, 1
    s_cmp_gt_i32 s60, 0
    s_waitcnt lgkmcnt(0)
    v_readfirstlane_b32 s52, v15
    s_nop 0
    s_cselect_b32 s52, s52, 8
    s_cmp_eq_u32 s52, 8
    s_cbranch_scc1 F_CD
    s_sleep 2
    s_branch F_CP
F_CD:
    ds_read_b64_tr_b16 v[64:65], v12 offset:0
    ds_read_b64_tr_b16 v[66:67], v12 offset:512
    ds_read_b64_tr_b16 v[68:69], v12 offset:4096
    ds_read_b64_tr_b16 v[70:71], v12 offset:4608
    ds_read_b64_tr_b16 v[72:73], v12 offset:8192
    ds_read_b64_tr_b16 v[74:75], v12 offset:8704
    ds_read_b64_tr_b16 v[76:77], v12 offset:12288
    ds_read_b64_tr_b16 v[78:79], v12 offset:12800
    ds_read_b64_tr_b16 v[80:81], v12 offset:16384
    ds_read_b64_tr_b16 v[82:83], v12 offset:16896
    ds_read_b64_tr_b16 v[84:85], v12 offset:20480
    ds_read_b64_tr_b16 v[86:87], v12 offset:20992
    ds_read_b64_tr_b16 v[88:89], v12 offset:24576
    ds_read_b64_tr_b16 v[90:91], v12 offset:25088
    ds_read_b64_tr_b16 v[92:93], v12 offset:28672
    ds_read_b64_tr_b16 v[94:95], v12 offset:29184
    ds_read_b64_tr_b16 v[96:97], v12 offset:32768
    ds_read_b64_tr_b16 v[98:99], v12 offset:33280
    ds_read_b64_tr_b16 v[100:101], v13 offset:0
    ds_read_b64_tr_b16 v[102:103], v13 offset:512
    ds_read_b64_tr_b16 v[104:105], v13 offset:4096
    ds_read_b64_tr_b16 v[106:107], v13 offset:4608
    ds_read_b64_tr_b16 v[108:109], v13 offset:8192
    ds_read_b64_tr_b16 v[110:111], v13 offset:8704
    ds_read_b64_tr_b16 v[112:113], v13 offset:12288
    ds_read_b64_tr_b16 v[114:115], v13 offset:12800
    ds_read_b64_tr_b16 v[116:117], v13 offset:16384
    ds_read_b64_tr_b16 v[118:119], v13 offset:16896
    ds_read_b64_tr_b16 v[120:121], v13 offset:20480
    ds_read_b64_tr_b16 v[122:123], v13 offset:20992
    ds_read_b64_tr_b16 v[124:125], v13 offset:24576
    ds_read_b64_tr_b16 v[126:127], v13 offset:25088
    ds_read_b64_tr_b16 v[128:129], v13 offset:28672
    ds_read_b64_tr_b16 v[130:131], v13 offset:29184
    ds_read_b64_tr_b16 v[132:133], v13 offset:32768
    ds_read_b64_tr_b16 v[134:135], v13 offset:33280
    s_waitcnt lgkmcnt(0)
    v_mov_b32 v12, 0
    v_mov_b32 v13, 0
    v_mov_b32 v14, 0
    v_mov_b32 v15, 0
F_NT:
    s_cmp_lg_u32 s38, 11
    s_cbranch_scc1 F_SEL
    s_cmp_lt_u32 s2, 192
    s_cbranch_scc1 T_EV
    v_lshrrev_b32 v7, 1, v3
    v_min_u32 v7, 16, v7
    s_and_b32 s52, s2, 31
    s_lshl_b32 s52, s52, 7
    v_add_u32 v7, s52, v7
    s_mov_b64 exec, 0xf
    s_movk_i32 s60, 4000
F_PL:
    buffer_load_dword v8, v7, s[40:43], 0 offen offset:2048 sc1
F_PL_W:
    s_waitcnt vmcnt(0)
F_PL_C:
    v_xor_b32 v9, s39, v8
    v_and_b32 v9, 0xffffdfff, v9
    v_cmp_ne_u32 vcc, 0, v9
    s_nop 0
    s_and_b64 exec, exec, vcc
    s_cbranch_execz F_PL_D
    s_sub_u32 s60, s60, 1
    s_cmp_gt_i32 s60, 0
    s_sleep 2
    s_cbranch_scc1 F_PL
F_PL_D:
    s_mov_b64 exec, 0xf
F_PL_K:
    v_lshrrev_b32 v7, 2, v3
    v_add_u32 v7, 161504, v7
    v_and_b32 v8, 0x2000, v8
    ds_write_b32 v7, v8
    s_mov_b64 exec, -1
    v_readlane_b32 s0, v8, 0
    v_readlane_b32 s1, v8, 1
    v_readlane_b32 s22, v8, 2
    s_branch T_EV
FINAL:
    s_cmp_ge_u32 s2, 144
    s_cbranch_scc1 END
    s_cmp_lg_u32 s38, 11
    s_cbranch_scc1 END
    s_branch T_EV
TOP8:
    s_and_b32 s65, s2, 3
    s_lshl_b32 s65, s65, 14
    s_and_b32 s66, s2, 4
    s_lshl_b32 s66, s66, 11
    s_xor_b32 s66, s66, s0
    s_add_u32 s65, s65, s66
    s_add_u32 s65, s65, 65536
    s_add_u32 s66, s65, 4096
    s_waitcnt lgkmcnt(0)
    buffer_load_dwordx4 v[16:19], v3, s[40:43], s65 offen offset:0 sc1
    buffer_load_dwordx4 v[20:23], v3, s[40:43], s65 offen offset:1024 sc1
    buffer_load_dwordx4 v[24:27], v3, s[40:43], s65 offen offset:2048 sc1
    buffer_load_dwordx4 v[28:31], v3, s[40:43], s65 offen offset:3072 sc1
    buffer_load_dwordx4 v[32:35], v3, s[40:43], s66 offen offset:0 sc1
    buffer_load_dwordx4 v[36:39], v3, s[40:43], s66 offen offset:1024 sc1
    buffer_load_dwordx4 v[40:43], v3, s[40:43], s66 offen offset:2048 sc1
    buffer_load_dwordx4 v[44:47], v3, s[40:43], s66 offen offset:3072 sc1
T_EV:
    v_bfe_i32 v7, v1, 0, 1
    v_bfe_i32 v8, v1, 1, 1
    v_bfe_i32 v9, v1, 3, 1
    v_bfe_i32 v11, v1, 4, 1
    v_bfe_i32 v13, v1, 5, 1
    v_xor_b32 v48, v7, v8
    v_xor_b32 v49, v8, v9
    v_xor_b32 v50, v7, v9
    v_xor_b32 v11, v11, v13
    v_xor_b32 v51, v9, v11
    v_xor_b32 v52, v8, v11
    v_xor_b32 v53, v7, v11
    v_mov_b32 v63, 161492
    v_lshl_add_u32 v13, v1, 2, v63
    v_add_u32 v13, 428, v13
    v_sub_u32 v54, 148464, v3
    v_and_b32 v7, 4, v1
    v_and_b32 v8, 48, v1
    v_lshlrev_b32 v8, 6, v8
    v_lshl_add_u32 v55, v7, 1, v8
    v_add_u32 v55, 147456, v55
    s_and_b32 s65, s2, 3
    s_lshl_b32 s65, s65, 14
    s_and_b32 s66, s2, 4
    s_lshl_b32 s66, s66, 11
    s_xor_b32 s66, s66, s0
    s_add_u32 s65, s65, s66
    s_add_u32 s65, s65, 65536
    s_add_u32 s66, s65, 4096
    s_and_b32 s67, s2, 127
    s_mul_i32 s68, s67, 64
    s_add_u32 s68, s68, s65
    v_mov_b32 v10, 0
    s_cmp_lt_u32 s2, 128
    s_cbranch_scc0 T_E2
    s_movk_i32 s60, 4000
    s_mov_b64 exec, 0x1
    s_waitcnt vmcnt(8)
    buffer_store_dword v167, v10, s[40:43], s50 offen sc1
    s_mov_b64 exec, -1
    s_waitcnt vmcnt(1)
    s_branch T_KP_C
T_E2:
    v_mov_b32 v16, -1
    v_mov_b32 v17, -1
    v_mov_b32 v18, -1
    v_mov_b32 v19, -1
    v_mov_b32 v20, -1
    v_mov_b32 v21, -1
    v_mov_b32 v22, -1
    v_mov_b32 v23, -1
    v_mov_b32 v24, -1
    v_mov_b32 v25, -1
    v_mov_b32 v26, -1
    v_mov_b32 v27, -1
    v_mov_b32 v28, -1
    v_mov_b32 v29, -1
    v_mov_b32 v30, -1
    v_mov_b32 v31, -1
    v_mov_b32 v32, -1
    v_mov_b32 v33, -1
    v_mov_b32 v34, -1
    v_mov_b32 v35, -1
    v_mov_b32 v36, -1
    v_mov_b32 v37, -1
    v_mov_b32 v38, -1
    v_mov_b32 v39, -1
    v_mov_b32 v40, -1
    v_mov_b32 v41, -1
    v_mov_b32 v42, -1
    v_mov_b32 v43, -1
    v_mov_b32 v44, -1
    v_mov_b32 v45, -1
    v_mov_b32 v46, -1
    v_mov_b32 v47, -1
    s_lshr_b32 s52, s67, 3
    s_and_b32 s53, s67, 3
    s_lshl2_add_u32 s52, s52, s53
    s_lshr_b32 s53, s67, 1
    s_xor_b32 s52, s52, s53
    s_lshl_b32 s52, s52, 7
    s_and_b32 s53, s67, 4
    s_lshl_b32 s53, s53, 11
    s_add_u32 s52, s52, s53
    s_cmp_lt_u32 s67, 96
    s_cselect_b32 s53, s1, s22
    s_xor_b32 s52, s52, s53
    s_lshl_b32 s53, s67, 14
    s_add_u32 s52, s52, s53
    s_add_u32 s67, s52, 2621452
    s_mov_b64 exec, 0xf
    s_movk_i32 s60, 4000
T_EP:
    buffer_load_dword v11, v3, s[40:43], s67 offen sc1
T_EP_W:
    s_waitcnt vmcnt(0)
T_EP_C:
    v_cmp_ne_u32 vcc, s39, v11
    s_nop 0
    s_and_b64 exec, exec, vcc
    s_cbranch_execz T_EP_D
    s_sub_u32 s60, s60, 1
    s_cmp_gt_i32 s60, 0
    s_sleep 2
    s_cbranch_scc1 T_EP
T_EP_D:
T_H:
    s_mov_b64 exec, 0x1
    s_movk_i32 s60, 4000
T_HP:
    buffer_load_dword v11, v10, s[40:43], s68 offen sc1
T_HP_W:
    s_waitcnt vmcnt(0)
T_HP_C:
    v_cmp_eq_u32 vcc, -1, v11
    s_nop 0
    s_and_b64 exec, exec, vcc
    s_cbranch_execz T_HP_D
    s_sub_u32 s60, s60, 1
    s_cmp_gt_i32 s60, 0
    s_sleep 1
    s_cbranch_scc1 T_HP
T_HP_D:
    s_mov_b64 exec, -1
    s_cmp_ge_u32 s2, 144
    s_cbranch_scc0 T_KQ
    s_movk_i32 s60, 4000
T_KN:
    buffer_load_dwordx4 v[16:19], v3, s[40:43], s65 offen offset:0 sc1
    buffer_load_dwordx4 v[20:23], v3, s[40:43], s65 offen offset:1024 sc1
    buffer_load_dwordx4 v[24:27], v3, s[40:43], s65 offen offset:2048 sc1
    buffer_load_dwordx4 v[28:31], v3, s[40:43], s65 offen offset:3072 sc1
    buffer_load_dwordx4 v[32:35], v3, s[40:43], s66 offen offset:0 sc1
    buffer_load_dwordx4 v[36:39], v3, s[40:43], s66 offen offset:1024 sc1
    buffer_load_dwordx4 v[40:43], v3, s[40:43], s66 offen offset:2048 sc1
    buffer_load_dwordx4 v[44:47], v3, s[40:43], s66 offen offset:3072 sc1
    s_waitcnt vmcnt(16)
    s_sub_u32 s60, s60, 1
    v_max3_u32 v56, v16, v17, v18
    v_max3_u32 v58, v19, v20, v21
    v_max3_u32 v57, v32, v33, v34
    v_max3_u32 v59, v35, v36, v37
    v_max3_u32 v56, v56, v22, v23
    v_max3_u32 v58, v58, v24, v25
    v_max3_u32 v57, v57, v38, v39
    v_max3_u32 v59, v59, v40, v41
    v_max3_u32 v56, v56, v26, v27
    v_max3_u32 v58, v58, v28, v29
    v_max3_u32 v57, v57, v42, v43
    v_max3_u32 v59, v59, v44, v45
    v_max3_u32 v58, v58, v30, v31
    v_max3_u32 v59, v59, v46, v47
    v_max_u32 v56, v56, v58
    v_max_u32 v57, v57, v59
    v_max_u32 v58, v56, v57
    v_cmp_eq_u32 vcc, -1, v58
    s_nop 0
    s_and_b64 exec, exec, vcc
    s_cselect_b32 s60, s60, 0
    s_cmp_gt_i32 s60, 0
    s_cbranch_scc1 T_KN
    s_branch T_KP_D
T_KQ:
    s_movk_i32 s60, 4000
T_KP:
    buffer_load_dwordx4 v[16:19], v3, s[40:43], s65 offen offset:0 sc1
    buffer_load_dwordx4 v[20:23], v3, s[40:43], s65 offen offset:1024 sc1
    buffer_load_dwordx4 v[24:27], v3, s[40:43], s65 offen offset:2048 sc1
    buffer_load_dwordx4 v[28:31], v3, s[40:43], s65 offen offset:3072 sc1
    buffer_load_dwordx4 v[32:35], v3, s[40:43], s66 offen offset:0 sc1
    buffer_load_dwordx4 v[36:39], v3, s[40:43], s66 offen offset:1024 sc1
    buffer_load_dwordx4 v[40:43], v3, s[40:43], s66 offen offset:2048 sc1
    buffer_load_dwordx4 v[44:47], v3, s[40:43], s66 offen offset:3072 sc1
T_KP_W:
    s_waitcnt vmcnt(0)
T_KP_C:
    v_max3_u32 v56, v16, v17, v18
    v_max3_u32 v58, v19, v20, v21
    v_max3_u32 v57, v32, v33, v34
    v_max3_u32 v59, v35, v36, v37
    v_max3_u32 v56, v56, v22, v23
    v_max3_u32 v58, v58, v24, v25
    v_max3_u32 v57, v57, v38, v39
    v_max3_u32 v59, v59, v40, v41
    v_max3_u32 v56, v56, v26, v27
    v_max3_u32 v58, v58, v28, v29
    v_max3_u32 v57, v57, v42, v43
    v_max3_u32 v59, v59, v44, v45
    v_max3_u32 v58, v58, v30, v31
    v_max3_u32 v59, v59, v46, v47
    v_max_u32 v56, v56, v58
    v_max_u32 v57, v57, v59
    v_max_u32 v58, v56, v57
    v_cmp_eq_u32 vcc, -1, v58
    s_nop 0
    s_and_b64 exec, exec, vcc
    s_cbranch_execz T_KP_D
    s_sub_u32 s60, s60, 1
    s_cmp_gt_i32 s60, 0
    s_cbranch_scc1 T_KP
T_KP_D:
    s_mov_b64 exec, -1
    v_mov_b32_dpp v58, v56 quad_perm:[1,0,3,2] row_mask:0xf bank_mask:0xf
    v_mov_b32_dpp v59, v57 quad_perm:[1,0,3,2] row_mask:0xf bank_mask:0xf
    v_med3_u32 v56, v56, v58, v48
    v_med3_u32 v57, v57, v59, v48
    ds_write_b128 v54, v[16:19] offset:7168
    v_mov_b32_dpp v58, v56 quad_perm:[2,3,0,1] row_mask:0xf bank_mask:0xf
    v_mov_b32_dpp v59, v57 quad_perm:[2,3,0,1] row_mask:0xf bank_mask:0xf
    v_med3_u32 v56, v56, v58, v49
    v_med3_u32 v57, v57, v59, v49
    ds_write_b128 v54, v[20:23] offset:6144
    v_mov_b32_dpp v58, v56 quad_perm:[1,0,3,2] row_mask:0xf bank_mask:0xf
    v_mov_b32_dpp v59, v57 quad_perm:[1,0,3,2] row_mask:0xf bank_mask:0xf
    v_med3_u32 v56, v56, v58, v50
    v_med3_u32 v57, v57, v59, v50
    ds_write_b128 v54, v[24:27] offset:5120
    v_mov_b32_dpp v58, v56 row_ror:8 row_mask:0xf bank_mask:0xf
    v_mov_b32_dpp v59, v57 row_ror:8 row_mask:0xf bank_mask:0xf
    v_med3_u32 v56, v56, v58, v51
    v_med3_u32 v57, v57, v59, v51
    ds_write_b128 v54, v[28:31] offset:4096
    v_mov_b32_dpp v58, v56 quad_perm:[2,3,0,1] row_mask:0xf bank_mask:0xf
    v_mov_b32_dpp v59, v57 quad_perm:[2,3,0,1] row_mask:0xf bank_mask:0xf
    v_med3_u32 v56, v56, v58, v52
    v_med3_u32 v57, v57, v59, v52
    ds_write_b128 v54, v[32:35] offset:3072
    v_mov_b32_dpp v58, v56 quad_perm:[1,0,3,2] row_mask:0xf bank_mask:0xf
    v_mov_b32_dpp v59, v57 quad_perm:[1,0,3,2] row_mask:0xf bank_mask:0xf
    v_med3_u32 v56, v56, v58, v53
    v_med3_u32 v57, v57, v59, v53
    ds_write_b128 v54, v[36:39] offset:2048
    s_nop 0
    v_max_u32_dpp v56, v57, v56 row_mirror row_mask:0xf bank_mask:0xf
    ds_write_b128 v54, v[40:43] offset:1024
    s_nop 0
    v_mov_b32_dpp v58, v56 row_ror:8 row_mask:0xf bank_mask:0xf
    v_med3_u32 v56, v56, v58, v51
    ds_write_b128 v54, v[44:47] offset:0
    s_nop 0
    v_mov_b32_dpp v58, v56 quad_perm:[2,3,0,1] row_mask:0xf bank_mask:0xf
    v_med3_u32 v56, v56, v58, v52
    s_nop 1
    v_mov_b32_dpp v58, v56 quad_perm:[1,0,3,2] row_mask:0xf bank_mask:0xf
    v_med3_u32 v56, v56, v58, v53
    s_nop 1
    v_max_u32_dpp v56, v56, v56 row_mirror row_mask:0xf bank_mask:0xf
    s_nop 1
    v_mov_b32_dpp v58, v56 row_ror:8 row_mask:0xf bank_mask:0xf
    v_med3_u32 v56, v56, v58, v51
    s_nop 1
    v_mov_b32_dpp v58, v56 quad_perm:[2,3,0,1] row_mask:0xf bank_mask:0xf
    v_med3_u32 v56, v56, v58, v52
    s_nop 1
    v_mov_b32_dpp v58, v56 quad_perm:[1,0,3,2] row_mask:0xf bank_mask:0xf
    v_med3_u32 v57, v56, v58, v53
    v_med3_u32 v56, v56, v58, v53
    s_nop 1
    v_permlane16_swap_b32 v56, v57
    v_max_u32 v56, v56, v57
    s_nop 1
    v_mov_b32_dpp v58, v56 row_ror:8 row_mask:0xf bank_mask:0xf
    v_med3_u32 v56, v56, v58, v51
    s_nop 1
    v_mov_b32_dpp v58, v56 quad_perm:[2,3,0,1] row_mask:0xf bank_mask:0xf
    v_med3_u32 v56, v56, v58, v52
    s_nop 1
    v_mov_b32_dpp v58, v56 quad_perm:[1,0,3,2] row_mask:0xf bank_mask:0xf
    v_med3_u32 v57, v56, v58, v53
    v_med3_u32 v56, v56, v58, v53
    s_nop 1
    v_permlane32_swap_b32 v56, v57
    v_max_u32 v56, v56, v57
    ds_write_b32 v13, v56
    s_cmp_lt_u32 s2, 144
    v_and_b32 v58, 0x4fc, v56
    v_lshl_or_b32 v58, v58, 2, v55
    v_mov_b32 v62, v56
    ds_read_b64 v[56:57], v58
    s_cbranch_scc1 T_V
    s_waitcnt lgkmcnt(0)
    s_barrier
    ds_read_b32 v7, v160
    s_waitcnt lgkmcnt(0)
    v_and_b32 v7, 0x7ff, v7
    v_mad_i32_i24 v7, v7, s64, v161
    buffer_load_dwordx4 v[8:11], v7, s[40:43], s63 offen sc1
T_V:
    v_min_u32_dpp v58, v62, v62 quad_perm:[1,0,3,2] row_mask:0xf bank_mask:0xf
    s_nop 1
    v_min_u32_dpp v58, v58, v58 quad_perm:[2,3,0,1] row_mask:0xf bank_mask:0xf
    s_nop 1
    v_min_u32_dpp v58, v58, v58 row_ror:8 row_mask:0xf bank_mask:0xf
    s_waitcnt lgkmcnt(0)
    v_cmp_ge_u32 vcc, v56, v58
    v_cmp_ge_u32 s[52:53], v57, v58
    s_bcnt1_i32_b64 s54, vcc
    s_bcnt1_i32_b64 s52, s[52:53]
    s_add_u32 s52, s52, s54
    s_cmp_eq_u32 s52, 8
    s_cbranch_scc0 T_M
T_OK:
    s_movk_i32 s60, 4000
    s_cmp_lt_u32 s2, 144
    s_cbranch_scc1 FIN
    s_setprio 0
    s_branch F_ZP_W
T_M:
    v_cmp_ne_u32 s[56:57], v62, v56
    v_cmp_ne_u32 s[74:75], v62, v57
    s_nop 0
    v_cndmask_b32 v56, 0, v56, s[56:57]
    v_cndmask_b32 v57, 0, v57, s[74:75]
    s_mov_b64 s[72:73], -1
T_L:
    v_max_u32 v59, v56, v57
    v_cmp_gt_u32 vcc, v59, v58
    s_nop 4
    s_cbranch_vccz T_X
    s_ff1_i32_b64 s52, vcc
    v_cmp_eq_u32 vcc, v62, v58
    v_readlane_b32 s53, v59, s52
    s_ff1_i32_b64 s54, vcc
    s_cmp_lt_u32 s2, 144
    s_cbranch_scc1 T_L2
    s_and_b32 s55, s53, 0x7ff
    s_mul_i32 s55, s55, s64
    s_add_u32 s55, s55, 9435648
    buffer_load_dwordx4 v[64:67], v3, s[40:43], s55 offen sc1
    buffer_load_dwordx4 v[68:71], v3, s[40:43], s55 offen offset:1024 sc1
T_L2:
    v_mov_b32 v59, s53
    v_cndmask_b32 v62, v62, v59, vcc
    v_cmp_ne_u32 s[56:57], s53, v56
    v_cmp_ne_u32 s[74:75], s53, v57
    s_nop 0
    v_cndmask_b32 v56, 0, v56, s[56:57]
    v_cndmask_b32 v57, 0, v57, s[74:75]
    v_min_u32_dpp v58, v62, v62 quad_perm:[1,0,3,2] row_mask:0xf bank_mask:0xf
    s_nop 1
    v_min_u32_dpp v58, v58, v58 quad_perm:[2,3,0,1] row_mask:0xf bank_mask:0xf
    s_nop 1
    v_min_u32_dpp v58, v58, v58 row_ror:8 row_mask:0xf bank_mask:0xf
    s_cmp_lt_u32 s2, 144
    s_cbranch_scc1 T_L
    s_lshr_b32 s52, s54, 1
    s_and_b32 s52, s52, 4
    s_and_b32 s54, s54, 3
    s_add_u32 s54, s54, s52
    s_mul_i32 s54, s54, 608
    s_add_u32 s54, s54, 147456
    v_and_b32 v72, 1, v1
    v_mul_u32_u24 v72, 4862, v72
    v_mul_u32_u24 v73, 6, v1
    v_sub_u32 v74, v73, v72
    v_add_u32 v73, v73, v72
    v_add_u32 v75, s54, v73
    v_add_u32 v76, s54, v74
    s_mov_b64 exec, s[72:73]
    s_movk_i32 s60, 4000
    s_branch T_Z_W
T_Z:
    buffer_load_dwordx4 v[8:11], v7, s[40:43], s63 offen sc1
T_Z_W:
    s_waitcnt vmcnt(0)
T_Z_C:
    v_cmp_ne_u32 vcc, s39, v11
    s_nop 0
    s_and_b64 exec, exec, vcc
    s_cbranch_execz T_Z_D
    s_wqm_b64 exec, exec
    s_sub_u32 s60, s60, 1
    s_cmp_gt_i32 s60, 0
    s_cbranch_scc1 T_Z
T_Z_D:
    s_mov_b64 exec, s[72:73]
    ds_write2_b32 v162, v8, v10 offset0:0 offset1:1
    ds_write_b32 v2, v9
    s_mov_b64 s[72:73], 0
    s_mov_b64 exec, -1
    s_movk_i32 s60, 4000
    s_branch T_F_W
T_F:
    buffer_load_dwordx4 v[64:67], v3, s[40:43], s55 offen sc1
    buffer_load_dwordx4 v[68:71], v3, s[40:43], s55 offen offset:1024 sc1
T_F_W:
    s_waitcnt vmcnt(0)
T_F_C:
    v_cmp_ne_u32 vcc, s39, v67
    v_cmp_ne_u32 s[56:57], s39, v71
    s_nop 0
    s_or_b32 vcc_lo, vcc_lo, s56
    s_and_b64 exec, exec, vcc
    s_cbranch_execz T_F_D
    s_wqm_b64 exec, exec
    s_sub_u32 s60, s60, 1
    s_cmp_gt_i32 s60, 0
    s_cbranch_scc1 T_F
T_F_D:
    s_mov_b64 exec, -1
    s_movk_i32 s60, 4000
T_C:
    ds_read_b32 v72, v63 offset:0
    s_sub_u32 s60, s60, 1
    s_cmp_gt_i32 s60, 0
    s_waitcnt lgkmcnt(0)
    v_readfirstlane_b32 s52, v72
    s_nop 0
    s_cselect_b32 s52, s52, 11
    s_cmp_lg_u32 s52, 11
    s_cbranch_scc1 T_C
    ds_write2_b32 v75, v64, v66 offset0:0 offset1:1
    ds_write_b32 v76, v65 offset:4864
    s_mov_b32 exec_hi, 0
    ds_write2_b32 v75, v68, v70 offset0:96 offset1:97
    ds_write_b32 v76, v69 offset:5248
    s_mov_b64 exec, -1
    s_branch T_L
T_X:
    s_movk_i32 s60, 4000
    s_cmp_lt_u32 s2, 144
    s_cbranch_scc1 FIN
    s_setprio 0
    s_branch F_BQ
F_SEL:
    s_setprio 0
    s_waitcnt lgkmcnt(0)
    s_barrier
    ds_read_b32 v7, v160
    s_waitcnt lgkmcnt(0)
    v_and_b32 v7, 0x7ff, v7
    v_mad_i32_i24 v7, v7, s64, v161
    s_movk_i32 s60, 4000
F_ZP:
    buffer_load_dwordx4 v[8:11], v7, s[40:43], s63 offen sc1
F_ZP_W:
    s_waitcnt vmcnt(0)
F_ZP_C:
    v_cmp_ne_u32 vcc, s39, v11
    s_nop 0
    s_and_b64 exec, exec, vcc
    s_cbranch_execz F_ZP_D
    s_wqm_b64 exec, exec
    s_sub_u32 s60, s60, 1
    s_cmp_gt_i32 s60, 0
    s_cbranch_scc1 F_ZP
F_ZP_D:
    s_mov_b64 exec, -1
    ds_write2_b32 v162, v8, v10 offset0:0 offset1:1
    ds_write_b32 v2, v9
    s_mov_b64 exec, 0x1
    ds_inc_u32 v63, v63 offset:0
    s_mov_b64 exec, -1
F_BQ:
    s_cmp_ge_u32 s38, s59
    s_waitcnt lgkmcnt(0)
    s_barrier
    s_cbranch_scc1 F_H
    ds_read_b128 v[16:19], v163 offset:0
    ds_read_b128 v[20:23], v163 offset:64
    ds_read_b128 v[24:27], v163 offset:128
    ds_read_b128 v[28:31], v163 offset:192
    ds_read_b128 v[32:35], v163 offset:256
    ds_read_b128 v[36:39], v163 offset:320
    ds_read_b128 v[40:43], v163 offset:384
    ds_read_b128 v[44:47], v163 offset:448
    ds_read_b128 v[48:51], v163 offset:512
    s_waitcnt lgkmcnt(8)
    v_smfmac_f32_16x16x64_bf16 v[12:15], v[16:19], v[64:71], v6
    s_waitcnt lgkmcnt(7)
    v_smfmac_f32_16x16x64_bf16 v[12:15], v[20:23], v[72:79], v6
    s_waitcnt lgkmcnt(6)
    v_smfmac_f32_16x16x64_bf16 v[12:15], v[24:27], v[80:87], v6
    s_waitcnt lgkmcnt(5)
    v_smfmac_f32_16x16x64_bf16 v[12:15], v[28:31], v[88:95], v6
    s_waitcnt lgkmcnt(4)
    v_smfmac_f32_16x16x64_bf16 v[12:15], v[32:35], v[96:103], v6
    s_waitcnt lgkmcnt(3)
    v_smfmac_f32_16x16x64_bf16 v[12:15], v[36:39], v[104:111], v6
    s_waitcnt lgkmcnt(2)
    v_smfmac_f32_16x16x64_bf16 v[12:15], v[40:43], v[112:119], v6
    s_waitcnt lgkmcnt(1)
    v_smfmac_f32_16x16x64_bf16 v[12:15], v[44:47], v[120:127], v6
    s_waitcnt lgkmcnt(0)
    v_smfmac_f32_16x16x64_bf16 v[12:15], v[48:51], v[128:135], v6
    s_nop 7
    v_permlane32_swap_b32 v12, v14
    v_permlane32_swap_b32 v13, v15
    v_add_f32 v12, v12, v14
    v_add_f32 v13, v13, v15
    v_cvt_pk_bf16_f32 v12, v12, v13
    s_nop 1
    v_mov_b32_dpp v13, v12 row_ror:8 row_mask:0xf bank_mask:0xf
    v_perm_b32 v8, v12, v13, v4
    v_mul_f32 v10, 0xbfb8aa3b, v8
    v_exp_f32 v10, v10
    v_perm_b32 v9, v12, v13, v5
    v_add_f32 v10, 1.0, v10
    v_rcp_f32 v10, v10
    s_nop 0
    v_mul_f32 v8, v8, v10
    v_cvt_pk_bf16_f32 v8, v8, v8
    v_lshlrev_b32 v8, 16, v8
    v_mul_f32 v8, v8, v9
    v_cvt_pk_bf16_f32 v8, v8, v8
    ds_write_b16 v164, v8
F_H:
    ds_read_b32 v56, v63 offset:12
    s_waitcnt lgkmcnt(0)
    s_barrier
    ds_read_b128 v[16:19], v60
    ds_read_b128 v[20:23], v60 offset:1024
    ds_read_b128 v[24:27], v61
    ds_read_b128 v[28:31], v61 offset:1024
    v_xor_b32 v165, v56, v165
    v_xor_b32 v166, v56, v166
    s_waitcnt lgkmcnt(3)
    v_mfma_f32_16x16x32_bf16 v[12:15], v[16:19], v[152:155], 0
    v_mfma_f32_16x16x32_bf16 v[8:11], v[16:19], v[136:139], 0
    s_waitcnt lgkmcnt(2)
    v_mfma_f32_16x16x32_bf16 v[12:15], v[20:23], v[156:159], v[12:15]
    v_mfma_f32_16x16x32_bf16 v[8:11], v[20:23], v[140:143], v[8:11]
    s_waitcnt lgkmcnt(1)
    v_mfma_f32_16x16x32_bf16 v[8:11], v[24:27], v[144:147], v[8:11]
    s_waitcnt lgkmcnt(0)
    v_mfma_f32_16x16x32_bf16 v[8:11], v[28:31], v[148:151], v[8:11]
    s_mov_b32 exec_hi, 0
    s_nop 1
    buffer_store_dwordx4 v[12:15], v166, s[40:43], s62 offen sc1
    s_mov_b64 exec, -1
    s_nop 2
    buffer_store_dwordx4 v[8:11], v165, s[40:43], s62 offen sc1
    s_branch END
FIN:
    s_cmp_ge_u32 s2, 72
    s_cselect_b32 s44, 32, 0
    s_cselect_b32 s45, 72, 0
    s_sub_u32 s45, s2, s45
    s_mul_i32 s46, s45, 43
    s_lshr_b32 s46, s46, 8
    s_mul_i32 s47, s46, 6
    s_sub_u32 s47, s45, s47
    v_lshrrev_b32 v6, 4, v1
    s_lshr_b32 s54, s2, 3
    s_lshl_b32 s55, s54, 16
    s_add_u32 s55, s55, s65
    s_add_u32 s55, s55, 196608
    v_mov_b32 v15, 0
    s_mov_b64 exec, 0x1
    buffer_load_dword v14, v15, s[40:43], s55 offen sc1
    s_mov_b64 exec, -1
    v_lshl_add_u32 v7, v6, 2, s44
    ds_bpermute_b32 v7, v7, v62
    v_and_b32 v8, 7, v1
    v_and_b32 v5, 15, v1
    s_lshl_b32 s48, s47, 2
    s_add_u32 s49, s48, 16384 - 16
    s_cmp_eq_u32 s47, 3
    s_cselect_b32 s49, 16384 + 8, s49
    s_cmp_lt_u32 s47, 3
    s_cselect_b32 s48, s48, s49
    s_cmp_lt_u32 s46, 6
    s_cselect_b32 s1, s1, s22
    s_and_b32 s49, s46, 7
    s_lshl_b32 s49, s49, 10
    s_or_b32 s1, s1, s49
    s_lshl_b32 s49, s46, 18
    s_add_u32 s48, s48, s49
    s_add_u32 s48, s48, 2621440
    s_lshl_b32 s47, s47, 1
    s_lshl_b32 s49, s46, 7
    s_add_u32 s49, s49, s47
    s_add_u32 s49, s49, 6291456
    s_mul_i32 s46, s46, 96
    s_add_u32 s46, s46, s47
    s_movk_i32 s47, 8192
    s_mov_b32 s52, s55
    s_lshl_b32 s54, s54, 14
    s_and_b32 s53, s55, 0x2000
    s_add_u32 s54, s54, s53
    s_and_b32 s53, s2, 3
    s_lshl_b32 s53, s53, 11
    s_add_u32 s54, s54, s53
    s_add_u32 s54, s54, 1441792
    s_add_u32 s53, s52, 4096
    v_mov_b32 v60, 0
    v_mov_b32 v61, 0
    v_mov_b32 v62, 0
    s_waitcnt lgkmcnt(0)
    v_and_b32 v9, 0x7ff, v7
    v_sub_u32 v9, 0x7ff, v9
    v_lshrrev_b32 v10, 4, v9
    v_lshlrev_b32 v11, 6, v10
    v_min_u32 v5, 11, v5
    v_lshl_add_u32 v11, v5, 2, v11
    v_mul_u32_u24 v12, 0x480, v9
    v_mad_u32_u24 v12, v8, 12, v12
    v_add_u32 v12, s46, v12
    v_and_b32 v13, 0x30, v9
    v_and_b32 v10, 0x780, v9
    v_lshlrev_b32 v10, 2, v10
    v_lshl_add_u32 v10, v13, 3, v10
    v_and_b32 v13, 0x40, v9
    v_lshl_add_u32 v10, v13, 7, v10
    v_mul_u32_u24 v13, 0x8080, v8
    v_xor_b32 v10, v13, v10
    v_xor_b32 v10, s1, v10
    v_and_b32 v13, 14, v9
    v_lshl_add_u32 v10, v13, 3, v10
    v_and_b32 v13, 1, v9
    v_lshl_add_u32 v10, v13, 1, v10
    v_mul_u32_u24 v9, 0x600, v9
    v_lshl_add_u32 v9, v8, 4, v9
    global_load_short_d16_hi v60, v12, s[4:5]
    buffer_load_short_d16_hi v61, v10, s[40:43], s48 offen sc1
    v_ashrrev_i32 v6, 31, v7
    v_not_b32 v6, v6
    v_or_b32 v6, 0x80000000, v6
    v_xor_b32 v7, v7, v6
    v_and_b32 v7, 0xffff0000, v7
    v_mul_f32 v7, 0xbfb8aa3b, v7
    v_exp_f32 v7, v7
    s_nop 0
    v_add_f32 v7, 1.0, v7
    v_rcp_f32 v7, v7
    s_nop 0
    v_cvt_pk_bf16_f32 v7, v7, v7
    v_lshlrev_b32 v7, 16, v7
    s_mov_b64 exec, 0x1
    s_movk_i32 s60, 4000
    s_waitcnt vmcnt(2)
    s_branch FN_HP_C
    s_movk_i32 s60, 4000
FN_HP:
    buffer_load_dword v14, v15, s[40:43], s55 offen sc1
FN_HP_W:
    s_waitcnt vmcnt(0)
FN_HP_C:
    v_cmp_eq_u32 vcc, -1, v14
    s_nop 0
    s_and_b64 exec, exec, vcc
    s_cbranch_execz FN_HP_D
    s_sub_u32 s60, s60, 1
    s_cmp_gt_i32 s60, 0
    s_cbranch_scc1 FN_HP
FN_HP_D:
    s_mov_b64 exec, -1
    buffer_load_dword v13, v11, s[40:43], s47 offen sc1
    buffer_load_short_d16_hi v62, v9, s[40:43], s49 offen sc1
    buffer_load_dwordx4 v[16:19], v3, s[40:43], s52 offen offset:0 sc1
    buffer_load_dwordx4 v[20:23], v3, s[40:43], s52 offen offset:1024 sc1
    buffer_load_dwordx4 v[24:27], v3, s[40:43], s52 offen offset:2048 sc1
    buffer_load_dwordx4 v[28:31], v3, s[40:43], s52 offen offset:3072 sc1
    buffer_load_dwordx4 v[32:35], v3, s[40:43], s53 offen offset:0 sc1
    buffer_load_dwordx4 v[36:39], v3, s[40:43], s53 offen offset:1024 sc1
    buffer_load_dwordx4 v[40:43], v3, s[40:43], s53 offen offset:2048 sc1
    buffer_load_dwordx4 v[44:47], v3, s[40:43], s53 offen offset:3072 sc1
    buffer_load_dwordx4 v[48:51], v3, s[40:43], s54 offen offset:0 sc1
    buffer_load_dwordx4 v[52:55], v3, s[40:43], s54 offen offset:1024 sc1
    s_waitcnt vmcnt(12)
    v_add_f32 v60, v60, v61
    v_cvt_pk_bf16_f32 v60, v60, v60
    v_lshlrev_b32 v60, 16, v60
    s_movk_i32 s60, 4000
    s_branch FN_PP_W
FN_PP:
    buffer_load_dword v13, v11, s[40:43], s47 offen sc1
    buffer_load_short_d16_hi v62, v9, s[40:43], s49 offen sc1
    buffer_load_dwordx4 v[16:19], v3, s[40:43], s52 offen offset:0 sc1
    buffer_load_dwordx4 v[20:23], v3, s[40:43], s52 offen offset:1024 sc1
    buffer_load_dwordx4 v[24:27], v3, s[40:43], s52 offen offset:2048 sc1
    buffer_load_dwordx4 v[28:31], v3, s[40:43], s52 offen offset:3072 sc1
    buffer_load_dwordx4 v[32:35], v3, s[40:43], s53 offen offset:0 sc1
    buffer_load_dwordx4 v[36:39], v3, s[40:43], s53 offen offset:1024 sc1
    buffer_load_dwordx4 v[40:43], v3, s[40:43], s53 offen offset:2048 sc1
    buffer_load_dwordx4 v[44:47], v3, s[40:43], s53 offen offset:3072 sc1
    buffer_load_dwordx4 v[48:51], v3, s[40:43], s54 offen offset:0 sc1
    buffer_load_dwordx4 v[52:55], v3, s[40:43], s54 offen offset:1024 sc1
FN_PP_W:
    s_waitcnt vmcnt(0)
FN_PP_C:
    v_cmp_ne_u32 s[56:57], s39, v13
    v_pk_add_f32 v[64:65], v[16:17], v[20:21]
    v_pk_add_f32 v[68:69], v[24:25], v[28:29]
    v_pk_add_f32 v[66:67], v[18:19], v[22:23]
    v_pk_add_f32 v[70:71], v[26:27], v[30:31]
    v_pk_add_f32 v[64:65], v[64:65], v[32:33]
    v_pk_add_f32 v[66:67], v[66:67], v[34:35]
    v_pk_add_f32 v[68:69], v[68:69], v[36:37]
    v_pk_add_f32 v[70:71], v[70:71], v[38:39]
    v_pk_add_f32 v[64:65], v[64:65], v[40:41]
    v_pk_add_f32 v[66:67], v[66:67], v[42:43]
    v_pk_add_f32 v[68:69], v[68:69], v[44:45]
    v_pk_add_f32 v[70:71], v[70:71], v[46:47]
    v_pk_add_f32 v[64:65], v[64:65], v[48:49]
    v_pk_add_f32 v[66:67], v[66:67], v[50:51]
    v_pk_add_f32 v[68:69], v[68:69], v[52:53]
    v_pk_add_f32 v[70:71], v[70:71], v[54:55]
    v_pk_add_f32 v[64:65], v[64:65], v[68:69]
    v_pk_add_f32 v[66:67], v[66:67], v[70:71]
    v_pk_add_f32 v[68:69], v[64:65], v[66:67]
    v_cmp_u_f32 vcc, v68, v69
    s_nop 0
    s_or_b64 vcc, vcc, s[56:57]
    s_and_b64 exec, exec, vcc
    s_cbranch_execz FN_PP_D
    s_sub_u32 s60, s60, 1
    s_cmp_gt_i32 s60, 0
    s_cbranch_scc1 FN_PP
FN_PP_D:
    s_mov_b64 exec, -1
    v_permlane32_swap_b32 v64, v66
    v_permlane32_swap_b32 v65, v67
    v_add_f32 v64, v64, v66
    v_add_f32 v65, v65, v67
    s_nop 1
    v_permlane16_swap_b32 v64, v65
    v_add_f32 v64, v64, v65
    s_nop 1
    v_add_f32_dpp v64, v64, v64 row_ror:8 row_mask:0xf bank_mask:0xf
    v_cvt_pk_bf16_f32 v64, v64, v64
    v_lshlrev_b32 v64, 16, v64
    v_mul_f32 v64, v64, v7
    v_cvt_pk_bf16_f32 v64, v64, v64
    v_lshlrev_b32 v64, 16, v64
    v_add_f32 v64, v64, v62
    v_cvt_pk_bf16_f32 v64, v64, v64
    v_lshlrev_b32 v64, 16, v64
    v_add_f32 v64, v64, v60
    v_cvt_pk_bf16_f32 v64, v64, v64
    s_mov_b32 exec_lo, 0xff00ff
    s_mov_b32 exec_hi, 0xff00ff
    global_store_short v12, v64, s[32:33]
    s_mov_b64 exec, -1
END:
    s_endpgm
CODE_END:
.section .rodata,"a"
.p2align 6
.amdhsa_kernel sequential_preLN__ssm_conv_s4__moe_arch_mod__prompt_kernel
  .amdhsa_next_free_vgpr 168
  .amdhsa_next_free_sgpr 102
  .amdhsa_accum_offset 168
  .amdhsa_group_segment_fixed_size 0
  .amdhsa_kernarg_size 136
  .amdhsa_user_sgpr_count 2
  .amdhsa_user_sgpr_kernarg_segment_ptr 1
  .amdhsa_system_sgpr_workgroup_id_x 1
.end_amdhsa_kernel
```

```asm
; @launch grid=(256,1,1) block=(768,1,1) lds=163840
.amdgcn_target "amdgcn-amd-amdhsa--gfx950"
    .text
    .globl sequential_preLN__ssm_conv_s4__moe_arch_mod__prompt_kernel
    .p2align 8
    .type sequential_preLN__ssm_conv_s4__moe_arch_mod__prompt_kernel,@function
sequential_preLN__ssm_conv_s4__moe_arch_mod__prompt_kernel:
    s_cmp_ge_u32 s2, 256
    s_cbranch_scc1 END
    s_load_dwordx16 s[4:19], s[0:1], 0
    s_load_dwordx2 s[36:37], s[0:1], 128
    s_load_dwordx16 s[20:35], s[0:1], 64
    s_getpc_b64 s[70:71]
    s_lshr_b32 s3, s2, 3
    s_mul_i32 s3, s3, 7
    v_subrev_u32 v2, 320, v0
    v_cmp_gt_u32 vcc, 7, v2
    v_add_lshl_u32 v2, v2, s3, 7
    v_min_u32 v2, CODE_END-sequential_preLN__ssm_conv_s4__moe_arch_mod__prompt_kernel-64, v2
    v_mov_b32 v3, s71
    s_mov_b64 exec, vcc
    v_add_co_u32 v2, vcc, s70, v2
    s_nop 1
    v_addc_co_u32 v3, vcc, 0, v3, vcc
    s_cbranch_execz P_NC
    global_load_dword v159, v[2:3], off
P_NC:
    s_mov_b64 exec, -1
    v_lshrrev_b32 v2, 6, v0
    v_and_b32 v1, 63, v0
    v_readfirstlane_b32 s38, v2
    v_lshlrev_b32 v3, 4, v1
    s_mov_b32 s42, 0x10000000
    s_mov_b32 s43, 0x00020000
    s_cmp_lt_u32 s2, 192
    s_cselect_b32 s3, 4, -1
    s_cmp_lg_u32 s38, s3
    s_cbranch_scc1 P_NP
    s_mul_i32 s52, s2, 768
    v_add_u32 v16, s52, v3
    s_mul_i32 s52, s2, 6
    s_and_b32 s52, s52, -4
    v_lshl_add_u32 v17, v1, 2, s52
    v_mov_b32 v18, 161536
    v_mov_b32 v19, 0
    ds_write_b32 v18, v19
    v_mov_b32 v20, s70
    v_mov_b32 v21, s71
    s_waitcnt lgkmcnt(0)
    s_mov_b32 exec_lo, 0xffffffff
    s_mov_b32 exec_hi, 0xffff
    s_mov_b32 m0, 138048
    s_nop 0
    global_load_lds_dwordx4 v16, s[6:7]
    s_mov_b32 m0, 138816
    s_nop 0
    global_load_lds_dwordx4 v16, s[8:9]
    s_mov_b32 m0, 139584
    s_nop 0
    global_load_lds_dwordx4 v16, s[10:11]
    s_mov_b32 m0, 140352
    s_nop 0
    global_load_lds_dwordx4 v16, s[12:13]
    s_mov_b32 m0, 141120
    s_nop 0
    global_load_lds_dwordx4 v16, s[14:15]
    s_mov_b32 m0, 141888
    s_nop 0
    global_load_lds_dwordx4 v16, s[16:17]
    s_mov_b64 exec, 0x3
    s_mov_b32 m0, 142656
    s_nop 0
    global_load_lds_dword v17, s[18:19]
    s_mov_b32 m0, 142672
    s_nop 0
    global_load_lds_dword v17, s[20:21]
    s_mov_b64 exec, 0x1
    s_mov_b32 m0, 161536
    s_nop 0
    global_load_lds_dword v[20:21], off
    s_mov_b64 exec, -1
P_NP:
    s_cmp_ge_u32 s38, 4
    s_cbranch_scc1 P_B
    s_setprio 3
    v_lshrrev_b32 v147, 5, v0
    v_and_b32 v148, 31, v0
    v_mul_u32_u24 v140, 0x480, v147
    s_mul_i32 s44, s2, 9216
    v_mad_u32_u24 v140, v148, 12, v140
    v_mov_b32 v104, 0
    v_mov_b32 v105, 0
    v_mov_b32 v106, 0
    v_mov_b32 v107, 0
    v_add_u32 v140, s44, v140
    v_add_u32 v149, 161280, v3
    s_mov_b64 exec, 0xffff
    ds_write_b128 v149, v[104:107]
    s_mov_b64 exec, -1
    v_mov_b32 v94, 1
    v_and_b32 v147, 1, v147
    v_mul_u32_u24 v141, 0x90, v148
    v_lshl_add_u32 v141, v147, 6, v141
    s_lshl_b32 s45, s38, 4
    s_sub_u32 s45, 147504, s45
    v_add_u32 v141, s45, v141
    v_lshrrev_b32 v142, 3, v1
    v_add_u32 v142, v142, v1
    s_mul_i32 s45, s38, 3456
    s_add_u32 s45, s45, 147456
    v_lshl_add_u32 v142, v142, 4, s45
    v_lshrrev_b32 v143, 2, v1
    v_mul_u32_u24 v143, 16320, v143
    v_add_u32 v143, v143, v3
    s_lshl_b32 s46, s2, 6
    s_sub_u32 s46, 2637760, s46
    s_mul_i32 s45, s38, 786432
    s_add_u32 s46, s46, s45
    s_add_u32 s47, s46, 262144
    s_add_u32 s48, s46, 524288
    s_mov_b32 s49, 0x05040100
    s_mov_b32 s50, 0x07060302
    v_mov_b32 v144, s49
    s_mov_b32 exec_lo, 0
    v_mov_b32 v144, s50
    s_mov_b64 exec, -1
    v_mov_b32 v145, 161328
    s_lshl_b32 s45, s38, 2
    v_add_u32 v146, s45, v145
    s_waitcnt lgkmcnt(0)
    global_load_dword v95, v104, s[36:37] offset:0
    global_load_dwordx3 v[60:62], v140, s[4:5] offset:0
    global_load_dwordx3 v[64:66], v140, s[4:5] offset:384
    global_load_dwordx3 v[68:70], v140, s[4:5] offset:768
    s_mov_b32 s40, s36
    s_mov_b32 s41, s37
    s_cmp_ge_u32 s2, 192
    s_cbranch_scc1 P_C
    s_lshr_b32 s65, s38, 2
    s_bitcmp1_b32 s2, 0
    s_addc_u32 s51, s65, 0
    s_cmp_eq_u32 s51, 3
    s_cselect_b32 s51, 0, s51
    s_lshl_b32 s52, s51, 8
    s_add_u32 s52, s52, 138048
    v_and_b32 v114, 0x7f, v0
    v_lshl_add_u32 v114, v114, 1, s52
    s_and_b32 s52, s2, 1
    s_add_u32 s52, s52, s51
    s_lshl_b32 s52, s52, 1
    s_add_u32 s52, s52, 142656
    v_mov_b32 v115, s52
    v_mov_b32 v119, 161536
    v_mov_b32 v29, 0
    v_mov_b32 v30, 0
    v_mov_b32 v31, 0
    v_mov_b32 v32, 0
    v_mov_b32 v33, 0
    v_mov_b32 v34, 0
    v_mov_b32 v35, 0
    v_mov_b32 v160, 0
    v_mov_b32 v161, 0
    v_mov_b32 v162, 0
    v_mov_b32 v163, 0
    v_mov_b32 v164, 0
    v_lshlrev_b32 v16, 4, v0
    v_add_u32 v17, 101184, v16
    ds_write_b128 v17, v[160:163] offset:0
    ds_write_b128 v17, v[160:163] offset:12288
    ds_write_b128 v17, v[160:163] offset:24576
    s_mul_i32 s59, s65, 16320
    s_mul_i32 s67, s65, 17408
    s_add_u32 s71, s67, 48960
    s_and_b32 s66, s38, 1
    s_lshl_b32 s66, s66, 8
    s_add_u32 s70, s66, s67
    s_add_u32 s70, s70, 16192
    s_add_u32 s66, s66, s59
    s_mov_b32 m0, s66
    s_mul_i32 s64, s65, 5888
    s_add_u32 s64, s64, 101184
    s_and_b32 s69, s38, 3
    v_and_b32 v5, 15, v0
    v_bfe_u32 v6, v0, 4, 2
    v_and_b32 v17, 48, v0
    v_mul_u32_u24 v110, 544, v5
    s_mov_b32 s52, 0
    s_movk_i32 s53, 2176
    s_movk_i32 s54, 4896
    s_cmp_eq_u32 s69, 1
    s_cselect_b32 s52, 9792, s52
    s_cselect_b32 s53, 1088, s53
    s_cselect_b32 s54, 3264, s54
    s_cmp_eq_u32 s69, 3
    s_cselect_b32 s52, 544, s52
    s_add_u32 s52, s52, s59
    s_cmp_eq_u32 s69, 2
    s_cselect_b32 s52, s71, s52
    s_cselect_b32 s54, 4352, s54
    s_add_u32 s67, s71, 8704
    v_and_b32 v111, 3, v0
    v_mul_u32_u24 v111, 544, v111
    v_bfe_u32 v18, v0, 2, 1
    v_bfe_u32 v19, v0, 3, 1
    v_xor_b32 v18, v18, v19
    v_mad_u32_u24 v111, v19, s53, v111
    v_mad_u32_u24 v111, v18, s54, v111
    v_add3_u32 v111, v111, v17, s52
    v_add3_u32 v110, v110, v17, s67
    s_barrier
    v_lshl_add_u32 v18, v5, 1, v6
    s_sub_u32 s52, s69, 11
    v_add_u32 v18, s52, v18
    v_add_u32 v19, 1, v18
    v_lshl_add_u32 v20, v6, 1, 2
    v_cmp_le_u32 s[52:53], v18, v20
    v_cmp_le_u32 s[54:55], v19, v20
    v_mov_b32 v18, 0x3f80
    v_cndmask_b32 v112, 0, v18, s[52:53]
    v_cndmask_b32 v19, 0, 1.0, s[54:55]
    v_or_b32 v112, v112, v19
    s_mul_i32 s52, s38, 1600
    s_add_u32 s52, s52, 120016
    v_lshl_add_u32 v113, v1, 2, s52
    s_mul_i32 s67, s65, 6400
    s_add_u32 s67, s67, 118848
    s_sub_u32 s63, s69, s65
    s_cselect_b32 s52, 3, 0
    s_add_u32 s63, s63, s52
    s_min_u32 s52, s63, 1
    s_add_u32 s63, s63, s52
    s_cmp_eq_u32 s69, 3
    s_cselect_b32 s63, 1, s63
    v_add_u32 v7, 1, v5
    v_and_b32 v8, 3, v7
    v_mul_u32_u24 v8, 1598, v8
    v_lshl_add_u32 v7, v7, 1, v8
    v_add3_u32 v7, v7, v17, s67
    v_add_u32 v18, s64, v17
    v_lshl_add_u32 v9, v5, 3, v18
    v_and_b32 v10, 1, v5
    v_mul_u32_u24 v10, 380, v10
    v_lshl_add_u32 v10, v5, 2, v10
    v_add_u32 v10, v18, v10
    v_lshlrev_b32 v8, 5, v5
    v_sub_u32 v8, v18, v8
    v_lshrrev_b32 v11, 2, v5
    v_lshl_add_u32 v2, v5, 2, v6
    v_add_u32 v15, v2, v11
    v_lshl_add_u32 v4, v15, 3, s59
    s_lshl_b32 s52, s65, 4
    s_add_u32 s52, s52, 161280
    v_mov_b32 v166, s52
    s_branch P_D
P_C:
    v_mov_b32 v8, 0
    v_mov_b32 v10, 0
    v_mov_b32 v166, 0
    v_mov_b32 v9, 0
    s_barrier
P_D:
    v_mov_b32 v117, 0
    v_mov_b32 v118, 0
    v_mov_b32 v116, 0
    s_waitcnt vmcnt(0)
LN1:
    v_dot2c_f32_bf16 v104, 0x3f803f80, v60
    v_dot2c_f32_bf16 v106, v60, v60
    v_dot2c_f32_bf16 v105, 0x3f803f80, v61
    v_dot2c_f32_bf16 v107, v61, v61
    v_dot2c_f32_bf16 v104, 0x3f803f80, v62
    v_dot2c_f32_bf16 v106, v62, v62
    v_dot2c_f32_bf16 v105, 0x3f803f80, v64
    v_dot2c_f32_bf16 v107, v64, v64
    v_dot2c_f32_bf16 v104, 0x3f803f80, v65
    v_dot2c_f32_bf16 v106, v65, v65
    v_dot2c_f32_bf16 v105, 0x3f803f80, v66
    v_dot2c_f32_bf16 v107, v66, v66
    v_dot2c_f32_bf16 v104, 0x3f803f80, v68
    v_dot2c_f32_bf16 v106, v68, v68
    v_dot2c_f32_bf16 v105, 0x3f803f80, v69
    v_dot2c_f32_bf16 v107, v69, v69
    v_dot2c_f32_bf16 v104, 0x3f803f80, v70
    v_dot2c_f32_bf16 v106, v70, v70
    v_add_u32 v95, 1, v95
    s_mov_b64 exec, 0x7
    ds_write_b64 v149, v[94:95] offset:136
    s_mov_b64 exec, -1
    v_add_f32 v104, v104, v105
    v_add_f32 v106, v106, v107
    v_lshlrev_b32 v72, 16, v60
    v_and_b32 v73, 0xffff0000, v60
    v_permlane16_swap_b32 v104, v106
    v_add_f32 v104, v104, v106
    v_lshlrev_b32 v74, 16, v61
    v_and_b32 v75, 0xffff0000, v61
    v_add_f32_dpp v104, v104, v104 quad_perm:[1,0,3,2] row_mask:0xf bank_mask:0xf
    v_lshlrev_b32 v76, 16, v62
    v_and_b32 v77, 0xffff0000, v62
    v_add_f32_dpp v104, v104, v104 quad_perm:[2,3,0,1] row_mask:0xf bank_mask:0xf
    v_lshlrev_b32 v78, 16, v64
    v_and_b32 v79, 0xffff0000, v64
    v_add_f32_dpp v104, v104, v104 row_half_mirror row_mask:0xf bank_mask:0xf
    v_lshlrev_b32 v80, 16, v65
    v_and_b32 v81, 0xffff0000, v65
    v_add_f32_dpp v104, v104, v104 row_mirror row_mask:0xf bank_mask:0xf
    v_mul_f32 v104, 0x3ae38e39, v104
    v_mov_b32 v105, v104
    v_lshlrev_b32 v82, 16, v66
    v_and_b32 v83, 0xffff0000, v66
    v_permlane16_swap_b32 v104, v105
    v_fma_f32 v105, -v104, v104, v105
    v_max_f32 v105, 0, v105
    v_cvt_pk_bf16_f32 v105, v104, v105
    v_lshlrev_b32 v104, 16, v105
    v_and_b32 v105, 0xffff0000, v105
    v_lshlrev_b32 v84, 16, v68
    v_and_b32 v85, 0xffff0000, v68
    v_lshlrev_b32 v86, 16, v69
    v_and_b32 v87, 0xffff0000, v69
    v_lshlrev_b32 v88, 16, v70
    v_and_b32 v89, 0xffff0000, v70
    v_readfirstlane_b32 s39, v95
    v_xor_b32 v99, 0x80000000, v95
    v_xor_b32 v103, 0x80000000, v95
    v_xor_b32 v95, 0x80000000, v95
    v_add_f32 v105, 0x3727c5ac, v105
    v_cvt_pk_bf16_f32 v105, v105, v105
    v_lshlrev_b32 v105, 16, v105
    v_sqrt_f32 v106, v105
    v_pk_add_f32 v[72:73], v[72:73], v[104:105] op_sel_hi:[1,0] neg_lo:[0,1] neg_hi:[0,1]
    v_pk_add_f32 v[74:75], v[74:75], v[104:105] op_sel_hi:[1,0] neg_lo:[0,1] neg_hi:[0,1]
    v_pk_add_f32 v[76:77], v[76:77], v[104:105] op_sel_hi:[1,0] neg_lo:[0,1] neg_hi:[0,1]
    v_cvt_pk_bf16_f32 v106, v106, v106
    v_lshlrev_b32 v106, 16, v106
    v_rcp_f32 v106, v106
    v_pk_add_f32 v[78:79], v[78:79], v[104:105] op_sel_hi:[1,0] neg_lo:[0,1] neg_hi:[0,1]
    v_pk_add_f32 v[80:81], v[80:81], v[104:105] op_sel_hi:[1,0] neg_lo:[0,1] neg_hi:[0,1]
    v_pk_add_f32 v[82:83], v[82:83], v[104:105] op_sel_hi:[1,0] neg_lo:[0,1] neg_hi:[0,1]
    v_pk_add_f32 v[84:85], v[84:85], v[104:105] op_sel_hi:[1,0] neg_lo:[0,1] neg_hi:[0,1]
    v_pk_add_f32 v[86:87], v[86:87], v[104:105] op_sel_hi:[1,0] neg_lo:[0,1] neg_hi:[0,1]
    v_pk_add_f32 v[88:89], v[88:89], v[104:105] op_sel_hi:[1,0] neg_lo:[0,1] neg_hi:[0,1]
    v_cvt_pk_bf16_f32 v73, v72, v73
    v_cvt_pk_bf16_f32 v75, v74, v75
    v_cvt_pk_bf16_f32 v77, v76, v77
    v_cvt_pk_bf16_f32 v79, v78, v79
    v_cvt_pk_bf16_f32 v81, v80, v81
    v_cvt_pk_bf16_f32 v83, v82, v83
    v_cvt_pk_bf16_f32 v85, v84, v85
    v_cvt_pk_bf16_f32 v87, v86, v87
    v_cvt_pk_bf16_f32 v89, v88, v89
    v_lshlrev_b32 v72, 16, v73
    v_and_b32 v73, 0xffff0000, v73
    v_lshlrev_b32 v74, 16, v75
    v_and_b32 v75, 0xffff0000, v75
    v_lshlrev_b32 v76, 16, v77
    v_and_b32 v77, 0xffff0000, v77
    v_pk_mul_f32 v[72:73], v[72:73], v[106:107] op_sel_hi:[1,0]
    v_pk_mul_f32 v[74:75], v[74:75], v[106:107] op_sel_hi:[1,0]
    v_pk_mul_f32 v[76:77], v[76:77], v[106:107] op_sel_hi:[1,0]
    v_cvt_pk_bf16_f32 v60, v72, v73
    v_cvt_pk_bf16_f32 v62, v76, v77
    v_cvt_pk_bf16_f32 v61, v74, v75
    v_cvt_pk_bf16_f32 v63, v74, v75
    v_permlane32_swap_b32 v60, v62
    s_nop 0
    v_permlane32_swap_b32 v61, v63
    v_perm_b32 v92, v60, v62, s49
    v_perm_b32 v93, v60, v62, s50
    v_lshlrev_b32 v78, 16, v79
    v_and_b32 v79, 0xffff0000, v79
    v_lshlrev_b32 v80, 16, v81
    v_and_b32 v81, 0xffff0000, v81
    v_lshlrev_b32 v82, 16, v83
    v_and_b32 v83, 0xffff0000, v83
    v_pk_mul_f32 v[78:79], v[78:79], v[106:107] op_sel_hi:[1,0]
    v_pk_mul_f32 v[80:81], v[80:81], v[106:107] op_sel_hi:[1,0]
    v_pk_mul_f32 v[82:83], v[82:83], v[106:107] op_sel_hi:[1,0]
    v_cvt_pk_bf16_f32 v64, v78, v79
    v_cvt_pk_bf16_f32 v66, v82, v83
    v_cvt_pk_bf16_f32 v65, v80, v81
    v_cvt_pk_bf16_f32 v67, v80, v81
    v_perm_b32 v94, v61, v63, v144
    ds_write_b128 v141, v[92:95] offset:0
    v_permlane32_swap_b32 v64, v66
    v_permlane32_swap_b32 v65, v67
    v_perm_b32 v96, v64, v66, s49
    v_perm_b32 v97, v64, v66, s50
    v_lshlrev_b32 v84, 16, v85
    v_and_b32 v85, 0xffff0000, v85
    v_lshlrev_b32 v86, 16, v87
    v_and_b32 v87, 0xffff0000, v87
    v_lshlrev_b32 v88, 16, v89
    v_and_b32 v89, 0xffff0000, v89
    v_pk_mul_f32 v[84:85], v[84:85], v[106:107] op_sel_hi:[1,0]
    v_pk_mul_f32 v[86:87], v[86:87], v[106:107] op_sel_hi:[1,0]
    v_pk_mul_f32 v[88:89], v[88:89], v[106:107] op_sel_hi:[1,0]
    v_cvt_pk_bf16_f32 v68, v84, v85
    v_cvt_pk_bf16_f32 v70, v88, v89
    v_cvt_pk_bf16_f32 v69, v86, v87
    v_cvt_pk_bf16_f32 v71, v86, v87
    v_perm_b32 v98, v65, v67, v144
    ds_write_b128 v141, v[96:99] offset:4608
    v_permlane32_swap_b32 v68, v70
    v_permlane32_swap_b32 v69, v71
    v_perm_b32 v100, v68, v70, s49
    v_perm_b32 v101, v68, v70, s50
    v_perm_b32 v102, v69, v71, v144
    ds_write_b128 v141, v[100:103] offset:9216
    s_mov_b64 exec, 0x1
    ds_write_b32 v146, v144
    s_mov_b64 exec, -1
LN1_U:
    s_movk_i32 s60, 4000
LN1_R:
    ds_read_b128 v[104:107], v145
    ds_read_b128 v[72:75], v142 offset:0
    ds_read_b128 v[76:79], v142 offset:1152
    ds_read_b128 v[80:83], v142 offset:2304
    s_sub_u32 s60, s60, 1
    s_waitcnt lgkmcnt(3)
    v_min3_u32 v104, v104, v105, v106
    v_min_u32 v104, v104, v107
    v_cmp_eq_u32 vcc, 0, v104
    s_cmp_gt_i32 s60, 0
    s_cselect_b64 s[52:53], vcc, 0
    s_cmp_lg_u64 s[52:53], 0
    s_waitcnt lgkmcnt(0)
    s_cbranch_scc1 LN1_R
    buffer_store_dwordx4 v[72:75], v143, s[40:43], s46 offen sc1
    buffer_store_dwordx4 v[76:79], v143, s[40:43], s47 offen sc1
    buffer_store_dwordx4 v[80:83], v143, s[40:43], s48 offen sc1
    s_cmp_ge_u32 s2, 192
    s_cbranch_scc1 FFN_DMA
    s_branch C_KS
P_B:
    s_cmp_ge_u32 s2, 192
    s_cbranch_scc1 FFN_DMA0
P_B2:
    s_lshr_b32 s65, s38, 2
    s_bitcmp1_b32 s2, 0
    s_addc_u32 s51, s65, 0
    s_cmp_eq_u32 s51, 3
    s_cselect_b32 s51, 0, s51
    s_lshl_b32 s52, s51, 8
    s_add_u32 s52, s52, 138048
    v_and_b32 v114, 0x7f, v0
    v_lshl_add_u32 v114, v114, 1, s52
    s_and_b32 s52, s2, 1
    s_add_u32 s52, s52, s51
    s_lshl_b32 s52, s52, 1
    s_add_u32 s52, s52, 142656
    v_mov_b32 v115, s52
    v_mov_b32 v119, 161536
    v_mov_b32 v29, 0
    v_mov_b32 v30, 0
    v_mov_b32 v31, 0
    v_mov_b32 v32, 0
    v_mov_b32 v33, 0
    v_mov_b32 v34, 0
    v_mov_b32 v35, 0
    v_mov_b32 v160, 0
    v_mov_b32 v161, 0
    v_mov_b32 v162, 0
    v_mov_b32 v163, 0
    v_mov_b32 v164, 0
    v_lshlrev_b32 v16, 4, v0
    v_add_u32 v17, 101184, v16
    ds_write_b128 v17, v[160:163] offset:0
    ds_write_b128 v17, v[160:163] offset:12288
    ds_write_b128 v17, v[160:163] offset:24576
    s_mul_i32 s59, s65, 16320
    s_mul_i32 s67, s65, 17408
    s_add_u32 s71, s67, 48960
    s_and_b32 s66, s38, 1
    s_lshl_b32 s66, s66, 8
    s_add_u32 s70, s66, s67
    s_add_u32 s70, s70, 16192
    s_add_u32 s66, s66, s59
    s_mov_b32 m0, s66
    s_mul_i32 s64, s65, 5888
    s_add_u32 s64, s64, 101184
    s_and_b32 s69, s38, 3
    v_and_b32 v5, 15, v0
    v_bfe_u32 v6, v0, 4, 2
    v_and_b32 v17, 48, v0
    v_mul_u32_u24 v110, 544, v5
    s_mov_b32 s52, 0
    s_movk_i32 s53, 2176
    s_movk_i32 s54, 4896
    s_cmp_eq_u32 s69, 1
    s_cselect_b32 s52, 9792, s52
    s_cselect_b32 s53, 1088, s53
    s_cselect_b32 s54, 3264, s54
    s_cmp_eq_u32 s69, 3
    s_cselect_b32 s52, 544, s52
    s_add_u32 s52, s52, s59
    s_cmp_eq_u32 s69, 2
    s_cselect_b32 s52, s71, s52
    s_cselect_b32 s54, 4352, s54
    s_add_u32 s67, s71, 8704
    v_and_b32 v111, 3, v0
    v_mul_u32_u24 v111, 544, v111
    v_bfe_u32 v18, v0, 2, 1
    v_bfe_u32 v19, v0, 3, 1
    v_xor_b32 v18, v18, v19
    v_mad_u32_u24 v111, v19, s53, v111
    v_mad_u32_u24 v111, v18, s54, v111
    v_add3_u32 v111, v111, v17, s52
    v_add3_u32 v110, v110, v17, s67
    s_barrier
    v_lshl_add_u32 v18, v5, 1, v6
    s_sub_u32 s52, s69, 11
    v_add_u32 v18, s52, v18
    v_add_u32 v19, 1, v18
    v_lshl_add_u32 v20, v6, 1, 2
    v_cmp_le_u32 s[52:53], v18, v20
    v_cmp_le_u32 s[54:55], v19, v20
    v_mov_b32 v18, 0x3f80
    v_cndmask_b32 v112, 0, v18, s[52:53]
    v_cndmask_b32 v19, 0, 1.0, s[54:55]
    v_or_b32 v112, v112, v19
    s_mul_i32 s52, s38, 1600
    s_add_u32 s52, s52, 120016
    v_lshl_add_u32 v113, v1, 2, s52
    s_mul_i32 s67, s65, 6400
    s_add_u32 s67, s67, 118848
    s_sub_u32 s63, s69, s65
    s_cselect_b32 s52, 3, 0
    s_add_u32 s63, s63, s52
    s_min_u32 s52, s63, 1
    s_add_u32 s63, s63, s52
    s_cmp_eq_u32 s69, 3
    s_cselect_b32 s63, 1, s63
    v_add_u32 v7, 1, v5
    v_and_b32 v8, 3, v7
    v_mul_u32_u24 v8, 1598, v8
    v_lshl_add_u32 v7, v7, 1, v8
    v_add3_u32 v7, v7, v17, s67
    v_add_u32 v18, s64, v17
    v_lshl_add_u32 v9, v5, 3, v18
    v_and_b32 v10, 1, v5
    v_mul_u32_u24 v10, 380, v10
    v_lshl_add_u32 v10, v5, 2, v10
    v_add_u32 v10, v18, v10
    v_lshlrev_b32 v8, 5, v5
    v_sub_u32 v8, v18, v8
    v_lshrrev_b32 v11, 2, v5
    v_lshl_add_u32 v2, v5, 2, v6
    v_add_u32 v15, v2, v11
    v_lshl_add_u32 v4, v15, 3, s59
    s_lshl_b32 s52, s65, 4
    s_add_u32 s52, s52, 161280
    v_mov_b32 v166, s52
    s_lshl_b32 s48, s2, 13
    s_add_u32 s48, s48, 258048
    s_mov_b32 s50, s2
    s_lshl_b32 s49, s2, 11
    s_add_u32 s49, s49, 1440768
    s_waitcnt lgkmcnt(0)
    s_mov_b32 s40, s36
    s_mov_b32 s41, s37
    s_bitcmp1_b32 s38, 0
    s_cselect_b32 s0, s26, s28
    s_cselect_b32 s1, s27, s29
    s_lshr_b32 s52, s2, 3
    s_mul_i32 s52, s52, 1728
    s_and_b32 s53, s2, 7
    s_lshl3_add_u32 s52, s53, s52
    s_add_u32 s52, s52, 3
    v_mul_u32_u24 v117, 0x48, v1
    v_add_lshl_u32 v117, v117, s52, 7
    s_cmp_lt_u32 s38, 10
    s_cbranch_scc1 C_NPB
    s_mov_b32 s52, m0
    s_mov_b32 m0, 163328
    s_mov_b64 exec, 0xffffff
    global_load_lds_dword v117, s[0:1]
    s_mov_b64 exec, -1
    s_mov_b32 m0, s52
C_NPB:
    s_lshr_b32 s52, s2, 3
    s_mul_i32 s52, s52, 3
    s_add_u32 s52, s52, s69
    s_mul_i32 s52, s52, 576
    s_and_b32 s53, s2, 7
    s_lshl3_add_u32 s52, s53, s52
    v_lshrrev_b32 v21, 3, v1
    v_and_b32 v22, 7, v1
    v_mul_u32_u24 v22, 0x48, v22
    v_add3_u32 v21, v21, v22, s52
    v_lshlrev_b32 v118, 7, v21
C_KS:
    s_movk_i32 s60, 4000
C_KP:
    ds_read_b32 v20, v119
    ds_read_u16_d16_hi v29, v115
    ds_read_u16_d16_hi v30, v114 offset:0
    ds_read_u16_d16_hi v31, v114 offset:768
    ds_read_u16_d16_hi v32, v114 offset:1536
    ds_read_u16_d16_hi v33, v114 offset:2304
    ds_read_u16_d16_hi v34, v114 offset:3072
    ds_read_u16_d16_hi v35, v114 offset:3840
    s_sub_u32 s60, s60, 1
    s_cmp_gt_i32 s60, 0
    s_waitcnt lgkmcnt(7)
    v_readfirstlane_b32 s52, v20
    s_nop 0
    s_cselect_b32 s52, s52, 1
    s_cmp_eq_u32 s52, 0
    s_cbranch_scc1 C_KP
    ds_read_u16_d16_hi v164, v115 offset:16
    s_setprio 2
    s_cmp_lt_u32 s38, 4
    s_cbranch_scc1 PG1
    s_setprio 3
PG1:
    s_waitcnt lgkmcnt(7)
    v_mul_f32 v20, 0x3fb8aa3b, v29
    v_mov_b32 v21, 0x3fb8aa3b
    v_fma_f32 v21, v29, v21, -v20
    v_fmac_f32 v21, 0x32a57060, v29
    v_exp_f32 v20, v20
    v_mul_f32 v21, 0x3f317218, v21
    v_fma_f32 v20, v20, v21, v20
    v_cvt_pk_bf16_f32 v20, v20, v20
    v_lshlrev_b32 v20, 16, v20
    s_waitcnt lgkmcnt(0)
    v_mul_f32 v21, v30, v20
    v_mul_f32 v36, v31, v20
    v_mul_f32 v32, v32, v20
    v_mul_f32 v33, v33, v20
    v_mul_f32 v21, 0x3fb8aa3b, v21
    v_mul_f32 v22, 0x3e22f983, v36
    v_mov_b32 v23, 0x3e22f983
    v_fma_f32 v23, v36, v23, -v22
    v_fmac_f32 v23, 0x31dc9c88, v36
    v_pk_mul_f32 v[24:25], v[34:35], v[32:33] op_sel:[0,0] op_sel_hi:[0,1]
    v_pk_fma_f32 v[24:25], v[34:35], v[32:33], v[24:25] op_sel:[1,1,0] op_sel_hi:[1,0,1] neg_lo:[1,0,0]
    s_bitcmp1_b32 s38, 1
    s_cbranch_scc1 C_ROLE1
    v_mul_f32 v36, 0x43000000, v21
    v_mul_f32 v37, 0x43000000, v22
    v_mul_f32 v38, 0x41000000, v21
    v_mul_f32 v39, 0x41000000, v22
    v_exp_f32 v36, v36
    v_fract_f32 v37, v37
    v_exp_f32 v38, v38
    v_fract_f32 v39, v39
    v_fmac_f32 v37, 0x43000000, v23
    v_fmac_f32 v39, 0x41000000, v23
    v_cos_f32 v26, v37
    v_sin_f32 v27, v37
    v_cos_f32 v28, v39
    v_sin_f32 v29, v39
    v_mul_f32 v26, v26, v36
    v_mul_f32 v27, v27, v36
    v_mul_f32 v28, v28, v38
    v_mul_f32 v29, v29, v38
    v_mov_b32 v44, 1.0
    v_mov_b32 v45, 0
    v_pk_mul_f32 v[56:57], v[24:25], v[28:29] op_sel:[0,0] op_sel_hi:[0,1]
    v_pk_mul_f32 v[50:51], v[28:29], v[28:29] op_sel:[0,0] op_sel_hi:[0,1]
    v_pk_fma_f32 v[56:57], v[24:25], v[28:29], v[56:57] op_sel:[1,1,0] op_sel_hi:[1,0,1] neg_lo:[1,0,0]
    v_pk_fma_f32 v[50:51], v[28:29], v[28:29], v[50:51] op_sel:[1,1,0] op_sel_hi:[1,0,1] neg_lo:[1,0,0]
    v_pk_mul_f32 v[58:59], v[56:57], v[26:27] op_sel:[0,0] op_sel_hi:[0,1]
    v_pk_fma_f32 v[58:59], v[56:57], v[26:27], v[58:59] op_sel:[1,1,0] op_sel_hi:[1,0,1] neg_lo:[1,0,0]
    v_cvt_pk_bf16_f32 v40, v56, v57
    ds_write_addtid_b32 v40 offset:4352
    v_pk_mul_f32 v[56:57], v[58:59], v[26:27] op_sel:[0,0] op_sel_hi:[0,1]
    v_pk_mul_f32 v[54:55], v[50:51], v[28:29] op_sel:[0,0] op_sel_hi:[0,1]
    v_pk_fma_f32 v[56:57], v[58:59], v[26:27], v[56:57] op_sel:[1,1,0] op_sel_hi:[1,0,1] neg_lo:[1,0,0]
    v_pk_fma_f32 v[54:55], v[50:51], v[28:29], v[54:55] op_sel:[1,1,0] op_sel_hi:[1,0,1] neg_lo:[1,0,0]
    v_cvt_pk_bf16_f32 v41, v58, v59
    ds_write_addtid_b32 v41 offset:9248
    v_cvt_pk_bf16_f32 v42, v44, -v45
    s_mov_b32 m0, s70
    s_nop 0
    ds_write_addtid_b32 v42 offset:41472
    v_cvt_pk_bf16_f32 v43, v28, -v29
    ds_write_addtid_b32 v43 offset:42016
    v_cvt_pk_bf16_f32 v40, v50, -v51
    ds_write_addtid_b32 v40 offset:42560
    v_pk_mul_f32 v[58:59], v[56:57], v[26:27] op_sel:[0,0] op_sel_hi:[0,1]
    v_pk_mul_f32 v[50:51], v[54:55], v[28:29] op_sel:[0,0] op_sel_hi:[0,1]
    v_pk_fma_f32 v[58:59], v[56:57], v[26:27], v[58:59] op_sel:[1,1,0] op_sel_hi:[1,0,1] neg_lo:[1,0,0]
    v_pk_fma_f32 v[50:51], v[54:55], v[28:29], v[50:51] op_sel:[1,1,0] op_sel_hi:[1,0,1] neg_lo:[1,0,0]
    v_cvt_pk_bf16_f32 v41, v56, v57
    s_mov_b32 m0, s66
    s_nop 0
    ds_write_addtid_b32 v41 offset:11968
    v_cvt_pk_bf16_f32 v42, v54, -v55
    s_mov_b32 m0, s70
    s_nop 0
    ds_write_addtid_b32 v42 offset:43104
    v_pk_mul_f32 v[56:57], v[58:59], v[26:27] op_sel:[0,0] op_sel_hi:[0,1]
    v_pk_mul_f32 v[54:55], v[50:51], v[28:29] op_sel:[0,0] op_sel_hi:[0,1]
    v_pk_fma_f32 v[56:57], v[58:59], v[26:27], v[56:57] op_sel:[1,1,0] op_sel_hi:[1,0,1] neg_lo:[1,0,0]
    v_pk_fma_f32 v[54:55], v[50:51], v[28:29], v[54:55] op_sel:[1,1,0] op_sel_hi:[1,0,1] neg_lo:[1,0,0]
    v_cvt_pk_bf16_f32 v43, v58, v59
    s_mov_b32 m0, s66
    s_nop 0
    ds_write_addtid_b32 v43 offset:15232
    v_cvt_pk_bf16_f32 v40, v50, -v51
    s_mov_b32 m0, s70
    s_nop 0
    ds_write_addtid_b32 v40 offset:43648
    v_pk_mul_f32 v[58:59], v[56:57], v[26:27] op_sel:[0,0] op_sel_hi:[0,1]
    v_pk_mul_f32 v[50:51], v[54:55], v[28:29] op_sel:[0,0] op_sel_hi:[0,1]
    v_pk_fma_f32 v[58:59], v[56:57], v[26:27], v[58:59] op_sel:[1,1,0] op_sel_hi:[1,0,1] neg_lo:[1,0,0]
    v_pk_fma_f32 v[50:51], v[54:55], v[28:29], v[50:51] op_sel:[1,1,0] op_sel_hi:[1,0,1] neg_lo:[1,0,0]
    v_cvt_pk_bf16_f32 v41, v56, v57
    ds_write_addtid_b32 v41 offset:33312
    v_cvt_pk_bf16_f32 v42, v54, -v55
    ds_write_addtid_b32 v42 offset:44192
    v_pk_mul_f32 v[56:57], v[58:59], v[26:27] op_sel:[0,0] op_sel_hi:[0,1]
    v_pk_mul_f32 v[54:55], v[50:51], v[28:29] op_sel:[0,0] op_sel_hi:[0,1]
    v_pk_fma_f32 v[56:57], v[58:59], v[26:27], v[56:57] op_sel:[1,1,0] op_sel_hi:[1,0,1] neg_lo:[1,0,0]
    v_pk_fma_f32 v[54:55], v[50:51], v[28:29], v[54:55] op_sel:[1,1,0] op_sel_hi:[1,0,1] neg_lo:[1,0,0]
    v_cvt_pk_bf16_f32 v43, v58, v59
    ds_write_addtid_b32 v43 offset:34400
    v_cvt_pk_bf16_f32 v40, v50, -v51
    ds_write_addtid_b32 v40 offset:44736
    v_pk_mul_f32 v[58:59], v[56:57], v[26:27] op_sel:[0,0] op_sel_hi:[0,1]
    v_pk_mul_f32 v[50:51], v[54:55], v[28:29] op_sel:[0,0] op_sel_hi:[0,1]
    v_pk_fma_f32 v[58:59], v[56:57], v[26:27], v[58:59] op_sel:[1,1,0] op_sel_hi:[1,0,1] neg_lo:[1,0,0]
    v_pk_fma_f32 v[50:51], v[54:55], v[28:29], v[50:51] op_sel:[1,1,0] op_sel_hi:[1,0,1] neg_lo:[1,0,0]
    v_cvt_pk_bf16_f32 v41, v56, v57
    ds_write_addtid_b32 v41 offset:37664
    v_cvt_pk_bf16_f32 v42, v54, -v55
    ds_write_addtid_b32 v42 offset:45280
    v_pk_mul_f32 v[56:57], v[58:59], v[26:27] op_sel:[0,0] op_sel_hi:[0,1]
    v_pk_mul_f32 v[54:55], v[50:51], v[28:29] op_sel:[0,0] op_sel_hi:[0,1]
    v_pk_fma_f32 v[56:57], v[58:59], v[26:27], v[56:57] op_sel:[1,1,0] op_sel_hi:[1,0,1] neg_lo:[1,0,0]
    v_pk_fma_f32 v[54:55], v[50:51], v[28:29], v[54:55] op_sel:[1,1,0] op_sel_hi:[1,0,1] neg_lo:[1,0,0]
    v_cvt_pk_bf16_f32 v43, v58, v59
    ds_write_addtid_b32 v43 offset:38752
    v_cvt_pk_bf16_f32 v40, v50, -v51
    ds_write_addtid_b32 v40 offset:45824
    v_pk_mul_f32 v[58:59], v[56:57], v[26:27] op_sel:[0,0] op_sel_hi:[0,1]
    v_pk_mul_f32 v[50:51], v[54:55], v[28:29] op_sel:[0,0] op_sel_hi:[0,1]
    v_pk_fma_f32 v[58:59], v[56:57], v[26:27], v[58:59] op_sel:[1,1,0] op_sel_hi:[1,0,1] neg_lo:[1,0,0]
    v_pk_fma_f32 v[50:51], v[54:55], v[28:29], v[50:51] op_sel:[1,1,0] op_sel_hi:[1,0,1] neg_lo:[1,0,0]
    v_cvt_pk_bf16_f32 v41, v56, v57
    ds_write_addtid_b32 v41 offset:39296
    v_cvt_pk_bf16_f32 v42, v54, -v55
    ds_write_addtid_b32 v42 offset:46368
    v_pk_mul_f32 v[56:57], v[58:59], v[26:27] op_sel:[0,0] op_sel_hi:[0,1]
    v_pk_mul_f32 v[54:55], v[50:51], v[28:29] op_sel:[0,0] op_sel_hi:[0,1]
    v_pk_fma_f32 v[56:57], v[58:59], v[26:27], v[56:57] op_sel:[1,1,0] op_sel_hi:[1,0,1] neg_lo:[1,0,0]
    v_pk_fma_f32 v[54:55], v[50:51], v[28:29], v[54:55] op_sel:[1,1,0] op_sel_hi:[1,0,1] neg_lo:[1,0,0]
    v_cvt_pk_bf16_f32 v43, v58, v59
    ds_write_addtid_b32 v43 offset:39840
    v_cvt_pk_bf16_f32 v40, v50, -v51
    ds_write_addtid_b32 v40 offset:46912
    v_pk_mul_f32 v[58:59], v[56:57], v[26:27] op_sel:[0,0] op_sel_hi:[0,1]
    v_pk_mul_f32 v[50:51], v[54:55], v[28:29] op_sel:[0,0] op_sel_hi:[0,1]
    v_pk_fma_f32 v[58:59], v[56:57], v[26:27], v[58:59] op_sel:[1,1,0] op_sel_hi:[1,0,1] neg_lo:[1,0,0]
    v_pk_fma_f32 v[50:51], v[54:55], v[28:29], v[50:51] op_sel:[1,1,0] op_sel_hi:[1,0,1] neg_lo:[1,0,0]
    v_cvt_pk_bf16_f32 v41, v56, v57
    ds_write_addtid_b32 v41 offset:40384
    v_cvt_pk_bf16_f32 v42, v54, -v55
    ds_write_addtid_b32 v42 offset:47456
    v_pk_mul_f32 v[56:57], v[58:59], v[26:27] op_sel:[0,0] op_sel_hi:[0,1]
    v_pk_mul_f32 v[54:55], v[50:51], v[28:29] op_sel:[0,0] op_sel_hi:[0,1]
    v_pk_fma_f32 v[56:57], v[58:59], v[26:27], v[56:57] op_sel:[1,1,0] op_sel_hi:[1,0,1] neg_lo:[1,0,0]
    v_pk_fma_f32 v[54:55], v[50:51], v[28:29], v[54:55] op_sel:[1,1,0] op_sel_hi:[1,0,1] neg_lo:[1,0,0]
    v_cvt_pk_bf16_f32 v43, v58, v59
    ds_write_addtid_b32 v43 offset:40928
    v_cvt_pk_bf16_f32 v40, v50, -v51
    ds_write_addtid_b32 v40 offset:48000
    v_pk_mul_f32 v[58:59], v[56:57], v[26:27] op_sel:[0,0] op_sel_hi:[0,1]
    v_pk_mul_f32 v[50:51], v[54:55], v[28:29] op_sel:[0,0] op_sel_hi:[0,1]
    v_pk_fma_f32 v[58:59], v[56:57], v[26:27], v[58:59] op_sel:[1,1,0] op_sel_hi:[1,0,1] neg_lo:[1,0,0]
    v_pk_fma_f32 v[50:51], v[54:55], v[28:29], v[50:51] op_sel:[1,1,0] op_sel_hi:[1,0,1] neg_lo:[1,0,0]
    v_cvt_pk_bf16_f32 v41, v56, v57
    ds_write_addtid_b32 v41 offset:34944
    v_cvt_pk_bf16_f32 v42, v54, -v55
    ds_write_addtid_b32 v42 offset:48544
    v_pk_mul_f32 v[56:57], v[58:59], v[26:27] op_sel:[0,0] op_sel_hi:[0,1]
    v_pk_mul_f32 v[54:55], v[50:51], v[28:29] op_sel:[0,0] op_sel_hi:[0,1]
    v_pk_fma_f32 v[56:57], v[58:59], v[26:27], v[56:57] op_sel:[1,1,0] op_sel_hi:[1,0,1] neg_lo:[1,0,0]
    v_pk_fma_f32 v[54:55], v[50:51], v[28:29], v[54:55] op_sel:[1,1,0] op_sel_hi:[1,0,1] neg_lo:[1,0,0]
    v_cvt_pk_bf16_f32 v43, v58, v59
    ds_write_addtid_b32 v43 offset:35488
    v_cvt_pk_bf16_f32 v40, v50, -v51
    ds_write_addtid_b32 v40 offset:49088
    v_pk_mul_f32 v[58:59], v[56:57], v[26:27] op_sel:[0,0] op_sel_hi:[0,1]
    v_pk_fma_f32 v[58:59], v[56:57], v[26:27], v[58:59] op_sel:[1,1,0] op_sel_hi:[1,0,1] neg_lo:[1,0,0]
    v_cvt_pk_bf16_f32 v41, v56, v57
    ds_write_addtid_b32 v41 offset:36032
    v_cvt_pk_bf16_f32 v42, v54, -v55
    ds_write_addtid_b32 v42 offset:49632
    v_cvt_pk_bf16_f32 v43, v58, v59
    ds_write_addtid_b32 v43 offset:36576
    s_branch C_MFMA
C_ROLE1:
    v_mul_f32 v36, 0x43000000, v21
    v_mul_f32 v37, 0x43000000, v22
    v_mul_f32 v38, 0x3f800000, v21
    v_mul_f32 v39, 0x3f800000, v22
    v_exp_f32 v36, v36
    v_fract_f32 v37, v37
    v_exp_f32 v38, v38
    v_fract_f32 v39, v39
    v_fmac_f32 v37, 0x43000000, v23
    v_fmac_f32 v39, 0x3f800000, v23
    v_cos_f32 v26, v37
    v_sin_f32 v27, v37
    v_cos_f32 v28, v39
    v_sin_f32 v29, v39
    v_mul_f32 v26, v26, v36
    v_mul_f32 v27, v27, v36
    v_mul_f32 v28, v28, v38
    v_mul_f32 v29, v29, v38
    v_pk_mul_f32 v[44:45], v[24:25], v[26:27] op_sel:[0,0] op_sel_hi:[0,1]
    v_pk_mul_f32 v[46:47], v[28:29], v[28:29] op_sel:[0,0] op_sel_hi:[0,1]
    v_pk_mul_f32 v[48:49], v[24:25], v[28:29] op_sel:[0,0] op_sel_hi:[0,1]
    v_pk_fma_f32 v[44:45], v[24:25], v[26:27], v[44:45] op_sel:[1,1,0] op_sel_hi:[1,0,1] neg_lo:[1,0,0]
    v_pk_fma_f32 v[46:47], v[28:29], v[28:29], v[46:47] op_sel:[1,1,0] op_sel_hi:[1,0,1] neg_lo:[1,0,0]
    v_pk_fma_f32 v[48:49], v[24:25], v[28:29], v[48:49] op_sel:[1,1,0] op_sel_hi:[1,0,1] neg_lo:[1,0,0]
    v_cvt_pk_bf16_f32 v40, v24, v25
    ds_write_addtid_b32 v40 offset:0
    v_pk_mul_f32 v[50:51], v[44:45], v[26:27] op_sel:[0,0] op_sel_hi:[0,1]
    v_pk_mul_f32 v[52:53], v[44:45], v[28:29] op_sel:[0,0] op_sel_hi:[0,1]
    v_pk_mul_f32 v[54:55], v[48:49], v[28:29] op_sel:[0,0] op_sel_hi:[0,1]
    v_pk_mul_f32 v[62:63], v[46:47], v[46:47] op_sel:[0,0] op_sel_hi:[0,1]
    v_pk_fma_f32 v[50:51], v[44:45], v[26:27], v[50:51] op_sel:[1,1,0] op_sel_hi:[1,0,1] neg_lo:[1,0,0]
    v_pk_fma_f32 v[52:53], v[44:45], v[28:29], v[52:53] op_sel:[1,1,0] op_sel_hi:[1,0,1] neg_lo:[1,0,0]
    v_pk_fma_f32 v[54:55], v[48:49], v[28:29], v[54:55] op_sel:[1,1,0] op_sel_hi:[1,0,1] neg_lo:[1,0,0]
    v_pk_fma_f32 v[62:63], v[46:47], v[46:47], v[62:63] op_sel:[1,1,0] op_sel_hi:[1,0,1] neg_lo:[1,0,0]
    v_cvt_pk_bf16_f32 v41, v44, v45
    ds_write_addtid_b32 v41 offset:4896
    v_cvt_pk_bf16_f32 v42, v48, v49
    ds_write_addtid_b32 v42 offset:544
    v_pk_mul_f32 v[56:57], v[50:51], v[26:27] op_sel:[0,0] op_sel_hi:[0,1]
    v_pk_mul_f32 v[58:59], v[50:51], v[46:47] op_sel:[0,0] op_sel_hi:[0,1]
    v_pk_mul_f32 v[44:45], v[52:53], v[28:29] op_sel:[0,0] op_sel_hi:[0,1]
    v_pk_mul_f32 v[48:49], v[54:55], v[28:29] op_sel:[0,0] op_sel_hi:[0,1]
    v_pk_fma_f32 v[56:57], v[50:51], v[26:27], v[56:57] op_sel:[1,1,0] op_sel_hi:[1,0,1] neg_lo:[1,0,0]
    v_pk_fma_f32 v[58:59], v[50:51], v[46:47], v[58:59] op_sel:[1,1,0] op_sel_hi:[1,0,1] neg_lo:[1,0,0]
    v_pk_fma_f32 v[44:45], v[52:53], v[28:29], v[44:45] op_sel:[1,1,0] op_sel_hi:[1,0,1] neg_lo:[1,0,0]
    v_pk_fma_f32 v[48:49], v[54:55], v[28:29], v[48:49] op_sel:[1,1,0] op_sel_hi:[1,0,1] neg_lo:[1,0,0]
    v_cvt_pk_bf16_f32 v43, v50, v51
    ds_write_addtid_b32 v43 offset:9792
    v_cvt_pk_bf16_f32 v40, v52, v53
    ds_write_addtid_b32 v40 offset:5440
    v_cvt_pk_bf16_f32 v41, v54, v55
    ds_write_addtid_b32 v41 offset:1088
    v_pk_mul_f32 v[54:55], v[48:49], v[28:29] op_sel:[0,0] op_sel_hi:[0,1]
    v_pk_mul_f32 v[52:53], v[44:45], v[28:29] op_sel:[0,0] op_sel_hi:[0,1]
    v_pk_mul_f32 v[50:51], v[58:59], v[46:47] op_sel:[0,0] op_sel_hi:[0,1]
    v_pk_mul_f32 v[24:25], v[56:57], v[46:47] op_sel:[0,0] op_sel_hi:[0,1]
    v_pk_fma_f32 v[54:55], v[48:49], v[28:29], v[54:55] op_sel:[1,1,0] op_sel_hi:[1,0,1] neg_lo:[1,0,0]
    v_pk_fma_f32 v[52:53], v[44:45], v[28:29], v[52:53] op_sel:[1,1,0] op_sel_hi:[1,0,1] neg_lo:[1,0,0]
    v_pk_fma_f32 v[50:51], v[58:59], v[46:47], v[50:51] op_sel:[1,1,0] op_sel_hi:[1,0,1] neg_lo:[1,0,0]
    v_pk_fma_f32 v[24:25], v[56:57], v[46:47], v[24:25] op_sel:[1,1,0] op_sel_hi:[1,0,1] neg_lo:[1,0,0]
    v_cvt_pk_bf16_f32 v42, v48, v49
    ds_write_addtid_b32 v42 offset:1632
    v_cvt_pk_bf16_f32 v43, v44, v45
    ds_write_addtid_b32 v43 offset:5984
    v_cvt_pk_bf16_f32 v40, v58, v59
    ds_write_addtid_b32 v40 offset:10336
    v_pk_mul_f32 v[48:49], v[54:55], v[28:29] op_sel:[0,0] op_sel_hi:[0,1]
    v_pk_mul_f32 v[44:45], v[52:53], v[28:29] op_sel:[0,0] op_sel_hi:[0,1]
    v_pk_mul_f32 v[58:59], v[50:51], v[46:47] op_sel:[0,0] op_sel_hi:[0,1]
    v_pk_mul_f32 v[56:57], v[24:25], v[46:47] op_sel:[0,0] op_sel_hi:[0,1]
    v_pk_fma_f32 v[48:49], v[54:55], v[28:29], v[48:49] op_sel:[1,1,0] op_sel_hi:[1,0,1] neg_lo:[1,0,0]
    v_pk_fma_f32 v[44:45], v[52:53], v[28:29], v[44:45] op_sel:[1,1,0] op_sel_hi:[1,0,1] neg_lo:[1,0,0]
    v_pk_fma_f32 v[58:59], v[50:51], v[46:47], v[58:59] op_sel:[1,1,0] op_sel_hi:[1,0,1] neg_lo:[1,0,0]
    v_pk_fma_f32 v[56:57], v[24:25], v[46:47], v[56:57] op_sel:[1,1,0] op_sel_hi:[1,0,1] neg_lo:[1,0,0]
    v_cvt_pk_bf16_f32 v41, v54, v55
    ds_write_addtid_b32 v41 offset:2176
    v_cvt_pk_bf16_f32 v42, v52, v53
    ds_write_addtid_b32 v42 offset:6528
    v_cvt_pk_bf16_f32 v43, v50, v51
    ds_write_addtid_b32 v43 offset:10880
    v_cvt_pk_bf16_f32 v40, v24, v25
    ds_write_addtid_b32 v40 offset:13600
    v_pk_mul_f32 v[54:55], v[48:49], v[28:29] op_sel:[0,0] op_sel_hi:[0,1]
    v_pk_mul_f32 v[52:53], v[44:45], v[28:29] op_sel:[0,0] op_sel_hi:[0,1]
    v_pk_mul_f32 v[50:51], v[58:59], v[62:63] op_sel:[0,0] op_sel_hi:[0,1]
    v_pk_mul_f32 v[24:25], v[56:57], v[46:47] op_sel:[0,0] op_sel_hi:[0,1]
    v_pk_mul_f32 v[64:65], v[56:57], v[26:27] op_sel:[0,0] op_sel_hi:[0,1]
    v_pk_fma_f32 v[54:55], v[48:49], v[28:29], v[54:55] op_sel:[1,1,0] op_sel_hi:[1,0,1] neg_lo:[1,0,0]
    v_pk_fma_f32 v[52:53], v[44:45], v[28:29], v[52:53] op_sel:[1,1,0] op_sel_hi:[1,0,1] neg_lo:[1,0,0]
    v_pk_fma_f32 v[50:51], v[58:59], v[62:63], v[50:51] op_sel:[1,1,0] op_sel_hi:[1,0,1] neg_lo:[1,0,0]
    v_pk_fma_f32 v[24:25], v[56:57], v[46:47], v[24:25] op_sel:[1,1,0] op_sel_hi:[1,0,1] neg_lo:[1,0,0]
    v_pk_fma_f32 v[64:65], v[56:57], v[26:27], v[64:65] op_sel:[1,1,0] op_sel_hi:[1,0,1] neg_lo:[1,0,0]
    v_cvt_pk_bf16_f32 v41, v48, v49
    ds_write_addtid_b32 v41 offset:2720
    v_cvt_pk_bf16_f32 v42, v44, v45
    ds_write_addtid_b32 v42 offset:7072
    v_cvt_pk_bf16_f32 v43, v58, v59
    ds_write_addtid_b32 v43 offset:11424
    v_cvt_pk_bf16_f32 v40, v56, v57
    ds_write_addtid_b32 v40 offset:14144
    v_pk_mul_f32 v[48:49], v[54:55], v[28:29] op_sel:[0,0] op_sel_hi:[0,1]
    v_pk_mul_f32 v[44:45], v[52:53], v[28:29] op_sel:[0,0] op_sel_hi:[0,1]
    v_pk_mul_f32 v[56:57], v[24:25], v[62:63] op_sel:[0,0] op_sel_hi:[0,1]
    v_pk_mul_f32 v[66:67], v[64:65], v[26:27] op_sel:[0,0] op_sel_hi:[0,1]
    v_pk_fma_f32 v[48:49], v[54:55], v[28:29], v[48:49] op_sel:[1,1,0] op_sel_hi:[1,0,1] neg_lo:[1,0,0]
    v_pk_fma_f32 v[44:45], v[52:53], v[28:29], v[44:45] op_sel:[1,1,0] op_sel_hi:[1,0,1] neg_lo:[1,0,0]
    v_pk_fma_f32 v[56:57], v[24:25], v[62:63], v[56:57] op_sel:[1,1,0] op_sel_hi:[1,0,1] neg_lo:[1,0,0]
    v_pk_fma_f32 v[66:67], v[64:65], v[26:27], v[66:67] op_sel:[1,1,0] op_sel_hi:[1,0,1] neg_lo:[1,0,0]
    v_cvt_pk_bf16_f32 v41, v54, v55
    ds_write_addtid_b32 v41 offset:3264
    v_cvt_pk_bf16_f32 v42, v52, v53
    ds_write_addtid_b32 v42 offset:7616
    v_cvt_pk_bf16_f32 v43, v50, v51
    ds_write_addtid_b32 v43 offset:12512
    v_cvt_pk_bf16_f32 v40, v24, v25
    ds_write_addtid_b32 v40 offset:14688
    v_cvt_pk_bf16_f32 v41, v64, v65
    s_mov_b32 m0, s70
    s_nop 0
    ds_write_addtid_b32 v41 offset:32768
    v_pk_mul_f32 v[52:53], v[44:45], v[28:29] op_sel:[0,0] op_sel_hi:[0,1]
    v_pk_mul_f32 v[64:65], v[66:67], v[26:27] op_sel:[0,0] op_sel_hi:[0,1]
    v_pk_fma_f32 v[52:53], v[44:45], v[28:29], v[52:53] op_sel:[1,1,0] op_sel_hi:[1,0,1] neg_lo:[1,0,0]
    v_pk_fma_f32 v[64:65], v[66:67], v[26:27], v[64:65] op_sel:[1,1,0] op_sel_hi:[1,0,1] neg_lo:[1,0,0]
    v_cvt_pk_bf16_f32 v42, v48, v49
    s_mov_b32 m0, s66
    s_nop 0
    ds_write_addtid_b32 v42 offset:3808
    v_cvt_pk_bf16_f32 v43, v44, v45
    ds_write_addtid_b32 v43 offset:8160
    v_cvt_pk_bf16_f32 v40, v56, v57
    ds_write_addtid_b32 v40 offset:15776
    v_cvt_pk_bf16_f32 v41, v66, v67
    s_mov_b32 m0, s70
    s_nop 0
    ds_write_addtid_b32 v41 offset:33856
    v_pk_mul_f32 v[66:67], v[64:65], v[26:27] op_sel:[0,0] op_sel_hi:[0,1]
    v_pk_fma_f32 v[66:67], v[64:65], v[26:27], v[66:67] op_sel:[1,1,0] op_sel_hi:[1,0,1] neg_lo:[1,0,0]
    v_cvt_pk_bf16_f32 v42, v52, v53
    s_mov_b32 m0, s66
    s_nop 0
    ds_write_addtid_b32 v42 offset:8704
    v_cvt_pk_bf16_f32 v43, v64, v65
    s_mov_b32 m0, s70
    s_nop 0
    ds_write_addtid_b32 v43 offset:37120
    v_cvt_pk_bf16_f32 v40, v66, v67
    ds_write_addtid_b32 v40 offset:38208
C_MFMA:
    s_mul_i32 s56, s2, 16384
    s_lshl_b32 s57, s38, 12
    s_add_u32 s56, s56, s57
    s_add_u32 s56, s56, 2605056
    s_mov_b64 exec, 0x1
    ds_inc_u32 v166, v166 offset:12
    s_mov_b64 exec, -1
    ds_write_b32 v113, v112
    s_setprio 2
    s_movk_i32 s60, 4000
C_KG:
    ds_read_b32 v16, v166 offset:12
    s_sub_u32 s60, s60, 1
    s_cmp_gt_i32 s60, 0
    s_waitcnt lgkmcnt(0)
    v_readfirstlane_b32 s52, v16
    s_nop 0
    s_cselect_b32 s52, s52, 4
    s_cmp_lg_u32 s52, 4
    s_cbranch_scc1 C_KG
    ds_read_b128 v[16:19], v111 offset:0
    ds_read_b128 v[20:23], v110 offset:0
    ds_read_b128 v[24:27], v111 offset:64
    ds_read_b128 v[28:31], v110 offset:64
    ds_read_b128 v[32:35], v111 offset:128
    ds_read_b128 v[36:39], v110 offset:128
    ds_read_b128 v[40:43], v111 offset:192
    ds_read_b128 v[44:47], v110 offset:192
    ds_read_b128 v[48:51], v111 offset:256
    ds_read_b128 v[52:55], v110 offset:256
    ds_read_b128 v[56:59], v111 offset:320
    ds_read_b128 v[60:63], v110 offset:320
    ds_read_b128 v[64:67], v111 offset:384
    ds_read_b128 v[68:71], v110 offset:384
    ds_read_b128 v[72:75], v111 offset:448
    ds_read_b128 v[76:79], v110 offset:448
    s_lshl_b32 s53, s63, 10
    s_sub_u32 s52, s64, s53
    s_add_u32 s52, s52, 3576
    v_and_b32 v165, 1, v5
    v_lshl_add_u32 v165, v6, 1, v165
    s_mul_i32 s53, s65, 384
    s_add_u32 s53, s53, 161920
    v_lshl_add_u32 v165, v165, 4, s53
    v_lshlrev_b32 v2, 3, v2
    v_sub_u32 v2, s52, v2
    s_mul_i32 s68, s63, 1088
    s_add_u32 s68, s68, s71
    v_lshl_add_u32 v15, v15, 3, s68
    s_cmp_lg_u32 s63, 0
    s_cbranch_scc1 C_LA1
    s_lshr_b32 s52, s2, 3
    s_mul_i32 s52, s52, 3
    s_add_u32 s52, s52, s65
    s_lshl_b32 s52, s52, 3
    s_and_b32 s53, s2, 7
    v_and_b32 v11, 7, v1
    v_add_u32 v11, s52, v11
    s_mul_i32 s54, s53, 7
    v_lshrrev_b32 v12, 3, v1
    v_add_u32 v12, s54, v12
    v_mul_u32_u24 v13, 0x48, v11
    v_add3_u32 v14, v12, v13, s53
    v_lshlrev_b32 v14, 7, v14
    v_add_u32 v10, s53, v12
    v_mul_u32_u24 v10, 0x240, v10
    s_add_u32 s53, s53, 64
    v_add_lshl_u32 v13, v13, s53, 7
    s_mul_i32 s53, s53, 0x240
    v_add_lshl_u32 v12, v11, s53, 7
    v_add_lshl_u32 v11, v11, v10, 7
    v_mov_b32 v10, 0
    v_lshrrev_b32 v9, 3, v1
    v_mul_u32_u24 v9, 3328, v9
    v_add3_u32 v9, v9, v3, s59
    s_branch C_LA2
C_LA1:
    v_and_b32 v93, 3, v5
    v_lshl_add_u32 v94, v6, 3, v11
    v_and_b32 v92, 1, v11
    v_mul_u32_u24 v92, 3456, v92
    v_add_u32 v92, s59, v92
    v_sub_u32 v93, v93, v94
    v_sub_u32 v94, v93, v94
    v_add_u32 v95, 44, v93
    v_lshrrev_b32 v96, 4, v95
    v_add_u32 v95, v95, v96
    v_lshl_add_u32 v11, v95, 3, v92
    v_add_u32 v95, 75, v94
    v_lshrrev_b32 v96, 4, v95
    v_add_u32 v95, v95, v96
    v_lshl_add_u32 v13, v95, 3, v92
    v_add_u32 v95, 40, v93
    v_lshrrev_b32 v96, 4, v95
    v_add_u32 v95, v95, v96
    v_lshl_add_u32 v12, v95, 3, v92
    v_add_u32 v95, 67, v94
    v_lshrrev_b32 v96, 4, v95
    v_add_u32 v95, v95, v96
    v_lshl_add_u32 v14, v95, 3, v92
C_LA2:
    s_cmp_eq_u32 s69, 2
    s_cbranch_scc1 C_T2
    v_lshrrev_b32 v89, 1, v6
    v_xor_b32 v88, v89, v6
    v_and_b32 v88, 1, v88
    v_lshlrev_b32 v88, 8, v88
    v_lshl_add_u32 v88, v89, 3, v88
    v_lshl_add_u32 v88, v5, 4, v88
    s_cmp_eq_u32 s69, 1
    s_cbranch_scc1 C_T1
    s_lshr_b32 s52, s69, 1
    s_mul_i32 s53, s52, 1600
    s_add_u32 s53, s53, s67
    v_add_u32 v88, s53, v88
    v_add_u32 v89, 3200, v88
    s_xor_b32 s52, s52, 1
    s_mov_b32 s53, 0
    s_waitcnt lgkmcnt(14)
    v_mfma_f32_16x16x32_bf16 v[80:83], v[16:19], v[20:23], 0
    s_waitcnt lgkmcnt(12)
    v_mfma_f32_16x16x32_bf16 v[84:87], v[24:27], v[28:31], 0
    s_waitcnt lgkmcnt(10)
    v_mfma_f32_16x16x32_bf16 v[80:83], v[32:35], v[36:39], v[80:83]
    s_waitcnt lgkmcnt(8)
    v_mfma_f32_16x16x32_bf16 v[84:87], v[40:43], v[44:47], v[84:87]
    s_waitcnt lgkmcnt(6)
    v_mfma_f32_16x16x32_bf16 v[80:83], v[48:51], v[52:55], v[80:83]
    s_waitcnt lgkmcnt(4)
    v_mfma_f32_16x16x32_bf16 v[84:87], v[56:59], v[60:63], v[84:87]
    s_waitcnt lgkmcnt(2)
    v_mfma_f32_16x16x32_bf16 v[80:83], v[64:67], v[68:71], v[80:83]
    s_waitcnt lgkmcnt(0)
    v_mfma_f32_16x16x32_bf16 v[84:87], v[72:75], v[76:79], v[84:87]
    s_nop 7
    v_pk_add_f32 v[80:81], v[80:81], v[84:85]
    v_pk_add_f32 v[82:83], v[82:83], v[86:87]
    v_cvt_pk_bf16_f32 v80, v80, v81
    v_cvt_pk_bf16_f32 v81, v82, v83
    ds_write_b64 v88, v[80:81] offset:32
    ds_write2_b32 v89, v80, v81 offset0:7 offset1:8
    s_mov_b64 exec, s[52:53]
    ds_write_b16 v88, v80 offset:1630
    ds_write_b16 v88, v80 offset:4826
    s_mov_b64 exec, -1
    s_branch C_B3
C_T1:
    s_add_u32 s53, s67, 544
    v_add_u32 v88, s53, v88
    v_add_u32 v89, 1600, v88
    s_waitcnt lgkmcnt(14)
    v_mfma_f32_16x16x32_bf16 v[80:83], v[16:19], v[20:23], 0
    s_waitcnt lgkmcnt(12)
    v_mfma_f32_16x16x32_bf16 v[84:87], v[24:27], v[28:31], 0
    s_waitcnt lgkmcnt(10)
    v_mfma_f32_16x16x32_bf16 v[80:83], v[32:35], v[36:39], v[80:83]
    s_waitcnt lgkmcnt(8)
    v_mfma_f32_16x16x32_bf16 v[84:87], v[40:43], v[44:47], v[84:87]
    s_waitcnt lgkmcnt(6)
    v_mfma_f32_16x16x32_bf16 v[80:83], v[48:51], v[52:55], v[80:83]
    s_waitcnt lgkmcnt(4)
    v_mfma_f32_16x16x32_bf16 v[84:87], v[56:59], v[60:63], v[84:87]
    s_waitcnt lgkmcnt(2)
    v_mfma_f32_16x16x32_bf16 v[80:83], v[64:67], v[68:71], v[80:83]
    s_waitcnt lgkmcnt(0)
    v_mfma_f32_16x16x32_bf16 v[84:87], v[72:75], v[76:79], v[84:87]
    s_nop 7
    v_pk_add_f32 v[80:81], v[80:81], v[84:85]
    v_pk_add_f32 v[82:83], v[82:83], v[86:87]
    v_cvt_pk_bf16_f32 v16, v81, v82
    v_cvt_pk_bf16_f32 v17, v82, v82
    v_cvt_pk_bf16_f32 v18, v82, v82
    v_cvt_pk_bf16_f32 v19, v82, v83
    ds_write2_b32 v88, v16, v17 offset0:1 offset1:2
    ds_write_b64 v88, v[16:17] offset:3200
    ds_write2_b32 v89, v18, v19 offset0:1 offset1:2
    ds_write_b64 v88, v[18:19] offset:4800
    v_cvt_pk_bf16_f32 v20, v80, v80
    v_cvt_pk_bf16_f32 v21, v80, v81
    s_mov_b64 exec, 0x1
    ds_write_b32 v88, v20
    ds_write_b32 v88, v20 offset:3196
    ds_write_b32 v88, v21 offset:1600
    ds_write_b32 v88, v21 offset:4796
    s_mov_b32 exec_lo, 0x0
    s_mov_b32 exec_hi, 0x8000
    ds_write_b16 v88, v17 offset:12
    ds_write_b16 v88, v17 offset:1610
    ds_write_b16 v88, v17 offset:3208
    ds_write_b16 v88, v17 offset:4806
    s_mov_b64 exec, -1
    s_branch C_B3
C_T2:
    v_lshlrev_b32 v88, 7, v6
    v_lshl_add_u32 v89, v5, 1, v88
    v_lshl_add_u32 v88, v5, 2, v88
    s_add_u32 s52, s64, 4728
    v_add_u32 v88, s52, v88
    s_add_u32 s52, s64, 4920
    v_add_u32 v89, s52, v89
    v_mov_b32 v90, s67
    s_waitcnt lgkmcnt(14)
    v_mfma_f32_16x16x32_bf16 v[80:83], v[16:19], v[20:23], 0
    s_waitcnt lgkmcnt(12)
    v_mfma_f32_16x16x32_bf16 v[84:87], v[24:27], v[28:31], 0
    s_waitcnt lgkmcnt(10)
    v_mfma_f32_16x16x32_bf16 v[80:83], v[32:35], v[36:39], v[80:83]
    s_waitcnt lgkmcnt(8)
    v_mfma_f32_16x16x32_bf16 v[84:87], v[40:43], v[44:47], v[84:87]
    s_waitcnt lgkmcnt(6)
    v_mfma_f32_16x16x32_bf16 v[80:83], v[48:51], v[52:55], v[80:83]
    s_waitcnt lgkmcnt(4)
    v_mfma_f32_16x16x32_bf16 v[84:87], v[56:59], v[60:63], v[84:87]
    s_waitcnt lgkmcnt(2)
    v_mfma_f32_16x16x32_bf16 v[80:83], v[64:67], v[68:71], v[80:83]
    s_waitcnt lgkmcnt(0)
    v_mfma_f32_16x16x32_bf16 v[84:87], v[72:75], v[76:79], v[84:87]
    s_nop 7
    v_pk_add_f32 v[80:81], v[80:81], v[84:85]
    v_pk_add_f32 v[82:83], v[82:83], v[86:87]
    v_cvt_pk_bf16_f32 v80, v80, v81
    v_cvt_pk_bf16_f32 v81, v82, v83
    s_mov_b32 exec_hi, 0
    ds_write2_b32 v88, v80, v81 offset0:0 offset1:16
    s_not_b64 exec, exec
    ds_write_b16 v89, v80 offset:4
    ds_write_b16_d16_hi v89, v80 offset:36
    ds_write_b16 v89, v81 offset:68
    ds_write_b16_d16_hi v89, v81 offset:100
    ds_write_b16 v89, v80 offset:384
    ds_write_b16_d16_hi v89, v80 offset:416
    ds_write_b16 v89, v81 offset:448
    ds_write_b16_d16_hi v89, v81 offset:480
    s_mov_b32 exec_lo, 0x80000000
    s_mov_b32 exec_hi, 0x0
    ds_write_b16_d16_hi v90, v81 offset:1126
    ds_write_b16_d16_hi v90, v81 offset:1128
    ds_write_b16_d16_hi v90, v81 offset:2724
    ds_write_b16_d16_hi v90, v81 offset:2726
    ds_write_b16_d16_hi v90, v81 offset:4322
    ds_write_b16_d16_hi v90, v81 offset:4324
    ds_write_b16_d16_hi v90, v81 offset:5920
    ds_write_b16_d16_hi v90, v81 offset:5922
    s_mov_b64 exec, -1
C_B3:
    s_mov_b64 exec, 0x1
    ds_inc_u32 v166, v166 offset:128
    s_mov_b64 exec, -1
    s_mov_b32 s61, s65
    s_cmp_lg_u32 s65, 1
    s_cbranch_scc1 C_NOUL
    s_waitcnt vmcnt(0)
    buffer_load_dwordx4 v[24:27], v3, s[40:43], s56 offen offset:0 sc1
    buffer_load_dwordx4 v[28:31], v3, s[40:43], s56 offen offset:1024 sc1
    buffer_load_dwordx4 v[32:35], v3, s[40:43], s56 offen offset:2048 sc1
    buffer_load_dwordx4 v[36:39], v3, s[40:43], s56 offen offset:3072 sc1
C_NOUL:
    s_movk_i32 s60, 4000
C_KM:
    ds_read_b128 v[16:19], v166 offset:128
    s_sub_u32 s60, s60, 1
    s_cmp_gt_i32 s60, 0
    s_waitcnt lgkmcnt(0)
    v_add_u32 v16, v16, v18
    s_nop 0
    v_readfirstlane_b32 s52, v16
    s_nop 0
    s_cselect_b32 s52, s52, 5
    s_cmp_lg_u32 s52, 5
    s_cbranch_scc1 C_KM
    s_sub_u32 s52, s38, 8
    s_cmp_ge_u32 s52, 3
    s_cbranch_scc1 C_NPA
    s_mov_b32 s52, m0
    s_mov_b32 m0, 163328
    s_nop 0
    global_load_lds_dword v118, s[28:29]
    s_mov_b32 m0, s52
C_NPA:
    s_setprio 3
    ds_read_b64 v[48:49], v7 offset:0
    ds_read_b64 v[50:51], v7 offset:8
    ds_read_b64 v[52:53], v7 offset:64
    ds_read_b64 v[54:55], v7 offset:72
    ds_read_b64 v[56:57], v7 offset:128
    ds_read_b64 v[58:59], v7 offset:136
    ds_read_b64 v[60:61], v7 offset:192
    ds_read_b64 v[62:63], v7 offset:200
    ds_read_b64 v[64:65], v7 offset:256
    ds_read_b64 v[66:67], v7 offset:264
    ds_read_b64 v[68:69], v7 offset:320
    ds_read_b64 v[70:71], v7 offset:328
    ds_read_b64 v[72:73], v7 offset:384
    ds_read_b64 v[74:75], v7 offset:392
    ds_read_b64 v[76:77], v7 offset:448
    ds_read_b64 v[78:79], v7 offset:456
    ds_read_b64 v[80:81], v7 offset:512
    ds_read_b64 v[82:83], v7 offset:520
    ds_read_b64 v[84:85], v7 offset:576
    ds_read_b64 v[86:87], v7 offset:584
    ds_read_b64 v[88:89], v7 offset:640
    ds_read_b64 v[90:91], v7 offset:648
    ds_read_b64 v[92:93], v7 offset:704
    ds_read_b64 v[94:95], v7 offset:712
    ds_read_b64 v[96:97], v7 offset:768
    ds_read_b64 v[98:99], v7 offset:776
    ds_read_b64 v[100:101], v7 offset:832
    ds_read_b64 v[102:103], v7 offset:840
    ds_read_b64 v[104:105], v7 offset:896
    ds_read_b64 v[106:107], v7 offset:904
    ds_read_b64 v[108:109], v7 offset:960
    ds_read_b64 v[110:111], v7 offset:968
    s_cmp_eq_u32 s63, 1
    s_cbranch_scc1 C_E1
    s_cmp_eq_u32 s63, 2
    s_cbranch_scc1 C_E2
    s_cmp_eq_u32 s63, 3
    s_cbranch_scc1 C_E3
    ds_read_b64 v[112:113], v7 offset:1152
    ds_read_b64 v[114:115], v7 offset:1160
    ds_read_b64 v[116:117], v7 offset:1216
    ds_read_b64 v[118:119], v7 offset:1224
    ds_read_b64 v[128:129], v7 offset:1280
    ds_read_b64 v[130:131], v7 offset:1288
    ds_read_b64 v[132:133], v7 offset:1344
    ds_read_b64 v[134:135], v7 offset:1352
    s_mov_b32 exec_hi, 0
    ds_write_b128 v9, v[160:163]
    s_mov_b64 exec, -1
    s_branch C_EE
C_E1:
    ds_read_b64 v[128:129], v7 offset:1152
    ds_read_b64 v[130:131], v7 offset:1160
    ds_read_b64 v[132:133], v7 offset:1216
    ds_read_b64 v[134:135], v7 offset:1224
    ds_read_b64 v[136:137], v7 offset:1280
    ds_read_b64 v[138:139], v7 offset:1288
    ds_read_b64 v[140:141], v7 offset:1344
    ds_read_b64 v[142:143], v7 offset:1352
    ds_read_b64 v[112:113], v7 offset:1024
    ds_read_b64 v[114:115], v7 offset:1032
    s_branch C_EE
C_E2:
    ds_read_b64 v[152:153], v7 offset:1152
    ds_read_b64 v[154:155], v7 offset:1160
    ds_read_b64 v[156:157], v7 offset:1216
    ds_read_b64 v[158:159], v7 offset:1224
    ds_read_b64 v[112:113], v7 offset:1024
    ds_read_b64 v[114:115], v7 offset:1032
    ds_read_b64 v[128:129], v9 offset:4608
    ds_read_b64 v[130:131], v9 offset:4616
    ds_read_b64 v[132:133], v9 offset:4672
    ds_read_b64 v[134:135], v9 offset:4680
    ds_read_b64 v[136:137], v9 offset:4736
    ds_read_b64 v[138:139], v9 offset:4744
    ds_read_b64 v[140:141], v9 offset:4800
    ds_read_b64 v[142:143], v9 offset:4808
    ds_read_b64 v[144:145], v9 offset:4864
    ds_read_b64 v[146:147], v9 offset:4872
    ds_read_b64 v[148:149], v9 offset:4928
    ds_read_b64 v[150:151], v9 offset:4936
    s_branch C_EE
C_E3:
    ds_read_b64 v[112:113], v7 offset:1024
    ds_read_b64 v[114:115], v7 offset:1032
    ds_read_b64 v[116:117], v7 offset:1088
    ds_read_b64 v[118:119], v7 offset:1096
    ds_read_b64 v[128:129], v9 offset:4608
    ds_read_b64 v[130:131], v9 offset:4616
    ds_read_b64 v[132:133], v9 offset:4672
    ds_read_b64 v[134:135], v9 offset:4680
    ds_read_b64 v[136:137], v9 offset:4736
    ds_read_b64 v[138:139], v9 offset:4744
    ds_read_b64 v[140:141], v9 offset:4800
    ds_read_b64 v[142:143], v9 offset:4808
    ds_read_b64 v[144:145], v9 offset:4864
    ds_read_b64 v[146:147], v9 offset:4872
    ds_read_b64 v[148:149], v9 offset:4928
    ds_read_b64 v[150:151], v9 offset:4936
    ds_read_b64 v[152:153], v10 offset:5120
    ds_read_b64 v[154:155], v10 offset:5128
    ds_read_b64 v[156:157], v10 offset:5184
    ds_read_b64 v[158:159], v10 offset:5192
    ds_read_b64 v[120:121], v10 offset:5248
    ds_read_b64 v[122:123], v10 offset:5256
    ds_read_b64 v[124:125], v10 offset:5312
    ds_read_b64 v[126:127], v10 offset:5320
C_EE:
    v_mov_b32 v167, v19
    v_readfirstlane_b32 s39, v19
    v_mul_u32_u24 v5, 37, v1
    v_lshrrev_b32 v5, 8, v5
    v_mul_u32_u24 v5, 1040, v5
    v_add_u32 v5, v5, v3
    v_add_u32 v6, 0x2400, v5
    s_mul_i32 s44, s2, 18432
    s_mul_i32 s45, s38, 96
    s_add_u32 s44, s44, s45
    s_add_u32 s72, s4, s44
    s_addc_u32 s73, s5, 0
    s_add_u32 s74, s24, s45
    s_addc_u32 s75, s25, 0
    s_mul_i32 s58, s69, 1920
    s_add_u32 s58, s58, s71
    s_add_u32 s58, s58, 4352
    s_cmp_lt_u32 s38, 4
    s_cbranch_scc1 C_B5
    v_mov_b32 v40, -1
    v_mov_b32 v41, -1
    v_mov_b32 v42, -1
    v_mov_b32 v43, -1
    v_lshlrev_b32 v20, 4, v0
    v_lshlrev_b32 v21, 2, v0
    s_cmp_lg_u32 s61, 1
    s_cbranch_scc1 C_PO
    v_xor_b32 v22, 0x80000000, v167
    s_movk_i32 s60, 4000
    s_branch C_UP_W
C_UP:
    buffer_load_dwordx4 v[24:27], v3, s[40:43], s56 offen offset:0 sc1
    buffer_load_dwordx4 v[28:31], v3, s[40:43], s56 offen offset:1024 sc1
    buffer_load_dwordx4 v[32:35], v3, s[40:43], s56 offen offset:2048 sc1
    buffer_load_dwordx4 v[36:39], v3, s[40:43], s56 offen offset:3072 sc1
C_UP_W:
    s_waitcnt vmcnt(0)
C_UP_C:
    v_xor_b32 v44, v22, v27
    v_xor_b32 v45, v22, v31
    v_xor_b32 v46, v22, v35
    v_xor_b32 v47, v22, v39
    v_or3_b32 v44, v44, v45, v46
    v_or_b32 v44, v44, v47
    v_cmp_ne_u32 vcc, 0, v44
    s_nop 0
    s_and_b64 exec, exec, vcc
    s_cbranch_execz C_UP_D
    s_wqm_b64 exec, exec
    s_sub_u32 s60, s60, 1
    s_cmp_gt_i32 s60, 0
    s_sleep 2
    s_cbranch_scc1 C_UP
C_UP_D:
    s_mov_b64 exec, -1
    s_lshl_b32 s52, s38, 10
    s_add_u32 m0, s52, 47936
    v_add_u32 v18, 161412, v3
    ds_write_addtid_b32 v25 offset:55040
    ds_write_addtid_b32 v29 offset:55296
    ds_write_addtid_b32 v33 offset:55552
    ds_write_addtid_b32 v37 offset:55808
    s_mov_b64 exec, 0x2
    ds_inc_u32 v18, v18
    s_mov_b64 exec, -1
    ds_write_addtid_b32 v26 offset:60928
    ds_write_addtid_b32 v30 offset:61184
    ds_write_addtid_b32 v34 offset:61440
    ds_write_addtid_b32 v38 offset:61696
    s_mov_b64 exec, 0x4
    ds_inc_u32 v18, v18
    s_mov_b64 exec, -1
    ds_write_addtid_b32 v24 offset:49152
    ds_write_addtid_b32 v28 offset:49408
    ds_write_addtid_b32 v32 offset:49664
    ds_write_addtid_b32 v36 offset:49920
    s_mov_b64 exec, 0x1
    ds_inc_u32 v18, v18
    s_mov_b64 exec, -1
C_PO:
    s_cmp_ge_u32 s50, 144
    s_cbranch_scc1 C_B5
    buffer_store_dwordx4 v[40:43], v20, s[40:43], s48 offen sc1
    buffer_store_dword v40, v21, s[40:43], s49 offen sc1
    s_cmp_lt_u32 s2, 128
    s_cselect_b32 s52, 8, -1
    s_cmp_lg_u32 s38, s52
    s_cbranch_scc1 C_B5
    v_lshrrev_b32 v22, 2, v1
    v_mul_u32_u24 v22, 8128, v22
    v_add_u32 v22, v22, v3
    s_mul_i32 s52, s2, 64
    s_add_u32 s52, s52, 65536
    s_mov_b32 exec_lo, 0xffffffff
    s_mov_b32 exec_hi, 0x0
    buffer_store_dwordx4 v[40:43], v22, s[40:43], s52 offen sc1
    s_mov_b64 exec, -1
C_B5:
    s_mov_b32 s56, 0xf7efdfbf
    s_mov_b32 s57, 0x7efdfb
    s_movk_i32 s60, 4000
C_UF:
    ds_read_b32 v16, v166 offset:132
    s_sub_u32 s60, s60, 1
    s_cmp_gt_i32 s60, 0
    s_waitcnt lgkmcnt(0)
    v_readfirstlane_b32 s52, v16
    s_nop 0
    s_cselect_b32 s52, s52, 4
    s_cmp_lg_u32 s52, 4
    s_cbranch_scc1 C_UF
    s_movk_i32 s60, 4000
    s_cmp_eq_u32 s63, 1
    s_cbranch_scc1 C_P1
    s_cmp_eq_u32 s63, 2
    s_cbranch_scc1 C_P2
    s_cmp_eq_u32 s63, 3
    s_cbranch_scc1 C_P3
    s_setprio 2
    ds_read_b128 v[32:35], v8 offset:3552
    ds_read_b128 v[36:39], v8 offset:4064
    ds_read_b128 v[40:43], v8 offset:3680
    s_waitcnt lgkmcnt(2)
    v_mfma_f32_16x16x32_bf16 v[136:139], v[112:115], v[32:35], 0
    v_mfma_f32_16x16x32_bf16 v[140:143], v[116:119], v[32:35], 0
    v_mfma_f32_16x16x32_bf16 v[144:147], v[128:131], v[32:35], 0
    v_mfma_f32_16x16x32_bf16 v[148:151], v[132:135], v[32:35], 0
    v_mfma_f32_16x16x32_bf16 v[28:31], v[52:55], v[32:35], 0
    v_mfma_f32_16x16x32_bf16 v[20:23], v[48:51], v[32:35], 0
    ds_read_b128 v[44:47], v8 offset:3808
    s_waitcnt lgkmcnt(2)
    v_mfma_f32_16x16x32_bf16 v[152:155], v[112:115], v[36:39], 0
    v_mfma_f32_16x16x32_bf16 v[156:159], v[116:119], v[36:39], 0
    v_mfma_f32_16x16x32_bf16 v[120:123], v[128:131], v[36:39], 0
    v_mfma_f32_16x16x32_bf16 v[124:127], v[132:135], v[36:39], 0
    v_mfma_f32_16x16x32_bf16 v[28:31], v[84:87], v[36:39], v[28:31]
    v_mfma_f32_16x16x32_bf16 v[20:23], v[80:83], v[36:39], v[20:23]
    v_mfma_f32_16x16x32_bf16 v[24:27], v[52:55], v[36:39], 0
    v_mfma_f32_16x16x32_bf16 v[16:19], v[48:51], v[36:39], 0
    v_cvt_pk_bf16_f32 v136, v136, v137
    v_cvt_pk_bf16_f32 v137, v138, v139
    ds_write_b64 v4, v[136:137] offset:680
    v_cvt_pk_bf16_f32 v140, v140, v141
    v_cvt_pk_bf16_f32 v141, v142, v143
    ds_write_b64 v4, v[140:141] offset:4136
    v_cvt_pk_bf16_f32 v144, v144, v145
    v_cvt_pk_bf16_f32 v145, v146, v147
    ds_write_b64 v4, v[144:145] offset:7592
    v_cvt_pk_bf16_f32 v148, v148, v149
    v_cvt_pk_bf16_f32 v149, v150, v151
    ds_write_b64 v4, v[148:149] offset:11048
    ds_read_b128 v[32:35], v8 offset:3936
    s_waitcnt lgkmcnt(6)
    v_mfma_f32_16x16x32_bf16 v[28:31], v[60:63], v[40:43], v[28:31]
    v_mfma_f32_16x16x32_bf16 v[20:23], v[56:59], v[40:43], v[20:23]
    v_cvt_pk_bf16_f32 v152, v152, v153
    v_cvt_pk_bf16_f32 v153, v154, v155
    ds_write_b64 v4, v[152:153] offset:136
    v_cvt_pk_bf16_f32 v156, v156, v157
    v_cvt_pk_bf16_f32 v157, v158, v159
    ds_write_b64 v4, v[156:157] offset:3592
    v_cvt_pk_bf16_f32 v120, v120, v121
    v_cvt_pk_bf16_f32 v121, v122, v123
    ds_write_b64 v4, v[120:121] offset:7048
    v_cvt_pk_bf16_f32 v124, v124, v125
    v_cvt_pk_bf16_f32 v125, v126, v127
    ds_write_b64 v4, v[124:125] offset:10504
    s_mov_b64 exec, 0x1
    ds_write_b32 v166, v166 offset:0
    s_mov_b64 exec, -1
    s_setprio 0
    ds_read_b128 v[84:87], v8 offset:4192
    ds_read_b64 v[160:161], v2 offset:512
    ds_read_b64 v[162:163], v2
    s_or_b32 s52, s38, s2
    s_cbranch_scc1 C_NOEP
    s_mov_b64 exec, 0x1
    buffer_store_dword v167, v10, s[40:43], 0 offen sc1
    s_mov_b64 exec, -1
C_NOEP:
    s_cmp_ge_u32 s2, 128
    s_cbranch_scc1 C_NX0
    s_mov_b32 m0, s58
    s_mov_b64 exec, s[56:57]
    global_load_lds_dwordx4 v5, s[72:73]
    s_add_u32 m0, s58, 896
    s_nop 0
    global_load_lds_dwordx4 v6, s[72:73]
    s_add_u32 m0, s58, 1792
    s_mov_b64 exec, 0x3f
    global_load_lds_dwordx4 v3, s[74:75]
    s_mov_b64 exec, -1
C_NX0:
    s_mov_b32 m0, 163328
    s_nop 0
    global_load_lds_dword v11, s[30:31]
    s_mov_b64 exec, 0xff
    global_load_lds_dword v13, s[28:29]
    global_load_lds_dword v13, s[26:27]
    global_load_lds_dword v12, s[30:31]
    s_mov_b64 exec, -1
    s_waitcnt lgkmcnt(13)
    v_mfma_f32_16x16x32_bf16 v[28:31], v[68:71], v[44:47], v[28:31]
    v_mfma_f32_16x16x32_bf16 v[20:23], v[64:67], v[44:47], v[20:23]
    ds_read_b128 v[80:83], v8 offset:4320
    s_waitcnt lgkmcnt(9)
    v_mfma_f32_16x16x32_bf16 v[28:31], v[76:79], v[32:35], v[28:31]
    v_mfma_f32_16x16x32_bf16 v[20:23], v[72:75], v[32:35], v[20:23]
    ds_read_b128 v[36:39], v8 offset:4448
    s_waitcnt lgkmcnt(2)
    v_and_b32 v48, 0xffff0000, v161
    v_lshlrev_b32 v49, 16, v161
    v_and_b32 v50, 0xffff0000, v160
    v_lshlrev_b32 v51, 16, v160
    v_mul_f32 v48, v48, v164
    v_mul_f32 v49, v49, v164
    v_mul_f32 v50, v50, v164
    v_mul_f32 v51, v51, v164
    v_cvt_pk_bf16_f32 v49, v48, v49
    v_lshlrev_b32 v48, 16, v49
    v_and_b32 v49, 0xffff0000, v49
    v_cvt_pk_bf16_f32 v51, v50, v51
    v_lshlrev_b32 v50, 16, v51
    v_and_b32 v51, 0xffff0000, v51
    v_and_b32 v52, 0xffff0000, v163
    v_lshlrev_b32 v53, 16, v163
    v_and_b32 v54, 0xffff0000, v162
    v_lshlrev_b32 v55, 16, v162
    v_mul_f32 v52, v52, v164
    v_mul_f32 v53, v53, v164
    v_mul_f32 v54, v54, v164
    v_mul_f32 v55, v55, v164
    v_cvt_pk_bf16_f32 v53, v52, v53
    v_lshlrev_b32 v52, 16, v53
    v_and_b32 v53, 0xffff0000, v53
    v_cvt_pk_bf16_f32 v55, v54, v55
    v_lshlrev_b32 v54, 16, v55
    v_and_b32 v55, 0xffff0000, v55
    v_mfma_f32_16x16x32_bf16 v[28:31], v[92:95], v[84:87], v[28:31]
    v_mfma_f32_16x16x32_bf16 v[20:23], v[88:91], v[84:87], v[20:23]
    v_mfma_f32_16x16x32_bf16 v[24:27], v[60:63], v[84:87], v[24:27]
    v_mfma_f32_16x16x32_bf16 v[16:19], v[56:59], v[84:87], v[16:19]
    s_waitcnt lgkmcnt(1)
    v_mfma_f32_16x16x32_bf16 v[28:31], v[100:103], v[80:83], v[28:31]
    v_mfma_f32_16x16x32_bf16 v[20:23], v[96:99], v[80:83], v[20:23]
    v_mfma_f32_16x16x32_bf16 v[24:27], v[68:71], v[80:83], v[24:27]
    v_mfma_f32_16x16x32_bf16 v[16:19], v[64:67], v[80:83], v[16:19]
    s_waitcnt lgkmcnt(0)
    v_mfma_f32_16x16x32_bf16 v[28:31], v[108:111], v[36:39], v[28:31]
    v_mfma_f32_16x16x32_bf16 v[20:23], v[104:107], v[36:39], v[20:23]
    v_mfma_f32_16x16x32_bf16 v[24:27], v[76:79], v[36:39], v[24:27]
    v_mfma_f32_16x16x32_bf16 v[16:19], v[72:75], v[36:39], v[16:19]
    s_mov_b32 exec_lo, 0xc000c000
    s_mov_b32 exec_hi, 0xc000c000
    s_nop 2
    ds_write_b128 v165, v[28:31] offset:128
    ds_write_b32 v166, v166 offset:64
    s_mov_b64 exec, -1
    s_setprio 0
    s_waitcnt vmcnt(7)
    s_cmp_lt_u32 s2, 128
    s_cbranch_scc1 C_EPI
    s_waitcnt vmcnt(4)
    s_branch C_EPI
C_P1:
    s_setprio 2
    ds_read_b128 v[32:35], v8 offset:2528
    ds_read_b128 v[36:39], v8 offset:3040
    ds_read_b128 v[40:43], v8 offset:2656
    s_waitcnt lgkmcnt(2)
    v_mfma_f32_16x16x32_bf16 v[144:147], v[128:131], v[32:35], 0
    v_mfma_f32_16x16x32_bf16 v[148:151], v[132:135], v[32:35], 0
    v_mfma_f32_16x16x32_bf16 v[152:155], v[136:139], v[32:35], 0
    v_mfma_f32_16x16x32_bf16 v[156:159], v[140:143], v[32:35], 0
    v_mfma_f32_16x16x32_bf16 v[28:31], v[52:55], v[32:35], 0
    v_mfma_f32_16x16x32_bf16 v[20:23], v[48:51], v[32:35], 0
    ds_read_b128 v[44:47], v8 offset:2784
    s_waitcnt lgkmcnt(2)
    v_mfma_f32_16x16x32_bf16 v[116:119], v[128:131], v[36:39], 0
    v_mfma_f32_16x16x32_bf16 v[160:163], v[132:135], v[36:39], 0
    v_mfma_f32_16x16x32_bf16 v[120:123], v[136:139], v[36:39], 0
    v_mfma_f32_16x16x32_bf16 v[124:127], v[140:143], v[36:39], 0
    v_mfma_f32_16x16x32_bf16 v[28:31], v[84:87], v[36:39], v[28:31]
    v_mfma_f32_16x16x32_bf16 v[20:23], v[80:83], v[36:39], v[20:23]
    v_mfma_f32_16x16x32_bf16 v[24:27], v[52:55], v[36:39], 0
    v_mfma_f32_16x16x32_bf16 v[16:19], v[48:51], v[36:39], 0
    v_cvt_pk_bf16_f32 v144, v144, v145
    v_cvt_pk_bf16_f32 v145, v146, v147
    ds_write_b64 v4, v[144:145] offset:1768
    v_cvt_pk_bf16_f32 v148, v148, v149
    v_cvt_pk_bf16_f32 v149, v150, v151
    ds_write_b64 v4, v[148:149] offset:5224
    v_cvt_pk_bf16_f32 v152, v152, v153
    v_cvt_pk_bf16_f32 v153, v154, v155
    ds_write_b64 v4, v[152:153] offset:8680
    v_cvt_pk_bf16_f32 v156, v156, v157
    v_cvt_pk_bf16_f32 v157, v158, v159
    ds_write_b64 v4, v[156:157] offset:12136
    ds_read_b128 v[32:35], v8 offset:2912
    s_waitcnt lgkmcnt(6)
    v_mfma_f32_16x16x32_bf16 v[28:31], v[60:63], v[40:43], v[28:31]
    v_mfma_f32_16x16x32_bf16 v[20:23], v[56:59], v[40:43], v[20:23]
    v_cvt_pk_bf16_f32 v116, v116, v117
    v_cvt_pk_bf16_f32 v117, v118, v119
    ds_write_b64 v4, v[116:117] offset:1224
    v_cvt_pk_bf16_f32 v160, v160, v161
    v_cvt_pk_bf16_f32 v161, v162, v163
    ds_write_b64 v4, v[160:161] offset:4680
    v_cvt_pk_bf16_f32 v120, v120, v121
    v_cvt_pk_bf16_f32 v121, v122, v123
    ds_write_b64 v4, v[120:121] offset:8136
    v_cvt_pk_bf16_f32 v124, v124, v125
    v_cvt_pk_bf16_f32 v125, v126, v127
    ds_write_b64 v4, v[124:125] offset:11592
    s_mov_b64 exec, 0x1
    ds_write_b32 v166, v166 offset:4
    s_mov_b64 exec, -1
    s_setprio 1
    ds_read_b128 v[36:39], v8 offset:3168
    ds_read_b64 v[144:145], v9 offset:4608
    ds_read_b64 v[146:147], v9 offset:4616
    ds_read_b64 v[148:149], v9 offset:4672
    ds_read_b64 v[150:151], v9 offset:4680
    ds_read_b64 v[152:153], v9 offset:4736
    ds_read_b64 v[154:155], v9 offset:4744
    ds_read_b64 v[156:157], v9 offset:4800
    ds_read_b64 v[158:159], v9 offset:4808
    ds_read_b64 v[160:161], v2 offset:512
    ds_read_b64 v[162:163], v2
    s_cmp_ge_u32 s2, 128
    s_cbranch_scc1 C_NX1
    s_mov_b32 m0, s58
    s_mov_b64 exec, s[56:57]
    global_load_lds_dwordx4 v5, s[72:73]
    s_add_u32 m0, s58, 896
    s_nop 0
    global_load_lds_dwordx4 v6, s[72:73]
    s_add_u32 m0, s58, 1792
    s_mov_b64 exec, 0x3f
    global_load_lds_dwordx4 v3, s[74:75]
    s_mov_b64 exec, -1
C_NX1:
    s_waitcnt lgkmcnt(15)
    v_mfma_f32_16x16x32_bf16 v[28:31], v[68:71], v[44:47], v[28:31]
    v_mfma_f32_16x16x32_bf16 v[20:23], v[64:67], v[44:47], v[20:23]
    ds_read_b128 v[40:43], v8 offset:3296
    v_mfma_f32_16x16x32_bf16 v[28:31], v[76:79], v[32:35], v[28:31]
    v_mfma_f32_16x16x32_bf16 v[20:23], v[72:75], v[32:35], v[20:23]
    ds_read_b128 v[128:131], v8 offset:3424
    s_waitcnt lgkmcnt(2)
    v_and_b32 v48, 0xffff0000, v161
    v_lshlrev_b32 v49, 16, v161
    v_and_b32 v50, 0xffff0000, v160
    v_lshlrev_b32 v51, 16, v160
    v_mul_f32 v48, v48, v164
    v_mul_f32 v49, v49, v164
    v_mul_f32 v50, v50, v164
    v_mul_f32 v51, v51, v164
    v_cvt_pk_bf16_f32 v49, v48, v49
    v_lshlrev_b32 v48, 16, v49
    v_and_b32 v49, 0xffff0000, v49
    v_cvt_pk_bf16_f32 v51, v50, v51
    v_lshlrev_b32 v50, 16, v51
    v_and_b32 v51, 0xffff0000, v51
    v_and_b32 v52, 0xffff0000, v163
    v_lshlrev_b32 v53, 16, v163
    v_and_b32 v54, 0xffff0000, v162
    v_lshlrev_b32 v55, 16, v162
    v_mul_f32 v52, v52, v164
    v_mul_f32 v53, v53, v164
    v_mul_f32 v54, v54, v164
    v_mul_f32 v55, v55, v164
    v_cvt_pk_bf16_f32 v53, v52, v53
    v_lshlrev_b32 v52, 16, v53
    v_and_b32 v53, 0xffff0000, v53
    v_cvt_pk_bf16_f32 v55, v54, v55
    v_lshlrev_b32 v54, 16, v55
    v_and_b32 v55, 0xffff0000, v55
    v_mfma_f32_16x16x32_bf16 v[28:31], v[92:95], v[36:39], v[28:31]
    v_mfma_f32_16x16x32_bf16 v[20:23], v[88:91], v[36:39], v[20:23]
    v_mfma_f32_16x16x32_bf16 v[24:27], v[60:63], v[36:39], v[24:27]
    v_mfma_f32_16x16x32_bf16 v[16:19], v[56:59], v[36:39], v[16:19]
    ds_read_b128 v[132:135], v8 offset:3552
    s_waitcnt lgkmcnt(2)
    v_mfma_f32_16x16x32_bf16 v[28:31], v[100:103], v[40:43], v[28:31]
    v_mfma_f32_16x16x32_bf16 v[20:23], v[96:99], v[40:43], v[20:23]
    v_mfma_f32_16x16x32_bf16 v[24:27], v[68:71], v[40:43], v[24:27]
    v_mfma_f32_16x16x32_bf16 v[16:19], v[64:67], v[40:43], v[16:19]
    ds_read_b96 v[60:62], v166
    ds_read_b128 v[136:139], v8 offset:3680
    s_waitcnt lgkmcnt(3)
    v_mfma_f32_16x16x32_bf16 v[28:31], v[108:111], v[128:131], v[28:31]
    v_mfma_f32_16x16x32_bf16 v[20:23], v[104:107], v[128:131], v[20:23]
    v_mfma_f32_16x16x32_bf16 v[24:27], v[76:79], v[128:131], v[24:27]
    v_mfma_f32_16x16x32_bf16 v[16:19], v[72:75], v[128:131], v[16:19]
    s_waitcnt lgkmcnt(1)
C_FL1:
    v_min3_u32 v60, v60, v61, v62
    v_cmp_eq_u32 vcc, 0, v60
    s_nop 4
    s_cbranch_vccz C_FD1
    ds_read_b96 v[60:62], v166
    s_sub_u32 s60, s60, 1
    s_cmp_gt_i32 s60, 0
    s_waitcnt lgkmcnt(0)
    s_cbranch_scc1 C_FL1
C_FD1:
    ds_read_b128 v[140:143], v8 offset:3808
    v_mfma_f32_16x16x32_bf16 v[20:23], v[112:115], v[132:135], v[20:23]
    v_mfma_f32_16x16x32_bf16 v[24:27], v[84:87], v[132:135], v[24:27]
    v_mfma_f32_16x16x32_bf16 v[16:19], v[80:83], v[132:135], v[16:19]
    s_mov_b32 exec_lo, 0xc000c000
    s_mov_b32 exec_hi, 0xc000c000
    ds_write_b128 v165, v[28:31] offset:256
    ds_write_b32 v166, v166 offset:68
    s_mov_b64 exec, -1
    ds_read_b128 v[44:47], v8 offset:3936
    s_waitcnt lgkmcnt(4)
    v_mfma_f32_16x16x32_bf16 v[24:27], v[92:95], v[136:139], v[24:27]
    v_mfma_f32_16x16x32_bf16 v[16:19], v[88:91], v[136:139], v[16:19]
    ds_read_b128 v[32:35], v8 offset:4064
    ds_read_b64_tr_b16 v[36:37], v11 offset:0
    ds_read_b64_tr_b16 v[38:39], v12 offset:0
    ds_read_b64_tr_b16 v[68:69], v11 offset:272
    ds_read_b64_tr_b16 v[70:71], v12 offset:272
    s_waitcnt lgkmcnt(8)
    v_mfma_f32_16x16x32_bf16 v[24:27], v[100:103], v[140:143], v[24:27]
    v_mfma_f32_16x16x32_bf16 v[16:19], v[96:99], v[140:143], v[16:19]
    ds_read_b64_tr_b16 v[64:65], v11 offset:544
    ds_read_b64_tr_b16 v[66:67], v12 offset:544
    s_waitcnt lgkmcnt(7)
    v_mfma_f32_16x16x32_bf16 v[24:27], v[108:111], v[44:47], v[24:27]
    v_mfma_f32_16x16x32_bf16 v[16:19], v[104:107], v[44:47], v[16:19]
    ds_read_b64_tr_b16 v[40:41], v11 offset:816
    ds_read_b64_tr_b16 v[42:43], v12 offset:816
    s_waitcnt lgkmcnt(8)
    v_mfma_f32_16x16x32_bf16 v[16:19], v[112:115], v[32:35], v[16:19]
    s_waitcnt lgkmcnt(6)
    v_mfma_f32_16x16x32_bf16 v[20:23], v[36:39], v[156:159], v[20:23]
    v_mfma_f32_16x16x32_bf16 v[16:19], v[36:39], v[148:151], v[16:19]
    s_waitcnt lgkmcnt(4)
    v_mfma_f32_16x16x32_bf16 v[20:23], v[68:71], v[152:155], v[20:23]
    v_mfma_f32_16x16x32_bf16 v[16:19], v[68:71], v[144:147], v[16:19]
    ds_read_b32 v60, v166 offset:64
    ds_read_b128 v[56:59], v165 offset:128
    s_waitcnt lgkmcnt(4)
    v_mfma_f32_16x16x32_bf16 v[20:23], v[64:67], v[148:151], v[20:23]
    s_waitcnt lgkmcnt(2)
    v_mfma_f32_16x16x32_bf16 v[20:23], v[40:43], v[144:147], v[20:23]
    s_setprio 0
    s_waitcnt lgkmcnt(0)
C_CL1:
    v_cmp_eq_u32 vcc, 0, v60
    s_nop 4
    s_cbranch_vccz C_CD
    ds_read_b32 v60, v166 offset:64
    ds_read_b128 v[56:59], v165 offset:128
    s_sub_u32 s60, s60, 1
    s_cmp_gt_i32 s60, 0
    s_waitcnt lgkmcnt(0)
    s_cbranch_scc1 C_CL1
    s_branch C_CD
C_P2:
    s_setprio 2
    ds_read_b128 v[32:35], v8 offset:1504
    ds_read_b128 v[36:39], v8 offset:2016
    ds_read_b128 v[40:43], v8 offset:1632
    s_waitcnt lgkmcnt(2)
    v_mfma_f32_16x16x32_bf16 v[116:119], v[152:155], v[32:35], 0
    v_mfma_f32_16x16x32_bf16 v[160:163], v[156:159], v[32:35], 0
    v_mfma_f32_16x16x32_bf16 v[28:31], v[52:55], v[32:35], 0
    v_mfma_f32_16x16x32_bf16 v[20:23], v[48:51], v[32:35], 0
    ds_read_b128 v[44:47], v8 offset:1760
    s_waitcnt lgkmcnt(2)
    v_mfma_f32_16x16x32_bf16 v[120:123], v[152:155], v[36:39], 0
    v_mfma_f32_16x16x32_bf16 v[124:127], v[156:159], v[36:39], 0
    v_mfma_f32_16x16x32_bf16 v[28:31], v[84:87], v[36:39], v[28:31]
    v_mfma_f32_16x16x32_bf16 v[20:23], v[80:83], v[36:39], v[20:23]
    v_mfma_f32_16x16x32_bf16 v[24:27], v[52:55], v[36:39], 0
    v_mfma_f32_16x16x32_bf16 v[16:19], v[48:51], v[36:39], 0
    v_cvt_pk_bf16_f32 v116, v116, v117
    v_cvt_pk_bf16_f32 v117, v118, v119
    ds_write_b64 v4, v[116:117] offset:2856
    v_cvt_pk_bf16_f32 v160, v160, v161
    v_cvt_pk_bf16_f32 v161, v162, v163
    ds_write_b64 v4, v[160:161] offset:6312
    ds_read_b128 v[32:35], v8 offset:1888
    s_waitcnt lgkmcnt(4)
    v_mfma_f32_16x16x32_bf16 v[28:31], v[60:63], v[40:43], v[28:31]
    v_mfma_f32_16x16x32_bf16 v[20:23], v[56:59], v[40:43], v[20:23]
    v_cvt_pk_bf16_f32 v120, v120, v121
    v_cvt_pk_bf16_f32 v121, v122, v123
    ds_write_b64 v4, v[120:121] offset:2312
    v_cvt_pk_bf16_f32 v124, v124, v125
    v_cvt_pk_bf16_f32 v125, v126, v127
    ds_write_b64 v4, v[124:125] offset:5768
    s_mov_b64 exec, 0x1
    ds_write_b32 v166, v166 offset:8
    s_mov_b64 exec, -1
    s_setprio 1
    ds_read_b128 v[36:39], v8 offset:2144
    ds_read_b64 v[116:117], v7 offset:1088
    ds_read_b64 v[118:119], v7 offset:1096
    ds_read_b64 v[120:121], v10 offset:5120
    ds_read_b64 v[122:123], v10 offset:5128
    ds_read_b64 v[124:125], v10 offset:5184
    ds_read_b64 v[126:127], v10 offset:5192
    ds_read_b64 v[160:161], v2 offset:512
    ds_read_b64 v[162:163], v2
    s_cmp_ge_u32 s2, 128
    s_cbranch_scc1 C_NX2
    s_mov_b32 m0, s58
    s_mov_b64 exec, s[56:57]
    global_load_lds_dwordx4 v5, s[72:73]
    s_add_u32 m0, s58, 896
    s_nop 0
    global_load_lds_dwordx4 v6, s[72:73]
    s_add_u32 m0, s58, 1792
    s_mov_b64 exec, 0x3f
    global_load_lds_dwordx4 v3, s[74:75]
    s_mov_b64 exec, -1
C_NX2:
    s_waitcnt lgkmcnt(15)
    v_mfma_f32_16x16x32_bf16 v[28:31], v[68:71], v[44:47], v[28:31]
    v_mfma_f32_16x16x32_bf16 v[20:23], v[64:67], v[44:47], v[20:23]
    ds_read_b128 v[40:43], v8 offset:2272
    s_waitcnt lgkmcnt(13)
    v_mfma_f32_16x16x32_bf16 v[28:31], v[76:79], v[32:35], v[28:31]
    v_mfma_f32_16x16x32_bf16 v[20:23], v[72:75], v[32:35], v[20:23]
    ds_read_b128 v[152:155], v8 offset:2400
    s_waitcnt lgkmcnt(2)
    v_and_b32 v48, 0xffff0000, v161
    v_lshlrev_b32 v49, 16, v161
    v_and_b32 v50, 0xffff0000, v160
    v_lshlrev_b32 v51, 16, v160
    v_mul_f32 v48, v48, v164
    v_mul_f32 v49, v49, v164
    v_mul_f32 v50, v50, v164
    v_mul_f32 v51, v51, v164
    v_cvt_pk_bf16_f32 v49, v48, v49
    v_lshlrev_b32 v48, 16, v49
    v_and_b32 v49, 0xffff0000, v49
    v_cvt_pk_bf16_f32 v51, v50, v51
    v_lshlrev_b32 v50, 16, v51
    v_and_b32 v51, 0xffff0000, v51
    v_and_b32 v52, 0xffff0000, v163
    v_lshlrev_b32 v53, 16, v163
    v_and_b32 v54, 0xffff0000, v162
    v_lshlrev_b32 v55, 16, v162
    v_mul_f32 v52, v52, v164
    v_mul_f32 v53, v53, v164
    v_mul_f32 v54, v54, v164
    v_mul_f32 v55, v55, v164
    v_cvt_pk_bf16_f32 v53, v52, v53
    v_lshlrev_b32 v52, 16, v53
    v_and_b32 v53, 0xffff0000, v53
    v_cvt_pk_bf16_f32 v55, v54, v55
    v_lshlrev_b32 v54, 16, v55
    v_and_b32 v55, 0xffff0000, v55
    v_mfma_f32_16x16x32_bf16 v[28:31], v[92:95], v[36:39], v[28:31]
    v_mfma_f32_16x16x32_bf16 v[20:23], v[88:91], v[36:39], v[20:23]
    v_mfma_f32_16x16x32_bf16 v[24:27], v[60:63], v[36:39], v[24:27]
    v_mfma_f32_16x16x32_bf16 v[16:19], v[56:59], v[36:39], v[16:19]
    ds_read_b128 v[156:159], v8 offset:2528
    s_waitcnt lgkmcnt(2)
    v_mfma_f32_16x16x32_bf16 v[28:31], v[100:103], v[40:43], v[28:31]
    v_mfma_f32_16x16x32_bf16 v[20:23], v[96:99], v[40:43], v[20:23]
    v_mfma_f32_16x16x32_bf16 v[24:27], v[68:71], v[40:43], v[24:27]
    v_mfma_f32_16x16x32_bf16 v[16:19], v[64:67], v[40:43], v[16:19]
    ds_read_b128 v[44:47], v8 offset:2656
    s_waitcnt lgkmcnt(2)
    v_mfma_f32_16x16x32_bf16 v[28:31], v[108:111], v[152:155], v[28:31]
    v_mfma_f32_16x16x32_bf16 v[20:23], v[104:107], v[152:155], v[20:23]
    v_mfma_f32_16x16x32_bf16 v[24:27], v[76:79], v[152:155], v[24:27]
    v_mfma_f32_16x16x32_bf16 v[16:19], v[72:75], v[152:155], v[16:19]
    ds_read_b128 v[32:35], v8 offset:2784
    s_waitcnt lgkmcnt(2)
    v_mfma_f32_16x16x32_bf16 v[20:23], v[112:115], v[156:159], v[20:23]
    v_mfma_f32_16x16x32_bf16 v[24:27], v[84:87], v[156:159], v[24:27]
    v_mfma_f32_16x16x32_bf16 v[16:19], v[80:83], v[156:159], v[16:19]
    s_mov_b32 exec_lo, 0xc000c000
    s_mov_b32 exec_hi, 0xc000c000
    ds_write_b128 v165, v[28:31] offset:384
    ds_write_b32 v166, v166 offset:72
    s_mov_b64 exec, -1
    ds_read_b96 v[60:62], v166
    ds_read_b128 v[36:39], v8 offset:2912
    s_waitcnt lgkmcnt(5)
    v_mfma_f32_16x16x32_bf16 v[24:27], v[92:95], v[44:47], v[24:27]
    v_mfma_f32_16x16x32_bf16 v[16:19], v[88:91], v[44:47], v[16:19]
    s_waitcnt lgkmcnt(1)
C_FL2:
    v_min3_u32 v60, v60, v61, v62
    v_cmp_eq_u32 vcc, 0, v60
    s_nop 4
    s_cbranch_vccz C_FD2
    ds_read_b96 v[60:62], v166
    s_sub_u32 s60, s60, 1
    s_cmp_gt_i32 s60, 0
    s_waitcnt lgkmcnt(0)
    s_cbranch_scc1 C_FL2
C_FD2:
    ds_read_b128 v[68:71], v8 offset:3040
    v_mfma_f32_16x16x32_bf16 v[24:27], v[100:103], v[32:35], v[24:27]
    v_mfma_f32_16x16x32_bf16 v[16:19], v[96:99], v[32:35], v[16:19]
    ds_read_b128 v[64:67], v8 offset:3552
    s_waitcnt lgkmcnt(2)
    v_mfma_f32_16x16x32_bf16 v[24:27], v[108:111], v[36:39], v[24:27]
    v_mfma_f32_16x16x32_bf16 v[16:19], v[104:107], v[36:39], v[16:19]
    ds_read_b128 v[40:43], v8 offset:4064
    ds_read_b64_tr_b16 v[76:77], v13 offset:6912
    ds_read_b64_tr_b16 v[78:79], v14 offset:6912
    ds_read_b64_tr_b16 v[72:73], v13 offset:7456
    ds_read_b64_tr_b16 v[74:75], v14 offset:7456
    s_waitcnt lgkmcnt(6)
    v_mfma_f32_16x16x32_bf16 v[16:19], v[112:115], v[68:71], v[16:19]
    ds_read_b64_tr_b16 v[152:153], v11 offset:0
    ds_read_b64_tr_b16 v[154:155], v12 offset:0
    s_waitcnt lgkmcnt(7)
    v_mfma_f32_16x16x32_bf16 v[20:23], v[116:119], v[64:67], v[20:23]
    ds_read_b64_tr_b16 v[84:85], v11 offset:272
    ds_read_b64_tr_b16 v[86:87], v12 offset:272
    s_waitcnt lgkmcnt(8)
    v_mfma_f32_16x16x32_bf16 v[16:19], v[116:119], v[40:43], v[16:19]
    ds_read_b64_tr_b16 v[80:81], v11 offset:544
    ds_read_b64_tr_b16 v[82:83], v12 offset:544
    s_waitcnt lgkmcnt(8)
    v_mfma_f32_16x16x32_bf16 v[20:23], v[76:79], v[124:127], v[20:23]
    v_mfma_f32_16x16x32_bf16 v[16:19], v[76:79], v[120:123], v[16:19]
    ds_read_b64_tr_b16 v[156:157], v11 offset:816
    ds_read_b64_tr_b16 v[158:159], v12 offset:816
    s_waitcnt lgkmcnt(8)
    v_mfma_f32_16x16x32_bf16 v[20:23], v[72:75], v[120:123], v[20:23]
    ds_read_b64_tr_b16 v[92:93], v11 offset:1088
    ds_read_b64_tr_b16 v[94:95], v12 offset:1088
    s_waitcnt lgkmcnt(8)
    v_mfma_f32_16x16x32_bf16 v[16:19], v[152:155], v[148:151], v[16:19]
    ds_read_b64_tr_b16 v[88:89], v11 offset:1360
    ds_read_b64_tr_b16 v[90:91], v12 offset:1360
    s_waitcnt lgkmcnt(8)
    v_mfma_f32_16x16x32_bf16 v[16:19], v[84:87], v[144:147], v[16:19]
    ds_read_b64_tr_b16 v[44:45], v11 offset:1632
    ds_read_b64_tr_b16 v[46:47], v12 offset:1632
    s_waitcnt lgkmcnt(8)
    v_mfma_f32_16x16x32_bf16 v[20:23], v[80:83], v[148:151], v[20:23]
    v_mfma_f32_16x16x32_bf16 v[16:19], v[80:83], v[140:143], v[16:19]
    ds_read_b64_tr_b16 v[100:101], v11 offset:1904
    ds_read_b64_tr_b16 v[102:103], v12 offset:1904
    s_waitcnt lgkmcnt(8)
    v_mfma_f32_16x16x32_bf16 v[20:23], v[156:159], v[144:147], v[20:23]
    v_mfma_f32_16x16x32_bf16 v[16:19], v[156:159], v[136:139], v[16:19]
    s_waitcnt lgkmcnt(6)
    v_mfma_f32_16x16x32_bf16 v[20:23], v[92:95], v[140:143], v[20:23]
    v_mfma_f32_16x16x32_bf16 v[16:19], v[92:95], v[132:135], v[16:19]
    s_waitcnt lgkmcnt(4)
    v_mfma_f32_16x16x32_bf16 v[20:23], v[88:91], v[136:139], v[20:23]
    v_mfma_f32_16x16x32_bf16 v[16:19], v[88:91], v[128:131], v[16:19]
    ds_read_b32 v60, v166 offset:68
    ds_read_b128 v[56:59], v165 offset:256
    s_waitcnt lgkmcnt(4)
    v_mfma_f32_16x16x32_bf16 v[20:23], v[44:47], v[132:135], v[20:23]
    s_waitcnt lgkmcnt(2)
    v_mfma_f32_16x16x32_bf16 v[20:23], v[100:103], v[128:131], v[20:23]
    s_setprio 0
    s_waitcnt lgkmcnt(0)
C_CL2:
    v_cmp_eq_u32 vcc, 0, v60
    s_nop 4
    s_cbranch_vccz C_CD
    ds_read_b32 v60, v166 offset:68
    ds_read_b128 v[56:59], v165 offset:256
    s_sub_u32 s60, s60, 1
    s_cmp_gt_i32 s60, 0
    s_waitcnt lgkmcnt(0)
    s_cbranch_scc1 C_CL2
    s_branch C_CD
C_P3:
    s_setprio 1
    ds_read_b128 v[32:35], v8 offset:480
    ds_read_b128 v[36:39], v8 offset:608
    ds_read_b128 v[40:43], v8 offset:736
    ds_read_b64 v[160:161], v2 offset:512
    ds_read_b64 v[162:163], v2
    s_waitcnt lgkmcnt(4)
    v_mfma_f32_16x16x32_bf16 v[28:31], v[52:55], v[32:35], 0
    v_mfma_f32_16x16x32_bf16 v[20:23], v[48:51], v[32:35], 0
    ds_read_b128 v[44:47], v8 offset:864
    s_waitcnt lgkmcnt(4)
    v_mfma_f32_16x16x32_bf16 v[28:31], v[60:63], v[36:39], v[28:31]
    v_mfma_f32_16x16x32_bf16 v[20:23], v[56:59], v[36:39], v[20:23]
    s_cmp_lg_u32 s38, 9
    s_cbranch_scc1 C_NPL0
    s_cmp_ge_u32 s2, 96
    s_cselect_b32 s52, 16, 8
    v_lshrrev_b32 v9, 1, v3
    v_writelane_b32 v9, s52, 3
    s_and_b32 s52, s2, 31
    s_lshl_b32 s52, s52, 7
    v_add_u32 v9, s52, v9
    s_mov_b64 exec, 0xf
    buffer_load_dword v10, v9, s[40:43], 0 offen offset:2048 sc1
    s_mov_b64 exec, -1
C_NPL0:
    s_cmp_ge_u32 s2, 128
    s_cbranch_scc1 C_NX3
    s_mov_b32 m0, s58
    s_mov_b64 exec, s[56:57]
    global_load_lds_dwordx4 v5, s[72:73]
    s_add_u32 m0, s58, 896
    s_nop 0
    global_load_lds_dwordx4 v6, s[72:73]
    s_add_u32 m0, s58, 1792
    s_mov_b64 exec, 0x3f
    global_load_lds_dwordx4 v3, s[74:75]
    s_mov_b64 exec, -1
C_NX3:
    ds_read_b128 v[32:35], v8 offset:992
    s_waitcnt lgkmcnt(4)
    v_mfma_f32_16x16x32_bf16 v[28:31], v[68:71], v[40:43], v[28:31]
    v_mfma_f32_16x16x32_bf16 v[20:23], v[64:67], v[40:43], v[20:23]
    ds_read_b128 v[36:39], v8 offset:1120
    s_waitcnt lgkmcnt(2)
    v_mfma_f32_16x16x32_bf16 v[28:31], v[76:79], v[44:47], v[28:31]
    v_mfma_f32_16x16x32_bf16 v[20:23], v[72:75], v[44:47], v[20:23]
    ds_read_b128 v[40:43], v8 offset:1248
    s_waitcnt lgkmcnt(2)
    v_mfma_f32_16x16x32_bf16 v[28:31], v[84:87], v[32:35], v[28:31]
    v_mfma_f32_16x16x32_bf16 v[20:23], v[80:83], v[32:35], v[20:23]
    v_mfma_f32_16x16x32_bf16 v[24:27], v[52:55], v[32:35], 0
    v_mfma_f32_16x16x32_bf16 v[16:19], v[48:51], v[32:35], 0
    ds_read_b128 v[44:47], v8 offset:1376
    s_waitcnt lgkmcnt(2)
    v_mfma_f32_16x16x32_bf16 v[28:31], v[92:95], v[36:39], v[28:31]
    v_mfma_f32_16x16x32_bf16 v[20:23], v[88:91], v[36:39], v[20:23]
    v_mfma_f32_16x16x32_bf16 v[24:27], v[60:63], v[36:39], v[24:27]
    v_mfma_f32_16x16x32_bf16 v[16:19], v[56:59], v[36:39], v[16:19]
    ds_read_b128 v[32:35], v8 offset:1504
    v_and_b32 v48, 0xffff0000, v161
    v_lshlrev_b32 v49, 16, v161
    v_and_b32 v50, 0xffff0000, v160
    v_lshlrev_b32 v51, 16, v160
    v_mul_f32 v48, v48, v164
    v_mul_f32 v49, v49, v164
    v_mul_f32 v50, v50, v164
    v_mul_f32 v51, v51, v164
    v_cvt_pk_bf16_f32 v49, v48, v49
    v_lshlrev_b32 v48, 16, v49
    v_and_b32 v49, 0xffff0000, v49
    v_cvt_pk_bf16_f32 v51, v50, v51
    v_lshlrev_b32 v50, 16, v51
    v_and_b32 v51, 0xffff0000, v51
    v_and_b32 v52, 0xffff0000, v163
    v_lshlrev_b32 v53, 16, v163
    v_and_b32 v54, 0xffff0000, v162
    v_lshlrev_b32 v55, 16, v162
    v_mul_f32 v52, v52, v164
    v_mul_f32 v53, v53, v164
    v_mul_f32 v54, v54, v164
    v_mul_f32 v55, v55, v164
    v_cvt_pk_bf16_f32 v53, v52, v53
    v_lshlrev_b32 v52, 16, v53
    v_and_b32 v53, 0xffff0000, v53
    v_cvt_pk_bf16_f32 v55, v54, v55
    v_lshlrev_b32 v54, 16, v55
    v_and_b32 v55, 0xffff0000, v55
    s_waitcnt lgkmcnt(2)
    v_mfma_f32_16x16x32_bf16 v[28:31], v[100:103], v[40:43], v[28:31]
    v_mfma_f32_16x16x32_bf16 v[20:23], v[96:99], v[40:43], v[20:23]
    v_mfma_f32_16x16x32_bf16 v[24:27], v[68:71], v[40:43], v[24:27]
    v_mfma_f32_16x16x32_bf16 v[16:19], v[64:67], v[40:43], v[16:19]
    ds_read_b128 v[36:39], v8 offset:1632
    s_waitcnt lgkmcnt(2)
    v_mfma_f32_16x16x32_bf16 v[28:31], v[108:111], v[44:47], v[28:31]
    v_mfma_f32_16x16x32_bf16 v[20:23], v[104:107], v[44:47], v[20:23]
    v_mfma_f32_16x16x32_bf16 v[24:27], v[76:79], v[44:47], v[24:27]
    v_mfma_f32_16x16x32_bf16 v[16:19], v[72:75], v[44:47], v[16:19]
    ds_read_b128 v[68:71], v8 offset:1760
    s_waitcnt lgkmcnt(2)
    v_mfma_f32_16x16x32_bf16 v[20:23], v[112:115], v[32:35], v[20:23]
    v_mfma_f32_16x16x32_bf16 v[24:27], v[84:87], v[32:35], v[24:27]
    v_mfma_f32_16x16x32_bf16 v[16:19], v[80:83], v[32:35], v[16:19]
    ds_read_b96 v[60:62], v166
    ds_read_b128 v[64:67], v8 offset:1888
    s_waitcnt lgkmcnt(3)
    v_mfma_f32_16x16x32_bf16 v[24:27], v[92:95], v[36:39], v[24:27]
    v_mfma_f32_16x16x32_bf16 v[16:19], v[88:91], v[36:39], v[16:19]
    s_waitcnt lgkmcnt(1)
C_FL3:
    v_min3_u32 v60, v60, v61, v62
    v_cmp_eq_u32 vcc, 0, v60
    s_nop 4
    s_cbranch_vccz C_FD3
    ds_read_b96 v[60:62], v166
    s_sub_u32 s60, s60, 1
    s_cmp_gt_i32 s60, 0
    s_waitcnt lgkmcnt(0)
    s_cbranch_scc1 C_FL3
C_FD3:
    ds_read_b128 v[40:43], v8 offset:2016
    v_mfma_f32_16x16x32_bf16 v[24:27], v[100:103], v[68:71], v[24:27]
    v_mfma_f32_16x16x32_bf16 v[16:19], v[96:99], v[68:71], v[16:19]
    ds_read_b128 v[76:79], v8 offset:2528
    s_waitcnt lgkmcnt(2)
    v_mfma_f32_16x16x32_bf16 v[24:27], v[108:111], v[64:67], v[24:27]
    v_mfma_f32_16x16x32_bf16 v[16:19], v[104:107], v[64:67], v[16:19]
    ds_read_b128 v[72:75], v8 offset:3040
    ds_read_b64_tr_b16 v[44:45], v13 offset:6912
    ds_read_b64_tr_b16 v[46:47], v14 offset:6912
    ds_read_b64_tr_b16 v[84:85], v13 offset:7456
    ds_read_b64_tr_b16 v[86:87], v14 offset:7456
    s_waitcnt lgkmcnt(6)
    v_mfma_f32_16x16x32_bf16 v[16:19], v[112:115], v[40:43], v[16:19]
    ds_read_b64_tr_b16 v[80:81], v13 offset:8000
    ds_read_b64_tr_b16 v[82:83], v14 offset:8000
    s_waitcnt lgkmcnt(7)
    v_mfma_f32_16x16x32_bf16 v[20:23], v[116:119], v[76:79], v[20:23]
    ds_read_b64_tr_b16 v[32:33], v13 offset:8544
    ds_read_b64_tr_b16 v[34:35], v14 offset:8544
    s_waitcnt lgkmcnt(8)
    v_mfma_f32_16x16x32_bf16 v[16:19], v[116:119], v[72:75], v[16:19]
    ds_read_b64_tr_b16 v[92:93], v11 offset:1088
    ds_read_b64_tr_b16 v[94:95], v12 offset:1088
    s_waitcnt lgkmcnt(8)
    v_mfma_f32_16x16x32_bf16 v[20:23], v[44:47], v[124:127], v[20:23]
    v_mfma_f32_16x16x32_bf16 v[16:19], v[44:47], v[120:123], v[16:19]
    ds_read_b64_tr_b16 v[88:89], v11 offset:1360
    ds_read_b64_tr_b16 v[90:91], v12 offset:1360
    s_waitcnt lgkmcnt(8)
    v_mfma_f32_16x16x32_bf16 v[20:23], v[84:87], v[120:123], v[20:23]
    v_mfma_f32_16x16x32_bf16 v[16:19], v[84:87], v[156:159], v[16:19]
    ds_read_b64_tr_b16 v[36:37], v11 offset:1632
    ds_read_b64_tr_b16 v[38:39], v12 offset:1632
    s_waitcnt lgkmcnt(8)
    v_mfma_f32_16x16x32_bf16 v[20:23], v[80:83], v[156:159], v[20:23]
    v_mfma_f32_16x16x32_bf16 v[16:19], v[80:83], v[152:155], v[16:19]
    ds_read_b64_tr_b16 v[100:101], v11 offset:1904
    ds_read_b64_tr_b16 v[102:103], v12 offset:1904
    s_waitcnt lgkmcnt(8)
    v_mfma_f32_16x16x32_bf16 v[20:23], v[32:35], v[152:155], v[20:23]
    ds_read_b64_tr_b16 v[96:97], v11 offset:2176
    ds_read_b64_tr_b16 v[98:99], v12 offset:2176
    s_waitcnt lgkmcnt(8)
    v_mfma_f32_16x16x32_bf16 v[16:19], v[92:95], v[148:151], v[16:19]
    ds_read_b64_tr_b16 v[68:69], v11 offset:2448
    ds_read_b64_tr_b16 v[70:71], v12 offset:2448
    s_cmp_lg_u32 s38, 9
    s_cbranch_scc1 C_NPL
    s_mov_b64 exec, 0xf
    s_waitcnt vmcnt(3)
    s_cmp_lt_u32 s2, 128
    s_cbranch_scc1 C_NPW
    s_waitcnt vmcnt(0)
C_NPW:
    v_xor_b32 v5, s39, v10
    v_and_b32 v5, 0xffffdfff, v5
    v_cmp_ne_u32 vcc, 0, v5
    s_nop 4
    s_cbranch_vccz C_NPL2
    buffer_load_dword v4, v9, s[40:43], 0 offen offset:2048 sc1
C_NPL2:
    s_mov_b64 exec, -1
C_NPL:
    s_waitcnt lgkmcnt(8)
    v_mfma_f32_16x16x32_bf16 v[16:19], v[88:91], v[144:147], v[16:19]
    ds_read_b64_tr_b16 v[108:109], v11 offset:2720
    ds_read_b64_tr_b16 v[110:111], v12 offset:2720
    s_waitcnt lgkmcnt(8)
    v_mfma_f32_16x16x32_bf16 v[20:23], v[36:39], v[148:151], v[20:23]
    v_mfma_f32_16x16x32_bf16 v[16:19], v[36:39], v[140:143], v[16:19]
    ds_read_b64_tr_b16 v[104:105], v11 offset:2992
    ds_read_b64_tr_b16 v[106:107], v12 offset:2992
    s_waitcnt lgkmcnt(8)
    v_mfma_f32_16x16x32_bf16 v[20:23], v[100:103], v[144:147], v[20:23]
    v_mfma_f32_16x16x32_bf16 v[16:19], v[100:103], v[136:139], v[16:19]
    s_waitcnt lgkmcnt(6)
    v_mfma_f32_16x16x32_bf16 v[20:23], v[96:99], v[140:143], v[20:23]
    v_mfma_f32_16x16x32_bf16 v[16:19], v[96:99], v[132:135], v[16:19]
    s_waitcnt lgkmcnt(4)
    v_mfma_f32_16x16x32_bf16 v[20:23], v[68:71], v[136:139], v[20:23]
    v_mfma_f32_16x16x32_bf16 v[16:19], v[68:71], v[128:131], v[16:19]
    ds_read_b32 v60, v166 offset:72
    ds_read_b128 v[56:59], v165 offset:384
    s_waitcnt lgkmcnt(4)
    v_mfma_f32_16x16x32_bf16 v[20:23], v[108:111], v[132:135], v[20:23]
    s_waitcnt lgkmcnt(2)
    v_mfma_f32_16x16x32_bf16 v[20:23], v[104:107], v[128:131], v[20:23]
    s_setprio 0
    s_waitcnt lgkmcnt(0)
C_CL3:
    v_cmp_eq_u32 vcc, 0, v60
    s_nop 4
    s_cbranch_vccz C_CD
    ds_read_b32 v60, v166 offset:72
    ds_read_b128 v[56:59], v165 offset:384
    s_sub_u32 s60, s60, 1
    s_cmp_gt_i32 s60, 0
    s_waitcnt lgkmcnt(0)
    s_cbranch_scc1 C_CL3
C_CD:
    s_cmp_eq_u32 s38, 9
    s_cbranch_scc1 C_CD2
    s_waitcnt vmcnt(3)
    s_cmp_lt_u32 s2, 128
    s_cbranch_scc1 C_CD2
    s_waitcnt vmcnt(0)
C_CD2:
    s_mov_b32 exec_lo, 0x30003
    s_mov_b32 exec_hi, 0x30003
    s_nop 4
    v_pk_add_f32 v[16:17], v[16:17], v[56:57]
    v_pk_add_f32 v[18:19], v[18:19], v[58:59]
    s_mov_b64 exec, -1
C_EPI:
    s_nop 3
    s_movk_i32 s54, 0x3f80
    s_mov_b32 s55, 1.0
    v_add_f32_dpp v16, v24, v16 row_shr:2 row_mask:0xf bank_mask:0xf
    v_add_f32_dpp v17, v25, v17 row_shr:2 row_mask:0xf bank_mask:0xf
    v_add_f32_dpp v18, v26, v18 row_shr:2 row_mask:0xf bank_mask:0xf
    v_add_f32_dpp v19, v27, v19 row_shr:2 row_mask:0xf bank_mask:0xf
    v_add_f32_dpp v20, v28, v20 row_shr:2 row_mask:0xf bank_mask:0xf
    v_add_f32_dpp v21, v29, v21 row_shr:2 row_mask:0xf bank_mask:0xf
    v_add_f32_dpp v22, v30, v22 row_shr:2 row_mask:0xf bank_mask:0xf
    v_add_f32_dpp v23, v31, v23 row_shr:2 row_mask:0xf bank_mask:0xf
    v_add_f32_dpp v20, v24, v20 row_shl:14 row_mask:0xf bank_mask:0xf
    v_add_f32_dpp v21, v25, v21 row_shl:14 row_mask:0xf bank_mask:0xf
    v_add_f32_dpp v22, v26, v22 row_shl:14 row_mask:0xf bank_mask:0xf
    v_add_f32_dpp v23, v27, v23 row_shl:14 row_mask:0xf bank_mask:0xf
    v_cvt_pk_bf16_f32 v16, v16, v17
    v_cvt_pk_bf16_f32 v17, v18, v19
    v_cvt_pk_bf16_f32 v18, v20, v21
    v_cvt_pk_bf16_f32 v19, v22, v23
    v_dot2c_f32_bf16 v48, s54, v16
    v_dot2c_f32_bf16 v49, s55, v16
    v_dot2c_f32_bf16 v50, s54, v17
    v_dot2c_f32_bf16 v51, s55, v17
    v_dot2c_f32_bf16 v52, s54, v18
    v_dot2c_f32_bf16 v53, s55, v18
    v_dot2c_f32_bf16 v54, s54, v19
    v_dot2c_f32_bf16 v55, s55, v19
    v_cvt_pk_bf16_f32 v48, v48, v49
    v_cvt_pk_bf16_f32 v49, v50, v51
    ds_write_b64 v15, v[48:49] offset:0
    v_cvt_pk_bf16_f32 v52, v52, v53
    v_cvt_pk_bf16_f32 v53, v54, v55
    ds_write_b64 v15, v[52:53] offset:544
    v_mov_b32 v20, 161504
    s_cmp_lt_u32 s38, 8
    s_cbranch_scc1 C_GA
    s_cmp_lg_u32 s38, 9
    s_cbranch_scc1 C_NOGA
    s_mov_b64 exec, 0xf
    v_xor_b32 v5, s39, v10
    v_and_b32 v5, 0xffffdfff, v5
    v_cmp_ne_u32 vcc, 0, v5
    s_nop 4
    s_cbranch_vccz C_PL_K
    s_movk_i32 s60, 4000
    s_branch C_PL_W
C_PL:
    buffer_load_dword v4, v9, s[40:43], 0 offen offset:2048 sc1
C_PL_W:
    s_waitcnt vmcnt(0)
C_PL_C:
    v_xor_b32 v5, s39, v4
    v_and_b32 v5, 0xffffdfff, v5
    v_cmp_ne_u32 vcc, 0, v5
    s_nop 0
    s_and_b64 exec, exec, vcc
    s_cbranch_execz C_PL_D
    s_sub_u32 s60, s60, 1
    s_cmp_gt_i32 s60, 0
    s_sleep 2
    s_cbranch_scc1 C_PL
C_PL_D:
    s_mov_b64 exec, 0xf
    v_mov_b32 v10, v4
C_PL_K:
    v_lshrrev_b32 v9, 2, v3
    v_add_u32 v9, 161504, v9
    v_and_b32 v10, 0x2000, v10
    ds_write_b32 v9, v10
    s_mov_b64 exec, -1
    s_branch C_NOGA
C_GA:
    v_lshrrev_b32 v7, 5, v0
    v_lshlrev_b32 v7, 3, v7
    v_lshl_add_u32 v7, v0, 2, v7
    v_add_u32 v7, 48960, v7
    v_and_b32 v8, 0x1f0, v3
    v_and_b32 v9, 32, v1
    v_lshl_add_u32 v8, v9, 8, v8
    s_lshl_b32 s52, s2, 6
    s_lshl_b32 s53, s38, 9
    s_xor_b32 s52, s52, s53
    s_and_b32 s53, s52, 0x180
    v_xor_b32 v8, s53, v8
    s_and_b32 s52, s52, 0x1e00
    s_lshl_b32 s53, s2, 14
    s_add_u32 s52, s52, s53
    s_add_u32 s52, s52, 2621440
    s_xor_b32 s53, s52, 0x1000
    v_mov_b32 v27, v167
    v_mov_b32 v31, v167
C_NOGA:
    s_waitcnt lgkmcnt(0)
    s_barrier
    ds_read_b128 v[16:19], v20
    s_sub_u32 s45, s38, 0
    s_cmp_ge_u32 s45, 8
    s_cbranch_scc1 C_NOST
    ds_read_b32 v24, v7 offset:0
    ds_read_b32 v25, v7 offset:17408
    ds_read_b32 v26, v7 offset:34816
    ds_read_b32 v28, v7 offset:2176
    ds_read_b32 v29, v7 offset:19584
    ds_read_b32 v30, v7 offset:36992
    s_waitcnt lgkmcnt(3)
    v_xor_b32 v8, v19, v8
    buffer_store_dwordx4 v[24:27], v8, s[40:43], s52 offen sc1
    s_waitcnt lgkmcnt(0)
    buffer_store_dwordx4 v[28:31], v8, s[40:43], s53 offen sc1
C_NOST:
    s_waitcnt lgkmcnt(0)
    v_readfirstlane_b32 s0, v16
    v_readfirstlane_b32 s1, v17
    v_readfirstlane_b32 s22, v18
    s_cmp_ge_u32 s2, 176
    s_cbranch_scc1 FFN_LATE
    s_cmp_ge_u32 s2, 128
    s_cbranch_scc1 FINAL
    v_and_b32 v7, 7, v1
    v_lshrrev_b32 v8, 3, v1
    s_mul_i32 s44, s2, 18432
    s_mul_i32 s45, s38, 96
    v_mul_u32_u24 v9, 0xe0, v7
    v_mad_u32_u24 v9, v8, 12, v9
    v_add_u32 v9, s58, v9
    v_xor_b32 v10, 1, v8
    v_mad_u32_u24 v13, v10, 12, s58
    s_lshr_b32 s47, s2, 3
    s_and_b32 s48, s2, 3
    s_lshl2_add_u32 s47, s47, s48
    s_lshl_b32 s48, s38, 3
    s_xor_b32 s47, s47, s48
    s_and_b32 s47, s47, 63
    s_lshl_b32 s47, s47, 7
    v_xor_b32 v94, s47, v3
    v_lshl_add_u32 v94, v8, 15, v94
    s_and_b32 s47, s2, 4
    s_lshl_b32 s47, s47, 11
    s_cmp_lt_u32 s38, 6
    s_cselect_b32 s48, s1, s22
    s_xor_b32 s47, s47, s48
    s_lshl_b32 s48, s38, 18
    s_add_u32 s47, s47, s48
    s_add_u32 s23, s47, 2637824
    s_lshl_b32 s48, s38, 11
    s_add_u32 s47, s47, 2621440
    v_mul_u32_u24 v84, 48, v7
    v_bfe_u32 v10, v1, 3, 1
    v_lshl_add_u32 v84, v10, 2, v84
    s_lshl_b32 s49, s69, 3
    s_add_u32 s49, s49, s71
    s_add_u32 s49, s49, 14336
    v_add_u32 v84, s49, v84
    v_mul_u32_u24 v85, 48, v1
    v_add_u32 v85, 60992, v85
    s_mov_b32 exec_lo, 0xf0000f
    s_mov_b32 exec_hi, 0xf0000f00
    v_subrev_u32 v84, 1536, v84
    s_mov_b32 exec_lo, 0xff000000
    s_mov_b32 exec_hi, 0xff0000
    v_subrev_u32 v84, 768, v84
    s_mov_b32 exec_lo, 0xff00
    s_mov_b32 exec_hi, 0xff
    v_subrev_u32 v84, 2304, v84
    s_mov_b64 exec, -1
    s_add_u32 s48, s48, 0
    v_and_b32 v10, 6, v7
    v_xor_b32 v10, v10, v8
    v_lshl_add_u32 v10, v7, 3, v10
    v_lshl_add_u32 v86, v10, 4, s48
    v_and_b32 v10, 6, v8
    v_xor_b32 v10, v10, v1
    v_lshl_add_u32 v87, v10, 4, s48
    v_mul_u32_u24 v88, 2944, v8
    v_add_u32 v88, v88, v3
    s_mul_i32 s48, s2, 24576
    s_lshl_b32 s49, s38, 7
    s_add_u32 s48, s48, s49
    s_add_u32 s48, s48, 6291456
    v_mul_u32_u24 v89, 2336, v7
    v_mad_u32_u24 v89, v8, 12, v89
    s_add_u32 s45, s45, 24576
    v_add_u32 v89, s45, v89
    v_add_u32 v10, 1536, v0
    v_add_u32 v11, 0, v0
    v_mul_u32_u24 v11, 911, v11
    v_lshrrev_b32 v11, 16, v11
    v_add_lshl_u32 v90, v10, v11, 4
    v_add_u32 v10, 2304, v0
    v_add_u32 v11, 768, v0
    v_mul_u32_u24 v11, 911, v11
    v_lshrrev_b32 v11, 16, v11
    v_add_lshl_u32 v91, v10, v11, 4
    v_lshl_add_u32 v92, v0, 4, s44
    v_bfe_u32 v10, v1, 3, 1
    v_lshl_add_u32 v10, v7, 1, v10
    s_lshl_b32 s49, s2, 4
    v_add_u32 v93, s49, v10
    v_sub_u32 v12, 0x7ff, v93
    v_lshrrev_b32 v93, 4, v1
    v_mul_u32_u24 v93, 8192, v93
    v_lshl_add_u32 v93, v10, 2, v93
    s_mul_i32 s49, s2, 64
    s_add_u32 s49, s49, 65536
    s_add_u32 s59, s49, 32768
    v_mov_b32 v51, 0
    v_mov_b32 v55, 0
    v_mov_b32 v76, 0
    v_mov_b32 v56, 0
    v_mov_b32 v57, 0
    v_mov_b32 v58, 0
    v_mov_b32 v59, 0
    v_mov_b32 v60, 0
    v_mov_b32 v61, 0
    v_mov_b32 v62, 0
    v_mov_b32 v63, 0
    s_lshl_b32 s50, s2, 6
    s_lshl_b32 s51, s38, 2
    s_add_u32 s50, s50, s51
    s_add_u32 s50, s50, 8192
    s_mov_b32 s56, 0x00100001
    s_mov_b32 s57, 0x10000100
    s_mov_b32 s58, 0xffff0000
    s_waitcnt vmcnt(0)
    buffer_load_dwordx4 v[28:31], v94, s[40:43], s47 offen sc1
    buffer_load_dwordx4 v[32:35], v94, s[40:43], s23 offen sc1
    ds_read_b32 v24, v13 offset:1792
    ds_read_b32 v25, v13 offset:1796
    ds_read_b32 v26, v13 offset:1800
    ds_read2_b32 v[16:17], v9 offset0:0 offset1:1
    ds_read2_b32 v[18:19], v9 offset0:2 offset1:28
    ds_read2_b32 v[20:21], v9 offset0:29 offset1:30
    s_waitcnt lgkmcnt(0)
    v_dot2c_f32_bf16 v76, 0x3f803f80, v24
    v_dot2c_f32_bf16 v76, 0x3f803f80, v25
    v_dot2c_f32_bf16 v76, 0x3f803f80, v26
    v_lshlrev_b32 v36, 16, v16
    v_and_b32 v37, 0xffff0000, v16
    v_lshlrev_b32 v42, 16, v19
    v_and_b32 v43, 0xffff0000, v19
    v_lshlrev_b32 v38, 16, v17
    v_and_b32 v39, 0xffff0000, v17
    v_lshlrev_b32 v44, 16, v20
    v_and_b32 v45, 0xffff0000, v20
    v_lshlrev_b32 v40, 16, v18
    v_and_b32 v41, 0xffff0000, v18
    v_lshlrev_b32 v46, 16, v21
    v_and_b32 v47, 0xffff0000, v21
    v_mov_b32 v77, v76
    s_nop 1
    v_permlane16_swap_b32 v76, v77
    v_add_f32 v76, v76, v77
    v_mov_b32 v77, v76
    s_nop 1
    v_permlane32_swap_b32 v76, v77
    v_add_f32 v76, v76, v77
    s_mov_b32 exec_lo, 0xf00f0
    s_mov_b32 exec_hi, 0xf00f000
    ds_write2_b32 v84, v76, v76 offset0:0 offset1:96
    s_mov_b32 exec_lo, 0xf0f0f0f
    s_mov_b32 exec_hi, 0xf0f0f0f
    v_mov_b32 v24, 0x3f803f80
    v_mov_b32 v25, 0x3f803f80
    v_mov_b32 v26, 0x3f803f80
    s_mov_b32 exec_lo, 0x11111111
    s_mov_b32 exec_hi, 0x11111111
    v_mov_b32 v56, v24
    v_mov_b32 v57, v25
    v_mov_b32 v58, v26
    s_mov_b32 exec_lo, 0x22222222
    s_mov_b32 exec_hi, 0x22222222
    v_mov_b32 v60, v24
    v_mov_b32 v61, v25
    v_mov_b32 v62, v26
    s_mov_b64 exec, -1
    s_movk_i32 s60, 4000
    s_branch L_YP_W
L_YP:
    buffer_load_dwordx4 v[28:31], v94, s[40:43], s47 offen sc1
    buffer_load_dwordx4 v[32:35], v94, s[40:43], s23 offen sc1
L_YP_W:
    s_waitcnt vmcnt(0)
L_YP_C:
    v_xor_b32 v10, v167, v31
    v_xor_b32 v11, v167, v35
    v_or_b32 v10, v10, v11
    v_cmp_ne_u32 vcc, 0, v10
    s_nop 0
    s_and_b64 exec, exec, vcc
    s_cbranch_execz L_YP_D
    s_wqm_b64 exec, exec
    s_sub_u32 s60, s60, 1
    s_cmp_gt_i32 s60, 0
    s_sleep 1
    s_cbranch_scc1 L_YP
L_YP_D:
    s_mov_b64 exec, -1
    v_dot2c_f32_bf16 v36, s54, v28
    v_dot2c_f32_bf16 v37, s54, v29
    v_dot2c_f32_bf16 v38, s54, v30
    v_dot2c_f32_bf16 v39, s54, v34
    v_dot2c_f32_bf16 v40, s54, v32
    v_dot2c_f32_bf16 v41, s54, v33
    v_dot2c_f32_bf16 v42, s55, v28
    v_dot2c_f32_bf16 v43, s55, v29
    v_dot2c_f32_bf16 v44, s55, v30
    v_dot2c_f32_bf16 v45, s55, v34
    v_cvt_pk_bf16_f32 v48, v36, v37
    v_dot2c_f32_bf16 v46, s55, v32
    v_cvt_pk_bf16_f32 v49, v38, v39
    v_dot2c_f32_bf16 v47, s55, v33
    v_cvt_pk_bf16_f32 v50, v40, v41
    v_cvt_pk_bf16_f32 v52, v42, v43
    v_cvt_pk_bf16_f32 v53, v44, v45
    v_mfma_f32_16x16x32_bf16 v[68:71], v[48:51], v[48:51], 0
    v_cvt_pk_bf16_f32 v54, v46, v47
    v_mfma_f32_16x16x32_bf16 v[64:67], v[56:59], v[48:51], 0
    s_nop 0
    v_mfma_f32_16x16x32_bf16 v[64:67], v[60:63], v[52:55], v[64:67]
    v_mfma_f32_16x16x32_bf16 v[72:75], v[52:55], v[52:55], 0
    v_lshlrev_b32 v36, 16, v48
    v_and_b32 v37, 0xffff0000, v48
    v_lshlrev_b32 v38, 16, v49
    v_and_b32 v39, 0xffff0000, v49
    v_lshlrev_b32 v40, 16, v50
    v_and_b32 v41, 0xffff0000, v50
    s_mov_b64 exec, s[56:57]
    v_mov_b32 v64, v68
    v_mov_b32 v65, v72
    s_lshl_b64 exec, exec, 1
    v_mov_b32 v64, v69
    v_mov_b32 v65, v73
    s_lshl_b64 exec, exec, 1
    v_mov_b32 v64, v70
    v_mov_b32 v65, v74
    s_lshl_b64 exec, exec, 1
    v_mov_b32 v64, v71
    v_mov_b32 v65, v75
    s_mov_b32 exec_lo, 0xfff0ff0f
    s_mov_b32 exec_hi, 0xf0ff0fff
    ds_write2_b32 v84, v64, v65 offset0:0 offset1:96
    s_mov_b64 exec, -1
    s_cmp_eq_u32 s38, 0
    s_cbranch_scc0 L_NP
    s_setprio 3
    v_lshlrev_b32 v42, 16, v52
    v_and_b32 v43, 0xffff0000, v52
    v_lshlrev_b32 v44, 16, v53
    v_and_b32 v45, 0xffff0000, v53
    v_lshlrev_b32 v46, 16, v54
    v_and_b32 v47, 0xffff0000, v54
    v_add_u32 v10, 1168, v89
    v_add_u32 v11, 12288, v92
L_NP:
    s_waitcnt lgkmcnt(0)
    s_barrier
    s_cbranch_scc1 L_HS
    s_setprio 1
    v_lshlrev_b32 v42, 16, v52
    v_and_b32 v43, 0xffff0000, v52
    v_lshlrev_b32 v44, 16, v53
    v_and_b32 v45, 0xffff0000, v53
    v_lshlrev_b32 v46, 16, v54
    v_and_b32 v47, 0xffff0000, v54
    v_add_u32 v10, 1168, v89
    v_add_u32 v11, 12288, v92
L_HS:
    ds_read_b128 v[52:55], v85 offset:0
    ds_read_b128 v[56:59], v85 offset:16
    ds_read_b128 v[60:63], v85 offset:17408
    ds_read_b128 v[64:67], v85 offset:17424
    ds_read_b128 v[68:71], v85 offset:34816
    ds_read_b128 v[72:75], v85 offset:34832
    s_waitcnt lgkmcnt(4)
    s_waitcnt lgkmcnt(2)
    v_pk_add_f32 v[52:53], v[52:53], v[60:61]
    v_pk_add_f32 v[54:55], v[54:55], v[62:63]
    v_pk_add_f32 v[56:57], v[56:57], v[64:65]
    v_pk_add_f32 v[58:59], v[58:59], v[66:67]
    s_waitcnt lgkmcnt(0)
    v_pk_add_f32 v[52:53], v[52:53], v[68:69]
    v_pk_add_f32 v[54:55], v[54:55], v[70:71]
    v_pk_add_f32 v[56:57], v[56:57], v[72:73]
    v_pk_add_f32 v[58:59], v[58:59], v[74:75]
    v_pk_add_f32 v[52:53], v[52:53], v[54:55]
    v_pk_add_f32 v[56:57], v[56:57], v[58:59]
    v_pk_add_f32 v[52:53], v[52:53], v[56:57]
    v_add_f32 v76, v52, v53
    v_add_f32 v78, v52, v53
    s_nop 1
    v_permlane16_swap_b32 v76, v78
    v_mov_b32 v77, v76
    v_mov_b32 v13, v78
    s_nop 0
    v_permlane32_swap_b32 v76, v77
    v_permlane32_swap_b32 v78, v13
    v_mul_f32 v76, 0x3ae38e39, v76
    v_mul_f32 v78, 0x3ae38e39, v78
    v_fma_f32 v78, -v76, v76, v78
    v_max_f32 v78, 0, v78
    v_cvt_pk_bf16_f32 v78, v76, v78
    v_and_b32 v82, 0xffff0000, v78
    v_lshlrev_b32 v80, 16, v78
    v_add_f32 v82, 0x3727c5ac, v82
    v_lshlrev_b32 v81, 16, v78
    v_cvt_pk_bf16_f32 v82, v82, v82
    v_lshlrev_b32 v82, 16, v82
    v_sqrt_f32 v82, v82
    v_fma_f32 v77, -v80, v13, v77
    v_cvt_pk_bf16_f32 v82, v82, v82
    v_lshlrev_b32 v82, 16, v82
    v_rcp_f32 v83, v82
    v_rcp_f32 v82, v82
    s_cbranch_scc0 L_NK
    v_mul_f32 v77, v77, v83
    v_cvt_pk_bf16_f32 v77, v77, v77
    v_ashrrev_i32 v76, 31, v77
    v_or_b32 v76, 0x80000000, v76
    v_xor_b32 v76, v76, v77
    v_and_or_b32 v76, v76, s58, v12
    buffer_store_dword v76, v93, s[40:43], s49 offen sc1
    buffer_store_dword v76, v93, s[40:43], s59 offen sc1
    s_setprio 1
L_NK:
    v_mov_b32_dpp v80, v80 row_ror:8 row_mask:0xf bank_mask:0xc
    v_mov_b32_dpp v81, v81 row_ror:8 row_mask:0xf bank_mask:0x3
    v_mov_b32_dpp v82, v82 row_ror:8 row_mask:0xf bank_mask:0xc
    v_mov_b32_dpp v83, v83 row_ror:8 row_mask:0xf bank_mask:0x3
    v_pk_add_f32 v[56:57], v[36:37], v[80:81] op_sel_hi:[1,0] neg_lo:[0,1] neg_hi:[0,1]
    v_pk_add_f32 v[58:59], v[38:39], v[80:81] op_sel_hi:[1,0] neg_lo:[0,1] neg_hi:[0,1]
    v_pk_add_f32 v[60:61], v[40:41], v[80:81] op_sel_hi:[1,0] neg_lo:[0,1] neg_hi:[0,1]
    v_pk_add_f32 v[62:63], v[42:43], v[80:81] op_sel:[0,1] neg_lo:[0,1] neg_hi:[0,1]
    v_pk_add_f32 v[64:65], v[44:45], v[80:81] op_sel:[0,1] neg_lo:[0,1] neg_hi:[0,1]
    v_pk_add_f32 v[66:67], v[46:47], v[80:81] op_sel:[0,1] neg_lo:[0,1] neg_hi:[0,1]
    v_cvt_pk_bf16_f32 v57, v56, v57
    v_cvt_pk_bf16_f32 v59, v58, v59
    v_cvt_pk_bf16_f32 v61, v60, v61
    v_cvt_pk_bf16_f32 v63, v62, v63
    v_cvt_pk_bf16_f32 v65, v64, v65
    v_cvt_pk_bf16_f32 v67, v66, v67
    v_lshlrev_b32 v56, 16, v57
    v_and_b32 v57, 0xffff0000, v57
    v_lshlrev_b32 v58, 16, v59
    v_and_b32 v59, 0xffff0000, v59
    v_lshlrev_b32 v60, 16, v61
    v_and_b32 v61, 0xffff0000, v61
    v_lshlrev_b32 v62, 16, v63
    v_and_b32 v63, 0xffff0000, v63
    v_lshlrev_b32 v64, 16, v65
    v_and_b32 v65, 0xffff0000, v65
    v_lshlrev_b32 v66, 16, v67
    v_and_b32 v67, 0xffff0000, v67
    v_pk_mul_f32 v[56:57], v[56:57], v[82:83] op_sel_hi:[1,0]
    v_pk_mul_f32 v[58:59], v[58:59], v[82:83] op_sel_hi:[1,0]
    v_pk_mul_f32 v[60:61], v[60:61], v[82:83] op_sel_hi:[1,0]
    v_pk_mul_f32 v[62:63], v[62:63], v[82:83] op_sel:[0,1]
    v_pk_mul_f32 v[64:65], v[64:65], v[82:83] op_sel:[0,1]
    v_pk_mul_f32 v[66:67], v[66:67], v[82:83] op_sel:[0,1]
    v_cvt_pk_bf16_f32 v28, v56, v57
    v_cvt_pk_bf16_f32 v29, v58, v59
    v_cvt_pk_bf16_f32 v30, v60, v61
    ds_write_b128 v86, v[28:31]
    v_cvt_pk_bf16_f32 v32, v62, v63
    v_cvt_pk_bf16_f32 v33, v64, v65
    v_cvt_pk_bf16_f32 v34, v66, v67
    ds_write_b128 v86, v[32:35] offset:1024
    ds_read_b128 v[56:59], v87
    ds_read_b128 v[60:63], v87 offset:1024
    s_waitcnt lgkmcnt(1)
    buffer_store_dwordx4 v[56:59], v88, s[40:43], s48 offen sc1
    s_waitcnt lgkmcnt(0)
    buffer_store_dwordx4 v[60:63], v88, s[40:43], s48 offen offset:1536 sc1
    s_setprio 0
    v_dot2c_f32_bf16 v36, s54, v28
    v_dot2c_f32_bf16 v37, s55, v28
    v_dot2c_f32_bf16 v38, s54, v29
    v_dot2c_f32_bf16 v39, s55, v29
    v_dot2c_f32_bf16 v40, s54, v30
    v_dot2c_f32_bf16 v41, s55, v30
    v_dot2c_f32_bf16 v42, s54, v32
    v_dot2c_f32_bf16 v43, s55, v32
    v_dot2c_f32_bf16 v44, s54, v33
    v_dot2c_f32_bf16 v45, s55, v33
    v_dot2c_f32_bf16 v46, s54, v34
    v_dot2c_f32_bf16 v47, s55, v34
    v_cvt_pk_bf16_f32 v48, v36, v37
    v_cvt_pk_bf16_f32 v49, v38, v39
    v_cvt_pk_bf16_f32 v50, v40, v41
    v_cvt_pk_bf16_f32 v51, v42, v43
    v_cvt_pk_bf16_f32 v52, v44, v45
    v_cvt_pk_bf16_f32 v53, v46, v47
    ds_write2_b32 v89, v48, v49 offset0:0 offset1:1
    ds_write_b32 v89, v50 offset:8
    ds_write2_b32 v10, v51, v52 offset0:0 offset1:1
    ds_write_b32 v10, v53 offset:8
    s_waitcnt lgkmcnt(0)
    s_barrier
    ds_read_b128 v[16:19], v90
    ds_read_b128 v[20:23], v91
    v_mov_b32 v10, 0
    s_waitcnt lgkmcnt(1)
    global_store_dwordx4 v92, v[16:19], s[32:33] sc1
    s_cmp_ge_u32 s38, 6
    s_cbranch_scc1 L_O1
    s_waitcnt lgkmcnt(0)
    global_store_dwordx4 v11, v[20:23], s[32:33] sc1
L_O1:
    s_cmp_eq_u32 s38, 11
    s_cbranch_scc1 TOP8
    s_waitcnt vmcnt(0)
    s_mov_b64 exec, 0x1
    buffer_store_dword v167, v10, s[40:43], s50 offen sc1
    s_mov_b64 exec, -1
    s_branch END
FFN_DMA0:
    s_sub_u32 s58, s2, 192
    s_and_b32 s61, s58, 7
    s_lshr_b32 s59, s58, 3
    s_lshl3_add_u32 s61, s61, s59
    s_lshl_b32 s61, s61, 1
    s_mov_b32 s59, 8
    s_mov_b32 s57, 73728
    s_add_u32 s56, s38, 1
    s_bfe_u32 s50, s56, 0x10003
    s_and_b32 s51, s56, 1
    s_bfe_u32 s52, s56, 0x10001
    s_mul_i32 s52, s52, 36
    s_add_u32 s52, s52, s51
    s_mul_i32 s48, s52, 73728
    s_lshl_b32 s53, s61, 6
    s_add_u32 s48, s48, s53
    s_lshl_b32 s49, s52, 10
    s_mul_i32 s53, s50, 73728
    s_add_u32 s49, s49, s53
    s_lshl_b32 s51, s51, 1
    s_lshl_b32 s53, s50, 2
    s_or_b32 s51, s51, s53
    v_bfe_u32 v2, v1, 4, 1
    v_and_b32 v4, 7, v1
    v_xor_b32 v2, v2, v4
    v_xor_b32 v2, s51, v2
    v_lshrrev_b32 v4, 3, v1
    v_mul_u32_u24 v4, 0x2400, v4
    v_lshl_add_u32 v2, v2, 4, v4
    s_mov_b32 s46, 5308416
    s_mov_b32 s47, 0x00020000
    s_waitcnt lgkmcnt(0)
    s_cmp_eq_u32 s50, 0
    s_cselect_b32 s44, s26, s28
    s_cselect_b32 s45, s27, s29
    s_mov_b32 s40, s36
    s_mov_b32 s41, s37
    s_barrier
    s_sub_u32 s51, s38, 3
    s_cmp_ge_u32 s51, 8
    s_cbranch_scc1 F_B0
    s_add_u32 m0, s49, 0
    s_add_u32 s53, s48, 0
    buffer_load_dwordx4 v2, s[44:47], s53 offen lds
    s_add_u32 m0, s49, 2048
    s_add_u32 s53, s48, 147456
    buffer_load_dwordx4 v2, s[44:47], s53 offen lds
    s_add_u32 m0, s49, 4096
    s_add_u32 s53, s48, 294912
    buffer_load_dwordx4 v2, s[44:47], s53 offen lds
    s_barrier
    s_branch F_B2
FFN_LATE:
    s_and_b32 s61, s2, 7
    s_lshl_b32 s61, s61, 1
    s_bitcmp0_b32 s2, 3
    s_addc_u32 s61, s61, 128
    s_sub_u32 s58, s2, 112
    s_mov_b32 s59, 4
    s_mov_b32 s57, 0
    v_mov_b32 v32, 0
    v_mov_b32 v33, 0
    v_mov_b32 v34, 0
    v_mov_b32 v35, 0
    v_mov_b32 v36, 0
    v_mov_b32 v37, 0
    v_mov_b32 v38, 0
    v_mov_b32 v39, 0
    v_mov_b32 v40, 0
    v_mov_b32 v41, 0
    v_mov_b32 v42, 0
    v_mov_b32 v43, 0
    v_mov_b32 v44, 0
    v_mov_b32 v45, 0
    v_mov_b32 v46, 0
    v_mov_b32 v47, 0
    s_sub_u32 s51, s38, 3
    s_cmp_ge_u32 s51, 8
    s_cbranch_scc1 F_B0
    s_add_u32 s56, s38, 1
    s_bfe_u32 s50, s56, 0x10003
    s_and_b32 s51, s56, 1
    s_bfe_u32 s52, s56, 0x10001
    s_lshl1_add_u32 s52, s50, s52
    s_mul_i32 s52, s52, 18
    s_add_u32 s52, s52, s51
    s_mul_i32 s48, s52, 73728
    s_lshl_b32 s53, s61, 6
    s_add_u32 s48, s48, s53
    s_lshl_b32 m0, s52, 10
    s_lshl_b32 s51, s51, 1
    s_add_u32 s44, s26, s48
    s_addc_u32 s45, s27, 0
    s_add_u32 s46, s28, s48
    s_addc_u32 s47, s29, 0
    v_bfe_u32 v2, v1, 4, 1
    v_xor_b32 v2, v2, v1
    v_xor_b32 v2, s51, v2
    v_and_b32 v2, 3, v2
    v_lshrrev_b32 v4, 3, v1
    v_mul_u32_u24 v4, 0x2400, v4
    v_lshl_add_u32 v2, v2, 4, v4
    v_mov_b32 v4, s44
    v_mov_b32 v5, s45
    s_mov_b32 exec_lo, 0xf0f0f0f0
    s_mov_b32 exec_hi, 0xf0f0f0f0
    v_mov_b32 v4, s46
    v_mov_b32 v5, s47
    s_mov_b64 exec, -1
    v_add_co_u32 v4, vcc, v4, v2
    s_nop 1
    v_addc_co_u32 v5, vcc, 0, v5, vcc
    s_barrier
    global_load_lds_dwordx4 v[4:5], off
    v_add_co_u32 v4, vcc, 147456, v4
    s_add_u32 m0, m0, 2048
    s_nop 0
    v_addc_co_u32 v5, vcc, 0, v5, vcc
    global_load_lds_dwordx4 v[4:5], off
    v_add_co_u32 v4, vcc, 147456, v4
    s_add_u32 m0, m0, 2048
    s_nop 0
    v_addc_co_u32 v5, vcc, 0, v5, vcc
    global_load_lds_dwordx4 v[4:5], off
    v_add_co_u32 v4, vcc, 147456, v4
    s_add_u32 m0, m0, 2048
    s_nop 0
    v_addc_co_u32 v5, vcc, 0, v5, vcc
    global_load_lds_dwordx4 v[4:5], off
    v_add_co_u32 v4, vcc, 147456, v4
    s_add_u32 m0, m0, 2048
    s_nop 0
    v_addc_co_u32 v5, vcc, 0, v5, vcc
    global_load_lds_dwordx4 v[4:5], off
    v_add_co_u32 v4, vcc, 147456, v4
    s_add_u32 m0, m0, 2048
    s_nop 0
    v_addc_co_u32 v5, vcc, 0, v5, vcc
    global_load_lds_dwordx4 v[4:5], off
    v_add_co_u32 v4, vcc, 147456, v4
    s_add_u32 m0, m0, 2048
    s_nop 0
    v_addc_co_u32 v5, vcc, 0, v5, vcc
    global_load_lds_dwordx4 v[4:5], off
    v_add_co_u32 v4, vcc, 147456, v4
    s_add_u32 m0, m0, 2048
    s_nop 0
    v_addc_co_u32 v5, vcc, 0, v5, vcc
    global_load_lds_dwordx4 v[4:5], off
    v_add_co_u32 v4, vcc, 147456, v4
    s_add_u32 m0, m0, 2048
    s_nop 0
    v_addc_co_u32 v5, vcc, 0, v5, vcc
    global_load_lds_dwordx4 v[4:5], off
    s_branch F_W
F_L2:
    s_sub_u32 s51, s38, 3
    s_cmp_ge_u32 s51, 8
    s_cbranch_scc1 F_B0
    s_add_u32 s56, s38, 1
    s_bfe_u32 s50, s56, 0x10003
    s_and_b32 s51, s56, 1
    s_bfe_u32 s52, s56, 0x10001
    s_mul_i32 s52, s52, 36
    s_add_u32 s52, s52, s51
    s_mul_i32 s48, s52, 73728
    s_lshl_b32 s53, s61, 6
    s_add_u32 s48, s48, s53
    s_lshl_b32 s49, s52, 10
    s_mul_i32 s53, s50, 73728
    s_add_u32 s49, s49, s53
    s_lshl_b32 s51, s51, 1
    s_lshl_b32 s53, s50, 2
    s_or_b32 s51, s51, s53
    v_bfe_u32 v2, v1, 4, 1
    v_and_b32 v4, 7, v1
    v_xor_b32 v2, v2, v4
    v_xor_b32 v2, s51, v2
    v_lshrrev_b32 v4, 3, v1
    v_mul_u32_u24 v4, 0x2400, v4
    v_lshl_add_u32 v2, v2, 4, v4
    s_mov_b32 s46, 5308416
    s_mov_b32 s47, 0x00020000
    s_cmp_eq_u32 s50, 0
    s_cselect_b32 s44, s26, s28
    s_cselect_b32 s45, s27, s29
    s_barrier
    s_add_u32 m0, s49, 0
    s_add_u32 s53, s48, 0
    buffer_load_dwordx4 v2, s[44:47], s53 offen lds
    s_add_u32 m0, s49, 2048
    s_add_u32 s53, s48, 147456
    buffer_load_dwordx4 v2, s[44:47], s53 offen lds
    s_add_u32 m0, s49, 4096
    s_add_u32 s53, s48, 294912
    buffer_load_dwordx4 v2, s[44:47], s53 offen lds
F_B2:
    s_add_u32 m0, s49, 6144
    s_add_u32 s53, s48, 442368
    buffer_load_dwordx4 v2, s[44:47], s53 offen lds
    s_add_u32 m0, s49, 8192
    s_add_u32 s53, s48, 589824
    buffer_load_dwordx4 v2, s[44:47], s53 offen lds
    s_add_u32 m0, s49, 10240
    s_add_u32 s53, s48, 737280
    buffer_load_dwordx4 v2, s[44:47], s53 offen lds
    s_add_u32 m0, s49, 12288
    s_add_u32 s53, s48, 884736
    buffer_load_dwordx4 v2, s[44:47], s53 offen lds
    s_add_u32 m0, s49, 14336
    s_add_u32 s53, s48, 1032192
    buffer_load_dwordx4 v2, s[44:47], s53 offen lds
    s_add_u32 m0, s49, 16384
    s_add_u32 s53, s48, 1179648
    buffer_load_dwordx4 v2, s[44:47], s53 offen lds
    s_add_u32 m0, s49, 18432
    s_add_u32 s53, s48, 1327104
    buffer_load_dwordx4 v2, s[44:47], s53 offen lds
    s_add_u32 m0, s49, 20480
    s_add_u32 s53, s48, 1474560
    buffer_load_dwordx4 v2, s[44:47], s53 offen lds
    s_add_u32 m0, s49, 22528
    s_add_u32 s53, s48, 1622016
    buffer_load_dwordx4 v2, s[44:47], s53 offen lds
    s_add_u32 m0, s49, 24576
    s_add_u32 s53, s48, 1769472
    buffer_load_dwordx4 v2, s[44:47], s53 offen lds
    s_add_u32 m0, s49, 26624
    s_add_u32 s53, s48, 1916928
    buffer_load_dwordx4 v2, s[44:47], s53 offen lds
    s_add_u32 m0, s49, 28672
    s_add_u32 s53, s48, 2064384
    buffer_load_dwordx4 v2, s[44:47], s53 offen lds
    s_add_u32 m0, s49, 30720
    s_add_u32 s53, s48, 2211840
    buffer_load_dwordx4 v2, s[44:47], s53 offen lds
    s_add_u32 m0, s49, 32768
    s_add_u32 s53, s48, 2359296
    buffer_load_dwordx4 v2, s[44:47], s53 offen lds
    s_add_u32 m0, s49, 34816
    s_add_u32 s53, s48, 2506752
    buffer_load_dwordx4 v2, s[44:47], s53 offen lds
    s_branch F_W
FFN_DMA:
    s_setprio 0
    s_sub_u32 s58, s2, 192
    s_and_b32 s61, s58, 7
    s_lshr_b32 s59, s58, 3
    s_lshl3_add_u32 s61, s61, s59
    s_lshl_b32 s61, s61, 1
    s_mov_b32 s59, 8
    s_mov_b32 s57, 73728
    s_branch F_L2
F_B0:
    s_setprio 3
    s_sub_u32 s52, s2, 192
    s_and_b32 s53, s52, 0xffffffe7
    s_xor_b32 s54, s38, 11
    s_or_b32 s53, s53, s54
    s_cbranch_scc1 F_NM
    s_cmp_eq_u32 s52, 24
    s_cbranch_scc1 F_NM
    s_lshl_b32 s53, s52, 18
    s_cmp_eq_u32 s52, 16
    s_cselect_b32 s53, 5767168, s53
    s_add_u32 s53, s53, 16384
    s_add_u32 s54, s53, 8192
    v_mov_b32 v10, 0
    v_mov_b32 v11, 161416
    s_mov_b64 exec, 0x1
    s_mov_b32 s62, -1
    s_movk_i32 s60, 8
F_ML:
    s_xor_b32 s53, s53, 0x2000
    s_xor_b32 s54, s54, 0x2000
    buffer_store_dword v10, v10, s[40:43], s53 offen offset:0 sc1
    buffer_store_dword v10, v10, s[40:43], s54 offen offset:0 sc1
    v_add_u32 v10, 0x80, v10
    s_waitcnt vmcnt(1)
    s_memtime s[64:65]
    s_waitcnt vmcnt(0)
    s_memtime s[66:67]
    s_sub_u32 s60, s60, 1
    s_cselect_b32 s62, 0, s62
    s_waitcnt lgkmcnt(0)
    s_sub_u32 s64, s66, s64
    s_cmp_lt_u32 s64, s62
    s_movk_i32 s62, 64
    s_cbranch_scc1 F_ML
    v_mov_b32 v10, 0
    s_bitcmp1_b32 s53, 13
    s_cselect_b32 s53, 0x2000, 0
    s_movk_i32 s60, 4000
    s_mov_b32 exec_lo, 0xffffffff
    s_mov_b32 exec_hi, 0x0
    v_lshlrev_b32 v10, 7, v1
F_MT:
    ds_read_b64 v[12:13], v11
    s_sub_u32 s60, s60, 1
    s_cmp_gt_i32 s60, 0
    s_waitcnt lgkmcnt(0)
    v_readfirstlane_b32 s54, v12
    s_nop 0
    s_cselect_b32 s54, s54, 1
    s_cmp_lg_u32 s54, 1
    s_cbranch_scc1 F_MT
    v_and_b32 v13, 0xffffdfff, v13
    v_or_b32 v13, s53, v13
    buffer_store_dword v13, v10, s[40:43], s52 offen offset:2048 sc1
    s_mov_b64 exec, -1
F_NM:
    s_barrier
F_W:
    s_mov_b64 exec, -1
    v_mov_b32 v167, 161420
    ds_read_b32 v167, v167
    v_and_b32 v7, 7, v1
    v_lshrrev_b32 v8, 3, v1
    v_and_b32 v5, 15, v1
    v_lshrrev_b32 v6, 4, v1
    s_mul_i32 s52, s61, 36864
    s_mul_i32 s53, s38, 96
    s_add_u32 s52, s52, s53
    v_mul_u32_u24 v9, 0x480, v8
    v_mad_u32_u24 v9, v7, 12, v9
    v_add_u32 v9, s52, v9
    global_load_dwordx3 v[16:18], v9, s[30:31]
    v_add_u32 v9, 0x2400, v9
    global_load_dwordx3 v[20:22], v9, s[30:31]
    v_add_u32 v9, 0x2400, v9
    global_load_dwordx3 v[24:26], v9, s[30:31]
    v_add_u32 v9, 0x2400, v9
    global_load_dwordx3 v[28:30], v9, s[30:31]
    v_add_u32 v9, 0x2400, v9
    s_cmp_eq_u32 s59, 4
    s_cbranch_scc1 F_W4
    global_load_dwordx3 v[32:34], v9, s[30:31]
    v_add_u32 v9, 0x2400, v9
    global_load_dwordx3 v[36:38], v9, s[30:31]
    v_add_u32 v9, 0x2400, v9
    global_load_dwordx3 v[40:42], v9, s[30:31]
    v_add_u32 v9, 0x2400, v9
    global_load_dwordx3 v[44:46], v9, s[30:31]
F_W4:
    v_mul_u32_u24 v10, 683, v0
    v_lshrrev_b32 v10, 16, v10
    v_mul_u32_u24 v11, 0x60, v10
    v_sub_u32 v11, v0, v11
    s_mov_b32 s52, 161920
    v_lshl_add_u32 v160, v10, 2, s52
    v_and_b32 v63, 4, v10
    v_lshl_add_u32 v160, v63, 2, v160
    v_mov_b32 v63, 161492
    s_mov_b32 s52, 3144192
    v_lshl_add_u32 v161, v11, 4, s52
    v_mul_u32_u24 v162, 608, v10
    v_mad_u32_u24 v162, v11, 6, v162
    v_and_b32 v11, 1, v11
    v_mul_u32_u24 v11, 4862, v11
    v_sub_u32 v2, v162, v11
    v_add_u32 v2, 152320, v2
    v_add_u32 v162, 147456, v162
    v_add_u32 v162, v11, v162
    v_mul_u32_u24 v163, 608, v5
    v_lshl_add_u32 v163, v6, 4, v163
    v_add_u32 v163, 147456, v163
    s_lshr_b32 s52, s38, 2
    s_lshl_b32 s52, s52, 10
    s_and_b32 s53, s38, 3
    s_lshl_b32 s53, s53, 2
    s_add_u32 s52, s52, s53
    s_add_u32 s52, s52, 157184
    v_add_u32 v164, s52, v3
    v_mov_b32 v10, 0
    ds_write_b32 v164, v10
    v_add_u32 v60, 157184, v3
    v_xor_b32 v61, 0x80, v60
    v_and_b32 v10, 6, v1
    v_and_b32 v11, 9, v1
    v_lshl_add_u32 v164, v10, 7, s52
    v_lshl_add_u32 v164, v11, 1, v164
    v_and_b32 v10, 16, v1
    v_and_b32 v11, 32, v1
    v_lshl_add_u32 v164, v10, 2, v164
    v_add_u32 v164, v11, v164
    v_and_b32 v10, 1, v6
    v_mul_u32_u24 v10, 0x48, v10
    v_and_b32 v11, 1, v8
    v_add3_u32 v166, v10, v11, 2
    v_lshl_add_u32 v10, v11, 2, v10
    v_lshrrev_b32 v11, 1, v6
    v_add_u32 v165, v10, v11
    s_mul_i32 s62, s38, 6
    s_cmp_lt_u32 s58, 64
    s_cselect_b32 s53, 13, 11
    s_cselect_b32 s54, 14, 11
    v_add_u32 v165, s62, v165
    v_and_b32 v10, 3, v165
    v_lshlrev_b32 v10, s54, v10
    v_lshl_add_u32 v10, v7, 4, v10
    v_and_b32 v11, 4, v165
    v_lshl_add_u32 v10, v11, 11, v10
    v_and_b32 v165, 0xf8, v165
    v_lshl_add_u32 v165, v165, s53, v10
    v_add_u32 v166, s62, v166
    v_and_b32 v10, 3, v166
    v_lshlrev_b32 v10, s54, v10
    v_lshl_add_u32 v10, v7, 4, v10
    v_and_b32 v11, 4, v166
    v_lshl_add_u32 v10, v11, 11, v10
    v_and_b32 v166, 0xf8, v166
    v_lshl_add_u32 v166, v166, s53, v10
    s_cselect_b32 s62, 0, 1171456
    s_lshl_b32 s53, s58, 7
    s_add_u32 s62, s62, s53
    s_add_u32 s62, s62, 262144
    s_mov_b32 s63, 6291456
    s_movk_i32 s64, -1536
    v_bfe_u32 v10, v1, 1, 1
    v_bfe_u32 v11, v1, 3, 2
    v_lshl_add_u32 v11, v10, 2, v11
    v_xor_b32 v11, s38, v11
    v_mul_u32_u24 v12, s57, v10
    v_lshl_add_u32 v12, v11, 4, v12
    v_and_b32 v10, 1, v1
    v_lshl_add_u32 v12, v10, 3, v12
    v_bfe_u32 v10, v1, 2, 2
    v_lshl_add_u32 v10, v6, 3, v10
    v_lshl_add_u32 v12, v10, 7, v12
    v_add_u32 v13, 36864, v12
    v_mov_b32 v14, 161488
    v_mov_b32 v15, 1
    s_mov_b32 s52, 0x05040100
    s_mov_b32 s53, 0x07060302
    v_mov_b32 v10, s52
    v_mov_b32 v4, 0x05040c0c
    v_mov_b32 v5, 0x01000c0c
    v_mov_b32 v6, 0x44444444
    s_mov_b32 exec_lo, 0xff00ff00
    s_mov_b32 exec_hi, 0xff00ff00
    v_mov_b32 v10, 0x03020706
    v_mov_b32 v4, 0x03020c0c
    v_mov_b32 v5, 0x07060c0c
    v_mov_b32 v6, 0xeeeeeeee
    s_mov_b64 exec, -1
    s_waitcnt lgkmcnt(0)
    v_readfirstlane_b32 s39, v167
    s_cmp_eq_u32 s59, 4
    s_cbranch_scc0 F_W8
    s_waitcnt vmcnt(0)
F_W8:
    s_sub_u32 s51, s38, 3
    s_cmp_ge_u32 s51, 8
    s_cbranch_scc1 F_NC
    s_waitcnt vmcnt(8)
    s_mov_b64 exec, 0x1
    ds_add_u32 v14, v15
    s_mov_b64 exec, -1
F_NC:
    s_waitcnt vmcnt(7)
    v_mov_b32 v19, v16
    v_mov_b32_dpp v11, v17 row_ror:8 row_mask:0xf bank_mask:0xf
    v_mov_b32_dpp v16, v18 row_ror:8 row_mask:0xf bank_mask:0xc
    v_mov_b32_dpp v18, v19 row_ror:8 row_mask:0xf bank_mask:0x3
    v_perm_b32 v152, v11, v17, v10
    v_perm_b32 v136, v18, v16, s52
    v_perm_b32 v144, v18, v16, s53
    s_waitcnt vmcnt(6)
    v_mov_b32 v23, v20
    v_mov_b32_dpp v11, v21 row_ror:8 row_mask:0xf bank_mask:0xf
    v_mov_b32_dpp v20, v22 row_ror:8 row_mask:0xf bank_mask:0xc
    v_mov_b32_dpp v22, v23 row_ror:8 row_mask:0xf bank_mask:0x3
    v_perm_b32 v153, v11, v21, v10
    v_perm_b32 v137, v22, v20, s52
    v_perm_b32 v145, v22, v20, s53
    s_waitcnt vmcnt(5)
    v_mov_b32 v27, v24
    v_mov_b32_dpp v11, v25 row_ror:8 row_mask:0xf bank_mask:0xf
    v_mov_b32_dpp v24, v26 row_ror:8 row_mask:0xf bank_mask:0xc
    v_mov_b32_dpp v26, v27 row_ror:8 row_mask:0xf bank_mask:0x3
    v_perm_b32 v154, v11, v25, v10
    v_perm_b32 v138, v26, v24, s52
    v_perm_b32 v146, v26, v24, s53
    s_waitcnt vmcnt(4)
    v_mov_b32 v31, v28
    v_mov_b32_dpp v11, v29 row_ror:8 row_mask:0xf bank_mask:0xf
    v_mov_b32_dpp v28, v30 row_ror:8 row_mask:0xf bank_mask:0xc
    v_mov_b32_dpp v30, v31 row_ror:8 row_mask:0xf bank_mask:0x3
    v_perm_b32 v155, v11, v29, v10
    v_perm_b32 v139, v30, v28, s52
    v_perm_b32 v147, v30, v28, s53
    s_waitcnt vmcnt(3)
    v_mov_b32 v35, v32
    v_mov_b32_dpp v11, v33 row_ror:8 row_mask:0xf bank_mask:0xf
    v_mov_b32_dpp v32, v34 row_ror:8 row_mask:0xf bank_mask:0xc
    v_mov_b32_dpp v34, v35 row_ror:8 row_mask:0xf bank_mask:0x3
    v_perm_b32 v156, v11, v33, v10
    v_perm_b32 v140, v34, v32, s52
    v_perm_b32 v148, v34, v32, s53
    s_waitcnt vmcnt(2)
    v_mov_b32 v39, v36
    v_mov_b32_dpp v11, v37 row_ror:8 row_mask:0xf bank_mask:0xf
    v_mov_b32_dpp v36, v38 row_ror:8 row_mask:0xf bank_mask:0xc
    v_mov_b32_dpp v38, v39 row_ror:8 row_mask:0xf bank_mask:0x3
    v_perm_b32 v157, v11, v37, v10
    v_perm_b32 v141, v38, v36, s52
    v_perm_b32 v149, v38, v36, s53
    s_waitcnt vmcnt(1)
    v_mov_b32 v43, v40
    v_mov_b32_dpp v11, v41 row_ror:8 row_mask:0xf bank_mask:0xf
    v_mov_b32_dpp v40, v42 row_ror:8 row_mask:0xf bank_mask:0xc
    v_mov_b32_dpp v42, v43 row_ror:8 row_mask:0xf bank_mask:0x3
    v_perm_b32 v158, v11, v41, v10
    v_perm_b32 v142, v42, v40, s52
    v_perm_b32 v150, v42, v40, s53
    s_waitcnt vmcnt(0)
    v_mov_b32 v47, v44
    v_mov_b32_dpp v11, v45 row_ror:8 row_mask:0xf bank_mask:0xf
    v_mov_b32_dpp v44, v46 row_ror:8 row_mask:0xf bank_mask:0xc
    v_mov_b32_dpp v46, v47 row_ror:8 row_mask:0xf bank_mask:0x3
    v_perm_b32 v159, v11, v45, v10
    v_perm_b32 v143, v46, v44, s52
    v_perm_b32 v151, v46, v44, s53
    s_cmp_ge_u32 s38, s59
    s_cbranch_scc1 F_NT
    s_movk_i32 s60, 4000
F_CP:
    ds_read_b32 v15, v14
    s_sub_u32 s60, s60, 1
    s_cmp_gt_i32 s60, 0
    s_waitcnt lgkmcnt(0)
    v_readfirstlane_b32 s52, v15
    s_nop 0
    s_cselect_b32 s52, s52, 8
    s_cmp_eq_u32 s52, 8
    s_cbranch_scc1 F_CD
    s_sleep 2
    s_branch F_CP
F_CD:
    ds_read_b64_tr_b16 v[64:65], v12 offset:0
    ds_read_b64_tr_b16 v[66:67], v12 offset:512
    ds_read_b64_tr_b16 v[68:69], v12 offset:4096
    ds_read_b64_tr_b16 v[70:71], v12 offset:4608
    ds_read_b64_tr_b16 v[72:73], v12 offset:8192
    ds_read_b64_tr_b16 v[74:75], v12 offset:8704
    ds_read_b64_tr_b16 v[76:77], v12 offset:12288
    ds_read_b64_tr_b16 v[78:79], v12 offset:12800
    ds_read_b64_tr_b16 v[80:81], v12 offset:16384
    ds_read_b64_tr_b16 v[82:83], v12 offset:16896
    ds_read_b64_tr_b16 v[84:85], v12 offset:20480
    ds_read_b64_tr_b16 v[86:87], v12 offset:20992
    ds_read_b64_tr_b16 v[88:89], v12 offset:24576
    ds_read_b64_tr_b16 v[90:91], v12 offset:25088
    ds_read_b64_tr_b16 v[92:93], v12 offset:28672
    ds_read_b64_tr_b16 v[94:95], v12 offset:29184
    ds_read_b64_tr_b16 v[96:97], v12 offset:32768
    ds_read_b64_tr_b16 v[98:99], v12 offset:33280
    ds_read_b64_tr_b16 v[100:101], v13 offset:0
    ds_read_b64_tr_b16 v[102:103], v13 offset:512
    ds_read_b64_tr_b16 v[104:105], v13 offset:4096
    ds_read_b64_tr_b16 v[106:107], v13 offset:4608
    ds_read_b64_tr_b16 v[108:109], v13 offset:8192
    ds_read_b64_tr_b16 v[110:111], v13 offset:8704
    ds_read_b64_tr_b16 v[112:113], v13 offset:12288
    ds_read_b64_tr_b16 v[114:115], v13 offset:12800
    ds_read_b64_tr_b16 v[116:117], v13 offset:16384
    ds_read_b64_tr_b16 v[118:119], v13 offset:16896
    ds_read_b64_tr_b16 v[120:121], v13 offset:20480
    ds_read_b64_tr_b16 v[122:123], v13 offset:20992
    ds_read_b64_tr_b16 v[124:125], v13 offset:24576
    ds_read_b64_tr_b16 v[126:127], v13 offset:25088
    ds_read_b64_tr_b16 v[128:129], v13 offset:28672
    ds_read_b64_tr_b16 v[130:131], v13 offset:29184
    ds_read_b64_tr_b16 v[132:133], v13 offset:32768
    ds_read_b64_tr_b16 v[134:135], v13 offset:33280
    s_waitcnt lgkmcnt(0)
    v_mov_b32 v12, 0
    v_mov_b32 v13, 0
    v_mov_b32 v14, 0
    v_mov_b32 v15, 0
F_NT:
    s_cmp_lg_u32 s38, 11
    s_cbranch_scc1 F_SEL
    s_cmp_lt_u32 s2, 192
    s_cbranch_scc1 T_EV
    v_lshrrev_b32 v7, 1, v3
    v_min_u32 v7, 16, v7
    s_and_b32 s52, s2, 31
    s_lshl_b32 s52, s52, 7
    v_add_u32 v7, s52, v7
    s_mov_b64 exec, 0xf
    s_movk_i32 s60, 4000
F_PL:
    buffer_load_dword v8, v7, s[40:43], 0 offen offset:2048 sc1
F_PL_W:
    s_waitcnt vmcnt(0)
F_PL_C:
    v_xor_b32 v9, s39, v8
    v_and_b32 v9, 0xffffdfff, v9
    v_cmp_ne_u32 vcc, 0, v9
    s_nop 0
    s_and_b64 exec, exec, vcc
    s_cbranch_execz F_PL_D
    s_sub_u32 s60, s60, 1
    s_cmp_gt_i32 s60, 0
    s_sleep 2
    s_cbranch_scc1 F_PL
F_PL_D:
    s_mov_b64 exec, 0xf
F_PL_K:
    v_lshrrev_b32 v7, 2, v3
    v_add_u32 v7, 161504, v7
    v_and_b32 v8, 0x2000, v8
    ds_write_b32 v7, v8
    s_mov_b64 exec, -1
    v_readlane_b32 s0, v8, 0
    v_readlane_b32 s1, v8, 1
    v_readlane_b32 s22, v8, 2
    s_branch T_EV
FINAL:
    s_cmp_ge_u32 s2, 144
    s_cbranch_scc1 END
    s_cmp_lg_u32 s38, 11
    s_cbranch_scc1 END
    s_branch T_EV
TOP8:
    s_and_b32 s65, s2, 3
    s_lshl_b32 s65, s65, 14
    s_and_b32 s66, s2, 4
    s_lshl_b32 s66, s66, 11
    s_xor_b32 s66, s66, s0
    s_add_u32 s65, s65, s66
    s_add_u32 s65, s65, 65536
    s_add_u32 s66, s65, 4096
    s_waitcnt lgkmcnt(0)
    buffer_load_dwordx4 v[16:19], v3, s[40:43], s65 offen offset:0 sc1
    buffer_load_dwordx4 v[20:23], v3, s[40:43], s65 offen offset:1024 sc1
    buffer_load_dwordx4 v[24:27], v3, s[40:43], s65 offen offset:2048 sc1
    buffer_load_dwordx4 v[28:31], v3, s[40:43], s65 offen offset:3072 sc1
    buffer_load_dwordx4 v[32:35], v3, s[40:43], s66 offen offset:0 sc1
    buffer_load_dwordx4 v[36:39], v3, s[40:43], s66 offen offset:1024 sc1
    buffer_load_dwordx4 v[40:43], v3, s[40:43], s66 offen offset:2048 sc1
    buffer_load_dwordx4 v[44:47], v3, s[40:43], s66 offen offset:3072 sc1
T_EV:
    v_bfe_i32 v7, v1, 0, 1
    v_bfe_i32 v8, v1, 1, 1
    v_bfe_i32 v9, v1, 3, 1
    v_bfe_i32 v11, v1, 4, 1
    v_bfe_i32 v13, v1, 5, 1
    v_xor_b32 v48, v7, v8
    v_xor_b32 v49, v8, v9
    v_xor_b32 v50, v7, v9
    v_xor_b32 v11, v11, v13
    v_xor_b32 v51, v9, v11
    v_xor_b32 v52, v8, v11
    v_xor_b32 v53, v7, v11
    v_mov_b32 v63, 161492
    v_lshl_add_u32 v13, v1, 2, v63
    v_add_u32 v13, 428, v13
    s_cmp_lt_u32 s2, 144
    s_cselect_b32 s68, 147456, 0
    v_sub_u32 v54, 1008, v3
    v_add_u32 v54, s68, v54
    v_and_b32 v7, 4, v1
    v_and_b32 v8, 48, v1
    v_lshlrev_b32 v8, 6, v8
    v_lshl_add_u32 v55, v7, 1, v8
    v_add_u32 v55, s68, v55
    s_and_b32 s65, s2, 3
    s_lshl_b32 s65, s65, 14
    s_and_b32 s66, s2, 4
    s_lshl_b32 s66, s66, 11
    s_xor_b32 s66, s66, s0
    s_add_u32 s65, s65, s66
    s_add_u32 s65, s65, 65536
    s_add_u32 s66, s65, 4096
    s_and_b32 s67, s2, 127
    s_mul_i32 s68, s67, 64
    s_add_u32 s68, s68, s65
    v_mov_b32 v10, 0
    s_cmp_lt_u32 s2, 128
    s_cbranch_scc0 T_E2
    s_movk_i32 s60, 4000
    s_mov_b64 exec, 0x1
    s_waitcnt vmcnt(8)
    buffer_store_dword v167, v10, s[40:43], s50 offen sc1
    s_mov_b64 exec, -1
    s_waitcnt vmcnt(1)
    s_branch T_KP_C
T_E2:
    v_mov_b32 v16, -1
    v_mov_b32 v17, -1
    v_mov_b32 v18, -1
    v_mov_b32 v19, -1
    v_mov_b32 v20, -1
    v_mov_b32 v21, -1
    v_mov_b32 v22, -1
    v_mov_b32 v23, -1
    v_mov_b32 v24, -1
    v_mov_b32 v25, -1
    v_mov_b32 v26, -1
    v_mov_b32 v27, -1
    v_mov_b32 v28, -1
    v_mov_b32 v29, -1
    v_mov_b32 v30, -1
    v_mov_b32 v31, -1
    v_mov_b32 v32, -1
    v_mov_b32 v33, -1
    v_mov_b32 v34, -1
    v_mov_b32 v35, -1
    v_mov_b32 v36, -1
    v_mov_b32 v37, -1
    v_mov_b32 v38, -1
    v_mov_b32 v39, -1
    v_mov_b32 v40, -1
    v_mov_b32 v41, -1
    v_mov_b32 v42, -1
    v_mov_b32 v43, -1
    v_mov_b32 v44, -1
    v_mov_b32 v45, -1
    v_mov_b32 v46, -1
    v_mov_b32 v47, -1
    s_lshr_b32 s52, s67, 3
    s_and_b32 s53, s67, 3
    s_lshl2_add_u32 s52, s52, s53
    s_lshr_b32 s53, s67, 1
    s_xor_b32 s52, s52, s53
    s_lshl_b32 s52, s52, 7
    s_and_b32 s53, s67, 4
    s_lshl_b32 s53, s53, 11
    s_add_u32 s52, s52, s53
    s_cmp_lt_u32 s67, 96
    s_cselect_b32 s53, s1, s22
    s_xor_b32 s52, s52, s53
    s_lshl_b32 s53, s67, 14
    s_add_u32 s52, s52, s53
    s_add_u32 s67, s52, 2621452
    s_mov_b64 exec, 0xf
    s_movk_i32 s60, 4000
T_EP:
    buffer_load_dword v11, v3, s[40:43], s67 offen sc1
T_EP_W:
    s_waitcnt vmcnt(0)
T_EP_C:
    v_cmp_ne_u32 vcc, s39, v11
    s_nop 0
    s_and_b64 exec, exec, vcc
    s_cbranch_execz T_EP_D
    s_sub_u32 s60, s60, 1
    s_cmp_gt_i32 s60, 0
    s_sleep 2
    s_cbranch_scc1 T_EP
T_EP_D:
T_H:
    s_mov_b64 exec, 0x1
    s_movk_i32 s60, 4000
T_HP:
    buffer_load_dword v11, v10, s[40:43], s68 offen sc1
T_HP_W:
    s_waitcnt vmcnt(0)
T_HP_C:
    v_cmp_eq_u32 vcc, -1, v11
    s_nop 0
    s_and_b64 exec, exec, vcc
    s_cbranch_execz T_HP_D
    s_sub_u32 s60, s60, 1
    s_cmp_gt_i32 s60, 0
    s_sleep 1
    s_cbranch_scc1 T_HP
T_HP_D:
    s_mov_b64 exec, -1
    s_cmp_ge_u32 s2, 144
    s_cbranch_scc0 T_KQ
    s_movk_i32 s60, 4000
T_KN:
    buffer_load_dwordx4 v[16:19], v3, s[40:43], s65 offen offset:0 sc1
    buffer_load_dwordx4 v[20:23], v3, s[40:43], s65 offen offset:1024 sc1
    buffer_load_dwordx4 v[24:27], v3, s[40:43], s65 offen offset:2048 sc1
    buffer_load_dwordx4 v[28:31], v3, s[40:43], s65 offen offset:3072 sc1
    buffer_load_dwordx4 v[32:35], v3, s[40:43], s66 offen offset:0 sc1
    buffer_load_dwordx4 v[36:39], v3, s[40:43], s66 offen offset:1024 sc1
    buffer_load_dwordx4 v[40:43], v3, s[40:43], s66 offen offset:2048 sc1
    buffer_load_dwordx4 v[44:47], v3, s[40:43], s66 offen offset:3072 sc1
    s_waitcnt vmcnt(16)
    s_sub_u32 s60, s60, 1
    v_max3_u32 v56, v16, v17, v18
    v_max3_u32 v58, v19, v20, v21
    v_max3_u32 v57, v32, v33, v34
    v_max3_u32 v59, v35, v36, v37
    v_max3_u32 v56, v56, v22, v23
    v_max3_u32 v58, v58, v24, v25
    v_max3_u32 v57, v57, v38, v39
    v_max3_u32 v59, v59, v40, v41
    v_max3_u32 v56, v56, v26, v27
    v_max3_u32 v58, v58, v28, v29
    v_max3_u32 v57, v57, v42, v43
    v_max3_u32 v59, v59, v44, v45
    v_max3_u32 v58, v58, v30, v31
    v_max3_u32 v59, v59, v46, v47
    v_max_u32 v56, v56, v58
    v_max_u32 v57, v57, v59
    v_max_u32 v58, v56, v57
    v_cmp_eq_u32 vcc, -1, v58
    s_nop 0
    s_and_b64 exec, exec, vcc
    s_cselect_b32 s60, s60, 0
    s_cmp_gt_i32 s60, 0
    s_cbranch_scc1 T_KN
    s_branch T_KP_D
T_KQ:
    s_movk_i32 s60, 4000
T_KP:
    buffer_load_dwordx4 v[16:19], v3, s[40:43], s65 offen offset:0 sc1
    buffer_load_dwordx4 v[20:23], v3, s[40:43], s65 offen offset:1024 sc1
    buffer_load_dwordx4 v[24:27], v3, s[40:43], s65 offen offset:2048 sc1
    buffer_load_dwordx4 v[28:31], v3, s[40:43], s65 offen offset:3072 sc1
    buffer_load_dwordx4 v[32:35], v3, s[40:43], s66 offen offset:0 sc1
    buffer_load_dwordx4 v[36:39], v3, s[40:43], s66 offen offset:1024 sc1
    buffer_load_dwordx4 v[40:43], v3, s[40:43], s66 offen offset:2048 sc1
    buffer_load_dwordx4 v[44:47], v3, s[40:43], s66 offen offset:3072 sc1
T_KP_W:
    s_waitcnt vmcnt(0)
T_KP_C:
    v_max3_u32 v56, v16, v17, v18
    v_max3_u32 v58, v19, v20, v21
    v_max3_u32 v57, v32, v33, v34
    v_max3_u32 v59, v35, v36, v37
    v_max3_u32 v56, v56, v22, v23
    v_max3_u32 v58, v58, v24, v25
    v_max3_u32 v57, v57, v38, v39
    v_max3_u32 v59, v59, v40, v41
    v_max3_u32 v56, v56, v26, v27
    v_max3_u32 v58, v58, v28, v29
    v_max3_u32 v57, v57, v42, v43
    v_max3_u32 v59, v59, v44, v45
    v_max3_u32 v58, v58, v30, v31
    v_max3_u32 v59, v59, v46, v47
    v_max_u32 v56, v56, v58
    v_max_u32 v57, v57, v59
    v_max_u32 v58, v56, v57
    v_cmp_eq_u32 vcc, -1, v58
    s_nop 0
    s_and_b64 exec, exec, vcc
    s_cbranch_execz T_KP_D
    s_sub_u32 s60, s60, 1
    s_cmp_gt_i32 s60, 0
    s_cbranch_scc1 T_KP
T_KP_D:
    s_mov_b64 exec, -1
    v_mov_b32_dpp v58, v56 quad_perm:[1,0,3,2] row_mask:0xf bank_mask:0xf
    v_mov_b32_dpp v59, v57 quad_perm:[1,0,3,2] row_mask:0xf bank_mask:0xf
    v_med3_u32 v56, v56, v58, v48
    v_med3_u32 v57, v57, v59, v48
    s_nop 0
    v_mov_b32_dpp v58, v56 quad_perm:[2,3,0,1] row_mask:0xf bank_mask:0xf
    v_mov_b32_dpp v59, v57 quad_perm:[2,3,0,1] row_mask:0xf bank_mask:0xf
    v_med3_u32 v56, v56, v58, v49
    v_med3_u32 v57, v57, v59, v49
    s_nop 0
    v_mov_b32_dpp v58, v56 quad_perm:[1,0,3,2] row_mask:0xf bank_mask:0xf
    v_mov_b32_dpp v59, v57 quad_perm:[1,0,3,2] row_mask:0xf bank_mask:0xf
    v_med3_u32 v56, v56, v58, v50
    v_med3_u32 v57, v57, v59, v50
    s_nop 0
    v_mov_b32_dpp v58, v56 row_ror:8 row_mask:0xf bank_mask:0xf
    v_mov_b32_dpp v59, v57 row_ror:8 row_mask:0xf bank_mask:0xf
    v_med3_u32 v56, v56, v58, v51
    v_med3_u32 v57, v57, v59, v51
    s_nop 0
    v_mov_b32_dpp v58, v56 quad_perm:[2,3,0,1] row_mask:0xf bank_mask:0xf
    v_mov_b32_dpp v59, v57 quad_perm:[2,3,0,1] row_mask:0xf bank_mask:0xf
    v_med3_u32 v56, v56, v58, v52
    v_med3_u32 v57, v57, v59, v52
    s_nop 0
    v_mov_b32_dpp v58, v56 quad_perm:[1,0,3,2] row_mask:0xf bank_mask:0xf
    v_mov_b32_dpp v59, v57 quad_perm:[1,0,3,2] row_mask:0xf bank_mask:0xf
    v_med3_u32 v56, v56, v58, v53
    v_med3_u32 v57, v57, v59, v53
    s_nop 1
    v_max_u32_dpp v56, v57, v56 row_mirror row_mask:0xf bank_mask:0xf
    s_nop 1
    v_mov_b32_dpp v58, v56 row_ror:8 row_mask:0xf bank_mask:0xf
    v_med3_u32 v56, v56, v58, v51
    s_nop 1
    v_mov_b32_dpp v58, v56 quad_perm:[2,3,0,1] row_mask:0xf bank_mask:0xf
    v_med3_u32 v56, v56, v58, v52
    s_nop 1
    v_mov_b32_dpp v58, v56 quad_perm:[1,0,3,2] row_mask:0xf bank_mask:0xf
    v_med3_u32 v56, v56, v58, v53
    s_nop 1
    v_max_u32_dpp v56, v56, v56 row_mirror row_mask:0xf bank_mask:0xf
    s_nop 1
    v_mov_b32_dpp v58, v56 row_ror:8 row_mask:0xf bank_mask:0xf
    v_med3_u32 v56, v56, v58, v51
    s_nop 1
    v_mov_b32_dpp v58, v56 quad_perm:[2,3,0,1] row_mask:0xf bank_mask:0xf
    v_med3_u32 v56, v56, v58, v52
    s_nop 1
    v_mov_b32_dpp v58, v56 quad_perm:[1,0,3,2] row_mask:0xf bank_mask:0xf
    v_med3_u32 v57, v56, v58, v53
    v_med3_u32 v56, v56, v58, v53
    s_nop 1
    v_permlane16_swap_b32 v56, v57
    v_max_u32 v56, v56, v57
    s_nop 1
    v_mov_b32_dpp v58, v56 row_ror:8 row_mask:0xf bank_mask:0xf
    v_med3_u32 v56, v56, v58, v51
    s_nop 1
    v_mov_b32_dpp v58, v56 quad_perm:[2,3,0,1] row_mask:0xf bank_mask:0xf
    v_med3_u32 v56, v56, v58, v52
    s_nop 1
    v_mov_b32_dpp v58, v56 quad_perm:[1,0,3,2] row_mask:0xf bank_mask:0xf
    v_med3_u32 v57, v56, v58, v53
    v_med3_u32 v56, v56, v58, v53
    s_nop 1
    v_permlane32_swap_b32 v56, v57
    v_max_u32 v56, v56, v57
    ds_write_b32 v13, v56
    s_cmp_lt_u32 s2, 144
    v_and_b32 v58, 0x4fc, v56
    v_lshl_or_b32 v58, v58, 2, v55
    v_mov_b32 v62, v56
    s_cbranch_scc1 T_V
    s_waitcnt lgkmcnt(0)
    s_barrier
    ds_read_b32 v7, v160
    s_waitcnt lgkmcnt(0)
    v_and_b32 v7, 0x7ff, v7
    v_mad_i32_i24 v7, v7, s64, v161
    buffer_load_dwordx4 v[8:11], v7, s[40:43], s63 offen sc1
T_V:
    ds_write_b128 v54, v[16:19] offset:7168
    ds_write_b128 v54, v[20:23] offset:6144
    ds_write_b128 v54, v[24:27] offset:5120
    ds_write_b128 v54, v[28:31] offset:4096
    ds_write_b128 v54, v[32:35] offset:3072
    ds_write_b128 v54, v[36:39] offset:2048
    ds_write_b128 v54, v[40:43] offset:1024
    ds_write_b128 v54, v[44:47] offset:0
    ds_read_b64 v[56:57], v58
    v_min_u32_dpp v58, v62, v62 quad_perm:[1,0,3,2] row_mask:0xf bank_mask:0xf
    s_nop 1
    v_min_u32_dpp v58, v58, v58 quad_perm:[2,3,0,1] row_mask:0xf bank_mask:0xf
    s_nop 1
    v_min_u32_dpp v58, v58, v58 row_ror:8 row_mask:0xf bank_mask:0xf
    s_waitcnt lgkmcnt(0)
    v_cmp_ge_u32 vcc, v56, v58
    v_cmp_ge_u32 s[52:53], v57, v58
    s_bcnt1_i32_b64 s54, vcc
    s_bcnt1_i32_b64 s52, s[52:53]
    s_add_u32 s52, s52, s54
    s_cmp_eq_u32 s52, 8
    s_cbranch_scc0 T_M
T_OK:
    s_movk_i32 s60, 4000
    s_cmp_lt_u32 s2, 144
    s_cbranch_scc1 FIN
    s_setprio 0
    s_branch F_ZP_W
T_M:
    v_cmp_ne_u32 s[56:57], v62, v56
    v_cmp_ne_u32 s[74:75], v62, v57
    s_nop 0
    v_cndmask_b32 v56, 0, v56, s[56:57]
    v_cndmask_b32 v57, 0, v57, s[74:75]
    s_mov_b64 s[72:73], -1
T_L:
    v_max_u32 v59, v56, v57
    v_cmp_gt_u32 vcc, v59, v58
    s_nop 4
    s_cbranch_vccz T_X
    s_ff1_i32_b64 s52, vcc
    v_cmp_eq_u32 vcc, v62, v58
    v_readlane_b32 s53, v59, s52
    s_ff1_i32_b64 s54, vcc
    s_cmp_lt_u32 s2, 144
    s_cbranch_scc1 T_L2
    s_and_b32 s55, s53, 0x7ff
    s_mul_i32 s55, s55, s64
    s_add_u32 s55, s55, 9435648
    buffer_load_dwordx4 v[64:67], v3, s[40:43], s55 offen sc1
    buffer_load_dwordx4 v[68:71], v3, s[40:43], s55 offen offset:1024 sc1
T_L2:
    v_mov_b32 v59, s53
    v_cndmask_b32 v62, v62, v59, vcc
    v_cmp_ne_u32 s[56:57], s53, v56
    v_cmp_ne_u32 s[74:75], s53, v57
    s_nop 0
    v_cndmask_b32 v56, 0, v56, s[56:57]
    v_cndmask_b32 v57, 0, v57, s[74:75]
    v_min_u32_dpp v58, v62, v62 quad_perm:[1,0,3,2] row_mask:0xf bank_mask:0xf
    s_nop 1
    v_min_u32_dpp v58, v58, v58 quad_perm:[2,3,0,1] row_mask:0xf bank_mask:0xf
    s_nop 1
    v_min_u32_dpp v58, v58, v58 row_ror:8 row_mask:0xf bank_mask:0xf
    s_cmp_lt_u32 s2, 144
    s_cbranch_scc1 T_L
    s_lshr_b32 s52, s54, 1
    s_and_b32 s52, s52, 4
    s_and_b32 s54, s54, 3
    s_add_u32 s54, s54, s52
    s_mul_i32 s54, s54, 608
    s_add_u32 s54, s54, 147456
    v_and_b32 v72, 1, v1
    v_mul_u32_u24 v72, 4862, v72
    v_mul_u32_u24 v73, 6, v1
    v_sub_u32 v74, v73, v72
    v_add_u32 v73, v73, v72
    v_add_u32 v75, s54, v73
    v_add_u32 v76, s54, v74
    s_mov_b64 exec, s[72:73]
    s_movk_i32 s60, 4000
    s_branch T_Z_W
T_Z:
    buffer_load_dwordx4 v[8:11], v7, s[40:43], s63 offen sc1
T_Z_W:
    s_waitcnt vmcnt(0)
T_Z_C:
    v_cmp_ne_u32 vcc, s39, v11
    s_nop 0
    s_and_b64 exec, exec, vcc
    s_cbranch_execz T_Z_D
    s_wqm_b64 exec, exec
    s_sub_u32 s60, s60, 1
    s_cmp_gt_i32 s60, 0
    s_cbranch_scc1 T_Z
T_Z_D:
    s_mov_b64 exec, s[72:73]
    ds_write2_b32 v162, v8, v10 offset0:0 offset1:1
    ds_write_b32 v2, v9
    s_mov_b64 s[72:73], 0
    s_mov_b64 exec, -1
    s_movk_i32 s60, 4000
    s_branch T_F_W
T_F:
    buffer_load_dwordx4 v[64:67], v3, s[40:43], s55 offen sc1
    buffer_load_dwordx4 v[68:71], v3, s[40:43], s55 offen offset:1024 sc1
T_F_W:
    s_waitcnt vmcnt(0)
T_F_C:
    v_cmp_ne_u32 vcc, s39, v67
    v_cmp_ne_u32 s[56:57], s39, v71
    s_nop 0
    s_or_b32 vcc_lo, vcc_lo, s56
    s_and_b64 exec, exec, vcc
    s_cbranch_execz T_F_D
    s_wqm_b64 exec, exec
    s_sub_u32 s60, s60, 1
    s_cmp_gt_i32 s60, 0
    s_cbranch_scc1 T_F
T_F_D:
    s_mov_b64 exec, -1
    s_movk_i32 s60, 4000
T_C:
    ds_read_b32 v72, v63 offset:0
    s_sub_u32 s60, s60, 1
    s_cmp_gt_i32 s60, 0
    s_waitcnt lgkmcnt(0)
    v_readfirstlane_b32 s52, v72
    s_nop 0
    s_cselect_b32 s52, s52, 11
    s_cmp_lg_u32 s52, 11
    s_cbranch_scc1 T_C
    ds_write2_b32 v75, v64, v66 offset0:0 offset1:1
    ds_write_b32 v76, v65 offset:4864
    s_mov_b32 exec_hi, 0
    ds_write2_b32 v75, v68, v70 offset0:96 offset1:97
    ds_write_b32 v76, v69 offset:5248
    s_mov_b64 exec, -1
    s_branch T_L
T_X:
    s_movk_i32 s60, 4000
    s_cmp_lt_u32 s2, 144
    s_cbranch_scc1 FIN
    s_setprio 0
    s_branch F_BQ
F_SEL:
    s_setprio 0
    s_waitcnt lgkmcnt(0)
    s_barrier
    ds_read_b32 v7, v160
    s_waitcnt lgkmcnt(0)
    v_and_b32 v7, 0x7ff, v7
    v_mad_i32_i24 v7, v7, s64, v161
    s_movk_i32 s60, 4000
F_ZP:
    buffer_load_dwordx4 v[8:11], v7, s[40:43], s63 offen sc1
F_ZP_W:
    s_waitcnt vmcnt(0)
F_ZP_C:
    v_cmp_ne_u32 vcc, s39, v11
    s_nop 0
    s_and_b64 exec, exec, vcc
    s_cbranch_execz F_ZP_D
    s_wqm_b64 exec, exec
    s_sub_u32 s60, s60, 1
    s_cmp_gt_i32 s60, 0
    s_cbranch_scc1 F_ZP
F_ZP_D:
    s_mov_b64 exec, -1
    ds_write2_b32 v162, v8, v10 offset0:0 offset1:1
    ds_write_b32 v2, v9
    s_mov_b64 exec, 0x1
    ds_inc_u32 v63, v63 offset:0
    s_mov_b64 exec, -1
F_BQ:
    s_cmp_ge_u32 s38, s59
    s_waitcnt lgkmcnt(0)
    s_barrier
    s_cbranch_scc1 F_H
    ds_read_b128 v[16:19], v163 offset:0
    ds_read_b128 v[20:23], v163 offset:64
    ds_read_b128 v[24:27], v163 offset:128
    ds_read_b128 v[28:31], v163 offset:192
    ds_read_b128 v[32:35], v163 offset:256
    ds_read_b128 v[36:39], v163 offset:320
    ds_read_b128 v[40:43], v163 offset:384
    ds_read_b128 v[44:47], v163 offset:448
    ds_read_b128 v[48:51], v163 offset:512
    s_waitcnt lgkmcnt(8)
    v_smfmac_f32_16x16x64_bf16 v[12:15], v[16:19], v[64:71], v6
    s_waitcnt lgkmcnt(7)
    v_smfmac_f32_16x16x64_bf16 v[12:15], v[20:23], v[72:79], v6
    s_waitcnt lgkmcnt(6)
    v_smfmac_f32_16x16x64_bf16 v[12:15], v[24:27], v[80:87], v6
    s_waitcnt lgkmcnt(5)
    v_smfmac_f32_16x16x64_bf16 v[12:15], v[28:31], v[88:95], v6
    s_waitcnt lgkmcnt(4)
    v_smfmac_f32_16x16x64_bf16 v[12:15], v[32:35], v[96:103], v6
    s_waitcnt lgkmcnt(3)
    v_smfmac_f32_16x16x64_bf16 v[12:15], v[36:39], v[104:111], v6
    s_waitcnt lgkmcnt(2)
    v_smfmac_f32_16x16x64_bf16 v[12:15], v[40:43], v[112:119], v6
    s_waitcnt lgkmcnt(1)
    v_smfmac_f32_16x16x64_bf16 v[12:15], v[44:47], v[120:127], v6
    s_waitcnt lgkmcnt(0)
    v_smfmac_f32_16x16x64_bf16 v[12:15], v[48:51], v[128:135], v6
    s_nop 7
    v_permlane32_swap_b32 v12, v14
    v_permlane32_swap_b32 v13, v15
    v_add_f32 v12, v12, v14
    v_add_f32 v13, v13, v15
    v_cvt_pk_bf16_f32 v12, v12, v13
    s_nop 1
    v_mov_b32_dpp v13, v12 row_ror:8 row_mask:0xf bank_mask:0xf
    v_perm_b32 v8, v12, v13, v4
    v_mul_f32 v10, 0xbfb8aa3b, v8
    v_exp_f32 v10, v10
    v_perm_b32 v9, v12, v13, v5
    v_add_f32 v10, 1.0, v10
    v_rcp_f32 v10, v10
    s_nop 0
    v_mul_f32 v8, v8, v10
    v_cvt_pk_bf16_f32 v8, v8, v8
    v_lshlrev_b32 v8, 16, v8
    v_mul_f32 v8, v8, v9
    v_cvt_pk_bf16_f32 v8, v8, v8
    ds_write_b16 v164, v8
F_H:
    ds_read_b32 v56, v63 offset:12
    s_waitcnt lgkmcnt(0)
    s_barrier
    ds_read_b128 v[16:19], v60
    ds_read_b128 v[20:23], v60 offset:1024
    ds_read_b128 v[24:27], v61
    ds_read_b128 v[28:31], v61 offset:1024
    v_xor_b32 v165, v56, v165
    v_xor_b32 v166, v56, v166
    s_waitcnt lgkmcnt(3)
    v_mfma_f32_16x16x32_bf16 v[12:15], v[16:19], v[152:155], 0
    v_mfma_f32_16x16x32_bf16 v[8:11], v[16:19], v[136:139], 0
    s_waitcnt lgkmcnt(2)
    v_mfma_f32_16x16x32_bf16 v[12:15], v[20:23], v[156:159], v[12:15]
    v_mfma_f32_16x16x32_bf16 v[8:11], v[20:23], v[140:143], v[8:11]
    s_waitcnt lgkmcnt(1)
    v_mfma_f32_16x16x32_bf16 v[8:11], v[24:27], v[144:147], v[8:11]
    s_waitcnt lgkmcnt(0)
    v_mfma_f32_16x16x32_bf16 v[8:11], v[28:31], v[148:151], v[8:11]
    s_mov_b32 exec_hi, 0
    s_nop 1
    buffer_store_dwordx4 v[12:15], v166, s[40:43], s62 offen sc1
    s_mov_b64 exec, -1
    s_nop 2
    buffer_store_dwordx4 v[8:11], v165, s[40:43], s62 offen sc1
    s_branch END
FIN:
    s_cmp_ge_u32 s2, 72
    s_cselect_b32 s44, 32, 0
    s_cselect_b32 s45, 72, 0
    s_sub_u32 s45, s2, s45
    s_mul_i32 s46, s45, 43
    s_lshr_b32 s46, s46, 8
    s_mul_i32 s47, s46, 6
    s_sub_u32 s47, s45, s47
    v_lshrrev_b32 v6, 4, v1
    s_lshr_b32 s54, s2, 3
    s_lshl_b32 s55, s54, 16
    s_add_u32 s55, s55, s65
    s_add_u32 s55, s55, 196608
    v_mov_b32 v15, 0
    s_mov_b64 exec, 0x1
    buffer_load_dword v14, v15, s[40:43], s55 offen sc1
    s_mov_b64 exec, -1
    v_lshl_add_u32 v7, v6, 2, s44
    ds_bpermute_b32 v7, v7, v62
    v_and_b32 v8, 7, v1
    v_and_b32 v5, 15, v1
    s_lshl_b32 s48, s47, 2
    s_add_u32 s49, s48, 16384 - 16
    s_cmp_eq_u32 s47, 3
    s_cselect_b32 s49, 16384 + 8, s49
    s_cmp_lt_u32 s47, 3
    s_cselect_b32 s48, s48, s49
    s_cmp_lt_u32 s46, 6
    s_cselect_b32 s1, s1, s22
    s_and_b32 s49, s46, 7
    s_lshl_b32 s49, s49, 10
    s_or_b32 s1, s1, s49
    s_lshl_b32 s49, s46, 18
    s_add_u32 s48, s48, s49
    s_add_u32 s48, s48, 2621440
    s_lshl_b32 s47, s47, 1
    s_lshl_b32 s49, s46, 7
    s_add_u32 s49, s49, s47
    s_add_u32 s49, s49, 6291456
    s_mul_i32 s46, s46, 96
    s_add_u32 s46, s46, s47
    s_movk_i32 s47, 8192
    s_mov_b32 s52, s55
    s_lshl_b32 s54, s54, 14
    s_and_b32 s53, s55, 0x2000
    s_add_u32 s54, s54, s53
    s_and_b32 s53, s2, 3
    s_lshl_b32 s53, s53, 11
    s_add_u32 s54, s54, s53
    s_add_u32 s54, s54, 1441792
    s_add_u32 s53, s52, 4096
    v_mov_b32 v60, 0
    v_mov_b32 v61, 0
    v_mov_b32 v62, 0
    s_waitcnt lgkmcnt(0)
    v_and_b32 v9, 0x7ff, v7
    v_sub_u32 v9, 0x7ff, v9
    v_lshrrev_b32 v10, 4, v9
    v_lshlrev_b32 v11, 6, v10
    v_min_u32 v5, 11, v5
    v_lshl_add_u32 v11, v5, 2, v11
    v_mul_u32_u24 v12, 0x480, v9
    v_mad_u32_u24 v12, v8, 12, v12
    v_add_u32 v12, s46, v12
    v_and_b32 v13, 0x30, v9
    v_and_b32 v10, 0x780, v9
    v_lshlrev_b32 v10, 2, v10
    v_lshl_add_u32 v10, v13, 3, v10
    v_and_b32 v13, 0x40, v9
    v_lshl_add_u32 v10, v13, 7, v10
    v_mul_u32_u24 v13, 0x8080, v8
    v_xor_b32 v10, v13, v10
    v_xor_b32 v10, s1, v10
    v_and_b32 v13, 14, v9
    v_lshl_add_u32 v10, v13, 3, v10
    v_and_b32 v13, 1, v9
    v_lshl_add_u32 v10, v13, 1, v10
    v_mul_u32_u24 v9, 0x600, v9
    v_lshl_add_u32 v9, v8, 4, v9
    global_load_short_d16_hi v60, v12, s[4:5]
    buffer_load_short_d16_hi v61, v10, s[40:43], s48 offen sc1
    v_ashrrev_i32 v6, 31, v7
    v_not_b32 v6, v6
    v_or_b32 v6, 0x80000000, v6
    v_xor_b32 v7, v7, v6
    v_and_b32 v7, 0xffff0000, v7
    v_mul_f32 v7, 0xbfb8aa3b, v7
    v_exp_f32 v7, v7
    s_nop 0
    v_add_f32 v7, 1.0, v7
    v_rcp_f32 v7, v7
    s_nop 0
    v_cvt_pk_bf16_f32 v7, v7, v7
    v_lshlrev_b32 v7, 16, v7
    s_mov_b64 exec, 0x1
    s_movk_i32 s60, 4000
    s_waitcnt vmcnt(2)
    s_branch FN_HP_C
    s_movk_i32 s60, 4000
FN_HP:
    buffer_load_dword v14, v15, s[40:43], s55 offen sc1
FN_HP_W:
    s_waitcnt vmcnt(0)
FN_HP_C:
    v_cmp_eq_u32 vcc, -1, v14
    s_nop 0
    s_and_b64 exec, exec, vcc
    s_cbranch_execz FN_HP_D
    s_sub_u32 s60, s60, 1
    s_cmp_gt_i32 s60, 0
    s_cbranch_scc1 FN_HP
FN_HP_D:
    s_mov_b64 exec, -1
    buffer_load_dword v13, v11, s[40:43], s47 offen sc1
    buffer_load_short_d16_hi v62, v9, s[40:43], s49 offen sc1
    buffer_load_dwordx4 v[16:19], v3, s[40:43], s52 offen offset:0 sc1
    buffer_load_dwordx4 v[20:23], v3, s[40:43], s52 offen offset:1024 sc1
    buffer_load_dwordx4 v[24:27], v3, s[40:43], s52 offen offset:2048 sc1
    buffer_load_dwordx4 v[28:31], v3, s[40:43], s52 offen offset:3072 sc1
    buffer_load_dwordx4 v[32:35], v3, s[40:43], s53 offen offset:0 sc1
    buffer_load_dwordx4 v[36:39], v3, s[40:43], s53 offen offset:1024 sc1
    buffer_load_dwordx4 v[40:43], v3, s[40:43], s53 offen offset:2048 sc1
    buffer_load_dwordx4 v[44:47], v3, s[40:43], s53 offen offset:3072 sc1
    buffer_load_dwordx4 v[48:51], v3, s[40:43], s54 offen offset:0 sc1
    buffer_load_dwordx4 v[52:55], v3, s[40:43], s54 offen offset:1024 sc1
    s_waitcnt vmcnt(12)
    v_add_f32 v60, v60, v61
    v_cvt_pk_bf16_f32 v60, v60, v60
    v_lshlrev_b32 v60, 16, v60
    s_movk_i32 s60, 4000
    s_branch FN_PP_W
FN_PP:
    buffer_load_dword v13, v11, s[40:43], s47 offen sc1
    buffer_load_short_d16_hi v62, v9, s[40:43], s49 offen sc1
    buffer_load_dwordx4 v[16:19], v3, s[40:43], s52 offen offset:0 sc1
    buffer_load_dwordx4 v[20:23], v3, s[40:43], s52 offen offset:1024 sc1
    buffer_load_dwordx4 v[24:27], v3, s[40:43], s52 offen offset:2048 sc1
    buffer_load_dwordx4 v[28:31], v3, s[40:43], s52 offen offset:3072 sc1
    buffer_load_dwordx4 v[32:35], v3, s[40:43], s53 offen offset:0 sc1
    buffer_load_dwordx4 v[36:39], v3, s[40:43], s53 offen offset:1024 sc1
    buffer_load_dwordx4 v[40:43], v3, s[40:43], s53 offen offset:2048 sc1
    buffer_load_dwordx4 v[44:47], v3, s[40:43], s53 offen offset:3072 sc1
    buffer_load_dwordx4 v[48:51], v3, s[40:43], s54 offen offset:0 sc1
    buffer_load_dwordx4 v[52:55], v3, s[40:43], s54 offen offset:1024 sc1
FN_PP_W:
    s_waitcnt vmcnt(0)
FN_PP_C:
    v_cmp_ne_u32 s[56:57], s39, v13
    v_pk_add_f32 v[64:65], v[16:17], v[20:21]
    v_pk_add_f32 v[68:69], v[24:25], v[28:29]
    v_pk_add_f32 v[66:67], v[18:19], v[22:23]
    v_pk_add_f32 v[70:71], v[26:27], v[30:31]
    v_pk_add_f32 v[64:65], v[64:65], v[32:33]
    v_pk_add_f32 v[66:67], v[66:67], v[34:35]
    v_pk_add_f32 v[68:69], v[68:69], v[36:37]
    v_pk_add_f32 v[70:71], v[70:71], v[38:39]
    v_pk_add_f32 v[64:65], v[64:65], v[40:41]
    v_pk_add_f32 v[66:67], v[66:67], v[42:43]
    v_pk_add_f32 v[68:69], v[68:69], v[44:45]
    v_pk_add_f32 v[70:71], v[70:71], v[46:47]
    v_pk_add_f32 v[64:65], v[64:65], v[48:49]
    v_pk_add_f32 v[66:67], v[66:67], v[50:51]
    v_pk_add_f32 v[68:69], v[68:69], v[52:53]
    v_pk_add_f32 v[70:71], v[70:71], v[54:55]
    v_pk_add_f32 v[64:65], v[64:65], v[68:69]
    v_pk_add_f32 v[66:67], v[66:67], v[70:71]
    v_pk_add_f32 v[68:69], v[64:65], v[66:67]
    v_cmp_u_f32 vcc, v68, v69
    s_nop 0
    s_or_b64 vcc, vcc, s[56:57]
    s_and_b64 exec, exec, vcc
    s_cbranch_execz FN_PP_D
    s_sub_u32 s60, s60, 1
    s_cmp_gt_i32 s60, 0
    s_cbranch_scc1 FN_PP
FN_PP_D:
    s_mov_b64 exec, -1
    v_permlane32_swap_b32 v64, v66
    v_permlane32_swap_b32 v65, v67
    v_add_f32 v64, v64, v66
    v_add_f32 v65, v65, v67
    s_nop 1
    v_permlane16_swap_b32 v64, v65
    v_add_f32 v64, v64, v65
    s_nop 1
    v_add_f32_dpp v64, v64, v64 row_ror:8 row_mask:0xf bank_mask:0xf
    v_cvt_pk_bf16_f32 v64, v64, v64
    v_lshlrev_b32 v64, 16, v64
    v_mul_f32 v64, v64, v7
    v_cvt_pk_bf16_f32 v64, v64, v64
    v_lshlrev_b32 v64, 16, v64
    v_add_f32 v64, v64, v62
    v_cvt_pk_bf16_f32 v64, v64, v64
    v_lshlrev_b32 v64, 16, v64
    v_add_f32 v64, v64, v60
    v_cvt_pk_bf16_f32 v64, v64, v64
    s_mov_b32 exec_lo, 0xff00ff
    s_mov_b32 exec_hi, 0xff00ff
    global_store_short v12, v64, s[32:33]
    s_mov_b64 exec, -1
END:
    s_endpgm
CODE_END:
.section .rodata,"a"
.p2align 6
.amdhsa_kernel sequential_preLN__ssm_conv_s4__moe_arch_mod__prompt_kernel
  .amdhsa_next_free_vgpr 168
  .amdhsa_next_free_sgpr 102
  .amdhsa_accum_offset 168
  .amdhsa_group_segment_fixed_size 0
  .amdhsa_kernarg_size 136
  .amdhsa_user_sgpr_count 2
  .amdhsa_user_sgpr_kernarg_segment_ptr 1
  .amdhsa_system_sgpr_workgroup_id_x 1
.end_amdhsa_kernel
```

```asm
; @launch grid=(256,1,1) block=(768,1,1) lds=163840
.amdgcn_target "amdgcn-amd-amdhsa--gfx950"
    .text
    .globl sequential_preLN__ssm_conv_s4__moe_arch_mod__prompt_kernel
    .p2align 8
    .type sequential_preLN__ssm_conv_s4__moe_arch_mod__prompt_kernel,@function
sequential_preLN__ssm_conv_s4__moe_arch_mod__prompt_kernel:
    s_cmp_ge_u32 s2, 256
    s_cbranch_scc1 END
    s_load_dwordx16 s[4:19], s[0:1], 0
    s_load_dwordx2 s[36:37], s[0:1], 128
    s_load_dwordx16 s[20:35], s[0:1], 64
    s_getpc_b64 s[70:71]
    s_lshr_b32 s3, s2, 3
    s_mul_i32 s3, s3, 7
    v_subrev_u32 v2, 320, v0
    v_cmp_gt_u32 vcc, 7, v2
    v_add_lshl_u32 v2, v2, s3, 7
    v_min_u32 v2, CODE_END-sequential_preLN__ssm_conv_s4__moe_arch_mod__prompt_kernel-64, v2
    v_mov_b32 v3, s71
    s_mov_b64 exec, vcc
    v_add_co_u32 v2, vcc, s70, v2
    s_nop 1
    v_addc_co_u32 v3, vcc, 0, v3, vcc
    s_cbranch_execz P_NC
    global_load_dword v159, v[2:3], off
P_NC:
    s_mov_b64 exec, -1
    v_lshrrev_b32 v2, 6, v0
    v_and_b32 v1, 63, v0
    v_readfirstlane_b32 s38, v2
    v_lshlrev_b32 v3, 4, v1
    s_mov_b32 s42, 0x10000000
    s_mov_b32 s43, 0x00020000
    s_cmp_lt_u32 s2, 192
    s_cselect_b32 s3, 4, -1
    s_cmp_lg_u32 s38, s3
    s_cbranch_scc1 P_NP
    s_mul_i32 s52, s2, 768
    v_add_u32 v16, s52, v3
    s_mul_i32 s52, s2, 6
    s_and_b32 s52, s52, -4
    v_lshl_add_u32 v17, v1, 2, s52
    v_mov_b32 v18, 161536
    v_mov_b32 v19, 0
    ds_write_b32 v18, v19
    v_mov_b32 v20, s70
    v_mov_b32 v21, s71
    s_waitcnt lgkmcnt(0)
    s_mov_b32 exec_lo, 0xffffffff
    s_mov_b32 exec_hi, 0xffff
    s_mov_b32 m0, 138048
    s_nop 0
    global_load_lds_dwordx4 v16, s[6:7]
    s_mov_b32 m0, 138816
    s_nop 0
    global_load_lds_dwordx4 v16, s[8:9]
    s_mov_b32 m0, 139584
    s_nop 0
    global_load_lds_dwordx4 v16, s[10:11]
    s_mov_b32 m0, 140352
    s_nop 0
    global_load_lds_dwordx4 v16, s[12:13]
    s_mov_b32 m0, 141120
    s_nop 0
    global_load_lds_dwordx4 v16, s[14:15]
    s_mov_b32 m0, 141888
    s_nop 0
    global_load_lds_dwordx4 v16, s[16:17]
    s_mov_b64 exec, 0x3
    s_mov_b32 m0, 142656
    s_nop 0
    global_load_lds_dword v17, s[18:19]
    s_mov_b32 m0, 142672
    s_nop 0
    global_load_lds_dword v17, s[20:21]
    s_mov_b64 exec, 0x1
    s_mov_b32 m0, 161536
    s_nop 0
    global_load_lds_dword v[20:21], off
    s_mov_b64 exec, -1
P_NP:
    s_cmp_ge_u32 s38, 4
    s_cbranch_scc1 P_B
    s_setprio 3
    v_lshrrev_b32 v147, 5, v0
    v_and_b32 v148, 31, v0
    v_mul_u32_u24 v140, 0x480, v147
    s_mul_i32 s44, s2, 9216
    v_mad_u32_u24 v140, v148, 12, v140
    v_mov_b32 v104, 0
    v_mov_b32 v105, 0
    v_mov_b32 v106, 0
    v_mov_b32 v107, 0
    v_add_u32 v140, s44, v140
    v_add_u32 v149, 161280, v3
    s_mov_b64 exec, 0xffff
    ds_write_b128 v149, v[104:107]
    s_mov_b64 exec, -1
    v_mov_b32 v94, 1
    v_and_b32 v147, 1, v147
    v_mul_u32_u24 v141, 0x90, v148
    v_lshl_add_u32 v141, v147, 6, v141
    s_lshl_b32 s45, s38, 4
    s_sub_u32 s45, 147504, s45
    v_add_u32 v141, s45, v141
    v_lshrrev_b32 v142, 3, v1
    v_add_u32 v142, v142, v1
    s_mul_i32 s45, s38, 3456
    s_add_u32 s45, s45, 147456
    v_lshl_add_u32 v142, v142, 4, s45
    v_lshrrev_b32 v143, 2, v1
    v_mul_u32_u24 v143, 16320, v143
    v_add_u32 v143, v143, v3
    s_lshl_b32 s46, s2, 6
    s_sub_u32 s46, 2637760, s46
    s_mul_i32 s45, s38, 786432
    s_add_u32 s46, s46, s45
    s_add_u32 s47, s46, 262144
    s_add_u32 s48, s46, 524288
    s_mov_b32 s49, 0x05040100
    s_mov_b32 s50, 0x07060302
    v_mov_b32 v144, s49
    s_mov_b32 exec_lo, 0
    v_mov_b32 v144, s50
    s_mov_b64 exec, -1
    v_mov_b32 v145, 161328
    s_lshl_b32 s45, s38, 2
    v_add_u32 v146, s45, v145
    s_waitcnt lgkmcnt(0)
    global_load_dword v95, v104, s[36:37] offset:0
    global_load_dwordx3 v[60:62], v140, s[4:5] offset:0
    global_load_dwordx3 v[64:66], v140, s[4:5] offset:384
    global_load_dwordx3 v[68:70], v140, s[4:5] offset:768
    s_mov_b32 s40, s36
    s_mov_b32 s41, s37
    s_cmp_ge_u32 s2, 192
    s_cbranch_scc1 P_C
    s_lshr_b32 s65, s38, 2
    s_bitcmp1_b32 s2, 0
    s_addc_u32 s51, s65, 0
    s_cmp_eq_u32 s51, 3
    s_cselect_b32 s51, 0, s51
    s_lshl_b32 s52, s51, 8
    s_add_u32 s52, s52, 138048
    v_and_b32 v114, 0x7f, v0
    v_lshl_add_u32 v114, v114, 1, s52
    s_and_b32 s52, s2, 1
    s_add_u32 s52, s52, s51
    s_lshl_b32 s52, s52, 1
    s_add_u32 s52, s52, 142656
    v_mov_b32 v115, s52
    v_mov_b32 v119, 161536
    v_mov_b32 v29, 0
    v_mov_b32 v30, 0
    v_mov_b32 v31, 0
    v_mov_b32 v32, 0
    v_mov_b32 v33, 0
    v_mov_b32 v34, 0
    v_mov_b32 v35, 0
    v_mov_b32 v160, 0
    v_mov_b32 v161, 0
    v_mov_b32 v162, 0
    v_mov_b32 v163, 0
    v_mov_b32 v164, 0
    v_lshlrev_b32 v16, 4, v0
    v_add_u32 v17, 101184, v16
    ds_write_b128 v17, v[160:163] offset:0
    ds_write_b128 v17, v[160:163] offset:12288
    ds_write_b128 v17, v[160:163] offset:24576
    s_mul_i32 s59, s65, 16320
    s_mul_i32 s67, s65, 17408
    s_add_u32 s71, s67, 48960
    s_and_b32 s66, s38, 1
    s_lshl_b32 s66, s66, 8
    s_add_u32 s70, s66, s67
    s_add_u32 s70, s70, 16192
    s_add_u32 s66, s66, s59
    s_mov_b32 m0, s66
    s_mul_i32 s64, s65, 5888
    s_add_u32 s64, s64, 101184
    s_and_b32 s69, s38, 3
    v_and_b32 v5, 15, v0
    v_bfe_u32 v6, v0, 4, 2
    v_and_b32 v17, 48, v0
    v_mul_u32_u24 v110, 544, v5
    s_mov_b32 s52, 0
    s_movk_i32 s53, 2176
    s_movk_i32 s54, 4896
    s_cmp_eq_u32 s69, 1
    s_cselect_b32 s52, 9792, s52
    s_cselect_b32 s53, 1088, s53
    s_cselect_b32 s54, 3264, s54
    s_cmp_eq_u32 s69, 3
    s_cselect_b32 s52, 544, s52
    s_add_u32 s52, s52, s59
    s_cmp_eq_u32 s69, 2
    s_cselect_b32 s52, s71, s52
    s_cselect_b32 s54, 4352, s54
    s_add_u32 s67, s71, 8704
    v_and_b32 v111, 3, v0
    v_mul_u32_u24 v111, 544, v111
    v_bfe_u32 v18, v0, 2, 1
    v_bfe_u32 v19, v0, 3, 1
    v_xor_b32 v18, v18, v19
    v_mad_u32_u24 v111, v19, s53, v111
    v_mad_u32_u24 v111, v18, s54, v111
    v_add3_u32 v111, v111, v17, s52
    v_add3_u32 v110, v110, v17, s67
    s_barrier
    v_lshl_add_u32 v18, v5, 1, v6
    s_sub_u32 s52, s69, 11
    v_add_u32 v18, s52, v18
    v_add_u32 v19, 1, v18
    v_lshl_add_u32 v20, v6, 1, 2
    v_cmp_le_u32 s[52:53], v18, v20
    v_cmp_le_u32 s[54:55], v19, v20
    v_mov_b32 v18, 0x3f80
    v_cndmask_b32 v112, 0, v18, s[52:53]
    v_cndmask_b32 v19, 0, 1.0, s[54:55]
    v_or_b32 v112, v112, v19
    s_mul_i32 s52, s38, 1600
    s_add_u32 s52, s52, 120016
    v_lshl_add_u32 v113, v1, 2, s52
    s_mul_i32 s67, s65, 6400
    s_add_u32 s67, s67, 118848
    s_sub_u32 s63, s69, s65
    s_cselect_b32 s52, 3, 0
    s_add_u32 s63, s63, s52
    s_min_u32 s52, s63, 1
    s_add_u32 s63, s63, s52
    s_cmp_eq_u32 s69, 3
    s_cselect_b32 s63, 1, s63
    v_add_u32 v7, 1, v5
    v_and_b32 v8, 3, v7
    v_mul_u32_u24 v8, 1598, v8
    v_lshl_add_u32 v7, v7, 1, v8
    v_add3_u32 v7, v7, v17, s67
    v_add_u32 v18, s64, v17
    v_lshl_add_u32 v9, v5, 3, v18
    v_and_b32 v10, 1, v5
    v_mul_u32_u24 v10, 380, v10
    v_lshl_add_u32 v10, v5, 2, v10
    v_add_u32 v10, v18, v10
    v_lshlrev_b32 v8, 5, v5
    v_sub_u32 v8, v18, v8
    v_lshrrev_b32 v11, 2, v5
    v_lshl_add_u32 v2, v5, 2, v6
    v_add_u32 v15, v2, v11
    v_lshl_add_u32 v4, v15, 3, s59
    s_lshl_b32 s52, s65, 4
    s_add_u32 s52, s52, 161280
    v_mov_b32 v166, s52
    s_branch P_D
P_C:
    v_mov_b32 v8, 0
    v_mov_b32 v10, 0
    v_mov_b32 v166, 0
    v_mov_b32 v9, 0
    s_barrier
P_D:
    v_mov_b32 v117, 0
    v_mov_b32 v118, 0
    v_mov_b32 v116, 0
    s_waitcnt vmcnt(0)
LN1:
    v_dot2c_f32_bf16 v104, 0x3f803f80, v60
    v_dot2c_f32_bf16 v106, v60, v60
    v_dot2c_f32_bf16 v105, 0x3f803f80, v61
    v_dot2c_f32_bf16 v107, v61, v61
    v_dot2c_f32_bf16 v104, 0x3f803f80, v62
    v_dot2c_f32_bf16 v106, v62, v62
    v_dot2c_f32_bf16 v105, 0x3f803f80, v64
    v_dot2c_f32_bf16 v107, v64, v64
    v_dot2c_f32_bf16 v104, 0x3f803f80, v65
    v_dot2c_f32_bf16 v106, v65, v65
    v_dot2c_f32_bf16 v105, 0x3f803f80, v66
    v_dot2c_f32_bf16 v107, v66, v66
    v_dot2c_f32_bf16 v104, 0x3f803f80, v68
    v_dot2c_f32_bf16 v106, v68, v68
    v_dot2c_f32_bf16 v105, 0x3f803f80, v69
    v_dot2c_f32_bf16 v107, v69, v69
    v_dot2c_f32_bf16 v104, 0x3f803f80, v70
    v_dot2c_f32_bf16 v106, v70, v70
    v_add_u32 v95, 1, v95
    s_mov_b64 exec, 0x7
    ds_write_b64 v149, v[94:95] offset:136
    s_mov_b64 exec, -1
    v_add_f32 v104, v104, v105
    v_add_f32 v106, v106, v107
    v_lshlrev_b32 v72, 16, v60
    v_and_b32 v73, 0xffff0000, v60
    v_permlane16_swap_b32 v104, v106
    v_add_f32 v104, v104, v106
    v_lshlrev_b32 v74, 16, v61
    v_and_b32 v75, 0xffff0000, v61
    v_add_f32_dpp v104, v104, v104 quad_perm:[1,0,3,2] row_mask:0xf bank_mask:0xf
    v_lshlrev_b32 v76, 16, v62
    v_and_b32 v77, 0xffff0000, v62
    v_add_f32_dpp v104, v104, v104 quad_perm:[2,3,0,1] row_mask:0xf bank_mask:0xf
    v_lshlrev_b32 v78, 16, v64
    v_and_b32 v79, 0xffff0000, v64
    v_add_f32_dpp v104, v104, v104 row_half_mirror row_mask:0xf bank_mask:0xf
    v_lshlrev_b32 v80, 16, v65
    v_and_b32 v81, 0xffff0000, v65
    v_add_f32_dpp v104, v104, v104 row_mirror row_mask:0xf bank_mask:0xf
    v_mul_f32 v104, 0x3ae38e39, v104
    v_mov_b32 v105, v104
    v_lshlrev_b32 v82, 16, v66
    v_and_b32 v83, 0xffff0000, v66
    v_permlane16_swap_b32 v104, v105
    v_fma_f32 v105, -v104, v104, v105
    v_max_f32 v105, 0, v105
    v_cvt_pk_bf16_f32 v105, v104, v105
    v_lshlrev_b32 v104, 16, v105
    v_and_b32 v105, 0xffff0000, v105
    v_lshlrev_b32 v84, 16, v68
    v_and_b32 v85, 0xffff0000, v68
    v_lshlrev_b32 v86, 16, v69
    v_and_b32 v87, 0xffff0000, v69
    v_lshlrev_b32 v88, 16, v70
    v_and_b32 v89, 0xffff0000, v70
    v_readfirstlane_b32 s39, v95
    v_xor_b32 v99, 0x80000000, v95
    v_xor_b32 v103, 0x80000000, v95
    v_xor_b32 v95, 0x80000000, v95
    v_add_f32 v105, 0x3727c5ac, v105
    v_cvt_pk_bf16_f32 v105, v105, v105
    v_lshlrev_b32 v105, 16, v105
    v_sqrt_f32 v106, v105
    v_pk_add_f32 v[72:73], v[72:73], v[104:105] op_sel_hi:[1,0] neg_lo:[0,1] neg_hi:[0,1]
    v_pk_add_f32 v[74:75], v[74:75], v[104:105] op_sel_hi:[1,0] neg_lo:[0,1] neg_hi:[0,1]
    v_pk_add_f32 v[76:77], v[76:77], v[104:105] op_sel_hi:[1,0] neg_lo:[0,1] neg_hi:[0,1]
    v_cvt_pk_bf16_f32 v106, v106, v106
    v_lshlrev_b32 v106, 16, v106
    v_rcp_f32 v106, v106
    v_pk_add_f32 v[78:79], v[78:79], v[104:105] op_sel_hi:[1,0] neg_lo:[0,1] neg_hi:[0,1]
    v_pk_add_f32 v[80:81], v[80:81], v[104:105] op_sel_hi:[1,0] neg_lo:[0,1] neg_hi:[0,1]
    v_pk_add_f32 v[82:83], v[82:83], v[104:105] op_sel_hi:[1,0] neg_lo:[0,1] neg_hi:[0,1]
    v_pk_add_f32 v[84:85], v[84:85], v[104:105] op_sel_hi:[1,0] neg_lo:[0,1] neg_hi:[0,1]
    v_pk_add_f32 v[86:87], v[86:87], v[104:105] op_sel_hi:[1,0] neg_lo:[0,1] neg_hi:[0,1]
    v_pk_add_f32 v[88:89], v[88:89], v[104:105] op_sel_hi:[1,0] neg_lo:[0,1] neg_hi:[0,1]
    v_cvt_pk_bf16_f32 v73, v72, v73
    v_cvt_pk_bf16_f32 v75, v74, v75
    v_cvt_pk_bf16_f32 v77, v76, v77
    v_cvt_pk_bf16_f32 v79, v78, v79
    v_cvt_pk_bf16_f32 v81, v80, v81
    v_cvt_pk_bf16_f32 v83, v82, v83
    v_cvt_pk_bf16_f32 v85, v84, v85
    v_cvt_pk_bf16_f32 v87, v86, v87
    v_cvt_pk_bf16_f32 v89, v88, v89
    v_lshlrev_b32 v72, 16, v73
    v_and_b32 v73, 0xffff0000, v73
    v_lshlrev_b32 v74, 16, v75
    v_and_b32 v75, 0xffff0000, v75
    v_lshlrev_b32 v76, 16, v77
    v_and_b32 v77, 0xffff0000, v77
    v_pk_mul_f32 v[72:73], v[72:73], v[106:107] op_sel_hi:[1,0]
    v_pk_mul_f32 v[74:75], v[74:75], v[106:107] op_sel_hi:[1,0]
    v_pk_mul_f32 v[76:77], v[76:77], v[106:107] op_sel_hi:[1,0]
    v_cvt_pk_bf16_f32 v60, v72, v73
    v_cvt_pk_bf16_f32 v62, v76, v77
    v_cvt_pk_bf16_f32 v61, v74, v75
    v_cvt_pk_bf16_f32 v63, v74, v75
    v_permlane32_swap_b32 v60, v62
    s_nop 0
    v_permlane32_swap_b32 v61, v63
    v_perm_b32 v92, v60, v62, s49
    v_perm_b32 v93, v60, v62, s50
    v_lshlrev_b32 v78, 16, v79
    v_and_b32 v79, 0xffff0000, v79
    v_lshlrev_b32 v80, 16, v81
    v_and_b32 v81, 0xffff0000, v81
    v_lshlrev_b32 v82, 16, v83
    v_and_b32 v83, 0xffff0000, v83
    v_pk_mul_f32 v[78:79], v[78:79], v[106:107] op_sel_hi:[1,0]
    v_pk_mul_f32 v[80:81], v[80:81], v[106:107] op_sel_hi:[1,0]
    v_pk_mul_f32 v[82:83], v[82:83], v[106:107] op_sel_hi:[1,0]
    v_cvt_pk_bf16_f32 v64, v78, v79
    v_cvt_pk_bf16_f32 v66, v82, v83
    v_cvt_pk_bf16_f32 v65, v80, v81
    v_cvt_pk_bf16_f32 v67, v80, v81
    v_perm_b32 v94, v61, v63, v144
    ds_write_b128 v141, v[92:95] offset:0
    v_permlane32_swap_b32 v64, v66
    v_permlane32_swap_b32 v65, v67
    v_perm_b32 v96, v64, v66, s49
    v_perm_b32 v97, v64, v66, s50
    v_lshlrev_b32 v84, 16, v85
    v_and_b32 v85, 0xffff0000, v85
    v_lshlrev_b32 v86, 16, v87
    v_and_b32 v87, 0xffff0000, v87
    v_lshlrev_b32 v88, 16, v89
    v_and_b32 v89, 0xffff0000, v89
    v_pk_mul_f32 v[84:85], v[84:85], v[106:107] op_sel_hi:[1,0]
    v_pk_mul_f32 v[86:87], v[86:87], v[106:107] op_sel_hi:[1,0]
    v_pk_mul_f32 v[88:89], v[88:89], v[106:107] op_sel_hi:[1,0]
    v_cvt_pk_bf16_f32 v68, v84, v85
    v_cvt_pk_bf16_f32 v70, v88, v89
    v_cvt_pk_bf16_f32 v69, v86, v87
    v_cvt_pk_bf16_f32 v71, v86, v87
    v_perm_b32 v98, v65, v67, v144
    ds_write_b128 v141, v[96:99] offset:4608
    v_permlane32_swap_b32 v68, v70
    v_permlane32_swap_b32 v69, v71
    v_perm_b32 v100, v68, v70, s49
    v_perm_b32 v101, v68, v70, s50
    v_perm_b32 v102, v69, v71, v144
    ds_write_b128 v141, v[100:103] offset:9216
    s_mov_b64 exec, 0x1
    ds_write_b32 v146, v144
    s_mov_b64 exec, -1
LN1_U:
    s_movk_i32 s60, 4000
LN1_R:
    ds_read_b128 v[104:107], v145
    ds_read_b128 v[72:75], v142 offset:0
    ds_read_b128 v[76:79], v142 offset:1152
    ds_read_b128 v[80:83], v142 offset:2304
    s_sub_u32 s60, s60, 1
    s_waitcnt lgkmcnt(3)
    v_min3_u32 v104, v104, v105, v106
    v_min_u32 v104, v104, v107
    v_cmp_eq_u32 vcc, 0, v104
    s_cmp_gt_i32 s60, 0
    s_cselect_b64 s[52:53], vcc, 0
    s_cmp_lg_u64 s[52:53], 0
    s_waitcnt lgkmcnt(0)
    s_cbranch_scc1 LN1_R
    buffer_store_dwordx4 v[72:75], v143, s[40:43], s46 offen sc1
    buffer_store_dwordx4 v[76:79], v143, s[40:43], s47 offen sc1
    buffer_store_dwordx4 v[80:83], v143, s[40:43], s48 offen sc1
    s_cmp_ge_u32 s2, 192
    s_cbranch_scc1 FFN_DMA
    s_branch C_KS
P_B:
    s_cmp_ge_u32 s2, 192
    s_cbranch_scc1 FFN_DMA0
P_B2:
    s_lshr_b32 s65, s38, 2
    s_bitcmp1_b32 s2, 0
    s_addc_u32 s51, s65, 0
    s_cmp_eq_u32 s51, 3
    s_cselect_b32 s51, 0, s51
    s_lshl_b32 s52, s51, 8
    s_add_u32 s52, s52, 138048
    v_and_b32 v114, 0x7f, v0
    v_lshl_add_u32 v114, v114, 1, s52
    s_and_b32 s52, s2, 1
    s_add_u32 s52, s52, s51
    s_lshl_b32 s52, s52, 1
    s_add_u32 s52, s52, 142656
    v_mov_b32 v115, s52
    v_mov_b32 v119, 161536
    v_mov_b32 v29, 0
    v_mov_b32 v30, 0
    v_mov_b32 v31, 0
    v_mov_b32 v32, 0
    v_mov_b32 v33, 0
    v_mov_b32 v34, 0
    v_mov_b32 v35, 0
    v_mov_b32 v160, 0
    v_mov_b32 v161, 0
    v_mov_b32 v162, 0
    v_mov_b32 v163, 0
    v_mov_b32 v164, 0
    v_lshlrev_b32 v16, 4, v0
    v_add_u32 v17, 101184, v16
    ds_write_b128 v17, v[160:163] offset:0
    ds_write_b128 v17, v[160:163] offset:12288
    ds_write_b128 v17, v[160:163] offset:24576
    s_mul_i32 s59, s65, 16320
    s_mul_i32 s67, s65, 17408
    s_add_u32 s71, s67, 48960
    s_and_b32 s66, s38, 1
    s_lshl_b32 s66, s66, 8
    s_add_u32 s70, s66, s67
    s_add_u32 s70, s70, 16192
    s_add_u32 s66, s66, s59
    s_mov_b32 m0, s66
    s_mul_i32 s64, s65, 5888
    s_add_u32 s64, s64, 101184
    s_and_b32 s69, s38, 3
    v_and_b32 v5, 15, v0
    v_bfe_u32 v6, v0, 4, 2
    v_and_b32 v17, 48, v0
    v_mul_u32_u24 v110, 544, v5
    s_mov_b32 s52, 0
    s_movk_i32 s53, 2176
    s_movk_i32 s54, 4896
    s_cmp_eq_u32 s69, 1
    s_cselect_b32 s52, 9792, s52
    s_cselect_b32 s53, 1088, s53
    s_cselect_b32 s54, 3264, s54
    s_cmp_eq_u32 s69, 3
    s_cselect_b32 s52, 544, s52
    s_add_u32 s52, s52, s59
    s_cmp_eq_u32 s69, 2
    s_cselect_b32 s52, s71, s52
    s_cselect_b32 s54, 4352, s54
    s_add_u32 s67, s71, 8704
    v_and_b32 v111, 3, v0
    v_mul_u32_u24 v111, 544, v111
    v_bfe_u32 v18, v0, 2, 1
    v_bfe_u32 v19, v0, 3, 1
    v_xor_b32 v18, v18, v19
    v_mad_u32_u24 v111, v19, s53, v111
    v_mad_u32_u24 v111, v18, s54, v111
    v_add3_u32 v111, v111, v17, s52
    v_add3_u32 v110, v110, v17, s67
    s_barrier
    v_lshl_add_u32 v18, v5, 1, v6
    s_sub_u32 s52, s69, 11
    v_add_u32 v18, s52, v18
    v_add_u32 v19, 1, v18
    v_lshl_add_u32 v20, v6, 1, 2
    v_cmp_le_u32 s[52:53], v18, v20
    v_cmp_le_u32 s[54:55], v19, v20
    v_mov_b32 v18, 0x3f80
    v_cndmask_b32 v112, 0, v18, s[52:53]
    v_cndmask_b32 v19, 0, 1.0, s[54:55]
    v_or_b32 v112, v112, v19
    s_mul_i32 s52, s38, 1600
    s_add_u32 s52, s52, 120016
    v_lshl_add_u32 v113, v1, 2, s52
    s_mul_i32 s67, s65, 6400
    s_add_u32 s67, s67, 118848
    s_sub_u32 s63, s69, s65
    s_cselect_b32 s52, 3, 0
    s_add_u32 s63, s63, s52
    s_min_u32 s52, s63, 1
    s_add_u32 s63, s63, s52
    s_cmp_eq_u32 s69, 3
    s_cselect_b32 s63, 1, s63
    v_add_u32 v7, 1, v5
    v_and_b32 v8, 3, v7
    v_mul_u32_u24 v8, 1598, v8
    v_lshl_add_u32 v7, v7, 1, v8
    v_add3_u32 v7, v7, v17, s67
    v_add_u32 v18, s64, v17
    v_lshl_add_u32 v9, v5, 3, v18
    v_and_b32 v10, 1, v5
    v_mul_u32_u24 v10, 380, v10
    v_lshl_add_u32 v10, v5, 2, v10
    v_add_u32 v10, v18, v10
    v_lshlrev_b32 v8, 5, v5
    v_sub_u32 v8, v18, v8
    v_lshrrev_b32 v11, 2, v5
    v_lshl_add_u32 v2, v5, 2, v6
    v_add_u32 v15, v2, v11
    v_lshl_add_u32 v4, v15, 3, s59
    s_lshl_b32 s52, s65, 4
    s_add_u32 s52, s52, 161280
    v_mov_b32 v166, s52
    s_lshl_b32 s48, s2, 13
    s_add_u32 s48, s48, 258048
    s_mov_b32 s50, s2
    s_lshl_b32 s49, s2, 11
    s_add_u32 s49, s49, 1440768
    s_waitcnt lgkmcnt(0)
    s_mov_b32 s40, s36
    s_mov_b32 s41, s37
    s_bitcmp1_b32 s38, 0
    s_cselect_b32 s0, s26, s28
    s_cselect_b32 s1, s27, s29
    s_lshr_b32 s52, s2, 3
    s_mul_i32 s52, s52, 1728
    s_and_b32 s53, s2, 7
    s_lshl3_add_u32 s52, s53, s52
    s_add_u32 s52, s52, 3
    v_mul_u32_u24 v117, 0x48, v1
    v_add_lshl_u32 v117, v117, s52, 7
    s_cmp_lt_u32 s38, 10
    s_cbranch_scc1 C_NPB
    s_mov_b32 s52, m0
    s_mov_b32 m0, 163328
    s_mov_b64 exec, 0xffffff
    global_load_lds_dword v117, s[0:1]
    s_mov_b64 exec, -1
    s_mov_b32 m0, s52
C_NPB:
    s_lshr_b32 s52, s2, 3
    s_mul_i32 s52, s52, 4
    s_add_u32 s52, s52, s69
    s_mul_i32 s52, s52, 432
    s_and_b32 s53, s2, 7
    s_lshl3_add_u32 s52, s53, s52
    v_lshrrev_b32 v22, 3, v1
    v_min_u32 v22, 5, v22
    v_and_b32 v21, 7, v1
    v_mul_u32_u24 v22, 0x48, v22
    v_add3_u32 v21, v21, v22, s52
    v_lshlrev_b32 v118, 7, v21
C_KS:
    s_movk_i32 s60, 4000
C_KP:
    ds_read_b32 v20, v119
    ds_read_u16_d16_hi v29, v115
    ds_read_u16_d16_hi v30, v114 offset:0
    ds_read_u16_d16_hi v31, v114 offset:768
    ds_read_u16_d16_hi v32, v114 offset:1536
    ds_read_u16_d16_hi v33, v114 offset:2304
    ds_read_u16_d16_hi v34, v114 offset:3072
    ds_read_u16_d16_hi v35, v114 offset:3840
    s_sub_u32 s60, s60, 1
    s_cmp_gt_i32 s60, 0
    s_waitcnt lgkmcnt(7)
    v_readfirstlane_b32 s52, v20
    s_nop 0
    s_cselect_b32 s52, s52, 1
    s_cmp_eq_u32 s52, 0
    s_cbranch_scc1 C_KP
    ds_read_u16_d16_hi v164, v115 offset:16
    s_setprio 2
    s_cmp_lt_u32 s38, 4
    s_cbranch_scc1 PG1
    s_setprio 3
PG1:
    s_waitcnt lgkmcnt(7)
    v_mul_f32 v20, 0x3fb8aa3b, v29
    v_mov_b32 v21, 0x3fb8aa3b
    v_fma_f32 v21, v29, v21, -v20
    v_fmac_f32 v21, 0x32a57060, v29
    v_exp_f32 v20, v20
    v_mul_f32 v21, 0x3f317218, v21
    v_fma_f32 v20, v20, v21, v20
    v_cvt_pk_bf16_f32 v20, v20, v20
    v_lshlrev_b32 v20, 16, v20
    s_waitcnt lgkmcnt(0)
    v_mul_f32 v21, v30, v20
    v_mul_f32 v36, v31, v20
    v_mul_f32 v32, v32, v20
    v_mul_f32 v33, v33, v20
    v_mul_f32 v21, 0x3fb8aa3b, v21
    v_mul_f32 v22, 0x3e22f983, v36
    v_mov_b32 v23, 0x3e22f983
    v_fma_f32 v23, v36, v23, -v22
    v_fmac_f32 v23, 0x31dc9c88, v36
    v_pk_mul_f32 v[24:25], v[34:35], v[32:33] op_sel:[0,0] op_sel_hi:[0,1]
    v_pk_fma_f32 v[24:25], v[34:35], v[32:33], v[24:25] op_sel:[1,1,0] op_sel_hi:[1,0,1] neg_lo:[1,0,0]
    s_bitcmp1_b32 s38, 1
    s_cbranch_scc1 C_ROLE1
    v_mul_f32 v36, 0x43000000, v21
    v_mul_f32 v37, 0x43000000, v22
    v_mul_f32 v38, 0x41000000, v21
    v_mul_f32 v39, 0x41000000, v22
    v_exp_f32 v36, v36
    v_fract_f32 v37, v37
    v_exp_f32 v38, v38
    v_fract_f32 v39, v39
    v_fmac_f32 v37, 0x43000000, v23
    v_fmac_f32 v39, 0x41000000, v23
    v_cos_f32 v26, v37
    v_sin_f32 v27, v37
    v_cos_f32 v28, v39
    v_sin_f32 v29, v39
    v_mul_f32 v26, v26, v36
    v_mul_f32 v27, v27, v36
    v_mul_f32 v28, v28, v38
    v_mul_f32 v29, v29, v38
    v_mov_b32 v44, 1.0
    v_mov_b32 v45, 0
    v_pk_mul_f32 v[56:57], v[24:25], v[28:29] op_sel:[0,0] op_sel_hi:[0,1]
    v_pk_mul_f32 v[50:51], v[28:29], v[28:29] op_sel:[0,0] op_sel_hi:[0,1]
    v_pk_fma_f32 v[56:57], v[24:25], v[28:29], v[56:57] op_sel:[1,1,0] op_sel_hi:[1,0,1] neg_lo:[1,0,0]
    v_pk_fma_f32 v[50:51], v[28:29], v[28:29], v[50:51] op_sel:[1,1,0] op_sel_hi:[1,0,1] neg_lo:[1,0,0]
    v_pk_mul_f32 v[58:59], v[56:57], v[26:27] op_sel:[0,0] op_sel_hi:[0,1]
    v_pk_fma_f32 v[58:59], v[56:57], v[26:27], v[58:59] op_sel:[1,1,0] op_sel_hi:[1,0,1] neg_lo:[1,0,0]
    v_cvt_pk_bf16_f32 v40, v56, v57
    ds_write_addtid_b32 v40 offset:4352
    v_pk_mul_f32 v[56:57], v[58:59], v[26:27] op_sel:[0,0] op_sel_hi:[0,1]
    v_pk_mul_f32 v[54:55], v[50:51], v[28:29] op_sel:[0,0] op_sel_hi:[0,1]
    v_pk_fma_f32 v[56:57], v[58:59], v[26:27], v[56:57] op_sel:[1,1,0] op_sel_hi:[1,0,1] neg_lo:[1,0,0]
    v_pk_fma_f32 v[54:55], v[50:51], v[28:29], v[54:55] op_sel:[1,1,0] op_sel_hi:[1,0,1] neg_lo:[1,0,0]
    v_cvt_pk_bf16_f32 v41, v58, v59
    ds_write_addtid_b32 v41 offset:9248
    v_cvt_pk_bf16_f32 v42, v44, -v45
    s_mov_b32 m0, s70
    s_nop 0
    ds_write_addtid_b32 v42 offset:41472
    v_cvt_pk_bf16_f32 v43, v28, -v29
    ds_write_addtid_b32 v43 offset:42016
    v_cvt_pk_bf16_f32 v40, v50, -v51
    ds_write_addtid_b32 v40 offset:42560
    v_pk_mul_f32 v[58:59], v[56:57], v[26:27] op_sel:[0,0] op_sel_hi:[0,1]
    v_pk_mul_f32 v[50:51], v[54:55], v[28:29] op_sel:[0,0] op_sel_hi:[0,1]
    v_pk_fma_f32 v[58:59], v[56:57], v[26:27], v[58:59] op_sel:[1,1,0] op_sel_hi:[1,0,1] neg_lo:[1,0,0]
    v_pk_fma_f32 v[50:51], v[54:55], v[28:29], v[50:51] op_sel:[1,1,0] op_sel_hi:[1,0,1] neg_lo:[1,0,0]
    v_cvt_pk_bf16_f32 v41, v56, v57
    s_mov_b32 m0, s66
    s_nop 0
    ds_write_addtid_b32 v41 offset:11968
    v_cvt_pk_bf16_f32 v42, v54, -v55
    s_mov_b32 m0, s70
    s_nop 0
    ds_write_addtid_b32 v42 offset:43104
    v_pk_mul_f32 v[56:57], v[58:59], v[26:27] op_sel:[0,0] op_sel_hi:[0,1]
    v_pk_mul_f32 v[54:55], v[50:51], v[28:29] op_sel:[0,0] op_sel_hi:[0,1]
    v_pk_fma_f32 v[56:57], v[58:59], v[26:27], v[56:57] op_sel:[1,1,0] op_sel_hi:[1,0,1] neg_lo:[1,0,0]
    v_pk_fma_f32 v[54:55], v[50:51], v[28:29], v[54:55] op_sel:[1,1,0] op_sel_hi:[1,0,1] neg_lo:[1,0,0]
    v_cvt_pk_bf16_f32 v43, v58, v59
    s_mov_b32 m0, s66
    s_nop 0
    ds_write_addtid_b32 v43 offset:15232
    v_cvt_pk_bf16_f32 v40, v50, -v51
    s_mov_b32 m0, s70
    s_nop 0
    ds_write_addtid_b32 v40 offset:43648
    v_pk_mul_f32 v[58:59], v[56:57], v[26:27] op_sel:[0,0] op_sel_hi:[0,1]
    v_pk_mul_f32 v[50:51], v[54:55], v[28:29] op_sel:[0,0] op_sel_hi:[0,1]
    v_pk_fma_f32 v[58:59], v[56:57], v[26:27], v[58:59] op_sel:[1,1,0] op_sel_hi:[1,0,1] neg_lo:[1,0,0]
    v_pk_fma_f32 v[50:51], v[54:55], v[28:29], v[50:51] op_sel:[1,1,0] op_sel_hi:[1,0,1] neg_lo:[1,0,0]
    v_cvt_pk_bf16_f32 v41, v56, v57
    ds_write_addtid_b32 v41 offset:33312
    v_cvt_pk_bf16_f32 v42, v54, -v55
    ds_write_addtid_b32 v42 offset:44192
    v_pk_mul_f32 v[56:57], v[58:59], v[26:27] op_sel:[0,0] op_sel_hi:[0,1]
    v_pk_mul_f32 v[54:55], v[50:51], v[28:29] op_sel:[0,0] op_sel_hi:[0,1]
    v_pk_fma_f32 v[56:57], v[58:59], v[26:27], v[56:57] op_sel:[1,1,0] op_sel_hi:[1,0,1] neg_lo:[1,0,0]
    v_pk_fma_f32 v[54:55], v[50:51], v[28:29], v[54:55] op_sel:[1,1,0] op_sel_hi:[1,0,1] neg_lo:[1,0,0]
    v_cvt_pk_bf16_f32 v43, v58, v59
    ds_write_addtid_b32 v43 offset:34400
    v_cvt_pk_bf16_f32 v40, v50, -v51
    ds_write_addtid_b32 v40 offset:44736
    v_pk_mul_f32 v[58:59], v[56:57], v[26:27] op_sel:[0,0] op_sel_hi:[0,1]
    v_pk_mul_f32 v[50:51], v[54:55], v[28:29] op_sel:[0,0] op_sel_hi:[0,1]
    v_pk_fma_f32 v[58:59], v[56:57], v[26:27], v[58:59] op_sel:[1,1,0] op_sel_hi:[1,0,1] neg_lo:[1,0,0]
    v_pk_fma_f32 v[50:51], v[54:55], v[28:29], v[50:51] op_sel:[1,1,0] op_sel_hi:[1,0,1] neg_lo:[1,0,0]
    v_cvt_pk_bf16_f32 v41, v56, v57
    ds_write_addtid_b32 v41 offset:37664
    v_cvt_pk_bf16_f32 v42, v54, -v55
    ds_write_addtid_b32 v42 offset:45280
    v_pk_mul_f32 v[56:57], v[58:59], v[26:27] op_sel:[0,0] op_sel_hi:[0,1]
    v_pk_mul_f32 v[54:55], v[50:51], v[28:29] op_sel:[0,0] op_sel_hi:[0,1]
    v_pk_fma_f32 v[56:57], v[58:59], v[26:27], v[56:57] op_sel:[1,1,0] op_sel_hi:[1,0,1] neg_lo:[1,0,0]
    v_pk_fma_f32 v[54:55], v[50:51], v[28:29], v[54:55] op_sel:[1,1,0] op_sel_hi:[1,0,1] neg_lo:[1,0,0]
    v_cvt_pk_bf16_f32 v43, v58, v59
    ds_write_addtid_b32 v43 offset:38752
    v_cvt_pk_bf16_f32 v40, v50, -v51
    ds_write_addtid_b32 v40 offset:45824
    v_pk_mul_f32 v[58:59], v[56:57], v[26:27] op_sel:[0,0] op_sel_hi:[0,1]
    v_pk_mul_f32 v[50:51], v[54:55], v[28:29] op_sel:[0,0] op_sel_hi:[0,1]
    v_pk_fma_f32 v[58:59], v[56:57], v[26:27], v[58:59] op_sel:[1,1,0] op_sel_hi:[1,0,1] neg_lo:[1,0,0]
    v_pk_fma_f32 v[50:51], v[54:55], v[28:29], v[50:51] op_sel:[1,1,0] op_sel_hi:[1,0,1] neg_lo:[1,0,0]
    v_cvt_pk_bf16_f32 v41, v56, v57
    ds_write_addtid_b32 v41 offset:39296
    v_cvt_pk_bf16_f32 v42, v54, -v55
    ds_write_addtid_b32 v42 offset:46368
    v_pk_mul_f32 v[56:57], v[58:59], v[26:27] op_sel:[0,0] op_sel_hi:[0,1]
    v_pk_mul_f32 v[54:55], v[50:51], v[28:29] op_sel:[0,0] op_sel_hi:[0,1]
    v_pk_fma_f32 v[56:57], v[58:59], v[26:27], v[56:57] op_sel:[1,1,0] op_sel_hi:[1,0,1] neg_lo:[1,0,0]
    v_pk_fma_f32 v[54:55], v[50:51], v[28:29], v[54:55] op_sel:[1,1,0] op_sel_hi:[1,0,1] neg_lo:[1,0,0]
    v_cvt_pk_bf16_f32 v43, v58, v59
    ds_write_addtid_b32 v43 offset:39840
    v_cvt_pk_bf16_f32 v40, v50, -v51
    ds_write_addtid_b32 v40 offset:46912
    v_pk_mul_f32 v[58:59], v[56:57], v[26:27] op_sel:[0,0] op_sel_hi:[0,1]
    v_pk_mul_f32 v[50:51], v[54:55], v[28:29] op_sel:[0,0] op_sel_hi:[0,1]
    v_pk_fma_f32 v[58:59], v[56:57], v[26:27], v[58:59] op_sel:[1,1,0] op_sel_hi:[1,0,1] neg_lo:[1,0,0]
    v_pk_fma_f32 v[50:51], v[54:55], v[28:29], v[50:51] op_sel:[1,1,0] op_sel_hi:[1,0,1] neg_lo:[1,0,0]
    v_cvt_pk_bf16_f32 v41, v56, v57
    ds_write_addtid_b32 v41 offset:40384
    v_cvt_pk_bf16_f32 v42, v54, -v55
    ds_write_addtid_b32 v42 offset:47456
    v_pk_mul_f32 v[56:57], v[58:59], v[26:27] op_sel:[0,0] op_sel_hi:[0,1]
    v_pk_mul_f32 v[54:55], v[50:51], v[28:29] op_sel:[0,0] op_sel_hi:[0,1]
    v_pk_fma_f32 v[56:57], v[58:59], v[26:27], v[56:57] op_sel:[1,1,0] op_sel_hi:[1,0,1] neg_lo:[1,0,0]
    v_pk_fma_f32 v[54:55], v[50:51], v[28:29], v[54:55] op_sel:[1,1,0] op_sel_hi:[1,0,1] neg_lo:[1,0,0]
    v_cvt_pk_bf16_f32 v43, v58, v59
    ds_write_addtid_b32 v43 offset:40928
    v_cvt_pk_bf16_f32 v40, v50, -v51
    ds_write_addtid_b32 v40 offset:48000
    v_pk_mul_f32 v[58:59], v[56:57], v[26:27] op_sel:[0,0] op_sel_hi:[0,1]
    v_pk_mul_f32 v[50:51], v[54:55], v[28:29] op_sel:[0,0] op_sel_hi:[0,1]
    v_pk_fma_f32 v[58:59], v[56:57], v[26:27], v[58:59] op_sel:[1,1,0] op_sel_hi:[1,0,1] neg_lo:[1,0,0]
    v_pk_fma_f32 v[50:51], v[54:55], v[28:29], v[50:51] op_sel:[1,1,0] op_sel_hi:[1,0,1] neg_lo:[1,0,0]
    v_cvt_pk_bf16_f32 v41, v56, v57
    ds_write_addtid_b32 v41 offset:34944
    v_cvt_pk_bf16_f32 v42, v54, -v55
    ds_write_addtid_b32 v42 offset:48544
    v_pk_mul_f32 v[56:57], v[58:59], v[26:27] op_sel:[0,0] op_sel_hi:[0,1]
    v_pk_mul_f32 v[54:55], v[50:51], v[28:29] op_sel:[0,0] op_sel_hi:[0,1]
    v_pk_fma_f32 v[56:57], v[58:59], v[26:27], v[56:57] op_sel:[1,1,0] op_sel_hi:[1,0,1] neg_lo:[1,0,0]
    v_pk_fma_f32 v[54:55], v[50:51], v[28:29], v[54:55] op_sel:[1,1,0] op_sel_hi:[1,0,1] neg_lo:[1,0,0]
    v_cvt_pk_bf16_f32 v43, v58, v59
    ds_write_addtid_b32 v43 offset:35488
    v_cvt_pk_bf16_f32 v40, v50, -v51
    ds_write_addtid_b32 v40 offset:49088
    v_pk_mul_f32 v[58:59], v[56:57], v[26:27] op_sel:[0,0] op_sel_hi:[0,1]
    v_pk_fma_f32 v[58:59], v[56:57], v[26:27], v[58:59] op_sel:[1,1,0] op_sel_hi:[1,0,1] neg_lo:[1,0,0]
    v_cvt_pk_bf16_f32 v41, v56, v57
    ds_write_addtid_b32 v41 offset:36032
    v_cvt_pk_bf16_f32 v42, v54, -v55
    ds_write_addtid_b32 v42 offset:49632
    v_cvt_pk_bf16_f32 v43, v58, v59
    ds_write_addtid_b32 v43 offset:36576
    s_branch C_MFMA
C_ROLE1:
    v_mul_f32 v36, 0x43000000, v21
    v_mul_f32 v37, 0x43000000, v22
    v_mul_f32 v38, 0x3f800000, v21
    v_mul_f32 v39, 0x3f800000, v22
    v_exp_f32 v36, v36
    v_fract_f32 v37, v37
    v_exp_f32 v38, v38
    v_fract_f32 v39, v39
    v_fmac_f32 v37, 0x43000000, v23
    v_fmac_f32 v39, 0x3f800000, v23
    v_cos_f32 v26, v37
    v_sin_f32 v27, v37
    v_cos_f32 v28, v39
    v_sin_f32 v29, v39
    v_mul_f32 v26, v26, v36
    v_mul_f32 v27, v27, v36
    v_mul_f32 v28, v28, v38
    v_mul_f32 v29, v29, v38
    v_pk_mul_f32 v[44:45], v[24:25], v[26:27] op_sel:[0,0] op_sel_hi:[0,1]
    v_pk_mul_f32 v[46:47], v[28:29], v[28:29] op_sel:[0,0] op_sel_hi:[0,1]
    v_pk_mul_f32 v[48:49], v[24:25], v[28:29] op_sel:[0,0] op_sel_hi:[0,1]
    v_pk_fma_f32 v[44:45], v[24:25], v[26:27], v[44:45] op_sel:[1,1,0] op_sel_hi:[1,0,1] neg_lo:[1,0,0]
    v_pk_fma_f32 v[46:47], v[28:29], v[28:29], v[46:47] op_sel:[1,1,0] op_sel_hi:[1,0,1] neg_lo:[1,0,0]
    v_pk_fma_f32 v[48:49], v[24:25], v[28:29], v[48:49] op_sel:[1,1,0] op_sel_hi:[1,0,1] neg_lo:[1,0,0]
    v_cvt_pk_bf16_f32 v40, v24, v25
    ds_write_addtid_b32 v40 offset:0
    v_pk_mul_f32 v[50:51], v[44:45], v[26:27] op_sel:[0,0] op_sel_hi:[0,1]
    v_pk_mul_f32 v[52:53], v[44:45], v[28:29] op_sel:[0,0] op_sel_hi:[0,1]
    v_pk_mul_f32 v[54:55], v[48:49], v[28:29] op_sel:[0,0] op_sel_hi:[0,1]
    v_pk_mul_f32 v[62:63], v[46:47], v[46:47] op_sel:[0,0] op_sel_hi:[0,1]
    v_pk_fma_f32 v[50:51], v[44:45], v[26:27], v[50:51] op_sel:[1,1,0] op_sel_hi:[1,0,1] neg_lo:[1,0,0]
    v_pk_fma_f32 v[52:53], v[44:45], v[28:29], v[52:53] op_sel:[1,1,0] op_sel_hi:[1,0,1] neg_lo:[1,0,0]
    v_pk_fma_f32 v[54:55], v[48:49], v[28:29], v[54:55] op_sel:[1,1,0] op_sel_hi:[1,0,1] neg_lo:[1,0,0]
    v_pk_fma_f32 v[62:63], v[46:47], v[46:47], v[62:63] op_sel:[1,1,0] op_sel_hi:[1,0,1] neg_lo:[1,0,0]
    v_cvt_pk_bf16_f32 v41, v44, v45
    ds_write_addtid_b32 v41 offset:4896
    v_cvt_pk_bf16_f32 v42, v48, v49
    ds_write_addtid_b32 v42 offset:544
    v_pk_mul_f32 v[56:57], v[50:51], v[26:27] op_sel:[0,0] op_sel_hi:[0,1]
    v_pk_mul_f32 v[58:59], v[50:51], v[46:47] op_sel:[0,0] op_sel_hi:[0,1]
    v_pk_mul_f32 v[44:45], v[52:53], v[28:29] op_sel:[0,0] op_sel_hi:[0,1]
    v_pk_mul_f32 v[48:49], v[54:55], v[28:29] op_sel:[0,0] op_sel_hi:[0,1]
    v_pk_fma_f32 v[56:57], v[50:51], v[26:27], v[56:57] op_sel:[1,1,0] op_sel_hi:[1,0,1] neg_lo:[1,0,0]
    v_pk_fma_f32 v[58:59], v[50:51], v[46:47], v[58:59] op_sel:[1,1,0] op_sel_hi:[1,0,1] neg_lo:[1,0,0]
    v_pk_fma_f32 v[44:45], v[52:53], v[28:29], v[44:45] op_sel:[1,1,0] op_sel_hi:[1,0,1] neg_lo:[1,0,0]
    v_pk_fma_f32 v[48:49], v[54:55], v[28:29], v[48:49] op_sel:[1,1,0] op_sel_hi:[1,0,1] neg_lo:[1,0,0]
    v_cvt_pk_bf16_f32 v43, v50, v51
    ds_write_addtid_b32 v43 offset:9792
    v_cvt_pk_bf16_f32 v40, v52, v53
    ds_write_addtid_b32 v40 offset:5440
    v_cvt_pk_bf16_f32 v41, v54, v55
    ds_write_addtid_b32 v41 offset:1088
    v_pk_mul_f32 v[54:55], v[48:49], v[28:29] op_sel:[0,0] op_sel_hi:[0,1]
    v_pk_mul_f32 v[52:53], v[44:45], v[28:29] op_sel:[0,0] op_sel_hi:[0,1]
    v_pk_mul_f32 v[50:51], v[58:59], v[46:47] op_sel:[0,0] op_sel_hi:[0,1]
    v_pk_mul_f32 v[24:25], v[56:57], v[46:47] op_sel:[0,0] op_sel_hi:[0,1]
    v_pk_fma_f32 v[54:55], v[48:49], v[28:29], v[54:55] op_sel:[1,1,0] op_sel_hi:[1,0,1] neg_lo:[1,0,0]
    v_pk_fma_f32 v[52:53], v[44:45], v[28:29], v[52:53] op_sel:[1,1,0] op_sel_hi:[1,0,1] neg_lo:[1,0,0]
    v_pk_fma_f32 v[50:51], v[58:59], v[46:47], v[50:51] op_sel:[1,1,0] op_sel_hi:[1,0,1] neg_lo:[1,0,0]
    v_pk_fma_f32 v[24:25], v[56:57], v[46:47], v[24:25] op_sel:[1,1,0] op_sel_hi:[1,0,1] neg_lo:[1,0,0]
    v_cvt_pk_bf16_f32 v42, v48, v49
    ds_write_addtid_b32 v42 offset:1632
    v_cvt_pk_bf16_f32 v43, v44, v45
    ds_write_addtid_b32 v43 offset:5984
    v_cvt_pk_bf16_f32 v40, v58, v59
    ds_write_addtid_b32 v40 offset:10336
    v_pk_mul_f32 v[48:49], v[54:55], v[28:29] op_sel:[0,0] op_sel_hi:[0,1]
    v_pk_mul_f32 v[44:45], v[52:53], v[28:29] op_sel:[0,0] op_sel_hi:[0,1]
    v_pk_mul_f32 v[58:59], v[50:51], v[46:47] op_sel:[0,0] op_sel_hi:[0,1]
    v_pk_mul_f32 v[56:57], v[24:25], v[46:47] op_sel:[0,0] op_sel_hi:[0,1]
    v_pk_fma_f32 v[48:49], v[54:55], v[28:29], v[48:49] op_sel:[1,1,0] op_sel_hi:[1,0,1] neg_lo:[1,0,0]
    v_pk_fma_f32 v[44:45], v[52:53], v[28:29], v[44:45] op_sel:[1,1,0] op_sel_hi:[1,0,1] neg_lo:[1,0,0]
    v_pk_fma_f32 v[58:59], v[50:51], v[46:47], v[58:59] op_sel:[1,1,0] op_sel_hi:[1,0,1] neg_lo:[1,0,0]
    v_pk_fma_f32 v[56:57], v[24:25], v[46:47], v[56:57] op_sel:[1,1,0] op_sel_hi:[1,0,1] neg_lo:[1,0,0]
    v_cvt_pk_bf16_f32 v41, v54, v55
    ds_write_addtid_b32 v41 offset:2176
    v_cvt_pk_bf16_f32 v42, v52, v53
    ds_write_addtid_b32 v42 offset:6528
    v_cvt_pk_bf16_f32 v43, v50, v51
    ds_write_addtid_b32 v43 offset:10880
    v_cvt_pk_bf16_f32 v40, v24, v25
    ds_write_addtid_b32 v40 offset:13600
    v_pk_mul_f32 v[54:55], v[48:49], v[28:29] op_sel:[0,0] op_sel_hi:[0,1]
    v_pk_mul_f32 v[52:53], v[44:45], v[28:29] op_sel:[0,0] op_sel_hi:[0,1]
    v_pk_mul_f32 v[50:51], v[58:59], v[62:63] op_sel:[0,0] op_sel_hi:[0,1]
    v_pk_mul_f32 v[24:25], v[56:57], v[46:47] op_sel:[0,0] op_sel_hi:[0,1]
    v_pk_mul_f32 v[64:65], v[56:57], v[26:27] op_sel:[0,0] op_sel_hi:[0,1]
    v_pk_fma_f32 v[54:55], v[48:49], v[28:29], v[54:55] op_sel:[1,1,0] op_sel_hi:[1,0,1] neg_lo:[1,0,0]
    v_pk_fma_f32 v[52:53], v[44:45], v[28:29], v[52:53] op_sel:[1,1,0] op_sel_hi:[1,0,1] neg_lo:[1,0,0]
    v_pk_fma_f32 v[50:51], v[58:59], v[62:63], v[50:51] op_sel:[1,1,0] op_sel_hi:[1,0,1] neg_lo:[1,0,0]
    v_pk_fma_f32 v[24:25], v[56:57], v[46:47], v[24:25] op_sel:[1,1,0] op_sel_hi:[1,0,1] neg_lo:[1,0,0]
    v_pk_fma_f32 v[64:65], v[56:57], v[26:27], v[64:65] op_sel:[1,1,0] op_sel_hi:[1,0,1] neg_lo:[1,0,0]
    v_cvt_pk_bf16_f32 v41, v48, v49
    ds_write_addtid_b32 v41 offset:2720
    v_cvt_pk_bf16_f32 v42, v44, v45
    ds_write_addtid_b32 v42 offset:7072
    v_cvt_pk_bf16_f32 v43, v58, v59
    ds_write_addtid_b32 v43 offset:11424
    v_cvt_pk_bf16_f32 v40, v56, v57
    ds_write_addtid_b32 v40 offset:14144
    v_pk_mul_f32 v[48:49], v[54:55], v[28:29] op_sel:[0,0] op_sel_hi:[0,1]
    v_pk_mul_f32 v[44:45], v[52:53], v[28:29] op_sel:[0,0] op_sel_hi:[0,1]
    v_pk_mul_f32 v[56:57], v[24:25], v[62:63] op_sel:[0,0] op_sel_hi:[0,1]
    v_pk_mul_f32 v[66:67], v[64:65], v[26:27] op_sel:[0,0] op_sel_hi:[0,1]
    v_pk_fma_f32 v[48:49], v[54:55], v[28:29], v[48:49] op_sel:[1,1,0] op_sel_hi:[1,0,1] neg_lo:[1,0,0]
    v_pk_fma_f32 v[44:45], v[52:53], v[28:29], v[44:45] op_sel:[1,1,0] op_sel_hi:[1,0,1] neg_lo:[1,0,0]
    v_pk_fma_f32 v[56:57], v[24:25], v[62:63], v[56:57] op_sel:[1,1,0] op_sel_hi:[1,0,1] neg_lo:[1,0,0]
    v_pk_fma_f32 v[66:67], v[64:65], v[26:27], v[66:67] op_sel:[1,1,0] op_sel_hi:[1,0,1] neg_lo:[1,0,0]
    v_cvt_pk_bf16_f32 v41, v54, v55
    ds_write_addtid_b32 v41 offset:3264
    v_cvt_pk_bf16_f32 v42, v52, v53
    ds_write_addtid_b32 v42 offset:7616
    v_cvt_pk_bf16_f32 v43, v50, v51
    ds_write_addtid_b32 v43 offset:12512
    v_cvt_pk_bf16_f32 v40, v24, v25
    ds_write_addtid_b32 v40 offset:14688
    v_cvt_pk_bf16_f32 v41, v64, v65
    s_mov_b32 m0, s70
    s_nop 0
    ds_write_addtid_b32 v41 offset:32768
    v_pk_mul_f32 v[52:53], v[44:45], v[28:29] op_sel:[0,0] op_sel_hi:[0,1]
    v_pk_mul_f32 v[64:65], v[66:67], v[26:27] op_sel:[0,0] op_sel_hi:[0,1]
    v_pk_fma_f32 v[52:53], v[44:45], v[28:29], v[52:53] op_sel:[1,1,0] op_sel_hi:[1,0,1] neg_lo:[1,0,0]
    v_pk_fma_f32 v[64:65], v[66:67], v[26:27], v[64:65] op_sel:[1,1,0] op_sel_hi:[1,0,1] neg_lo:[1,0,0]
    v_cvt_pk_bf16_f32 v42, v48, v49
    s_mov_b32 m0, s66
    s_nop 0
    ds_write_addtid_b32 v42 offset:3808
    v_cvt_pk_bf16_f32 v43, v44, v45
    ds_write_addtid_b32 v43 offset:8160
    v_cvt_pk_bf16_f32 v40, v56, v57
    ds_write_addtid_b32 v40 offset:15776
    v_cvt_pk_bf16_f32 v41, v66, v67
    s_mov_b32 m0, s70
    s_nop 0
    ds_write_addtid_b32 v41 offset:33856
    v_pk_mul_f32 v[66:67], v[64:65], v[26:27] op_sel:[0,0] op_sel_hi:[0,1]
    v_pk_fma_f32 v[66:67], v[64:65], v[26:27], v[66:67] op_sel:[1,1,0] op_sel_hi:[1,0,1] neg_lo:[1,0,0]
    v_cvt_pk_bf16_f32 v42, v52, v53
    s_mov_b32 m0, s66
    s_nop 0
    ds_write_addtid_b32 v42 offset:8704
    v_cvt_pk_bf16_f32 v43, v64, v65
    s_mov_b32 m0, s70
    s_nop 0
    ds_write_addtid_b32 v43 offset:37120
    v_cvt_pk_bf16_f32 v40, v66, v67
    ds_write_addtid_b32 v40 offset:38208
C_MFMA:
    s_mul_i32 s56, s2, 16384
    s_lshl_b32 s57, s38, 12
    s_add_u32 s56, s56, s57
    s_add_u32 s56, s56, 2605056
    s_mov_b64 exec, 0x1
    ds_inc_u32 v166, v166 offset:12
    s_mov_b64 exec, -1
    ds_write_b32 v113, v112
    s_setprio 2
    s_movk_i32 s60, 4000
C_KG:
    ds_read_b32 v16, v166 offset:12
    s_sub_u32 s60, s60, 1
    s_cmp_gt_i32 s60, 0
    s_waitcnt lgkmcnt(0)
    v_readfirstlane_b32 s52, v16
    s_nop 0
    s_cselect_b32 s52, s52, 4
    s_cmp_lg_u32 s52, 4
    s_cbranch_scc1 C_KG
    ds_read_b128 v[16:19], v111 offset:0
    ds_read_b128 v[20:23], v110 offset:0
    ds_read_b128 v[24:27], v111 offset:64
    ds_read_b128 v[28:31], v110 offset:64
    ds_read_b128 v[32:35], v111 offset:128
    ds_read_b128 v[36:39], v110 offset:128
    ds_read_b128 v[40:43], v111 offset:192
    ds_read_b128 v[44:47], v110 offset:192
    ds_read_b128 v[48:51], v111 offset:256
    ds_read_b128 v[52:55], v110 offset:256
    ds_read_b128 v[56:59], v111 offset:320
    ds_read_b128 v[60:63], v110 offset:320
    ds_read_b128 v[64:67], v111 offset:384
    ds_read_b128 v[68:71], v110 offset:384
    ds_read_b128 v[72:75], v111 offset:448
    ds_read_b128 v[76:79], v110 offset:448
    s_lshl_b32 s53, s63, 10
    s_sub_u32 s52, s64, s53
    s_add_u32 s52, s52, 3576
    v_and_b32 v165, 1, v5
    v_lshl_add_u32 v165, v6, 1, v165
    s_mul_i32 s53, s65, 384
    s_add_u32 s53, s53, 161920
    v_lshl_add_u32 v165, v165, 4, s53
    v_lshlrev_b32 v2, 3, v2
    v_sub_u32 v2, s52, v2
    s_mul_i32 s68, s63, 1088
    s_add_u32 s68, s68, s71
    v_lshl_add_u32 v15, v15, 3, s68
    s_cmp_lg_u32 s63, 0
    s_cbranch_scc1 C_LA1
    s_lshr_b32 s52, s2, 3
    s_mul_i32 s52, s52, 3
    s_add_u32 s52, s52, s65
    s_lshl_b32 s52, s52, 3
    s_and_b32 s53, s2, 7
    v_and_b32 v11, 7, v1
    v_add_u32 v11, s52, v11
    s_mul_i32 s54, s53, 7
    v_lshrrev_b32 v12, 3, v1
    v_add_u32 v12, s54, v12
    v_mul_u32_u24 v13, 0x48, v11
    v_add3_u32 v14, v12, v13, s53
    v_lshlrev_b32 v14, 7, v14
    v_add_u32 v10, s53, v12
    v_mul_u32_u24 v10, 0x240, v10
    s_add_u32 s53, s53, 64
    v_add_lshl_u32 v13, v13, s53, 7
    s_mul_i32 s53, s53, 0x240
    v_add_lshl_u32 v12, v11, s53, 7
    v_add_lshl_u32 v11, v11, v10, 7
    v_mov_b32 v10, 0
    v_lshrrev_b32 v9, 3, v1
    v_mul_u32_u24 v9, 3328, v9
    v_add3_u32 v9, v9, v3, s59
    s_branch C_LA2
C_LA1:
    v_and_b32 v93, 3, v5
    v_lshl_add_u32 v94, v6, 3, v11
    v_and_b32 v92, 1, v11
    v_mul_u32_u24 v92, 3456, v92
    v_add_u32 v92, s59, v92
    v_sub_u32 v93, v93, v94
    v_sub_u32 v94, v93, v94
    v_add_u32 v95, 44, v93
    v_lshrrev_b32 v96, 4, v95
    v_add_u32 v95, v95, v96
    v_lshl_add_u32 v11, v95, 3, v92
    v_add_u32 v95, 75, v94
    v_lshrrev_b32 v96, 4, v95
    v_add_u32 v95, v95, v96
    v_lshl_add_u32 v13, v95, 3, v92
    v_add_u32 v95, 40, v93
    v_lshrrev_b32 v96, 4, v95
    v_add_u32 v95, v95, v96
    v_lshl_add_u32 v12, v95, 3, v92
    v_add_u32 v95, 67, v94
    v_lshrrev_b32 v96, 4, v95
    v_add_u32 v95, v95, v96
    v_lshl_add_u32 v14, v95, 3, v92
C_LA2:
    s_cmp_eq_u32 s69, 2
    s_cbranch_scc1 C_T2
    v_lshrrev_b32 v89, 1, v6
    v_xor_b32 v88, v89, v6
    v_and_b32 v88, 1, v88
    v_lshlrev_b32 v88, 8, v88
    v_lshl_add_u32 v88, v89, 3, v88
    v_lshl_add_u32 v88, v5, 4, v88
    s_cmp_eq_u32 s69, 1
    s_cbranch_scc1 C_T1
    s_lshr_b32 s52, s69, 1
    s_mul_i32 s53, s52, 1600
    s_add_u32 s53, s53, s67
    v_add_u32 v88, s53, v88
    v_add_u32 v89, 3200, v88
    s_xor_b32 s52, s52, 1
    s_mov_b32 s53, 0
    s_waitcnt lgkmcnt(14)
    v_mfma_f32_16x16x32_bf16 v[80:83], v[16:19], v[20:23], 0
    s_waitcnt lgkmcnt(12)
    v_mfma_f32_16x16x32_bf16 v[84:87], v[24:27], v[28:31], 0
    s_waitcnt lgkmcnt(10)
    v_mfma_f32_16x16x32_bf16 v[80:83], v[32:35], v[36:39], v[80:83]
    s_waitcnt lgkmcnt(8)
    v_mfma_f32_16x16x32_bf16 v[84:87], v[40:43], v[44:47], v[84:87]
    s_waitcnt lgkmcnt(6)
    v_mfma_f32_16x16x32_bf16 v[80:83], v[48:51], v[52:55], v[80:83]
    s_waitcnt lgkmcnt(4)
    v_mfma_f32_16x16x32_bf16 v[84:87], v[56:59], v[60:63], v[84:87]
    s_waitcnt lgkmcnt(2)
    v_mfma_f32_16x16x32_bf16 v[80:83], v[64:67], v[68:71], v[80:83]
    s_waitcnt lgkmcnt(0)
    v_mfma_f32_16x16x32_bf16 v[84:87], v[72:75], v[76:79], v[84:87]
    s_nop 7
    v_pk_add_f32 v[80:81], v[80:81], v[84:85]
    v_pk_add_f32 v[82:83], v[82:83], v[86:87]
    v_cvt_pk_bf16_f32 v80, v80, v81
    v_cvt_pk_bf16_f32 v81, v82, v83
    ds_write_b64 v88, v[80:81] offset:32
    ds_write2_b32 v89, v80, v81 offset0:7 offset1:8
    s_mov_b64 exec, s[52:53]
    ds_write_b16 v88, v80 offset:1630
    ds_write_b16 v88, v80 offset:4826
    s_mov_b64 exec, -1
    s_branch C_B3
C_T1:
    s_add_u32 s53, s67, 544
    v_add_u32 v88, s53, v88
    v_add_u32 v89, 1600, v88
    s_waitcnt lgkmcnt(14)
    v_mfma_f32_16x16x32_bf16 v[80:83], v[16:19], v[20:23], 0
    s_waitcnt lgkmcnt(12)
    v_mfma_f32_16x16x32_bf16 v[84:87], v[24:27], v[28:31], 0
    s_waitcnt lgkmcnt(10)
    v_mfma_f32_16x16x32_bf16 v[80:83], v[32:35], v[36:39], v[80:83]
    s_waitcnt lgkmcnt(8)
    v_mfma_f32_16x16x32_bf16 v[84:87], v[40:43], v[44:47], v[84:87]
    s_waitcnt lgkmcnt(6)
    v_mfma_f32_16x16x32_bf16 v[80:83], v[48:51], v[52:55], v[80:83]
    s_waitcnt lgkmcnt(4)
    v_mfma_f32_16x16x32_bf16 v[84:87], v[56:59], v[60:63], v[84:87]
    s_waitcnt lgkmcnt(2)
    v_mfma_f32_16x16x32_bf16 v[80:83], v[64:67], v[68:71], v[80:83]
    s_waitcnt lgkmcnt(0)
    v_mfma_f32_16x16x32_bf16 v[84:87], v[72:75], v[76:79], v[84:87]
    s_nop 7
    v_pk_add_f32 v[80:81], v[80:81], v[84:85]
    v_pk_add_f32 v[82:83], v[82:83], v[86:87]
    v_cvt_pk_bf16_f32 v16, v81, v82
    v_cvt_pk_bf16_f32 v17, v82, v82
    v_cvt_pk_bf16_f32 v18, v82, v82
    v_cvt_pk_bf16_f32 v19, v82, v83
    ds_write2_b32 v88, v16, v17 offset0:1 offset1:2
    ds_write_b64 v88, v[16:17] offset:3200
    ds_write2_b32 v89, v18, v19 offset0:1 offset1:2
    ds_write_b64 v88, v[18:19] offset:4800
    v_cvt_pk_bf16_f32 v20, v80, v80
    v_cvt_pk_bf16_f32 v21, v80, v81
    s_mov_b64 exec, 0x1
    ds_write_b32 v88, v20
    ds_write_b32 v88, v20 offset:3196
    ds_write_b32 v88, v21 offset:1600
    ds_write_b32 v88, v21 offset:4796
    s_mov_b32 exec_lo, 0x0
    s_mov_b32 exec_hi, 0x8000
    ds_write_b16 v88, v17 offset:12
    ds_write_b16 v88, v17 offset:1610
    ds_write_b16 v88, v17 offset:3208
    ds_write_b16 v88, v17 offset:4806
    s_mov_b64 exec, -1
    s_branch C_B3
C_T2:
    v_lshlrev_b32 v88, 7, v6
    v_lshl_add_u32 v89, v5, 1, v88
    v_lshl_add_u32 v88, v5, 2, v88
    s_add_u32 s52, s64, 4728
    v_add_u32 v88, s52, v88
    s_add_u32 s52, s64, 4920
    v_add_u32 v89, s52, v89
    v_mov_b32 v90, s67
    s_waitcnt lgkmcnt(14)
    v_mfma_f32_16x16x32_bf16 v[80:83], v[16:19], v[20:23], 0
    s_waitcnt lgkmcnt(12)
    v_mfma_f32_16x16x32_bf16 v[84:87], v[24:27], v[28:31], 0
    s_waitcnt lgkmcnt(10)
    v_mfma_f32_16x16x32_bf16 v[80:83], v[32:35], v[36:39], v[80:83]
    s_waitcnt lgkmcnt(8)
    v_mfma_f32_16x16x32_bf16 v[84:87], v[40:43], v[44:47], v[84:87]
    s_waitcnt lgkmcnt(6)
    v_mfma_f32_16x16x32_bf16 v[80:83], v[48:51], v[52:55], v[80:83]
    s_waitcnt lgkmcnt(4)
    v_mfma_f32_16x16x32_bf16 v[84:87], v[56:59], v[60:63], v[84:87]
    s_waitcnt lgkmcnt(2)
    v_mfma_f32_16x16x32_bf16 v[80:83], v[64:67], v[68:71], v[80:83]
    s_waitcnt lgkmcnt(0)
    v_mfma_f32_16x16x32_bf16 v[84:87], v[72:75], v[76:79], v[84:87]
    s_nop 7
    v_pk_add_f32 v[80:81], v[80:81], v[84:85]
    v_pk_add_f32 v[82:83], v[82:83], v[86:87]
    v_cvt_pk_bf16_f32 v80, v80, v81
    v_cvt_pk_bf16_f32 v81, v82, v83
    s_mov_b32 exec_hi, 0
    ds_write2_b32 v88, v80, v81 offset0:0 offset1:16
    s_not_b64 exec, exec
    ds_write_b16 v89, v80 offset:4
    ds_write_b16_d16_hi v89, v80 offset:36
    ds_write_b16 v89, v81 offset:68
    ds_write_b16_d16_hi v89, v81 offset:100
    ds_write_b16 v89, v80 offset:384
    ds_write_b16_d16_hi v89, v80 offset:416
    ds_write_b16 v89, v81 offset:448
    ds_write_b16_d16_hi v89, v81 offset:480
    s_mov_b32 exec_lo, 0x80000000
    s_mov_b32 exec_hi, 0x0
    ds_write_b16_d16_hi v90, v81 offset:1126
    ds_write_b16_d16_hi v90, v81 offset:1128
    ds_write_b16_d16_hi v90, v81 offset:2724
    ds_write_b16_d16_hi v90, v81 offset:2726
    ds_write_b16_d16_hi v90, v81 offset:4322
    ds_write_b16_d16_hi v90, v81 offset:4324
    ds_write_b16_d16_hi v90, v81 offset:5920
    ds_write_b16_d16_hi v90, v81 offset:5922
    s_mov_b64 exec, -1
C_B3:
    s_mov_b64 exec, 0x1
    ds_inc_u32 v166, v166 offset:128
    s_mov_b64 exec, -1
    s_mov_b32 s61, s65
    s_cmp_lg_u32 s65, 1
    s_cbranch_scc1 C_NOUL
    s_waitcnt vmcnt(0)
    buffer_load_dwordx4 v[24:27], v3, s[40:43], s56 offen offset:0 sc1
    buffer_load_dwordx4 v[28:31], v3, s[40:43], s56 offen offset:1024 sc1
    buffer_load_dwordx4 v[32:35], v3, s[40:43], s56 offen offset:2048 sc1
    buffer_load_dwordx4 v[36:39], v3, s[40:43], s56 offen offset:3072 sc1
C_NOUL:
    s_movk_i32 s60, 4000
C_KM:
    ds_read_b128 v[16:19], v166 offset:128
    s_sub_u32 s60, s60, 1
    s_cmp_gt_i32 s60, 0
    s_waitcnt lgkmcnt(0)
    v_add_u32 v16, v16, v18
    s_nop 0
    v_readfirstlane_b32 s52, v16
    s_nop 0
    s_cselect_b32 s52, s52, 5
    s_cmp_lg_u32 s52, 5
    s_cbranch_scc1 C_KM
    s_cmp_lg_u32 s65, 1
    s_cbranch_scc1 C_NPA
    s_mov_b32 s52, m0
    s_mov_b32 m0, 163328
    s_nop 0
    global_load_lds_dword v118, s[28:29]
    s_mov_b32 m0, s52
C_NPA:
    s_setprio 3
    ds_read_b64 v[48:49], v7 offset:0
    ds_read_b64 v[50:51], v7 offset:8
    ds_read_b64 v[52:53], v7 offset:64
    ds_read_b64 v[54:55], v7 offset:72
    ds_read_b64 v[56:57], v7 offset:128
    ds_read_b64 v[58:59], v7 offset:136
    ds_read_b64 v[60:61], v7 offset:192
    ds_read_b64 v[62:63], v7 offset:200
    ds_read_b64 v[64:65], v7 offset:256
    ds_read_b64 v[66:67], v7 offset:264
    ds_read_b64 v[68:69], v7 offset:320
    ds_read_b64 v[70:71], v7 offset:328
    ds_read_b64 v[72:73], v7 offset:384
    ds_read_b64 v[74:75], v7 offset:392
    ds_read_b64 v[76:77], v7 offset:448
    ds_read_b64 v[78:79], v7 offset:456
    ds_read_b64 v[80:81], v7 offset:512
    ds_read_b64 v[82:83], v7 offset:520
    ds_read_b64 v[84:85], v7 offset:576
    ds_read_b64 v[86:87], v7 offset:584
    ds_read_b64 v[88:89], v7 offset:640
    ds_read_b64 v[90:91], v7 offset:648
    ds_read_b64 v[92:93], v7 offset:704
    ds_read_b64 v[94:95], v7 offset:712
    ds_read_b64 v[96:97], v7 offset:768
    ds_read_b64 v[98:99], v7 offset:776
    ds_read_b64 v[100:101], v7 offset:832
    ds_read_b64 v[102:103], v7 offset:840
    ds_read_b64 v[104:105], v7 offset:896
    ds_read_b64 v[106:107], v7 offset:904
    ds_read_b64 v[108:109], v7 offset:960
    ds_read_b64 v[110:111], v7 offset:968
    s_cmp_eq_u32 s63, 1
    s_cbranch_scc1 C_E1
    s_cmp_eq_u32 s63, 2
    s_cbranch_scc1 C_E2
    s_cmp_eq_u32 s63, 3
    s_cbranch_scc1 C_E3
    ds_read_b64 v[112:113], v7 offset:1152
    ds_read_b64 v[114:115], v7 offset:1160
    ds_read_b64 v[116:117], v7 offset:1216
    ds_read_b64 v[118:119], v7 offset:1224
    ds_read_b64 v[128:129], v7 offset:1280
    ds_read_b64 v[130:131], v7 offset:1288
    ds_read_b64 v[132:133], v7 offset:1344
    ds_read_b64 v[134:135], v7 offset:1352
    s_mov_b32 exec_hi, 0
    ds_write_b128 v9, v[160:163]
    s_mov_b64 exec, -1
    s_branch C_EE
C_E1:
    ds_read_b64 v[128:129], v7 offset:1152
    ds_read_b64 v[130:131], v7 offset:1160
    ds_read_b64 v[132:133], v7 offset:1216
    ds_read_b64 v[134:135], v7 offset:1224
    ds_read_b64 v[136:137], v7 offset:1280
    ds_read_b64 v[138:139], v7 offset:1288
    ds_read_b64 v[140:141], v7 offset:1344
    ds_read_b64 v[142:143], v7 offset:1352
    ds_read_b64 v[112:113], v7 offset:1024
    ds_read_b64 v[114:115], v7 offset:1032
    s_branch C_EE
C_E2:
    ds_read_b64 v[152:153], v7 offset:1152
    ds_read_b64 v[154:155], v7 offset:1160
    ds_read_b64 v[156:157], v7 offset:1216
    ds_read_b64 v[158:159], v7 offset:1224
    ds_read_b64 v[112:113], v7 offset:1024
    ds_read_b64 v[114:115], v7 offset:1032
    ds_read_b64 v[128:129], v9 offset:4608
    ds_read_b64 v[130:131], v9 offset:4616
    ds_read_b64 v[132:133], v9 offset:4672
    ds_read_b64 v[134:135], v9 offset:4680
    ds_read_b64 v[136:137], v9 offset:4736
    ds_read_b64 v[138:139], v9 offset:4744
    ds_read_b64 v[140:141], v9 offset:4800
    ds_read_b64 v[142:143], v9 offset:4808
    ds_read_b64 v[144:145], v9 offset:4864
    ds_read_b64 v[146:147], v9 offset:4872
    ds_read_b64 v[148:149], v9 offset:4928
    ds_read_b64 v[150:151], v9 offset:4936
    s_branch C_EE
C_E3:
    ds_read_b64 v[112:113], v7 offset:1024
    ds_read_b64 v[114:115], v7 offset:1032
    ds_read_b64 v[116:117], v7 offset:1088
    ds_read_b64 v[118:119], v7 offset:1096
    ds_read_b64 v[128:129], v9 offset:4608
    ds_read_b64 v[130:131], v9 offset:4616
    ds_read_b64 v[132:133], v9 offset:4672
    ds_read_b64 v[134:135], v9 offset:4680
    ds_read_b64 v[136:137], v9 offset:4736
    ds_read_b64 v[138:139], v9 offset:4744
    ds_read_b64 v[140:141], v9 offset:4800
    ds_read_b64 v[142:143], v9 offset:4808
    ds_read_b64 v[144:145], v9 offset:4864
    ds_read_b64 v[146:147], v9 offset:4872
    ds_read_b64 v[148:149], v9 offset:4928
    ds_read_b64 v[150:151], v9 offset:4936
    ds_read_b64 v[152:153], v10 offset:5120
    ds_read_b64 v[154:155], v10 offset:5128
    ds_read_b64 v[156:157], v10 offset:5184
    ds_read_b64 v[158:159], v10 offset:5192
    ds_read_b64 v[120:121], v10 offset:5248
    ds_read_b64 v[122:123], v10 offset:5256
    ds_read_b64 v[124:125], v10 offset:5312
    ds_read_b64 v[126:127], v10 offset:5320
C_EE:
    v_mov_b32 v167, v19
    v_readfirstlane_b32 s39, v19
    v_mul_u32_u24 v5, 37, v1
    v_lshrrev_b32 v5, 8, v5
    v_mul_u32_u24 v5, 1040, v5
    v_add_u32 v5, v5, v3
    v_add_u32 v6, 0x2400, v5
    s_mul_i32 s44, s2, 18432
    s_mul_i32 s45, s38, 96
    s_add_u32 s44, s44, s45
    s_add_u32 s72, s4, s44
    s_addc_u32 s73, s5, 0
    s_add_u32 s74, s24, s45
    s_addc_u32 s75, s25, 0
    s_mul_i32 s58, s69, 1920
    s_add_u32 s58, s58, s71
    s_add_u32 s58, s58, 4352
    s_cmp_ge_u32 s38, 8
    s_cbranch_scc1 C_B5
    s_cmp_ge_u32 s38, 4
    s_cbranch_scc1 C_UQ
    s_cmp_ge_u32 s2, 144
    s_cbranch_scc1 C_B5
    v_mov_b32 v40, -1
    v_mov_b32 v41, -1
    v_mov_b32 v42, -1
    v_mov_b32 v43, -1
    v_lshlrev_b32 v20, 4, v0
    v_lshlrev_b32 v21, 3, v0
    s_lshl_b32 s48, s2, 13
    s_add_u32 s48, s48, 262144
    s_add_u32 s53, s48, 4096
    s_lshl_b32 s49, s2, 11
    s_add_u32 s49, s49, 1441792
    buffer_store_dwordx4 v[40:43], v20, s[40:43], s48 offen sc1
    buffer_store_dwordx4 v[40:43], v20, s[40:43], s53 offen sc1
    buffer_store_dwordx2 v[40:41], v21, s[40:43], s49 offen sc1
    s_branch C_KQ
C_UQ:
    v_xor_b32 v22, 0x80000000, v167
    s_movk_i32 s60, 4000
    s_waitcnt vmcnt(1)
    s_branch C_UP_C
    s_movk_i32 s60, 4000
    s_branch C_UP_W
C_UP:
    buffer_load_dwordx4 v[24:27], v3, s[40:43], s56 offen offset:0 sc1
    buffer_load_dwordx4 v[28:31], v3, s[40:43], s56 offen offset:1024 sc1
    buffer_load_dwordx4 v[32:35], v3, s[40:43], s56 offen offset:2048 sc1
    buffer_load_dwordx4 v[36:39], v3, s[40:43], s56 offen offset:3072 sc1
C_UP_W:
    s_waitcnt vmcnt(0)
C_UP_C:
    v_xor_b32 v44, v22, v27
    v_xor_b32 v45, v22, v31
    v_xor_b32 v46, v22, v35
    v_xor_b32 v47, v22, v39
    v_or3_b32 v44, v44, v45, v46
    v_or_b32 v44, v44, v47
    v_cmp_ne_u32 vcc, 0, v44
    s_nop 0
    s_and_b64 exec, exec, vcc
    s_cbranch_execz C_UP_D
    s_wqm_b64 exec, exec
    s_sub_u32 s60, s60, 1
    s_cmp_gt_i32 s60, 0
    s_sleep 2
    s_cbranch_scc1 C_UP
C_UP_D:
    s_mov_b64 exec, -1
    s_lshl_b32 s52, s38, 10
    s_add_u32 m0, s52, 47936
    v_add_u32 v18, 161412, v3
    ds_write_addtid_b32 v25 offset:55040
    ds_write_addtid_b32 v29 offset:55296
    ds_write_addtid_b32 v33 offset:55552
    ds_write_addtid_b32 v37 offset:55808
    s_mov_b64 exec, 0x2
    ds_inc_u32 v18, v18
    s_mov_b64 exec, -1
    ds_write_addtid_b32 v26 offset:60928
    ds_write_addtid_b32 v30 offset:61184
    ds_write_addtid_b32 v34 offset:61440
    ds_write_addtid_b32 v38 offset:61696
    s_mov_b64 exec, 0x4
    ds_inc_u32 v18, v18
    s_mov_b64 exec, -1
    ds_write_addtid_b32 v24 offset:49152
    ds_write_addtid_b32 v28 offset:49408
    ds_write_addtid_b32 v32 offset:49664
    ds_write_addtid_b32 v36 offset:49920
    s_mov_b64 exec, 0x1
    ds_inc_u32 v18, v18
    s_mov_b64 exec, -1
C_PO:
C_KQ:
    s_cmp_lt_u32 s2, 128
    s_cselect_b32 s52, 3, -1
    s_cmp_lg_u32 s38, s52
    s_cbranch_scc1 C_B5
    v_lshrrev_b32 v22, 2, v1
    v_mul_u32_u24 v22, 8128, v22
    v_add_u32 v22, v22, v3
    s_mul_i32 s52, s2, 64
    s_add_u32 s52, s52, 65536
    s_mov_b32 exec_lo, 0xffffffff
    s_mov_b32 exec_hi, 0x0
    buffer_store_dwordx4 v[40:43], v22, s[40:43], s52 offen sc1
    s_mov_b64 exec, -1
C_B5:
    s_mov_b32 s56, 0xf7efdfbf
    s_mov_b32 s57, 0x7efdfb
    s_movk_i32 s60, 4000
C_UF:
    ds_read_b32 v16, v166 offset:132
    s_sub_u32 s60, s60, 1
    s_cmp_gt_i32 s60, 0
    s_waitcnt lgkmcnt(0)
    v_readfirstlane_b32 s52, v16
    s_nop 0
    s_cselect_b32 s52, s52, 4
    s_cmp_lg_u32 s52, 4
    s_cbranch_scc1 C_UF
    s_movk_i32 s60, 4000
    s_cmp_eq_u32 s63, 1
    s_cbranch_scc1 C_P1
    s_cmp_eq_u32 s63, 2
    s_cbranch_scc1 C_P2
    s_cmp_eq_u32 s63, 3
    s_cbranch_scc1 C_P3
    s_setprio 2
    ds_read_b128 v[32:35], v8 offset:3552
    ds_read_b128 v[36:39], v8 offset:4064
    ds_read_b128 v[40:43], v8 offset:3680
    s_waitcnt lgkmcnt(2)
    v_mfma_f32_16x16x32_bf16 v[136:139], v[112:115], v[32:35], 0
    v_mfma_f32_16x16x32_bf16 v[140:143], v[116:119], v[32:35], 0
    v_mfma_f32_16x16x32_bf16 v[144:147], v[128:131], v[32:35], 0
    v_mfma_f32_16x16x32_bf16 v[148:151], v[132:135], v[32:35], 0
    v_mfma_f32_16x16x32_bf16 v[28:31], v[52:55], v[32:35], 0
    v_mfma_f32_16x16x32_bf16 v[20:23], v[48:51], v[32:35], 0
    ds_read_b128 v[44:47], v8 offset:3808
    s_waitcnt lgkmcnt(2)
    v_mfma_f32_16x16x32_bf16 v[152:155], v[112:115], v[36:39], 0
    v_mfma_f32_16x16x32_bf16 v[156:159], v[116:119], v[36:39], 0
    v_mfma_f32_16x16x32_bf16 v[120:123], v[128:131], v[36:39], 0
    v_mfma_f32_16x16x32_bf16 v[124:127], v[132:135], v[36:39], 0
    v_mfma_f32_16x16x32_bf16 v[28:31], v[84:87], v[36:39], v[28:31]
    v_mfma_f32_16x16x32_bf16 v[20:23], v[80:83], v[36:39], v[20:23]
    v_mfma_f32_16x16x32_bf16 v[24:27], v[52:55], v[36:39], 0
    v_mfma_f32_16x16x32_bf16 v[16:19], v[48:51], v[36:39], 0
    v_cvt_pk_bf16_f32 v136, v136, v137
    v_cvt_pk_bf16_f32 v137, v138, v139
    ds_write_b64 v4, v[136:137] offset:680
    v_cvt_pk_bf16_f32 v140, v140, v141
    v_cvt_pk_bf16_f32 v141, v142, v143
    ds_write_b64 v4, v[140:141] offset:4136
    v_cvt_pk_bf16_f32 v144, v144, v145
    v_cvt_pk_bf16_f32 v145, v146, v147
    ds_write_b64 v4, v[144:145] offset:7592
    v_cvt_pk_bf16_f32 v148, v148, v149
    v_cvt_pk_bf16_f32 v149, v150, v151
    ds_write_b64 v4, v[148:149] offset:11048
    ds_read_b128 v[32:35], v8 offset:3936
    s_waitcnt lgkmcnt(6)
    v_mfma_f32_16x16x32_bf16 v[28:31], v[60:63], v[40:43], v[28:31]
    v_mfma_f32_16x16x32_bf16 v[20:23], v[56:59], v[40:43], v[20:23]
    v_cvt_pk_bf16_f32 v152, v152, v153
    v_cvt_pk_bf16_f32 v153, v154, v155
    ds_write_b64 v4, v[152:153] offset:136
    v_cvt_pk_bf16_f32 v156, v156, v157
    v_cvt_pk_bf16_f32 v157, v158, v159
    ds_write_b64 v4, v[156:157] offset:3592
    v_cvt_pk_bf16_f32 v120, v120, v121
    v_cvt_pk_bf16_f32 v121, v122, v123
    ds_write_b64 v4, v[120:121] offset:7048
    v_cvt_pk_bf16_f32 v124, v124, v125
    v_cvt_pk_bf16_f32 v125, v126, v127
    ds_write_b64 v4, v[124:125] offset:10504
    s_mov_b64 exec, 0x1
    ds_write_b32 v166, v166 offset:0
    s_mov_b64 exec, -1
    s_setprio 0
    ds_read_b128 v[84:87], v8 offset:4192
    ds_read_b64 v[160:161], v2 offset:512
    ds_read_b64 v[162:163], v2
    s_or_b32 s52, s38, s2
    s_cbranch_scc1 C_NOEP
    s_mov_b64 exec, 0x1
    buffer_store_dword v167, v10, s[40:43], 0 offen sc1
    s_mov_b64 exec, -1
C_NOEP:
    s_cmp_ge_u32 s2, 128
    s_cbranch_scc1 C_NX0
    s_mov_b32 m0, s58
    s_mov_b64 exec, s[56:57]
    global_load_lds_dwordx4 v5, s[72:73]
    s_add_u32 m0, s58, 896
    s_nop 0
    global_load_lds_dwordx4 v6, s[72:73]
    s_add_u32 m0, s58, 1792
    s_mov_b64 exec, 0x3f
    global_load_lds_dwordx4 v3, s[74:75]
    s_mov_b64 exec, -1
C_NX0:
    s_mov_b32 m0, 163328
    s_nop 0
    global_load_lds_dword v11, s[30:31]
    s_mov_b64 exec, 0xff
    global_load_lds_dword v13, s[28:29]
    global_load_lds_dword v13, s[26:27]
    global_load_lds_dword v12, s[30:31]
    s_mov_b64 exec, -1
    s_waitcnt lgkmcnt(13)
    v_mfma_f32_16x16x32_bf16 v[28:31], v[68:71], v[44:47], v[28:31]
    v_mfma_f32_16x16x32_bf16 v[20:23], v[64:67], v[44:47], v[20:23]
    ds_read_b128 v[80:83], v8 offset:4320
    s_waitcnt lgkmcnt(9)
    v_mfma_f32_16x16x32_bf16 v[28:31], v[76:79], v[32:35], v[28:31]
    v_mfma_f32_16x16x32_bf16 v[20:23], v[72:75], v[32:35], v[20:23]
    ds_read_b128 v[36:39], v8 offset:4448
    s_waitcnt lgkmcnt(2)
    v_and_b32 v48, 0xffff0000, v161
    v_lshlrev_b32 v49, 16, v161
    v_and_b32 v50, 0xffff0000, v160
    v_lshlrev_b32 v51, 16, v160
    v_mul_f32 v48, v48, v164
    v_mul_f32 v49, v49, v164
    v_mul_f32 v50, v50, v164
    v_mul_f32 v51, v51, v164
    v_cvt_pk_bf16_f32 v49, v48, v49
    v_lshlrev_b32 v48, 16, v49
    v_and_b32 v49, 0xffff0000, v49
    v_cvt_pk_bf16_f32 v51, v50, v51
    v_lshlrev_b32 v50, 16, v51
    v_and_b32 v51, 0xffff0000, v51
    v_and_b32 v52, 0xffff0000, v163
    v_lshlrev_b32 v53, 16, v163
    v_and_b32 v54, 0xffff0000, v162
    v_lshlrev_b32 v55, 16, v162
    v_mul_f32 v52, v52, v164
    v_mul_f32 v53, v53, v164
    v_mul_f32 v54, v54, v164
    v_mul_f32 v55, v55, v164
    v_cvt_pk_bf16_f32 v53, v52, v53
    v_lshlrev_b32 v52, 16, v53
    v_and_b32 v53, 0xffff0000, v53
    v_cvt_pk_bf16_f32 v55, v54, v55
    v_lshlrev_b32 v54, 16, v55
    v_and_b32 v55, 0xffff0000, v55
    v_mfma_f32_16x16x32_bf16 v[28:31], v[92:95], v[84:87], v[28:31]
    v_mfma_f32_16x16x32_bf16 v[20:23], v[88:91], v[84:87], v[20:23]
    v_mfma_f32_16x16x32_bf16 v[24:27], v[60:63], v[84:87], v[24:27]
    v_mfma_f32_16x16x32_bf16 v[16:19], v[56:59], v[84:87], v[16:19]
    s_waitcnt lgkmcnt(1)
    v_mfma_f32_16x16x32_bf16 v[28:31], v[100:103], v[80:83], v[28:31]
    v_mfma_f32_16x16x32_bf16 v[20:23], v[96:99], v[80:83], v[20:23]
    v_mfma_f32_16x16x32_bf16 v[24:27], v[68:71], v[80:83], v[24:27]
    v_mfma_f32_16x16x32_bf16 v[16:19], v[64:67], v[80:83], v[16:19]
    s_waitcnt lgkmcnt(0)
    v_mfma_f32_16x16x32_bf16 v[28:31], v[108:111], v[36:39], v[28:31]
    v_mfma_f32_16x16x32_bf16 v[20:23], v[104:107], v[36:39], v[20:23]
    v_mfma_f32_16x16x32_bf16 v[24:27], v[76:79], v[36:39], v[24:27]
    v_mfma_f32_16x16x32_bf16 v[16:19], v[72:75], v[36:39], v[16:19]
    s_mov_b32 exec_lo, 0xc000c000
    s_mov_b32 exec_hi, 0xc000c000
    s_nop 2
    ds_write_b128 v165, v[28:31] offset:128
    ds_write_b32 v166, v166 offset:64
    s_mov_b64 exec, -1
    s_setprio 0
    s_waitcnt vmcnt(7)
    s_cmp_lt_u32 s2, 128
    s_cbranch_scc1 C_EPI
    s_waitcnt vmcnt(4)
    s_branch C_EPI
C_P1:
    s_setprio 2
    ds_read_b128 v[32:35], v8 offset:2528
    ds_read_b128 v[36:39], v8 offset:3040
    ds_read_b128 v[40:43], v8 offset:2656
    s_waitcnt lgkmcnt(2)
    v_mfma_f32_16x16x32_bf16 v[144:147], v[128:131], v[32:35], 0
    v_mfma_f32_16x16x32_bf16 v[148:151], v[132:135], v[32:35], 0
    v_mfma_f32_16x16x32_bf16 v[152:155], v[136:139], v[32:35], 0
    v_mfma_f32_16x16x32_bf16 v[156:159], v[140:143], v[32:35], 0
    v_mfma_f32_16x16x32_bf16 v[28:31], v[52:55], v[32:35], 0
    v_mfma_f32_16x16x32_bf16 v[20:23], v[48:51], v[32:35], 0
    ds_read_b128 v[44:47], v8 offset:2784
    s_waitcnt lgkmcnt(2)
    v_mfma_f32_16x16x32_bf16 v[116:119], v[128:131], v[36:39], 0
    v_mfma_f32_16x16x32_bf16 v[160:163], v[132:135], v[36:39], 0
    v_mfma_f32_16x16x32_bf16 v[120:123], v[136:139], v[36:39], 0
    v_mfma_f32_16x16x32_bf16 v[124:127], v[140:143], v[36:39], 0
    v_mfma_f32_16x16x32_bf16 v[28:31], v[84:87], v[36:39], v[28:31]
    v_mfma_f32_16x16x32_bf16 v[20:23], v[80:83], v[36:39], v[20:23]
    v_mfma_f32_16x16x32_bf16 v[24:27], v[52:55], v[36:39], 0
    v_mfma_f32_16x16x32_bf16 v[16:19], v[48:51], v[36:39], 0
    v_cvt_pk_bf16_f32 v144, v144, v145
    v_cvt_pk_bf16_f32 v145, v146, v147
    ds_write_b64 v4, v[144:145] offset:1768
    v_cvt_pk_bf16_f32 v148, v148, v149
    v_cvt_pk_bf16_f32 v149, v150, v151
    ds_write_b64 v4, v[148:149] offset:5224
    v_cvt_pk_bf16_f32 v152, v152, v153
    v_cvt_pk_bf16_f32 v153, v154, v155
    ds_write_b64 v4, v[152:153] offset:8680
    v_cvt_pk_bf16_f32 v156, v156, v157
    v_cvt_pk_bf16_f32 v157, v158, v159
    ds_write_b64 v4, v[156:157] offset:12136
    ds_read_b128 v[32:35], v8 offset:2912
    s_waitcnt lgkmcnt(6)
    v_mfma_f32_16x16x32_bf16 v[28:31], v[60:63], v[40:43], v[28:31]
    v_mfma_f32_16x16x32_bf16 v[20:23], v[56:59], v[40:43], v[20:23]
    v_cvt_pk_bf16_f32 v116, v116, v117
    v_cvt_pk_bf16_f32 v117, v118, v119
    ds_write_b64 v4, v[116:117] offset:1224
    v_cvt_pk_bf16_f32 v160, v160, v161
    v_cvt_pk_bf16_f32 v161, v162, v163
    ds_write_b64 v4, v[160:161] offset:4680
    v_cvt_pk_bf16_f32 v120, v120, v121
    v_cvt_pk_bf16_f32 v121, v122, v123
    ds_write_b64 v4, v[120:121] offset:8136
    v_cvt_pk_bf16_f32 v124, v124, v125
    v_cvt_pk_bf16_f32 v125, v126, v127
    ds_write_b64 v4, v[124:125] offset:11592
    s_mov_b64 exec, 0x1
    ds_write_b32 v166, v166 offset:4
    s_mov_b64 exec, -1
    s_setprio 1
    ds_read_b128 v[36:39], v8 offset:3168
    ds_read_b64 v[144:145], v9 offset:4608
    ds_read_b64 v[146:147], v9 offset:4616
    ds_read_b64 v[148:149], v9 offset:4672
    ds_read_b64 v[150:151], v9 offset:4680
    ds_read_b64 v[152:153], v9 offset:4736
    ds_read_b64 v[154:155], v9 offset:4744
    ds_read_b64 v[156:157], v9 offset:4800
    ds_read_b64 v[158:159], v9 offset:4808
    ds_read_b64 v[160:161], v2 offset:512
    ds_read_b64 v[162:163], v2
    s_cmp_ge_u32 s2, 128
    s_cbranch_scc1 C_NX1
    s_mov_b32 m0, s58
    s_mov_b64 exec, s[56:57]
    global_load_lds_dwordx4 v5, s[72:73]
    s_add_u32 m0, s58, 896
    s_nop 0
    global_load_lds_dwordx4 v6, s[72:73]
    s_add_u32 m0, s58, 1792
    s_mov_b64 exec, 0x3f
    global_load_lds_dwordx4 v3, s[74:75]
    s_mov_b64 exec, -1
C_NX1:
    s_waitcnt lgkmcnt(15)
    v_mfma_f32_16x16x32_bf16 v[28:31], v[68:71], v[44:47], v[28:31]
    v_mfma_f32_16x16x32_bf16 v[20:23], v[64:67], v[44:47], v[20:23]
    ds_read_b128 v[40:43], v8 offset:3296
    v_mfma_f32_16x16x32_bf16 v[28:31], v[76:79], v[32:35], v[28:31]
    v_mfma_f32_16x16x32_bf16 v[20:23], v[72:75], v[32:35], v[20:23]
    ds_read_b128 v[128:131], v8 offset:3424
    s_waitcnt lgkmcnt(2)
    v_and_b32 v48, 0xffff0000, v161
    v_lshlrev_b32 v49, 16, v161
    v_and_b32 v50, 0xffff0000, v160
    v_lshlrev_b32 v51, 16, v160
    v_mul_f32 v48, v48, v164
    v_mul_f32 v49, v49, v164
    v_mul_f32 v50, v50, v164
    v_mul_f32 v51, v51, v164
    v_cvt_pk_bf16_f32 v49, v48, v49
    v_lshlrev_b32 v48, 16, v49
    v_and_b32 v49, 0xffff0000, v49
    v_cvt_pk_bf16_f32 v51, v50, v51
    v_lshlrev_b32 v50, 16, v51
    v_and_b32 v51, 0xffff0000, v51
    v_and_b32 v52, 0xffff0000, v163
    v_lshlrev_b32 v53, 16, v163
    v_and_b32 v54, 0xffff0000, v162
    v_lshlrev_b32 v55, 16, v162
    v_mul_f32 v52, v52, v164
    v_mul_f32 v53, v53, v164
    v_mul_f32 v54, v54, v164
    v_mul_f32 v55, v55, v164
    v_cvt_pk_bf16_f32 v53, v52, v53
    v_lshlrev_b32 v52, 16, v53
    v_and_b32 v53, 0xffff0000, v53
    v_cvt_pk_bf16_f32 v55, v54, v55
    v_lshlrev_b32 v54, 16, v55
    v_and_b32 v55, 0xffff0000, v55
    v_mfma_f32_16x16x32_bf16 v[28:31], v[92:95], v[36:39], v[28:31]
    v_mfma_f32_16x16x32_bf16 v[20:23], v[88:91], v[36:39], v[20:23]
    v_mfma_f32_16x16x32_bf16 v[24:27], v[60:63], v[36:39], v[24:27]
    v_mfma_f32_16x16x32_bf16 v[16:19], v[56:59], v[36:39], v[16:19]
    ds_read_b128 v[132:135], v8 offset:3552
    s_waitcnt lgkmcnt(2)
    v_mfma_f32_16x16x32_bf16 v[28:31], v[100:103], v[40:43], v[28:31]
    v_mfma_f32_16x16x32_bf16 v[20:23], v[96:99], v[40:43], v[20:23]
    v_mfma_f32_16x16x32_bf16 v[24:27], v[68:71], v[40:43], v[24:27]
    v_mfma_f32_16x16x32_bf16 v[16:19], v[64:67], v[40:43], v[16:19]
    ds_read_b96 v[60:62], v166
    ds_read_b128 v[136:139], v8 offset:3680
    s_waitcnt lgkmcnt(3)
    v_mfma_f32_16x16x32_bf16 v[28:31], v[108:111], v[128:131], v[28:31]
    v_mfma_f32_16x16x32_bf16 v[20:23], v[104:107], v[128:131], v[20:23]
    v_mfma_f32_16x16x32_bf16 v[24:27], v[76:79], v[128:131], v[24:27]
    v_mfma_f32_16x16x32_bf16 v[16:19], v[72:75], v[128:131], v[16:19]
    s_waitcnt lgkmcnt(1)
C_FL1:
    v_min3_u32 v60, v60, v61, v62
    v_cmp_eq_u32 vcc, 0, v60
    s_nop 4
    s_cbranch_vccz C_FD1
    ds_read_b96 v[60:62], v166
    s_sub_u32 s60, s60, 1
    s_cmp_gt_i32 s60, 0
    s_waitcnt lgkmcnt(0)
    s_cbranch_scc1 C_FL1
C_FD1:
    ds_read_b128 v[140:143], v8 offset:3808
    v_mfma_f32_16x16x32_bf16 v[20:23], v[112:115], v[132:135], v[20:23]
    v_mfma_f32_16x16x32_bf16 v[24:27], v[84:87], v[132:135], v[24:27]
    v_mfma_f32_16x16x32_bf16 v[16:19], v[80:83], v[132:135], v[16:19]
    s_mov_b32 exec_lo, 0xc000c000
    s_mov_b32 exec_hi, 0xc000c000
    ds_write_b128 v165, v[28:31] offset:256
    ds_write_b32 v166, v166 offset:68
    s_mov_b64 exec, -1
    ds_read_b128 v[44:47], v8 offset:3936
    s_waitcnt lgkmcnt(4)
    v_mfma_f32_16x16x32_bf16 v[24:27], v[92:95], v[136:139], v[24:27]
    v_mfma_f32_16x16x32_bf16 v[16:19], v[88:91], v[136:139], v[16:19]
    ds_read_b128 v[32:35], v8 offset:4064
    ds_read_b64_tr_b16 v[36:37], v11 offset:0
    ds_read_b64_tr_b16 v[38:39], v12 offset:0
    ds_read_b64_tr_b16 v[68:69], v11 offset:272
    ds_read_b64_tr_b16 v[70:71], v12 offset:272
    s_waitcnt lgkmcnt(8)
    v_mfma_f32_16x16x32_bf16 v[24:27], v[100:103], v[140:143], v[24:27]
    v_mfma_f32_16x16x32_bf16 v[16:19], v[96:99], v[140:143], v[16:19]
    ds_read_b64_tr_b16 v[64:65], v11 offset:544
    ds_read_b64_tr_b16 v[66:67], v12 offset:544
    s_waitcnt lgkmcnt(7)
    v_mfma_f32_16x16x32_bf16 v[24:27], v[108:111], v[44:47], v[24:27]
    v_mfma_f32_16x16x32_bf16 v[16:19], v[104:107], v[44:47], v[16:19]
    ds_read_b64_tr_b16 v[40:41], v11 offset:816
    ds_read_b64_tr_b16 v[42:43], v12 offset:816
    s_waitcnt lgkmcnt(8)
    v_mfma_f32_16x16x32_bf16 v[16:19], v[112:115], v[32:35], v[16:19]
    s_waitcnt lgkmcnt(6)
    v_mfma_f32_16x16x32_bf16 v[20:23], v[36:39], v[156:159], v[20:23]
    v_mfma_f32_16x16x32_bf16 v[16:19], v[36:39], v[148:151], v[16:19]
    s_waitcnt lgkmcnt(4)
    v_mfma_f32_16x16x32_bf16 v[20:23], v[68:71], v[152:155], v[20:23]
    v_mfma_f32_16x16x32_bf16 v[16:19], v[68:71], v[144:147], v[16:19]
    ds_read_b32 v60, v166 offset:64
    ds_read_b128 v[56:59], v165 offset:128
    s_waitcnt lgkmcnt(4)
    v_mfma_f32_16x16x32_bf16 v[20:23], v[64:67], v[148:151], v[20:23]
    s_waitcnt lgkmcnt(2)
    v_mfma_f32_16x16x32_bf16 v[20:23], v[40:43], v[144:147], v[20:23]
    s_setprio 0
    s_waitcnt lgkmcnt(0)
C_CL1:
    v_cmp_eq_u32 vcc, 0, v60
    s_nop 4
    s_cbranch_vccz C_CD
    ds_read_b32 v60, v166 offset:64
    ds_read_b128 v[56:59], v165 offset:128
    s_sub_u32 s60, s60, 1
    s_cmp_gt_i32 s60, 0
    s_waitcnt lgkmcnt(0)
    s_cbranch_scc1 C_CL1
    s_branch C_CD
C_P2:
    s_setprio 2
    ds_read_b128 v[32:35], v8 offset:1504
    ds_read_b128 v[36:39], v8 offset:2016
    ds_read_b128 v[40:43], v8 offset:1632
    s_waitcnt lgkmcnt(2)
    v_mfma_f32_16x16x32_bf16 v[116:119], v[152:155], v[32:35], 0
    v_mfma_f32_16x16x32_bf16 v[160:163], v[156:159], v[32:35], 0
    v_mfma_f32_16x16x32_bf16 v[28:31], v[52:55], v[32:35], 0
    v_mfma_f32_16x16x32_bf16 v[20:23], v[48:51], v[32:35], 0
    ds_read_b128 v[44:47], v8 offset:1760
    s_waitcnt lgkmcnt(2)
    v_mfma_f32_16x16x32_bf16 v[120:123], v[152:155], v[36:39], 0
    v_mfma_f32_16x16x32_bf16 v[124:127], v[156:159], v[36:39], 0
    v_mfma_f32_16x16x32_bf16 v[28:31], v[84:87], v[36:39], v[28:31]
    v_mfma_f32_16x16x32_bf16 v[20:23], v[80:83], v[36:39], v[20:23]
    v_mfma_f32_16x16x32_bf16 v[24:27], v[52:55], v[36:39], 0
    v_mfma_f32_16x16x32_bf16 v[16:19], v[48:51], v[36:39], 0
    v_cvt_pk_bf16_f32 v116, v116, v117
    v_cvt_pk_bf16_f32 v117, v118, v119
    ds_write_b64 v4, v[116:117] offset:2856
    v_cvt_pk_bf16_f32 v160, v160, v161
    v_cvt_pk_bf16_f32 v161, v162, v163
    ds_write_b64 v4, v[160:161] offset:6312
    ds_read_b128 v[32:35], v8 offset:1888
    s_waitcnt lgkmcnt(4)
    v_mfma_f32_16x16x32_bf16 v[28:31], v[60:63], v[40:43], v[28:31]
    v_mfma_f32_16x16x32_bf16 v[20:23], v[56:59], v[40:43], v[20:23]
    v_cvt_pk_bf16_f32 v120, v120, v121
    v_cvt_pk_bf16_f32 v121, v122, v123
    ds_write_b64 v4, v[120:121] offset:2312
    v_cvt_pk_bf16_f32 v124, v124, v125
    v_cvt_pk_bf16_f32 v125, v126, v127
    ds_write_b64 v4, v[124:125] offset:5768
    s_mov_b64 exec, 0x1
    ds_write_b32 v166, v166 offset:8
    s_mov_b64 exec, -1
    s_setprio 1
    ds_read_b128 v[36:39], v8 offset:2144
    ds_read_b64 v[116:117], v7 offset:1088
    ds_read_b64 v[118:119], v7 offset:1096
    ds_read_b64 v[120:121], v10 offset:5120
    ds_read_b64 v[122:123], v10 offset:5128
    ds_read_b64 v[124:125], v10 offset:5184
    ds_read_b64 v[126:127], v10 offset:5192
    ds_read_b64 v[160:161], v2 offset:512
    ds_read_b64 v[162:163], v2
    s_cmp_ge_u32 s2, 128
    s_cbranch_scc1 C_NX2
    s_mov_b32 m0, s58
    s_mov_b64 exec, s[56:57]
    global_load_lds_dwordx4 v5, s[72:73]
    s_add_u32 m0, s58, 896
    s_nop 0
    global_load_lds_dwordx4 v6, s[72:73]
    s_add_u32 m0, s58, 1792
    s_mov_b64 exec, 0x3f
    global_load_lds_dwordx4 v3, s[74:75]
    s_mov_b64 exec, -1
C_NX2:
    s_waitcnt lgkmcnt(15)
    v_mfma_f32_16x16x32_bf16 v[28:31], v[68:71], v[44:47], v[28:31]
    v_mfma_f32_16x16x32_bf16 v[20:23], v[64:67], v[44:47], v[20:23]
    ds_read_b128 v[40:43], v8 offset:2272
    s_waitcnt lgkmcnt(13)
    v_mfma_f32_16x16x32_bf16 v[28:31], v[76:79], v[32:35], v[28:31]
    v_mfma_f32_16x16x32_bf16 v[20:23], v[72:75], v[32:35], v[20:23]
    ds_read_b128 v[152:155], v8 offset:2400
    s_waitcnt lgkmcnt(2)
    v_and_b32 v48, 0xffff0000, v161
    v_lshlrev_b32 v49, 16, v161
    v_and_b32 v50, 0xffff0000, v160
    v_lshlrev_b32 v51, 16, v160
    v_mul_f32 v48, v48, v164
    v_mul_f32 v49, v49, v164
    v_mul_f32 v50, v50, v164
    v_mul_f32 v51, v51, v164
    v_cvt_pk_bf16_f32 v49, v48, v49
    v_lshlrev_b32 v48, 16, v49
    v_and_b32 v49, 0xffff0000, v49
    v_cvt_pk_bf16_f32 v51, v50, v51
    v_lshlrev_b32 v50, 16, v51
    v_and_b32 v51, 0xffff0000, v51
    v_and_b32 v52, 0xffff0000, v163
    v_lshlrev_b32 v53, 16, v163
    v_and_b32 v54, 0xffff0000, v162
    v_lshlrev_b32 v55, 16, v162
    v_mul_f32 v52, v52, v164
    v_mul_f32 v53, v53, v164
    v_mul_f32 v54, v54, v164
    v_mul_f32 v55, v55, v164
    v_cvt_pk_bf16_f32 v53, v52, v53
    v_lshlrev_b32 v52, 16, v53
    v_and_b32 v53, 0xffff0000, v53
    v_cvt_pk_bf16_f32 v55, v54, v55
    v_lshlrev_b32 v54, 16, v55
    v_and_b32 v55, 0xffff0000, v55
    v_mfma_f32_16x16x32_bf16 v[28:31], v[92:95], v[36:39], v[28:31]
    v_mfma_f32_16x16x32_bf16 v[20:23], v[88:91], v[36:39], v[20:23]
    v_mfma_f32_16x16x32_bf16 v[24:27], v[60:63], v[36:39], v[24:27]
    v_mfma_f32_16x16x32_bf16 v[16:19], v[56:59], v[36:39], v[16:19]
    ds_read_b128 v[156:159], v8 offset:2528
    s_waitcnt lgkmcnt(2)
    v_mfma_f32_16x16x32_bf16 v[28:31], v[100:103], v[40:43], v[28:31]
    v_mfma_f32_16x16x32_bf16 v[20:23], v[96:99], v[40:43], v[20:23]
    v_mfma_f32_16x16x32_bf16 v[24:27], v[68:71], v[40:43], v[24:27]
    v_mfma_f32_16x16x32_bf16 v[16:19], v[64:67], v[40:43], v[16:19]
    ds_read_b128 v[44:47], v8 offset:2656
    s_waitcnt lgkmcnt(2)
    v_mfma_f32_16x16x32_bf16 v[28:31], v[108:111], v[152:155], v[28:31]
    v_mfma_f32_16x16x32_bf16 v[20:23], v[104:107], v[152:155], v[20:23]
    v_mfma_f32_16x16x32_bf16 v[24:27], v[76:79], v[152:155], v[24:27]
    v_mfma_f32_16x16x32_bf16 v[16:19], v[72:75], v[152:155], v[16:19]
    ds_read_b128 v[32:35], v8 offset:2784
    s_waitcnt lgkmcnt(2)
    v_mfma_f32_16x16x32_bf16 v[20:23], v[112:115], v[156:159], v[20:23]
    v_mfma_f32_16x16x32_bf16 v[24:27], v[84:87], v[156:159], v[24:27]
    v_mfma_f32_16x16x32_bf16 v[16:19], v[80:83], v[156:159], v[16:19]
    s_mov_b32 exec_lo, 0xc000c000
    s_mov_b32 exec_hi, 0xc000c000
    ds_write_b128 v165, v[28:31] offset:384
    ds_write_b32 v166, v166 offset:72
    s_mov_b64 exec, -1
    ds_read_b96 v[60:62], v166
    ds_read_b128 v[36:39], v8 offset:2912
    s_waitcnt lgkmcnt(5)
    v_mfma_f32_16x16x32_bf16 v[24:27], v[92:95], v[44:47], v[24:27]
    v_mfma_f32_16x16x32_bf16 v[16:19], v[88:91], v[44:47], v[16:19]
    s_waitcnt lgkmcnt(1)
C_FL2:
    v_min3_u32 v60, v60, v61, v62
    v_cmp_eq_u32 vcc, 0, v60
    s_nop 4
    s_cbranch_vccz C_FD2
    ds_read_b96 v[60:62], v166
    s_sub_u32 s60, s60, 1
    s_cmp_gt_i32 s60, 0
    s_waitcnt lgkmcnt(0)
    s_cbranch_scc1 C_FL2
C_FD2:
    ds_read_b128 v[68:71], v8 offset:3040
    v_mfma_f32_16x16x32_bf16 v[24:27], v[100:103], v[32:35], v[24:27]
    v_mfma_f32_16x16x32_bf16 v[16:19], v[96:99], v[32:35], v[16:19]
    ds_read_b128 v[64:67], v8 offset:3552
    s_waitcnt lgkmcnt(2)
    v_mfma_f32_16x16x32_bf16 v[24:27], v[108:111], v[36:39], v[24:27]
    v_mfma_f32_16x16x32_bf16 v[16:19], v[104:107], v[36:39], v[16:19]
    ds_read_b128 v[40:43], v8 offset:4064
    ds_read_b64_tr_b16 v[76:77], v13 offset:6912
    ds_read_b64_tr_b16 v[78:79], v14 offset:6912
    ds_read_b64_tr_b16 v[72:73], v13 offset:7456
    ds_read_b64_tr_b16 v[74:75], v14 offset:7456
    s_waitcnt lgkmcnt(6)
    v_mfma_f32_16x16x32_bf16 v[16:19], v[112:115], v[68:71], v[16:19]
    ds_read_b64_tr_b16 v[152:153], v11 offset:0
    ds_read_b64_tr_b16 v[154:155], v12 offset:0
    s_waitcnt lgkmcnt(7)
    v_mfma_f32_16x16x32_bf16 v[20:23], v[116:119], v[64:67], v[20:23]
    ds_read_b64_tr_b16 v[84:85], v11 offset:272
    ds_read_b64_tr_b16 v[86:87], v12 offset:272
    s_waitcnt lgkmcnt(8)
    v_mfma_f32_16x16x32_bf16 v[16:19], v[116:119], v[40:43], v[16:19]
    ds_read_b64_tr_b16 v[80:81], v11 offset:544
    ds_read_b64_tr_b16 v[82:83], v12 offset:544
    s_waitcnt lgkmcnt(8)
    v_mfma_f32_16x16x32_bf16 v[20:23], v[76:79], v[124:127], v[20:23]
    v_mfma_f32_16x16x32_bf16 v[16:19], v[76:79], v[120:123], v[16:19]
    ds_read_b64_tr_b16 v[156:157], v11 offset:816
    ds_read_b64_tr_b16 v[158:159], v12 offset:816
    s_waitcnt lgkmcnt(8)
    v_mfma_f32_16x16x32_bf16 v[20:23], v[72:75], v[120:123], v[20:23]
    ds_read_b64_tr_b16 v[92:93], v11 offset:1088
    ds_read_b64_tr_b16 v[94:95], v12 offset:1088
    s_waitcnt lgkmcnt(8)
    v_mfma_f32_16x16x32_bf16 v[16:19], v[152:155], v[148:151], v[16:19]
    ds_read_b64_tr_b16 v[88:89], v11 offset:1360
    ds_read_b64_tr_b16 v[90:91], v12 offset:1360
    s_waitcnt lgkmcnt(8)
    v_mfma_f32_16x16x32_bf16 v[16:19], v[84:87], v[144:147], v[16:19]
    ds_read_b64_tr_b16 v[44:45], v11 offset:1632
    ds_read_b64_tr_b16 v[46:47], v12 offset:1632
    s_waitcnt lgkmcnt(8)
    v_mfma_f32_16x16x32_bf16 v[20:23], v[80:83], v[148:151], v[20:23]
    v_mfma_f32_16x16x32_bf16 v[16:19], v[80:83], v[140:143], v[16:19]
    ds_read_b64_tr_b16 v[100:101], v11 offset:1904
    ds_read_b64_tr_b16 v[102:103], v12 offset:1904
    s_waitcnt lgkmcnt(8)
    v_mfma_f32_16x16x32_bf16 v[20:23], v[156:159], v[144:147], v[20:23]
    v_mfma_f32_16x16x32_bf16 v[16:19], v[156:159], v[136:139], v[16:19]
    s_waitcnt lgkmcnt(6)
    v_mfma_f32_16x16x32_bf16 v[20:23], v[92:95], v[140:143], v[20:23]
    v_mfma_f32_16x16x32_bf16 v[16:19], v[92:95], v[132:135], v[16:19]
    s_waitcnt lgkmcnt(4)
    v_mfma_f32_16x16x32_bf16 v[20:23], v[88:91], v[136:139], v[20:23]
    v_mfma_f32_16x16x32_bf16 v[16:19], v[88:91], v[128:131], v[16:19]
    ds_read_b32 v60, v166 offset:68
    ds_read_b128 v[56:59], v165 offset:256
    s_waitcnt lgkmcnt(4)
    v_mfma_f32_16x16x32_bf16 v[20:23], v[44:47], v[132:135], v[20:23]
    s_waitcnt lgkmcnt(2)
    v_mfma_f32_16x16x32_bf16 v[20:23], v[100:103], v[128:131], v[20:23]
    s_setprio 0
    s_waitcnt lgkmcnt(0)
C_CL2:
    v_cmp_eq_u32 vcc, 0, v60
    s_nop 4
    s_cbranch_vccz C_CD
    ds_read_b32 v60, v166 offset:68
    ds_read_b128 v[56:59], v165 offset:256
    s_sub_u32 s60, s60, 1
    s_cmp_gt_i32 s60, 0
    s_waitcnt lgkmcnt(0)
    s_cbranch_scc1 C_CL2
    s_branch C_CD
C_P3:
    s_setprio 1
    ds_read_b128 v[32:35], v8 offset:480
    ds_read_b128 v[36:39], v8 offset:608
    ds_read_b128 v[40:43], v8 offset:736
    ds_read_b64 v[160:161], v2 offset:512
    ds_read_b64 v[162:163], v2
    s_waitcnt lgkmcnt(4)
    v_mfma_f32_16x16x32_bf16 v[28:31], v[52:55], v[32:35], 0
    v_mfma_f32_16x16x32_bf16 v[20:23], v[48:51], v[32:35], 0
    ds_read_b128 v[44:47], v8 offset:864
    s_waitcnt lgkmcnt(4)
    v_mfma_f32_16x16x32_bf16 v[28:31], v[60:63], v[36:39], v[28:31]
    v_mfma_f32_16x16x32_bf16 v[20:23], v[56:59], v[36:39], v[20:23]
    s_cmp_lg_u32 s38, 9
    s_cbranch_scc1 C_NPL0
    s_cmp_ge_u32 s2, 96
    s_cselect_b32 s52, 16, 8
    v_lshrrev_b32 v9, 1, v3
    v_writelane_b32 v9, s52, 3
    s_and_b32 s52, s2, 31
    s_lshl_b32 s52, s52, 7
    v_add_u32 v9, s52, v9
    s_mov_b64 exec, 0xf
    buffer_load_dword v10, v9, s[40:43], 0 offen offset:2048 sc1
    s_mov_b64 exec, -1
C_NPL0:
    s_cmp_ge_u32 s2, 128
    s_cbranch_scc1 C_NX3
    s_mov_b32 m0, s58
    s_mov_b64 exec, s[56:57]
    global_load_lds_dwordx4 v5, s[72:73]
    s_add_u32 m0, s58, 896
    s_nop 0
    global_load_lds_dwordx4 v6, s[72:73]
    s_add_u32 m0, s58, 1792
    s_mov_b64 exec, 0x3f
    global_load_lds_dwordx4 v3, s[74:75]
    s_mov_b64 exec, -1
C_NX3:
    ds_read_b128 v[32:35], v8 offset:992
    s_waitcnt lgkmcnt(4)
    v_mfma_f32_16x16x32_bf16 v[28:31], v[68:71], v[40:43], v[28:31]
    v_mfma_f32_16x16x32_bf16 v[20:23], v[64:67], v[40:43], v[20:23]
    ds_read_b128 v[36:39], v8 offset:1120
    s_waitcnt lgkmcnt(2)
    v_mfma_f32_16x16x32_bf16 v[28:31], v[76:79], v[44:47], v[28:31]
    v_mfma_f32_16x16x32_bf16 v[20:23], v[72:75], v[44:47], v[20:23]
    ds_read_b128 v[40:43], v8 offset:1248
    s_waitcnt lgkmcnt(2)
    v_mfma_f32_16x16x32_bf16 v[28:31], v[84:87], v[32:35], v[28:31]
    v_mfma_f32_16x16x32_bf16 v[20:23], v[80:83], v[32:35], v[20:23]
    v_mfma_f32_16x16x32_bf16 v[24:27], v[52:55], v[32:35], 0
    v_mfma_f32_16x16x32_bf16 v[16:19], v[48:51], v[32:35], 0
    ds_read_b128 v[44:47], v8 offset:1376
    s_waitcnt lgkmcnt(2)
    v_mfma_f32_16x16x32_bf16 v[28:31], v[92:95], v[36:39], v[28:31]
    v_mfma_f32_16x16x32_bf16 v[20:23], v[88:91], v[36:39], v[20:23]
    v_mfma_f32_16x16x32_bf16 v[24:27], v[60:63], v[36:39], v[24:27]
    v_mfma_f32_16x16x32_bf16 v[16:19], v[56:59], v[36:39], v[16:19]
    ds_read_b128 v[32:35], v8 offset:1504
    v_and_b32 v48, 0xffff0000, v161
    v_lshlrev_b32 v49, 16, v161
    v_and_b32 v50, 0xffff0000, v160
    v_lshlrev_b32 v51, 16, v160
    v_mul_f32 v48, v48, v164
    v_mul_f32 v49, v49, v164
    v_mul_f32 v50, v50, v164
    v_mul_f32 v51, v51, v164
    v_cvt_pk_bf16_f32 v49, v48, v49
    v_lshlrev_b32 v48, 16, v49
    v_and_b32 v49, 0xffff0000, v49
    v_cvt_pk_bf16_f32 v51, v50, v51
    v_lshlrev_b32 v50, 16, v51
    v_and_b32 v51, 0xffff0000, v51
    v_and_b32 v52, 0xffff0000, v163
    v_lshlrev_b32 v53, 16, v163
    v_and_b32 v54, 0xffff0000, v162
    v_lshlrev_b32 v55, 16, v162
    v_mul_f32 v52, v52, v164
    v_mul_f32 v53, v53, v164
    v_mul_f32 v54, v54, v164
    v_mul_f32 v55, v55, v164
    v_cvt_pk_bf16_f32 v53, v52, v53
    v_lshlrev_b32 v52, 16, v53
    v_and_b32 v53, 0xffff0000, v53
    v_cvt_pk_bf16_f32 v55, v54, v55
    v_lshlrev_b32 v54, 16, v55
    v_and_b32 v55, 0xffff0000, v55
    s_waitcnt lgkmcnt(2)
    v_mfma_f32_16x16x32_bf16 v[28:31], v[100:103], v[40:43], v[28:31]
    v_mfma_f32_16x16x32_bf16 v[20:23], v[96:99], v[40:43], v[20:23]
    v_mfma_f32_16x16x32_bf16 v[24:27], v[68:71], v[40:43], v[24:27]
    v_mfma_f32_16x16x32_bf16 v[16:19], v[64:67], v[40:43], v[16:19]
    ds_read_b128 v[36:39], v8 offset:1632
    s_waitcnt lgkmcnt(2)
    v_mfma_f32_16x16x32_bf16 v[28:31], v[108:111], v[44:47], v[28:31]
    v_mfma_f32_16x16x32_bf16 v[20:23], v[104:107], v[44:47], v[20:23]
    v_mfma_f32_16x16x32_bf16 v[24:27], v[76:79], v[44:47], v[24:27]
    v_mfma_f32_16x16x32_bf16 v[16:19], v[72:75], v[44:47], v[16:19]
    ds_read_b128 v[68:71], v8 offset:1760
    s_waitcnt lgkmcnt(2)
    v_mfma_f32_16x16x32_bf16 v[20:23], v[112:115], v[32:35], v[20:23]
    v_mfma_f32_16x16x32_bf16 v[24:27], v[84:87], v[32:35], v[24:27]
    v_mfma_f32_16x16x32_bf16 v[16:19], v[80:83], v[32:35], v[16:19]
    ds_read_b96 v[60:62], v166
    ds_read_b128 v[64:67], v8 offset:1888
    s_waitcnt lgkmcnt(3)
    v_mfma_f32_16x16x32_bf16 v[24:27], v[92:95], v[36:39], v[24:27]
    v_mfma_f32_16x16x32_bf16 v[16:19], v[88:91], v[36:39], v[16:19]
    s_waitcnt lgkmcnt(1)
C_FL3:
    v_min3_u32 v60, v60, v61, v62
    v_cmp_eq_u32 vcc, 0, v60
    s_nop 4
    s_cbranch_vccz C_FD3
    ds_read_b96 v[60:62], v166
    s_sub_u32 s60, s60, 1
    s_cmp_gt_i32 s60, 0
    s_waitcnt lgkmcnt(0)
    s_cbranch_scc1 C_FL3
C_FD3:
    ds_read_b128 v[40:43], v8 offset:2016
    v_mfma_f32_16x16x32_bf16 v[24:27], v[100:103], v[68:71], v[24:27]
    v_mfma_f32_16x16x32_bf16 v[16:19], v[96:99], v[68:71], v[16:19]
    ds_read_b128 v[76:79], v8 offset:2528
    s_waitcnt lgkmcnt(2)
    v_mfma_f32_16x16x32_bf16 v[24:27], v[108:111], v[64:67], v[24:27]
    v_mfma_f32_16x16x32_bf16 v[16:19], v[104:107], v[64:67], v[16:19]
    ds_read_b128 v[72:75], v8 offset:3040
    ds_read_b64_tr_b16 v[44:45], v13 offset:6912
    ds_read_b64_tr_b16 v[46:47], v14 offset:6912
    ds_read_b64_tr_b16 v[84:85], v13 offset:7456
    ds_read_b64_tr_b16 v[86:87], v14 offset:7456
    s_waitcnt lgkmcnt(6)
    v_mfma_f32_16x16x32_bf16 v[16:19], v[112:115], v[40:43], v[16:19]
    ds_read_b64_tr_b16 v[80:81], v13 offset:8000
    ds_read_b64_tr_b16 v[82:83], v14 offset:8000
    s_waitcnt lgkmcnt(7)
    v_mfma_f32_16x16x32_bf16 v[20:23], v[116:119], v[76:79], v[20:23]
    ds_read_b64_tr_b16 v[32:33], v13 offset:8544
    ds_read_b64_tr_b16 v[34:35], v14 offset:8544
    s_waitcnt lgkmcnt(8)
    v_mfma_f32_16x16x32_bf16 v[16:19], v[116:119], v[72:75], v[16:19]
    ds_read_b64_tr_b16 v[92:93], v11 offset:1088
    ds_read_b64_tr_b16 v[94:95], v12 offset:1088
    s_waitcnt lgkmcnt(8)
    v_mfma_f32_16x16x32_bf16 v[20:23], v[44:47], v[124:127], v[20:23]
    v_mfma_f32_16x16x32_bf16 v[16:19], v[44:47], v[120:123], v[16:19]
    ds_read_b64_tr_b16 v[88:89], v11 offset:1360
    ds_read_b64_tr_b16 v[90:91], v12 offset:1360
    s_waitcnt lgkmcnt(8)
    v_mfma_f32_16x16x32_bf16 v[20:23], v[84:87], v[120:123], v[20:23]
    v_mfma_f32_16x16x32_bf16 v[16:19], v[84:87], v[156:159], v[16:19]
    ds_read_b64_tr_b16 v[36:37], v11 offset:1632
    ds_read_b64_tr_b16 v[38:39], v12 offset:1632
    s_waitcnt lgkmcnt(8)
    v_mfma_f32_16x16x32_bf16 v[20:23], v[80:83], v[156:159], v[20:23]
    v_mfma_f32_16x16x32_bf16 v[16:19], v[80:83], v[152:155], v[16:19]
    ds_read_b64_tr_b16 v[100:101], v11 offset:1904
    ds_read_b64_tr_b16 v[102:103], v12 offset:1904
    s_waitcnt lgkmcnt(8)
    v_mfma_f32_16x16x32_bf16 v[20:23], v[32:35], v[152:155], v[20:23]
    ds_read_b64_tr_b16 v[96:97], v11 offset:2176
    ds_read_b64_tr_b16 v[98:99], v12 offset:2176
    s_waitcnt lgkmcnt(8)
    v_mfma_f32_16x16x32_bf16 v[16:19], v[92:95], v[148:151], v[16:19]
    ds_read_b64_tr_b16 v[68:69], v11 offset:2448
    ds_read_b64_tr_b16 v[70:71], v12 offset:2448
    s_cmp_lg_u32 s38, 9
    s_cbranch_scc1 C_NPL
    s_mov_b64 exec, 0xf
    s_waitcnt vmcnt(3)
    s_cmp_lt_u32 s2, 128
    s_cbranch_scc1 C_NPW
    s_waitcnt vmcnt(0)
C_NPW:
    v_xor_b32 v5, s39, v10
    v_and_b32 v5, 0xffffdfff, v5
    v_cmp_ne_u32 vcc, 0, v5
    s_nop 4
    s_cbranch_vccz C_NPL2
    buffer_load_dword v4, v9, s[40:43], 0 offen offset:2048 sc1
C_NPL2:
    s_mov_b64 exec, -1
C_NPL:
    s_waitcnt lgkmcnt(8)
    v_mfma_f32_16x16x32_bf16 v[16:19], v[88:91], v[144:147], v[16:19]
    ds_read_b64_tr_b16 v[108:109], v11 offset:2720
    ds_read_b64_tr_b16 v[110:111], v12 offset:2720
    s_waitcnt lgkmcnt(8)
    v_mfma_f32_16x16x32_bf16 v[20:23], v[36:39], v[148:151], v[20:23]
    v_mfma_f32_16x16x32_bf16 v[16:19], v[36:39], v[140:143], v[16:19]
    ds_read_b64_tr_b16 v[104:105], v11 offset:2992
    ds_read_b64_tr_b16 v[106:107], v12 offset:2992
    s_waitcnt lgkmcnt(8)
    v_mfma_f32_16x16x32_bf16 v[20:23], v[100:103], v[144:147], v[20:23]
    v_mfma_f32_16x16x32_bf16 v[16:19], v[100:103], v[136:139], v[16:19]
    s_waitcnt lgkmcnt(6)
    v_mfma_f32_16x16x32_bf16 v[20:23], v[96:99], v[140:143], v[20:23]
    v_mfma_f32_16x16x32_bf16 v[16:19], v[96:99], v[132:135], v[16:19]
    s_waitcnt lgkmcnt(4)
    v_mfma_f32_16x16x32_bf16 v[20:23], v[68:71], v[136:139], v[20:23]
    v_mfma_f32_16x16x32_bf16 v[16:19], v[68:71], v[128:131], v[16:19]
    ds_read_b32 v60, v166 offset:72
    ds_read_b128 v[56:59], v165 offset:384
    s_waitcnt lgkmcnt(4)
    v_mfma_f32_16x16x32_bf16 v[20:23], v[108:111], v[132:135], v[20:23]
    s_waitcnt lgkmcnt(2)
    v_mfma_f32_16x16x32_bf16 v[20:23], v[104:107], v[128:131], v[20:23]
    s_setprio 0
    s_waitcnt lgkmcnt(0)
C_CL3:
    v_cmp_eq_u32 vcc, 0, v60
    s_nop 4
    s_cbranch_vccz C_CD
    ds_read_b32 v60, v166 offset:72
    ds_read_b128 v[56:59], v165 offset:384
    s_sub_u32 s60, s60, 1
    s_cmp_gt_i32 s60, 0
    s_waitcnt lgkmcnt(0)
    s_cbranch_scc1 C_CL3
C_CD:
    s_cmp_eq_u32 s38, 9
    s_cbranch_scc1 C_CD2
    s_waitcnt vmcnt(3)
    s_cmp_lt_u32 s2, 128
    s_cbranch_scc1 C_CD2
    s_waitcnt vmcnt(0)
C_CD2:
    s_mov_b32 exec_lo, 0x30003
    s_mov_b32 exec_hi, 0x30003
    s_nop 4
    v_pk_add_f32 v[16:17], v[16:17], v[56:57]
    v_pk_add_f32 v[18:19], v[18:19], v[58:59]
    s_mov_b64 exec, -1
C_EPI:
    s_nop 3
    s_movk_i32 s54, 0x3f80
    s_mov_b32 s55, 1.0
    v_add_f32_dpp v16, v24, v16 row_shr:2 row_mask:0xf bank_mask:0xf
    v_add_f32_dpp v17, v25, v17 row_shr:2 row_mask:0xf bank_mask:0xf
    v_add_f32_dpp v18, v26, v18 row_shr:2 row_mask:0xf bank_mask:0xf
    v_add_f32_dpp v19, v27, v19 row_shr:2 row_mask:0xf bank_mask:0xf
    v_add_f32_dpp v20, v28, v20 row_shr:2 row_mask:0xf bank_mask:0xf
    v_add_f32_dpp v21, v29, v21 row_shr:2 row_mask:0xf bank_mask:0xf
    v_add_f32_dpp v22, v30, v22 row_shr:2 row_mask:0xf bank_mask:0xf
    v_add_f32_dpp v23, v31, v23 row_shr:2 row_mask:0xf bank_mask:0xf
    v_add_f32_dpp v20, v24, v20 row_shl:14 row_mask:0xf bank_mask:0xf
    v_add_f32_dpp v21, v25, v21 row_shl:14 row_mask:0xf bank_mask:0xf
    v_add_f32_dpp v22, v26, v22 row_shl:14 row_mask:0xf bank_mask:0xf
    v_add_f32_dpp v23, v27, v23 row_shl:14 row_mask:0xf bank_mask:0xf
    v_cvt_pk_bf16_f32 v16, v16, v17
    v_cvt_pk_bf16_f32 v17, v18, v19
    v_cvt_pk_bf16_f32 v18, v20, v21
    v_cvt_pk_bf16_f32 v19, v22, v23
    v_dot2c_f32_bf16 v48, s54, v16
    v_dot2c_f32_bf16 v49, s55, v16
    v_dot2c_f32_bf16 v50, s54, v17
    v_dot2c_f32_bf16 v51, s55, v17
    v_dot2c_f32_bf16 v52, s54, v18
    v_dot2c_f32_bf16 v53, s55, v18
    v_dot2c_f32_bf16 v54, s54, v19
    v_dot2c_f32_bf16 v55, s55, v19
    v_cvt_pk_bf16_f32 v48, v48, v49
    v_cvt_pk_bf16_f32 v49, v50, v51
    ds_write_b64 v15, v[48:49] offset:0
    v_cvt_pk_bf16_f32 v52, v52, v53
    v_cvt_pk_bf16_f32 v53, v54, v55
    ds_write_b64 v15, v[52:53] offset:544
    v_mov_b32 v20, 161504
    s_cmp_lt_u32 s38, 8
    s_cbranch_scc1 C_GA
    s_cmp_lg_u32 s38, 9
    s_cbranch_scc1 C_NOGA
    s_mov_b64 exec, 0xf
    v_xor_b32 v5, s39, v10
    v_and_b32 v5, 0xffffdfff, v5
    v_cmp_ne_u32 vcc, 0, v5
    s_nop 4
    s_cbranch_vccz C_PL_K
    s_movk_i32 s60, 4000
    s_branch C_PL_W
C_PL:
    buffer_load_dword v4, v9, s[40:43], 0 offen offset:2048 sc1
C_PL_W:
    s_waitcnt vmcnt(0)
C_PL_C:
    v_xor_b32 v5, s39, v4
    v_and_b32 v5, 0xffffdfff, v5
    v_cmp_ne_u32 vcc, 0, v5
    s_nop 0
    s_and_b64 exec, exec, vcc
    s_cbranch_execz C_PL_D
    s_sub_u32 s60, s60, 1
    s_cmp_gt_i32 s60, 0
    s_sleep 2
    s_cbranch_scc1 C_PL
C_PL_D:
    s_mov_b64 exec, 0xf
    v_mov_b32 v10, v4
C_PL_K:
    v_lshrrev_b32 v9, 2, v3
    v_add_u32 v9, 161504, v9
    v_and_b32 v10, 0x2000, v10
    ds_write_b32 v9, v10
    s_mov_b64 exec, -1
    s_branch C_NOGA
C_GA:
    v_lshrrev_b32 v7, 5, v0
    v_lshlrev_b32 v7, 3, v7
    v_lshl_add_u32 v7, v0, 2, v7
    v_add_u32 v7, 48960, v7
    v_and_b32 v8, 0x1f0, v3
    v_and_b32 v9, 32, v1
    v_lshl_add_u32 v8, v9, 8, v8
    s_lshl_b32 s52, s2, 6
    s_lshl_b32 s53, s38, 9
    s_xor_b32 s52, s52, s53
    s_and_b32 s53, s52, 0x180
    v_xor_b32 v8, s53, v8
    s_and_b32 s52, s52, 0x1e00
    s_lshl_b32 s53, s2, 14
    s_add_u32 s52, s52, s53
    s_add_u32 s52, s52, 2621440
    s_xor_b32 s53, s52, 0x1000
    v_mov_b32 v27, v167
    v_mov_b32 v31, v167
C_NOGA:
    s_waitcnt lgkmcnt(0)
    s_barrier
    ds_read_b128 v[16:19], v20
    s_sub_u32 s45, s38, 0
    s_cmp_ge_u32 s45, 8
    s_cbranch_scc1 C_NOST
    ds_read_b32 v24, v7 offset:0
    ds_read_b32 v25, v7 offset:17408
    ds_read_b32 v26, v7 offset:34816
    ds_read_b32 v28, v7 offset:2176
    ds_read_b32 v29, v7 offset:19584
    ds_read_b32 v30, v7 offset:36992
    s_waitcnt lgkmcnt(3)
    v_xor_b32 v8, v19, v8
    buffer_store_dwordx4 v[24:27], v8, s[40:43], s52 offen sc1
    s_waitcnt lgkmcnt(0)
    buffer_store_dwordx4 v[28:31], v8, s[40:43], s53 offen sc1
C_NOST:
    s_waitcnt lgkmcnt(0)
    v_readfirstlane_b32 s0, v16
    v_readfirstlane_b32 s1, v17
    v_readfirstlane_b32 s22, v18
    s_cmp_ge_u32 s2, 176
    s_cbranch_scc1 FFN_LATE
    s_cmp_ge_u32 s2, 128
    s_cbranch_scc1 FINAL
    v_and_b32 v7, 7, v1
    v_lshrrev_b32 v8, 3, v1
    s_mul_i32 s44, s2, 18432
    s_mul_i32 s45, s38, 96
    v_mul_u32_u24 v9, 0xe0, v7
    v_mad_u32_u24 v9, v8, 12, v9
    v_add_u32 v9, s58, v9
    v_xor_b32 v10, 1, v8
    v_mad_u32_u24 v13, v10, 12, s58
    s_lshr_b32 s47, s2, 3
    s_and_b32 s48, s2, 3
    s_lshl2_add_u32 s47, s47, s48
    s_lshl_b32 s48, s38, 3
    s_xor_b32 s47, s47, s48
    s_and_b32 s47, s47, 63
    s_lshl_b32 s47, s47, 7
    v_xor_b32 v94, s47, v3
    v_lshl_add_u32 v94, v8, 15, v94
    s_and_b32 s47, s2, 4
    s_lshl_b32 s47, s47, 11
    s_cmp_lt_u32 s38, 6
    s_cselect_b32 s48, s1, s22
    s_xor_b32 s47, s47, s48
    s_lshl_b32 s48, s38, 18
    s_add_u32 s47, s47, s48
    s_add_u32 s23, s47, 2637824
    s_lshl_b32 s48, s38, 11
    s_add_u32 s47, s47, 2621440
    v_mul_u32_u24 v84, 48, v7
    v_bfe_u32 v10, v1, 3, 1
    v_lshl_add_u32 v84, v10, 2, v84
    s_lshl_b32 s49, s69, 3
    s_add_u32 s49, s49, s71
    s_add_u32 s49, s49, 14336
    v_add_u32 v84, s49, v84
    v_mul_u32_u24 v85, 48, v1
    v_add_u32 v85, 60992, v85
    s_mov_b32 exec_lo, 0xf0000f
    s_mov_b32 exec_hi, 0xf0000f00
    v_subrev_u32 v84, 1536, v84
    s_mov_b32 exec_lo, 0xff000000
    s_mov_b32 exec_hi, 0xff0000
    v_subrev_u32 v84, 768, v84
    s_mov_b32 exec_lo, 0xff00
    s_mov_b32 exec_hi, 0xff
    v_subrev_u32 v84, 2304, v84
    s_mov_b64 exec, -1
    s_add_u32 s48, s48, 0
    v_and_b32 v10, 6, v7
    v_xor_b32 v10, v10, v8
    v_lshl_add_u32 v10, v7, 3, v10
    v_lshl_add_u32 v86, v10, 4, s48
    v_and_b32 v10, 6, v8
    v_xor_b32 v10, v10, v1
    v_lshl_add_u32 v87, v10, 4, s48
    v_mul_u32_u24 v88, 2944, v8
    v_add_u32 v88, v88, v3
    s_mul_i32 s48, s2, 24576
    s_lshl_b32 s49, s38, 7
    s_add_u32 s48, s48, s49
    s_add_u32 s48, s48, 6291456
    v_mul_u32_u24 v89, 2336, v7
    v_mad_u32_u24 v89, v8, 12, v89
    s_add_u32 s45, s45, 24576
    v_add_u32 v89, s45, v89
    v_add_u32 v10, 1536, v0
    v_add_u32 v11, 0, v0
    v_mul_u32_u24 v11, 911, v11
    v_lshrrev_b32 v11, 16, v11
    v_add_lshl_u32 v90, v10, v11, 4
    v_add_u32 v10, 2304, v0
    v_add_u32 v11, 768, v0
    v_mul_u32_u24 v11, 911, v11
    v_lshrrev_b32 v11, 16, v11
    v_add_lshl_u32 v91, v10, v11, 4
    v_lshl_add_u32 v92, v0, 4, s44
    v_bfe_u32 v10, v1, 3, 1
    v_lshl_add_u32 v10, v7, 1, v10
    s_lshl_b32 s49, s2, 4
    v_add_u32 v93, s49, v10
    v_sub_u32 v12, 0x7ff, v93
    v_lshrrev_b32 v93, 4, v1
    v_mul_u32_u24 v93, 8192, v93
    v_lshl_add_u32 v93, v10, 2, v93
    s_mul_i32 s49, s2, 64
    s_add_u32 s49, s49, 65536
    s_add_u32 s59, s49, 32768
    v_mov_b32 v51, 0
    v_mov_b32 v55, 0
    v_mov_b32 v76, 0
    v_mov_b32 v56, 0
    v_mov_b32 v57, 0
    v_mov_b32 v58, 0
    v_mov_b32 v59, 0
    v_mov_b32 v60, 0
    v_mov_b32 v61, 0
    v_mov_b32 v62, 0
    v_mov_b32 v63, 0
    s_lshl_b32 s50, s2, 6
    s_lshl_b32 s51, s38, 2
    s_add_u32 s50, s50, s51
    s_add_u32 s50, s50, 8192
    s_mov_b32 s56, 0x00100001
    s_mov_b32 s57, 0x10000100
    s_mov_b32 s58, 0xffff0000
    s_waitcnt vmcnt(0)
    buffer_load_dwordx4 v[28:31], v94, s[40:43], s47 offen sc1
    buffer_load_dwordx4 v[32:35], v94, s[40:43], s23 offen sc1
    ds_read_b32 v24, v13 offset:1792
    ds_read_b32 v25, v13 offset:1796
    ds_read_b32 v26, v13 offset:1800
    ds_read2_b32 v[16:17], v9 offset0:0 offset1:1
    ds_read2_b32 v[18:19], v9 offset0:2 offset1:28
    ds_read2_b32 v[20:21], v9 offset0:29 offset1:30
    s_waitcnt lgkmcnt(0)
    v_dot2c_f32_bf16 v76, 0x3f803f80, v24
    v_dot2c_f32_bf16 v76, 0x3f803f80, v25
    v_dot2c_f32_bf16 v76, 0x3f803f80, v26
    v_lshlrev_b32 v36, 16, v16
    v_and_b32 v37, 0xffff0000, v16
    v_lshlrev_b32 v42, 16, v19
    v_and_b32 v43, 0xffff0000, v19
    v_lshlrev_b32 v38, 16, v17
    v_and_b32 v39, 0xffff0000, v17
    v_lshlrev_b32 v44, 16, v20
    v_and_b32 v45, 0xffff0000, v20
    v_lshlrev_b32 v40, 16, v18
    v_and_b32 v41, 0xffff0000, v18
    v_lshlrev_b32 v46, 16, v21
    v_and_b32 v47, 0xffff0000, v21
    v_mov_b32 v77, v76
    s_nop 1
    v_permlane16_swap_b32 v76, v77
    v_add_f32 v76, v76, v77
    v_mov_b32 v77, v76
    s_nop 1
    v_permlane32_swap_b32 v76, v77
    v_add_f32 v76, v76, v77
    s_mov_b32 exec_lo, 0xf00f0
    s_mov_b32 exec_hi, 0xf00f000
    ds_write2_b32 v84, v76, v76 offset0:0 offset1:96
    s_mov_b32 exec_lo, 0xf0f0f0f
    s_mov_b32 exec_hi, 0xf0f0f0f
    v_mov_b32 v24, 0x3f803f80
    v_mov_b32 v25, 0x3f803f80
    v_mov_b32 v26, 0x3f803f80
    s_mov_b32 exec_lo, 0x11111111
    s_mov_b32 exec_hi, 0x11111111
    v_mov_b32 v56, v24
    v_mov_b32 v57, v25
    v_mov_b32 v58, v26
    s_mov_b32 exec_lo, 0x22222222
    s_mov_b32 exec_hi, 0x22222222
    v_mov_b32 v60, v24
    v_mov_b32 v61, v25
    v_mov_b32 v62, v26
    s_mov_b64 exec, -1
    s_movk_i32 s60, 4000
    s_branch L_YP_W
L_YP:
    buffer_load_dwordx4 v[28:31], v94, s[40:43], s47 offen sc1
    buffer_load_dwordx4 v[32:35], v94, s[40:43], s23 offen sc1
L_YP_W:
    s_waitcnt vmcnt(0)
L_YP_C:
    v_xor_b32 v10, v167, v31
    v_xor_b32 v11, v167, v35
    v_or_b32 v10, v10, v11
    v_cmp_ne_u32 vcc, 0, v10
    s_nop 0
    s_and_b64 exec, exec, vcc
    s_cbranch_execz L_YP_D
    s_wqm_b64 exec, exec
    s_sub_u32 s60, s60, 1
    s_cmp_gt_i32 s60, 0
    s_sleep 1
    s_cbranch_scc1 L_YP
L_YP_D:
    s_mov_b64 exec, -1
    v_dot2c_f32_bf16 v36, s54, v28
    v_dot2c_f32_bf16 v37, s54, v29
    v_dot2c_f32_bf16 v38, s54, v30
    v_dot2c_f32_bf16 v39, s54, v34
    v_dot2c_f32_bf16 v40, s54, v32
    v_dot2c_f32_bf16 v41, s54, v33
    v_dot2c_f32_bf16 v42, s55, v28
    v_dot2c_f32_bf16 v43, s55, v29
    v_dot2c_f32_bf16 v44, s55, v30
    v_dot2c_f32_bf16 v45, s55, v34
    v_cvt_pk_bf16_f32 v48, v36, v37
    v_dot2c_f32_bf16 v46, s55, v32
    v_cvt_pk_bf16_f32 v49, v38, v39
    v_dot2c_f32_bf16 v47, s55, v33
    v_cvt_pk_bf16_f32 v50, v40, v41
    v_cvt_pk_bf16_f32 v52, v42, v43
    v_cvt_pk_bf16_f32 v53, v44, v45
    v_mfma_f32_16x16x32_bf16 v[68:71], v[48:51], v[48:51], 0
    v_cvt_pk_bf16_f32 v54, v46, v47
    v_mfma_f32_16x16x32_bf16 v[64:67], v[56:59], v[48:51], 0
    s_nop 0
    v_mfma_f32_16x16x32_bf16 v[64:67], v[60:63], v[52:55], v[64:67]
    v_mfma_f32_16x16x32_bf16 v[72:75], v[52:55], v[52:55], 0
    v_lshlrev_b32 v36, 16, v48
    v_and_b32 v37, 0xffff0000, v48
    v_lshlrev_b32 v38, 16, v49
    v_and_b32 v39, 0xffff0000, v49
    v_lshlrev_b32 v40, 16, v50
    v_and_b32 v41, 0xffff0000, v50
    s_mov_b64 exec, s[56:57]
    v_mov_b32 v64, v68
    v_mov_b32 v65, v72
    s_lshl_b64 exec, exec, 1
    v_mov_b32 v64, v69
    v_mov_b32 v65, v73
    s_lshl_b64 exec, exec, 1
    v_mov_b32 v64, v70
    v_mov_b32 v65, v74
    s_lshl_b64 exec, exec, 1
    v_mov_b32 v64, v71
    v_mov_b32 v65, v75
    s_mov_b32 exec_lo, 0xfff0ff0f
    s_mov_b32 exec_hi, 0xf0ff0fff
    ds_write2_b32 v84, v64, v65 offset0:0 offset1:96
    s_mov_b64 exec, -1
    s_cmp_eq_u32 s38, 0
    s_cbranch_scc0 L_NP
    s_setprio 3
    v_lshlrev_b32 v42, 16, v52
    v_and_b32 v43, 0xffff0000, v52
    v_lshlrev_b32 v44, 16, v53
    v_and_b32 v45, 0xffff0000, v53
    v_lshlrev_b32 v46, 16, v54
    v_and_b32 v47, 0xffff0000, v54
    v_add_u32 v10, 1168, v89
    v_add_u32 v11, 12288, v92
L_NP:
    s_waitcnt lgkmcnt(0)
    s_barrier
    s_cbranch_scc1 L_HS
    s_setprio 1
    v_lshlrev_b32 v42, 16, v52
    v_and_b32 v43, 0xffff0000, v52
    v_lshlrev_b32 v44, 16, v53
    v_and_b32 v45, 0xffff0000, v53
    v_lshlrev_b32 v46, 16, v54
    v_and_b32 v47, 0xffff0000, v54
    v_add_u32 v10, 1168, v89
    v_add_u32 v11, 12288, v92
L_HS:
    ds_read_b128 v[52:55], v85 offset:0
    ds_read_b128 v[56:59], v85 offset:16
    ds_read_b128 v[60:63], v85 offset:17408
    ds_read_b128 v[64:67], v85 offset:17424
    ds_read_b128 v[68:71], v85 offset:34816
    ds_read_b128 v[72:75], v85 offset:34832
    s_waitcnt lgkmcnt(4)
    s_waitcnt lgkmcnt(2)
    v_pk_add_f32 v[52:53], v[52:53], v[60:61]
    v_pk_add_f32 v[54:55], v[54:55], v[62:63]
    v_pk_add_f32 v[56:57], v[56:57], v[64:65]
    v_pk_add_f32 v[58:59], v[58:59], v[66:67]
    s_waitcnt lgkmcnt(0)
    v_pk_add_f32 v[52:53], v[52:53], v[68:69]
    v_pk_add_f32 v[54:55], v[54:55], v[70:71]
    v_pk_add_f32 v[56:57], v[56:57], v[72:73]
    v_pk_add_f32 v[58:59], v[58:59], v[74:75]
    v_pk_add_f32 v[52:53], v[52:53], v[54:55]
    v_pk_add_f32 v[56:57], v[56:57], v[58:59]
    v_pk_add_f32 v[52:53], v[52:53], v[56:57]
    v_add_f32 v76, v52, v53
    v_add_f32 v78, v52, v53
    s_nop 1
    v_permlane16_swap_b32 v76, v78
    v_mov_b32 v77, v76
    v_mov_b32 v13, v78
    s_nop 0
    v_permlane32_swap_b32 v76, v77
    v_permlane32_swap_b32 v78, v13
    v_mul_f32 v76, 0x3ae38e39, v76
    v_mul_f32 v78, 0x3ae38e39, v78
    v_fma_f32 v78, -v76, v76, v78
    v_max_f32 v78, 0, v78
    v_cvt_pk_bf16_f32 v78, v76, v78
    v_and_b32 v82, 0xffff0000, v78
    v_lshlrev_b32 v80, 16, v78
    v_add_f32 v82, 0x3727c5ac, v82
    v_lshlrev_b32 v81, 16, v78
    v_cvt_pk_bf16_f32 v82, v82, v82
    v_lshlrev_b32 v82, 16, v82
    v_sqrt_f32 v82, v82
    v_fma_f32 v77, -v80, v13, v77
    v_cvt_pk_bf16_f32 v82, v82, v82
    v_lshlrev_b32 v82, 16, v82
    v_rcp_f32 v83, v82
    v_rcp_f32 v82, v82
    s_cbranch_scc0 L_NK
    v_mul_f32 v77, v77, v83
    v_cvt_pk_bf16_f32 v77, v77, v77
    v_ashrrev_i32 v76, 31, v77
    v_or_b32 v76, 0x80000000, v76
    v_xor_b32 v76, v76, v77
    v_and_or_b32 v76, v76, s58, v12
    buffer_store_dword v76, v93, s[40:43], s49 offen sc1
    buffer_store_dword v76, v93, s[40:43], s59 offen sc1
    s_setprio 1
L_NK:
    v_mov_b32_dpp v80, v80 row_ror:8 row_mask:0xf bank_mask:0xc
    v_mov_b32_dpp v81, v81 row_ror:8 row_mask:0xf bank_mask:0x3
    v_mov_b32_dpp v82, v82 row_ror:8 row_mask:0xf bank_mask:0xc
    v_mov_b32_dpp v83, v83 row_ror:8 row_mask:0xf bank_mask:0x3
    v_pk_add_f32 v[56:57], v[36:37], v[80:81] op_sel_hi:[1,0] neg_lo:[0,1] neg_hi:[0,1]
    v_pk_add_f32 v[58:59], v[38:39], v[80:81] op_sel_hi:[1,0] neg_lo:[0,1] neg_hi:[0,1]
    v_pk_add_f32 v[60:61], v[40:41], v[80:81] op_sel_hi:[1,0] neg_lo:[0,1] neg_hi:[0,1]
    v_pk_add_f32 v[62:63], v[42:43], v[80:81] op_sel:[0,1] neg_lo:[0,1] neg_hi:[0,1]
    v_pk_add_f32 v[64:65], v[44:45], v[80:81] op_sel:[0,1] neg_lo:[0,1] neg_hi:[0,1]
    v_pk_add_f32 v[66:67], v[46:47], v[80:81] op_sel:[0,1] neg_lo:[0,1] neg_hi:[0,1]
    v_cvt_pk_bf16_f32 v57, v56, v57
    v_cvt_pk_bf16_f32 v59, v58, v59
    v_cvt_pk_bf16_f32 v61, v60, v61
    v_cvt_pk_bf16_f32 v63, v62, v63
    v_cvt_pk_bf16_f32 v65, v64, v65
    v_cvt_pk_bf16_f32 v67, v66, v67
    v_lshlrev_b32 v56, 16, v57
    v_and_b32 v57, 0xffff0000, v57
    v_lshlrev_b32 v58, 16, v59
    v_and_b32 v59, 0xffff0000, v59
    v_lshlrev_b32 v60, 16, v61
    v_and_b32 v61, 0xffff0000, v61
    v_lshlrev_b32 v62, 16, v63
    v_and_b32 v63, 0xffff0000, v63
    v_lshlrev_b32 v64, 16, v65
    v_and_b32 v65, 0xffff0000, v65
    v_lshlrev_b32 v66, 16, v67
    v_and_b32 v67, 0xffff0000, v67
    v_pk_mul_f32 v[56:57], v[56:57], v[82:83] op_sel_hi:[1,0]
    v_pk_mul_f32 v[58:59], v[58:59], v[82:83] op_sel_hi:[1,0]
    v_pk_mul_f32 v[60:61], v[60:61], v[82:83] op_sel_hi:[1,0]
    v_pk_mul_f32 v[62:63], v[62:63], v[82:83] op_sel:[0,1]
    v_pk_mul_f32 v[64:65], v[64:65], v[82:83] op_sel:[0,1]
    v_pk_mul_f32 v[66:67], v[66:67], v[82:83] op_sel:[0,1]
    v_cvt_pk_bf16_f32 v28, v56, v57
    v_cvt_pk_bf16_f32 v29, v58, v59
    v_cvt_pk_bf16_f32 v30, v60, v61
    ds_write_b128 v86, v[28:31]
    v_cvt_pk_bf16_f32 v32, v62, v63
    v_cvt_pk_bf16_f32 v33, v64, v65
    v_cvt_pk_bf16_f32 v34, v66, v67
    ds_write_b128 v86, v[32:35] offset:1024
    ds_read_b128 v[56:59], v87
    ds_read_b128 v[60:63], v87 offset:1024
    s_waitcnt lgkmcnt(1)
    buffer_store_dwordx4 v[56:59], v88, s[40:43], s48 offen sc1
    s_waitcnt lgkmcnt(0)
    buffer_store_dwordx4 v[60:63], v88, s[40:43], s48 offen offset:1536 sc1
    s_setprio 0
    v_dot2c_f32_bf16 v36, s54, v28
    v_dot2c_f32_bf16 v37, s55, v28
    v_dot2c_f32_bf16 v38, s54, v29
    v_dot2c_f32_bf16 v39, s55, v29
    v_dot2c_f32_bf16 v40, s54, v30
    v_dot2c_f32_bf16 v41, s55, v30
    v_dot2c_f32_bf16 v42, s54, v32
    v_dot2c_f32_bf16 v43, s55, v32
    v_dot2c_f32_bf16 v44, s54, v33
    v_dot2c_f32_bf16 v45, s55, v33
    v_dot2c_f32_bf16 v46, s54, v34
    v_dot2c_f32_bf16 v47, s55, v34
    v_cvt_pk_bf16_f32 v48, v36, v37
    v_cvt_pk_bf16_f32 v49, v38, v39
    v_cvt_pk_bf16_f32 v50, v40, v41
    v_cvt_pk_bf16_f32 v51, v42, v43
    v_cvt_pk_bf16_f32 v52, v44, v45
    v_cvt_pk_bf16_f32 v53, v46, v47
    ds_write2_b32 v89, v48, v49 offset0:0 offset1:1
    ds_write_b32 v89, v50 offset:8
    ds_write2_b32 v10, v51, v52 offset0:0 offset1:1
    ds_write_b32 v10, v53 offset:8
    s_waitcnt lgkmcnt(0)
    s_barrier
    ds_read_b128 v[16:19], v90
    ds_read_b128 v[20:23], v91
    v_mov_b32 v10, 0
    s_waitcnt lgkmcnt(1)
    global_store_dwordx4 v92, v[16:19], s[32:33] sc1
    s_cmp_ge_u32 s38, 6
    s_cbranch_scc1 L_O1
    s_waitcnt lgkmcnt(0)
    global_store_dwordx4 v11, v[20:23], s[32:33] sc1
L_O1:
    s_cmp_eq_u32 s38, 11
    s_cbranch_scc1 TOP8
    s_waitcnt vmcnt(0)
    s_mov_b64 exec, 0x1
    buffer_store_dword v167, v10, s[40:43], s50 offen sc1
    s_mov_b64 exec, -1
    s_branch END
FFN_DMA0:
    s_sub_u32 s58, s2, 192
    s_and_b32 s61, s58, 7
    s_lshr_b32 s59, s58, 3
    s_lshl3_add_u32 s61, s61, s59
    s_lshl_b32 s61, s61, 1
    s_mov_b32 s59, 8
    s_mov_b32 s57, 73728
    s_add_u32 s56, s38, 1
    s_bfe_u32 s50, s56, 0x10003
    s_and_b32 s51, s56, 1
    s_bfe_u32 s52, s56, 0x10001
    s_mul_i32 s52, s52, 36
    s_add_u32 s52, s52, s51
    s_mul_i32 s48, s52, 73728
    s_lshl_b32 s53, s61, 6
    s_add_u32 s48, s48, s53
    s_lshl_b32 s49, s52, 10
    s_mul_i32 s53, s50, 73728
    s_add_u32 s49, s49, s53
    s_lshl_b32 s51, s51, 1
    s_lshl_b32 s53, s50, 2
    s_or_b32 s51, s51, s53
    v_bfe_u32 v2, v1, 4, 1
    v_and_b32 v4, 7, v1
    v_xor_b32 v2, v2, v4
    v_xor_b32 v2, s51, v2
    v_lshrrev_b32 v4, 3, v1
    v_mul_u32_u24 v4, 0x2400, v4
    v_lshl_add_u32 v2, v2, 4, v4
    s_mov_b32 s46, 5308416
    s_mov_b32 s47, 0x00020000
    s_waitcnt lgkmcnt(0)
    s_cmp_eq_u32 s50, 0
    s_cselect_b32 s44, s26, s28
    s_cselect_b32 s45, s27, s29
    s_mov_b32 s40, s36
    s_mov_b32 s41, s37
    s_barrier
    s_sub_u32 s51, s38, 3
    s_cmp_ge_u32 s51, 8
    s_cbranch_scc1 F_B0
    s_add_u32 m0, s49, 0
    s_add_u32 s53, s48, 0
    buffer_load_dwordx4 v2, s[44:47], s53 offen lds
    s_add_u32 m0, s49, 2048
    s_add_u32 s53, s48, 147456
    buffer_load_dwordx4 v2, s[44:47], s53 offen lds
    s_add_u32 m0, s49, 4096
    s_add_u32 s53, s48, 294912
    buffer_load_dwordx4 v2, s[44:47], s53 offen lds
    s_barrier
    s_branch F_B2
FFN_LATE:
    s_and_b32 s61, s2, 7
    s_lshl_b32 s61, s61, 1
    s_bitcmp0_b32 s2, 3
    s_addc_u32 s61, s61, 128
    s_sub_u32 s58, s2, 112
    s_mov_b32 s59, 4
    s_mov_b32 s57, 0
    v_mov_b32 v32, 0
    v_mov_b32 v33, 0
    v_mov_b32 v34, 0
    v_mov_b32 v35, 0
    v_mov_b32 v36, 0
    v_mov_b32 v37, 0
    v_mov_b32 v38, 0
    v_mov_b32 v39, 0
    v_mov_b32 v40, 0
    v_mov_b32 v41, 0
    v_mov_b32 v42, 0
    v_mov_b32 v43, 0
    v_mov_b32 v44, 0
    v_mov_b32 v45, 0
    v_mov_b32 v46, 0
    v_mov_b32 v47, 0
    s_sub_u32 s51, s38, 3
    s_cmp_ge_u32 s51, 8
    s_cbranch_scc1 F_B0
    s_add_u32 s56, s38, 1
    s_bfe_u32 s50, s56, 0x10003
    s_and_b32 s51, s56, 1
    s_bfe_u32 s52, s56, 0x10001
    s_lshl1_add_u32 s52, s50, s52
    s_mul_i32 s52, s52, 18
    s_add_u32 s52, s52, s51
    s_mul_i32 s48, s52, 73728
    s_lshl_b32 s53, s61, 6
    s_add_u32 s48, s48, s53
    s_lshl_b32 m0, s52, 10
    s_lshl_b32 s51, s51, 1
    s_add_u32 s44, s26, s48
    s_addc_u32 s45, s27, 0
    s_add_u32 s46, s28, s48
    s_addc_u32 s47, s29, 0
    v_bfe_u32 v2, v1, 4, 1
    v_xor_b32 v2, v2, v1
    v_xor_b32 v2, s51, v2
    v_and_b32 v2, 3, v2
    v_lshrrev_b32 v4, 3, v1
    v_mul_u32_u24 v4, 0x2400, v4
    v_lshl_add_u32 v2, v2, 4, v4
    v_mov_b32 v4, s44
    v_mov_b32 v5, s45
    s_mov_b32 exec_lo, 0xf0f0f0f0
    s_mov_b32 exec_hi, 0xf0f0f0f0
    v_mov_b32 v4, s46
    v_mov_b32 v5, s47
    s_mov_b64 exec, -1
    v_add_co_u32 v4, vcc, v4, v2
    s_nop 1
    v_addc_co_u32 v5, vcc, 0, v5, vcc
    s_barrier
    global_load_lds_dwordx4 v[4:5], off
    v_add_co_u32 v4, vcc, 147456, v4
    s_add_u32 m0, m0, 2048
    s_nop 0
    v_addc_co_u32 v5, vcc, 0, v5, vcc
    global_load_lds_dwordx4 v[4:5], off
    v_add_co_u32 v4, vcc, 147456, v4
    s_add_u32 m0, m0, 2048
    s_nop 0
    v_addc_co_u32 v5, vcc, 0, v5, vcc
    global_load_lds_dwordx4 v[4:5], off
    v_add_co_u32 v4, vcc, 147456, v4
    s_add_u32 m0, m0, 2048
    s_nop 0
    v_addc_co_u32 v5, vcc, 0, v5, vcc
    global_load_lds_dwordx4 v[4:5], off
    v_add_co_u32 v4, vcc, 147456, v4
    s_add_u32 m0, m0, 2048
    s_nop 0
    v_addc_co_u32 v5, vcc, 0, v5, vcc
    global_load_lds_dwordx4 v[4:5], off
    v_add_co_u32 v4, vcc, 147456, v4
    s_add_u32 m0, m0, 2048
    s_nop 0
    v_addc_co_u32 v5, vcc, 0, v5, vcc
    global_load_lds_dwordx4 v[4:5], off
    v_add_co_u32 v4, vcc, 147456, v4
    s_add_u32 m0, m0, 2048
    s_nop 0
    v_addc_co_u32 v5, vcc, 0, v5, vcc
    global_load_lds_dwordx4 v[4:5], off
    v_add_co_u32 v4, vcc, 147456, v4
    s_add_u32 m0, m0, 2048
    s_nop 0
    v_addc_co_u32 v5, vcc, 0, v5, vcc
    global_load_lds_dwordx4 v[4:5], off
    v_add_co_u32 v4, vcc, 147456, v4
    s_add_u32 m0, m0, 2048
    s_nop 0
    v_addc_co_u32 v5, vcc, 0, v5, vcc
    global_load_lds_dwordx4 v[4:5], off
    s_branch F_W
F_L2:
    s_sub_u32 s51, s38, 3
    s_cmp_ge_u32 s51, 8
    s_cbranch_scc1 F_B0
    s_add_u32 s56, s38, 1
    s_bfe_u32 s50, s56, 0x10003
    s_and_b32 s51, s56, 1
    s_bfe_u32 s52, s56, 0x10001
    s_mul_i32 s52, s52, 36
    s_add_u32 s52, s52, s51
    s_mul_i32 s48, s52, 73728
    s_lshl_b32 s53, s61, 6
    s_add_u32 s48, s48, s53
    s_lshl_b32 s49, s52, 10
    s_mul_i32 s53, s50, 73728
    s_add_u32 s49, s49, s53
    s_lshl_b32 s51, s51, 1
    s_lshl_b32 s53, s50, 2
    s_or_b32 s51, s51, s53
    v_bfe_u32 v2, v1, 4, 1
    v_and_b32 v4, 7, v1
    v_xor_b32 v2, v2, v4
    v_xor_b32 v2, s51, v2
    v_lshrrev_b32 v4, 3, v1
    v_mul_u32_u24 v4, 0x2400, v4
    v_lshl_add_u32 v2, v2, 4, v4
    s_mov_b32 s46, 5308416
    s_mov_b32 s47, 0x00020000
    s_cmp_eq_u32 s50, 0
    s_cselect_b32 s44, s26, s28
    s_cselect_b32 s45, s27, s29
F_B1:
    s_barrier
    s_add_u32 m0, s49, 0
    s_add_u32 s53, s48, 0
    buffer_load_dwordx4 v2, s[44:47], s53 offen lds
    s_add_u32 m0, s49, 2048
    s_add_u32 s53, s48, 147456
    buffer_load_dwordx4 v2, s[44:47], s53 offen lds
    s_add_u32 m0, s49, 4096
    s_add_u32 s53, s48, 294912
    buffer_load_dwordx4 v2, s[44:47], s53 offen lds
F_B2:
    s_add_u32 m0, s49, 6144
    s_add_u32 s53, s48, 442368
    buffer_load_dwordx4 v2, s[44:47], s53 offen lds
    s_add_u32 m0, s49, 8192
    s_add_u32 s53, s48, 589824
    buffer_load_dwordx4 v2, s[44:47], s53 offen lds
    s_add_u32 m0, s49, 10240
    s_add_u32 s53, s48, 737280
    buffer_load_dwordx4 v2, s[44:47], s53 offen lds
    s_add_u32 m0, s49, 12288
    s_add_u32 s53, s48, 884736
    buffer_load_dwordx4 v2, s[44:47], s53 offen lds
    s_add_u32 m0, s49, 14336
    s_add_u32 s53, s48, 1032192
    buffer_load_dwordx4 v2, s[44:47], s53 offen lds
    s_add_u32 m0, s49, 16384
    s_add_u32 s53, s48, 1179648
    buffer_load_dwordx4 v2, s[44:47], s53 offen lds
    s_add_u32 m0, s49, 18432
    s_add_u32 s53, s48, 1327104
    buffer_load_dwordx4 v2, s[44:47], s53 offen lds
    s_add_u32 m0, s49, 20480
    s_add_u32 s53, s48, 1474560
    buffer_load_dwordx4 v2, s[44:47], s53 offen lds
    s_add_u32 m0, s49, 22528
    s_add_u32 s53, s48, 1622016
    buffer_load_dwordx4 v2, s[44:47], s53 offen lds
    s_add_u32 m0, s49, 24576
    s_add_u32 s53, s48, 1769472
    buffer_load_dwordx4 v2, s[44:47], s53 offen lds
    s_add_u32 m0, s49, 26624
    s_add_u32 s53, s48, 1916928
    buffer_load_dwordx4 v2, s[44:47], s53 offen lds
    s_add_u32 m0, s49, 28672
    s_add_u32 s53, s48, 2064384
    buffer_load_dwordx4 v2, s[44:47], s53 offen lds
    s_add_u32 m0, s49, 30720
    s_add_u32 s53, s48, 2211840
    buffer_load_dwordx4 v2, s[44:47], s53 offen lds
    s_add_u32 m0, s49, 32768
    s_add_u32 s53, s48, 2359296
    buffer_load_dwordx4 v2, s[44:47], s53 offen lds
    s_add_u32 m0, s49, 34816
    s_add_u32 s53, s48, 2506752
    buffer_load_dwordx4 v2, s[44:47], s53 offen lds
    s_branch F_W
FFN_DMA:
    s_setprio 0
    s_sub_u32 s58, s2, 192
    s_and_b32 s61, s58, 7
    s_lshr_b32 s59, s58, 3
    s_lshl3_add_u32 s61, s61, s59
    s_lshl_b32 s61, s61, 1
    s_mov_b32 s59, 8
    s_mov_b32 s57, 73728
    s_branch F_L2
F_B0:
    s_setprio 3
    s_sub_u32 s52, s2, 192
    s_and_b32 s53, s52, 0xffffffe7
    s_xor_b32 s54, s38, 11
    s_or_b32 s53, s53, s54
    s_cbranch_scc1 F_NM
    s_cmp_eq_u32 s52, 24
    s_cbranch_scc1 F_NM
    s_lshl_b32 s53, s52, 18
    s_cmp_eq_u32 s52, 16
    s_cselect_b32 s53, 5767168, s53
    s_add_u32 s53, s53, 16384
    s_add_u32 s54, s53, 8192
    v_mov_b32 v10, 0
    v_mov_b32 v11, 161416
    s_mov_b64 exec, 0x1
    s_mov_b32 s62, -1
    s_movk_i32 s60, 8
F_ML:
    s_xor_b32 s53, s53, 0x2000
    s_xor_b32 s54, s54, 0x2000
    buffer_store_dword v10, v10, s[40:43], s53 offen offset:0 sc1
    buffer_store_dword v10, v10, s[40:43], s54 offen offset:0 sc1
    v_add_u32 v10, 0x80, v10
    s_waitcnt vmcnt(1)
    s_memtime s[64:65]
    s_waitcnt vmcnt(0)
    s_memtime s[66:67]
    s_sub_u32 s60, s60, 1
    s_cselect_b32 s62, 0, s62
    s_waitcnt lgkmcnt(0)
    s_sub_u32 s64, s66, s64
    s_cmp_lt_u32 s64, s62
    s_movk_i32 s62, 64
    s_cbranch_scc1 F_ML
    v_mov_b32 v10, 0
    s_bitcmp1_b32 s53, 13
    s_cselect_b32 s53, 0x2000, 0
    s_movk_i32 s60, 4000
    s_mov_b32 exec_lo, 0xffffffff
    s_mov_b32 exec_hi, 0x0
    v_lshlrev_b32 v10, 7, v1
F_MT:
    ds_read_b64 v[12:13], v11
    s_sub_u32 s60, s60, 1
    s_cmp_gt_i32 s60, 0
    s_waitcnt lgkmcnt(0)
    v_readfirstlane_b32 s54, v12
    s_nop 0
    s_cselect_b32 s54, s54, 1
    s_cmp_lg_u32 s54, 1
    s_cbranch_scc1 F_MT
    v_and_b32 v13, 0xffffdfff, v13
    v_or_b32 v13, s53, v13
    buffer_store_dword v13, v10, s[40:43], s52 offen offset:2048 sc1
    s_mov_b64 exec, -1
F_NM:
    s_barrier
F_W:
    s_mov_b64 exec, -1
    v_mov_b32 v167, 161420
    ds_read_b32 v167, v167
    v_and_b32 v7, 7, v1
    v_lshrrev_b32 v8, 3, v1
    v_and_b32 v5, 15, v1
    v_lshrrev_b32 v6, 4, v1
    s_mul_i32 s52, s61, 36864
    s_mul_i32 s53, s38, 96
    s_add_u32 s52, s52, s53
    v_mul_u32_u24 v9, 0x480, v8
    v_mad_u32_u24 v9, v7, 12, v9
    v_add_u32 v9, s52, v9
    global_load_dwordx3 v[16:18], v9, s[30:31]
    v_add_u32 v9, 0x2400, v9
    global_load_dwordx3 v[20:22], v9, s[30:31]
    v_add_u32 v9, 0x2400, v9
    global_load_dwordx3 v[24:26], v9, s[30:31]
    v_add_u32 v9, 0x2400, v9
    global_load_dwordx3 v[28:30], v9, s[30:31]
    v_add_u32 v9, 0x2400, v9
    s_cmp_eq_u32 s59, 4
    s_cbranch_scc1 F_W4
    global_load_dwordx3 v[32:34], v9, s[30:31]
    v_add_u32 v9, 0x2400, v9
    global_load_dwordx3 v[36:38], v9, s[30:31]
    v_add_u32 v9, 0x2400, v9
    global_load_dwordx3 v[40:42], v9, s[30:31]
    v_add_u32 v9, 0x2400, v9
    global_load_dwordx3 v[44:46], v9, s[30:31]
F_W4:
    v_mul_u32_u24 v10, 683, v0
    v_lshrrev_b32 v10, 16, v10
    v_mul_u32_u24 v11, 0x60, v10
    v_sub_u32 v11, v0, v11
    s_mov_b32 s52, 161920
    v_lshl_add_u32 v160, v10, 2, s52
    v_and_b32 v63, 4, v10
    v_lshl_add_u32 v160, v63, 2, v160
    v_mov_b32 v63, 161492
    s_mov_b32 s52, 3144192
    v_lshl_add_u32 v161, v11, 4, s52
    v_mul_u32_u24 v162, 608, v10
    v_mad_u32_u24 v162, v11, 6, v162
    v_and_b32 v11, 1, v11
    v_mul_u32_u24 v11, 4862, v11
    v_sub_u32 v2, v162, v11
    v_add_u32 v2, 152320, v2
    v_add_u32 v162, 147456, v162
    v_add_u32 v162, v11, v162
    v_mul_u32_u24 v163, 608, v5
    v_lshl_add_u32 v163, v6, 4, v163
    v_add_u32 v163, 147456, v163
    s_lshr_b32 s52, s38, 2
    s_lshl_b32 s52, s52, 10
    s_and_b32 s53, s38, 3
    s_lshl_b32 s53, s53, 2
    s_add_u32 s52, s52, s53
    s_add_u32 s52, s52, 157184
    v_add_u32 v164, s52, v3
    v_mov_b32 v10, 0
    ds_write_b32 v164, v10
    v_add_u32 v60, 157184, v3
    v_xor_b32 v61, 0x80, v60
    v_and_b32 v10, 6, v1
    v_and_b32 v11, 9, v1
    v_lshl_add_u32 v164, v10, 7, s52
    v_lshl_add_u32 v164, v11, 1, v164
    v_and_b32 v10, 16, v1
    v_and_b32 v11, 32, v1
    v_lshl_add_u32 v164, v10, 2, v164
    v_add_u32 v164, v11, v164
    v_and_b32 v10, 1, v6
    v_mul_u32_u24 v10, 0x48, v10
    v_and_b32 v11, 1, v8
    v_add3_u32 v166, v10, v11, 2
    v_lshl_add_u32 v10, v11, 2, v10
    v_lshrrev_b32 v11, 1, v6
    v_add_u32 v165, v10, v11
    s_mul_i32 s62, s38, 6
    s_cmp_lt_u32 s58, 64
    s_cselect_b32 s53, 13, 11
    s_cselect_b32 s54, 14, 11
    v_add_u32 v165, s62, v165
    v_and_b32 v10, 3, v165
    v_lshlrev_b32 v10, s54, v10
    v_lshl_add_u32 v10, v7, 4, v10
    v_and_b32 v11, 4, v165
    v_lshl_add_u32 v10, v11, 11, v10
    v_and_b32 v165, 0xf8, v165
    v_lshl_add_u32 v165, v165, s53, v10
    v_add_u32 v166, s62, v166
    v_and_b32 v10, 3, v166
    v_lshlrev_b32 v10, s54, v10
    v_lshl_add_u32 v10, v7, 4, v10
    v_and_b32 v11, 4, v166
    v_lshl_add_u32 v10, v11, 11, v10
    v_and_b32 v166, 0xf8, v166
    v_lshl_add_u32 v166, v166, s53, v10
    s_cselect_b32 s62, 0, 1171456
    s_lshl_b32 s53, s58, 7
    s_add_u32 s62, s62, s53
    s_add_u32 s62, s62, 262144
    s_mov_b32 s63, 6291456
    s_movk_i32 s64, -1536
    v_bfe_u32 v10, v1, 1, 1
    v_bfe_u32 v11, v1, 3, 2
    v_lshl_add_u32 v11, v10, 2, v11
    v_xor_b32 v11, s38, v11
    v_mul_u32_u24 v12, s57, v10
    v_lshl_add_u32 v12, v11, 4, v12
    v_and_b32 v10, 1, v1
    v_lshl_add_u32 v12, v10, 3, v12
    v_bfe_u32 v10, v1, 2, 2
    v_lshl_add_u32 v10, v6, 3, v10
    v_lshl_add_u32 v12, v10, 7, v12
    v_add_u32 v13, 36864, v12
    v_mov_b32 v14, 161488
    v_mov_b32 v15, 1
    s_mov_b32 s52, 0x05040100
    s_mov_b32 s53, 0x07060302
    v_mov_b32 v10, s52
    v_mov_b32 v4, 0x05040c0c
    v_mov_b32 v5, 0x01000c0c
    v_mov_b32 v6, 0x44444444
    s_mov_b32 exec_lo, 0xff00ff00
    s_mov_b32 exec_hi, 0xff00ff00
    v_mov_b32 v10, 0x03020706
    v_mov_b32 v4, 0x03020c0c
    v_mov_b32 v5, 0x07060c0c
    v_mov_b32 v6, 0xeeeeeeee
    s_mov_b64 exec, -1
    s_waitcnt lgkmcnt(0)
    v_readfirstlane_b32 s39, v167
    s_cmp_eq_u32 s59, 4
    s_cbranch_scc0 F_W8
    s_waitcnt vmcnt(0)
F_W8:
    s_sub_u32 s51, s38, 3
    s_cmp_ge_u32 s51, 8
    s_cbranch_scc1 F_NC
    s_waitcnt vmcnt(8)
    s_mov_b64 exec, 0x1
    ds_add_u32 v14, v15
    s_mov_b64 exec, -1
F_NC:
    s_waitcnt vmcnt(7)
    v_mov_b32 v19, v16
    v_mov_b32_dpp v11, v17 row_ror:8 row_mask:0xf bank_mask:0xf
    v_mov_b32_dpp v16, v18 row_ror:8 row_mask:0xf bank_mask:0xc
    v_mov_b32_dpp v18, v19 row_ror:8 row_mask:0xf bank_mask:0x3
    v_perm_b32 v152, v11, v17, v10
    v_perm_b32 v136, v18, v16, s52
    v_perm_b32 v144, v18, v16, s53
    s_waitcnt vmcnt(6)
    v_mov_b32 v23, v20
    v_mov_b32_dpp v11, v21 row_ror:8 row_mask:0xf bank_mask:0xf
    v_mov_b32_dpp v20, v22 row_ror:8 row_mask:0xf bank_mask:0xc
    v_mov_b32_dpp v22, v23 row_ror:8 row_mask:0xf bank_mask:0x3
    v_perm_b32 v153, v11, v21, v10
    v_perm_b32 v137, v22, v20, s52
    v_perm_b32 v145, v22, v20, s53
    s_waitcnt vmcnt(5)
    v_mov_b32 v27, v24
    v_mov_b32_dpp v11, v25 row_ror:8 row_mask:0xf bank_mask:0xf
    v_mov_b32_dpp v24, v26 row_ror:8 row_mask:0xf bank_mask:0xc
    v_mov_b32_dpp v26, v27 row_ror:8 row_mask:0xf bank_mask:0x3
    v_perm_b32 v154, v11, v25, v10
    v_perm_b32 v138, v26, v24, s52
    v_perm_b32 v146, v26, v24, s53
    s_waitcnt vmcnt(4)
    v_mov_b32 v31, v28
    v_mov_b32_dpp v11, v29 row_ror:8 row_mask:0xf bank_mask:0xf
    v_mov_b32_dpp v28, v30 row_ror:8 row_mask:0xf bank_mask:0xc
    v_mov_b32_dpp v30, v31 row_ror:8 row_mask:0xf bank_mask:0x3
    v_perm_b32 v155, v11, v29, v10
    v_perm_b32 v139, v30, v28, s52
    v_perm_b32 v147, v30, v28, s53
    s_waitcnt vmcnt(3)
    v_mov_b32 v35, v32
    v_mov_b32_dpp v11, v33 row_ror:8 row_mask:0xf bank_mask:0xf
    v_mov_b32_dpp v32, v34 row_ror:8 row_mask:0xf bank_mask:0xc
    v_mov_b32_dpp v34, v35 row_ror:8 row_mask:0xf bank_mask:0x3
    v_perm_b32 v156, v11, v33, v10
    v_perm_b32 v140, v34, v32, s52
    v_perm_b32 v148, v34, v32, s53
    s_waitcnt vmcnt(2)
    v_mov_b32 v39, v36
    v_mov_b32_dpp v11, v37 row_ror:8 row_mask:0xf bank_mask:0xf
    v_mov_b32_dpp v36, v38 row_ror:8 row_mask:0xf bank_mask:0xc
    v_mov_b32_dpp v38, v39 row_ror:8 row_mask:0xf bank_mask:0x3
    v_perm_b32 v157, v11, v37, v10
    v_perm_b32 v141, v38, v36, s52
    v_perm_b32 v149, v38, v36, s53
    s_waitcnt vmcnt(1)
    v_mov_b32 v43, v40
    v_mov_b32_dpp v11, v41 row_ror:8 row_mask:0xf bank_mask:0xf
    v_mov_b32_dpp v40, v42 row_ror:8 row_mask:0xf bank_mask:0xc
    v_mov_b32_dpp v42, v43 row_ror:8 row_mask:0xf bank_mask:0x3
    v_perm_b32 v158, v11, v41, v10
    v_perm_b32 v142, v42, v40, s52
    v_perm_b32 v150, v42, v40, s53
    s_waitcnt vmcnt(0)
    v_mov_b32 v47, v44
    v_mov_b32_dpp v11, v45 row_ror:8 row_mask:0xf bank_mask:0xf
    v_mov_b32_dpp v44, v46 row_ror:8 row_mask:0xf bank_mask:0xc
    v_mov_b32_dpp v46, v47 row_ror:8 row_mask:0xf bank_mask:0x3
    v_perm_b32 v159, v11, v45, v10
    v_perm_b32 v143, v46, v44, s52
    v_perm_b32 v151, v46, v44, s53
    s_cmp_ge_u32 s38, s59
    s_cbranch_scc1 F_NT
    s_movk_i32 s60, 4000
F_CP:
    ds_read_b32 v15, v14
    s_sub_u32 s60, s60, 1
    s_cmp_gt_i32 s60, 0
    s_waitcnt lgkmcnt(0)
    v_readfirstlane_b32 s52, v15
    s_nop 0
    s_cselect_b32 s52, s52, 8
    s_cmp_eq_u32 s52, 8
    s_cbranch_scc1 F_CD
    s_sleep 2
    s_branch F_CP
F_CD:
    ds_read_b64_tr_b16 v[64:65], v12 offset:0
    ds_read_b64_tr_b16 v[66:67], v12 offset:512
    ds_read_b64_tr_b16 v[68:69], v12 offset:4096
    ds_read_b64_tr_b16 v[70:71], v12 offset:4608
    ds_read_b64_tr_b16 v[72:73], v12 offset:8192
    ds_read_b64_tr_b16 v[74:75], v12 offset:8704
    ds_read_b64_tr_b16 v[76:77], v12 offset:12288
    ds_read_b64_tr_b16 v[78:79], v12 offset:12800
    ds_read_b64_tr_b16 v[80:81], v12 offset:16384
    ds_read_b64_tr_b16 v[82:83], v12 offset:16896
    ds_read_b64_tr_b16 v[84:85], v12 offset:20480
    ds_read_b64_tr_b16 v[86:87], v12 offset:20992
    ds_read_b64_tr_b16 v[88:89], v12 offset:24576
    ds_read_b64_tr_b16 v[90:91], v12 offset:25088
    ds_read_b64_tr_b16 v[92:93], v12 offset:28672
    ds_read_b64_tr_b16 v[94:95], v12 offset:29184
    ds_read_b64_tr_b16 v[96:97], v12 offset:32768
    ds_read_b64_tr_b16 v[98:99], v12 offset:33280
    ds_read_b64_tr_b16 v[100:101], v13 offset:0
    ds_read_b64_tr_b16 v[102:103], v13 offset:512
    ds_read_b64_tr_b16 v[104:105], v13 offset:4096
    ds_read_b64_tr_b16 v[106:107], v13 offset:4608
    ds_read_b64_tr_b16 v[108:109], v13 offset:8192
    ds_read_b64_tr_b16 v[110:111], v13 offset:8704
    ds_read_b64_tr_b16 v[112:113], v13 offset:12288
    ds_read_b64_tr_b16 v[114:115], v13 offset:12800
    ds_read_b64_tr_b16 v[116:117], v13 offset:16384
    ds_read_b64_tr_b16 v[118:119], v13 offset:16896
    ds_read_b64_tr_b16 v[120:121], v13 offset:20480
    ds_read_b64_tr_b16 v[122:123], v13 offset:20992
    ds_read_b64_tr_b16 v[124:125], v13 offset:24576
    ds_read_b64_tr_b16 v[126:127], v13 offset:25088
    ds_read_b64_tr_b16 v[128:129], v13 offset:28672
    ds_read_b64_tr_b16 v[130:131], v13 offset:29184
    ds_read_b64_tr_b16 v[132:133], v13 offset:32768
    ds_read_b64_tr_b16 v[134:135], v13 offset:33280
    s_waitcnt lgkmcnt(0)
    v_mov_b32 v12, 0
    v_mov_b32 v13, 0
    v_mov_b32 v14, 0
    v_mov_b32 v15, 0
F_NT:
    s_cmp_lg_u32 s38, 11
    s_cbranch_scc1 F_SEL
    s_cmp_lt_u32 s2, 192
    s_cbranch_scc1 T_EV
    v_lshrrev_b32 v7, 1, v3
    v_min_u32 v7, 16, v7
    s_and_b32 s52, s2, 31
    s_lshl_b32 s52, s52, 7
    v_add_u32 v7, s52, v7
    s_mov_b64 exec, 0xf
    s_movk_i32 s60, 4000
F_PL:
    buffer_load_dword v8, v7, s[40:43], 0 offen offset:2048 sc1
F_PL_W:
    s_waitcnt vmcnt(0)
F_PL_C:
    v_xor_b32 v9, s39, v8
    v_and_b32 v9, 0xffffdfff, v9
    v_cmp_ne_u32 vcc, 0, v9
    s_nop 0
    s_and_b64 exec, exec, vcc
    s_cbranch_execz F_PL_D
    s_sub_u32 s60, s60, 1
    s_cmp_gt_i32 s60, 0
    s_sleep 2
    s_cbranch_scc1 F_PL
F_PL_D:
    s_mov_b64 exec, 0xf
F_PL_K:
    v_lshrrev_b32 v7, 2, v3
    v_add_u32 v7, 161504, v7
    v_and_b32 v8, 0x2000, v8
    ds_write_b32 v7, v8
    s_mov_b64 exec, -1
    v_readlane_b32 s0, v8, 0
    v_readlane_b32 s1, v8, 1
    v_readlane_b32 s22, v8, 2
    s_branch T_EV
FINAL:
    s_cmp_ge_u32 s2, 144
    s_cbranch_scc1 END
    s_cmp_lg_u32 s38, 11
    s_cbranch_scc1 END
    s_branch T_EV
TOP8:
    s_and_b32 s65, s2, 3
    s_lshl_b32 s65, s65, 14
    s_and_b32 s66, s2, 4
    s_lshl_b32 s66, s66, 11
    s_xor_b32 s66, s66, s0
    s_add_u32 s65, s65, s66
    s_add_u32 s65, s65, 65536
    s_add_u32 s66, s65, 4096
    s_waitcnt lgkmcnt(0)
    buffer_load_dwordx4 v[16:19], v3, s[40:43], s65 offen offset:0 sc1
    buffer_load_dwordx4 v[20:23], v3, s[40:43], s65 offen offset:1024 sc1
    buffer_load_dwordx4 v[24:27], v3, s[40:43], s65 offen offset:2048 sc1
    buffer_load_dwordx4 v[28:31], v3, s[40:43], s65 offen offset:3072 sc1
    buffer_load_dwordx4 v[32:35], v3, s[40:43], s66 offen offset:0 sc1
    buffer_load_dwordx4 v[36:39], v3, s[40:43], s66 offen offset:1024 sc1
    buffer_load_dwordx4 v[40:43], v3, s[40:43], s66 offen offset:2048 sc1
    buffer_load_dwordx4 v[44:47], v3, s[40:43], s66 offen offset:3072 sc1
T_EV:
    v_bfe_i32 v7, v1, 0, 1
    v_bfe_i32 v8, v1, 1, 1
    v_bfe_i32 v9, v1, 3, 1
    v_bfe_i32 v11, v1, 4, 1
    v_bfe_i32 v13, v1, 5, 1
    v_xor_b32 v48, v7, v8
    v_xor_b32 v49, v8, v9
    v_xor_b32 v50, v7, v9
    v_xor_b32 v11, v11, v13
    v_xor_b32 v51, v9, v11
    v_xor_b32 v52, v8, v11
    v_xor_b32 v53, v7, v11
    v_mov_b32 v63, 161492
    v_lshl_add_u32 v13, v1, 2, v63
    v_add_u32 v13, 428, v13
    s_cmp_lt_u32 s2, 144
    s_cselect_b32 s68, 147456, 0
    v_sub_u32 v54, 1008, v3
    v_add_u32 v54, s68, v54
    v_and_b32 v7, 4, v1
    v_and_b32 v8, 48, v1
    v_lshlrev_b32 v8, 6, v8
    v_lshl_add_u32 v55, v7, 1, v8
    v_add_u32 v55, s68, v55
    s_and_b32 s65, s2, 3
    s_lshl_b32 s65, s65, 14
    s_and_b32 s66, s2, 4
    s_lshl_b32 s66, s66, 11
    s_xor_b32 s66, s66, s0
    s_add_u32 s65, s65, s66
    s_add_u32 s65, s65, 65536
    s_add_u32 s66, s65, 4096
    s_and_b32 s67, s2, 127
    s_mul_i32 s68, s67, 64
    s_add_u32 s68, s68, s65
    v_mov_b32 v10, 0
    s_cmp_lt_u32 s2, 128
    s_cbranch_scc0 T_E2
    s_movk_i32 s60, 4000
    s_mov_b64 exec, 0x1
    s_waitcnt vmcnt(8)
    buffer_store_dword v167, v10, s[40:43], s50 offen sc1
    s_mov_b64 exec, -1
    s_waitcnt vmcnt(1)
    s_branch T_KP_C
T_E2:
    v_mov_b32 v16, -1
    v_mov_b32 v17, -1
    v_mov_b32 v18, -1
    v_mov_b32 v19, -1
    v_mov_b32 v20, -1
    v_mov_b32 v21, -1
    v_mov_b32 v22, -1
    v_mov_b32 v23, -1
    v_mov_b32 v24, -1
    v_mov_b32 v25, -1
    v_mov_b32 v26, -1
    v_mov_b32 v27, -1
    v_mov_b32 v28, -1
    v_mov_b32 v29, -1
    v_mov_b32 v30, -1
    v_mov_b32 v31, -1
    v_mov_b32 v32, -1
    v_mov_b32 v33, -1
    v_mov_b32 v34, -1
    v_mov_b32 v35, -1
    v_mov_b32 v36, -1
    v_mov_b32 v37, -1
    v_mov_b32 v38, -1
    v_mov_b32 v39, -1
    v_mov_b32 v40, -1
    v_mov_b32 v41, -1
    v_mov_b32 v42, -1
    v_mov_b32 v43, -1
    v_mov_b32 v44, -1
    v_mov_b32 v45, -1
    v_mov_b32 v46, -1
    v_mov_b32 v47, -1
    s_lshr_b32 s52, s67, 3
    s_and_b32 s53, s67, 3
    s_lshl2_add_u32 s52, s52, s53
    s_lshr_b32 s53, s67, 1
    s_xor_b32 s52, s52, s53
    s_lshl_b32 s52, s52, 7
    s_and_b32 s53, s67, 4
    s_lshl_b32 s53, s53, 11
    s_add_u32 s52, s52, s53
    s_cmp_lt_u32 s67, 96
    s_cselect_b32 s53, s1, s22
    s_xor_b32 s52, s52, s53
    s_lshl_b32 s53, s67, 14
    s_add_u32 s52, s52, s53
    s_add_u32 s67, s52, 2621452
    s_mov_b64 exec, 0xf
    s_movk_i32 s60, 4000
T_EP:
    buffer_load_dword v11, v3, s[40:43], s67 offen sc1
T_EP_W:
    s_waitcnt vmcnt(0)
T_EP_C:
    v_cmp_ne_u32 vcc, s39, v11
    s_nop 0
    s_and_b64 exec, exec, vcc
    s_cbranch_execz T_EP_D
    s_sub_u32 s60, s60, 1
    s_cmp_gt_i32 s60, 0
    s_sleep 2
    s_cbranch_scc1 T_EP
T_EP_D:
T_H:
    s_mov_b64 exec, 0x1
    s_movk_i32 s60, 4000
T_HP:
    buffer_load_dword v11, v10, s[40:43], s68 offen sc1
T_HP_W:
    s_waitcnt vmcnt(0)
T_HP_C:
    v_cmp_eq_u32 vcc, -1, v11
    s_nop 0
    s_and_b64 exec, exec, vcc
    s_cbranch_execz T_HP_D
    s_sub_u32 s60, s60, 1
    s_cmp_gt_i32 s60, 0
    s_sleep 1
    s_cbranch_scc1 T_HP
T_HP_D:
    s_mov_b64 exec, -1
    s_cmp_ge_u32 s2, 144
    s_cbranch_scc0 T_KQ
    s_movk_i32 s60, 4000
T_KN:
    buffer_load_dwordx4 v[16:19], v3, s[40:43], s65 offen offset:0 sc1
    buffer_load_dwordx4 v[20:23], v3, s[40:43], s65 offen offset:1024 sc1
    buffer_load_dwordx4 v[24:27], v3, s[40:43], s65 offen offset:2048 sc1
    buffer_load_dwordx4 v[28:31], v3, s[40:43], s65 offen offset:3072 sc1
    buffer_load_dwordx4 v[32:35], v3, s[40:43], s66 offen offset:0 sc1
    buffer_load_dwordx4 v[36:39], v3, s[40:43], s66 offen offset:1024 sc1
    buffer_load_dwordx4 v[40:43], v3, s[40:43], s66 offen offset:2048 sc1
    buffer_load_dwordx4 v[44:47], v3, s[40:43], s66 offen offset:3072 sc1
    s_waitcnt vmcnt(16)
    s_sub_u32 s60, s60, 1
    v_max3_u32 v56, v16, v17, v18
    v_max3_u32 v58, v19, v20, v21
    v_max3_u32 v57, v32, v33, v34
    v_max3_u32 v59, v35, v36, v37
    v_max3_u32 v56, v56, v22, v23
    v_max3_u32 v58, v58, v24, v25
    v_max3_u32 v57, v57, v38, v39
    v_max3_u32 v59, v59, v40, v41
    v_max3_u32 v56, v56, v26, v27
    v_max3_u32 v58, v58, v28, v29
    v_max3_u32 v57, v57, v42, v43
    v_max3_u32 v59, v59, v44, v45
    v_max3_u32 v58, v58, v30, v31
    v_max3_u32 v59, v59, v46, v47
    v_max_u32 v56, v56, v58
    v_max_u32 v57, v57, v59
    v_max_u32 v58, v56, v57
    v_cmp_eq_u32 vcc, -1, v58
    s_nop 0
    s_and_b64 exec, exec, vcc
    s_cselect_b32 s60, s60, 0
    s_cmp_gt_i32 s60, 0
    s_cbranch_scc1 T_KN
    s_branch T_KP_D
T_KQ:
    s_movk_i32 s60, 4000
T_KP:
    buffer_load_dwordx4 v[16:19], v3, s[40:43], s65 offen offset:0 sc1
    buffer_load_dwordx4 v[20:23], v3, s[40:43], s65 offen offset:1024 sc1
    buffer_load_dwordx4 v[24:27], v3, s[40:43], s65 offen offset:2048 sc1
    buffer_load_dwordx4 v[28:31], v3, s[40:43], s65 offen offset:3072 sc1
    buffer_load_dwordx4 v[32:35], v3, s[40:43], s66 offen offset:0 sc1
    buffer_load_dwordx4 v[36:39], v3, s[40:43], s66 offen offset:1024 sc1
    buffer_load_dwordx4 v[40:43], v3, s[40:43], s66 offen offset:2048 sc1
    buffer_load_dwordx4 v[44:47], v3, s[40:43], s66 offen offset:3072 sc1
T_KP_W:
    s_waitcnt vmcnt(0)
T_KP_C:
    v_max3_u32 v56, v16, v17, v18
    v_max3_u32 v58, v19, v20, v21
    v_max3_u32 v57, v32, v33, v34
    v_max3_u32 v59, v35, v36, v37
    v_max3_u32 v56, v56, v22, v23
    v_max3_u32 v58, v58, v24, v25
    v_max3_u32 v57, v57, v38, v39
    v_max3_u32 v59, v59, v40, v41
    v_max3_u32 v56, v56, v26, v27
    v_max3_u32 v58, v58, v28, v29
    v_max3_u32 v57, v57, v42, v43
    v_max3_u32 v59, v59, v44, v45
    v_max3_u32 v58, v58, v30, v31
    v_max3_u32 v59, v59, v46, v47
    v_max_u32 v56, v56, v58
    v_max_u32 v57, v57, v59
    v_max_u32 v58, v56, v57
    v_cmp_eq_u32 vcc, -1, v58
    s_nop 0
    s_and_b64 exec, exec, vcc
    s_cbranch_execz T_KP_D
    s_sub_u32 s60, s60, 1
    s_cmp_gt_i32 s60, 0
    s_cbranch_scc1 T_KP
T_KP_D:
    s_mov_b64 exec, -1
    v_mov_b32_dpp v58, v56 quad_perm:[1,0,3,2] row_mask:0xf bank_mask:0xf
    v_mov_b32_dpp v59, v57 quad_perm:[1,0,3,2] row_mask:0xf bank_mask:0xf
    v_med3_u32 v56, v56, v58, v48
    v_med3_u32 v57, v57, v59, v48
    s_nop 0
    v_mov_b32_dpp v58, v56 quad_perm:[2,3,0,1] row_mask:0xf bank_mask:0xf
    v_mov_b32_dpp v59, v57 quad_perm:[2,3,0,1] row_mask:0xf bank_mask:0xf
    v_med3_u32 v56, v56, v58, v49
    v_med3_u32 v57, v57, v59, v49
    s_nop 0
    v_mov_b32_dpp v58, v56 quad_perm:[1,0,3,2] row_mask:0xf bank_mask:0xf
    v_mov_b32_dpp v59, v57 quad_perm:[1,0,3,2] row_mask:0xf bank_mask:0xf
    v_med3_u32 v56, v56, v58, v50
    v_med3_u32 v57, v57, v59, v50
    s_nop 0
    v_mov_b32_dpp v58, v56 row_ror:8 row_mask:0xf bank_mask:0xf
    v_mov_b32_dpp v59, v57 row_ror:8 row_mask:0xf bank_mask:0xf
    v_med3_u32 v56, v56, v58, v51
    v_med3_u32 v57, v57, v59, v51
    s_nop 0
    v_mov_b32_dpp v58, v56 quad_perm:[2,3,0,1] row_mask:0xf bank_mask:0xf
    v_mov_b32_dpp v59, v57 quad_perm:[2,3,0,1] row_mask:0xf bank_mask:0xf
    v_med3_u32 v56, v56, v58, v52
    v_med3_u32 v57, v57, v59, v52
    s_nop 0
    v_mov_b32_dpp v58, v56 quad_perm:[1,0,3,2] row_mask:0xf bank_mask:0xf
    v_mov_b32_dpp v59, v57 quad_perm:[1,0,3,2] row_mask:0xf bank_mask:0xf
    v_med3_u32 v56, v56, v58, v53
    v_med3_u32 v57, v57, v59, v53
    s_nop 1
    v_max_u32_dpp v56, v57, v56 row_mirror row_mask:0xf bank_mask:0xf
    s_nop 1
    v_mov_b32_dpp v58, v56 row_ror:8 row_mask:0xf bank_mask:0xf
    v_med3_u32 v56, v56, v58, v51
    s_nop 1
    v_mov_b32_dpp v58, v56 quad_perm:[2,3,0,1] row_mask:0xf bank_mask:0xf
    v_med3_u32 v56, v56, v58, v52
    s_nop 1
    v_mov_b32_dpp v58, v56 quad_perm:[1,0,3,2] row_mask:0xf bank_mask:0xf
    v_med3_u32 v56, v56, v58, v53
    s_nop 1
    v_max_u32_dpp v56, v56, v56 row_mirror row_mask:0xf bank_mask:0xf
    s_nop 1
    v_mov_b32_dpp v58, v56 row_ror:8 row_mask:0xf bank_mask:0xf
    v_med3_u32 v56, v56, v58, v51
    s_nop 1
    v_mov_b32_dpp v58, v56 quad_perm:[2,3,0,1] row_mask:0xf bank_mask:0xf
    v_med3_u32 v56, v56, v58, v52
    s_nop 1
    v_mov_b32_dpp v58, v56 quad_perm:[1,0,3,2] row_mask:0xf bank_mask:0xf
    v_med3_u32 v57, v56, v58, v53
    v_med3_u32 v56, v56, v58, v53
    s_nop 1
    v_permlane16_swap_b32 v56, v57
    v_max_u32 v56, v56, v57
    s_nop 1
    v_mov_b32_dpp v58, v56 row_ror:8 row_mask:0xf bank_mask:0xf
    v_med3_u32 v56, v56, v58, v51
    s_nop 1
    v_mov_b32_dpp v58, v56 quad_perm:[2,3,0,1] row_mask:0xf bank_mask:0xf
    v_med3_u32 v56, v56, v58, v52
    s_nop 1
    v_mov_b32_dpp v58, v56 quad_perm:[1,0,3,2] row_mask:0xf bank_mask:0xf
    v_med3_u32 v57, v56, v58, v53
    v_med3_u32 v56, v56, v58, v53
    s_nop 1
    v_permlane32_swap_b32 v56, v57
    v_max_u32 v56, v56, v57
    ds_write_b32 v13, v56
    s_cmp_lt_u32 s2, 144
    v_and_b32 v58, 0x4fc, v56
    v_lshl_or_b32 v58, v58, 2, v55
    v_mov_b32 v62, v56
    s_cbranch_scc1 T_V
    s_waitcnt lgkmcnt(0)
    s_barrier
    ds_read_b32 v7, v160
    s_waitcnt lgkmcnt(0)
    v_and_b32 v7, 0x7ff, v7
    v_mad_i32_i24 v7, v7, s64, v161
    buffer_load_dwordx4 v[8:11], v7, s[40:43], s63 offen sc1
T_V:
    ds_write_b128 v54, v[16:19] offset:7168
    ds_write_b128 v54, v[20:23] offset:6144
    ds_write_b128 v54, v[24:27] offset:5120
    ds_write_b128 v54, v[28:31] offset:4096
    ds_write_b128 v54, v[32:35] offset:3072
    ds_write_b128 v54, v[36:39] offset:2048
    ds_write_b128 v54, v[40:43] offset:1024
    ds_write_b128 v54, v[44:47] offset:0
    ds_read_b64 v[56:57], v58
    v_min_u32_dpp v58, v62, v62 quad_perm:[1,0,3,2] row_mask:0xf bank_mask:0xf
    s_nop 1
    v_min_u32_dpp v58, v58, v58 quad_perm:[2,3,0,1] row_mask:0xf bank_mask:0xf
    s_nop 1
    v_min_u32_dpp v58, v58, v58 row_ror:8 row_mask:0xf bank_mask:0xf
    s_waitcnt lgkmcnt(0)
    v_cmp_ge_u32 vcc, v56, v58
    v_cmp_ge_u32 s[52:53], v57, v58
    s_bcnt1_i32_b64 s54, vcc
    s_bcnt1_i32_b64 s52, s[52:53]
    s_add_u32 s52, s52, s54
    s_cmp_eq_u32 s52, 8
    s_cbranch_scc0 T_M
T_OK:
    s_movk_i32 s60, 4000
    s_cmp_lt_u32 s2, 144
    s_cbranch_scc1 FIN
    s_setprio 0
    s_branch F_ZP_W
T_M:
    v_cmp_ne_u32 s[56:57], v62, v56
    v_cmp_ne_u32 s[74:75], v62, v57
    s_nop 0
    v_cndmask_b32 v56, 0, v56, s[56:57]
    v_cndmask_b32 v57, 0, v57, s[74:75]
    s_mov_b64 s[72:73], -1
T_L:
    v_max_u32 v59, v56, v57
    v_cmp_gt_u32 vcc, v59, v58
    s_nop 4
    s_cbranch_vccz T_X
    s_ff1_i32_b64 s52, vcc
    v_cmp_eq_u32 vcc, v62, v58
    v_readlane_b32 s53, v59, s52
    s_ff1_i32_b64 s54, vcc
    s_cmp_lt_u32 s2, 144
    s_cbranch_scc1 T_L2
    s_and_b32 s55, s53, 0x7ff
    s_mul_i32 s55, s55, s64
    s_add_u32 s55, s55, 9435648
    buffer_load_dwordx4 v[64:67], v3, s[40:43], s55 offen sc1
    buffer_load_dwordx4 v[68:71], v3, s[40:43], s55 offen offset:1024 sc1
T_L2:
    v_mov_b32 v59, s53
    v_cndmask_b32 v62, v62, v59, vcc
    v_cmp_ne_u32 s[56:57], s53, v56
    v_cmp_ne_u32 s[74:75], s53, v57
    s_nop 0
    v_cndmask_b32 v56, 0, v56, s[56:57]
    v_cndmask_b32 v57, 0, v57, s[74:75]
    v_min_u32_dpp v58, v62, v62 quad_perm:[1,0,3,2] row_mask:0xf bank_mask:0xf
    s_nop 1
    v_min_u32_dpp v58, v58, v58 quad_perm:[2,3,0,1] row_mask:0xf bank_mask:0xf
    s_nop 1
    v_min_u32_dpp v58, v58, v58 row_ror:8 row_mask:0xf bank_mask:0xf
    s_cmp_lt_u32 s2, 144
    s_cbranch_scc1 T_L
    s_lshr_b32 s52, s54, 1
    s_and_b32 s52, s52, 4
    s_and_b32 s54, s54, 3
    s_add_u32 s54, s54, s52
    s_mul_i32 s54, s54, 608
    s_add_u32 s54, s54, 147456
    v_and_b32 v72, 1, v1
    v_mul_u32_u24 v72, 4862, v72
    v_mul_u32_u24 v73, 6, v1
    v_sub_u32 v74, v73, v72
    v_add_u32 v73, v73, v72
    v_add_u32 v75, s54, v73
    v_add_u32 v76, s54, v74
    s_mov_b64 exec, s[72:73]
    s_movk_i32 s60, 4000
    s_branch T_Z_W
T_Z:
    buffer_load_dwordx4 v[8:11], v7, s[40:43], s63 offen sc1
T_Z_W:
    s_waitcnt vmcnt(0)
T_Z_C:
    v_cmp_ne_u32 vcc, s39, v11
    s_nop 0
    s_and_b64 exec, exec, vcc
    s_cbranch_execz T_Z_D
    s_wqm_b64 exec, exec
    s_sub_u32 s60, s60, 1
    s_cmp_gt_i32 s60, 0
    s_cbranch_scc1 T_Z
T_Z_D:
    s_mov_b64 exec, s[72:73]
    ds_write2_b32 v162, v8, v10 offset0:0 offset1:1
    ds_write_b32 v2, v9
    s_mov_b64 s[72:73], 0
    s_mov_b64 exec, -1
    s_movk_i32 s60, 4000
    s_branch T_F_W
T_F:
    buffer_load_dwordx4 v[64:67], v3, s[40:43], s55 offen sc1
    buffer_load_dwordx4 v[68:71], v3, s[40:43], s55 offen offset:1024 sc1
T_F_W:
    s_waitcnt vmcnt(0)
T_F_C:
    v_cmp_ne_u32 vcc, s39, v67
    v_cmp_ne_u32 s[56:57], s39, v71
    s_nop 0
    s_or_b32 vcc_lo, vcc_lo, s56
    s_and_b64 exec, exec, vcc
    s_cbranch_execz T_F_D
    s_wqm_b64 exec, exec
    s_sub_u32 s60, s60, 1
    s_cmp_gt_i32 s60, 0
    s_cbranch_scc1 T_F
T_F_D:
    s_mov_b64 exec, -1
    s_movk_i32 s60, 4000
T_C:
    ds_read_b32 v72, v63 offset:0
    s_sub_u32 s60, s60, 1
    s_cmp_gt_i32 s60, 0
    s_waitcnt lgkmcnt(0)
    v_readfirstlane_b32 s52, v72
    s_nop 0
    s_cselect_b32 s52, s52, 11
    s_cmp_lg_u32 s52, 11
    s_cbranch_scc1 T_C
    ds_write2_b32 v75, v64, v66 offset0:0 offset1:1
    ds_write_b32 v76, v65 offset:4864
    s_mov_b32 exec_hi, 0
    ds_write2_b32 v75, v68, v70 offset0:96 offset1:97
    ds_write_b32 v76, v69 offset:5248
    s_mov_b64 exec, -1
    s_branch T_L
T_X:
    s_movk_i32 s60, 4000
    s_cmp_lt_u32 s2, 144
    s_cbranch_scc1 FIN
    s_setprio 0
    s_branch F_BQ
F_SEL:
    s_setprio 0
    s_waitcnt lgkmcnt(0)
    s_barrier
    ds_read_b32 v7, v160
    s_waitcnt lgkmcnt(0)
    v_and_b32 v7, 0x7ff, v7
    v_mad_i32_i24 v7, v7, s64, v161
    s_movk_i32 s60, 4000
F_ZP:
    buffer_load_dwordx4 v[8:11], v7, s[40:43], s63 offen sc1
F_ZP_W:
    s_waitcnt vmcnt(0)
F_ZP_C:
    v_cmp_ne_u32 vcc, s39, v11
    s_nop 0
    s_and_b64 exec, exec, vcc
    s_cbranch_execz F_ZP_D
    s_wqm_b64 exec, exec
    s_sub_u32 s60, s60, 1
    s_cmp_gt_i32 s60, 0
    s_cbranch_scc1 F_ZP
F_ZP_D:
    s_mov_b64 exec, -1
    ds_write2_b32 v162, v8, v10 offset0:0 offset1:1
    ds_write_b32 v2, v9
    s_mov_b64 exec, 0x1
    ds_inc_u32 v63, v63 offset:0
    s_mov_b64 exec, -1
F_BQ:
    s_cmp_ge_u32 s38, s59
    s_waitcnt lgkmcnt(0)
    s_barrier
    s_cbranch_scc1 F_H
    ds_read_b128 v[16:19], v163 offset:0
    ds_read_b128 v[20:23], v163 offset:64
    ds_read_b128 v[24:27], v163 offset:128
    ds_read_b128 v[28:31], v163 offset:192
    ds_read_b128 v[32:35], v163 offset:256
    ds_read_b128 v[36:39], v163 offset:320
    ds_read_b128 v[40:43], v163 offset:384
    ds_read_b128 v[44:47], v163 offset:448
    ds_read_b128 v[48:51], v163 offset:512
    s_waitcnt lgkmcnt(8)
    v_smfmac_f32_16x16x64_bf16 v[12:15], v[16:19], v[64:71], v6
    s_waitcnt lgkmcnt(7)
    v_smfmac_f32_16x16x64_bf16 v[12:15], v[20:23], v[72:79], v6
    s_waitcnt lgkmcnt(6)
    v_smfmac_f32_16x16x64_bf16 v[12:15], v[24:27], v[80:87], v6
    s_waitcnt lgkmcnt(5)
    v_smfmac_f32_16x16x64_bf16 v[12:15], v[28:31], v[88:95], v6
    s_waitcnt lgkmcnt(4)
    v_smfmac_f32_16x16x64_bf16 v[12:15], v[32:35], v[96:103], v6
    s_waitcnt lgkmcnt(3)
    v_smfmac_f32_16x16x64_bf16 v[12:15], v[36:39], v[104:111], v6
    s_waitcnt lgkmcnt(2)
    v_smfmac_f32_16x16x64_bf16 v[12:15], v[40:43], v[112:119], v6
    s_waitcnt lgkmcnt(1)
    v_smfmac_f32_16x16x64_bf16 v[12:15], v[44:47], v[120:127], v6
    s_waitcnt lgkmcnt(0)
    v_smfmac_f32_16x16x64_bf16 v[12:15], v[48:51], v[128:135], v6
    s_nop 7
    v_permlane32_swap_b32 v12, v14
    v_permlane32_swap_b32 v13, v15
    v_add_f32 v12, v12, v14
    v_add_f32 v13, v13, v15
    v_cvt_pk_bf16_f32 v12, v12, v13
    s_nop 1
    v_mov_b32_dpp v13, v12 row_ror:8 row_mask:0xf bank_mask:0xf
    v_perm_b32 v8, v12, v13, v4
    v_mul_f32 v10, 0xbfb8aa3b, v8
    v_exp_f32 v10, v10
    v_perm_b32 v9, v12, v13, v5
    v_add_f32 v10, 1.0, v10
    v_rcp_f32 v10, v10
    s_nop 0
    v_mul_f32 v8, v8, v10
    v_cvt_pk_bf16_f32 v8, v8, v8
    v_lshlrev_b32 v8, 16, v8
    v_mul_f32 v8, v8, v9
    v_cvt_pk_bf16_f32 v8, v8, v8
    ds_write_b16 v164, v8
F_H:
    ds_read_b32 v56, v63 offset:12
    s_waitcnt lgkmcnt(0)
    s_barrier
    ds_read_b128 v[16:19], v60
    ds_read_b128 v[20:23], v60 offset:1024
    ds_read_b128 v[24:27], v61
    ds_read_b128 v[28:31], v61 offset:1024
    v_xor_b32 v165, v56, v165
    v_xor_b32 v166, v56, v166
    s_waitcnt lgkmcnt(3)
    v_mfma_f32_16x16x32_bf16 v[12:15], v[16:19], v[152:155], 0
    v_mfma_f32_16x16x32_bf16 v[8:11], v[16:19], v[136:139], 0
    s_waitcnt lgkmcnt(2)
    v_mfma_f32_16x16x32_bf16 v[12:15], v[20:23], v[156:159], v[12:15]
    v_mfma_f32_16x16x32_bf16 v[8:11], v[20:23], v[140:143], v[8:11]
    s_waitcnt lgkmcnt(1)
    v_mfma_f32_16x16x32_bf16 v[8:11], v[24:27], v[144:147], v[8:11]
    s_waitcnt lgkmcnt(0)
    v_mfma_f32_16x16x32_bf16 v[8:11], v[28:31], v[148:151], v[8:11]
    s_mov_b32 exec_hi, 0
    s_nop 1
    buffer_store_dwordx4 v[12:15], v166, s[40:43], s62 offen sc1
    s_mov_b64 exec, -1
    s_nop 2
    buffer_store_dwordx4 v[8:11], v165, s[40:43], s62 offen sc1
    s_branch END
FIN:
    s_cmp_ge_u32 s2, 72
    s_cselect_b32 s44, 32, 0
    s_cselect_b32 s45, 72, 0
    s_sub_u32 s45, s2, s45
    s_mul_i32 s46, s45, 43
    s_lshr_b32 s46, s46, 8
    s_mul_i32 s47, s46, 6
    s_sub_u32 s47, s45, s47
    v_lshrrev_b32 v6, 4, v1
    s_lshr_b32 s54, s2, 3
    s_lshl_b32 s55, s54, 16
    s_add_u32 s55, s55, s65
    s_add_u32 s55, s55, 196608
    v_mov_b32 v15, 0
    s_mov_b64 exec, 0x1
    buffer_load_dword v14, v15, s[40:43], s55 offen sc1
    s_mov_b64 exec, -1
    v_lshl_add_u32 v7, v6, 2, s44
    ds_bpermute_b32 v7, v7, v62
    v_and_b32 v8, 7, v1
    v_and_b32 v5, 15, v1
    s_lshl_b32 s48, s47, 2
    s_add_u32 s49, s48, 16384 - 16
    s_cmp_eq_u32 s47, 3
    s_cselect_b32 s49, 16384 + 8, s49
    s_cmp_lt_u32 s47, 3
    s_cselect_b32 s48, s48, s49
    s_cmp_lt_u32 s46, 6
    s_cselect_b32 s1, s1, s22
    s_and_b32 s49, s46, 7
    s_lshl_b32 s49, s49, 10
    s_or_b32 s1, s1, s49
    s_lshl_b32 s49, s46, 18
    s_add_u32 s48, s48, s49
    s_add_u32 s48, s48, 2621440
    s_lshl_b32 s47, s47, 1
    s_lshl_b32 s49, s46, 7
    s_add_u32 s49, s49, s47
    s_add_u32 s49, s49, 6291456
    s_mul_i32 s46, s46, 96
    s_add_u32 s46, s46, s47
    s_movk_i32 s47, 8192
    s_mov_b32 s52, s55
    s_lshl_b32 s54, s54, 14
    s_and_b32 s53, s55, 0x2000
    s_add_u32 s54, s54, s53
    s_and_b32 s53, s2, 3
    s_lshl_b32 s53, s53, 11
    s_add_u32 s54, s54, s53
    s_add_u32 s54, s54, 1441792
    s_add_u32 s53, s52, 4096
    v_mov_b32 v60, 0
    v_mov_b32 v61, 0
    v_mov_b32 v62, 0
    s_waitcnt lgkmcnt(0)
    v_and_b32 v9, 0x7ff, v7
    v_sub_u32 v9, 0x7ff, v9
    v_lshrrev_b32 v10, 4, v9
    v_lshlrev_b32 v11, 6, v10
    v_min_u32 v5, 11, v5
    v_lshl_add_u32 v11, v5, 2, v11
    v_mul_u32_u24 v12, 0x480, v9
    v_mad_u32_u24 v12, v8, 12, v12
    v_add_u32 v12, s46, v12
    v_and_b32 v13, 0x30, v9
    v_and_b32 v10, 0x780, v9
    v_lshlrev_b32 v10, 2, v10
    v_lshl_add_u32 v10, v13, 3, v10
    v_and_b32 v13, 0x40, v9
    v_lshl_add_u32 v10, v13, 7, v10
    v_mul_u32_u24 v13, 0x8080, v8
    v_xor_b32 v10, v13, v10
    v_xor_b32 v10, s1, v10
    v_and_b32 v13, 14, v9
    v_lshl_add_u32 v10, v13, 3, v10
    v_and_b32 v13, 1, v9
    v_lshl_add_u32 v10, v13, 1, v10
    v_mul_u32_u24 v9, 0x600, v9
    v_lshl_add_u32 v9, v8, 4, v9
    global_load_short_d16_hi v60, v12, s[4:5]
    buffer_load_short_d16_hi v61, v10, s[40:43], s48 offen sc1
    v_ashrrev_i32 v6, 31, v7
    v_not_b32 v6, v6
    v_or_b32 v6, 0x80000000, v6
    v_xor_b32 v7, v7, v6
    v_and_b32 v7, 0xffff0000, v7
    v_mul_f32 v7, 0xbfb8aa3b, v7
    v_exp_f32 v7, v7
    s_nop 0
    v_add_f32 v7, 1.0, v7
    v_rcp_f32 v7, v7
    s_nop 0
    v_cvt_pk_bf16_f32 v7, v7, v7
    v_lshlrev_b32 v7, 16, v7
    s_mov_b64 exec, 0x1
    s_movk_i32 s60, 4000
    s_waitcnt vmcnt(2)
    s_branch FN_HP_C
    s_movk_i32 s60, 4000
FN_HP:
    buffer_load_dword v14, v15, s[40:43], s55 offen sc1
FN_HP_W:
    s_waitcnt vmcnt(0)
FN_HP_C:
    v_cmp_eq_u32 vcc, -1, v14
    s_nop 0
    s_and_b64 exec, exec, vcc
    s_cbranch_execz FN_HP_D
    s_sub_u32 s60, s60, 1
    s_cmp_gt_i32 s60, 0
    s_cbranch_scc1 FN_HP
FN_HP_D:
    s_mov_b64 exec, -1
    buffer_load_dword v13, v11, s[40:43], s47 offen sc1
    buffer_load_short_d16_hi v62, v9, s[40:43], s49 offen sc1
    buffer_load_dwordx4 v[16:19], v3, s[40:43], s52 offen offset:0 sc1
    buffer_load_dwordx4 v[20:23], v3, s[40:43], s52 offen offset:1024 sc1
    buffer_load_dwordx4 v[24:27], v3, s[40:43], s52 offen offset:2048 sc1
    buffer_load_dwordx4 v[28:31], v3, s[40:43], s52 offen offset:3072 sc1
    buffer_load_dwordx4 v[32:35], v3, s[40:43], s53 offen offset:0 sc1
    buffer_load_dwordx4 v[36:39], v3, s[40:43], s53 offen offset:1024 sc1
    buffer_load_dwordx4 v[40:43], v3, s[40:43], s53 offen offset:2048 sc1
    buffer_load_dwordx4 v[44:47], v3, s[40:43], s53 offen offset:3072 sc1
    buffer_load_dwordx4 v[48:51], v3, s[40:43], s54 offen offset:0 sc1
    buffer_load_dwordx4 v[52:55], v3, s[40:43], s54 offen offset:1024 sc1
    s_waitcnt vmcnt(12)
    v_add_f32 v60, v60, v61
    v_cvt_pk_bf16_f32 v60, v60, v60
    v_lshlrev_b32 v60, 16, v60
    s_movk_i32 s60, 4000
    s_branch FN_PP_W
FN_PP:
    buffer_load_dword v13, v11, s[40:43], s47 offen sc1
    buffer_load_short_d16_hi v62, v9, s[40:43], s49 offen sc1
    buffer_load_dwordx4 v[16:19], v3, s[40:43], s52 offen offset:0 sc1
    buffer_load_dwordx4 v[20:23], v3, s[40:43], s52 offen offset:1024 sc1
    buffer_load_dwordx4 v[24:27], v3, s[40:43], s52 offen offset:2048 sc1
    buffer_load_dwordx4 v[28:31], v3, s[40:43], s52 offen offset:3072 sc1
    buffer_load_dwordx4 v[32:35], v3, s[40:43], s53 offen offset:0 sc1
    buffer_load_dwordx4 v[36:39], v3, s[40:43], s53 offen offset:1024 sc1
    buffer_load_dwordx4 v[40:43], v3, s[40:43], s53 offen offset:2048 sc1
    buffer_load_dwordx4 v[44:47], v3, s[40:43], s53 offen offset:3072 sc1
    buffer_load_dwordx4 v[48:51], v3, s[40:43], s54 offen offset:0 sc1
    buffer_load_dwordx4 v[52:55], v3, s[40:43], s54 offen offset:1024 sc1
FN_PP_W:
    s_waitcnt vmcnt(0)
FN_PP_C:
    v_cmp_ne_u32 s[56:57], s39, v13
    v_pk_add_f32 v[64:65], v[16:17], v[20:21]
    v_pk_add_f32 v[68:69], v[24:25], v[28:29]
    v_pk_add_f32 v[66:67], v[18:19], v[22:23]
    v_pk_add_f32 v[70:71], v[26:27], v[30:31]
    v_pk_add_f32 v[64:65], v[64:65], v[32:33]
    v_pk_add_f32 v[66:67], v[66:67], v[34:35]
    v_pk_add_f32 v[68:69], v[68:69], v[36:37]
    v_pk_add_f32 v[70:71], v[70:71], v[38:39]
    v_pk_add_f32 v[64:65], v[64:65], v[40:41]
    v_pk_add_f32 v[66:67], v[66:67], v[42:43]
    v_pk_add_f32 v[68:69], v[68:69], v[44:45]
    v_pk_add_f32 v[70:71], v[70:71], v[46:47]
    v_pk_add_f32 v[64:65], v[64:65], v[48:49]
    v_pk_add_f32 v[66:67], v[66:67], v[50:51]
    v_pk_add_f32 v[68:69], v[68:69], v[52:53]
    v_pk_add_f32 v[70:71], v[70:71], v[54:55]
    v_pk_add_f32 v[64:65], v[64:65], v[68:69]
    v_pk_add_f32 v[66:67], v[66:67], v[70:71]
    v_pk_add_f32 v[68:69], v[64:65], v[66:67]
    v_cmp_u_f32 vcc, v68, v69
    s_nop 0
    s_or_b64 vcc, vcc, s[56:57]
    s_and_b64 exec, exec, vcc
    s_cbranch_execz FN_PP_D
    s_sub_u32 s60, s60, 1
    s_cmp_gt_i32 s60, 0
    s_cbranch_scc1 FN_PP
FN_PP_D:
    s_mov_b64 exec, -1
    v_permlane32_swap_b32 v64, v66
    v_permlane32_swap_b32 v65, v67
    v_add_f32 v64, v64, v66
    v_add_f32 v65, v65, v67
    s_nop 1
    v_permlane16_swap_b32 v64, v65
    v_add_f32 v64, v64, v65
    s_nop 1
    v_add_f32_dpp v64, v64, v64 row_ror:8 row_mask:0xf bank_mask:0xf
    v_cvt_pk_bf16_f32 v64, v64, v64
    v_lshlrev_b32 v64, 16, v64
    v_mul_f32 v64, v64, v7
    v_cvt_pk_bf16_f32 v64, v64, v64
    v_lshlrev_b32 v64, 16, v64
    v_add_f32 v64, v64, v62
    v_cvt_pk_bf16_f32 v64, v64, v64
    v_lshlrev_b32 v64, 16, v64
    v_add_f32 v64, v64, v60
    v_cvt_pk_bf16_f32 v64, v64, v64
    s_mov_b32 exec_lo, 0xff00ff
    s_mov_b32 exec_hi, 0xff00ff
    global_store_short v12, v64, s[32:33]
    s_mov_b64 exec, -1
END:
    s_endpgm
CODE_END:
.section .rodata,"a"
.p2align 6
.amdhsa_kernel sequential_preLN__ssm_conv_s4__moe_arch_mod__prompt_kernel
  .amdhsa_next_free_vgpr 168
  .amdhsa_next_free_sgpr 102
  .amdhsa_accum_offset 168
  .amdhsa_group_segment_fixed_size 0
  .amdhsa_kernarg_size 136
  .amdhsa_user_sgpr_count 2
  .amdhsa_user_sgpr_kernarg_segment_ptr 1
  .amdhsa_system_sgpr_workgroup_id_x 1
.end_amdhsa_kernel
```
